```python
import torch

def _softmax(x, axis=-1):
    return torch.softmax(x, dim=axis)

def _gelu(x):
    return torch.nn.functional.gelu(x, approximate='tanh')

def _silu(x):
    return torch.nn.functional.silu(x)

def _sigmoid(x):
    return torch.sigmoid(x)

def _layernorm(x, axis=-1, eps=1e-05):
    m = x.mean(dim=axis, keepdim=True)
    v = x.var(dim=axis, keepdim=True, unbiased=False)
    return (x - m) / torch.sqrt(v + eps)

def _scatter_add(tgt, idx, src, axis=0):
    return tgt.clone().index_add_(axis, idx, src)

def _segment_sum(src, seg, n):
    out = torch.zeros((n,) + src.shape[1:], dtype=src.dtype)
    return out.index_add_(0, seg, src)

def _pad(x, pw):
    flat = tuple((v for pair in reversed(pw) for v in pair))
    return torch.nn.functional.pad(x, flat)
kernel_name = 'adaLN_cond__compressed_kv_cla__mixer_gmlp__prompt'

def setup_inputs():

    _w = lambda a: (lambda t: t.to(torch.bfloat16) if t.is_floating_point() else t)(torch.as_tensor(a))

    def _A_setup():
        B, H, Sq, Sk, D, M = (1, 32, 2048, 2048, 128, 640)
        Dc = 4 * D
        return {'x': _w((lambda *s: torch.randn(*s, dtype=torch.bfloat16) * 0.05)(B, Sq, M)), 'c_kv': _w((lambda *s: torch.randn(*s, dtype=torch.bfloat16) * 1.6)(B, Sk, Dc)), 'w_q': _w((lambda *s: torch.randn(*s, dtype=torch.bfloat16) * 0.8)(M, H, D) * M ** (-0.5)), 'w_uk': _w((lambda *s: torch.randn(*s, dtype=torch.bfloat16) * 0.8)(Dc, H, D) * Dc ** (-0.5)), 'w_uv': _w((lambda *s: torch.randn(*s, dtype=torch.bfloat16) * 1.6)(Dc, H, D) * Dc ** (-0.5)), 'w_o': _w((lambda *s: torch.randn(*s, dtype=torch.bfloat16) * 1.6)(H, D, M) * (H * D) ** (-0.5))}
    _A_in = _A_setup()

    def _B_setup():
        B, S, D, F = (1, 2048, 640, 1728)
        Fh = F // 2
        return {'x': _w((lambda *s: torch.randn(*s, dtype=torch.bfloat16) * 0.05)(B, S, D)), 'w_in': _w((lambda *s: torch.randn(*s, dtype=torch.bfloat16) * 0.4)(D, 2 * Fh)), 'w_sp': _w(0.01 * (lambda *s: torch.randn(*s, dtype=torch.bfloat16) * 0.4)(S, S)), 'b_sp': _w(1.0 + 0.01 * (lambda *s: torch.randn(*s, dtype=torch.bfloat16) * 0.05)(S)), 'w_out': _w((lambda *s: torch.randn(*s, dtype=torch.bfloat16) * 0.05)(Fh, D))}
    _B_in = _B_setup()
    return {'A_x': _A_in['x'], 'A_c_kv': _A_in['c_kv'], 'A_w_q': _A_in['w_q'], 'A_w_uk': _A_in['w_uk'], 'A_w_uv': _A_in['w_uv'], 'A_w_o': _A_in['w_o'], 'B_x': _B_in['x'], 'B_w_in': _B_in['w_in'], 'B_w_sp': _B_in['w_sp'], 'B_b_sp': _B_in['b_sp'], 'B_w_out': _B_in['w_out'], 'c': _w((lambda *s: torch.randn(*s, dtype=torch.bfloat16) * 0.1)(1, 640) * 8.0), 'w_mod': _w((lambda *s: torch.randn(*s, dtype=torch.bfloat16) * 0.1)(640, 6 * 640) * 640 ** (-0.5) * 8.0)}

def reference(A_x, A_c_kv, A_w_q, A_w_uk, A_w_uv, A_w_o, B_x, B_w_in, B_w_sp, B_b_sp, B_w_out, c, w_mod):

    def _A_ref(x, c_kv, w_q, w_uk, w_uv, w_o):
        B, Sq, M = (x.shape[0], x.shape[1], x.shape[2])
        Sk = c_kv.shape[1]
        H, D = (w_q.shape[1], w_q.shape[2])
        q = torch.einsum('bqm,mhd->bhqd', x, w_q)
        k = torch.einsum('bkc,chd->bhkd', c_kv, w_uk)
        v = torch.einsum('bkc,chd->bhkd', c_kv, w_uv)
        scores = torch.einsum('bhqd,bhkd->bhqk', q, k) * D ** (-0.5)
        off = Sk - Sq
        qi = torch.arange(Sq)[:, None]
        kj = torch.arange(Sk)[None, :]
        cmask = kj <= qi + off
        scores = torch.where(cmask[None, None], scores, -1000000000.0)
        p = _softmax(scores, axis=-1)
        ctx = torch.einsum('bhqk,bhkd->bhqd', p, v)
        return torch.einsum('bhqd,hdm->bqm', ctx, w_o)

    def _B_ref(x, w_in, w_sp, b_sp, w_out):
        B, S, D = x.shape
        F = w_in.shape[-1]
        Fh = F // 2
        z = _gelu(torch.einsum('bsd,df->bsf', x, w_in))
        z1 = z[..., :Fh].clone()
        z2 = _layernorm(z[..., Fh:], axis=-1)
        g = torch.einsum('ts,bsf->btf', w_sp, z2) + b_sp[None, :, None]
        return torch.einsum('bsf,fd->bsd', z1 * g, w_out)
    x = A_x
    mod = (_silu(c) @ w_mod).reshape(c.shape[0], 6, 1, -1)
    sa, ca, ga, sb, cb, gb = (mod[:, 0].clone(), mod[:, 1].clone(), mod[:, 2].clone(), mod[:, 3].clone(), mod[:, 4].clone(), mod[:, 5].clone())
    h = _layernorm(x, axis=-1) * (1 + ca) + sa
    x = x + ga * _A_ref(h, A_c_kv, A_w_q, A_w_uk, A_w_uv, A_w_o)
    h = _layernorm(x, axis=-1) * (1 + cb) + sb
    x = x + gb * _B_ref(h, B_w_in, B_w_sp, B_b_sp, B_w_out)
    return x
```

```asm
; @launch grid=(256,1,1) block=(256,1,1) lds=163840
.amdgcn_target "amdgcn-amd-amdhsa--gfx950"
.text
.globl adaLN_cond__compressed_kv_cla__mixer_gmlp__prompt_kernel
.p2align 8
.type adaLN_cond__compressed_kv_cla__mixer_gmlp__prompt_kernel,@function
adaLN_cond__compressed_kv_cla__mixer_gmlp__prompt_kernel:
  s_cmp_ge_u32 s2, 256
  s_cbranch_scc1 L_end
L_go:
  s_load_dwordx2 s[12:13], s[0:1], 8
  s_load_dwordx2 s[20:21], s[0:1], 24
  s_load_dwordx2 s[24:25], s[0:1], 32
  s_load_dwordx2 s[8:9], s[0:1], 0
  s_load_dwordx2 s[16:17], s[0:1], 16
  s_load_dwordx2 s[28:29], s[0:1], 120
  s_load_dwordx2 s[32:33], s[0:1], 112
  s_load_dwordx2 s[36:37], s[0:1], 96
  s_load_dwordx2 s[40:41], s[0:1], 88
  v_lshrrev_b32 v1, 6, v0
  v_and_b32 v0, 63, v0
  v_readfirstlane_b32 s48, v1
  s_and_b32 s51, s2, 7
  s_lshr_b32 s52, s2, 3
  s_and_b32 s49, s52, 3
  s_lshl_b32 s53, s51, 2
  s_add_u32 s49, s49, s53
  s_lshr_b32 s50, s52, 2
  s_getpc_b64 s[4:5]
L_pc1:
  s_lshl_b32 s6, s52, 2
  s_add_u32 s6, s6, s48
  s_lshl_b32 s6, s6, 10
  v_and_b32 v91, 7, v0
  v_lshl_add_u32 v91, v91, 7, s6
  v_min_u32 v91, code_end - L_pc1 - 4, v91
  global_load_dword v23, v91, s[4:5]
  v_lshrrev_b32 v21, 4, v0
  v_and_b32 v22, 15, v0
  v_and_b32 v24, 7, v0
  v_xor_b32 v24, v24, v21
  v_lshrrev_b32 v25, 3, v0
  v_lshlrev_b32 v25, 10, v25
  v_lshl_add_u32 v1, v24, 4, v25
  v_xor_b32 v2, 64, v1
  v_add_u32 v2, 8192, v2
  v_lshlrev_b32 v24, 1, v21
  v_xor_b32 v24, v22, v24
  v_lshlrev_b32 v25, 13, v21
  v_lshl_add_u32 v3, v24, 4, v25
  v_xor_b32 v4, 128, v3
  s_mov_b32 s14, 0x200000
  s_mov_b32 s15, 0x20000
  s_waitcnt lgkmcnt(0)
  s_cmp_ge_u32 s48, 2
  s_cselect_b32 s44, s24, s20
  s_cselect_b32 s45, s25, s21
  s_mov_b32 s46, 0x400000
  s_mov_b32 s47, 0x20000
  s_sub_u32 s58, 15, s50
  s_mov_b32 s59, s50
  s_and_b32 s51, s48, 1
  s_lshl_b32 s55, s51, 18
  s_lshl_b32 s52, s49, 8
  s_add_u32 s55, s55, s52
  s_cmp_ge_u32 s48, 2
  s_cselect_b32 s54, s59, s58
  s_lshl_b32 s54, s54, 17
  s_lshl_b32 s53, s51, 16
  s_add_u32 s54, s54, s53
  s_lshl_b32 s56, s48, 13
  s_add_u32 m0, s56, 65536
  s_add_u32 s51, s54, 0
  buffer_load_dwordx4 v1, s[12:15], s51 offen lds
  s_add_u32 m0, s56, 66560
  s_add_u32 s51, s54, 0
  buffer_load_dwordx4 v2, s[12:15], s51 offen lds
  s_add_u32 m0, s56, 67584
  s_add_u32 s51, s54, 16384
  buffer_load_dwordx4 v1, s[12:15], s51 offen lds
  s_add_u32 m0, s56, 68608
  s_add_u32 s51, s54, 16384
  buffer_load_dwordx4 v2, s[12:15], s51 offen lds
  s_add_u32 m0, s56, 69632
  s_add_u32 s51, s54, 32768
  buffer_load_dwordx4 v1, s[12:15], s51 offen lds
  s_add_u32 m0, s56, 70656
  s_add_u32 s51, s54, 32768
  buffer_load_dwordx4 v2, s[12:15], s51 offen lds
  s_add_u32 m0, s56, 71680
  s_add_u32 s51, s54, 49152
  buffer_load_dwordx4 v1, s[12:15], s51 offen lds
  s_add_u32 m0, s56, 72704
  s_add_u32 s51, s54, 49152
  buffer_load_dwordx4 v2, s[12:15], s51 offen lds
  s_and_b32 s6, s48, 1
  v_lshrrev_b32 v24, 1, v0
  v_lshlrev_b32 v24, 13, v24
  v_and_b32 v25, 1, v0
  v_lshl_add_u32 v24, v25, 7, v24
  v_mov_b32 v25, 0x40000000
  v_cmp_gt_u32 vcc, 16, v0
  s_nop 1
  v_cndmask_b32 v12, v25, v24, vcc
  v_lshlrev_b32 v26, 7, v0
  v_cndmask_b32 v26, v25, v26, vcc
  v_cmp_gt_u32 vcc, 20, v0
  s_nop 1
  v_cndmask_b32 v13, v25, v24, vcc
  s_lshl_b32 s57, s6, 19
  s_lshl_b32 s53, s50, 16
  s_add_u32 s57, s57, s53
  s_add_u32 s57, s57, s52
  s_lshl_b32 s53, s2, 2
  s_add_u32 s53, s53, s48
  s_lshl_b32 s53, s53, 11
  v_add_u32 v90, s53, v26
  s_add_u32 s6, s57, 524288
  buffer_load_dword v23, v90, s[12:15], 0 offen
  buffer_load_dword v23, v12, s[44:47], s6 offen
  s_mov_b32 s10, 0x280000
  s_mov_b32 s11, 0x20000
  s_mov_b32 s18, 0x500000
  s_mov_b32 s19, 0x20000
  s_mov_b32 s22, 0x400000
  s_mov_b32 s23, 0x20000
  s_mov_b32 s26, 0x400000
  s_mov_b32 s27, 0x20000
  s_mov_b32 s30, 0x10000000
  s_mov_b32 s31, 0x20000
  s_mov_b32 s34, 0x100
  s_mov_b32 s35, 0x20000
  s_mov_b32 s38, 0x4b0000
  s_mov_b32 s39, 0x20000
  s_mov_b32 s42, 0x500
  s_mov_b32 s43, 0x20000
  s_add_u32 m0, s56, 0
  s_add_u32 s51, s55, 0
  buffer_load_dwordx4 v3, s[44:47], s51 offen lds
  s_add_u32 m0, s56, 1024
  s_add_u32 s51, s55, 32768
  buffer_load_dwordx4 v3, s[44:47], s51 offen lds
  s_add_u32 m0, s56, 2048
  s_add_u32 s51, s55, 65536
  buffer_load_dwordx4 v4, s[44:47], s51 offen lds
  s_add_u32 m0, s56, 3072
  s_add_u32 s51, s55, 98304
  buffer_load_dwordx4 v4, s[44:47], s51 offen lds
  s_add_u32 m0, s56, 4096
  s_add_u32 s51, s55, 131072
  buffer_load_dwordx4 v3, s[44:47], s51 offen lds
  s_add_u32 m0, s56, 5120
  s_add_u32 s51, s55, 163840
  buffer_load_dwordx4 v3, s[44:47], s51 offen lds
  s_add_u32 m0, s56, 6144
  s_add_u32 s51, s55, 196608
  buffer_load_dwordx4 v4, s[44:47], s51 offen lds
  s_add_u32 m0, s56, 7168
  s_add_u32 s51, s55, 229376
  buffer_load_dwordx4 v4, s[44:47], s51 offen lds
  s_add_u32 m0, s56, 98304
  s_add_u32 s51, s54, 128
  buffer_load_dwordx4 v1, s[12:15], s51 offen lds
  s_add_u32 m0, s56, 99328
  s_add_u32 s51, s54, 128
  buffer_load_dwordx4 v2, s[12:15], s51 offen lds
  s_add_u32 m0, s56, 100352
  s_add_u32 s51, s54, 16512
  buffer_load_dwordx4 v1, s[12:15], s51 offen lds
  s_add_u32 m0, s56, 101376
  s_add_u32 s51, s54, 16512
  buffer_load_dwordx4 v2, s[12:15], s51 offen lds
  s_add_u32 m0, s56, 102400
  s_add_u32 s51, s54, 32896
  buffer_load_dwordx4 v1, s[12:15], s51 offen lds
  s_add_u32 m0, s56, 103424
  s_add_u32 s51, s54, 32896
  buffer_load_dwordx4 v2, s[12:15], s51 offen lds
  s_lshl_b32 s82, s48, 18
  s_add_u32 s82, s82, s52
  s_branch L_main
.p2align 12
L_main:
  s_lshr_b32 s80, s2, 2
  s_and_b32 s83, s2, 3
  s_lshl_b32 s81, s48, 10
  s_add_u32 s81, s81, 151552
  v_lshrrev_b32 v24, 3, v0
  v_mul_u32_u24 v24, 7680, v24
  v_and_b32 v25, 7, v0
  v_lshl_add_u32 v14, v25, 4, v24
  v_lshlrev_b32 v89, 2, v0
  v_lshlrev_b32 v15, 4, v0
  v_lshrrev_b32 v24, 1, v22
  v_xor_b32 v24, v24, v21
  v_lshlrev_b32 v24, 4, v24
  v_lshl_add_u32 v24, v22, 7, v24
  s_and_b32 s51, s48, 1
  s_lshl_b32 s51, s51, 13
  s_add_u32 s51, s51, 65536
  v_add_u32 v5, s51, v24
  v_xor_b32 v6, 64, v5
  v_lshrrev_b32 v26, 2, v22
  v_and_b32 v24, 1, v21
  v_lshl_add_u32 v24, v24, 2, v26
  v_lshl_add_u32 v26, v21, 3, v26
  v_lshlrev_b32 v26, 8, v26
  v_and_b32 v25, 3, v0
  v_lshl_add_u32 v26, v25, 3, v26
  v_lshl_add_u32 v26, v24, 5, v26
  s_lshr_b32 s51, s48, 1
  s_lshl_b32 s51, s51, 7
  v_xor_b32 v7, s51, v26
  v_xor_b32 v8, 32, v7
  v_xor_b32 v9, 64, v7
  v_xor_b32 v10, 96, v7
  s_cmp_ge_u32 s48, 2
  s_cselect_b32 s70, s59, s58
  s_lshl_b32 s52, s70, 7
  s_add_u32 s52, s52, 458752
  v_mov_b32 v11, s52
  s_lshl_b32 s70, s70, 1
  s_and_b32 s52, s48, 1
  s_add_u32 s70, s70, s52
  s_mul_i32 s70, s70, 81920
  s_add_u32 s70, s70, 1048576
  s_bfe_u32 s6, s49, 0x10001
  s_mul_i32 s7, s6, 0
  s_add_u32 s82, s82, s7
  s_mul_i32 s7, s6, 5242880
  s_sub_u32 s76, s82, s7
  s_mul_i32 s7, s6, 0
  s_add_u32 s70, s70, s7
  s_mul_i32 s7, s6, 81920
  s_sub_u32 s77, s70, s7
  s_lshl_b32 s64, s49, 19
  s_add_u32 s65, s64, 20971520
  s_add_u32 s64, s64, 4194304
  s_lshr_b32 s53, s48, 1
  s_mul_i32 s72, s52, 24576
  s_lshl_b32 s51, s53, 11
  s_add_u32 s72, s72, s51
  s_xor_b32 s73, s72, 16384
  s_mul_i32 s74, s52, 17408
  s_lshl_b32 s51, s53, 13
  s_add_u32 s74, s74, s51
  s_xor_b32 s75, s74, 16384
  v_mov_b32 v19, 0x40000000
  s_cmp_eq_u32 s48, 0
  s_cselect_b32 s51, 0, 0x40000000
  v_mov_b32 v16, 0x40000000
  v_writelane_b32 v19, s51, 0
  v_writelane_b32 v16, 0, 0
  v_mov_b32 v20, 1
  s_mov_b64 exec, 0
  s_cmp_eq_u32 s48, 0
  s_cbranch_scc1 HS0
  s_cmp_eq_u32 s48, 1
  s_cbranch_scc1 HS1
  s_cmp_eq_u32 s48, 2
  s_cbranch_scc1 HS2
  s_branch HS3
HOPR_a:
  s_mov_b64 exec, -1
  s_waitcnt vmcnt(6)
  s_barrier
  ds_read_b64_tr_b16 a[224:225], v7 offset:0
  ds_read_b64_tr_b16 a[226:227], v7 offset:1024
  ds_read_b64_tr_b16 a[228:229], v7 offset:8192
  ds_read_b64_tr_b16 a[230:231], v7 offset:9216
  ds_read_b128 a[96:99], v5 offset:0
  ds_read_b128 a[100:103], v6 offset:0
  ds_read_b128 a[104:107], v5 offset:2048
  ds_read_b128 a[108:111], v6 offset:2048
  ds_read_b128 a[112:115], v5 offset:4096
  ds_read_b128 a[116:119], v6 offset:4096
  ds_read_b128 a[120:123], v5 offset:6144
  ds_read_b128 a[124:127], v6 offset:6144
  ds_read_b128 a[128:131], v5 offset:16384
  ds_read_b128 a[132:135], v6 offset:16384
  s_add_u32 m0, s56, 104448
  s_add_u32 s51, s54, 49280
  buffer_load_dwordx4 v1, s[12:15], s51 offen lds
  s_add_u32 m0, s56, 105472
  s_add_u32 s51, s54, 49280
  buffer_load_dwordx4 v2, s[12:15], s51 offen lds
  s_waitcnt lgkmcnt(9)
  v_mfma_f32_16x16x32_bf16 a[0:3], a[224:227], a[96:99], 0
  ds_read_b128 a[136:139], v5 offset:18432
  s_waitcnt lgkmcnt(9)
  v_mfma_f32_16x16x32_bf16 a[0:3], a[228:231], a[100:103], a[0:3]
  ds_read_b128 a[140:143], v6 offset:18432
  s_waitcnt lgkmcnt(9)
  v_mfma_f32_16x16x32_bf16 a[4:7], a[224:227], a[104:107], 0
  ds_read_b128 a[144:147], v5 offset:20480
  s_waitcnt lgkmcnt(9)
  v_mfma_f32_16x16x32_bf16 a[4:7], a[228:231], a[108:111], a[4:7]
  ds_read_b128 a[148:151], v6 offset:20480
  s_waitcnt lgkmcnt(9)
  v_mfma_f32_16x16x32_bf16 a[8:11], a[224:227], a[112:115], 0
  ds_read_b128 a[152:155], v5 offset:22528
  s_waitcnt lgkmcnt(9)
  v_mfma_f32_16x16x32_bf16 a[8:11], a[228:231], a[116:119], a[8:11]
  ds_read_b128 a[156:159], v6 offset:22528
  s_waitcnt lgkmcnt(9)
  v_mfma_f32_16x16x32_bf16 a[12:15], a[224:227], a[120:123], 0
  ds_read_b64_tr_b16 a[232:233], v8 offset:0
  s_waitcnt lgkmcnt(9)
  v_mfma_f32_16x16x32_bf16 a[12:15], a[228:231], a[124:127], a[12:15]
  ds_read_b64_tr_b16 a[234:235], v8 offset:1024
  s_waitcnt lgkmcnt(9)
  v_mfma_f32_16x16x32_bf16 a[16:19], a[224:227], a[128:131], 0
  ds_read_b64_tr_b16 a[236:237], v8 offset:8192
  s_waitcnt lgkmcnt(9)
  v_mfma_f32_16x16x32_bf16 a[16:19], a[228:231], a[132:135], a[16:19]
  ds_read_b64_tr_b16 a[238:239], v8 offset:9216
  s_waitcnt lgkmcnt(9)
  v_mfma_f32_16x16x32_bf16 a[20:23], a[224:227], a[136:139], 0
  s_add_u32 m0, s56, 32768
  s_waitcnt lgkmcnt(8)
  v_mfma_f32_16x16x32_bf16 a[20:23], a[228:231], a[140:143], a[20:23]
  s_add_u32 s51, s55, 524288
  s_waitcnt lgkmcnt(7)
  v_mfma_f32_16x16x32_bf16 a[24:27], a[224:227], a[144:147], 0
  buffer_load_dwordx4 v3, s[44:47], s51 offen lds
  s_waitcnt lgkmcnt(6)
  v_mfma_f32_16x16x32_bf16 a[24:27], a[228:231], a[148:151], a[24:27]
  s_add_u32 m0, s56, 33792
  s_waitcnt lgkmcnt(5)
  v_mfma_f32_16x16x32_bf16 a[28:31], a[224:227], a[152:155], 0
  s_add_u32 s51, s55, 557056
  s_waitcnt lgkmcnt(4)
  v_mfma_f32_16x16x32_bf16 a[28:31], a[228:231], a[156:159], a[28:31]
  s_waitcnt lgkmcnt(0)
  buffer_load_dwordx4 v3, s[44:47], s51 offen lds
  v_mfma_f32_16x16x32_bf16 a[32:35], a[232:235], a[96:99], 0
  s_add_u32 m0, s56, 34816
  ds_read_b64_tr_b16 a[224:225], v9 offset:0
  v_mfma_f32_16x16x32_bf16 a[32:35], a[236:239], a[100:103], a[32:35]
  s_add_u32 s51, s55, 589824
  ds_read_b64_tr_b16 a[226:227], v9 offset:1024
  v_mfma_f32_16x16x32_bf16 a[36:39], a[232:235], a[104:107], 0
  ds_read_b64_tr_b16 a[228:229], v9 offset:8192
  buffer_load_dwordx4 v4, s[44:47], s51 offen lds
  v_mfma_f32_16x16x32_bf16 a[36:39], a[236:239], a[108:111], a[36:39]
  ds_read_b64_tr_b16 a[230:231], v9 offset:9216
  v_mfma_f32_16x16x32_bf16 a[40:43], a[232:235], a[112:115], 0
  s_add_u32 m0, s56, 35840
  v_and_b32 v92, 31, v0
  v_lshrrev_b32 v93, 5, v0
  v_mfma_f32_16x16x32_bf16 a[40:43], a[236:239], a[116:119], a[40:43]
  s_add_u32 s51, s55, 622592
  v_mul_u32_u24 v21, 1280, v93
  v_lshl_add_u32 v21, v92, 3, v21
  v_mfma_f32_16x16x32_bf16 a[44:47], a[232:235], a[120:123], 0
  buffer_load_dwordx4 v4, s[44:47], s51 offen lds
  v_mfma_f32_16x16x32_bf16 a[44:47], a[236:239], a[124:127], a[44:47]
  v_lshrrev_b32 v94, 1, v92
  v_mul_u32_u24 v22, 144, v94
  v_mfma_f32_16x16x32_bf16 a[48:51], a[232:235], a[128:131], 0
  v_lshl_add_u32 v22, v93, 4, v22
  v_and_b32 v94, 1, v92
  v_mfma_f32_16x16x32_bf16 a[48:51], a[236:239], a[132:135], a[48:51]
  s_add_u32 m0, s56, 36864
  v_lshl_add_u32 v22, v94, 3, v22
  v_mfma_f32_16x16x32_bf16 a[52:55], a[232:235], a[136:139], 0
  s_add_u32 s51, s55, 655360
  v_mfma_f32_16x16x32_bf16 a[52:55], a[236:239], a[140:143], a[52:55]
  s_lshl_b32 s6, s48, 5
  buffer_load_dwordx4 v3, s[44:47], s51 offen lds
  v_mfma_f32_16x16x32_bf16 a[56:59], a[232:235], a[144:147], 0
  s_add_u32 s6, s6, 139264
  v_add_u32 v22, s6, v22
  v_lshlrev_b32 v95, 4, v92
  v_mfma_f32_16x16x32_bf16 a[56:59], a[236:239], a[148:151], a[56:59]
  s_add_u32 m0, s56, 37888
  v_add_u32 v95, 131072, v95
  v_mfma_f32_16x16x32_bf16 a[60:63], a[232:235], a[152:155], 0
  s_add_u32 s51, s55, 688128
  v_mfma_f32_16x16x32_bf16 a[60:63], a[236:239], a[156:159], a[60:63]
  s_waitcnt lgkmcnt(0)
  buffer_load_dwordx4 v3, s[44:47], s51 offen lds
  v_mfma_f32_16x16x32_bf16 a[64:67], a[224:227], a[96:99], 0
  ds_read_b64_tr_b16 a[232:233], v10 offset:0
  v_mfma_f32_16x16x32_bf16 a[64:67], a[228:231], a[100:103], a[64:67]
  s_add_u32 m0, s56, 38912
  ds_read_b64_tr_b16 a[234:235], v10 offset:1024
  v_mfma_f32_16x16x32_bf16 a[68:71], a[224:227], a[104:107], 0
  s_add_u32 s51, s55, 720896
  ds_read_b64_tr_b16 a[236:237], v10 offset:8192
  v_mfma_f32_16x16x32_bf16 a[68:71], a[228:231], a[108:111], a[68:71]
  ds_read_b64_tr_b16 a[238:239], v10 offset:9216
  v_mfma_f32_16x16x32_bf16 a[72:75], a[224:227], a[112:115], 0
  buffer_load_dwordx4 v4, s[44:47], s51 offen lds
  v_mfma_f32_16x16x32_bf16 a[72:75], a[228:231], a[116:119], a[72:75]
  s_add_u32 m0, s56, 39936
  v_mfma_f32_16x16x32_bf16 a[76:79], a[224:227], a[120:123], 0
  s_add_u32 s51, s55, 753664
  v_mfma_f32_16x16x32_bf16 a[76:79], a[228:231], a[124:127], a[76:79]
  buffer_load_dwordx4 v4, s[44:47], s51 offen lds
  v_mfma_f32_16x16x32_bf16 a[80:83], a[224:227], a[128:131], 0
  v_mfma_f32_16x16x32_bf16 a[80:83], a[228:231], a[132:135], a[80:83]
  v_mfma_f32_16x16x32_bf16 a[84:87], a[224:227], a[136:139], 0
  v_mfma_f32_16x16x32_bf16 a[84:87], a[228:231], a[140:143], a[84:87]
  v_mfma_f32_16x16x32_bf16 a[88:91], a[224:227], a[144:147], 0
  v_mfma_f32_16x16x32_bf16 a[88:91], a[228:231], a[148:151], a[88:91]
  v_mfma_f32_16x16x32_bf16 a[92:95], a[224:227], a[152:155], 0
  s_waitcnt vmcnt(8) lgkmcnt(0)
  s_barrier
  v_mfma_f32_16x16x32_bf16 a[92:95], a[228:231], a[156:159], a[92:95]
  s_add_u32 m0, s56, 65536
  ds_read_b128 a[160:163], v5 offset:32768
  v_mfma_f32_16x16x32_bf16 v[96:99], a[232:235], a[96:99], 0
  s_add_u32 s51, s54, 256
  ds_read_b64_tr_b16 a[224:225], v7 offset:16384
  v_mfma_f32_16x16x32_bf16 v[96:99], a[236:239], a[100:103], v[96:99]
  ds_read_b64_tr_b16 a[226:227], v7 offset:17408
  buffer_load_dwordx4 v1, s[12:15], s51 offen lds
  v_mfma_f32_16x16x32_bf16 v[100:103], a[232:235], a[104:107], 0
  s_add_u32 m0, s56, 66560
  ds_read_b64_tr_b16 a[228:229], v7 offset:24576
  v_mfma_f32_16x16x32_bf16 v[100:103], a[236:239], a[108:111], v[100:103]
  s_add_u32 s51, s54, 256
  ds_read_b64_tr_b16 a[230:231], v7 offset:25600
  v_mfma_f32_16x16x32_bf16 v[104:107], a[232:235], a[112:115], 0
  ds_read_b128 a[164:167], v6 offset:32768
  v_mfma_f32_16x16x32_bf16 v[104:107], a[236:239], a[116:119], v[104:107]
  buffer_load_dwordx4 v2, s[12:15], s51 offen lds
  v_mfma_f32_16x16x32_bf16 v[108:111], a[232:235], a[120:123], 0
  s_add_u32 m0, s56, 67584
  ds_read_b128 a[168:171], v5 offset:34816
  v_mfma_f32_16x16x32_bf16 v[108:111], a[236:239], a[124:127], v[108:111]
  s_add_u32 s51, s54, 16640
  v_mfma_f32_16x16x32_bf16 v[112:115], a[232:235], a[128:131], 0
  buffer_load_dwordx4 v1, s[12:15], s51 offen lds
  v_mfma_f32_16x16x32_bf16 v[112:115], a[236:239], a[132:135], v[112:115]
  v_mfma_f32_16x16x32_bf16 v[116:119], a[232:235], a[136:139], 0
  s_add_u32 m0, s56, 68608
  ds_read_b128 a[172:175], v6 offset:34816
  v_mfma_f32_16x16x32_bf16 v[116:119], a[236:239], a[140:143], v[116:119]
  s_add_u32 s51, s54, 16640
  v_mfma_f32_16x16x32_bf16 v[120:123], a[232:235], a[144:147], 0
  buffer_load_dwordx4 v2, s[12:15], s51 offen lds
  v_mfma_f32_16x16x32_bf16 v[120:123], a[236:239], a[148:151], v[120:123]
  v_mfma_f32_16x16x32_bf16 v[124:127], a[232:235], a[152:155], 0
  s_add_u32 m0, s56, 69632
  ds_read_b128 a[176:179], v5 offset:36864
  v_mfma_f32_16x16x32_bf16 v[124:127], a[236:239], a[156:159], v[124:127]
  s_waitcnt lgkmcnt(4)
  s_add_u32 s51, s54, 33024
  v_mfma_f32_16x16x32_bf16 v[128:131], a[96:99], a[224:227], 0
  ds_read_b64_tr_b16 a[232:233], v8 offset:16384
  buffer_load_dwordx4 v1, s[12:15], s51 offen lds
  v_mfma_f32_16x16x32_bf16 v[128:131], a[100:103], a[228:231], v[128:131]
  ds_read_b64_tr_b16 a[234:235], v8 offset:17408
  v_mfma_f32_16x16x32_bf16 v[132:135], a[104:107], a[224:227], 0
  s_add_u32 m0, s56, 70656
  ds_read_b64_tr_b16 a[236:237], v8 offset:24576
  v_mfma_f32_16x16x32_bf16 v[132:135], a[108:111], a[228:231], v[132:135]
  s_add_u32 s51, s54, 33024
  ds_read_b64_tr_b16 a[238:239], v8 offset:25600
  v_mfma_f32_16x16x32_bf16 v[136:139], a[112:115], a[224:227], 0
  ds_read_b128 a[180:183], v6 offset:36864
  buffer_load_dwordx4 v2, s[12:15], s51 offen lds
  v_mfma_f32_16x16x32_bf16 v[136:139], a[116:119], a[228:231], v[136:139]
  ds_read_b128 a[184:187], v5 offset:38912
  v_mfma_f32_16x16x32_bf16 v[140:143], a[120:123], a[224:227], 0
  v_mfma_f32_16x16x32_bf16 v[140:143], a[124:127], a[228:231], v[140:143]
  s_add_u32 m0, s56, 71680
  v_mfma_f32_16x16x32_bf16 v[144:147], a[128:131], a[224:227], 0
  s_add_u32 s51, s54, 49408
  v_mfma_f32_16x16x32_bf16 v[144:147], a[132:135], a[228:231], v[144:147]
  ds_read_b128 a[188:191], v6 offset:38912
  v_mfma_f32_16x16x32_bf16 v[148:151], a[136:139], a[224:227], 0
  buffer_load_dwordx4 v1, s[12:15], s51 offen lds
  v_mfma_f32_16x16x32_bf16 v[148:151], a[140:143], a[228:231], v[148:151]
  s_add_u32 m0, s56, 72704
  v_mfma_f32_16x16x32_bf16 v[152:155], a[144:147], a[224:227], 0
  s_add_u32 s51, s54, 49408
  v_mfma_f32_16x16x32_bf16 v[152:155], a[148:151], a[228:231], v[152:155]
  ds_read_b128 a[192:195], v5 offset:49152
  v_mfma_f32_16x16x32_bf16 v[156:159], a[152:155], a[224:227], 0
  buffer_load_dwordx4 v2, s[12:15], s51 offen lds
  v_mfma_f32_16x16x32_bf16 v[156:159], a[156:159], a[228:231], v[156:159]
  s_waitcnt lgkmcnt(4)
  s_mul_i32 s52, s83, 320
  v_mfma_f32_16x16x32_bf16 v[160:163], a[96:99], a[232:235], 0
  ds_read_b64_tr_b16 a[224:225], v9 offset:16384
  buffer_load_dword v17, v89, s[40:43], s52 offen
  v_mfma_f32_16x16x32_bf16 v[160:163], a[100:103], a[236:239], v[160:163]
  ds_read_b64_tr_b16 a[226:227], v9 offset:17408
  v_mfma_f32_16x16x32_bf16 v[164:167], a[104:107], a[232:235], 0
  ds_read_b64_tr_b16 a[228:229], v9 offset:24576
  v_mfma_f32_16x16x32_bf16 v[164:167], a[108:111], a[236:239], v[164:167]
  ds_read_b64_tr_b16 a[230:231], v9 offset:25600
  v_mfma_f32_16x16x32_bf16 v[168:171], a[112:115], a[232:235], 0
  ds_read_b128 a[196:199], v6 offset:49152
  v_mfma_f32_16x16x32_bf16 v[168:171], a[116:119], a[236:239], v[168:171]
  ds_read_b128 a[200:203], v5 offset:51200
  v_mfma_f32_16x16x32_bf16 v[172:175], a[120:123], a[232:235], 0
  buffer_load_dword v18, v89, s[40:43], s52 offen offset:256
  v_mfma_f32_16x16x32_bf16 v[172:175], a[124:127], a[236:239], v[172:175]
  s_lshl_b32 s53, s83, 2
  v_mfma_f32_16x16x32_bf16 v[176:179], a[128:131], a[232:235], 0
  s_add_u32 s53, s53, s48
  ds_read_b128 a[204:207], v6 offset:51200
  v_mfma_f32_16x16x32_bf16 v[176:179], a[132:135], a[236:239], v[176:179]
  s_mul_i32 s53, s53, 307200
  v_mfma_f32_16x16x32_bf16 v[180:183], a[136:139], a[232:235], 0
  s_lshl_b32 s52, s80, 7
  v_mfma_f32_16x16x32_bf16 v[180:183], a[140:143], a[236:239], v[180:183]
  s_add_u32 s53, s53, s52
  v_mfma_f32_16x16x32_bf16 v[184:187], a[144:147], a[232:235], 0
  s_cmp_lt_u32 s80, 60
  s_cselect_b32 s53, s53, 0x40000000
  ds_read_b128 a[208:211], v5 offset:53248
  v_mfma_f32_16x16x32_bf16 v[184:187], a[148:151], a[236:239], v[184:187]
  s_mul_i32 s7, s48, 5120
  v_mfma_f32_16x16x32_bf16 v[188:191], a[152:155], a[232:235], 0
  s_add_u32 m0, s7, 131072
  v_mfma_f32_16x16x32_bf16 v[188:191], a[156:159], a[236:239], v[188:191]
  s_waitcnt lgkmcnt(4)
  s_add_u32 s52, s53, 0
  ds_read_b128 a[212:215], v6 offset:53248
  v_mfma_f32_16x16x32_bf16 v[192:195], a[96:99], a[224:227], 0
  ds_read_b64_tr_b16 a[232:233], v10 offset:16384
  buffer_load_dwordx4 v14, s[36:39], s52 offen lds
  v_mfma_f32_16x16x32_bf16 v[192:195], a[100:103], a[228:231], v[192:195]
  s_add_u32 m0, s7, 132096
  ds_read_b64_tr_b16 a[234:235], v10 offset:17408
  v_mfma_f32_16x16x32_bf16 v[196:199], a[104:107], a[224:227], 0
  s_add_u32 s52, s53, 61440
  ds_read_b64_tr_b16 a[236:237], v10 offset:24576
  v_mfma_f32_16x16x32_bf16 v[196:199], a[108:111], a[228:231], v[196:199]
  ds_read_b64_tr_b16 a[238:239], v10 offset:25600
  buffer_load_dwordx4 v14, s[36:39], s52 offen lds
  v_mfma_f32_16x16x32_bf16 v[200:203], a[112:115], a[224:227], 0
  ds_read_b128 a[216:219], v5 offset:55296
  v_mfma_f32_16x16x32_bf16 v[200:203], a[116:119], a[228:231], v[200:203]
  v_mfma_f32_16x16x32_bf16 v[204:207], a[120:123], a[224:227], 0
  v_mfma_f32_16x16x32_bf16 v[204:207], a[124:127], a[228:231], v[204:207]
  s_add_u32 m0, s7, 133120
  ds_read_b128 a[220:223], v6 offset:55296
  v_mfma_f32_16x16x32_bf16 v[208:211], a[128:131], a[224:227], 0
  s_add_u32 s52, s53, 122880
  v_mfma_f32_16x16x32_bf16 v[208:211], a[132:135], a[228:231], v[208:211]
  buffer_load_dwordx4 v14, s[36:39], s52 offen lds
  v_mfma_f32_16x16x32_bf16 v[212:215], a[136:139], a[224:227], 0
  v_mfma_f32_16x16x32_bf16 v[212:215], a[140:143], a[228:231], v[212:215]
  v_mfma_f32_16x16x32_bf16 v[216:219], a[144:147], a[224:227], 0
  v_mfma_f32_16x16x32_bf16 v[216:219], a[148:151], a[228:231], v[216:219]
  v_mfma_f32_16x16x32_bf16 v[220:223], a[152:155], a[224:227], 0
  s_add_u32 m0, s7, 134144
  v_mfma_f32_16x16x32_bf16 v[220:223], a[156:159], a[228:231], v[220:223]
  s_waitcnt lgkmcnt(2)
  s_add_u32 s52, s53, 184320
  s_waitcnt vmcnt(5) lgkmcnt(0)
  s_barrier
  v_mfma_f32_16x16x32_bf16 v[224:227], a[96:99], a[232:235], 0
  ds_read_b64_tr_b16 a[224:225], v7 offset:32768
  buffer_load_dwordx4 v14, s[36:39], s52 offen lds
  v_mfma_f32_16x16x32_bf16 v[224:227], a[100:103], a[236:239], v[224:227]
  ds_read_b64_tr_b16 a[226:227], v7 offset:33792
  v_mfma_f32_16x16x32_bf16 v[228:231], a[104:107], a[232:235], 0
  ds_read_b64_tr_b16 a[228:229], v7 offset:40960
  v_mfma_f32_16x16x32_bf16 v[228:231], a[108:111], a[236:239], v[228:231]
  ds_read_b64_tr_b16 a[230:231], v7 offset:41984
  v_mfma_f32_16x16x32_bf16 v[232:235], a[112:115], a[232:235], 0
  v_mfma_f32_16x16x32_bf16 v[232:235], a[116:119], a[236:239], v[232:235]
  s_add_u32 m0, s7, 135168
  v_mfma_f32_16x16x32_bf16 v[236:239], a[120:123], a[232:235], 0
  s_add_u32 s52, s53, 245760
  v_mfma_f32_16x16x32_bf16 v[236:239], a[124:127], a[236:239], v[236:239]
  buffer_load_dwordx4 v14, s[36:39], s52 offen lds
  v_mfma_f32_16x16x32_bf16 v[240:243], a[128:131], a[232:235], 0
  v_mfma_f32_16x16x32_bf16 v[240:243], a[132:135], a[236:239], v[240:243]
  v_mfma_f32_16x16x32_bf16 v[244:247], a[136:139], a[232:235], 0
  v_mfma_f32_16x16x32_bf16 v[244:247], a[140:143], a[236:239], v[244:247]
  v_mfma_f32_16x16x32_bf16 v[248:251], a[144:147], a[232:235], 0
  v_mfma_f32_16x16x32_bf16 v[248:251], a[148:151], a[236:239], v[248:251]
  v_mfma_f32_16x16x32_bf16 v[252:255], a[152:155], a[232:235], 0
  v_mfma_f32_16x16x32_bf16 v[252:255], a[156:159], a[236:239], v[252:255]
  s_waitcnt lgkmcnt(0)
  v_mfma_f32_16x16x32_bf16 a[0:3], a[224:227], a[160:163], a[0:3]
  s_add_u32 m0, s56, 0
  ds_read_b64_tr_b16 a[232:233], v8 offset:32768
  v_mfma_f32_16x16x32_bf16 a[0:3], a[228:231], a[164:167], a[0:3]
  s_add_u32 s51, s55, 1048576
  ds_read_b64_tr_b16 a[234:235], v8 offset:33792
  v_mfma_f32_16x16x32_bf16 a[4:7], a[224:227], a[168:171], a[4:7]
  ds_read_b64_tr_b16 a[236:237], v8 offset:40960
  buffer_load_dwordx4 v3, s[44:47], s51 offen lds
  v_mfma_f32_16x16x32_bf16 a[4:7], a[228:231], a[172:175], a[4:7]
  s_add_u32 m0, s56, 1024
  ds_read_b64_tr_b16 a[238:239], v8 offset:41984
  v_mfma_f32_16x16x32_bf16 a[8:11], a[224:227], a[176:179], a[8:11]
  s_add_u32 s51, s55, 1081344
  s_waitcnt vmcnt(7)
  v_lshlrev_b32 v24, 16, v17
  v_and_b32 v25, 0xffff0000, v17
  v_mfma_f32_16x16x32_bf16 a[8:11], a[228:231], a[180:183], a[8:11]
  ds_read_b128 a[96:99], v5 offset:0
  s_waitcnt vmcnt(6)
  v_lshlrev_b32 v26, 16, v18
  v_mfma_f32_16x16x32_bf16 a[12:15], a[224:227], a[184:187], a[12:15]
  buffer_load_dwordx4 v3, s[44:47], s51 offen lds
  v_mfma_f32_16x16x32_bf16 a[12:15], a[228:231], a[188:191], a[12:15]
  v_and_b32 v27, 0xffff0000, v18
  v_mul_f32 v28, 0xbfb8aa3b, v24
  v_mfma_f32_16x16x32_bf16 a[16:19], a[224:227], a[192:195], a[16:19]
  s_add_u32 m0, s56, 2048
  v_mul_f32 v29, 0xbfb8aa3b, v25
  v_mul_f32 v30, 0xbfb8aa3b, v26
  v_mfma_f32_16x16x32_bf16 a[16:19], a[228:231], a[196:199], a[16:19]
  s_add_u32 s51, s55, 1114112
  v_mul_f32 v31, 0xbfb8aa3b, v27
  v_mfma_f32_16x16x32_bf16 a[20:23], a[224:227], a[200:203], a[20:23]
  buffer_load_dwordx4 v4, s[44:47], s51 offen lds
  v_mfma_f32_16x16x32_bf16 a[20:23], a[228:231], a[204:207], a[20:23]
  ds_read_b128 a[100:103], v6 offset:0
  v_mfma_f32_16x16x32_bf16 a[24:27], a[224:227], a[208:211], a[24:27]
  v_exp_f32 v28, v28
  v_mfma_f32_16x16x32_bf16 a[24:27], a[228:231], a[212:215], a[24:27]
  s_add_u32 m0, s56, 3072
  v_exp_f32 v29, v29
  v_mfma_f32_16x16x32_bf16 a[28:31], a[224:227], a[216:219], a[28:31]
  s_add_u32 s51, s55, 1146880
  v_exp_f32 v30, v30
  v_mfma_f32_16x16x32_bf16 a[28:31], a[228:231], a[220:223], a[28:31]
  s_waitcnt lgkmcnt(2)
  buffer_load_dwordx4 v4, s[44:47], s51 offen lds
  v_mfma_f32_16x16x32_bf16 a[32:35], a[232:235], a[160:163], a[32:35]
  ds_read_b64_tr_b16 a[224:225], v9 offset:32768
  v_mfma_f32_16x16x32_bf16 a[32:35], a[236:239], a[164:167], a[32:35]
  ds_read_b64_tr_b16 a[226:227], v9 offset:33792
  v_mfma_f32_16x16x32_bf16 a[36:39], a[232:235], a[168:171], a[36:39]
  s_add_u32 m0, s56, 4096
  ds_read_b64_tr_b16 a[228:229], v9 offset:40960
  v_mfma_f32_16x16x32_bf16 a[36:39], a[236:239], a[172:175], a[36:39]
  s_add_u32 s51, s55, 1179648
  ds_read_b64_tr_b16 a[230:231], v9 offset:41984
  v_mfma_f32_16x16x32_bf16 a[40:43], a[232:235], a[176:179], a[40:43]
  ds_read_b128 a[104:107], v5 offset:2048
  v_mfma_f32_16x16x32_bf16 a[40:43], a[236:239], a[180:183], a[40:43]
  buffer_load_dwordx4 v3, s[44:47], s51 offen lds
  v_mfma_f32_16x16x32_bf16 a[44:47], a[232:235], a[184:187], a[44:47]
  v_exp_f32 v31, v31
  v_mfma_f32_16x16x32_bf16 a[44:47], a[236:239], a[188:191], a[44:47]
  s_add_u32 m0, s56, 5120
  ds_read_b128 a[108:111], v6 offset:2048
  v_add_f32 v28, 1.0, v28
  v_mfma_f32_16x16x32_bf16 a[48:51], a[232:235], a[192:195], a[48:51]
  s_add_u32 s51, s55, 1212416
  v_add_f32 v29, 1.0, v29
  v_add_f32 v30, 1.0, v30
  v_mfma_f32_16x16x32_bf16 a[48:51], a[236:239], a[196:199], a[48:51]
  buffer_load_dwordx4 v3, s[44:47], s51 offen lds
  v_mfma_f32_16x16x32_bf16 a[52:55], a[232:235], a[200:203], a[52:55]
  v_add_f32 v31, 1.0, v31
  v_mfma_f32_16x16x32_bf16 a[52:55], a[236:239], a[204:207], a[52:55]
  v_rcp_f32 v28, v28
  v_mfma_f32_16x16x32_bf16 a[56:59], a[232:235], a[208:211], a[56:59]
  s_add_u32 m0, s56, 6144
  v_rcp_f32 v29, v29
  v_mfma_f32_16x16x32_bf16 a[56:59], a[236:239], a[212:215], a[56:59]
  s_add_u32 s51, s55, 1245184
  ds_read_b128 a[112:115], v5 offset:4096
  v_mfma_f32_16x16x32_bf16 a[60:63], a[232:235], a[216:219], a[60:63]
  buffer_load_dwordx4 v4, s[44:47], s51 offen lds
  v_mfma_f32_16x16x32_bf16 a[60:63], a[236:239], a[220:223], a[60:63]
  s_waitcnt lgkmcnt(3)
  v_rcp_f32 v30, v30
  v_mfma_f32_16x16x32_bf16 a[64:67], a[224:227], a[160:163], a[64:67]
  ds_read_b64_tr_b16 a[232:233], v10 offset:32768
  v_mfma_f32_16x16x32_bf16 a[64:67], a[228:231], a[164:167], a[64:67]
  s_add_u32 m0, s56, 7168
  ds_read_b64_tr_b16 a[234:235], v10 offset:33792
  v_mfma_f32_16x16x32_bf16 a[68:71], a[224:227], a[168:171], a[68:71]
  s_add_u32 s51, s55, 1277952
  ds_read_b64_tr_b16 a[236:237], v10 offset:40960
  v_mfma_f32_16x16x32_bf16 a[68:71], a[228:231], a[172:175], a[68:71]
  ds_read_b64_tr_b16 a[238:239], v10 offset:41984
  buffer_load_dwordx4 v4, s[44:47], s51 offen lds
  v_mfma_f32_16x16x32_bf16 a[72:75], a[224:227], a[176:179], a[72:75]
  ds_read_b128 a[116:119], v6 offset:4096
  v_mfma_f32_16x16x32_bf16 a[72:75], a[228:231], a[180:183], a[72:75]
  v_rcp_f32 v31, v31
  v_mfma_f32_16x16x32_bf16 a[76:79], a[224:227], a[184:187], a[76:79]
  v_mul_f32 v24, v24, v28
  v_mul_f32 v25, v25, v29
  v_mfma_f32_16x16x32_bf16 a[76:79], a[228:231], a[188:191], a[76:79]
  s_add_u32 m0, s56, 98304
  v_mul_f32 v26, v26, v30
  v_mul_f32 v27, v27, v31
  v_mfma_f32_16x16x32_bf16 a[80:83], a[224:227], a[192:195], a[80:83]
  s_add_u32 s51, s54, 384
  v_cvt_pk_bf16_f32 v24, v24, v25
  v_cvt_pk_bf16_f32 v25, v26, v27
  v_mfma_f32_16x16x32_bf16 a[80:83], a[228:231], a[196:199], a[80:83]
  ds_read_b128 a[120:123], v5 offset:6144
  v_lshl_add_u32 v26, v0, 2, s81
  v_mfma_f32_16x16x32_bf16 a[84:87], a[224:227], a[200:203], a[84:87]
  buffer_load_dwordx4 v1, s[12:15], s51 offen lds
  v_mfma_f32_16x16x32_bf16 a[84:87], a[228:231], a[204:207], a[84:87]
  ds_write_b32 v26, v24
  v_mfma_f32_16x16x32_bf16 a[88:91], a[224:227], a[208:211], a[88:91]
  s_add_u32 m0, s56, 99328
  ds_write_b32 v26, v25 offset:256
  v_lshrrev_b32 v27, 4, v0
  v_mfma_f32_16x16x32_bf16 a[88:91], a[228:231], a[212:215], a[88:91]
  s_add_u32 s51, s54, 384
  v_bfe_u32 v28, v0, 2, 2
  v_lshl_add_u32 v28, v27, 3, v28
  v_mfma_f32_16x16x32_bf16 a[92:95], a[224:227], a[216:219], a[92:95]
  buffer_load_dwordx4 v2, s[12:15], s51 offen lds
  v_mfma_f32_16x16x32_bf16 a[92:95], a[228:231], a[220:223], a[92:95]
  s_waitcnt lgkmcnt(4)
  ds_read_b128 a[124:127], v6 offset:6144
  v_lshlrev_b32 v28, 7, v28
  v_mfma_f32_16x16x32_bf16 v[96:99], a[232:235], a[160:163], v[96:99]
  ds_read_b64_tr_b16 a[224:225], v7 offset:49152
  v_and_b32 v29, 3, v0
  v_mfma_f32_16x16x32_bf16 v[96:99], a[236:239], a[164:167], v[96:99]
  s_add_u32 m0, s56, 100352
  ds_read_b64_tr_b16 a[226:227], v7 offset:50176
  v_lshl_add_u32 v28, v29, 3, v28
  v_mfma_f32_16x16x32_bf16 v[100:103], a[232:235], a[168:171], v[100:103]
  s_add_u32 s51, s54, 16768
  ds_read_b64_tr_b16 a[228:229], v7 offset:57344
  v_mfma_f32_16x16x32_bf16 v[100:103], a[236:239], a[172:175], v[100:103]
  s_lshl_b32 s6, s48, 5
  ds_read_b64_tr_b16 a[230:231], v7 offset:58368
  v_mfma_f32_16x16x32_bf16 v[104:107], a[232:235], a[176:179], v[104:107]
  s_add_u32 s6, s6, 131072
  buffer_load_dwordx4 v1, s[12:15], s51 offen lds
  v_mfma_f32_16x16x32_bf16 v[104:107], a[236:239], a[180:183], v[104:107]
  ds_read_b128 a[128:131], v5 offset:16384
  v_add_u32 v28, s6, v28
  v_mfma_f32_16x16x32_bf16 v[108:111], a[232:235], a[184:187], v[108:111]
  s_add_u32 m0, s56, 101376
  v_lshl_add_u32 v27, v27, 4, s81
  v_mfma_f32_16x16x32_bf16 v[108:111], a[236:239], a[188:191], v[108:111]
  s_add_u32 s51, s54, 16768
  ds_read_b128 v[32:35], v27 offset:0
  v_mfma_f32_16x16x32_bf16 v[112:115], a[232:235], a[192:195], v[112:115]
  buffer_load_dwordx4 v2, s[12:15], s51 offen lds
  v_mfma_f32_16x16x32_bf16 v[112:115], a[236:239], a[196:199], v[112:115]
  ds_read_b128 v[36:39], v27 offset:64
  v_mfma_f32_16x16x32_bf16 v[116:119], a[232:235], a[200:203], v[116:119]
  ds_read_b128 v[40:43], v27 offset:128
  v_mfma_f32_16x16x32_bf16 v[116:119], a[236:239], a[204:207], v[116:119]
  s_add_u32 m0, s56, 102400
  ds_read_b128 a[132:135], v6 offset:16384
  v_mfma_f32_16x16x32_bf16 v[120:123], a[232:235], a[208:211], v[120:123]
  s_add_u32 s51, s54, 33152
  ds_read_b128 v[44:47], v27 offset:192
  v_mfma_f32_16x16x32_bf16 v[120:123], a[236:239], a[212:215], v[120:123]
  buffer_load_dwordx4 v1, s[12:15], s51 offen lds
  v_mfma_f32_16x16x32_bf16 v[124:127], a[232:235], a[216:219], v[124:127]
  ds_read_b128 v[48:51], v27 offset:256
  v_mfma_f32_16x16x32_bf16 v[124:127], a[236:239], a[220:223], v[124:127]
HS0:
  s_cbranch_execz HS4
  s_waitcnt vmcnt(13) lgkmcnt(7)
  s_barrier
  v_mfma_f32_16x16x32_bf16 v[128:131], a[160:163], a[224:227], v[128:131]
  s_add_u32 m0, s56, 103424
  ds_read_b64_tr_b16 a[232:233], v8 offset:49152
  v_mfma_f32_16x16x32_bf16 v[128:131], a[164:167], a[228:231], v[128:131]
  s_add_u32 s51, s54, 33152
  ds_read_b64_tr_b16 a[234:235], v8 offset:50176
  v_mfma_f32_16x16x32_bf16 v[132:135], a[168:171], a[224:227], v[132:135]
  ds_read_b64_tr_b16 a[236:237], v8 offset:57344
  buffer_load_dwordx4 v2, s[12:15], s51 offen lds
  v_mfma_f32_16x16x32_bf16 v[132:135], a[172:175], a[228:231], v[132:135]
  ds_read_b64_tr_b16 a[238:239], v8 offset:58368
  v_mfma_f32_16x16x32_bf16 v[136:139], a[176:179], a[224:227], v[136:139]
  ds_read_b128 a[136:139], v5 offset:18432
  v_mfma_f32_16x16x32_bf16 v[136:139], a[180:183], a[228:231], v[136:139]
  s_add_u32 m0, s56, 104448
  ds_read_b64_tr_b16 v[52:53], v28 offset:0
  v_mfma_f32_16x16x32_bf16 v[140:143], a[184:187], a[224:227], v[140:143]
  s_add_u32 s51, s54, 49536
  ds_read_b64_tr_b16 v[54:55], v28 offset:512
  v_mfma_f32_16x16x32_bf16 v[140:143], a[188:191], a[228:231], v[140:143]
  ds_read_b128 a[140:143], v6 offset:18432
  v_mfma_f32_16x16x32_bf16 v[144:147], a[192:195], a[224:227], v[144:147]
  buffer_load_dwordx4 v1, s[12:15], s51 offen lds
  v_mfma_f32_16x16x32_bf16 v[144:147], a[196:199], a[228:231], v[144:147]
  ds_read_b64_tr_b16 v[56:57], v28 offset:4096
  v_mfma_f32_16x16x32_bf16 v[148:151], a[200:203], a[224:227], v[148:151]
  s_add_u32 m0, s56, 105472
  ds_read_b64_tr_b16 v[58:59], v28 offset:4608
  v_mfma_f32_16x16x32_bf16 v[148:151], a[204:207], a[228:231], v[148:151]
  s_add_u32 s51, s54, 49536
  ds_read_b64_tr_b16 v[60:61], v28 offset:8192
  v_mfma_f32_16x16x32_bf16 v[152:155], a[208:211], a[224:227], v[152:155]
  buffer_load_dwordx4 v2, s[12:15], s51 offen lds
  v_mfma_f32_16x16x32_bf16 v[152:155], a[212:215], a[228:231], v[152:155]
  s_add_u32 s52, s57, 1572864
  ds_read_b128 a[144:147], v5 offset:20480
  v_mfma_f32_16x16x32_bf16 v[156:159], a[216:219], a[224:227], v[156:159]
  buffer_load_dword v23, v12, s[44:47], s52 offen
  v_mfma_f32_16x16x32_bf16 v[156:159], a[220:223], a[228:231], v[156:159]
  s_waitcnt lgkmcnt(8)
  ds_read_b64_tr_b16 v[62:63], v28 offset:8704
  v_mfma_f32_16x16x32_bf16 v[160:163], a[160:163], a[232:235], v[160:163]
  s_add_u32 s52, s57, 2621440
  ds_read_b64_tr_b16 a[224:225], v9 offset:49152
  v_mfma_f32_16x16x32_bf16 v[160:163], a[164:167], a[236:239], v[160:163]
  ds_read_b64_tr_b16 a[226:227], v9 offset:50176
  buffer_load_dword v23, v12, s[44:47], s52 offen
  v_mfma_f32_16x16x32_bf16 v[164:167], a[168:171], a[232:235], v[164:167]
  ds_read_b64_tr_b16 a[228:229], v9 offset:57344
  v_mfma_f32_16x16x32_bf16 v[164:167], a[172:175], a[236:239], v[164:167]
  ds_read_b64_tr_b16 a[230:231], v9 offset:58368
  v_mfma_f32_16x16x32_bf16 v[168:171], a[176:179], a[232:235], v[168:171]
  ds_read_b128 a[148:151], v6 offset:20480
  v_mfma_f32_16x16x32_bf16 v[168:171], a[180:183], a[236:239], v[168:171]
  ds_read_b64_tr_b16 v[64:65], v28 offset:12288
  v_mfma_f32_16x16x32_bf16 v[172:175], a[184:187], a[232:235], v[172:175]
  ds_read_b64_tr_b16 v[66:67], v28 offset:12800
  v_mfma_f32_16x16x32_bf16 v[172:175], a[188:191], a[236:239], v[172:175]
  ds_read_b64_tr_b16 v[68:69], v28 offset:16384
  v_mfma_f32_16x16x32_bf16 v[176:179], a[192:195], a[232:235], v[176:179]
  ds_read_b64_tr_b16 v[70:71], v28 offset:16896
  v_mfma_f32_16x16x32_bf16 v[176:179], a[196:199], a[236:239], v[176:179]
  ds_read_b128 a[152:155], v5 offset:22528
  v_mfma_f32_16x16x32_bf16 v[180:183], a[200:203], a[232:235], v[180:183]
  v_mov_b32 v17, 0
  v_and_b32 v90, 31, v0
  v_mfma_f32_16x16x32_bf16 v[180:183], a[204:207], a[236:239], v[180:183]
  v_lshlrev_b32 v90, 7, v90
  v_mfma_f32_16x16x32_bf16 v[184:187], a[208:211], a[232:235], v[184:187]
  s_lshl_b32 s6, s2, 12
  v_mfma_f32_16x16x32_bf16 v[184:187], a[212:215], a[236:239], v[184:187]
  s_cmp_lt_u32 s2, 80
  s_cselect_b32 s6, s6, 0x40000000
  v_mfma_f32_16x16x32_bf16 v[188:191], a[216:219], a[232:235], v[188:191]
  s_cmp_eq_u32 s48, 0
  s_cselect_b32 s6, s6, 0x40000000
  s_waitcnt lgkmcnt(14)
  v_mfma_f32_16x16x32_bf16 v[72:75], v[32:35], v[52:55], 0
  s_waitcnt lgkmcnt(13)
  v_mfma_f32_16x16x32_bf16 v[72:75], v[36:39], v[56:59], v[72:75]
  s_waitcnt lgkmcnt(10)
  v_mfma_f32_16x16x32_bf16 v[72:75], v[40:43], v[60:63], v[72:75]
  s_waitcnt lgkmcnt(3)
  v_mfma_f32_16x16x32_bf16 v[72:75], v[44:47], v[64:67], v[72:75]
  s_waitcnt lgkmcnt(1)
  v_mfma_f32_16x16x32_bf16 v[72:75], v[48:51], v[68:71], v[72:75]
  v_mfma_f32_16x16x32_bf16 v[188:191], a[220:223], a[236:239], v[188:191]
  s_add_u32 s6, s6, 458752
  ds_read_b128 a[156:159], v6 offset:22528
  v_mfma_f32_16x16x32_bf16 v[192:195], a[160:163], a[224:227], v[192:195]
  ds_read_b64_tr_b16 a[232:233], v10 offset:49152
  v_mfma_f32_16x16x32_bf16 v[192:195], a[164:167], a[228:231], v[192:195]
  ds_read_b64_tr_b16 a[234:235], v10 offset:50176
  v_mfma_f32_16x16x32_bf16 v[196:199], a[168:171], a[224:227], v[196:199]
  ds_read_b64_tr_b16 a[236:237], v10 offset:57344
  v_mfma_f32_16x16x32_bf16 v[196:199], a[172:175], a[228:231], v[196:199]
  ds_read_b64_tr_b16 a[238:239], v10 offset:58368
  v_mfma_f32_16x16x32_bf16 v[200:203], a[176:179], a[224:227], v[200:203]
  buffer_store_dword v17, v90, s[28:31], s6 offen sc1
  v_mfma_f32_16x16x32_bf16 v[200:203], a[180:183], a[228:231], v[200:203]
  s_lshl_b32 s53, s80, 2
  v_mfma_f32_16x16x32_bf16 v[204:207], a[184:187], a[224:227], v[204:207]
  s_add_u32 s53, s53, s48
  v_mfma_f32_16x16x32_bf16 v[204:207], a[188:191], a[228:231], v[204:207]
  s_lshl_b32 s53, s53, 6
  v_mfma_f32_16x16x32_bf16 v[208:211], a[192:195], a[224:227], v[208:211]
  s_add_u32 s53, s53, s83
  v_mfma_f32_16x16x32_bf16 v[208:211], a[196:199], a[228:231], v[208:211]
  s_lshl_b32 s53, s53, 2
  v_mfma_f32_16x16x32_bf16 v[212:215], a[200:203], a[224:227], v[212:215]
  s_add_u32 s53, s53, 786432
  v_and_b32 v29, 15, v0
  v_lshlrev_b32 v29, 4, v29
  v_mfma_f32_16x16x32_bf16 v[212:215], a[204:207], a[228:231], v[212:215]
  buffer_store_dword v72, v29, s[28:31], s53 offen sc1
  v_mfma_f32_16x16x32_bf16 v[216:219], a[208:211], a[224:227], v[216:219]
  v_mfma_f32_16x16x32_bf16 v[216:219], a[212:215], a[228:231], v[216:219]
  v_mfma_f32_16x16x32_bf16 v[220:223], a[216:219], a[224:227], v[220:223]
  v_mfma_f32_16x16x32_bf16 v[220:223], a[220:223], a[228:231], v[220:223]
  s_waitcnt vmcnt(4) lgkmcnt(0)
  s_barrier
  v_mfma_f32_16x16x32_bf16 v[224:227], a[160:163], a[232:235], v[224:227]
  ds_read_b64_tr_b16 a[224:225], v7 offset:0
  v_mfma_f32_16x16x32_bf16 v[224:227], a[164:167], a[236:239], v[224:227]
  ds_read_b64_tr_b16 a[226:227], v7 offset:1024
  v_mfma_f32_16x16x32_bf16 v[228:231], a[168:171], a[232:235], v[228:231]
  ds_read_b64_tr_b16 a[228:229], v7 offset:8192
  v_mfma_f32_16x16x32_bf16 v[228:231], a[172:175], a[236:239], v[228:231]
  ds_read_b64_tr_b16 a[230:231], v7 offset:9216
  v_mfma_f32_16x16x32_bf16 v[232:235], a[176:179], a[232:235], v[232:235]
  s_add_u32 m0, s56, 32768
  v_mfma_f32_16x16x32_bf16 v[232:235], a[180:183], a[236:239], v[232:235]
  s_add_u32 s51, s55, 1572864
  v_mfma_f32_16x16x32_bf16 v[236:239], a[184:187], a[232:235], v[236:239]
  buffer_load_dwordx4 v3, s[44:47], s51 offen lds
  v_mfma_f32_16x16x32_bf16 v[236:239], a[188:191], a[236:239], v[236:239]
  s_add_u32 m0, s56, 33792
  v_mfma_f32_16x16x32_bf16 v[240:243], a[192:195], a[232:235], v[240:243]
  s_add_u32 s51, s55, 1605632
  v_mfma_f32_16x16x32_bf16 v[240:243], a[196:199], a[236:239], v[240:243]
  buffer_load_dwordx4 v3, s[44:47], s51 offen lds
  v_mfma_f32_16x16x32_bf16 v[244:247], a[200:203], a[232:235], v[244:247]
  s_add_u32 m0, s56, 34816
  v_mfma_f32_16x16x32_bf16 v[244:247], a[204:207], a[236:239], v[244:247]
  s_add_u32 s51, s55, 1638400
  v_mfma_f32_16x16x32_bf16 v[248:251], a[208:211], a[232:235], v[248:251]
  buffer_load_dwordx4 v4, s[44:47], s51 offen lds
  v_mfma_f32_16x16x32_bf16 v[248:251], a[212:215], a[236:239], v[248:251]
  v_mfma_f32_16x16x32_bf16 v[252:255], a[216:219], a[232:235], v[252:255]
  v_mfma_f32_16x16x32_bf16 v[252:255], a[220:223], a[236:239], v[252:255]
  s_waitcnt lgkmcnt(0)
  v_mfma_f32_16x16x32_bf16 a[0:3], a[224:227], a[96:99], a[0:3]
  s_add_u32 m0, s56, 35840
  ds_read_b64_tr_b16 a[232:233], v8 offset:0
  v_mfma_f32_16x16x32_bf16 a[0:3], a[228:231], a[100:103], a[0:3]
  s_add_u32 s51, s55, 1671168
  ds_read_b64_tr_b16 a[234:235], v8 offset:1024
  v_mfma_f32_16x16x32_bf16 a[4:7], a[224:227], a[104:107], a[4:7]
  ds_read_b64_tr_b16 a[236:237], v8 offset:8192
  buffer_load_dwordx4 v4, s[44:47], s51 offen lds
  v_mfma_f32_16x16x32_bf16 a[4:7], a[228:231], a[108:111], a[4:7]
  s_add_u32 m0, s56, 36864
  ds_read_b64_tr_b16 a[238:239], v8 offset:9216
  v_mfma_f32_16x16x32_bf16 a[8:11], a[224:227], a[112:115], a[8:11]
  s_add_u32 s51, s55, 1703936
  v_mfma_f32_16x16x32_bf16 a[8:11], a[228:231], a[116:119], a[8:11]
  ds_read_b128 a[160:163], v5 offset:32768
  v_mfma_f32_16x16x32_bf16 a[12:15], a[224:227], a[120:123], a[12:15]
  buffer_load_dwordx4 v3, s[44:47], s51 offen lds
  v_mfma_f32_16x16x32_bf16 a[12:15], a[228:231], a[124:127], a[12:15]
  v_mfma_f32_16x16x32_bf16 a[16:19], a[224:227], a[128:131], a[16:19]
  v_mfma_f32_16x16x32_bf16 a[16:19], a[228:231], a[132:135], a[16:19]
  s_add_u32 m0, s56, 37888
  v_mfma_f32_16x16x32_bf16 a[20:23], a[224:227], a[136:139], a[20:23]
  s_add_u32 s51, s55, 1736704
  v_mfma_f32_16x16x32_bf16 a[20:23], a[228:231], a[140:143], a[20:23]
  ds_read_b128 a[164:167], v6 offset:32768
  v_mfma_f32_16x16x32_bf16 a[24:27], a[224:227], a[144:147], a[24:27]
  buffer_load_dwordx4 v3, s[44:47], s51 offen lds
  v_mfma_f32_16x16x32_bf16 a[24:27], a[228:231], a[148:151], a[24:27]
  v_mfma_f32_16x16x32_bf16 a[28:31], a[224:227], a[152:155], a[28:31]
  s_add_u32 m0, s56, 38912
  v_mfma_f32_16x16x32_bf16 a[28:31], a[228:231], a[156:159], a[28:31]
  s_waitcnt lgkmcnt(2)
  s_add_u32 s51, s55, 1769472
  v_mfma_f32_16x16x32_bf16 a[32:35], a[232:235], a[96:99], a[32:35]
  ds_read_b64_tr_b16 a[224:225], v9 offset:0
  buffer_load_dwordx4 v4, s[44:47], s51 offen lds
  v_mfma_f32_16x16x32_bf16 a[32:35], a[236:239], a[100:103], a[32:35]
  ds_read_b64_tr_b16 a[226:227], v9 offset:1024
  v_mfma_f32_16x16x32_bf16 a[36:39], a[232:235], a[104:107], a[36:39]
  ds_read_b64_tr_b16 a[228:229], v9 offset:8192
  v_mfma_f32_16x16x32_bf16 a[36:39], a[236:239], a[108:111], a[36:39]
  ds_read_b64_tr_b16 a[230:231], v9 offset:9216
  v_mfma_f32_16x16x32_bf16 a[40:43], a[232:235], a[112:115], a[40:43]
  s_add_u32 m0, s56, 39936
  ds_read_b128 a[168:171], v5 offset:34816
  v_mfma_f32_16x16x32_bf16 a[40:43], a[236:239], a[116:119], a[40:43]
  s_add_u32 s51, s55, 1802240
  v_mfma_f32_16x16x32_bf16 a[44:47], a[232:235], a[120:123], a[44:47]
  buffer_load_dwordx4 v4, s[44:47], s51 offen lds
  v_mfma_f32_16x16x32_bf16 a[44:47], a[236:239], a[124:127], a[44:47]
  ds_read_b128 a[172:175], v6 offset:34816
  v_mfma_f32_16x16x32_bf16 a[48:51], a[232:235], a[128:131], a[48:51]
  s_waitcnt vmcnt(8)
  s_barrier
  v_mfma_f32_16x16x32_bf16 a[48:51], a[236:239], a[132:135], a[48:51]
  s_add_u32 m0, s56, 65536
  v_mfma_f32_16x16x32_bf16 a[52:55], a[232:235], a[136:139], a[52:55]
  s_add_u32 s51, s54, 512
  v_mfma_f32_16x16x32_bf16 a[52:55], a[236:239], a[140:143], a[52:55]
  s_lshl_b32 s52, s83, 6
  buffer_load_dwordx4 v1, s[12:15], s51 offen lds
  v_mfma_f32_16x16x32_bf16 a[56:59], a[232:235], a[144:147], a[56:59]
  s_cmp_lt_u32 s2, 80
  s_cselect_b32 s52, s52, 0x40000000
  buffer_atomic_add v20, v19, s[32:35], s52 offen offset:0
  v_mfma_f32_16x16x32_bf16 a[56:59], a[236:239], a[148:151], a[56:59]
  ds_read_b128 a[176:179], v5 offset:36864
  v_mfma_f32_16x16x32_bf16 a[60:63], a[232:235], a[152:155], a[60:63]
  v_mfma_f32_16x16x32_bf16 a[60:63], a[236:239], a[156:159], a[60:63]
  s_waitcnt lgkmcnt(3)
  s_add_u32 m0, s56, 66560
  v_mfma_f32_16x16x32_bf16 a[64:67], a[224:227], a[96:99], a[64:67]
  s_add_u32 s51, s54, 512
  ds_read_b64_tr_b16 a[232:233], v10 offset:0
  v_mfma_f32_16x16x32_bf16 a[64:67], a[228:231], a[100:103], a[64:67]
  ds_read_b64_tr_b16 a[234:235], v10 offset:1024
  buffer_load_dwordx4 v2, s[12:15], s51 offen lds
  v_mfma_f32_16x16x32_bf16 a[68:71], a[224:227], a[104:107], a[68:71]
  ds_read_b64_tr_b16 a[236:237], v10 offset:8192
  v_mfma_f32_16x16x32_bf16 a[68:71], a[228:231], a[108:111], a[68:71]
  ds_read_b64_tr_b16 a[238:239], v10 offset:9216
  v_mfma_f32_16x16x32_bf16 a[72:75], a[224:227], a[112:115], a[72:75]
  s_add_u32 m0, s56, 67584
  ds_read_b128 a[180:183], v6 offset:36864
  v_mfma_f32_16x16x32_bf16 a[72:75], a[228:231], a[116:119], a[72:75]
  s_add_u32 s51, s54, 16896
  v_mfma_f32_16x16x32_bf16 a[76:79], a[224:227], a[120:123], a[76:79]
  buffer_load_dwordx4 v1, s[12:15], s51 offen lds
  v_mfma_f32_16x16x32_bf16 a[76:79], a[228:231], a[124:127], a[76:79]
  v_mfma_f32_16x16x32_bf16 a[80:83], a[224:227], a[128:131], a[80:83]
  v_mfma_f32_16x16x32_bf16 a[80:83], a[228:231], a[132:135], a[80:83]
  ds_read_b128 a[184:187], v5 offset:38912
  v_mfma_f32_16x16x32_bf16 a[84:87], a[224:227], a[136:139], a[84:87]
  s_add_u32 m0, s56, 68608
  v_mfma_f32_16x16x32_bf16 a[84:87], a[228:231], a[140:143], a[84:87]
  s_add_u32 s51, s54, 16896
  v_mfma_f32_16x16x32_bf16 a[88:91], a[224:227], a[144:147], a[88:91]
  buffer_load_dwordx4 v2, s[12:15], s51 offen lds
  v_mfma_f32_16x16x32_bf16 a[88:91], a[228:231], a[148:151], a[88:91]
  v_mfma_f32_16x16x32_bf16 a[92:95], a[224:227], a[152:155], a[92:95]
  v_mfma_f32_16x16x32_bf16 a[92:95], a[228:231], a[156:159], a[92:95]
  s_waitcnt lgkmcnt(2)
  s_add_u32 m0, s56, 69632
  ds_read_b128 a[188:191], v6 offset:38912
  v_mfma_f32_16x16x32_bf16 v[96:99], a[232:235], a[96:99], v[96:99]
  s_add_u32 s51, s54, 33280
  ds_read_b64_tr_b16 a[224:225], v7 offset:16384
  v_mfma_f32_16x16x32_bf16 v[96:99], a[236:239], a[100:103], v[96:99]
  ds_read_b64_tr_b16 a[226:227], v7 offset:17408
  buffer_load_dwordx4 v1, s[12:15], s51 offen lds
  v_mfma_f32_16x16x32_bf16 v[100:103], a[232:235], a[104:107], v[100:103]
  ds_read_b64_tr_b16 a[228:229], v7 offset:24576
  v_mfma_f32_16x16x32_bf16 v[100:103], a[236:239], a[108:111], v[100:103]
  ds_read_b64_tr_b16 a[230:231], v7 offset:25600
  v_mfma_f32_16x16x32_bf16 v[104:107], a[232:235], a[112:115], v[104:107]
  v_mfma_f32_16x16x32_bf16 v[104:107], a[236:239], a[116:119], v[104:107]
  s_add_u32 m0, s56, 70656
  ds_read_b128 a[192:195], v5 offset:49152
  v_mfma_f32_16x16x32_bf16 v[108:111], a[232:235], a[120:123], v[108:111]
  s_add_u32 s51, s54, 33280
  v_mfma_f32_16x16x32_bf16 v[108:111], a[236:239], a[124:127], v[108:111]
  buffer_load_dwordx4 v2, s[12:15], s51 offen lds
  v_mfma_f32_16x16x32_bf16 v[112:115], a[232:235], a[128:131], v[112:115]
  v_mfma_f32_16x16x32_bf16 v[112:115], a[236:239], a[132:135], v[112:115]
  v_mfma_f32_16x16x32_bf16 v[116:119], a[232:235], a[136:139], v[116:119]
  s_add_u32 m0, s56, 71680
  v_mfma_f32_16x16x32_bf16 v[116:119], a[236:239], a[140:143], v[116:119]
  s_add_u32 s51, s54, 49664
  ds_read_b128 a[196:199], v6 offset:49152
  v_mfma_f32_16x16x32_bf16 v[120:123], a[232:235], a[144:147], v[120:123]
  buffer_load_dwordx4 v1, s[12:15], s51 offen lds
  v_mfma_f32_16x16x32_bf16 v[120:123], a[236:239], a[148:151], v[120:123]
  v_mfma_f32_16x16x32_bf16 v[124:127], a[232:235], a[152:155], v[124:127]
  v_mfma_f32_16x16x32_bf16 v[124:127], a[236:239], a[156:159], v[124:127]
  s_waitcnt lgkmcnt(2)
  v_mfma_f32_16x16x32_bf16 v[128:131], a[96:99], a[224:227], v[128:131]
  s_add_u32 m0, s56, 72704
  ds_read_b64_tr_b16 a[232:233], v8 offset:16384
  v_mfma_f32_16x16x32_bf16 v[128:131], a[100:103], a[228:231], v[128:131]
  s_add_u32 s51, s54, 49664
  ds_read_b64_tr_b16 a[234:235], v8 offset:17408
  v_mfma_f32_16x16x32_bf16 v[132:135], a[104:107], a[224:227], v[132:135]
  ds_read_b64_tr_b16 a[236:237], v8 offset:24576
  buffer_load_dwordx4 v2, s[12:15], s51 offen lds
  v_mfma_f32_16x16x32_bf16 v[132:135], a[108:111], a[228:231], v[132:135]
  ds_read_b64_tr_b16 a[238:239], v8 offset:25600
  v_mfma_f32_16x16x32_bf16 v[136:139], a[112:115], a[224:227], v[136:139]
  s_lshl_b32 s52, s2, 2
  ds_read_b128 a[200:203], v5 offset:51200
  v_mfma_f32_16x16x32_bf16 v[136:139], a[116:119], a[228:231], v[136:139]
  s_add_u32 s52, s52, s48
  v_mfma_f32_16x16x32_bf16 v[140:143], a[120:123], a[224:227], v[140:143]
  s_mul_i32 s52, s52, 2560
  v_mfma_f32_16x16x32_bf16 v[140:143], a[124:127], a[228:231], v[140:143]
  ds_read_b128 a[204:207], v6 offset:51200
  v_mfma_f32_16x16x32_bf16 v[144:147], a[128:131], a[224:227], v[144:147]
  buffer_load_dwordx2 v[76:77], v21, s[8:11], s52 offen offset:0
  v_mfma_f32_16x16x32_bf16 v[144:147], a[132:135], a[228:231], v[144:147]
  buffer_load_dwordx2 v[78:79], v21, s[8:11], s52 offen offset:256
  v_mfma_f32_16x16x32_bf16 v[148:151], a[136:139], a[224:227], v[148:151]
  v_mfma_f32_16x16x32_bf16 v[148:151], a[140:143], a[228:231], v[148:151]
  v_mfma_f32_16x16x32_bf16 v[152:155], a[144:147], a[224:227], v[152:155]
  buffer_load_dwordx2 v[80:81], v21, s[8:11], s52 offen offset:512
  v_mfma_f32_16x16x32_bf16 v[152:155], a[148:151], a[228:231], v[152:155]
  ds_read_b128 a[208:211], v5 offset:53248
  v_mfma_f32_16x16x32_bf16 v[156:159], a[152:155], a[224:227], v[156:159]
  v_mfma_f32_16x16x32_bf16 v[156:159], a[156:159], a[228:231], v[156:159]
  s_waitcnt lgkmcnt(3)
  v_mfma_f32_16x16x32_bf16 v[160:163], a[96:99], a[232:235], v[160:163]
  ds_read_b64_tr_b16 a[224:225], v9 offset:16384
  buffer_load_dwordx2 v[82:83], v21, s[8:11], s52 offen offset:768
  v_mfma_f32_16x16x32_bf16 v[160:163], a[100:103], a[236:239], v[160:163]
  ds_read_b64_tr_b16 a[226:227], v9 offset:17408
  v_mfma_f32_16x16x32_bf16 v[164:167], a[104:107], a[232:235], v[164:167]
  ds_read_b64_tr_b16 a[228:229], v9 offset:24576
  v_mfma_f32_16x16x32_bf16 v[164:167], a[108:111], a[236:239], v[164:167]
  ds_read_b64_tr_b16 a[230:231], v9 offset:25600
  v_mfma_f32_16x16x32_bf16 v[168:171], a[112:115], a[232:235], v[168:171]
  ds_read_b128 a[212:215], v6 offset:53248
  v_mfma_f32_16x16x32_bf16 v[168:171], a[116:119], a[236:239], v[168:171]
  buffer_load_dwordx2 v[84:85], v21, s[8:11], s52 offen offset:1024
  v_mfma_f32_16x16x32_bf16 v[172:175], a[120:123], a[232:235], v[172:175]
  v_mfma_f32_16x16x32_bf16 v[172:175], a[124:127], a[236:239], v[172:175]
  s_add_u32 s52, s57, 3670016
  v_mfma_f32_16x16x32_bf16 v[176:179], a[128:131], a[232:235], v[176:179]
  buffer_load_dword v23, v12, s[44:47], s52 offen
  v_mfma_f32_16x16x32_bf16 v[176:179], a[132:135], a[236:239], v[176:179]
  ds_read_b128 a[216:219], v5 offset:55296
  v_mfma_f32_16x16x32_bf16 v[180:183], a[136:139], a[232:235], v[180:183]
  v_mfma_f32_16x16x32_bf16 v[180:183], a[140:143], a[236:239], v[180:183]
  v_mfma_f32_16x16x32_bf16 v[184:187], a[144:147], a[232:235], v[184:187]
  v_mfma_f32_16x16x32_bf16 v[184:187], a[148:151], a[236:239], v[184:187]
  v_mfma_f32_16x16x32_bf16 v[188:191], a[152:155], a[232:235], v[188:191]
  v_mfma_f32_16x16x32_bf16 v[188:191], a[156:159], a[236:239], v[188:191]
  s_waitcnt lgkmcnt(2)
  ds_read_b128 a[220:223], v6 offset:55296
  v_mfma_f32_16x16x32_bf16 v[192:195], a[96:99], a[224:227], v[192:195]
  ds_read_b64_tr_b16 a[232:233], v10 offset:16384
  v_mfma_f32_16x16x32_bf16 v[192:195], a[100:103], a[228:231], v[192:195]
  ds_read_b64_tr_b16 a[234:235], v10 offset:17408
  v_mfma_f32_16x16x32_bf16 v[196:199], a[104:107], a[224:227], v[196:199]
  ds_read_b64_tr_b16 a[236:237], v10 offset:24576
  v_mfma_f32_16x16x32_bf16 v[196:199], a[108:111], a[228:231], v[196:199]
  ds_read_b64_tr_b16 a[238:239], v10 offset:25600
  v_mfma_f32_16x16x32_bf16 v[200:203], a[112:115], a[224:227], v[200:203]
  v_mfma_f32_16x16x32_bf16 v[200:203], a[116:119], a[228:231], v[200:203]
  v_mfma_f32_16x16x32_bf16 v[204:207], a[120:123], a[224:227], v[204:207]
  v_mfma_f32_16x16x32_bf16 v[204:207], a[124:127], a[228:231], v[204:207]
  v_mfma_f32_16x16x32_bf16 v[208:211], a[128:131], a[224:227], v[208:211]
  v_mfma_f32_16x16x32_bf16 v[208:211], a[132:135], a[228:231], v[208:211]
  v_mfma_f32_16x16x32_bf16 v[212:215], a[136:139], a[224:227], v[212:215]
  v_mfma_f32_16x16x32_bf16 v[212:215], a[140:143], a[228:231], v[212:215]
  v_mfma_f32_16x16x32_bf16 v[216:219], a[144:147], a[224:227], v[216:219]
  v_mfma_f32_16x16x32_bf16 v[216:219], a[148:151], a[228:231], v[216:219]
  v_mfma_f32_16x16x32_bf16 v[220:223], a[152:155], a[224:227], v[220:223]
  v_mfma_f32_16x16x32_bf16 v[220:223], a[156:159], a[228:231], v[220:223]
  s_waitcnt vmcnt(6) lgkmcnt(0)
  s_barrier
  v_mfma_f32_16x16x32_bf16 v[224:227], a[96:99], a[232:235], v[224:227]
  ds_read_b64_tr_b16 a[224:225], v7 offset:32768
  v_mfma_f32_16x16x32_bf16 v[224:227], a[100:103], a[236:239], v[224:227]
  ds_read_b64_tr_b16 a[226:227], v7 offset:33792
  v_mfma_f32_16x16x32_bf16 v[228:231], a[104:107], a[232:235], v[228:231]
  ds_read_b64_tr_b16 a[228:229], v7 offset:40960
  v_mfma_f32_16x16x32_bf16 v[228:231], a[108:111], a[236:239], v[228:231]
  ds_read_b64_tr_b16 a[230:231], v7 offset:41984
  v_mfma_f32_16x16x32_bf16 v[232:235], a[112:115], a[232:235], v[232:235]
  s_add_u32 m0, s56, 0
  v_mfma_f32_16x16x32_bf16 v[232:235], a[116:119], a[236:239], v[232:235]
  s_add_u32 s51, s55, 2097152
  v_mfma_f32_16x16x32_bf16 v[236:239], a[120:123], a[232:235], v[236:239]
  buffer_load_dwordx4 v3, s[44:47], s51 offen lds
  v_mfma_f32_16x16x32_bf16 v[236:239], a[124:127], a[236:239], v[236:239]
  s_add_u32 m0, s56, 1024
  v_mfma_f32_16x16x32_bf16 v[240:243], a[128:131], a[232:235], v[240:243]
  s_add_u32 s51, s55, 2129920
  v_mfma_f32_16x16x32_bf16 v[240:243], a[132:135], a[236:239], v[240:243]
  buffer_load_dwordx4 v3, s[44:47], s51 offen lds
  v_mfma_f32_16x16x32_bf16 v[244:247], a[136:139], a[232:235], v[244:247]
  s_add_u32 m0, s56, 2048
  v_mfma_f32_16x16x32_bf16 v[244:247], a[140:143], a[236:239], v[244:247]
  s_add_u32 s51, s55, 2162688
  v_mfma_f32_16x16x32_bf16 v[248:251], a[144:147], a[232:235], v[248:251]
  buffer_load_dwordx4 v4, s[44:47], s51 offen lds
  v_mfma_f32_16x16x32_bf16 v[248:251], a[148:151], a[236:239], v[248:251]
  v_mfma_f32_16x16x32_bf16 v[252:255], a[152:155], a[232:235], v[252:255]
  v_mfma_f32_16x16x32_bf16 v[252:255], a[156:159], a[236:239], v[252:255]
  s_waitcnt lgkmcnt(0)
  v_mfma_f32_16x16x32_bf16 a[0:3], a[224:227], a[160:163], a[0:3]
  s_add_u32 m0, s56, 3072
  ds_read_b64_tr_b16 a[232:233], v8 offset:32768
  v_and_b32 v17, 3, v0
  v_mfma_f32_16x16x32_bf16 a[0:3], a[228:231], a[164:167], a[0:3]
  s_add_u32 s51, s55, 2195456
  ds_read_b64_tr_b16 a[234:235], v8 offset:33792
  v_lshlrev_b32 v17, 6, v17
  v_mfma_f32_16x16x32_bf16 a[4:7], a[224:227], a[168:171], a[4:7]
  s_lshr_b32 s61, s2, 4
  ds_read_b64_tr_b16 a[236:237], v8 offset:40960
  buffer_load_dwordx4 v4, s[44:47], s51 offen lds
  v_mfma_f32_16x16x32_bf16 a[4:7], a[228:231], a[172:175], a[4:7]
  s_add_u32 m0, s56, 4096
  ds_read_b64_tr_b16 a[238:239], v8 offset:41984
  v_mfma_f32_16x16x32_bf16 a[8:11], a[224:227], a[176:179], a[8:11]
  s_add_u32 s51, s55, 2228224
  s_waitcnt vmcnt(9)
  v_lshlrev_b32 v32, 16, v76
  v_and_b32 v33, 0xffff0000, v76
  v_mfma_f32_16x16x32_bf16 a[8:11], a[228:231], a[180:183], a[8:11]
  s_lshl_b32 s61, s61, 1
  ds_read_b128 a[96:99], v5 offset:0
  v_lshlrev_b32 v34, 16, v77
  v_mfma_f32_16x16x32_bf16 a[12:15], a[224:227], a[184:187], a[12:15]
  s_bfe_u32 s53, s2, 0x10001
  buffer_load_dwordx4 v3, s[44:47], s51 offen lds
  v_mfma_f32_16x16x32_bf16 a[12:15], a[228:231], a[188:191], a[12:15]
  s_add_u32 s61, s61, s53
  v_and_b32 v35, 0xffff0000, v77
  s_waitcnt vmcnt(9)
  v_lshlrev_b32 v36, 16, v78
  v_mfma_f32_16x16x32_bf16 a[16:19], a[224:227], a[192:195], a[16:19]
  s_mul_i32 s61, s61, 81920
  v_and_b32 v37, 0xffff0000, v78
  v_lshlrev_b32 v38, 16, v79
  v_mfma_f32_16x16x32_bf16 a[16:19], a[228:231], a[196:199], a[16:19]
  s_add_u32 m0, s56, 5120
  v_and_b32 v39, 0xffff0000, v79
  s_waitcnt vmcnt(8)
  v_lshlrev_b32 v40, 16, v80
  v_mfma_f32_16x16x32_bf16 a[20:23], a[224:227], a[200:203], a[20:23]
  s_add_u32 s51, s55, 2260992
  v_and_b32 v41, 0xffff0000, v80
  v_lshlrev_b32 v42, 16, v81
  v_mfma_f32_16x16x32_bf16 a[20:23], a[228:231], a[204:207], a[20:23]
  s_bfe_u32 s53, s2, 0x20002
  ds_read_b128 a[100:103], v6 offset:0
  v_and_b32 v43, 0xffff0000, v81
  v_mfma_f32_16x16x32_bf16 a[24:27], a[224:227], a[208:211], a[24:27]
  s_lshl_b32 s53, s53, 10
  buffer_load_dwordx4 v3, s[44:47], s51 offen lds
  v_mfma_f32_16x16x32_bf16 a[24:27], a[228:231], a[212:215], a[24:27]
  s_add_u32 s61, s61, s53
  s_waitcnt vmcnt(8)
  v_lshlrev_b32 v44, 16, v82
  v_and_b32 v45, 0xffff0000, v82
  v_mfma_f32_16x16x32_bf16 a[28:31], a[224:227], a[216:219], a[28:31]
  s_add_u32 m0, s56, 6144
  v_lshlrev_b32 v46, 16, v83
  v_and_b32 v47, 0xffff0000, v83
  v_mfma_f32_16x16x32_bf16 a[28:31], a[228:231], a[220:223], a[28:31]
  s_waitcnt lgkmcnt(2)
  s_add_u32 s51, s55, 2293760
  s_waitcnt vmcnt(7)
  v_lshlrev_b32 v48, 16, v84
  v_and_b32 v49, 0xffff0000, v84
  v_mfma_f32_16x16x32_bf16 a[32:35], a[232:235], a[160:163], a[32:35]
  s_and_b32 s53, s2, 1
  ds_read_b64_tr_b16 a[224:225], v9 offset:32768
  buffer_load_dwordx4 v4, s[44:47], s51 offen lds
  v_mfma_f32_16x16x32_bf16 a[32:35], a[236:239], a[164:167], a[32:35]
  s_lshl_b32 s53, s53, 7
  ds_read_b64_tr_b16 a[226:227], v9 offset:33792
  v_lshlrev_b32 v50, 16, v85
  v_mfma_f32_16x16x32_bf16 a[36:39], a[232:235], a[168:171], a[36:39]
  s_add_u32 s61, s61, s53
  ds_read_b64_tr_b16 a[228:229], v9 offset:40960
  v_and_b32 v51, 0xffff0000, v85
  v_mfma_f32_16x16x32_bf16 a[36:39], a[236:239], a[172:175], a[36:39]
  s_add_u32 s61, s61, s56
  ds_read_b64_tr_b16 a[230:231], v9 offset:41984
  v_add_f32 v92, v32, v33
  v_mfma_f32_16x16x32_bf16 a[40:43], a[232:235], a[176:179], a[40:43]
  s_add_u32 m0, s56, 7168
  ds_read_b128 a[104:107], v5 offset:2048
  v_add_f32 v93, v34, v35
  v_mfma_f32_16x16x32_bf16 a[40:43], a[236:239], a[180:183], a[40:43]
  s_add_u32 s51, s55, 2326528
  v_add_f32 v92, v92, v36
  v_add_f32 v93, v93, v37
  v_mfma_f32_16x16x32_bf16 a[44:47], a[232:235], a[184:187], a[44:47]
  s_add_u32 s61, s61, 1048576
  buffer_load_dwordx4 v4, s[44:47], s51 offen lds
  v_mfma_f32_16x16x32_bf16 a[44:47], a[236:239], a[188:191], a[44:47]
  ds_read_b128 a[108:111], v6 offset:2048
  v_add_f32 v92, v92, v38
  v_mfma_f32_16x16x32_bf16 a[48:51], a[232:235], a[192:195], a[48:51]
  v_add_f32 v93, v93, v39
  v_add_f32 v92, v92, v40
  v_mfma_f32_16x16x32_bf16 a[48:51], a[236:239], a[196:199], a[48:51]
  s_add_u32 m0, s56, 98304
  v_add_f32 v93, v93, v41
  v_add_f32 v92, v92, v42
  v_mfma_f32_16x16x32_bf16 a[52:55], a[232:235], a[200:203], a[52:55]
  s_add_u32 s51, s54, 640
  v_add_f32 v93, v93, v43
  v_add_f32 v92, v92, v44
  v_mfma_f32_16x16x32_bf16 a[52:55], a[236:239], a[204:207], a[52:55]
  buffer_load_dwordx4 v1, s[12:15], s51 offen lds
  v_mfma_f32_16x16x32_bf16 a[56:59], a[232:235], a[208:211], a[56:59]
  v_add_f32 v93, v93, v45
  v_add_f32 v92, v92, v46
  v_mfma_f32_16x16x32_bf16 a[56:59], a[236:239], a[212:215], a[56:59]
  ds_read_b128 a[112:115], v5 offset:4096
  v_add_f32 v93, v93, v47
  v_mfma_f32_16x16x32_bf16 a[60:63], a[232:235], a[216:219], a[60:63]
  v_add_f32 v92, v92, v48
  v_add_f32 v93, v93, v49
  v_mfma_f32_16x16x32_bf16 a[60:63], a[236:239], a[220:223], a[60:63]
  s_waitcnt lgkmcnt(3)
  s_add_u32 m0, s56, 99328
  v_add_f32 v92, v92, v50
  v_add_f32 v93, v93, v51
  v_mfma_f32_16x16x32_bf16 a[64:67], a[224:227], a[160:163], a[64:67]
  s_add_u32 s51, s54, 640
  ds_read_b64_tr_b16 a[232:233], v10 offset:32768
  v_add_f32 v92, v92, v93
  v_mfma_f32_16x16x32_bf16 a[64:67], a[228:231], a[164:167], a[64:67]
  ds_read_b64_tr_b16 a[234:235], v10 offset:33792
  buffer_load_dwordx4 v2, s[12:15], s51 offen lds
  v_mfma_f32_16x16x32_bf16 a[68:71], a[224:227], a[168:171], a[68:71]
  ds_read_b64_tr_b16 a[236:237], v10 offset:40960
  v_add_f32 v92, v92, v92 row_ror:1
  v_mfma_f32_16x16x32_bf16 a[68:71], a[228:231], a[172:175], a[68:71]
  ds_read_b64_tr_b16 a[238:239], v10 offset:41984
  v_add_f32 v92, v92, v92 row_ror:2
  v_mfma_f32_16x16x32_bf16 a[72:75], a[224:227], a[176:179], a[72:75]
  s_add_u32 m0, s56, 100352
  ds_read_b128 a[116:119], v6 offset:4096
  v_add_f32 v92, v92, v92 row_ror:4
  v_mfma_f32_16x16x32_bf16 a[72:75], a[228:231], a[180:183], a[72:75]
  s_add_u32 s51, s54, 17024
  v_add_f32 v92, v92, v92 row_ror:8
  v_mov_b32 v93, v92
  v_mfma_f32_16x16x32_bf16 a[76:79], a[224:227], a[184:187], a[76:79]
  buffer_load_dwordx4 v1, s[12:15], s51 offen lds
  v_mfma_f32_16x16x32_bf16 a[76:79], a[228:231], a[188:191], a[76:79]
  v_permlane16_swap_b32 v92, v93
  v_add_f32 v92, v92, v93
  v_mfma_f32_16x16x32_bf16 a[80:83], a[224:227], a[192:195], a[80:83]
  v_mul_f32 v92, 0x3acccccd, v92
  v_sub_f32 v32, v32, v92
  v_mfma_f32_16x16x32_bf16 a[80:83], a[228:231], a[196:199], a[80:83]
  ds_read_b128 a[120:123], v5 offset:6144
  v_sub_f32 v33, v33, v92
  v_mfma_f32_16x16x32_bf16 a[84:87], a[224:227], a[200:203], a[84:87]
HS1:
  s_cbranch_execz HS5
  s_add_u32 m0, s56, 101376
  v_sub_f32 v34, v34, v92
  v_sub_f32 v35, v35, v92
  v_mfma_f32_16x16x32_bf16 a[84:87], a[228:231], a[204:207], a[84:87]
  s_add_u32 s51, s54, 17024
  v_sub_f32 v36, v36, v92
  v_sub_f32 v37, v37, v92
  v_mfma_f32_16x16x32_bf16 a[88:91], a[224:227], a[208:211], a[88:91]
  buffer_load_dwordx4 v2, s[12:15], s51 offen lds
  v_mfma_f32_16x16x32_bf16 a[88:91], a[228:231], a[212:215], a[88:91]
  v_sub_f32 v38, v38, v92
  v_sub_f32 v39, v39, v92
  v_mfma_f32_16x16x32_bf16 a[92:95], a[224:227], a[216:219], a[92:95]
  v_sub_f32 v40, v40, v92
  v_sub_f32 v41, v41, v92
  v_mfma_f32_16x16x32_bf16 a[92:95], a[228:231], a[220:223], a[92:95]
  s_waitcnt lgkmcnt(2)
  s_add_u32 m0, s56, 102400
  ds_read_b128 a[124:127], v6 offset:6144
  v_sub_f32 v42, v42, v92
  v_mfma_f32_16x16x32_bf16 v[96:99], a[232:235], a[160:163], v[96:99]
  s_add_u32 s51, s54, 33408
  ds_read_b64_tr_b16 a[224:225], v7 offset:49152
  v_sub_f32 v43, v43, v92
  v_mfma_f32_16x16x32_bf16 v[96:99], a[236:239], a[164:167], v[96:99]
  ds_read_b64_tr_b16 a[226:227], v7 offset:50176
  buffer_load_dwordx4 v1, s[12:15], s51 offen lds
  v_mfma_f32_16x16x32_bf16 v[100:103], a[232:235], a[168:171], v[100:103]
  ds_read_b64_tr_b16 a[228:229], v7 offset:57344
  v_sub_f32 v44, v44, v92
  v_mfma_f32_16x16x32_bf16 v[100:103], a[236:239], a[172:175], v[100:103]
  ds_read_b64_tr_b16 a[230:231], v7 offset:58368
  v_sub_f32 v45, v45, v92
  v_mfma_f32_16x16x32_bf16 v[104:107], a[232:235], a[176:179], v[104:107]
  v_sub_f32 v46, v46, v92
  v_sub_f32 v47, v47, v92
  v_mfma_f32_16x16x32_bf16 v[104:107], a[236:239], a[180:183], v[104:107]
  s_add_u32 m0, s56, 103424
  ds_read_b128 a[128:131], v5 offset:16384
  v_sub_f32 v48, v48, v92
  v_mfma_f32_16x16x32_bf16 v[108:111], a[232:235], a[184:187], v[108:111]
  s_add_u32 s51, s54, 33408
  buffer_load_dword v18, v17, s[32:35], 0 offen sc1
  v_mfma_f32_16x16x32_bf16 v[108:111], a[236:239], a[188:191], v[108:111]
  buffer_load_dwordx4 v2, s[12:15], s51 offen lds
  v_mfma_f32_16x16x32_bf16 v[112:115], a[232:235], a[192:195], v[112:115]
  v_sub_f32 v49, v49, v92
  v_sub_f32 v50, v50, v92
  v_mfma_f32_16x16x32_bf16 v[112:115], a[236:239], a[196:199], v[112:115]
  v_sub_f32 v51, v51, v92
  v_mul_f32 v92, v32, v32
  v_mfma_f32_16x16x32_bf16 v[116:119], a[232:235], a[200:203], v[116:119]
  s_add_u32 m0, s56, 104448
  v_mul_f32 v93, v33, v33
  v_fmac_f32 v92, v34, v34
  v_mfma_f32_16x16x32_bf16 v[116:119], a[236:239], a[204:207], v[116:119]
  s_add_u32 s51, s54, 49792
  ds_read_b128 a[132:135], v6 offset:16384
  v_fmac_f32 v93, v35, v35
  v_mfma_f32_16x16x32_bf16 v[120:123], a[232:235], a[208:211], v[120:123]
  buffer_load_dwordx4 v1, s[12:15], s51 offen lds
  v_mfma_f32_16x16x32_bf16 v[120:123], a[236:239], a[212:215], v[120:123]
  v_fmac_f32 v92, v36, v36
  v_fmac_f32 v93, v37, v37
  v_mfma_f32_16x16x32_bf16 v[124:127], a[232:235], a[216:219], v[124:127]
  v_fmac_f32 v92, v38, v38
  v_fmac_f32 v93, v39, v39
  v_mfma_f32_16x16x32_bf16 v[124:127], a[236:239], a[220:223], v[124:127]
  s_waitcnt lgkmcnt(2)
  v_fmac_f32 v92, v40, v40
  v_fmac_f32 v93, v41, v41
  v_mfma_f32_16x16x32_bf16 v[128:131], a[160:163], a[224:227], v[128:131]
  s_add_u32 m0, s56, 105472
  ds_read_b64_tr_b16 a[232:233], v8 offset:49152
  v_fmac_f32 v92, v42, v42
  v_mfma_f32_16x16x32_bf16 v[128:131], a[164:167], a[228:231], v[128:131]
  s_add_u32 s51, s54, 49792
  ds_read_b64_tr_b16 a[234:235], v8 offset:50176
  v_fmac_f32 v93, v43, v43
  v_mfma_f32_16x16x32_bf16 v[132:135], a[168:171], a[224:227], v[132:135]
  ds_read_b64_tr_b16 a[236:237], v8 offset:57344
  buffer_load_dwordx4 v2, s[12:15], s51 offen lds
  v_mfma_f32_16x16x32_bf16 v[132:135], a[172:175], a[228:231], v[132:135]
  ds_read_b64_tr_b16 a[238:239], v8 offset:58368
  v_fmac_f32 v92, v44, v44
  v_mfma_f32_16x16x32_bf16 v[136:139], a[176:179], a[224:227], v[136:139]
  ds_read_b128 a[136:139], v5 offset:18432
  v_fmac_f32 v93, v45, v45
  v_mfma_f32_16x16x32_bf16 v[136:139], a[180:183], a[228:231], v[136:139]
  v_fmac_f32 v92, v46, v46
  v_fmac_f32 v93, v47, v47
  v_mfma_f32_16x16x32_bf16 v[140:143], a[184:187], a[224:227], v[140:143]
  v_fmac_f32 v92, v48, v48
  v_fmac_f32 v93, v49, v49
  v_mfma_f32_16x16x32_bf16 v[140:143], a[188:191], a[228:231], v[140:143]
  ds_read_b128 a[140:143], v6 offset:18432
  v_fmac_f32 v92, v50, v50
  v_mfma_f32_16x16x32_bf16 v[144:147], a[192:195], a[224:227], v[144:147]
  v_fmac_f32 v93, v51, v51
  v_add_f32 v92, v92, v93
  v_mfma_f32_16x16x32_bf16 v[144:147], a[196:199], a[228:231], v[144:147]
  s_nop 0
  v_add_f32 v92, v92, v92 row_ror:1
  v_mfma_f32_16x16x32_bf16 v[148:151], a[200:203], a[224:227], v[148:151]
  s_nop 0
  v_add_f32 v92, v92, v92 row_ror:2
  v_mfma_f32_16x16x32_bf16 v[148:151], a[204:207], a[228:231], v[148:151]
  s_nop 0
  v_add_f32 v92, v92, v92 row_ror:4
  v_mfma_f32_16x16x32_bf16 v[152:155], a[208:211], a[224:227], v[152:155]
  s_nop 0
  v_add_f32 v92, v92, v92 row_ror:8
  v_mov_b32 v93, v92
  v_mfma_f32_16x16x32_bf16 v[152:155], a[212:215], a[228:231], v[152:155]
  ds_read_b128 a[144:147], v5 offset:20480
  v_permlane16_swap_b32 v92, v93
  v_mfma_f32_16x16x32_bf16 v[156:159], a[216:219], a[224:227], v[156:159]
  v_add_f32 v92, v92, v93
  v_mov_b32 v93, 0x3727c5ac
  v_mfma_f32_16x16x32_bf16 v[156:159], a[220:223], a[228:231], v[156:159]
  s_waitcnt lgkmcnt(3)
  v_fmac_f32 v93, 0x3acccccd, v92
  v_mfma_f32_16x16x32_bf16 v[160:163], a[160:163], a[232:235], v[160:163]
  ds_read_b64_tr_b16 a[224:225], v9 offset:49152
  v_mfma_f32_16x16x32_bf16 v[160:163], a[164:167], a[236:239], v[160:163]
  ds_read_b64_tr_b16 a[226:227], v9 offset:50176
  v_mfma_f32_16x16x32_bf16 v[164:167], a[168:171], a[232:235], v[164:167]
  ds_read_b64_tr_b16 a[228:229], v9 offset:57344
  v_mfma_f32_16x16x32_bf16 v[164:167], a[172:175], a[236:239], v[164:167]
  ds_read_b64_tr_b16 a[230:231], v9 offset:58368
  v_mfma_f32_16x16x32_bf16 v[168:171], a[176:179], a[232:235], v[168:171]
  ds_read_b128 a[148:151], v6 offset:20480
  s_waitcnt vmcnt(3)
  v_cmp_gt_u32 vcc, 20, v18
  s_nop 0
  s_cbranch_vccnz L_pm_w
L_pm_ok:
  v_mfma_f32_16x16x32_bf16 v[168:171], a[180:183], a[236:239], v[168:171]
  s_lshl_b32 s53, s48, 10
  v_rsq_f32 v93, v93
  v_mfma_f32_16x16x32_bf16 v[172:175], a[184:187], a[232:235], v[172:175]
  s_add_u32 s52, s53, 786432
  v_mul_f32 v93, 0x3e0293ee, v93
  v_mul_f32 v32, v32, v93
  v_mfma_f32_16x16x32_bf16 v[172:175], a[188:191], a[236:239], v[172:175]
  buffer_load_dwordx4 v[52:55], v15, s[28:31], s52 offen sc1
  v_mfma_f32_16x16x32_bf16 v[176:179], a[192:195], a[232:235], v[176:179]
  s_add_u32 s52, s53, 790528
  v_mul_f32 v33, v33, v93
  v_mul_f32 v34, v34, v93
  v_mfma_f32_16x16x32_bf16 v[176:179], a[196:199], a[236:239], v[176:179]
  ds_read_b128 a[152:155], v5 offset:22528
  v_mul_f32 v35, v35, v93
  v_mfma_f32_16x16x32_bf16 v[180:183], a[200:203], a[232:235], v[180:183]
  buffer_load_dwordx4 v[56:59], v15, s[28:31], s52 offen sc1
  v_mfma_f32_16x16x32_bf16 v[180:183], a[204:207], a[236:239], v[180:183]
  v_mul_f32 v36, v36, v93
  v_mul_f32 v37, v37, v93
  v_mfma_f32_16x16x32_bf16 v[184:187], a[208:211], a[232:235], v[184:187]
  s_add_u32 s52, s53, 794624
  v_mul_f32 v38, v38, v93
  v_mul_f32 v39, v39, v93
  v_mfma_f32_16x16x32_bf16 v[184:187], a[212:215], a[236:239], v[184:187]
  buffer_load_dwordx4 v[60:63], v15, s[28:31], s52 offen sc1
  v_mfma_f32_16x16x32_bf16 v[188:191], a[216:219], a[232:235], v[188:191]
  v_mul_f32 v40, v40, v93
  v_mul_f32 v41, v41, v93
  v_mfma_f32_16x16x32_bf16 v[188:191], a[220:223], a[236:239], v[188:191]
  s_waitcnt lgkmcnt(2)
  ds_read_b128 a[156:159], v6 offset:22528
  v_mul_f32 v42, v42, v93
  v_mfma_f32_16x16x32_bf16 v[192:195], a[160:163], a[224:227], v[192:195]
  s_add_u32 s52, s53, 798720
  ds_read_b64_tr_b16 a[232:233], v10 offset:49152
  v_mul_f32 v43, v43, v93
  v_mfma_f32_16x16x32_bf16 v[192:195], a[164:167], a[228:231], v[192:195]
  ds_read_b64_tr_b16 a[234:235], v10 offset:50176
  buffer_load_dwordx4 v[64:67], v15, s[28:31], s52 offen sc1
  v_mfma_f32_16x16x32_bf16 v[196:199], a[168:171], a[224:227], v[196:199]
  ds_read_b64_tr_b16 a[236:237], v10 offset:57344
  v_mul_f32 v44, v44, v93
  v_mfma_f32_16x16x32_bf16 v[196:199], a[172:175], a[228:231], v[196:199]
  ds_read_b64_tr_b16 a[238:239], v10 offset:58368
  v_mul_f32 v45, v45, v93
  v_mfma_f32_16x16x32_bf16 v[200:203], a[176:179], a[224:227], v[200:203]
  s_add_u32 s52, s53, 802816
  v_mul_f32 v46, v46, v93
  v_mul_f32 v47, v47, v93
  v_mfma_f32_16x16x32_bf16 v[200:203], a[180:183], a[228:231], v[200:203]
  buffer_load_dwordx4 v[68:71], v15, s[28:31], s52 offen sc1
  v_mfma_f32_16x16x32_bf16 v[204:207], a[184:187], a[224:227], v[204:207]
  s_and_b32 s52, s80, 7
  v_mul_f32 v48, v48, v93
  v_mul_f32 v49, v49, v93
  v_mfma_f32_16x16x32_bf16 v[204:207], a[188:191], a[228:231], v[204:207]
  s_lshl_b32 s52, s52, 7
  v_mul_f32 v50, v50, v93
  v_mul_f32 v51, v51, v93
  v_mfma_f32_16x16x32_bf16 v[208:211], a[192:195], a[224:227], v[208:211]
  s_add_u32 s52, s52, 464896
  v_mfma_f32_16x16x32_bf16 v[208:211], a[196:199], a[228:231], v[208:211]
  s_sub_u32 s5, s2, 80
  v_mfma_f32_16x16x32_bf16 v[212:215], a[200:203], a[224:227], v[212:215]
  s_cmp_lt_u32 s5, 160
  s_cselect_b32 s52, s52, 0x40000000
  v_mfma_f32_16x16x32_bf16 v[212:215], a[204:207], a[228:231], v[212:215]
  buffer_atomic_add v20, v19, s[28:31], s52 offen offset:0
  v_mfma_f32_16x16x32_bf16 v[216:219], a[208:211], a[224:227], v[216:219]
  v_mfma_f32_16x16x32_bf16 v[216:219], a[212:215], a[228:231], v[216:219]
  v_mfma_f32_16x16x32_bf16 v[220:223], a[216:219], a[224:227], v[220:223]
  v_mfma_f32_16x16x32_bf16 v[220:223], a[220:223], a[228:231], v[220:223]
  s_waitcnt vmcnt(6) lgkmcnt(0)
  s_barrier
  v_mfma_f32_16x16x32_bf16 v[224:227], a[160:163], a[232:235], v[224:227]
  ds_read_b64_tr_b16 a[224:225], v7 offset:0
  v_mfma_f32_16x16x32_bf16 v[224:227], a[164:167], a[236:239], v[224:227]
  ds_read_b64_tr_b16 a[226:227], v7 offset:1024
  v_mfma_f32_16x16x32_bf16 v[228:231], a[168:171], a[232:235], v[228:231]
  ds_read_b64_tr_b16 a[228:229], v7 offset:8192
  v_mfma_f32_16x16x32_bf16 v[228:231], a[172:175], a[236:239], v[228:231]
  ds_read_b64_tr_b16 a[230:231], v7 offset:9216
  v_mfma_f32_16x16x32_bf16 v[232:235], a[176:179], a[232:235], v[232:235]
  s_add_u32 m0, s56, 32768
  v_mfma_f32_16x16x32_bf16 v[232:235], a[180:183], a[236:239], v[232:235]
  s_add_u32 s51, s55, 2621440
  v_mfma_f32_16x16x32_bf16 v[236:239], a[184:187], a[232:235], v[236:239]
  buffer_load_dwordx4 v3, s[44:47], s51 offen lds
  v_mfma_f32_16x16x32_bf16 v[236:239], a[188:191], a[236:239], v[236:239]
  s_add_u32 m0, s56, 33792
  v_mfma_f32_16x16x32_bf16 v[240:243], a[192:195], a[232:235], v[240:243]
  s_add_u32 s51, s55, 2654208
  v_mfma_f32_16x16x32_bf16 v[240:243], a[196:199], a[236:239], v[240:243]
  buffer_load_dwordx4 v3, s[44:47], s51 offen lds
  v_mfma_f32_16x16x32_bf16 v[244:247], a[200:203], a[232:235], v[244:247]
  s_add_u32 m0, s56, 34816
  v_mfma_f32_16x16x32_bf16 v[244:247], a[204:207], a[236:239], v[244:247]
  s_add_u32 s51, s55, 2686976
  v_mfma_f32_16x16x32_bf16 v[248:251], a[208:211], a[232:235], v[248:251]
  buffer_load_dwordx4 v4, s[44:47], s51 offen lds
  v_mfma_f32_16x16x32_bf16 v[248:251], a[212:215], a[236:239], v[248:251]
  v_mfma_f32_16x16x32_bf16 v[252:255], a[216:219], a[232:235], v[252:255]
  v_mfma_f32_16x16x32_bf16 v[252:255], a[220:223], a[236:239], v[252:255]
  s_waitcnt lgkmcnt(0)
  v_mfma_f32_16x16x32_bf16 a[0:3], a[224:227], a[96:99], a[0:3]
  s_add_u32 m0, s56, 35840
  ds_read_b64_tr_b16 a[232:233], v8 offset:0
  v_mfma_f32_16x16x32_bf16 a[0:3], a[228:231], a[100:103], a[0:3]
  s_add_u32 s51, s55, 2719744
  ds_read_b64_tr_b16 a[234:235], v8 offset:1024
  v_mfma_f32_16x16x32_bf16 a[4:7], a[224:227], a[104:107], a[4:7]
  ds_read_b64_tr_b16 a[236:237], v8 offset:8192
  buffer_load_dwordx4 v4, s[44:47], s51 offen lds
  v_mfma_f32_16x16x32_bf16 a[4:7], a[228:231], a[108:111], a[4:7]
  s_add_u32 m0, s56, 36864
  ds_read_b64_tr_b16 a[238:239], v8 offset:9216
  v_mfma_f32_16x16x32_bf16 a[8:11], a[224:227], a[112:115], a[8:11]
  s_add_u32 s51, s55, 2752512
  v_mfma_f32_16x16x32_bf16 a[8:11], a[228:231], a[116:119], a[8:11]
  ds_read_b128 a[160:163], v5 offset:32768
  v_mfma_f32_16x16x32_bf16 a[12:15], a[224:227], a[120:123], a[12:15]
  buffer_load_dwordx4 v3, s[44:47], s51 offen lds
  v_mfma_f32_16x16x32_bf16 a[12:15], a[228:231], a[124:127], a[12:15]
  v_mfma_f32_16x16x32_bf16 a[16:19], a[224:227], a[128:131], a[16:19]
  v_mfma_f32_16x16x32_bf16 a[16:19], a[228:231], a[132:135], a[16:19]
  s_add_u32 m0, s56, 37888
  v_mfma_f32_16x16x32_bf16 a[20:23], a[224:227], a[136:139], a[20:23]
  s_add_u32 s51, s55, 2785280
  v_mfma_f32_16x16x32_bf16 a[20:23], a[228:231], a[140:143], a[20:23]
  ds_read_b128 a[164:167], v6 offset:32768
  v_mfma_f32_16x16x32_bf16 a[24:27], a[224:227], a[144:147], a[24:27]
  buffer_load_dwordx4 v3, s[44:47], s51 offen lds
  v_mfma_f32_16x16x32_bf16 a[24:27], a[228:231], a[148:151], a[24:27]
  v_mfma_f32_16x16x32_bf16 a[28:31], a[224:227], a[152:155], a[28:31]
  s_add_u32 m0, s56, 38912
  v_mfma_f32_16x16x32_bf16 a[28:31], a[228:231], a[156:159], a[28:31]
  s_waitcnt lgkmcnt(2)
  s_add_u32 s51, s55, 2818048
  v_mfma_f32_16x16x32_bf16 a[32:35], a[232:235], a[96:99], a[32:35]
  s_cmp_ge_u32 s48, 2
  s_cselect_b32 s6, 1.0, 0
  ds_read_b64_tr_b16 a[224:225], v9 offset:0
  buffer_load_dwordx4 v4, s[44:47], s51 offen lds
  v_mfma_f32_16x16x32_bf16 a[32:35], a[236:239], a[100:103], a[32:35]
  s_cmp_ge_u32 s48, 2
  s_cselect_b32 s7, 1.0, 0x3e0293ee
  ds_read_b64_tr_b16 a[226:227], v9 offset:1024
  v_mfma_f32_16x16x32_bf16 a[36:39], a[232:235], a[104:107], a[36:39]
  s_lshl_b32 s53, s48, 8
  ds_read_b64_tr_b16 a[228:229], v9 offset:8192
  v_mfma_f32_16x16x32_bf16 a[36:39], a[236:239], a[108:111], a[36:39]
  s_add_u32 s53, s53, 131072
  ds_read_b64_tr_b16 a[230:231], v9 offset:9216
  v_lshl_add_u32 v94, v0, 2, s53
  v_mfma_f32_16x16x32_bf16 a[40:43], a[232:235], a[112:115], a[40:43]
  s_add_u32 m0, s56, 39936
  ds_read_b128 a[168:171], v5 offset:34816
  s_waitcnt vmcnt(12)
  v_add_f32 v52, v52, v53
  v_mfma_f32_16x16x32_bf16 a[40:43], a[236:239], a[116:119], a[40:43]
  s_add_u32 s51, s55, 2850816
  v_add_f32 v54, v54, v55
  v_add_f32 v52, v52, v54
  v_mfma_f32_16x16x32_bf16 a[44:47], a[232:235], a[120:123], a[44:47]
  buffer_load_dwordx4 v4, s[44:47], s51 offen lds
  v_mfma_f32_16x16x32_bf16 a[44:47], a[236:239], a[124:127], a[44:47]
  ds_read_b128 a[172:175], v6 offset:34816
  v_cvt_pk_bf16_f32 v52, v52, v52
  v_mfma_f32_16x16x32_bf16 a[48:51], a[232:235], a[128:131], a[48:51]
  v_lshlrev_b32 v52, 16, v52
  v_mul_f32 v52, 0x3e0293ee, v52
  v_mfma_f32_16x16x32_bf16 a[48:51], a[236:239], a[132:135], a[48:51]
  s_add_u32 m0, s56, 65536
  ds_write_b32 v94, v52 offset:0
  s_waitcnt vmcnt(12)
  v_add_f32 v56, v56, v57
  v_mfma_f32_16x16x32_bf16 a[52:55], a[232:235], a[136:139], a[52:55]
  s_add_u32 s51, s54, 768
  v_add_f32 v58, v58, v59
  v_add_f32 v56, v56, v58
  v_mfma_f32_16x16x32_bf16 a[52:55], a[236:239], a[140:143], a[52:55]
  buffer_load_dwordx4 v1, s[12:15], s51 offen lds
  v_mfma_f32_16x16x32_bf16 a[56:59], a[232:235], a[144:147], a[56:59]
  v_cvt_pk_bf16_f32 v56, v56, v56
  v_lshlrev_b32 v56, 16, v56
  v_mfma_f32_16x16x32_bf16 a[56:59], a[236:239], a[148:151], a[56:59]
  ds_read_b128 a[176:179], v5 offset:36864
  v_mul_f32 v56, 0x3e0293ee, v56
  v_mfma_f32_16x16x32_bf16 a[60:63], a[232:235], a[152:155], a[60:63]
  ds_write_b32 v94, v56 offset:1024
  s_waitcnt vmcnt(12)
  v_add_f32 v60, v60, v61
  v_mfma_f32_16x16x32_bf16 a[60:63], a[236:239], a[156:159], a[60:63]
  s_waitcnt lgkmcnt(5)
  s_add_u32 m0, s56, 66560
  v_add_f32 v62, v62, v63
  v_add_f32 v60, v60, v62
  v_mfma_f32_16x16x32_bf16 a[64:67], a[224:227], a[96:99], a[64:67]
  s_add_u32 s51, s54, 768
  ds_read_b64_tr_b16 a[232:233], v10 offset:0
  v_cvt_pk_bf16_f32 v60, v60, v60
  v_mfma_f32_16x16x32_bf16 a[64:67], a[228:231], a[100:103], a[64:67]
  ds_read_b64_tr_b16 a[234:235], v10 offset:1024
  buffer_load_dwordx4 v2, s[12:15], s51 offen lds
  v_mfma_f32_16x16x32_bf16 a[68:71], a[224:227], a[104:107], a[68:71]
  ds_read_b64_tr_b16 a[236:237], v10 offset:8192
  v_lshlrev_b32 v60, 16, v60
  v_mfma_f32_16x16x32_bf16 a[68:71], a[228:231], a[108:111], a[68:71]
  ds_read_b64_tr_b16 a[238:239], v10 offset:9216
  v_add_f32 v60, s6, v60
  v_mfma_f32_16x16x32_bf16 a[72:75], a[224:227], a[112:115], a[72:75]
  s_add_u32 m0, s56, 67584
  ds_read_b128 a[180:183], v6 offset:36864
  v_cvt_pk_bf16_f32 v60, v60, v60
  v_mfma_f32_16x16x32_bf16 a[72:75], a[228:231], a[116:119], a[72:75]
  s_add_u32 s51, s54, 17152
  v_lshlrev_b32 v60, 16, v60
  v_mul_f32 v60, s7, v60
  v_mfma_f32_16x16x32_bf16 a[76:79], a[224:227], a[120:123], a[76:79]
  buffer_load_dwordx4 v1, s[12:15], s51 offen lds
  v_mfma_f32_16x16x32_bf16 a[76:79], a[228:231], a[124:127], a[76:79]
  ds_write_b32 v94, v60 offset:2048
  s_waitcnt vmcnt(13)
  v_add_f32 v64, v64, v65
  v_mfma_f32_16x16x32_bf16 a[80:83], a[224:227], a[128:131], a[80:83]
  v_add_f32 v66, v66, v67
  v_add_f32 v64, v64, v66
  v_mfma_f32_16x16x32_bf16 a[80:83], a[228:231], a[132:135], a[80:83]
  ds_read_b128 a[184:187], v5 offset:38912
  v_cvt_pk_bf16_f32 v64, v64, v64
  v_mfma_f32_16x16x32_bf16 a[84:87], a[224:227], a[136:139], a[84:87]
  s_add_u32 m0, s56, 68608
  v_lshlrev_b32 v64, 16, v64
  v_add_f32 v64, 1.0, v64
  v_mfma_f32_16x16x32_bf16 a[84:87], a[228:231], a[140:143], a[84:87]
  s_add_u32 s51, s54, 17152
  v_cvt_pk_bf16_f32 v64, v64, v64
  v_lshlrev_b32 v64, 16, v64
  v_mfma_f32_16x16x32_bf16 a[88:91], a[224:227], a[144:147], a[88:91]
  buffer_load_dwordx4 v2, s[12:15], s51 offen lds
  v_mfma_f32_16x16x32_bf16 a[88:91], a[228:231], a[148:151], a[88:91]
  ds_write_b32 v94, v64 offset:3072
  s_waitcnt vmcnt(13)
  v_add_f32 v68, v68, v69
  v_mfma_f32_16x16x32_bf16 a[92:95], a[224:227], a[152:155], a[92:95]
  v_add_f32 v70, v70, v71
  v_add_f32 v68, v68, v70
  v_mfma_f32_16x16x32_bf16 a[92:95], a[228:231], a[156:159], a[92:95]
  s_waitcnt lgkmcnt(4)
  s_add_u32 m0, s56, 69632
  ds_read_b128 a[188:191], v6 offset:38912
  v_cvt_pk_bf16_f32 v68, v68, v68
  v_mfma_f32_16x16x32_bf16 v[96:99], a[232:235], a[96:99], v[96:99]
  s_add_u32 s51, s54, 33536
  ds_read_b64_tr_b16 a[224:225], v7 offset:16384
  v_lshlrev_b32 v68, 16, v68
  v_mfma_f32_16x16x32_bf16 v[96:99], a[236:239], a[100:103], v[96:99]
  ds_read_b64_tr_b16 a[226:227], v7 offset:17408
  buffer_load_dwordx4 v1, s[12:15], s51 offen lds
  v_mfma_f32_16x16x32_bf16 v[100:103], a[232:235], a[104:107], v[100:103]
  ds_read_b64_tr_b16 a[228:229], v7 offset:24576
  v_add_f32 v68, 1.0, v68
  v_mfma_f32_16x16x32_bf16 v[100:103], a[236:239], a[108:111], v[100:103]
  ds_read_b64_tr_b16 a[230:231], v7 offset:25600
  v_cvt_pk_bf16_f32 v68, v68, v68
  v_mfma_f32_16x16x32_bf16 v[104:107], a[232:235], a[112:115], v[104:107]
  v_lshlrev_b32 v68, 16, v68
  v_mfma_f32_16x16x32_bf16 v[104:107], a[236:239], a[116:119], v[104:107]
  s_add_u32 m0, s56, 70656
  ds_read_b128 a[192:195], v5 offset:49152
  v_mfma_f32_16x16x32_bf16 v[108:111], a[232:235], a[120:123], v[108:111]
  s_add_u32 s51, s54, 33536
  ds_write_b32 v94, v68 offset:4096
  v_mfma_f32_16x16x32_bf16 v[108:111], a[236:239], a[124:127], v[108:111]
  buffer_load_dwordx4 v2, s[12:15], s51 offen lds
  v_mfma_f32_16x16x32_bf16 v[112:115], a[232:235], a[128:131], v[112:115]
  v_mfma_f32_16x16x32_bf16 v[112:115], a[236:239], a[132:135], v[112:115]
  v_mfma_f32_16x16x32_bf16 v[116:119], a[232:235], a[136:139], v[116:119]
  s_waitcnt lgkmcnt(0)
  s_barrier
  s_add_u32 m0, s56, 71680
  v_mfma_f32_16x16x32_bf16 v[116:119], a[236:239], a[140:143], v[116:119]
  s_add_u32 s51, s54, 49920
  ds_read_b128 a[196:199], v6 offset:49152
  v_mfma_f32_16x16x32_bf16 v[120:123], a[232:235], a[144:147], v[120:123]
  s_mul_i32 s6, s48, 1152
  buffer_load_dwordx4 v1, s[12:15], s51 offen lds
  v_mfma_f32_16x16x32_bf16 v[120:123], a[236:239], a[148:151], v[120:123]
  s_add_u32 s6, s6, 139264
  ds_read_b128 v[52:55], v95 offset:2560
  v_add_u32 v92, s6, v15
  v_mfma_f32_16x16x32_bf16 v[124:127], a[232:235], a[152:155], v[124:127]
  ds_read_b128 v[72:75], v95 offset:0
  v_lshrrev_b32 v93, 3, v0
  v_mfma_f32_16x16x32_bf16 v[124:127], a[236:239], a[156:159], v[124:127]
  ds_read_b128 v[56:59], v95 offset:3072
  v_lshl_add_u32 v92, v93, 4, v92
  v_mfma_f32_16x16x32_bf16 v[128:131], a[96:99], a[224:227], v[128:131]
  s_add_u32 m0, s56, 72704
  ds_read_b64_tr_b16 a[232:233], v8 offset:16384
  v_lshrrev_b32 v93, 5, v0
  v_mfma_f32_16x16x32_bf16 v[128:131], a[100:103], a[228:231], v[128:131]
  s_add_u32 s51, s54, 49920
  ds_read_b64_tr_b16 a[234:235], v8 offset:17408
  v_lshlrev_b32 v93, 12, v93
  v_mfma_f32_16x16x32_bf16 v[132:135], a[104:107], a[224:227], v[132:135]
  ds_read_b64_tr_b16 a[236:237], v8 offset:24576
  buffer_load_dwordx4 v2, s[12:15], s51 offen lds
  v_mfma_f32_16x16x32_bf16 v[132:135], a[108:111], a[228:231], v[132:135]
  s_lshl_b32 s52, s50, 2
  ds_read_b64_tr_b16 a[238:239], v8 offset:25600
  v_bfe_u32 v94, v0, 3, 2
  v_mfma_f32_16x16x32_bf16 v[136:139], a[112:115], a[224:227], v[136:139]
  s_add_u32 s52, s52, s48
  ds_read_b128 a[200:203], v5 offset:51200
  s_waitcnt lgkmcnt(6)
  v_fma_f32 v32, v32, v52, v72
  v_mfma_f32_16x16x32_bf16 v[136:139], a[116:119], a[228:231], v[136:139]
  s_mul_i32 s52, s52, 81920
  ds_read_b128 v[76:79], v95 offset:512
  v_fma_f32 v33, v33, v53, v73
  v_mfma_f32_16x16x32_bf16 v[140:143], a[120:123], a[224:227], v[140:143]
  s_lshl_b32 s5, s49, 8
  ds_read_b128 v[60:63], v95 offset:3584
  v_fma_f32 v34, v34, v54, v74
  v_mfma_f32_16x16x32_bf16 v[140:143], a[124:127], a[228:231], v[140:143]
  s_add_u32 s52, s52, s5
  ds_read_b128 a[204:207], v6 offset:51200
  v_fma_f32 v35, v35, v55, v75
  v_mfma_f32_16x16x32_bf16 v[144:147], a[128:131], a[224:227], v[144:147]
  s_add_u32 s52, s52, 0
  ds_read_b128 v[80:83], v95 offset:1024
  v_cvt_pk_bf16_f32 v24, v32, v33
  v_mfma_f32_16x16x32_bf16 v[144:147], a[132:135], a[228:231], v[144:147]
  buffer_load_dword v23, v13, s[16:19], s52 offen
  v_mfma_f32_16x16x32_bf16 v[148:151], a[136:139], a[224:227], v[148:151]
  ds_read_b128 v[64:67], v95 offset:4096
  v_cvt_pk_bf16_f32 v25, v34, v35
  v_mfma_f32_16x16x32_bf16 v[148:151], a[140:143], a[228:231], v[148:151]
  ds_read_b128 v[84:87], v95 offset:1536
  v_lshl_add_u32 v93, v94, 8, v93
  v_mfma_f32_16x16x32_bf16 v[152:155], a[144:147], a[224:227], v[152:155]
  ds_read_b128 v[68:71], v95 offset:4608
  v_and_b32 v94, 7, v0
  v_mfma_f32_16x16x32_bf16 v[152:155], a[148:151], a[228:231], v[152:155]
  ds_read_b128 a[208:211], v5 offset:53248
  v_lshl_add_u32 v93, v94, 4, v93
  v_mfma_f32_16x16x32_bf16 v[156:159], a[152:155], a[224:227], v[156:159]
  ds_read_b128 v[88:91], v95 offset:2048
  v_mfma_f32_16x16x32_bf16 v[156:159], a[156:159], a[228:231], v[156:159]
  s_waitcnt lgkmcnt(10)
  ds_write_b64 v22, v[24:25] offset:0
  v_mfma_f32_16x16x32_bf16 v[160:163], a[96:99], a[232:235], v[160:163]
  ds_read_b64_tr_b16 a[224:225], v9 offset:16384
  s_waitcnt lgkmcnt(10)
  v_fma_f32 v36, v36, v56, v76
  v_mfma_f32_16x16x32_bf16 v[160:163], a[100:103], a[236:239], v[160:163]
  ds_read_b64_tr_b16 a[226:227], v9 offset:17408
  v_fma_f32 v37, v37, v57, v77
  v_mfma_f32_16x16x32_bf16 v[164:167], a[104:107], a[232:235], v[164:167]
  ds_read_b64_tr_b16 a[228:229], v9 offset:24576
  v_fma_f32 v38, v38, v58, v78
  v_mfma_f32_16x16x32_bf16 v[164:167], a[108:111], a[236:239], v[164:167]
  ds_read_b64_tr_b16 a[230:231], v9 offset:25600
  v_fma_f32 v39, v39, v59, v79
  v_mfma_f32_16x16x32_bf16 v[168:171], a[112:115], a[232:235], v[168:171]
  ds_read_b128 a[212:215], v6 offset:53248
  v_cvt_pk_bf16_f32 v26, v36, v37
  v_mfma_f32_16x16x32_bf16 v[168:171], a[116:119], a[236:239], v[168:171]
  v_cvt_pk_bf16_f32 v27, v38, v39
  v_mfma_f32_16x16x32_bf16 v[172:175], a[120:123], a[232:235], v[172:175]
  ds_write_b64 v22, v[26:27] offset:2304
  v_mfma_f32_16x16x32_bf16 v[172:175], a[124:127], a[236:239], v[172:175]
  s_waitcnt lgkmcnt(12)
  v_fma_f32 v40, v40, v60, v80
  v_fma_f32 v41, v41, v61, v81
  v_mfma_f32_16x16x32_bf16 v[176:179], a[128:131], a[232:235], v[176:179]
  v_fma_f32 v42, v42, v62, v82
  v_fma_f32 v43, v43, v63, v83
  v_mfma_f32_16x16x32_bf16 v[176:179], a[132:135], a[236:239], v[176:179]
  ds_read_b128 a[216:219], v5 offset:55296
  v_cvt_pk_bf16_f32 v24, v40, v41
  v_mfma_f32_16x16x32_bf16 v[180:183], a[136:139], a[232:235], v[180:183]
  v_cvt_pk_bf16_f32 v25, v42, v43
  v_mfma_f32_16x16x32_bf16 v[180:183], a[140:143], a[236:239], v[180:183]
  ds_write_b64 v22, v[24:25] offset:4608
  v_mfma_f32_16x16x32_bf16 v[184:187], a[144:147], a[232:235], v[184:187]
  s_waitcnt lgkmcnt(12)
  v_fma_f32 v44, v44, v64, v84
  v_fma_f32 v45, v45, v65, v85
  v_mfma_f32_16x16x32_bf16 v[184:187], a[148:151], a[236:239], v[184:187]
  v_fma_f32 v46, v46, v66, v86
  v_fma_f32 v47, v47, v67, v87
  v_mfma_f32_16x16x32_bf16 v[188:191], a[152:155], a[232:235], v[188:191]
  v_cvt_pk_bf16_f32 v26, v44, v45
  v_cvt_pk_bf16_f32 v27, v46, v47
  v_mfma_f32_16x16x32_bf16 v[188:191], a[156:159], a[236:239], v[188:191]
  s_waitcnt lgkmcnt(4)
  ds_read_b128 a[220:223], v6 offset:55296
  v_mfma_f32_16x16x32_bf16 v[192:195], a[96:99], a[224:227], v[192:195]
  ds_read_b64_tr_b16 a[232:233], v10 offset:16384
  v_mfma_f32_16x16x32_bf16 v[192:195], a[100:103], a[228:231], v[192:195]
  ds_read_b64_tr_b16 a[234:235], v10 offset:17408
  v_mfma_f32_16x16x32_bf16 v[196:199], a[104:107], a[224:227], v[196:199]
  ds_read_b64_tr_b16 a[236:237], v10 offset:24576
  v_mfma_f32_16x16x32_bf16 v[196:199], a[108:111], a[228:231], v[196:199]
  ds_read_b64_tr_b16 a[238:239], v10 offset:25600
  v_mfma_f32_16x16x32_bf16 v[200:203], a[112:115], a[224:227], v[200:203]
  ds_write_b64 v22, v[26:27] offset:6912
  v_mfma_f32_16x16x32_bf16 v[200:203], a[116:119], a[228:231], v[200:203]
  v_fma_f32 v48, v48, v68, v88
  v_fma_f32 v49, v49, v69, v89
  v_mfma_f32_16x16x32_bf16 v[204:207], a[120:123], a[224:227], v[204:207]
  v_fma_f32 v50, v50, v70, v90
  v_fma_f32 v51, v51, v71, v91
  v_mfma_f32_16x16x32_bf16 v[204:207], a[124:127], a[228:231], v[204:207]
  v_cvt_pk_bf16_f32 v24, v48, v49
  v_cvt_pk_bf16_f32 v25, v50, v51
  v_mfma_f32_16x16x32_bf16 v[208:211], a[128:131], a[224:227], v[208:211]
  ds_write_b64 v22, v[24:25] offset:9216
  v_mfma_f32_16x16x32_bf16 v[208:211], a[132:135], a[228:231], v[208:211]
  v_mfma_f32_16x16x32_bf16 v[212:215], a[136:139], a[224:227], v[212:215]
  v_mfma_f32_16x16x32_bf16 v[212:215], a[140:143], a[228:231], v[212:215]
  v_mfma_f32_16x16x32_bf16 v[216:219], a[144:147], a[224:227], v[216:219]
  v_mfma_f32_16x16x32_bf16 v[216:219], a[148:151], a[228:231], v[216:219]
  v_mfma_f32_16x16x32_bf16 v[220:223], a[152:155], a[224:227], v[220:223]
  v_mfma_f32_16x16x32_bf16 v[220:223], a[156:159], a[228:231], v[220:223]
  s_waitcnt vmcnt(1) lgkmcnt(0)
  s_barrier
  v_mfma_f32_16x16x32_bf16 v[224:227], a[96:99], a[232:235], v[224:227]
  ds_read_b64_tr_b16 a[224:225], v7 offset:32768
  v_mfma_f32_16x16x32_bf16 v[224:227], a[100:103], a[236:239], v[224:227]
  ds_read_b64_tr_b16 a[226:227], v7 offset:33792
  v_mfma_f32_16x16x32_bf16 v[228:231], a[104:107], a[232:235], v[228:231]
  ds_read_b64_tr_b16 a[228:229], v7 offset:40960
  v_mfma_f32_16x16x32_bf16 v[228:231], a[108:111], a[236:239], v[228:231]
  ds_read_b64_tr_b16 a[230:231], v7 offset:41984
  v_mfma_f32_16x16x32_bf16 v[232:235], a[112:115], a[232:235], v[232:235]
  s_add_u32 m0, s56, 0
  ds_read_b128 v[32:35], v92 offset:0
  v_mfma_f32_16x16x32_bf16 v[232:235], a[116:119], a[236:239], v[232:235]
  s_add_u32 s51, s55, 3145728
  ds_read_b128 v[36:39], v92 offset:4608
  v_mfma_f32_16x16x32_bf16 v[236:239], a[120:123], a[232:235], v[236:239]
HS2:
  s_cbranch_execz HS6
  buffer_load_dwordx4 v3, s[44:47], s51 offen lds
  v_mfma_f32_16x16x32_bf16 v[236:239], a[124:127], a[236:239], v[236:239]
  s_add_u32 m0, s56, 1024
  ds_read_b128 v[40:43], v92 offset:9216
  v_mfma_f32_16x16x32_bf16 v[240:243], a[128:131], a[232:235], v[240:243]
  s_add_u32 s51, s55, 3178496
  v_mfma_f32_16x16x32_bf16 v[240:243], a[132:135], a[236:239], v[240:243]
  buffer_load_dwordx4 v3, s[44:47], s51 offen lds
  v_mfma_f32_16x16x32_bf16 v[244:247], a[136:139], a[232:235], v[244:247]
  s_add_u32 m0, s56, 2048
  v_mfma_f32_16x16x32_bf16 v[244:247], a[140:143], a[236:239], v[244:247]
  s_add_u32 s51, s55, 3211264
  v_mfma_f32_16x16x32_bf16 v[248:251], a[144:147], a[232:235], v[248:251]
  buffer_load_dwordx4 v4, s[44:47], s51 offen lds
  v_mfma_f32_16x16x32_bf16 v[248:251], a[148:151], a[236:239], v[248:251]
  v_mfma_f32_16x16x32_bf16 v[252:255], a[152:155], a[232:235], v[252:255]
  v_mfma_f32_16x16x32_bf16 v[252:255], a[156:159], a[236:239], v[252:255]
  s_waitcnt lgkmcnt(3)
  v_mfma_f32_16x16x32_bf16 a[0:3], a[224:227], a[160:163], a[0:3]
  s_add_u32 m0, s56, 3072
  ds_read_b64_tr_b16 a[232:233], v8 offset:32768
  v_mfma_f32_16x16x32_bf16 a[0:3], a[228:231], a[164:167], a[0:3]
  s_add_u32 s51, s55, 3244032
  ds_read_b64_tr_b16 a[234:235], v8 offset:33792
  v_mfma_f32_16x16x32_bf16 a[4:7], a[224:227], a[168:171], a[4:7]
  s_add_u32 s53, s61, 0
  ds_read_b64_tr_b16 a[236:237], v8 offset:40960
  buffer_load_dwordx4 v4, s[44:47], s51 offen lds
  v_mfma_f32_16x16x32_bf16 a[4:7], a[228:231], a[172:175], a[4:7]
  s_add_u32 m0, s56, 4096
  ds_read_b64_tr_b16 a[238:239], v8 offset:41984
  v_mfma_f32_16x16x32_bf16 a[8:11], a[224:227], a[176:179], a[8:11]
  s_add_u32 s51, s55, 3276800
  s_waitcnt lgkmcnt(6)
  buffer_store_dwordx4 v[32:35], v93, s[28:31], s53 offen sc1
  v_mfma_f32_16x16x32_bf16 a[8:11], a[228:231], a[180:183], a[8:11]
  ds_read_b128 a[96:99], v5 offset:0
  v_mfma_f32_16x16x32_bf16 a[12:15], a[224:227], a[184:187], a[12:15]
  buffer_load_dwordx4 v3, s[44:47], s51 offen lds
  v_mfma_f32_16x16x32_bf16 a[12:15], a[228:231], a[188:191], a[12:15]
  v_mfma_f32_16x16x32_bf16 a[16:19], a[224:227], a[192:195], a[16:19]
  v_mfma_f32_16x16x32_bf16 a[16:19], a[228:231], a[196:199], a[16:19]
  s_add_u32 m0, s56, 5120
  v_mfma_f32_16x16x32_bf16 a[20:23], a[224:227], a[200:203], a[20:23]
  s_add_u32 s51, s55, 3309568
  v_mfma_f32_16x16x32_bf16 a[20:23], a[228:231], a[204:207], a[20:23]
  s_add_u32 s53, s61, 32768
  ds_read_b128 a[100:103], v6 offset:0
  v_mfma_f32_16x16x32_bf16 a[24:27], a[224:227], a[208:211], a[24:27]
  buffer_load_dwordx4 v3, s[44:47], s51 offen lds
  v_mfma_f32_16x16x32_bf16 a[24:27], a[228:231], a[212:215], a[24:27]
  s_waitcnt lgkmcnt(7)
  buffer_store_dwordx4 v[36:39], v93, s[28:31], s53 offen sc1
  v_mfma_f32_16x16x32_bf16 a[28:31], a[224:227], a[216:219], a[28:31]
  s_add_u32 m0, s56, 6144
  v_mfma_f32_16x16x32_bf16 a[28:31], a[228:231], a[220:223], a[28:31]
  s_waitcnt lgkmcnt(2)
  s_add_u32 s51, s55, 3342336
  v_mfma_f32_16x16x32_bf16 a[32:35], a[232:235], a[160:163], a[32:35]
  ds_read_b64_tr_b16 a[224:225], v9 offset:32768
  buffer_load_dwordx4 v4, s[44:47], s51 offen lds
  v_mfma_f32_16x16x32_bf16 a[32:35], a[236:239], a[164:167], a[32:35]
  s_add_u32 s53, s61, 65536
  ds_read_b64_tr_b16 a[226:227], v9 offset:33792
  v_mfma_f32_16x16x32_bf16 a[36:39], a[232:235], a[168:171], a[36:39]
  s_cmp_lt_u32 s48, 2
  s_cselect_b32 s53, s53, 0x40000000
  ds_read_b64_tr_b16 a[228:229], v9 offset:40960
  v_mfma_f32_16x16x32_bf16 a[36:39], a[236:239], a[172:175], a[36:39]
  ds_read_b64_tr_b16 a[230:231], v9 offset:41984
  v_mfma_f32_16x16x32_bf16 a[40:43], a[232:235], a[176:179], a[40:43]
  s_add_u32 m0, s56, 7168
  ds_read_b128 a[104:107], v5 offset:2048
  v_mfma_f32_16x16x32_bf16 a[40:43], a[236:239], a[180:183], a[40:43]
  s_add_u32 s51, s55, 3375104
  buffer_store_dwordx4 v[40:43], v93, s[28:31], s53 offen sc1
  v_mfma_f32_16x16x32_bf16 a[44:47], a[232:235], a[184:187], a[44:47]
  buffer_load_dwordx4 v4, s[44:47], s51 offen lds
  v_mfma_f32_16x16x32_bf16 a[44:47], a[236:239], a[188:191], a[44:47]
  ds_read_b128 a[108:111], v6 offset:2048
  v_mfma_f32_16x16x32_bf16 a[48:51], a[232:235], a[192:195], a[48:51]
  v_mfma_f32_16x16x32_bf16 a[48:51], a[236:239], a[196:199], a[48:51]
  s_add_u32 m0, s56, 98304
  v_mfma_f32_16x16x32_bf16 a[52:55], a[232:235], a[200:203], a[52:55]
  s_add_u32 s51, s54, 896
  v_mfma_f32_16x16x32_bf16 a[52:55], a[236:239], a[204:207], a[52:55]
  buffer_load_dwordx4 v1, s[12:15], s51 offen lds
  v_mfma_f32_16x16x32_bf16 a[56:59], a[232:235], a[208:211], a[56:59]
  v_mfma_f32_16x16x32_bf16 a[56:59], a[236:239], a[212:215], a[56:59]
  ds_read_b128 a[112:115], v5 offset:4096
  v_mfma_f32_16x16x32_bf16 a[60:63], a[232:235], a[216:219], a[60:63]
  v_and_b32 v17, 7, v0
  v_lshlrev_b32 v17, 7, v17
  v_mfma_f32_16x16x32_bf16 a[60:63], a[236:239], a[220:223], a[60:63]
  s_waitcnt lgkmcnt(3)
  s_add_u32 m0, s56, 99328
  v_add_u32 v17, 464896, v17
  v_mfma_f32_16x16x32_bf16 a[64:67], a[224:227], a[160:163], a[64:67]
  s_add_u32 s51, s54, 896
  ds_read_b64_tr_b16 a[232:233], v10 offset:32768
  v_mfma_f32_16x16x32_bf16 a[64:67], a[228:231], a[164:167], a[64:67]
  ds_read_b64_tr_b16 a[234:235], v10 offset:33792
  buffer_load_dwordx4 v2, s[12:15], s51 offen lds
  v_mfma_f32_16x16x32_bf16 a[68:71], a[224:227], a[168:171], a[68:71]
  ds_read_b64_tr_b16 a[236:237], v10 offset:40960
  v_mfma_f32_16x16x32_bf16 a[68:71], a[228:231], a[172:175], a[68:71]
  ds_read_b64_tr_b16 a[238:239], v10 offset:41984
  v_mfma_f32_16x16x32_bf16 a[72:75], a[224:227], a[176:179], a[72:75]
  s_add_u32 m0, s56, 100352
  ds_read_b128 a[116:119], v6 offset:4096
  v_mfma_f32_16x16x32_bf16 a[72:75], a[228:231], a[180:183], a[72:75]
  s_add_u32 s51, s54, 17280
  v_mfma_f32_16x16x32_bf16 a[76:79], a[224:227], a[184:187], a[76:79]
  buffer_load_dwordx4 v1, s[12:15], s51 offen lds
  v_mfma_f32_16x16x32_bf16 a[76:79], a[228:231], a[188:191], a[76:79]
  v_mfma_f32_16x16x32_bf16 a[80:83], a[224:227], a[192:195], a[80:83]
  buffer_load_dword v18, v17, s[28:31], 0 offen sc1
  v_mfma_f32_16x16x32_bf16 a[80:83], a[228:231], a[196:199], a[80:83]
  ds_read_b128 a[120:123], v5 offset:6144
  v_mfma_f32_16x16x32_bf16 a[84:87], a[224:227], a[200:203], a[84:87]
  s_add_u32 m0, s56, 101376
  v_mfma_f32_16x16x32_bf16 a[84:87], a[228:231], a[204:207], a[84:87]
  s_add_u32 s51, s54, 17280
  v_mfma_f32_16x16x32_bf16 a[88:91], a[224:227], a[208:211], a[88:91]
  buffer_load_dwordx4 v2, s[12:15], s51 offen lds
  v_mfma_f32_16x16x32_bf16 a[88:91], a[228:231], a[212:215], a[88:91]
  v_mfma_f32_16x16x32_bf16 a[92:95], a[224:227], a[216:219], a[92:95]
  v_mfma_f32_16x16x32_bf16 a[92:95], a[228:231], a[220:223], a[92:95]
  s_waitcnt lgkmcnt(2)
  s_add_u32 m0, s56, 102400
  ds_read_b128 a[124:127], v6 offset:6144
  v_mfma_f32_16x16x32_bf16 v[96:99], a[232:235], a[160:163], v[96:99]
  s_add_u32 s51, s54, 33664
  ds_read_b64_tr_b16 a[224:225], v7 offset:49152
  v_mfma_f32_16x16x32_bf16 v[96:99], a[236:239], a[164:167], v[96:99]
  ds_read_b64_tr_b16 a[226:227], v7 offset:50176
  buffer_load_dwordx4 v1, s[12:15], s51 offen lds
  v_mfma_f32_16x16x32_bf16 v[100:103], a[232:235], a[168:171], v[100:103]
  ds_read_b64_tr_b16 a[228:229], v7 offset:57344
  v_mfma_f32_16x16x32_bf16 v[100:103], a[236:239], a[172:175], v[100:103]
  ds_read_b64_tr_b16 a[230:231], v7 offset:58368
  v_mfma_f32_16x16x32_bf16 v[104:107], a[232:235], a[176:179], v[104:107]
  v_mfma_f32_16x16x32_bf16 v[104:107], a[236:239], a[180:183], v[104:107]
  s_add_u32 m0, s56, 103424
  ds_read_b128 a[128:131], v5 offset:16384
  v_mfma_f32_16x16x32_bf16 v[108:111], a[232:235], a[184:187], v[108:111]
  s_add_u32 s51, s54, 33664
  v_mfma_f32_16x16x32_bf16 v[108:111], a[236:239], a[188:191], v[108:111]
  buffer_load_dwordx4 v2, s[12:15], s51 offen lds
  v_mfma_f32_16x16x32_bf16 v[112:115], a[232:235], a[192:195], v[112:115]
  v_mfma_f32_16x16x32_bf16 v[112:115], a[236:239], a[196:199], v[112:115]
  v_mfma_f32_16x16x32_bf16 v[116:119], a[232:235], a[200:203], v[116:119]
  s_add_u32 m0, s56, 104448
  v_mfma_f32_16x16x32_bf16 v[116:119], a[236:239], a[204:207], v[116:119]
  s_add_u32 s51, s54, 50048
  ds_read_b128 a[132:135], v6 offset:16384
  v_mfma_f32_16x16x32_bf16 v[120:123], a[232:235], a[208:211], v[120:123]
  buffer_load_dwordx4 v1, s[12:15], s51 offen lds
  v_mfma_f32_16x16x32_bf16 v[120:123], a[236:239], a[212:215], v[120:123]
  v_mfma_f32_16x16x32_bf16 v[124:127], a[232:235], a[216:219], v[124:127]
  v_mfma_f32_16x16x32_bf16 v[124:127], a[236:239], a[220:223], v[124:127]
  s_waitcnt lgkmcnt(2)
  v_mfma_f32_16x16x32_bf16 v[128:131], a[160:163], a[224:227], v[128:131]
  s_add_u32 m0, s56, 105472
  ds_read_b64_tr_b16 a[232:233], v8 offset:49152
  v_mfma_f32_16x16x32_bf16 v[128:131], a[164:167], a[228:231], v[128:131]
  s_add_u32 s51, s54, 50048
  ds_read_b64_tr_b16 a[234:235], v8 offset:50176
  v_mfma_f32_16x16x32_bf16 v[132:135], a[168:171], a[224:227], v[132:135]
  ds_read_b64_tr_b16 a[236:237], v8 offset:57344
  buffer_load_dwordx4 v2, s[12:15], s51 offen lds
  v_mfma_f32_16x16x32_bf16 v[132:135], a[172:175], a[228:231], v[132:135]
  s_lshr_b32 s52, s2, 4
  ds_read_b64_tr_b16 a[238:239], v8 offset:58368
  v_mfma_f32_16x16x32_bf16 v[136:139], a[176:179], a[224:227], v[136:139]
  s_lshl_b32 s52, s52, 7
  ds_read_b128 a[136:139], v5 offset:18432
  v_mfma_f32_16x16x32_bf16 v[136:139], a[180:183], a[228:231], v[136:139]
  s_add_u32 s52, s52, 458752
  v_mfma_f32_16x16x32_bf16 v[140:143], a[184:187], a[224:227], v[140:143]
  s_waitcnt vmcnt(10)
  v_mfma_f32_16x16x32_bf16 v[140:143], a[188:191], a[228:231], v[140:143]
  ds_read_b128 a[140:143], v6 offset:18432
  v_mfma_f32_16x16x32_bf16 v[144:147], a[192:195], a[224:227], v[144:147]
  buffer_atomic_add v20, v16, s[28:31], s52 offen offset:0
  v_mfma_f32_16x16x32_bf16 v[144:147], a[196:199], a[228:231], v[144:147]
  s_lshl_b32 s52, s50, 2
  v_mfma_f32_16x16x32_bf16 v[148:151], a[200:203], a[224:227], v[148:151]
  s_add_u32 s52, s52, s48
  v_mfma_f32_16x16x32_bf16 v[148:151], a[204:207], a[228:231], v[148:151]
  s_mul_i32 s52, s52, 81920
  v_mfma_f32_16x16x32_bf16 v[152:155], a[208:211], a[224:227], v[152:155]
  s_lshl_b32 s5, s49, 8
  v_mfma_f32_16x16x32_bf16 v[152:155], a[212:215], a[228:231], v[152:155]
  s_add_u32 s52, s52, s5
  ds_read_b128 a[144:147], v5 offset:20480
  v_mfma_f32_16x16x32_bf16 v[156:159], a[216:219], a[224:227], v[156:159]
  s_add_u32 s52, s52, 2621440
  v_mfma_f32_16x16x32_bf16 v[156:159], a[220:223], a[228:231], v[156:159]
  s_waitcnt lgkmcnt(3)
  buffer_load_dword v23, v13, s[16:19], s52 offen
  v_mfma_f32_16x16x32_bf16 v[160:163], a[160:163], a[232:235], v[160:163]
  ds_read_b64_tr_b16 a[224:225], v9 offset:49152
  v_mfma_f32_16x16x32_bf16 v[160:163], a[164:167], a[236:239], v[160:163]
  ds_read_b64_tr_b16 a[226:227], v9 offset:50176
  v_mfma_f32_16x16x32_bf16 v[164:167], a[168:171], a[232:235], v[164:167]
  ds_read_b64_tr_b16 a[228:229], v9 offset:57344
  v_mfma_f32_16x16x32_bf16 v[164:167], a[172:175], a[236:239], v[164:167]
  ds_read_b64_tr_b16 a[230:231], v9 offset:58368
  v_mfma_f32_16x16x32_bf16 v[168:171], a[176:179], a[232:235], v[168:171]
  ds_read_b128 a[148:151], v6 offset:20480
  v_mfma_f32_16x16x32_bf16 v[168:171], a[180:183], a[236:239], v[168:171]
  v_mfma_f32_16x16x32_bf16 v[172:175], a[184:187], a[232:235], v[172:175]
  v_mfma_f32_16x16x32_bf16 v[172:175], a[188:191], a[236:239], v[172:175]
  v_mfma_f32_16x16x32_bf16 v[176:179], a[192:195], a[232:235], v[176:179]
  v_mfma_f32_16x16x32_bf16 v[176:179], a[196:199], a[236:239], v[176:179]
  ds_read_b128 a[152:155], v5 offset:22528
  v_mfma_f32_16x16x32_bf16 v[180:183], a[200:203], a[232:235], v[180:183]
  v_mfma_f32_16x16x32_bf16 v[180:183], a[204:207], a[236:239], v[180:183]
  v_mfma_f32_16x16x32_bf16 v[184:187], a[208:211], a[232:235], v[184:187]
  v_mfma_f32_16x16x32_bf16 v[184:187], a[212:215], a[236:239], v[184:187]
  v_mfma_f32_16x16x32_bf16 v[188:191], a[216:219], a[232:235], v[188:191]
  v_mfma_f32_16x16x32_bf16 v[188:191], a[220:223], a[236:239], v[188:191]
  s_waitcnt lgkmcnt(2)
  ds_read_b128 a[156:159], v6 offset:22528
  v_mfma_f32_16x16x32_bf16 v[192:195], a[160:163], a[224:227], v[192:195]
  ds_read_b64_tr_b16 a[232:233], v10 offset:49152
  v_mfma_f32_16x16x32_bf16 v[192:195], a[164:167], a[228:231], v[192:195]
  ds_read_b64_tr_b16 a[234:235], v10 offset:50176
  v_mfma_f32_16x16x32_bf16 v[196:199], a[168:171], a[224:227], v[196:199]
  ds_read_b64_tr_b16 a[236:237], v10 offset:57344
  v_mfma_f32_16x16x32_bf16 v[196:199], a[172:175], a[228:231], v[196:199]
  ds_read_b64_tr_b16 a[238:239], v10 offset:58368
  v_mfma_f32_16x16x32_bf16 v[200:203], a[176:179], a[224:227], v[200:203]
  v_mfma_f32_16x16x32_bf16 v[200:203], a[180:183], a[228:231], v[200:203]
  v_mfma_f32_16x16x32_bf16 v[204:207], a[184:187], a[224:227], v[204:207]
  v_mfma_f32_16x16x32_bf16 v[204:207], a[188:191], a[228:231], v[204:207]
  v_mfma_f32_16x16x32_bf16 v[208:211], a[192:195], a[224:227], v[208:211]
  v_mfma_f32_16x16x32_bf16 v[208:211], a[196:199], a[228:231], v[208:211]
  v_mfma_f32_16x16x32_bf16 v[212:215], a[200:203], a[224:227], v[212:215]
  v_mfma_f32_16x16x32_bf16 v[212:215], a[204:207], a[228:231], v[212:215]
  v_mfma_f32_16x16x32_bf16 v[216:219], a[208:211], a[224:227], v[216:219]
  v_mfma_f32_16x16x32_bf16 v[216:219], a[212:215], a[228:231], v[216:219]
  v_mfma_f32_16x16x32_bf16 v[220:223], a[216:219], a[224:227], v[220:223]
  v_mfma_f32_16x16x32_bf16 v[220:223], a[220:223], a[228:231], v[220:223]
  s_waitcnt lgkmcnt(0)
  s_waitcnt vmcnt(2)
  s_waitcnt lgkmcnt(0)
  s_barrier
  v_cmp_gt_u32 vcc, 20, v18
  s_nop 0
  s_cbranch_vccnz L_p2_w
L_p2_ok:
  v_mfma_f32_16x16x32_bf16 v[224:227], a[160:163], a[232:235], v[224:227]
  ds_read_b64_tr_b16 a[224:225], v7 offset:0
  v_mfma_f32_16x16x32_bf16 v[224:227], a[164:167], a[236:239], v[224:227]
  ds_read_b64_tr_b16 a[226:227], v7 offset:1024
  v_mfma_f32_16x16x32_bf16 v[228:231], a[168:171], a[232:235], v[228:231]
  ds_read_b64_tr_b16 a[228:229], v7 offset:8192
  v_mfma_f32_16x16x32_bf16 v[228:231], a[172:175], a[236:239], v[228:231]
  ds_read_b64_tr_b16 a[230:231], v7 offset:9216
  v_mfma_f32_16x16x32_bf16 v[232:235], a[176:179], a[232:235], v[232:235]
  s_add_u32 m0, s56, 32768
  v_mfma_f32_16x16x32_bf16 v[232:235], a[180:183], a[236:239], v[232:235]
  s_add_u32 s51, s55, 3670016
  v_mfma_f32_16x16x32_bf16 v[236:239], a[184:187], a[232:235], v[236:239]
  buffer_load_dwordx4 v3, s[44:47], s51 offen lds
  v_mfma_f32_16x16x32_bf16 v[236:239], a[188:191], a[236:239], v[236:239]
  s_add_u32 m0, s56, 33792
  v_mfma_f32_16x16x32_bf16 v[240:243], a[192:195], a[232:235], v[240:243]
  s_add_u32 s51, s55, 3702784
  v_mfma_f32_16x16x32_bf16 v[240:243], a[196:199], a[236:239], v[240:243]
  buffer_load_dwordx4 v3, s[44:47], s51 offen lds
  v_mfma_f32_16x16x32_bf16 v[244:247], a[200:203], a[232:235], v[244:247]
  s_add_u32 m0, s56, 34816
  v_mfma_f32_16x16x32_bf16 v[244:247], a[204:207], a[236:239], v[244:247]
  s_add_u32 s51, s55, 3735552
  v_mfma_f32_16x16x32_bf16 v[248:251], a[208:211], a[232:235], v[248:251]
  buffer_load_dwordx4 v4, s[44:47], s51 offen lds
  v_mfma_f32_16x16x32_bf16 v[248:251], a[212:215], a[236:239], v[248:251]
  v_mfma_f32_16x16x32_bf16 v[252:255], a[216:219], a[232:235], v[252:255]
  v_mfma_f32_16x16x32_bf16 v[252:255], a[220:223], a[236:239], v[252:255]
  s_waitcnt lgkmcnt(0)
  v_mfma_f32_16x16x32_bf16 a[0:3], a[224:227], a[96:99], a[0:3]
  s_add_u32 m0, s56, 35840
  ds_read_b64_tr_b16 a[232:233], v8 offset:0
  v_mfma_f32_16x16x32_bf16 a[0:3], a[228:231], a[100:103], a[0:3]
  s_add_u32 s51, s55, 3768320
  ds_read_b64_tr_b16 a[234:235], v8 offset:1024
  v_mfma_f32_16x16x32_bf16 a[4:7], a[224:227], a[104:107], a[4:7]
  s_lshl_b32 s52, s2, 8
  ds_read_b64_tr_b16 a[236:237], v8 offset:8192
  buffer_load_dwordx4 v4, s[44:47], s51 offen lds
  v_mfma_f32_16x16x32_bf16 a[4:7], a[228:231], a[108:111], a[4:7]
  s_add_u32 m0, s56, 36864
  ds_read_b64_tr_b16 a[238:239], v8 offset:9216
  v_mfma_f32_16x16x32_bf16 a[8:11], a[224:227], a[112:115], a[8:11]
  s_add_u32 s51, s55, 3801088
  v_mfma_f32_16x16x32_bf16 a[8:11], a[228:231], a[116:119], a[8:11]
  s_add_u32 s52, s52, 806912
  ds_read_b128 a[160:163], v5 offset:32768
  v_and_b32 v28, 15, v0
  v_mfma_f32_16x16x32_bf16 a[12:15], a[224:227], a[120:123], a[12:15]
  buffer_load_dwordx4 v3, s[44:47], s51 offen lds
  v_mfma_f32_16x16x32_bf16 a[12:15], a[228:231], a[124:127], a[12:15]
  v_lshlrev_b32 v29, 4, v28
  v_mfma_f32_16x16x32_bf16 a[16:19], a[224:227], a[128:131], a[16:19]
  buffer_load_dwordx4 v[24:27], v29, s[28:31], s52 offen sc1
  v_mfma_f32_16x16x32_bf16 a[16:19], a[228:231], a[132:135], a[16:19]
  s_add_u32 m0, s56, 37888
  v_mfma_f32_16x16x32_bf16 a[20:23], a[224:227], a[136:139], a[20:23]
  s_add_u32 s51, s55, 3833856
  v_mfma_f32_16x16x32_bf16 a[20:23], a[228:231], a[140:143], a[20:23]
  ds_read_b128 a[164:167], v6 offset:32768
  v_mfma_f32_16x16x32_bf16 a[24:27], a[224:227], a[144:147], a[24:27]
  buffer_load_dwordx4 v3, s[44:47], s51 offen lds
  v_mfma_f32_16x16x32_bf16 a[24:27], a[228:231], a[148:151], a[24:27]
  v_mfma_f32_16x16x32_bf16 a[28:31], a[224:227], a[152:155], a[28:31]
  s_add_u32 m0, s56, 38912
  v_mfma_f32_16x16x32_bf16 a[28:31], a[228:231], a[156:159], a[28:31]
  s_waitcnt lgkmcnt(2)
  s_add_u32 s51, s55, 3866624
  v_mfma_f32_16x16x32_bf16 a[32:35], a[232:235], a[96:99], a[32:35]
  ds_read_b64_tr_b16 a[224:225], v9 offset:0
  buffer_load_dwordx4 v4, s[44:47], s51 offen lds
  v_mfma_f32_16x16x32_bf16 a[32:35], a[236:239], a[100:103], a[32:35]
  ds_read_b64_tr_b16 a[226:227], v9 offset:1024
  v_mfma_f32_16x16x32_bf16 a[36:39], a[232:235], a[104:107], a[36:39]
  ds_read_b64_tr_b16 a[228:229], v9 offset:8192
  v_mfma_f32_16x16x32_bf16 a[36:39], a[236:239], a[108:111], a[36:39]
  ds_read_b64_tr_b16 a[230:231], v9 offset:9216
  v_mfma_f32_16x16x32_bf16 a[40:43], a[232:235], a[112:115], a[40:43]
  s_add_u32 m0, s56, 39936
  ds_read_b128 a[168:171], v5 offset:34816
  v_mfma_f32_16x16x32_bf16 a[40:43], a[236:239], a[116:119], a[40:43]
  s_add_u32 s51, s55, 3899392
  v_mfma_f32_16x16x32_bf16 a[44:47], a[232:235], a[120:123], a[44:47]
  buffer_load_dwordx4 v4, s[44:47], s51 offen lds
  v_mfma_f32_16x16x32_bf16 a[44:47], a[236:239], a[124:127], a[44:47]
  ds_read_b128 a[172:175], v6 offset:34816
  v_mfma_f32_16x16x32_bf16 a[48:51], a[232:235], a[128:131], a[48:51]
  v_mfma_f32_16x16x32_bf16 a[48:51], a[236:239], a[132:135], a[48:51]
  s_add_u32 m0, s56, 65536
  v_mfma_f32_16x16x32_bf16 a[52:55], a[232:235], a[136:139], a[52:55]
  s_add_u32 s51, s82, 0
  v_mfma_f32_16x16x32_bf16 a[52:55], a[236:239], a[140:143], a[52:55]
  buffer_load_dwordx4 v3, s[16:19], s51 offen lds
  v_mfma_f32_16x16x32_bf16 a[56:59], a[232:235], a[144:147], a[56:59]
  v_mfma_f32_16x16x32_bf16 a[56:59], a[236:239], a[148:151], a[56:59]
  ds_read_b128 a[176:179], v5 offset:36864
  v_mfma_f32_16x16x32_bf16 a[60:63], a[232:235], a[152:155], a[60:63]
  v_mfma_f32_16x16x32_bf16 a[60:63], a[236:239], a[156:159], a[60:63]
  s_waitcnt lgkmcnt(3)
  s_add_u32 m0, s56, 66560
  v_mfma_f32_16x16x32_bf16 a[64:67], a[224:227], a[96:99], a[64:67]
  s_add_u32 s51, s82, 32768
  ds_read_b64_tr_b16 a[232:233], v10 offset:0
  v_mfma_f32_16x16x32_bf16 a[64:67], a[228:231], a[100:103], a[64:67]
  ds_read_b64_tr_b16 a[234:235], v10 offset:1024
  buffer_load_dwordx4 v3, s[16:19], s51 offen lds
  v_mfma_f32_16x16x32_bf16 a[68:71], a[224:227], a[104:107], a[68:71]
  ds_read_b64_tr_b16 a[236:237], v10 offset:8192
  v_mfma_f32_16x16x32_bf16 a[68:71], a[228:231], a[108:111], a[68:71]
  ds_read_b64_tr_b16 a[238:239], v10 offset:9216
  v_mfma_f32_16x16x32_bf16 a[72:75], a[224:227], a[112:115], a[72:75]
  s_add_u32 m0, s56, 67584
  ds_read_b128 a[180:183], v6 offset:36864
  v_mfma_f32_16x16x32_bf16 a[72:75], a[228:231], a[116:119], a[72:75]
  s_add_u32 s51, s82, 65536
  v_mfma_f32_16x16x32_bf16 a[76:79], a[224:227], a[120:123], a[76:79]
  buffer_load_dwordx4 v4, s[16:19], s51 offen lds
  v_mfma_f32_16x16x32_bf16 a[76:79], a[228:231], a[124:127], a[76:79]
  v_mfma_f32_16x16x32_bf16 a[80:83], a[224:227], a[128:131], a[80:83]
  s_sub_u32 s6, s2, 80
  v_mfma_f32_16x16x32_bf16 a[80:83], a[228:231], a[132:135], a[80:83]
  s_cmp_lt_u32 s6, 40
  s_cselect_b32 s6, 1.0, 0
  ds_read_b128 a[184:187], v5 offset:38912
  v_mfma_f32_16x16x32_bf16 a[84:87], a[224:227], a[136:139], a[84:87]
  s_add_u32 m0, s56, 68608
  v_mfma_f32_16x16x32_bf16 a[84:87], a[228:231], a[140:143], a[84:87]
  s_add_u32 s51, s82, 98304
  v_mfma_f32_16x16x32_bf16 a[88:91], a[224:227], a[144:147], a[88:91]
  s_lshl_b32 s7, s2, 6
  buffer_load_dwordx4 v4, s[16:19], s51 offen lds
  v_mfma_f32_16x16x32_bf16 a[88:91], a[228:231], a[148:151], a[88:91]
  s_add_u32 s7, s7, 5120
  v_mfma_f32_16x16x32_bf16 a[92:95], a[224:227], a[152:155], a[92:95]
  s_cmp_lt_u32 s2, 160
  s_cselect_b32 s7, s7, 0x40000000
  v_mfma_f32_16x16x32_bf16 a[92:95], a[228:231], a[156:159], a[92:95]
  s_waitcnt lgkmcnt(2)
  s_add_u32 m0, s56, 69632
  ds_read_b128 a[188:191], v6 offset:38912
  v_mfma_f32_16x16x32_bf16 v[96:99], a[232:235], a[96:99], v[96:99]
  s_add_u32 s51, s82, 131072
  ds_read_b64_tr_b16 a[224:225], v7 offset:16384
  v_mfma_f32_16x16x32_bf16 v[96:99], a[236:239], a[100:103], v[96:99]
  s_cmp_eq_u32 s48, 0
  s_cselect_b32 s7, s7, 0x40000000
  ds_read_b64_tr_b16 a[226:227], v7 offset:17408
  buffer_load_dwordx4 v3, s[16:19], s51 offen lds
  v_mfma_f32_16x16x32_bf16 v[100:103], a[232:235], a[104:107], v[100:103]
  ds_read_b64_tr_b16 a[228:229], v7 offset:24576
  s_waitcnt vmcnt(8)
  v_add_f32 v24, v24, v25
  v_mfma_f32_16x16x32_bf16 v[100:103], a[236:239], a[108:111], v[100:103]
  ds_read_b64_tr_b16 a[230:231], v7 offset:25600
  v_add_f32 v26, v26, v27
  v_mfma_f32_16x16x32_bf16 v[104:107], a[232:235], a[112:115], v[104:107]
  v_add_f32 v24, v24, v26
  v_cvt_pk_bf16_f32 v24, v24, v24
  v_mfma_f32_16x16x32_bf16 v[104:107], a[236:239], a[116:119], v[104:107]
  s_add_u32 m0, s56, 70656
  ds_read_b128 a[192:195], v5 offset:49152
  v_lshlrev_b32 v24, 16, v24
  v_mfma_f32_16x16x32_bf16 v[108:111], a[232:235], a[120:123], v[108:111]
  s_add_u32 s51, s82, 163840
  v_add_f32 v24, s6, v24
  v_cvt_pk_bf16_f32 v24, v24, v24
  v_mfma_f32_16x16x32_bf16 v[108:111], a[236:239], a[124:127], v[108:111]
  buffer_load_dwordx4 v3, s[16:19], s51 offen lds
  v_mfma_f32_16x16x32_bf16 v[112:115], a[232:235], a[128:131], v[112:115]
  v_lshlrev_b32 v24, 16, v24
  v_lshlrev_b32 v29, 2, v28
  v_mfma_f32_16x16x32_bf16 v[112:115], a[236:239], a[132:135], v[112:115]
  buffer_store_dword v24, v29, s[28:31], s7 offen sc1
  v_mfma_f32_16x16x32_bf16 v[116:119], a[232:235], a[136:139], v[116:119]
  s_add_u32 m0, s56, 71680
  v_mfma_f32_16x16x32_bf16 v[116:119], a[236:239], a[140:143], v[116:119]
  s_add_u32 s51, s82, 196608
  ds_read_b128 a[196:199], v6 offset:49152
  v_mfma_f32_16x16x32_bf16 v[120:123], a[232:235], a[144:147], v[120:123]
  s_sub_u32 s6, s2, 40
  buffer_load_dwordx4 v4, s[16:19], s51 offen lds
  v_mfma_f32_16x16x32_bf16 v[120:123], a[236:239], a[148:151], v[120:123]
  s_cmp_lt_u32 s6, 40
  s_cselect_b32 s7, 64, 0
  v_mfma_f32_16x16x32_bf16 v[124:127], a[232:235], a[152:155], v[124:127]
  s_cmp_lt_u32 s6, 40
  s_cselect_b32 s5, 0, 40
  v_mfma_f32_16x16x32_bf16 v[124:127], a[236:239], a[156:159], v[124:127]
  s_waitcnt lgkmcnt(2)
  s_sub_u32 s5, s6, s5
  v_mfma_f32_16x16x32_bf16 v[128:131], a[96:99], a[224:227], v[128:131]
  s_add_u32 m0, s56, 72704
  ds_read_b64_tr_b16 a[232:233], v8 offset:16384
  v_mfma_f32_16x16x32_bf16 v[128:131], a[100:103], a[228:231], v[128:131]
  s_add_u32 s51, s82, 229376
  ds_read_b64_tr_b16 a[234:235], v8 offset:17408
  v_mfma_f32_16x16x32_bf16 v[132:135], a[104:107], a[224:227], v[132:135]
  s_lshr_b32 s4, s5, 1
  ds_read_b64_tr_b16 a[236:237], v8 offset:24576
  buffer_load_dwordx4 v4, s[16:19], s51 offen lds
  v_mfma_f32_16x16x32_bf16 v[132:135], a[108:111], a[228:231], v[132:135]
  s_add_u32 m0, s56, 131072
  ds_read_b64_tr_b16 a[238:239], v8 offset:25600
  v_mfma_f32_16x16x32_bf16 v[136:139], a[112:115], a[224:227], v[136:139]
  s_add_u32 s51, s82, 2097152
  ds_read_b128 a[200:203], v5 offset:51200
  v_mfma_f32_16x16x32_bf16 v[136:139], a[116:119], a[228:231], v[136:139]
  s_lshl_b32 s4, s4, 7
  buffer_load_dwordx4 v3, s[16:19], s51 offen lds
  v_mfma_f32_16x16x32_bf16 v[140:143], a[120:123], a[224:227], v[140:143]
  s_add_u32 m0, s56, 132096
  v_mfma_f32_16x16x32_bf16 v[140:143], a[124:127], a[228:231], v[140:143]
  s_add_u32 s51, s82, 2129920
  ds_read_b128 a[204:207], v6 offset:51200
  v_mfma_f32_16x16x32_bf16 v[144:147], a[128:131], a[224:227], v[144:147]
  s_add_u32 s7, s7, s4
  buffer_load_dwordx4 v3, s[16:19], s51 offen lds
  v_mfma_f32_16x16x32_bf16 v[144:147], a[132:135], a[228:231], v[144:147]
  s_and_b32 s5, s5, 1
  v_mfma_f32_16x16x32_bf16 v[148:151], a[136:139], a[224:227], v[148:151]
  s_lshl_b32 s5, s5, 3
  v_mfma_f32_16x16x32_bf16 v[148:151], a[140:143], a[228:231], v[148:151]
  s_add_u32 s7, s7, s5
  v_mfma_f32_16x16x32_bf16 v[152:155], a[144:147], a[224:227], v[152:155]
  s_add_u32 m0, s56, 133120
  v_mfma_f32_16x16x32_bf16 v[152:155], a[148:151], a[228:231], v[152:155]
  s_add_u32 s51, s82, 2162688
  ds_read_b128 a[208:211], v5 offset:53248
  v_mfma_f32_16x16x32_bf16 v[156:159], a[152:155], a[224:227], v[156:159]
  s_add_u32 s7, s7, 16384
  buffer_load_dwordx4 v4, s[16:19], s51 offen lds
  v_mfma_f32_16x16x32_bf16 v[156:159], a[156:159], a[228:231], v[156:159]
  s_waitcnt lgkmcnt(3)
  s_cmp_lt_u32 s6, 80
  s_cselect_b32 s7, s7, 0x40000000
  v_mfma_f32_16x16x32_bf16 v[160:163], a[96:99], a[232:235], v[160:163]
  s_cmp_eq_u32 s48, 0
  s_cselect_b32 s7, s7, 0x40000000
  ds_read_b64_tr_b16 a[224:225], v9 offset:16384
  v_lshrrev_b32 v29, 2, v28
  v_mfma_f32_16x16x32_bf16 v[160:163], a[100:103], a[236:239], v[160:163]
  s_add_u32 m0, s56, 134144
  ds_read_b64_tr_b16 a[226:227], v9 offset:17408
  v_lshlrev_b32 v29, 4, v29
  v_mfma_f32_16x16x32_bf16 v[164:167], a[104:107], a[232:235], v[164:167]
  s_add_u32 s51, s82, 2195456
  ds_read_b64_tr_b16 a[228:229], v9 offset:24576
  v_and_b32 v28, 3, v28
  v_mfma_f32_16x16x32_bf16 v[164:167], a[108:111], a[236:239], v[164:167]
  s_lshl_b32 s53, s58, 15
  ds_read_b64_tr_b16 a[230:231], v9 offset:25600
  buffer_load_dwordx4 v4, s[16:19], s51 offen lds
  v_mfma_f32_16x16x32_bf16 v[168:171], a[112:115], a[232:235], v[168:171]
  s_add_u32 s53, s53, s64
  ds_read_b128 a[212:215], v6 offset:53248
  v_lshl_add_u32 v29, v28, 1, v29
  v_mfma_f32_16x16x32_bf16 v[168:171], a[116:119], a[236:239], v[168:171]
  s_add_u32 s36, s53, s72
  buffer_store_short_d16_hi v24, v29, s[28:31], s7 offen sc1
  v_mfma_f32_16x16x32_bf16 v[172:175], a[120:123], a[232:235], v[172:175]
  s_add_u32 s37, s53, s73
  v_mfma_f32_16x16x32_bf16 v[172:175], a[124:127], a[236:239], v[172:175]
  s_add_u32 m0, s56, 135168
  v_mfma_f32_16x16x32_bf16 v[176:179], a[128:131], a[232:235], v[176:179]
  s_add_u32 s51, s82, 2228224
  v_mfma_f32_16x16x32_bf16 v[176:179], a[132:135], a[236:239], v[176:179]
  s_lshl_b32 s53, s59, 15
  ds_read_b128 a[216:219], v5 offset:55296
  v_mfma_f32_16x16x32_bf16 v[180:183], a[136:139], a[232:235], v[180:183]
  s_add_u32 s53, s53, s64
  buffer_load_dwordx4 v3, s[16:19], s51 offen lds
  v_mfma_f32_16x16x32_bf16 v[180:183], a[140:143], a[236:239], v[180:183]
  s_add_u32 s38, s53, s72
  v_mfma_f32_16x16x32_bf16 v[184:187], a[144:147], a[232:235], v[184:187]
  s_add_u32 s39, s53, s73
  v_mfma_f32_16x16x32_bf16 v[184:187], a[148:151], a[236:239], v[184:187]
  s_add_u32 m0, s56, 136192
  v_mfma_f32_16x16x32_bf16 v[188:191], a[152:155], a[232:235], v[188:191]
  s_add_u32 s51, s82, 2260992
  v_mfma_f32_16x16x32_bf16 v[188:191], a[156:159], a[236:239], v[188:191]
  s_waitcnt lgkmcnt(2)
  s_lshl_b32 s53, s58, 15
  ds_read_b128 a[220:223], v6 offset:55296
  buffer_load_dwordx4 v3, s[16:19], s51 offen lds
  v_mfma_f32_16x16x32_bf16 v[192:195], a[96:99], a[224:227], v[192:195]
  s_add_u32 s53, s53, s65
  ds_read_b64_tr_b16 a[232:233], v10 offset:16384
  v_mfma_f32_16x16x32_bf16 v[192:195], a[100:103], a[228:231], v[192:195]
  s_add_u32 s40, s53, s74
  ds_read_b64_tr_b16 a[234:235], v10 offset:17408
  v_mfma_f32_16x16x32_bf16 v[196:199], a[104:107], a[224:227], v[196:199]
  s_add_u32 m0, s56, 137216
  ds_read_b64_tr_b16 a[236:237], v10 offset:24576
  v_mfma_f32_16x16x32_bf16 v[196:199], a[108:111], a[228:231], v[196:199]
  s_add_u32 s51, s82, 2293760
  ds_read_b64_tr_b16 a[238:239], v10 offset:25600
  v_mfma_f32_16x16x32_bf16 v[200:203], a[112:115], a[224:227], v[200:203]
  s_add_u32 s41, s53, s75
  buffer_load_dwordx4 v4, s[16:19], s51 offen lds
  v_mfma_f32_16x16x32_bf16 v[200:203], a[116:119], a[228:231], v[200:203]
HS3:
  s_cbranch_execz HS7
  s_lshl_b32 s53, s59, 15
  v_mfma_f32_16x16x32_bf16 v[204:207], a[120:123], a[224:227], v[204:207]
  s_add_u32 s53, s53, s65
  v_mfma_f32_16x16x32_bf16 v[204:207], a[124:127], a[228:231], v[204:207]
  s_add_u32 s42, s53, s74
  v_mfma_f32_16x16x32_bf16 v[208:211], a[128:131], a[224:227], v[208:211]
  s_add_u32 m0, s56, 138240
  v_mfma_f32_16x16x32_bf16 v[208:211], a[132:135], a[228:231], v[208:211]
  s_add_u32 s51, s82, 2326528
  v_mfma_f32_16x16x32_bf16 v[212:215], a[136:139], a[224:227], v[212:215]
  s_add_u32 s43, s53, s75
  buffer_load_dwordx4 v4, s[16:19], s51 offen lds
  v_mfma_f32_16x16x32_bf16 v[212:215], a[140:143], a[228:231], v[212:215]
  v_add_u32 v21, s72, v15
  v_add_u32 v22, s73, v15
  v_mfma_f32_16x16x32_bf16 v[216:219], a[144:147], a[224:227], v[216:219]
  v_add_u32 v17, s74, v15
  v_add_u32 v19, s75, v15
  v_mfma_f32_16x16x32_bf16 v[216:219], a[148:151], a[228:231], v[216:219]
  v_add_u32 v17, 65536, v17
  v_add_u32 v19, 65536, v19
  v_mfma_f32_16x16x32_bf16 v[220:223], a[152:155], a[224:227], v[220:223]
  v_mfma_f32_16x16x32_bf16 v[220:223], a[156:159], a[228:231], v[220:223]
  s_waitcnt vmcnt(9) lgkmcnt(0)
  s_barrier
  v_mfma_f32_16x16x32_bf16 v[224:227], a[96:99], a[232:235], v[224:227]
  ds_read_b64_tr_b16 a[224:225], v7 offset:32768
  v_mfma_f32_16x16x32_bf16 v[224:227], a[100:103], a[236:239], v[224:227]
  ds_read_b64_tr_b16 a[226:227], v7 offset:33792
  v_mfma_f32_16x16x32_bf16 v[228:231], a[104:107], a[232:235], v[228:231]
  ds_read_b64_tr_b16 a[228:229], v7 offset:40960
  v_mfma_f32_16x16x32_bf16 v[228:231], a[108:111], a[236:239], v[228:231]
  ds_read_b64_tr_b16 a[230:231], v7 offset:41984
  v_mfma_f32_16x16x32_bf16 v[232:235], a[112:115], a[232:235], v[232:235]
  s_add_u32 m0, s56, 98304
  v_mfma_f32_16x16x32_bf16 v[232:235], a[116:119], a[236:239], v[232:235]
  s_add_u32 s51, s82, 1048576
  v_mfma_f32_16x16x32_bf16 v[236:239], a[120:123], a[232:235], v[236:239]
  buffer_load_dwordx4 v3, s[16:19], s51 offen lds
  v_mfma_f32_16x16x32_bf16 v[236:239], a[124:127], a[236:239], v[236:239]
  s_add_u32 m0, s56, 99328
  v_mfma_f32_16x16x32_bf16 v[240:243], a[128:131], a[232:235], v[240:243]
  s_add_u32 s51, s82, 1081344
  v_mfma_f32_16x16x32_bf16 v[240:243], a[132:135], a[236:239], v[240:243]
  buffer_load_dwordx4 v3, s[16:19], s51 offen lds
  v_mfma_f32_16x16x32_bf16 v[244:247], a[136:139], a[232:235], v[244:247]
  s_add_u32 m0, s56, 100352
  v_mfma_f32_16x16x32_bf16 v[244:247], a[140:143], a[236:239], v[244:247]
  s_add_u32 s51, s82, 1114112
  v_mfma_f32_16x16x32_bf16 v[248:251], a[144:147], a[232:235], v[248:251]
  buffer_load_dwordx4 v4, s[16:19], s51 offen lds
  v_mfma_f32_16x16x32_bf16 v[248:251], a[148:151], a[236:239], v[248:251]
  v_mfma_f32_16x16x32_bf16 v[252:255], a[152:155], a[232:235], v[252:255]
  buffer_load_dword v18, v11, s[28:31], 0 offen sc1
  v_mfma_f32_16x16x32_bf16 v[252:255], a[156:159], a[236:239], v[252:255]
  s_waitcnt lgkmcnt(0)
  v_mfma_f32_16x16x32_bf16 a[0:3], a[224:227], a[160:163], a[0:3]
  s_add_u32 m0, s56, 101376
  ds_read_b64_tr_b16 a[232:233], v8 offset:32768
  v_mfma_f32_16x16x32_bf16 a[0:3], a[228:231], a[164:167], a[0:3]
  s_add_u32 s51, s82, 1146880
  ds_read_b64_tr_b16 a[234:235], v8 offset:33792
  v_mfma_f32_16x16x32_bf16 a[4:7], a[224:227], a[168:171], a[4:7]
  ds_read_b64_tr_b16 a[236:237], v8 offset:40960
  buffer_load_dwordx4 v4, s[16:19], s51 offen lds
  v_mfma_f32_16x16x32_bf16 a[4:7], a[228:231], a[172:175], a[4:7]
  s_add_u32 m0, s56, 102400
  ds_read_b64_tr_b16 a[238:239], v8 offset:41984
  v_mfma_f32_16x16x32_bf16 a[8:11], a[224:227], a[176:179], a[8:11]
  s_add_u32 s51, s82, 1179648
  v_mfma_f32_16x16x32_bf16 a[8:11], a[228:231], a[180:183], a[8:11]
  buffer_load_dwordx4 v3, s[16:19], s51 offen lds
  v_mfma_f32_16x16x32_bf16 a[12:15], a[224:227], a[184:187], a[12:15]
  v_accvgpr_read_b32 v64, a0
  v_accvgpr_read_b32 v65, a1
  v_mfma_f32_16x16x32_bf16 a[12:15], a[228:231], a[188:191], a[12:15]
  v_accvgpr_read_b32 v66, a2
  v_accvgpr_read_b32 v67, a3
  v_mfma_f32_16x16x32_bf16 a[16:19], a[224:227], a[192:195], a[16:19]
  s_add_u32 m0, s56, 103424
  v_cvt_pk_bf16_f32 v64, v64, v65
  v_cvt_pk_bf16_f32 v65, v66, v67
  v_mfma_f32_16x16x32_bf16 a[16:19], a[228:231], a[196:199], a[16:19]
  s_add_u32 s51, s82, 1212416
  v_accvgpr_read_b32 v68, a4
  v_accvgpr_read_b32 v69, a5
  v_mfma_f32_16x16x32_bf16 a[20:23], a[224:227], a[200:203], a[20:23]
  buffer_load_dwordx4 v3, s[16:19], s51 offen lds
  v_mfma_f32_16x16x32_bf16 a[20:23], a[228:231], a[204:207], a[20:23]
  v_accvgpr_read_b32 v70, a6
  v_accvgpr_read_b32 v71, a7
  v_mfma_f32_16x16x32_bf16 a[24:27], a[224:227], a[208:211], a[24:27]
  v_cvt_pk_bf16_f32 v68, v68, v69
  v_cvt_pk_bf16_f32 v69, v70, v71
  v_mfma_f32_16x16x32_bf16 a[24:27], a[228:231], a[212:215], a[24:27]
  s_add_u32 m0, s56, 104448
  v_accvgpr_read_b32 v72, a8
  v_accvgpr_read_b32 v73, a9
  v_mfma_f32_16x16x32_bf16 a[28:31], a[224:227], a[216:219], a[28:31]
  s_add_u32 s51, s82, 1245184
  v_accvgpr_read_b32 v74, a10
  v_accvgpr_read_b32 v75, a11
  v_mfma_f32_16x16x32_bf16 a[28:31], a[228:231], a[220:223], a[28:31]
  s_waitcnt lgkmcnt(0)
  buffer_load_dwordx4 v4, s[16:19], s51 offen lds
  v_mfma_f32_16x16x32_bf16 a[32:35], a[232:235], a[160:163], a[32:35]
  ds_read_b64_tr_b16 a[224:225], v9 offset:32768
  v_cvt_pk_bf16_f32 v72, v72, v73
  v_mfma_f32_16x16x32_bf16 a[32:35], a[236:239], a[164:167], a[32:35]
  ds_read_b64_tr_b16 a[226:227], v9 offset:33792
  v_cvt_pk_bf16_f32 v73, v74, v75
  v_mfma_f32_16x16x32_bf16 a[36:39], a[232:235], a[168:171], a[36:39]
  s_add_u32 m0, s56, 105472
  ds_read_b64_tr_b16 a[228:229], v9 offset:40960
  v_accvgpr_read_b32 v76, a12
  v_mfma_f32_16x16x32_bf16 a[36:39], a[236:239], a[172:175], a[36:39]
  s_add_u32 s51, s82, 1277952
  ds_read_b64_tr_b16 a[230:231], v9 offset:41984
  v_accvgpr_read_b32 v77, a13
  v_mfma_f32_16x16x32_bf16 a[40:43], a[232:235], a[176:179], a[40:43]
  buffer_load_dwordx4 v4, s[16:19], s51 offen lds
  v_mfma_f32_16x16x32_bf16 a[40:43], a[236:239], a[180:183], a[40:43]
  v_accvgpr_read_b32 v78, a14
  v_accvgpr_read_b32 v79, a15
  v_mfma_f32_16x16x32_bf16 a[44:47], a[232:235], a[184:187], a[44:47]
  v_cvt_pk_bf16_f32 v76, v76, v77
  v_cvt_pk_bf16_f32 v77, v78, v79
  v_mfma_f32_16x16x32_bf16 a[44:47], a[236:239], a[188:191], a[44:47]
  v_accvgpr_read_b32 v80, a16
  v_accvgpr_read_b32 v81, a17
  v_mfma_f32_16x16x32_bf16 a[48:51], a[232:235], a[192:195], a[48:51]
  v_accvgpr_read_b32 v82, a18
  v_accvgpr_read_b32 v83, a19
  v_mfma_f32_16x16x32_bf16 a[48:51], a[236:239], a[196:199], a[48:51]
  v_cvt_pk_bf16_f32 v80, v80, v81
  v_cvt_pk_bf16_f32 v81, v82, v83
  v_mfma_f32_16x16x32_bf16 a[52:55], a[232:235], a[200:203], a[52:55]
  v_accvgpr_read_b32 v84, a20
  v_accvgpr_read_b32 v85, a21
  v_mfma_f32_16x16x32_bf16 a[52:55], a[236:239], a[204:207], a[52:55]
  v_accvgpr_read_b32 v86, a22
  v_accvgpr_read_b32 v87, a23
  v_mfma_f32_16x16x32_bf16 a[56:59], a[232:235], a[208:211], a[56:59]
  v_cvt_pk_bf16_f32 v84, v84, v85
  v_cvt_pk_bf16_f32 v85, v86, v87
  s_waitcnt vmcnt(5)
  v_cmp_gt_u32 vcc, 64, v18
  s_nop 0
  s_cbranch_vccnz L_ph_w
L_ph_ok:
  v_mfma_f32_16x16x32_bf16 a[56:59], a[236:239], a[212:215], a[56:59]
  s_add_u32 s52, s70, 0
  v_accvgpr_read_b32 v88, a24
  v_accvgpr_read_b32 v89, a25
  v_mfma_f32_16x16x32_bf16 a[60:63], a[232:235], a[216:219], a[60:63]
  buffer_load_dwordx4 a[96:99], v15, s[28:31], s52 offen offset:0 sc1
  v_mfma_f32_16x16x32_bf16 a[60:63], a[236:239], a[220:223], a[60:63]
  s_waitcnt lgkmcnt(0)
  v_accvgpr_read_b32 v90, a26
  v_accvgpr_read_b32 v91, a27
  v_mfma_f32_16x16x32_bf16 a[64:67], a[224:227], a[160:163], a[64:67]
  ds_read_b64_tr_b16 a[232:233], v10 offset:32768
  v_cvt_pk_bf16_f32 v88, v88, v89
  v_mfma_f32_16x16x32_bf16 a[64:67], a[228:231], a[164:167], a[64:67]
  ds_read_b64_tr_b16 a[234:235], v10 offset:33792
  buffer_load_dwordx4 a[100:103], v15, s[28:31], s52 offen offset:1024 sc1
  v_mfma_f32_16x16x32_bf16 a[68:71], a[224:227], a[168:171], a[68:71]
  ds_read_b64_tr_b16 a[236:237], v10 offset:40960
  v_cvt_pk_bf16_f32 v89, v90, v91
  v_mfma_f32_16x16x32_bf16 a[68:71], a[228:231], a[172:175], a[68:71]
  ds_read_b64_tr_b16 a[238:239], v10 offset:41984
  v_accvgpr_read_b32 v92, a28
  v_mfma_f32_16x16x32_bf16 a[72:75], a[224:227], a[176:179], a[72:75]
  v_accvgpr_read_b32 v93, a29
  v_accvgpr_read_b32 v94, a30
  v_mfma_f32_16x16x32_bf16 a[72:75], a[228:231], a[180:183], a[72:75]
  v_accvgpr_read_b32 v95, a31
  v_cvt_pk_bf16_f32 v92, v92, v93
  v_mfma_f32_16x16x32_bf16 a[76:79], a[224:227], a[184:187], a[76:79]
  buffer_load_dwordx4 a[104:107], v15, s[28:31], s52 offen offset:2048 sc1
  v_mfma_f32_16x16x32_bf16 a[76:79], a[228:231], a[188:191], a[76:79]
  v_cvt_pk_bf16_f32 v93, v94, v95
  v_accvgpr_read_b32 v24, a32
  v_mfma_f32_16x16x32_bf16 a[80:83], a[224:227], a[192:195], a[80:83]
  v_accvgpr_read_b32 v25, a33
  v_accvgpr_read_b32 v26, a34
  v_mfma_f32_16x16x32_bf16 a[80:83], a[228:231], a[196:199], a[80:83]
  v_accvgpr_read_b32 v27, a35
  v_cvt_pk_bf16_f32 v66, v24, v25
  v_mfma_f32_16x16x32_bf16 a[84:87], a[224:227], a[200:203], a[84:87]
  v_cvt_pk_bf16_f32 v67, v26, v27
  v_accvgpr_read_b32 v28, a36
  v_mfma_f32_16x16x32_bf16 a[84:87], a[228:231], a[204:207], a[84:87]
  buffer_load_dwordx4 a[108:111], v15, s[28:31], s52 offen offset:3072 sc1
  v_mfma_f32_16x16x32_bf16 a[88:91], a[224:227], a[208:211], a[88:91]
  v_accvgpr_read_b32 v29, a37
  v_accvgpr_read_b32 v30, a38
  v_mfma_f32_16x16x32_bf16 a[88:91], a[228:231], a[212:215], a[88:91]
  v_accvgpr_read_b32 v31, a39
  v_cvt_pk_bf16_f32 v70, v28, v29
  v_mfma_f32_16x16x32_bf16 a[92:95], a[224:227], a[216:219], a[92:95]
  s_add_u32 s52, s70, 4096
  v_cvt_pk_bf16_f32 v71, v30, v31
  v_accvgpr_read_b32 v32, a40
  v_mfma_f32_16x16x32_bf16 a[92:95], a[228:231], a[220:223], a[92:95]
  s_waitcnt lgkmcnt(0)
  buffer_load_dwordx4 a[112:115], v15, s[28:31], s52 offen offset:0 sc1
  v_mfma_f32_16x16x32_bf16 v[96:99], a[232:235], a[160:163], v[96:99]
  ds_read_b64_tr_b16 a[224:225], v7 offset:49152
  v_accvgpr_read_b32 v33, a41
  v_mfma_f32_16x16x32_bf16 v[96:99], a[236:239], a[164:167], v[96:99]
  ds_read_b64_tr_b16 a[226:227], v7 offset:50176
  v_accvgpr_read_b32 v34, a42
  v_mfma_f32_16x16x32_bf16 v[100:103], a[232:235], a[168:171], v[100:103]
  ds_read_b64_tr_b16 a[228:229], v7 offset:57344
  v_accvgpr_read_b32 v35, a43
  v_mfma_f32_16x16x32_bf16 v[100:103], a[236:239], a[172:175], v[100:103]
  ds_read_b64_tr_b16 a[230:231], v7 offset:58368
  v_cvt_pk_bf16_f32 v74, v32, v33
  v_mfma_f32_16x16x32_bf16 v[104:107], a[232:235], a[176:179], v[104:107]
  buffer_load_dwordx4 a[116:119], v15, s[28:31], s52 offen offset:1024 sc1
  v_mfma_f32_16x16x32_bf16 v[104:107], a[236:239], a[180:183], v[104:107]
  v_cvt_pk_bf16_f32 v75, v34, v35
  v_accvgpr_read_b32 v36, a44
  v_mfma_f32_16x16x32_bf16 v[108:111], a[232:235], a[184:187], v[108:111]
  v_accvgpr_read_b32 v37, a45
  v_accvgpr_read_b32 v38, a46
  v_mfma_f32_16x16x32_bf16 v[108:111], a[236:239], a[188:191], v[108:111]
  v_accvgpr_read_b32 v39, a47
  v_cvt_pk_bf16_f32 v78, v36, v37
  v_mfma_f32_16x16x32_bf16 v[112:115], a[232:235], a[192:195], v[112:115]
  v_cvt_pk_bf16_f32 v79, v38, v39
  v_accvgpr_read_b32 v40, a48
  v_mfma_f32_16x16x32_bf16 v[112:115], a[236:239], a[196:199], v[112:115]
  buffer_load_dwordx4 a[120:123], v15, s[28:31], s52 offen offset:2048 sc1
  v_mfma_f32_16x16x32_bf16 v[116:119], a[232:235], a[200:203], v[116:119]
  v_accvgpr_read_b32 v41, a49
  v_accvgpr_read_b32 v42, a50
  v_mfma_f32_16x16x32_bf16 v[116:119], a[236:239], a[204:207], v[116:119]
  v_accvgpr_read_b32 v43, a51
  v_cvt_pk_bf16_f32 v82, v40, v41
  v_mfma_f32_16x16x32_bf16 v[120:123], a[232:235], a[208:211], v[120:123]
  v_cvt_pk_bf16_f32 v83, v42, v43
  v_mfma_f32_16x16x32_bf16 v[120:123], a[236:239], a[212:215], v[120:123]
  s_add_u32 s53, s38, 0
  buffer_load_dwordx4 a[124:127], v15, s[28:31], s52 offen offset:3072 sc1
  v_mfma_f32_16x16x32_bf16 v[124:127], a[232:235], a[216:219], v[124:127]
  buffer_store_dwordx4 v[80:83], v15, s[28:31], s53 offen sc1
  v_mfma_f32_16x16x32_bf16 v[124:127], a[236:239], a[220:223], v[124:127]
  s_waitcnt lgkmcnt(0)
  v_accvgpr_read_b32 v44, a52
  v_accvgpr_read_b32 v45, a53
  v_mfma_f32_16x16x32_bf16 v[128:131], a[160:163], a[224:227], v[128:131]
  ds_read_b64_tr_b16 a[232:233], v8 offset:49152
  v_accvgpr_read_b32 v46, a54
  v_mfma_f32_16x16x32_bf16 v[128:131], a[164:167], a[228:231], v[128:131]
  s_add_u32 s52, s70, 8192
  ds_read_b64_tr_b16 a[234:235], v8 offset:50176
  v_accvgpr_read_b32 v47, a55
  v_mfma_f32_16x16x32_bf16 v[132:135], a[168:171], a[224:227], v[132:135]
  ds_read_b64_tr_b16 a[236:237], v8 offset:57344
  buffer_load_dwordx4 a[128:131], v15, s[28:31], s52 offen offset:0 sc1
  v_mfma_f32_16x16x32_bf16 v[132:135], a[172:175], a[228:231], v[132:135]
  ds_read_b64_tr_b16 a[238:239], v8 offset:58368
  v_cvt_pk_bf16_f32 v86, v44, v45
  v_mfma_f32_16x16x32_bf16 v[136:139], a[176:179], a[224:227], v[136:139]
  v_cvt_pk_bf16_f32 v87, v46, v47
  v_mfma_f32_16x16x32_bf16 v[136:139], a[180:183], a[228:231], v[136:139]
  s_add_u32 s53, s38, 4096
  buffer_store_dwordx4 v[84:87], v15, s[28:31], s53 offen sc1
  v_mfma_f32_16x16x32_bf16 v[140:143], a[184:187], a[224:227], v[140:143]
  v_accvgpr_read_b32 v48, a56
  v_accvgpr_read_b32 v49, a57
  v_mfma_f32_16x16x32_bf16 v[140:143], a[188:191], a[228:231], v[140:143]
  buffer_load_dwordx4 a[132:135], v15, s[28:31], s52 offen offset:1024 sc1
  v_mfma_f32_16x16x32_bf16 v[144:147], a[192:195], a[224:227], v[144:147]
  v_accvgpr_read_b32 v50, a58
  v_accvgpr_read_b32 v51, a59
  v_mfma_f32_16x16x32_bf16 v[144:147], a[196:199], a[228:231], v[144:147]
  v_cvt_pk_bf16_f32 v90, v48, v49
  v_cvt_pk_bf16_f32 v91, v50, v51
  v_mfma_f32_16x16x32_bf16 v[148:151], a[200:203], a[224:227], v[148:151]
  v_accvgpr_read_b32 v52, a60
  v_accvgpr_read_b32 v53, a61
  v_mfma_f32_16x16x32_bf16 v[148:151], a[204:207], a[228:231], v[148:151]
  buffer_load_dwordx4 a[136:139], v15, s[28:31], s52 offen offset:2048 sc1
  v_mfma_f32_16x16x32_bf16 v[152:155], a[208:211], a[224:227], v[152:155]
  v_accvgpr_read_b32 v54, a62
  v_accvgpr_read_b32 v55, a63
  v_mfma_f32_16x16x32_bf16 v[152:155], a[212:215], a[228:231], v[152:155]
  v_cvt_pk_bf16_f32 v94, v52, v53
  v_cvt_pk_bf16_f32 v95, v54, v55
  v_mfma_f32_16x16x32_bf16 v[156:159], a[216:219], a[224:227], v[156:159]
  v_accvgpr_read_b32 v24, a64
  v_accvgpr_read_b32 v25, a65
  v_mfma_f32_16x16x32_bf16 v[156:159], a[220:223], a[228:231], v[156:159]
  s_waitcnt lgkmcnt(0)
  v_accvgpr_read_b32 v26, a66
  v_accvgpr_read_b32 v27, a67
  v_mfma_f32_16x16x32_bf16 v[160:163], a[160:163], a[232:235], v[160:163]
  ds_read_b64_tr_b16 a[224:225], v9 offset:49152
  buffer_load_dwordx4 a[140:143], v15, s[28:31], s52 offen offset:3072 sc1
  v_mfma_f32_16x16x32_bf16 v[160:163], a[164:167], a[236:239], v[160:163]
  ds_read_b64_tr_b16 a[226:227], v9 offset:50176
  v_cvt_pk_bf16_f32 v99, v98, v99
  v_mfma_f32_16x16x32_bf16 v[164:167], a[168:171], a[232:235], v[164:167]
  ds_read_b64_tr_b16 a[228:229], v9 offset:57344
  v_cvt_pk_bf16_f32 v98, v96, v97
  v_mfma_f32_16x16x32_bf16 v[164:167], a[172:175], a[236:239], v[164:167]
  ds_read_b64_tr_b16 a[230:231], v9 offset:58368
  v_cvt_pk_bf16_f32 v96, v24, v25
  v_mfma_f32_16x16x32_bf16 v[168:171], a[176:179], a[232:235], v[168:171]
  s_add_u32 s52, s70, 12288
  v_cvt_pk_bf16_f32 v97, v26, v27
  v_accvgpr_read_b32 v28, a68
  v_mfma_f32_16x16x32_bf16 v[168:171], a[180:183], a[236:239], v[168:171]
  buffer_load_dwordx4 a[144:147], v15, s[28:31], s52 offen offset:0 sc1
  v_mfma_f32_16x16x32_bf16 v[172:175], a[184:187], a[232:235], v[172:175]
  v_accvgpr_read_b32 v29, a69
  v_accvgpr_read_b32 v30, a70
  v_mfma_f32_16x16x32_bf16 v[172:175], a[188:191], a[236:239], v[172:175]
  v_accvgpr_read_b32 v31, a71
  v_cvt_pk_bf16_f32 v103, v102, v103
  v_mfma_f32_16x16x32_bf16 v[176:179], a[192:195], a[232:235], v[176:179]
  v_cvt_pk_bf16_f32 v102, v100, v101
  v_cvt_pk_bf16_f32 v100, v28, v29
  v_mfma_f32_16x16x32_bf16 v[176:179], a[196:199], a[236:239], v[176:179]
  buffer_load_dwordx4 a[148:151], v15, s[28:31], s52 offen offset:1024 sc1
  v_mfma_f32_16x16x32_bf16 v[180:183], a[200:203], a[232:235], v[180:183]
  v_cvt_pk_bf16_f32 v101, v30, v31
  v_accvgpr_read_b32 v32, a72
  v_mfma_f32_16x16x32_bf16 v[180:183], a[204:207], a[236:239], v[180:183]
  v_accvgpr_read_b32 v33, a73
  v_accvgpr_read_b32 v34, a74
  v_mfma_f32_16x16x32_bf16 v[184:187], a[208:211], a[232:235], v[184:187]
  v_accvgpr_read_b32 v35, a75
  v_cvt_pk_bf16_f32 v107, v106, v107
  v_mfma_f32_16x16x32_bf16 v[184:187], a[212:215], a[236:239], v[184:187]
  v_cvt_pk_bf16_f32 v106, v104, v105
  v_cvt_pk_bf16_f32 v104, v32, v33
  v_mfma_f32_16x16x32_bf16 v[188:191], a[216:219], a[232:235], v[188:191]
  buffer_load_dwordx4 a[152:155], v15, s[28:31], s52 offen offset:2048 sc1
  v_mfma_f32_16x16x32_bf16 v[188:191], a[220:223], a[236:239], v[188:191]
  s_waitcnt lgkmcnt(0)
  v_cvt_pk_bf16_f32 v105, v34, v35
  v_accvgpr_read_b32 v36, a76
  v_mfma_f32_16x16x32_bf16 v[192:195], a[160:163], a[224:227], v[192:195]
  ds_read_b64_tr_b16 a[232:233], v10 offset:49152
  v_accvgpr_read_b32 v37, a77
  v_mfma_f32_16x16x32_bf16 v[192:195], a[164:167], a[228:231], v[192:195]
  ds_read_b64_tr_b16 a[234:235], v10 offset:50176
  v_accvgpr_read_b32 v38, a78
  v_mfma_f32_16x16x32_bf16 v[196:199], a[168:171], a[224:227], v[196:199]
  ds_read_b64_tr_b16 a[236:237], v10 offset:57344
  v_accvgpr_read_b32 v39, a79
  v_mfma_f32_16x16x32_bf16 v[196:199], a[172:175], a[228:231], v[196:199]
  ds_read_b64_tr_b16 a[238:239], v10 offset:58368
  v_cvt_pk_bf16_f32 v111, v110, v111
  v_mfma_f32_16x16x32_bf16 v[200:203], a[176:179], a[224:227], v[200:203]
  buffer_load_dwordx4 a[156:159], v15, s[28:31], s52 offen offset:3072 sc1
  v_mfma_f32_16x16x32_bf16 v[200:203], a[180:183], a[228:231], v[200:203]
  s_lshr_b32 s6, s48, 1
  v_cvt_pk_bf16_f32 v110, v108, v109
  v_cvt_pk_bf16_f32 v108, v36, v37
  v_mfma_f32_16x16x32_bf16 v[204:207], a[184:187], a[224:227], v[204:207]
  s_lshl_b32 s6, s6, 7
  v_cvt_pk_bf16_f32 v109, v38, v39
  v_accvgpr_read_b32 v40, a80
  v_mfma_f32_16x16x32_bf16 v[204:207], a[188:191], a[228:231], v[204:207]
  s_add_u32 s6, s6, 65536
  v_xor_b32 v7, s6, v7
  v_xor_b32 v8, 32, v7
  v_mfma_f32_16x16x32_bf16 v[208:211], a[192:195], a[224:227], v[208:211]
  v_xor_b32 v9, 64, v7
  v_xor_b32 v10, 96, v7
  v_mfma_f32_16x16x32_bf16 v[208:211], a[196:199], a[228:231], v[208:211]
  v_xor_b32 v11, 128, v7
  v_xor_b32 v12, 160, v7
  v_mfma_f32_16x16x32_bf16 v[212:215], a[200:203], a[224:227], v[212:215]
  v_xor_b32 v13, 192, v7
  v_xor_b32 v14, 224, v7
  v_mfma_f32_16x16x32_bf16 v[212:215], a[204:207], a[228:231], v[212:215]
  v_accvgpr_read_b32 v41, a81
  v_accvgpr_read_b32 v42, a82
  v_mfma_f32_16x16x32_bf16 v[216:219], a[208:211], a[224:227], v[216:219]
  v_accvgpr_read_b32 v43, a83
  v_cvt_pk_bf16_f32 v115, v114, v115
  v_mfma_f32_16x16x32_bf16 v[216:219], a[212:215], a[228:231], v[216:219]
  v_cvt_pk_bf16_f32 v114, v112, v113
  v_cvt_pk_bf16_f32 v112, v40, v41
  v_mfma_f32_16x16x32_bf16 v[220:223], a[216:219], a[224:227], v[220:223]
  v_cvt_pk_bf16_f32 v113, v42, v43
  v_accvgpr_read_b32 v44, a84
  v_mfma_f32_16x16x32_bf16 v[220:223], a[220:223], a[228:231], v[220:223]
  s_waitcnt lgkmcnt(0)
  v_accvgpr_read_b32 v45, a85
  v_accvgpr_read_b32 v46, a86
  s_waitcnt lgkmcnt(0)
  s_barrier
  v_mfma_f32_16x16x32_bf16 v[224:227], a[160:163], a[232:235], v[224:227]
  ds_read_b64_tr_b16 a[240:241], v7 offset:0
  v_accvgpr_read_b32 v47, a87
  v_mfma_f32_16x16x32_bf16 v[224:227], a[164:167], a[236:239], v[224:227]
  ds_read_b64_tr_b16 a[242:243], v7 offset:1024
  v_cvt_pk_bf16_f32 v119, v118, v119
  v_mfma_f32_16x16x32_bf16 v[228:231], a[168:171], a[232:235], v[228:231]
  ds_read_b64_tr_b16 a[244:245], v7 offset:8192
  v_cvt_pk_bf16_f32 v118, v116, v117
  v_mfma_f32_16x16x32_bf16 v[228:231], a[172:175], a[236:239], v[228:231]
  ds_read_b64_tr_b16 a[246:247], v7 offset:9216
  v_cvt_pk_bf16_f32 v116, v44, v45
  v_mfma_f32_16x16x32_bf16 v[232:235], a[176:179], a[232:235], v[232:235]
  ds_read_b64_tr_b16 a[248:249], v7 offset:16384
  v_cvt_pk_bf16_f32 v117, v46, v47
  v_mfma_f32_16x16x32_bf16 v[232:235], a[180:183], a[236:239], v[232:235]
  ds_read_b64_tr_b16 a[250:251], v7 offset:17408
  v_accvgpr_read_b32 v48, a88
  v_mfma_f32_16x16x32_bf16 v[236:239], a[184:187], a[232:235], v[236:239]
  ds_read_b64_tr_b16 a[252:253], v7 offset:24576
  v_accvgpr_read_b32 v49, a89
  v_mfma_f32_16x16x32_bf16 v[236:239], a[188:191], a[236:239], v[236:239]
  ds_read_b64_tr_b16 a[254:255], v7 offset:25600
  v_accvgpr_read_b32 v50, a90
  v_mfma_f32_16x16x32_bf16 v[240:243], a[192:195], a[232:235], v[240:243]
  v_accvgpr_read_b32 v51, a91
  v_cvt_pk_bf16_f32 v123, v122, v123
  v_mfma_f32_16x16x32_bf16 v[240:243], a[196:199], a[236:239], v[240:243]
  v_cvt_pk_bf16_f32 v122, v120, v121
  v_cvt_pk_bf16_f32 v120, v48, v49
  v_mfma_f32_16x16x32_bf16 v[244:247], a[200:203], a[232:235], v[244:247]
  v_cvt_pk_bf16_f32 v121, v50, v51
  v_accvgpr_read_b32 v52, a92
  v_mfma_f32_16x16x32_bf16 v[244:247], a[204:207], a[236:239], v[244:247]
  v_accvgpr_read_b32 v53, a93
  v_accvgpr_read_b32 v54, a94
  v_mfma_f32_16x16x32_bf16 v[248:251], a[208:211], a[232:235], v[248:251]
  v_accvgpr_read_b32 v55, a95
  v_cvt_pk_bf16_f32 v127, v126, v127
  v_mfma_f32_16x16x32_bf16 v[248:251], a[212:215], a[236:239], v[248:251]
  v_cvt_pk_bf16_f32 v126, v124, v125
  v_cvt_pk_bf16_f32 v124, v52, v53
  v_mfma_f32_16x16x32_bf16 v[252:255], a[216:219], a[232:235], v[252:255]
  v_cvt_pk_bf16_f32 v125, v54, v55
  v_mfma_f32_16x16x32_bf16 v[252:255], a[220:223], a[236:239], v[252:255]
  s_waitcnt vmcnt(17) lgkmcnt(6)
  v_mfma_f32_16x16x32_bf16 v[32:35], a[240:243], a[96:99], 0
  s_add_u32 s53, s39, 0
  ds_read_b64_tr_b16 a[224:225], v8 offset:0
  v_cvt_pk_bf16_f32 v128, v128, v129
  s_waitcnt vmcnt(13) lgkmcnt(5)
  v_mfma_f32_16x16x32_bf16 v[32:35], a[244:247], a[112:115], v[32:35]
  ds_read_b64_tr_b16 a[226:227], v8 offset:1024
  buffer_store_dwordx4 v[88:91], v15, s[28:31], s53 offen sc1
  s_waitcnt vmcnt(9) lgkmcnt(4)
  v_mfma_f32_16x16x32_bf16 v[32:35], a[248:251], a[128:131], v[32:35]
  ds_read_b64_tr_b16 a[228:229], v8 offset:8192
  v_cvt_pk_bf16_f32 v129, v130, v131
  s_waitcnt vmcnt(4) lgkmcnt(3)
  v_mfma_f32_16x16x32_bf16 v[32:35], a[252:255], a[144:147], v[32:35]
  ds_read_b64_tr_b16 a[230:231], v8 offset:9216
  v_cvt_pk_bf16_f32 v130, v132, v133
  v_mfma_f32_16x16x32_bf16 v[36:39], a[240:243], a[100:103], 0
  ds_read_b64_tr_b16 a[232:233], v8 offset:16384
  v_cvt_pk_bf16_f32 v131, v134, v135
  v_mfma_f32_16x16x32_bf16 v[36:39], a[244:247], a[116:119], v[36:39]
  s_add_u32 s53, s39, 4096
  ds_read_b64_tr_b16 a[234:235], v8 offset:17408
  v_cvt_pk_bf16_f32 v136, v136, v137
  v_mfma_f32_16x16x32_bf16 v[36:39], a[248:251], a[132:135], v[36:39]
  ds_read_b64_tr_b16 a[236:237], v8 offset:24576
  buffer_store_dwordx4 v[92:95], v15, s[28:31], s53 offen sc1
  s_waitcnt vmcnt(4)
  v_mfma_f32_16x16x32_bf16 v[36:39], a[252:255], a[148:151], v[36:39]
  s_add_u32 s52, s70, 16384
  ds_read_b64_tr_b16 a[238:239], v8 offset:25600
  v_cvt_pk_bf16_f32 v137, v138, v139
  v_mfma_f32_16x16x32_bf16 v[40:43], a[240:243], a[104:107], 0
  ds_write_b128 v21, v[64:67] offset:0
  v_cvt_pk_bf16_f32 v138, v140, v141
  v_mfma_f32_16x16x32_bf16 v[40:43], a[244:247], a[120:123], v[40:43]
  buffer_load_dwordx4 a[160:163], v15, s[28:31], s52 offen offset:0 sc1
  v_mfma_f32_16x16x32_bf16 v[40:43], a[248:251], a[136:139], v[40:43]
  v_cvt_pk_bf16_f32 v139, v142, v143
  v_cvt_pk_bf16_f32 v144, v144, v145
  s_waitcnt vmcnt(4)
  v_mfma_f32_16x16x32_bf16 v[40:43], a[252:255], a[152:155], v[40:43]
  ds_write_b128 v21, v[68:71] offset:4096
  v_cvt_pk_bf16_f32 v145, v146, v147
  v_mfma_f32_16x16x32_bf16 v[44:47], a[240:243], a[108:111], 0
  buffer_load_dwordx4 a[164:167], v15, s[28:31], s52 offen offset:1024 sc1
  v_mfma_f32_16x16x32_bf16 v[44:47], a[244:247], a[124:127], v[44:47]
  v_cvt_pk_bf16_f32 v146, v148, v149
  v_cvt_pk_bf16_f32 v147, v150, v151
  v_mfma_f32_16x16x32_bf16 v[44:47], a[248:251], a[140:143], v[44:47]
  ds_write_b128 v22, v[72:75] offset:0
  v_cvt_pk_bf16_f32 v152, v152, v153
  s_waitcnt vmcnt(4)
  v_mfma_f32_16x16x32_bf16 v[44:47], a[252:255], a[156:159], v[44:47]
  s_waitcnt lgkmcnt(3)
  v_cvt_pk_bf16_f32 v153, v154, v155
  v_cvt_pk_bf16_f32 v154, v156, v157
  v_mfma_f32_16x16x32_bf16 v[48:51], a[224:227], a[96:99], 0
  ds_read_b64_tr_b16 a[240:241], v9 offset:0
  buffer_load_dwordx4 a[168:171], v15, s[28:31], s52 offen offset:2048 sc1
  v_mfma_f32_16x16x32_bf16 v[48:51], a[228:231], a[112:115], v[48:51]
  ds_read_b64_tr_b16 a[242:243], v9 offset:1024
  v_cvt_pk_bf16_f32 v155, v158, v159
  v_mfma_f32_16x16x32_bf16 v[48:51], a[232:235], a[128:131], v[48:51]
  ds_read_b64_tr_b16 a[244:245], v9 offset:8192
  v_cvt_pk_bf16_f32 v160, v160, v161
  v_mfma_f32_16x16x32_bf16 v[48:51], a[236:239], a[144:147], v[48:51]
  ds_read_b64_tr_b16 a[246:247], v9 offset:9216
  v_cvt_pk_bf16_f32 v161, v162, v163
  v_mfma_f32_16x16x32_bf16 v[52:55], a[224:227], a[100:103], 0
  ds_read_b64_tr_b16 a[248:249], v9 offset:16384
  v_cvt_pk_bf16_f32 v162, v164, v165
  v_mfma_f32_16x16x32_bf16 v[52:55], a[228:231], a[116:119], v[52:55]
  ds_read_b64_tr_b16 a[250:251], v9 offset:17408
  buffer_load_dwordx4 a[172:175], v15, s[28:31], s52 offen offset:3072 sc1
  v_mfma_f32_16x16x32_bf16 v[52:55], a[232:235], a[132:135], v[52:55]
  ds_read_b64_tr_b16 a[252:253], v9 offset:24576
  v_cvt_pk_bf16_f32 v163, v166, v167
  v_mfma_f32_16x16x32_bf16 v[52:55], a[236:239], a[148:151], v[52:55]
  ds_read_b64_tr_b16 a[254:255], v9 offset:25600
  v_cvt_pk_bf16_f32 v168, v168, v169
  v_mfma_f32_16x16x32_bf16 v[56:59], a[224:227], a[104:107], 0
  ds_write_b128 v22, v[76:79] offset:4096
  v_cvt_pk_bf16_f32 v169, v170, v171
  v_mfma_f32_16x16x32_bf16 v[56:59], a[228:231], a[120:123], v[56:59]
  s_add_u32 s52, s70, 20480
  v_cvt_pk_bf16_f32 v170, v172, v173
  v_cvt_pk_bf16_f32 v171, v174, v175
  v_mfma_f32_16x16x32_bf16 v[56:59], a[232:235], a[136:139], v[56:59]
HS4:
  s_cbranch_execz HS8
  buffer_load_dwordx4 a[176:179], v15, s[28:31], s52 offen offset:0 sc1
  v_mfma_f32_16x16x32_bf16 v[56:59], a[236:239], a[152:155], v[56:59]
  ds_write_b128 v21, v[80:83] offset:32768
  v_cvt_pk_bf16_f32 v176, v176, v177
  v_mfma_f32_16x16x32_bf16 v[60:63], a[224:227], a[108:111], 0
  v_cvt_pk_bf16_f32 v177, v178, v179
  v_cvt_pk_bf16_f32 v178, v180, v181
  v_mfma_f32_16x16x32_bf16 v[60:63], a[228:231], a[124:127], v[60:63]
  v_cvt_pk_bf16_f32 v179, v182, v183
  v_cvt_pk_bf16_f32 v184, v184, v185
  v_mfma_f32_16x16x32_bf16 v[60:63], a[232:235], a[140:143], v[60:63]
  ds_write_b128 v21, v[84:87] offset:36864
  v_cvt_pk_bf16_f32 v185, v186, v187
  v_mfma_f32_16x16x32_bf16 v[60:63], a[236:239], a[156:159], v[60:63]
  s_waitcnt lgkmcnt(3)
  buffer_load_dwordx4 a[180:183], v15, s[28:31], s52 offen offset:1024 sc1
  v_mfma_f32_16x16x32_bf16 v[132:135], a[240:243], a[96:99], 0
  ds_read_b64_tr_b16 a[224:225], v10 offset:0
  v_cvt_pk_bf16_f32 v186, v188, v189
  v_mfma_f32_16x16x32_bf16 v[132:135], a[244:247], a[112:115], v[132:135]
  ds_read_b64_tr_b16 a[226:227], v10 offset:1024
  v_cvt_pk_bf16_f32 v187, v190, v191
  v_mfma_f32_16x16x32_bf16 v[132:135], a[248:251], a[128:131], v[132:135]
  ds_read_b64_tr_b16 a[228:229], v10 offset:8192
  v_cvt_pk_bf16_f32 v192, v192, v193
  v_mfma_f32_16x16x32_bf16 v[132:135], a[252:255], a[144:147], v[132:135]
  ds_read_b64_tr_b16 a[230:231], v10 offset:9216
  buffer_load_dwordx4 a[184:187], v15, s[28:31], s52 offen offset:2048 sc1
  v_mfma_f32_16x16x32_bf16 v[140:143], a[240:243], a[100:103], 0
  ds_read_b64_tr_b16 a[232:233], v10 offset:16384
  v_cvt_pk_bf16_f32 v193, v194, v195
  v_mfma_f32_16x16x32_bf16 v[140:143], a[244:247], a[116:119], v[140:143]
  ds_read_b64_tr_b16 a[234:235], v10 offset:17408
  v_cvt_pk_bf16_f32 v194, v196, v197
  v_mfma_f32_16x16x32_bf16 v[140:143], a[248:251], a[132:135], v[140:143]
  ds_read_b64_tr_b16 a[236:237], v10 offset:24576
  v_cvt_pk_bf16_f32 v195, v198, v199
  v_mfma_f32_16x16x32_bf16 v[140:143], a[252:255], a[148:151], v[140:143]
  ds_read_b64_tr_b16 a[238:239], v10 offset:25600
  v_cvt_pk_bf16_f32 v200, v200, v201
  v_mfma_f32_16x16x32_bf16 v[148:151], a[240:243], a[104:107], 0
  ds_write_b128 v22, v[88:91] offset:32768
  v_cvt_pk_bf16_f32 v201, v202, v203
  v_mfma_f32_16x16x32_bf16 v[148:151], a[244:247], a[120:123], v[148:151]
  buffer_load_dwordx4 a[188:191], v15, s[28:31], s52 offen offset:3072 sc1
  v_mfma_f32_16x16x32_bf16 v[148:151], a[248:251], a[136:139], v[148:151]
  v_cvt_pk_bf16_f32 v202, v204, v205
  v_cvt_pk_bf16_f32 v203, v206, v207
  v_mfma_f32_16x16x32_bf16 v[148:151], a[252:255], a[152:155], v[148:151]
  ds_write_b128 v22, v[92:95] offset:36864
  v_cvt_pk_bf16_f32 v208, v208, v209
  v_mfma_f32_16x16x32_bf16 v[156:159], a[240:243], a[108:111], 0
  s_add_u32 s52, s70, 24576
  v_cvt_pk_bf16_f32 v209, v210, v211
  v_cvt_pk_bf16_f32 v210, v212, v213
  v_mfma_f32_16x16x32_bf16 v[156:159], a[244:247], a[124:127], v[156:159]
  buffer_load_dwordx4 a[192:195], v15, s[28:31], s52 offen offset:0 sc1
  v_mfma_f32_16x16x32_bf16 v[156:159], a[248:251], a[140:143], v[156:159]
  v_cvt_pk_bf16_f32 v211, v214, v215
  v_cvt_pk_bf16_f32 v216, v216, v217
  v_mfma_f32_16x16x32_bf16 v[156:159], a[252:255], a[156:159], v[156:159]
  s_waitcnt lgkmcnt(2)
  v_cvt_pk_bf16_f32 v217, v218, v219
  v_cvt_pk_bf16_f32 v218, v220, v221
  v_mfma_f32_16x16x32_bf16 v[164:167], a[224:227], a[96:99], 0
  ds_read_b64_tr_b16 a[240:241], v11 offset:0
  v_cvt_pk_bf16_f32 v219, v222, v223
  v_mfma_f32_16x16x32_bf16 v[164:167], a[228:231], a[112:115], v[164:167]
  ds_read_b64_tr_b16 a[242:243], v11 offset:1024
  v_cvt_pk_bf16_f32 v224, v224, v225
  v_mfma_f32_16x16x32_bf16 v[164:167], a[232:235], a[128:131], v[164:167]
  ds_read_b64_tr_b16 a[244:245], v11 offset:8192
  buffer_load_dwordx4 a[196:199], v15, s[28:31], s52 offen offset:1024 sc1
  v_mfma_f32_16x16x32_bf16 v[164:167], a[236:239], a[144:147], v[164:167]
  ds_read_b64_tr_b16 a[246:247], v11 offset:9216
  v_cvt_pk_bf16_f32 v225, v226, v227
  v_mfma_f32_16x16x32_bf16 v[172:175], a[224:227], a[100:103], 0
  ds_read_b64_tr_b16 a[248:249], v11 offset:16384
  v_cvt_pk_bf16_f32 v226, v228, v229
  v_mfma_f32_16x16x32_bf16 v[172:175], a[228:231], a[116:119], v[172:175]
  ds_read_b64_tr_b16 a[250:251], v11 offset:17408
  v_cvt_pk_bf16_f32 v227, v230, v231
  v_mfma_f32_16x16x32_bf16 v[172:175], a[232:235], a[132:135], v[172:175]
  ds_read_b64_tr_b16 a[252:253], v11 offset:24576
  v_cvt_pk_bf16_f32 v232, v232, v233
  v_mfma_f32_16x16x32_bf16 v[172:175], a[236:239], a[148:151], v[172:175]
  ds_read_b64_tr_b16 a[254:255], v11 offset:25600
  v_cvt_pk_bf16_f32 v233, v234, v235
  v_mfma_f32_16x16x32_bf16 v[180:183], a[224:227], a[104:107], 0
  buffer_load_dwordx4 a[200:203], v15, s[28:31], s52 offen offset:2048 sc1
  v_mfma_f32_16x16x32_bf16 v[180:183], a[228:231], a[120:123], v[180:183]
  v_cvt_pk_bf16_f32 v234, v236, v237
  v_cvt_pk_bf16_f32 v235, v238, v239
  v_mfma_f32_16x16x32_bf16 v[180:183], a[232:235], a[136:139], v[180:183]
  v_cvt_pk_bf16_f32 v240, v240, v241
  v_cvt_pk_bf16_f32 v241, v242, v243
  v_mfma_f32_16x16x32_bf16 v[180:183], a[236:239], a[152:155], v[180:183]
  buffer_load_dwordx4 a[204:207], v15, s[28:31], s52 offen offset:3072 sc1
  v_mfma_f32_16x16x32_bf16 v[188:191], a[224:227], a[108:111], 0
  v_cvt_pk_bf16_f32 v242, v244, v245
  v_cvt_pk_bf16_f32 v243, v246, v247
  v_mfma_f32_16x16x32_bf16 v[188:191], a[228:231], a[124:127], v[188:191]
  v_cvt_pk_bf16_f32 v248, v248, v249
  v_cvt_pk_bf16_f32 v249, v250, v251
  v_mfma_f32_16x16x32_bf16 v[188:191], a[232:235], a[140:143], v[188:191]
  v_cvt_pk_bf16_f32 v250, v252, v253
  v_cvt_pk_bf16_f32 v251, v254, v255
  v_mfma_f32_16x16x32_bf16 v[188:191], a[236:239], a[156:159], v[188:191]
  s_waitcnt lgkmcnt(0)
  s_add_u32 s52, s70, 28672
  v_accvgpr_write_b32 a0, v64
  v_accvgpr_write_b32 a1, v65
  v_mfma_f32_16x16x32_bf16 v[196:199], a[240:243], a[96:99], 0
  ds_read_b64_tr_b16 a[224:225], v12 offset:0
  buffer_load_dwordx4 a[208:211], v15, s[28:31], s52 offen offset:0 sc1
  v_mfma_f32_16x16x32_bf16 v[196:199], a[244:247], a[112:115], v[196:199]
  ds_read_b64_tr_b16 a[226:227], v12 offset:1024
  v_accvgpr_write_b32 a2, v66
  v_mfma_f32_16x16x32_bf16 v[196:199], a[248:251], a[128:131], v[196:199]
  ds_read_b64_tr_b16 a[228:229], v12 offset:8192
  v_accvgpr_write_b32 a3, v67
  v_mfma_f32_16x16x32_bf16 v[196:199], a[252:255], a[144:147], v[196:199]
  ds_read_b64_tr_b16 a[230:231], v12 offset:9216
  v_accvgpr_write_b32 a4, v68
  v_mfma_f32_16x16x32_bf16 v[204:207], a[240:243], a[100:103], 0
  ds_read_b64_tr_b16 a[232:233], v12 offset:16384
  v_accvgpr_write_b32 a5, v69
  v_mfma_f32_16x16x32_bf16 v[204:207], a[244:247], a[116:119], v[204:207]
  ds_read_b64_tr_b16 a[234:235], v12 offset:17408
  buffer_load_dwordx4 a[212:215], v15, s[28:31], s52 offen offset:1024 sc1
  v_mfma_f32_16x16x32_bf16 v[204:207], a[248:251], a[132:135], v[204:207]
  ds_read_b64_tr_b16 a[236:237], v12 offset:24576
  v_accvgpr_write_b32 a6, v70
  v_mfma_f32_16x16x32_bf16 v[204:207], a[252:255], a[148:151], v[204:207]
  ds_read_b64_tr_b16 a[238:239], v12 offset:25600
  v_accvgpr_write_b32 a7, v71
  v_mfma_f32_16x16x32_bf16 v[212:215], a[240:243], a[104:107], 0
  v_accvgpr_write_b32 a8, v72
  v_accvgpr_write_b32 a9, v73
  v_mfma_f32_16x16x32_bf16 v[212:215], a[244:247], a[120:123], v[212:215]
  v_accvgpr_write_b32 a10, v74
  v_accvgpr_write_b32 a11, v75
  v_mfma_f32_16x16x32_bf16 v[212:215], a[248:251], a[136:139], v[212:215]
  buffer_load_dwordx4 a[216:219], v15, s[28:31], s52 offen offset:2048 sc1
  v_mfma_f32_16x16x32_bf16 v[212:215], a[252:255], a[152:155], v[212:215]
  v_accvgpr_write_b32 a12, v76
  v_accvgpr_write_b32 a13, v77
  v_mfma_f32_16x16x32_bf16 v[220:223], a[240:243], a[108:111], 0
  v_accvgpr_write_b32 a14, v78
  v_accvgpr_write_b32 a15, v79
  v_mfma_f32_16x16x32_bf16 v[220:223], a[244:247], a[124:127], v[220:223]
  v_mfma_f32_16x16x32_bf16 v[220:223], a[248:251], a[140:143], v[220:223]
  v_mfma_f32_16x16x32_bf16 v[220:223], a[252:255], a[156:159], v[220:223]
  s_waitcnt lgkmcnt(0)
  buffer_load_dwordx4 a[220:223], v15, s[28:31], s52 offen offset:3072 sc1
  v_mfma_f32_16x16x32_bf16 v[228:231], a[224:227], a[96:99], 0
  s_add_u32 s53, s38, 1024
  ds_read_b64_tr_b16 a[240:241], v13 offset:0
  v_mfma_f32_16x16x32_bf16 v[228:231], a[228:231], a[112:115], v[228:231]
  ds_read_b64_tr_b16 a[242:243], v13 offset:1024
  buffer_store_dwordx4 v[112:115], v15, s[28:31], s53 offen sc1
  v_mfma_f32_16x16x32_bf16 v[228:231], a[232:235], a[128:131], v[228:231]
  ds_read_b64_tr_b16 a[244:245], v13 offset:8192
  v_mfma_f32_16x16x32_bf16 v[228:231], a[236:239], a[144:147], v[228:231]
  ds_read_b64_tr_b16 a[246:247], v13 offset:9216
  v_mfma_f32_16x16x32_bf16 v[236:239], a[224:227], a[100:103], 0
  ds_read_b64_tr_b16 a[248:249], v13 offset:16384
  v_mfma_f32_16x16x32_bf16 v[236:239], a[228:231], a[116:119], v[236:239]
  ds_read_b64_tr_b16 a[250:251], v13 offset:17408
  v_mfma_f32_16x16x32_bf16 v[236:239], a[232:235], a[132:135], v[236:239]
  ds_read_b64_tr_b16 a[252:253], v13 offset:24576
  v_mfma_f32_16x16x32_bf16 v[236:239], a[236:239], a[148:151], v[236:239]
  ds_read_b64_tr_b16 a[254:255], v13 offset:25600
  v_mfma_f32_16x16x32_bf16 v[244:247], a[224:227], a[104:107], 0
  v_mfma_f32_16x16x32_bf16 v[244:247], a[228:231], a[120:123], v[244:247]
  v_mfma_f32_16x16x32_bf16 v[244:247], a[232:235], a[136:139], v[244:247]
  v_mfma_f32_16x16x32_bf16 v[244:247], a[236:239], a[152:155], v[244:247]
  v_mfma_f32_16x16x32_bf16 v[252:255], a[224:227], a[108:111], 0
  v_mfma_f32_16x16x32_bf16 v[252:255], a[228:231], a[124:127], v[252:255]
  v_mfma_f32_16x16x32_bf16 v[252:255], a[232:235], a[140:143], v[252:255]
  v_mfma_f32_16x16x32_bf16 v[252:255], a[236:239], a[156:159], v[252:255]
  s_waitcnt lgkmcnt(0)
  v_mfma_f32_16x16x32_bf16 v[64:67], a[240:243], a[96:99], 0
  ds_read_b64_tr_b16 a[224:225], v14 offset:0
  v_mfma_f32_16x16x32_bf16 v[64:67], a[244:247], a[112:115], v[64:67]
  ds_read_b64_tr_b16 a[226:227], v14 offset:1024
  v_mfma_f32_16x16x32_bf16 v[64:67], a[248:251], a[128:131], v[64:67]
  ds_read_b64_tr_b16 a[228:229], v14 offset:8192
  v_mfma_f32_16x16x32_bf16 v[64:67], a[252:255], a[144:147], v[64:67]
  ds_read_b64_tr_b16 a[230:231], v14 offset:9216
  v_mfma_f32_16x16x32_bf16 v[68:71], a[240:243], a[100:103], 0
  ds_read_b64_tr_b16 a[232:233], v14 offset:16384
  v_mfma_f32_16x16x32_bf16 v[68:71], a[244:247], a[116:119], v[68:71]
  ds_read_b64_tr_b16 a[234:235], v14 offset:17408
  v_mfma_f32_16x16x32_bf16 v[68:71], a[248:251], a[132:135], v[68:71]
  s_add_u32 s53, s38, 5120
  ds_read_b64_tr_b16 a[236:237], v14 offset:24576
  v_mfma_f32_16x16x32_bf16 v[68:71], a[252:255], a[148:151], v[68:71]
  ds_read_b64_tr_b16 a[238:239], v14 offset:25600
  v_mfma_f32_16x16x32_bf16 v[72:75], a[240:243], a[104:107], 0
  buffer_store_dwordx4 v[116:119], v15, s[28:31], s53 offen sc1
  v_mfma_f32_16x16x32_bf16 v[72:75], a[244:247], a[120:123], v[72:75]
  v_mfma_f32_16x16x32_bf16 v[72:75], a[248:251], a[136:139], v[72:75]
  v_mfma_f32_16x16x32_bf16 v[72:75], a[252:255], a[152:155], v[72:75]
  v_mfma_f32_16x16x32_bf16 v[76:79], a[240:243], a[108:111], 0
  v_mfma_f32_16x16x32_bf16 v[76:79], a[244:247], a[124:127], v[76:79]
  v_mfma_f32_16x16x32_bf16 v[76:79], a[248:251], a[140:143], v[76:79]
  v_mfma_f32_16x16x32_bf16 v[76:79], a[252:255], a[156:159], v[76:79]
  s_waitcnt lgkmcnt(0)
  s_barrier
  v_mfma_f32_16x16x32_bf16 v[80:83], a[224:227], a[96:99], 0
  ds_read_b64_tr_b16 a[240:241], v7 offset:32768
  v_mfma_f32_16x16x32_bf16 v[80:83], a[228:231], a[112:115], v[80:83]
  ds_read_b64_tr_b16 a[242:243], v7 offset:33792
  v_mfma_f32_16x16x32_bf16 v[80:83], a[232:235], a[128:131], v[80:83]
  ds_read_b64_tr_b16 a[244:245], v7 offset:40960
  v_mfma_f32_16x16x32_bf16 v[80:83], a[236:239], a[144:147], v[80:83]
  ds_read_b64_tr_b16 a[246:247], v7 offset:41984
  v_mfma_f32_16x16x32_bf16 v[84:87], a[224:227], a[100:103], 0
  ds_read_b64_tr_b16 a[248:249], v7 offset:49152
  v_mfma_f32_16x16x32_bf16 v[84:87], a[228:231], a[116:119], v[84:87]
  ds_read_b64_tr_b16 a[250:251], v7 offset:50176
  v_mfma_f32_16x16x32_bf16 v[84:87], a[232:235], a[132:135], v[84:87]
  ds_read_b64_tr_b16 a[252:253], v7 offset:57344
  v_mfma_f32_16x16x32_bf16 v[84:87], a[236:239], a[148:151], v[84:87]
  ds_read_b64_tr_b16 a[254:255], v7 offset:58368
  v_mfma_f32_16x16x32_bf16 v[88:91], a[224:227], a[104:107], 0
  v_mfma_f32_16x16x32_bf16 v[88:91], a[228:231], a[120:123], v[88:91]
  v_mfma_f32_16x16x32_bf16 v[88:91], a[232:235], a[136:139], v[88:91]
  v_mfma_f32_16x16x32_bf16 v[88:91], a[236:239], a[152:155], v[88:91]
  v_mfma_f32_16x16x32_bf16 v[92:95], a[224:227], a[108:111], 0
  v_mfma_f32_16x16x32_bf16 v[92:95], a[228:231], a[124:127], v[92:95]
  v_mfma_f32_16x16x32_bf16 v[92:95], a[232:235], a[140:143], v[92:95]
  v_mfma_f32_16x16x32_bf16 v[92:95], a[236:239], a[156:159], v[92:95]
  s_waitcnt vmcnt(2) lgkmcnt(0)
  v_mfma_f32_16x16x32_bf16 v[32:35], a[240:243], a[160:163], v[32:35]
  s_add_u32 m0, s56, 65536
  ds_read_b64_tr_b16 a[224:225], v8 offset:32768
  v_mfma_f32_16x16x32_bf16 v[32:35], a[244:247], a[176:179], v[32:35]
  s_add_u32 s51, s82, 3145728
  ds_read_b64_tr_b16 a[226:227], v8 offset:33792
  v_mfma_f32_16x16x32_bf16 v[32:35], a[248:251], a[192:195], v[32:35]
  ds_read_b64_tr_b16 a[228:229], v8 offset:40960
  buffer_load_dwordx4 v3, s[16:19], s51 offen lds
  v_mfma_f32_16x16x32_bf16 v[32:35], a[252:255], a[208:211], v[32:35]
  s_add_u32 m0, s56, 66560
  ds_read_b64_tr_b16 a[230:231], v8 offset:41984
  v_mfma_f32_16x16x32_bf16 v[36:39], a[240:243], a[164:167], v[36:39]
  s_add_u32 s51, s82, 3178496
  ds_read_b64_tr_b16 a[232:233], v8 offset:49152
  v_mfma_f32_16x16x32_bf16 v[36:39], a[244:247], a[180:183], v[36:39]
  ds_read_b64_tr_b16 a[234:235], v8 offset:50176
  buffer_load_dwordx4 v3, s[16:19], s51 offen lds
  v_mfma_f32_16x16x32_bf16 v[36:39], a[248:251], a[196:199], v[36:39]
  s_add_u32 m0, s56, 67584
  ds_read_b64_tr_b16 a[236:237], v8 offset:57344
  v_mfma_f32_16x16x32_bf16 v[36:39], a[252:255], a[212:215], v[36:39]
  s_add_u32 s51, s82, 3211264
  ds_read_b64_tr_b16 a[238:239], v8 offset:58368
  v_mfma_f32_16x16x32_bf16 v[40:43], a[240:243], a[168:171], v[40:43]
  buffer_load_dwordx4 v4, s[16:19], s51 offen lds
  v_xor_b32 v7, 0x30000, v7
  v_xor_b32 v8, 0x30000, v8
  v_mfma_f32_16x16x32_bf16 v[40:43], a[244:247], a[184:187], v[40:43]
  s_add_u32 m0, s56, 68608
  ds_write_b128 v21, v[96:99] offset:1024
  v_mfma_f32_16x16x32_bf16 v[40:43], a[248:251], a[200:203], v[40:43]
  s_add_u32 s51, s82, 3244032
  v_mfma_f32_16x16x32_bf16 v[40:43], a[252:255], a[216:219], v[40:43]
  buffer_load_dwordx4 v4, s[16:19], s51 offen lds
  v_mfma_f32_16x16x32_bf16 v[44:47], a[240:243], a[172:175], v[44:47]
  ds_write_b128 v21, v[100:103] offset:5120
  v_mfma_f32_16x16x32_bf16 v[44:47], a[244:247], a[188:191], v[44:47]
  s_add_u32 m0, s56, 69632
  v_mfma_f32_16x16x32_bf16 v[44:47], a[248:251], a[204:207], v[44:47]
  s_add_u32 s51, s82, 3276800
  v_mfma_f32_16x16x32_bf16 v[44:47], a[252:255], a[220:223], v[44:47]
  s_waitcnt lgkmcnt(2)
  ds_write_b128 v22, v[104:107] offset:1024
  buffer_load_dwordx4 v3, s[16:19], s51 offen lds
  v_mfma_f32_16x16x32_bf16 v[48:51], a[224:227], a[160:163], v[48:51]
  ds_read_b64_tr_b16 a[240:241], v9 offset:32768
  v_mfma_f32_16x16x32_bf16 v[48:51], a[228:231], a[176:179], v[48:51]
  s_add_u32 m0, s56, 70656
  ds_read_b64_tr_b16 a[242:243], v9 offset:33792
  v_mfma_f32_16x16x32_bf16 v[48:51], a[232:235], a[192:195], v[48:51]
  s_add_u32 s51, s82, 3309568
  ds_read_b64_tr_b16 a[244:245], v9 offset:40960
  v_mfma_f32_16x16x32_bf16 v[48:51], a[236:239], a[208:211], v[48:51]
  ds_read_b64_tr_b16 a[246:247], v9 offset:41984
  buffer_load_dwordx4 v3, s[16:19], s51 offen lds
  v_mfma_f32_16x16x32_bf16 v[52:55], a[224:227], a[164:167], v[52:55]
  ds_read_b64_tr_b16 a[248:249], v9 offset:49152
  v_mfma_f32_16x16x32_bf16 v[52:55], a[228:231], a[180:183], v[52:55]
  s_add_u32 s52, s70, 32768
  ds_read_b64_tr_b16 a[250:251], v9 offset:50176
  v_mfma_f32_16x16x32_bf16 v[52:55], a[232:235], a[196:199], v[52:55]
  ds_read_b64_tr_b16 a[252:253], v9 offset:57344
  buffer_load_dwordx4 a[96:99], v15, s[28:31], s52 offen offset:0 sc1
  v_mfma_f32_16x16x32_bf16 v[52:55], a[236:239], a[212:215], v[52:55]
  ds_read_b64_tr_b16 a[254:255], v9 offset:58368
  v_mfma_f32_16x16x32_bf16 v[56:59], a[224:227], a[168:171], v[56:59]
  ds_write_b128 v22, v[108:111] offset:5120
  v_xor_b32 v9, 0x30000, v9
  v_mfma_f32_16x16x32_bf16 v[56:59], a[228:231], a[184:187], v[56:59]
  v_mfma_f32_16x16x32_bf16 v[56:59], a[232:235], a[200:203], v[56:59]
  buffer_load_dwordx4 a[100:103], v15, s[28:31], s52 offen offset:1024 sc1
  v_mfma_f32_16x16x32_bf16 v[56:59], a[236:239], a[216:219], v[56:59]
  ds_write_b128 v21, v[112:115] offset:33792
  v_mfma_f32_16x16x32_bf16 v[60:63], a[224:227], a[172:175], v[60:63]
  v_mfma_f32_16x16x32_bf16 v[60:63], a[228:231], a[188:191], v[60:63]
  v_mfma_f32_16x16x32_bf16 v[60:63], a[232:235], a[204:207], v[60:63]
  ds_write_b128 v21, v[116:119] offset:37888
  v_mfma_f32_16x16x32_bf16 v[60:63], a[236:239], a[220:223], v[60:63]
  s_waitcnt lgkmcnt(3)
  buffer_load_dwordx4 a[104:107], v15, s[28:31], s52 offen offset:2048 sc1
  v_mfma_f32_16x16x32_bf16 v[132:135], a[240:243], a[160:163], v[132:135]
  ds_read_b64_tr_b16 a[224:225], v10 offset:32768
  v_mfma_f32_16x16x32_bf16 v[132:135], a[244:247], a[176:179], v[132:135]
  ds_read_b64_tr_b16 a[226:227], v10 offset:33792
  v_mfma_f32_16x16x32_bf16 v[132:135], a[248:251], a[192:195], v[132:135]
  ds_read_b64_tr_b16 a[228:229], v10 offset:40960
  buffer_load_dwordx4 a[108:111], v15, s[28:31], s52 offen offset:3072 sc1
  v_mfma_f32_16x16x32_bf16 v[132:135], a[252:255], a[208:211], v[132:135]
  ds_read_b64_tr_b16 a[230:231], v10 offset:41984
  v_mfma_f32_16x16x32_bf16 v[140:143], a[240:243], a[164:167], v[140:143]
  ds_read_b64_tr_b16 a[232:233], v10 offset:49152
  v_mfma_f32_16x16x32_bf16 v[140:143], a[244:247], a[180:183], v[140:143]
  s_add_u32 s52, s70, 36864
  ds_read_b64_tr_b16 a[234:235], v10 offset:50176
  v_mfma_f32_16x16x32_bf16 v[140:143], a[248:251], a[196:199], v[140:143]
  ds_read_b64_tr_b16 a[236:237], v10 offset:57344
  buffer_load_dwordx4 a[112:115], v15, s[28:31], s52 offen offset:0 sc1
  v_mfma_f32_16x16x32_bf16 v[140:143], a[252:255], a[212:215], v[140:143]
  ds_read_b64_tr_b16 a[238:239], v10 offset:58368
  v_mfma_f32_16x16x32_bf16 v[148:151], a[240:243], a[168:171], v[148:151]
  ds_write_b128 v22, v[120:123] offset:33792
  v_xor_b32 v10, 0x30000, v10
  v_mfma_f32_16x16x32_bf16 v[148:151], a[244:247], a[184:187], v[148:151]
  v_mfma_f32_16x16x32_bf16 v[148:151], a[248:251], a[200:203], v[148:151]
  buffer_load_dwordx4 a[116:119], v15, s[28:31], s52 offen offset:1024 sc1
  v_mfma_f32_16x16x32_bf16 v[148:151], a[252:255], a[216:219], v[148:151]
  ds_write_b128 v22, v[124:127] offset:37888
  v_mfma_f32_16x16x32_bf16 v[156:159], a[240:243], a[172:175], v[156:159]
  v_mfma_f32_16x16x32_bf16 v[156:159], a[244:247], a[188:191], v[156:159]
  buffer_load_dwordx4 a[120:123], v15, s[28:31], s52 offen offset:2048 sc1
  v_mfma_f32_16x16x32_bf16 v[156:159], a[248:251], a[204:207], v[156:159]
  v_mfma_f32_16x16x32_bf16 v[156:159], a[252:255], a[220:223], v[156:159]
  s_waitcnt lgkmcnt(2)
  v_mfma_f32_16x16x32_bf16 v[164:167], a[224:227], a[160:163], v[164:167]
  ds_read_b64_tr_b16 a[240:241], v11 offset:32768
  v_mfma_f32_16x16x32_bf16 v[164:167], a[228:231], a[176:179], v[164:167]
  ds_read_b64_tr_b16 a[242:243], v11 offset:33792
  buffer_load_dwordx4 a[124:127], v15, s[28:31], s52 offen offset:3072 sc1
  v_mfma_f32_16x16x32_bf16 v[164:167], a[232:235], a[192:195], v[164:167]
  ds_read_b64_tr_b16 a[244:245], v11 offset:40960
  v_mfma_f32_16x16x32_bf16 v[164:167], a[236:239], a[208:211], v[164:167]
  ds_read_b64_tr_b16 a[246:247], v11 offset:41984
  v_mfma_f32_16x16x32_bf16 v[172:175], a[224:227], a[164:167], v[172:175]
  s_add_u32 s52, s70, 40960
  ds_read_b64_tr_b16 a[248:249], v11 offset:49152
  v_mfma_f32_16x16x32_bf16 v[172:175], a[228:231], a[180:183], v[172:175]
  ds_read_b64_tr_b16 a[250:251], v11 offset:50176
  buffer_load_dwordx4 a[128:131], v15, s[28:31], s52 offen offset:0 sc1
  v_mfma_f32_16x16x32_bf16 v[172:175], a[232:235], a[196:199], v[172:175]
  ds_read_b64_tr_b16 a[252:253], v11 offset:57344
  v_mfma_f32_16x16x32_bf16 v[172:175], a[236:239], a[212:215], v[172:175]
  ds_read_b64_tr_b16 a[254:255], v11 offset:58368
  v_mfma_f32_16x16x32_bf16 v[180:183], a[224:227], a[168:171], v[180:183]
  v_xor_b32 v11, 0x30000, v11
  v_mfma_f32_16x16x32_bf16 v[180:183], a[228:231], a[184:187], v[180:183]
  buffer_load_dwordx4 a[132:135], v15, s[28:31], s52 offen offset:1024 sc1
  v_mfma_f32_16x16x32_bf16 v[180:183], a[232:235], a[200:203], v[180:183]
  v_mfma_f32_16x16x32_bf16 v[180:183], a[236:239], a[216:219], v[180:183]
  v_mfma_f32_16x16x32_bf16 v[188:191], a[224:227], a[172:175], v[188:191]
  v_mfma_f32_16x16x32_bf16 v[188:191], a[228:231], a[188:191], v[188:191]
  buffer_load_dwordx4 a[136:139], v15, s[28:31], s52 offen offset:2048 sc1
  v_mfma_f32_16x16x32_bf16 v[188:191], a[232:235], a[204:207], v[188:191]
  v_mfma_f32_16x16x32_bf16 v[188:191], a[236:239], a[220:223], v[188:191]
  s_waitcnt lgkmcnt(0)
  v_mfma_f32_16x16x32_bf16 v[196:199], a[240:243], a[160:163], v[196:199]
  ds_read_b64_tr_b16 a[224:225], v12 offset:32768
  buffer_load_dwordx4 a[140:143], v15, s[28:31], s52 offen offset:3072 sc1
  v_mfma_f32_16x16x32_bf16 v[196:199], a[244:247], a[176:179], v[196:199]
  ds_read_b64_tr_b16 a[226:227], v12 offset:33792
  v_mfma_f32_16x16x32_bf16 v[196:199], a[248:251], a[192:195], v[196:199]
  ds_read_b64_tr_b16 a[228:229], v12 offset:40960
  v_mfma_f32_16x16x32_bf16 v[196:199], a[252:255], a[208:211], v[196:199]
  s_add_u32 s52, s70, 45056
  ds_read_b64_tr_b16 a[230:231], v12 offset:41984
  v_mfma_f32_16x16x32_bf16 v[204:207], a[240:243], a[164:167], v[204:207]
  ds_read_b64_tr_b16 a[232:233], v12 offset:49152
  buffer_load_dwordx4 a[144:147], v15, s[28:31], s52 offen offset:0 sc1
  v_mfma_f32_16x16x32_bf16 v[204:207], a[244:247], a[180:183], v[204:207]
  ds_read_b64_tr_b16 a[234:235], v12 offset:50176
  v_mfma_f32_16x16x32_bf16 v[204:207], a[248:251], a[196:199], v[204:207]
  ds_read_b64_tr_b16 a[236:237], v12 offset:57344
  v_mfma_f32_16x16x32_bf16 v[204:207], a[252:255], a[212:215], v[204:207]
  ds_read_b64_tr_b16 a[238:239], v12 offset:58368
  v_mfma_f32_16x16x32_bf16 v[212:215], a[240:243], a[168:171], v[212:215]
  v_xor_b32 v12, 0x30000, v12
  v_mfma_f32_16x16x32_bf16 v[212:215], a[244:247], a[184:187], v[212:215]
  buffer_load_dwordx4 a[148:151], v15, s[28:31], s52 offen offset:1024 sc1
  v_mfma_f32_16x16x32_bf16 v[212:215], a[248:251], a[200:203], v[212:215]
  v_mfma_f32_16x16x32_bf16 v[212:215], a[252:255], a[216:219], v[212:215]
  v_mfma_f32_16x16x32_bf16 v[220:223], a[240:243], a[172:175], v[220:223]
  buffer_load_dwordx4 a[152:155], v15, s[28:31], s52 offen offset:2048 sc1
  v_mfma_f32_16x16x32_bf16 v[220:223], a[244:247], a[188:191], v[220:223]
  v_mfma_f32_16x16x32_bf16 v[220:223], a[248:251], a[204:207], v[220:223]
  v_mfma_f32_16x16x32_bf16 v[220:223], a[252:255], a[220:223], v[220:223]
  s_waitcnt lgkmcnt(0)
  v_mfma_f32_16x16x32_bf16 v[228:231], a[224:227], a[160:163], v[228:231]
  ds_read_b64_tr_b16 a[240:241], v13 offset:32768
  buffer_load_dwordx4 a[156:159], v15, s[28:31], s52 offen offset:3072 sc1
  v_mfma_f32_16x16x32_bf16 v[228:231], a[228:231], a[176:179], v[228:231]
  s_add_u32 s53, s39, 1024
  ds_read_b64_tr_b16 a[242:243], v13 offset:33792
  v_mfma_f32_16x16x32_bf16 v[228:231], a[232:235], a[192:195], v[228:231]
  ds_read_b64_tr_b16 a[244:245], v13 offset:40960
  buffer_store_dwordx4 v[120:123], v15, s[28:31], s53 offen sc1
  v_mfma_f32_16x16x32_bf16 v[228:231], a[236:239], a[208:211], v[228:231]
  ds_read_b64_tr_b16 a[246:247], v13 offset:41984
  v_mfma_f32_16x16x32_bf16 v[236:239], a[224:227], a[164:167], v[236:239]
  ds_read_b64_tr_b16 a[248:249], v13 offset:49152
  v_mfma_f32_16x16x32_bf16 v[236:239], a[228:231], a[180:183], v[236:239]
  ds_read_b64_tr_b16 a[250:251], v13 offset:50176
  v_mfma_f32_16x16x32_bf16 v[236:239], a[232:235], a[196:199], v[236:239]
  ds_read_b64_tr_b16 a[252:253], v13 offset:57344
  v_mfma_f32_16x16x32_bf16 v[236:239], a[236:239], a[212:215], v[236:239]
  ds_read_b64_tr_b16 a[254:255], v13 offset:58368
  v_mfma_f32_16x16x32_bf16 v[244:247], a[224:227], a[168:171], v[244:247]
  v_xor_b32 v13, 0x30000, v13
  v_mfma_f32_16x16x32_bf16 v[244:247], a[228:231], a[184:187], v[244:247]
  v_mfma_f32_16x16x32_bf16 v[244:247], a[232:235], a[200:203], v[244:247]
  v_mfma_f32_16x16x32_bf16 v[244:247], a[236:239], a[216:219], v[244:247]
  s_add_u32 s53, s39, 5120
  v_mfma_f32_16x16x32_bf16 v[252:255], a[224:227], a[172:175], v[252:255]
  buffer_store_dwordx4 v[124:127], v15, s[28:31], s53 offen sc1
  v_mfma_f32_16x16x32_bf16 v[252:255], a[228:231], a[188:191], v[252:255]
  v_mfma_f32_16x16x32_bf16 v[252:255], a[232:235], a[204:207], v[252:255]
  v_mfma_f32_16x16x32_bf16 v[252:255], a[236:239], a[220:223], v[252:255]
  s_waitcnt lgkmcnt(0)
  v_mfma_f32_16x16x32_bf16 v[64:67], a[240:243], a[160:163], v[64:67]
  ds_read_b64_tr_b16 a[224:225], v14 offset:32768
  v_mfma_f32_16x16x32_bf16 v[64:67], a[244:247], a[176:179], v[64:67]
  ds_read_b64_tr_b16 a[226:227], v14 offset:33792
  v_mfma_f32_16x16x32_bf16 v[64:67], a[248:251], a[192:195], v[64:67]
  ds_read_b64_tr_b16 a[228:229], v14 offset:40960
  v_mfma_f32_16x16x32_bf16 v[64:67], a[252:255], a[208:211], v[64:67]
  ds_read_b64_tr_b16 a[230:231], v14 offset:41984
  v_mfma_f32_16x16x32_bf16 v[68:71], a[240:243], a[164:167], v[68:71]
  ds_read_b64_tr_b16 a[232:233], v14 offset:49152
  v_mfma_f32_16x16x32_bf16 v[68:71], a[244:247], a[180:183], v[68:71]
  ds_read_b64_tr_b16 a[234:235], v14 offset:50176
  v_mfma_f32_16x16x32_bf16 v[68:71], a[248:251], a[196:199], v[68:71]
  s_add_u32 s53, s42, 0
  ds_read_b64_tr_b16 a[236:237], v14 offset:57344
  v_mfma_f32_16x16x32_bf16 v[68:71], a[252:255], a[212:215], v[68:71]
  ds_read_b64_tr_b16 a[238:239], v14 offset:58368
  v_mfma_f32_16x16x32_bf16 v[72:75], a[240:243], a[168:171], v[72:75]
  buffer_store_dwordx4 v[144:147], v15, s[28:31], s53 offen sc1
  v_xor_b32 v14, 0x30000, v14
  v_mfma_f32_16x16x32_bf16 v[72:75], a[244:247], a[184:187], v[72:75]
  v_mfma_f32_16x16x32_bf16 v[72:75], a[248:251], a[200:203], v[72:75]
  v_mfma_f32_16x16x32_bf16 v[72:75], a[252:255], a[216:219], v[72:75]
  v_mfma_f32_16x16x32_bf16 v[76:79], a[240:243], a[172:175], v[76:79]
  v_mfma_f32_16x16x32_bf16 v[76:79], a[244:247], a[188:191], v[76:79]
  v_mfma_f32_16x16x32_bf16 v[76:79], a[248:251], a[204:207], v[76:79]
  v_mfma_f32_16x16x32_bf16 v[76:79], a[252:255], a[220:223], v[76:79]
  s_waitcnt lgkmcnt(0)
  s_barrier
  v_mfma_f32_16x16x32_bf16 v[80:83], a[224:227], a[160:163], v[80:83]
  ds_read_b64_tr_b16 a[240:241], v7 offset:0
  v_mfma_f32_16x16x32_bf16 v[80:83], a[228:231], a[176:179], v[80:83]
  s_add_u32 s53, s43, 0
  ds_read_b64_tr_b16 a[242:243], v7 offset:1024
  v_mfma_f32_16x16x32_bf16 v[80:83], a[232:235], a[192:195], v[80:83]
  ds_read_b64_tr_b16 a[244:245], v7 offset:8192
  buffer_store_dwordx4 v[152:155], v15, s[28:31], s53 offen sc1
  v_mfma_f32_16x16x32_bf16 v[80:83], a[236:239], a[208:211], v[80:83]
  ds_read_b64_tr_b16 a[246:247], v7 offset:9216
  v_mfma_f32_16x16x32_bf16 v[84:87], a[224:227], a[164:167], v[84:87]
  ds_read_b64_tr_b16 a[248:249], v7 offset:16384
  v_mfma_f32_16x16x32_bf16 v[84:87], a[228:231], a[180:183], v[84:87]
  ds_read_b64_tr_b16 a[250:251], v7 offset:17408
  v_mfma_f32_16x16x32_bf16 v[84:87], a[232:235], a[196:199], v[84:87]
  ds_read_b64_tr_b16 a[252:253], v7 offset:24576
  v_mfma_f32_16x16x32_bf16 v[84:87], a[236:239], a[212:215], v[84:87]
  ds_read_b64_tr_b16 a[254:255], v7 offset:25600
  v_mfma_f32_16x16x32_bf16 v[88:91], a[224:227], a[168:171], v[88:91]
  v_mfma_f32_16x16x32_bf16 v[88:91], a[228:231], a[184:187], v[88:91]
  v_mfma_f32_16x16x32_bf16 v[88:91], a[232:235], a[200:203], v[88:91]
  v_mfma_f32_16x16x32_bf16 v[88:91], a[236:239], a[216:219], v[88:91]
  v_mfma_f32_16x16x32_bf16 v[92:95], a[224:227], a[172:175], v[92:95]
  v_mfma_f32_16x16x32_bf16 v[92:95], a[228:231], a[188:191], v[92:95]
  v_mfma_f32_16x16x32_bf16 v[92:95], a[232:235], a[204:207], v[92:95]
  v_mfma_f32_16x16x32_bf16 v[92:95], a[236:239], a[220:223], v[92:95]
  s_waitcnt vmcnt(4) lgkmcnt(0)
  v_mfma_f32_16x16x32_bf16 v[32:35], a[240:243], a[96:99], v[32:35]
  s_add_u32 m0, s56, 71680
  ds_read_b64_tr_b16 a[224:225], v8 offset:0
  v_mfma_f32_16x16x32_bf16 v[32:35], a[244:247], a[112:115], v[32:35]
  s_add_u32 s51, s82, 3342336
  ds_read_b64_tr_b16 a[226:227], v8 offset:1024
  v_mfma_f32_16x16x32_bf16 v[32:35], a[248:251], a[128:131], v[32:35]
  ds_read_b64_tr_b16 a[228:229], v8 offset:8192
  buffer_load_dwordx4 v4, s[16:19], s51 offen lds
  v_mfma_f32_16x16x32_bf16 v[32:35], a[252:255], a[144:147], v[32:35]
  s_add_u32 m0, s56, 72704
  ds_read_b64_tr_b16 a[230:231], v8 offset:9216
  v_mfma_f32_16x16x32_bf16 v[36:39], a[240:243], a[100:103], v[36:39]
  s_add_u32 s51, s82, 3375104
  ds_read_b64_tr_b16 a[232:233], v8 offset:16384
  v_mfma_f32_16x16x32_bf16 v[36:39], a[244:247], a[116:119], v[36:39]
  ds_read_b64_tr_b16 a[234:235], v8 offset:17408
  buffer_load_dwordx4 v4, s[16:19], s51 offen lds
  v_mfma_f32_16x16x32_bf16 v[36:39], a[248:251], a[132:135], v[36:39]
  s_add_u32 m0, s56, 98304
  ds_read_b64_tr_b16 a[236:237], v8 offset:24576
  v_mfma_f32_16x16x32_bf16 v[36:39], a[252:255], a[148:151], v[36:39]
HS5:
  s_cbranch_execz HS9
  s_add_u32 s51, s82, 4194304
  ds_read_b64_tr_b16 a[238:239], v8 offset:25600
  v_mfma_f32_16x16x32_bf16 v[40:43], a[240:243], a[104:107], v[40:43]
  v_xor_b32 v7, 0x30000, v7
  v_xor_b32 v8, 0x30000, v8
  v_mfma_f32_16x16x32_bf16 v[40:43], a[244:247], a[120:123], v[40:43]
  buffer_load_dwordx4 v3, s[16:19], s51 offen lds
  v_mfma_f32_16x16x32_bf16 v[40:43], a[248:251], a[136:139], v[40:43]
  s_add_u32 m0, s56, 99328
  v_mfma_f32_16x16x32_bf16 v[40:43], a[252:255], a[152:155], v[40:43]
  s_add_u32 s51, s82, 4227072
  v_mfma_f32_16x16x32_bf16 v[44:47], a[240:243], a[108:111], v[44:47]
  buffer_load_dwordx4 v3, s[16:19], s51 offen lds
  v_mfma_f32_16x16x32_bf16 v[44:47], a[244:247], a[124:127], v[44:47]
  v_mfma_f32_16x16x32_bf16 v[44:47], a[248:251], a[140:143], v[44:47]
  s_add_u32 m0, s56, 100352
  v_mfma_f32_16x16x32_bf16 v[44:47], a[252:255], a[156:159], v[44:47]
  s_waitcnt lgkmcnt(0)
  s_add_u32 s51, s82, 4259840
  v_mfma_f32_16x16x32_bf16 v[48:51], a[224:227], a[96:99], v[48:51]
  ds_read_b64_tr_b16 a[240:241], v9 offset:0
  buffer_load_dwordx4 v4, s[16:19], s51 offen lds
  v_mfma_f32_16x16x32_bf16 v[48:51], a[228:231], a[112:115], v[48:51]
  ds_read_b64_tr_b16 a[242:243], v9 offset:1024
  v_mfma_f32_16x16x32_bf16 v[48:51], a[232:235], a[128:131], v[48:51]
  ds_read_b64_tr_b16 a[244:245], v9 offset:8192
  v_mfma_f32_16x16x32_bf16 v[48:51], a[236:239], a[144:147], v[48:51]
  s_add_u32 s52, s70, 49152
  ds_read_b64_tr_b16 a[246:247], v9 offset:9216
  v_mfma_f32_16x16x32_bf16 v[52:55], a[224:227], a[100:103], v[52:55]
  ds_read_b64_tr_b16 a[248:249], v9 offset:16384
  buffer_load_dwordx4 a[160:163], v15, s[28:31], s52 offen offset:0 sc1
  v_mfma_f32_16x16x32_bf16 v[52:55], a[228:231], a[116:119], v[52:55]
  ds_read_b64_tr_b16 a[250:251], v9 offset:17408
  v_mfma_f32_16x16x32_bf16 v[52:55], a[232:235], a[132:135], v[52:55]
  ds_read_b64_tr_b16 a[252:253], v9 offset:24576
  v_mfma_f32_16x16x32_bf16 v[52:55], a[236:239], a[148:151], v[52:55]
  ds_read_b64_tr_b16 a[254:255], v9 offset:25600
  v_mfma_f32_16x16x32_bf16 v[56:59], a[224:227], a[104:107], v[56:59]
  v_xor_b32 v9, 0x30000, v9
  v_mfma_f32_16x16x32_bf16 v[56:59], a[228:231], a[120:123], v[56:59]
  buffer_load_dwordx4 a[164:167], v15, s[28:31], s52 offen offset:1024 sc1
  v_mfma_f32_16x16x32_bf16 v[56:59], a[232:235], a[136:139], v[56:59]
  v_mfma_f32_16x16x32_bf16 v[56:59], a[236:239], a[152:155], v[56:59]
  v_mfma_f32_16x16x32_bf16 v[60:63], a[224:227], a[108:111], v[60:63]
  buffer_load_dwordx4 a[168:171], v15, s[28:31], s52 offen offset:2048 sc1
  v_mfma_f32_16x16x32_bf16 v[60:63], a[228:231], a[124:127], v[60:63]
  v_mfma_f32_16x16x32_bf16 v[60:63], a[232:235], a[140:143], v[60:63]
  v_mfma_f32_16x16x32_bf16 v[60:63], a[236:239], a[156:159], v[60:63]
  s_waitcnt lgkmcnt(0)
  v_mfma_f32_16x16x32_bf16 v[132:135], a[240:243], a[96:99], v[132:135]
  ds_read_b64_tr_b16 a[224:225], v10 offset:0
  buffer_load_dwordx4 a[172:175], v15, s[28:31], s52 offen offset:3072 sc1
  v_mfma_f32_16x16x32_bf16 v[132:135], a[244:247], a[112:115], v[132:135]
  ds_read_b64_tr_b16 a[226:227], v10 offset:1024
  v_mfma_f32_16x16x32_bf16 v[132:135], a[248:251], a[128:131], v[132:135]
  ds_read_b64_tr_b16 a[228:229], v10 offset:8192
  v_mfma_f32_16x16x32_bf16 v[132:135], a[252:255], a[144:147], v[132:135]
  s_add_u32 s52, s70, 53248
  ds_read_b64_tr_b16 a[230:231], v10 offset:9216
  v_mfma_f32_16x16x32_bf16 v[140:143], a[240:243], a[100:103], v[140:143]
  ds_read_b64_tr_b16 a[232:233], v10 offset:16384
  buffer_load_dwordx4 a[176:179], v15, s[28:31], s52 offen offset:0 sc1
  v_mfma_f32_16x16x32_bf16 v[140:143], a[244:247], a[116:119], v[140:143]
  ds_read_b64_tr_b16 a[234:235], v10 offset:17408
  v_mfma_f32_16x16x32_bf16 v[140:143], a[248:251], a[132:135], v[140:143]
  ds_read_b64_tr_b16 a[236:237], v10 offset:24576
  v_mfma_f32_16x16x32_bf16 v[140:143], a[252:255], a[148:151], v[140:143]
  ds_read_b64_tr_b16 a[238:239], v10 offset:25600
  v_mfma_f32_16x16x32_bf16 v[148:151], a[240:243], a[104:107], v[148:151]
  v_xor_b32 v10, 0x30000, v10
  v_mfma_f32_16x16x32_bf16 v[148:151], a[244:247], a[120:123], v[148:151]
  buffer_load_dwordx4 a[180:183], v15, s[28:31], s52 offen offset:1024 sc1
  v_mfma_f32_16x16x32_bf16 v[148:151], a[248:251], a[136:139], v[148:151]
  v_mfma_f32_16x16x32_bf16 v[148:151], a[252:255], a[152:155], v[148:151]
  v_mfma_f32_16x16x32_bf16 v[156:159], a[240:243], a[108:111], v[156:159]
  buffer_load_dwordx4 a[184:187], v15, s[28:31], s52 offen offset:2048 sc1
  v_mfma_f32_16x16x32_bf16 v[156:159], a[244:247], a[124:127], v[156:159]
  v_mfma_f32_16x16x32_bf16 v[156:159], a[248:251], a[140:143], v[156:159]
  v_mfma_f32_16x16x32_bf16 v[156:159], a[252:255], a[156:159], v[156:159]
  s_waitcnt lgkmcnt(0)
  v_mfma_f32_16x16x32_bf16 v[164:167], a[224:227], a[96:99], v[164:167]
  ds_read_b64_tr_b16 a[240:241], v11 offset:0
  buffer_load_dwordx4 a[188:191], v15, s[28:31], s52 offen offset:3072 sc1
  v_mfma_f32_16x16x32_bf16 v[164:167], a[228:231], a[112:115], v[164:167]
  ds_read_b64_tr_b16 a[242:243], v11 offset:1024
  v_mfma_f32_16x16x32_bf16 v[164:167], a[232:235], a[128:131], v[164:167]
  ds_read_b64_tr_b16 a[244:245], v11 offset:8192
  v_mfma_f32_16x16x32_bf16 v[164:167], a[236:239], a[144:147], v[164:167]
  s_add_u32 s52, s70, 57344
  ds_read_b64_tr_b16 a[246:247], v11 offset:9216
  v_mfma_f32_16x16x32_bf16 v[172:175], a[224:227], a[100:103], v[172:175]
  ds_read_b64_tr_b16 a[248:249], v11 offset:16384
  buffer_load_dwordx4 a[192:195], v15, s[28:31], s52 offen offset:0 sc1
  v_mfma_f32_16x16x32_bf16 v[172:175], a[228:231], a[116:119], v[172:175]
  ds_read_b64_tr_b16 a[250:251], v11 offset:17408
  v_mfma_f32_16x16x32_bf16 v[172:175], a[232:235], a[132:135], v[172:175]
  ds_read_b64_tr_b16 a[252:253], v11 offset:24576
  v_mfma_f32_16x16x32_bf16 v[172:175], a[236:239], a[148:151], v[172:175]
  ds_read_b64_tr_b16 a[254:255], v11 offset:25600
  v_mfma_f32_16x16x32_bf16 v[180:183], a[224:227], a[104:107], v[180:183]
  v_xor_b32 v11, 0x30000, v11
  v_mfma_f32_16x16x32_bf16 v[180:183], a[228:231], a[120:123], v[180:183]
  buffer_load_dwordx4 a[196:199], v15, s[28:31], s52 offen offset:1024 sc1
  v_mfma_f32_16x16x32_bf16 v[180:183], a[232:235], a[136:139], v[180:183]
  v_mfma_f32_16x16x32_bf16 v[180:183], a[236:239], a[152:155], v[180:183]
  v_mfma_f32_16x16x32_bf16 v[188:191], a[224:227], a[108:111], v[188:191]
  buffer_load_dwordx4 a[200:203], v15, s[28:31], s52 offen offset:2048 sc1
  v_mfma_f32_16x16x32_bf16 v[188:191], a[228:231], a[124:127], v[188:191]
  v_mfma_f32_16x16x32_bf16 v[188:191], a[232:235], a[140:143], v[188:191]
  v_mfma_f32_16x16x32_bf16 v[188:191], a[236:239], a[156:159], v[188:191]
  s_waitcnt lgkmcnt(0)
  v_mfma_f32_16x16x32_bf16 v[196:199], a[240:243], a[96:99], v[196:199]
  ds_read_b64_tr_b16 a[224:225], v12 offset:0
  buffer_load_dwordx4 a[204:207], v15, s[28:31], s52 offen offset:3072 sc1
  v_mfma_f32_16x16x32_bf16 v[196:199], a[244:247], a[112:115], v[196:199]
  ds_read_b64_tr_b16 a[226:227], v12 offset:1024
  v_mfma_f32_16x16x32_bf16 v[196:199], a[248:251], a[128:131], v[196:199]
  ds_read_b64_tr_b16 a[228:229], v12 offset:8192
  v_mfma_f32_16x16x32_bf16 v[196:199], a[252:255], a[144:147], v[196:199]
  s_add_u32 s52, s70, 61440
  ds_read_b64_tr_b16 a[230:231], v12 offset:9216
  v_mfma_f32_16x16x32_bf16 v[204:207], a[240:243], a[100:103], v[204:207]
  ds_read_b64_tr_b16 a[232:233], v12 offset:16384
  buffer_load_dwordx4 a[208:211], v15, s[28:31], s52 offen offset:0 sc1
  v_mfma_f32_16x16x32_bf16 v[204:207], a[244:247], a[116:119], v[204:207]
  ds_read_b64_tr_b16 a[234:235], v12 offset:17408
  v_mfma_f32_16x16x32_bf16 v[204:207], a[248:251], a[132:135], v[204:207]
  ds_read_b64_tr_b16 a[236:237], v12 offset:24576
  v_mfma_f32_16x16x32_bf16 v[204:207], a[252:255], a[148:151], v[204:207]
  ds_read_b64_tr_b16 a[238:239], v12 offset:25600
  v_mfma_f32_16x16x32_bf16 v[212:215], a[240:243], a[104:107], v[212:215]
  v_xor_b32 v12, 0x30000, v12
  v_mfma_f32_16x16x32_bf16 v[212:215], a[244:247], a[120:123], v[212:215]
  buffer_load_dwordx4 a[212:215], v15, s[28:31], s52 offen offset:1024 sc1
  v_mfma_f32_16x16x32_bf16 v[212:215], a[248:251], a[136:139], v[212:215]
  v_mfma_f32_16x16x32_bf16 v[212:215], a[252:255], a[152:155], v[212:215]
  v_mfma_f32_16x16x32_bf16 v[220:223], a[240:243], a[108:111], v[220:223]
  buffer_load_dwordx4 a[216:219], v15, s[28:31], s52 offen offset:2048 sc1
  v_mfma_f32_16x16x32_bf16 v[220:223], a[244:247], a[124:127], v[220:223]
  v_mfma_f32_16x16x32_bf16 v[220:223], a[248:251], a[140:143], v[220:223]
  v_mfma_f32_16x16x32_bf16 v[220:223], a[252:255], a[156:159], v[220:223]
  s_waitcnt lgkmcnt(0)
  v_mfma_f32_16x16x32_bf16 v[228:231], a[224:227], a[96:99], v[228:231]
  ds_read_b64_tr_b16 a[240:241], v13 offset:0
  buffer_load_dwordx4 a[220:223], v15, s[28:31], s52 offen offset:3072 sc1
  v_mfma_f32_16x16x32_bf16 v[228:231], a[228:231], a[112:115], v[228:231]
  s_add_u32 s53, s42, 2048
  ds_read_b64_tr_b16 a[242:243], v13 offset:1024
  v_mfma_f32_16x16x32_bf16 v[228:231], a[232:235], a[128:131], v[228:231]
  ds_read_b64_tr_b16 a[244:245], v13 offset:8192
  buffer_store_dwordx4 v[176:179], v15, s[28:31], s53 offen sc1
  v_mfma_f32_16x16x32_bf16 v[228:231], a[236:239], a[144:147], v[228:231]
  ds_read_b64_tr_b16 a[246:247], v13 offset:9216
  v_mfma_f32_16x16x32_bf16 v[236:239], a[224:227], a[100:103], v[236:239]
  ds_read_b64_tr_b16 a[248:249], v13 offset:16384
  v_mfma_f32_16x16x32_bf16 v[236:239], a[228:231], a[116:119], v[236:239]
  ds_read_b64_tr_b16 a[250:251], v13 offset:17408
  v_mfma_f32_16x16x32_bf16 v[236:239], a[232:235], a[132:135], v[236:239]
  ds_read_b64_tr_b16 a[252:253], v13 offset:24576
  v_mfma_f32_16x16x32_bf16 v[236:239], a[236:239], a[148:151], v[236:239]
  ds_read_b64_tr_b16 a[254:255], v13 offset:25600
  v_mfma_f32_16x16x32_bf16 v[244:247], a[224:227], a[104:107], v[244:247]
  v_xor_b32 v13, 0x30000, v13
  v_mfma_f32_16x16x32_bf16 v[244:247], a[228:231], a[120:123], v[244:247]
  v_mfma_f32_16x16x32_bf16 v[244:247], a[232:235], a[136:139], v[244:247]
  v_mfma_f32_16x16x32_bf16 v[244:247], a[236:239], a[152:155], v[244:247]
  v_mfma_f32_16x16x32_bf16 v[252:255], a[224:227], a[108:111], v[252:255]
  v_mfma_f32_16x16x32_bf16 v[252:255], a[228:231], a[124:127], v[252:255]
  v_mfma_f32_16x16x32_bf16 v[252:255], a[232:235], a[140:143], v[252:255]
  v_mfma_f32_16x16x32_bf16 v[252:255], a[236:239], a[156:159], v[252:255]
  s_waitcnt lgkmcnt(0)
  s_add_u32 s53, s43, 2048
  v_mfma_f32_16x16x32_bf16 v[64:67], a[240:243], a[96:99], v[64:67]
  ds_read_b64_tr_b16 a[224:225], v14 offset:0
  buffer_store_dwordx4 v[184:187], v15, s[28:31], s53 offen sc1
  v_mfma_f32_16x16x32_bf16 v[64:67], a[244:247], a[112:115], v[64:67]
  ds_read_b64_tr_b16 a[226:227], v14 offset:1024
  v_mfma_f32_16x16x32_bf16 v[64:67], a[248:251], a[128:131], v[64:67]
  ds_read_b64_tr_b16 a[228:229], v14 offset:8192
  v_mfma_f32_16x16x32_bf16 v[64:67], a[252:255], a[144:147], v[64:67]
  ds_read_b64_tr_b16 a[230:231], v14 offset:9216
  v_mfma_f32_16x16x32_bf16 v[68:71], a[240:243], a[100:103], v[68:71]
  ds_read_b64_tr_b16 a[232:233], v14 offset:16384
  v_mfma_f32_16x16x32_bf16 v[68:71], a[244:247], a[116:119], v[68:71]
  ds_read_b64_tr_b16 a[234:235], v14 offset:17408
  v_mfma_f32_16x16x32_bf16 v[68:71], a[248:251], a[132:135], v[68:71]
  ds_read_b64_tr_b16 a[236:237], v14 offset:24576
  v_mfma_f32_16x16x32_bf16 v[68:71], a[252:255], a[148:151], v[68:71]
  ds_read_b64_tr_b16 a[238:239], v14 offset:25600
  s_load_dwordx2 s[44:45], s[0:1], 40
  s_load_dwordx2 s[20:21], s[0:1], 56
  s_load_dwordx2 s[24:25], s[0:1], 80
  s_load_dwordx2 s[12:13], s[0:1], 64
  s_load_dwordx2 s[32:33], s[0:1], 0
  v_mfma_f32_16x16x32_bf16 v[72:75], a[240:243], a[104:107], v[72:75]
  v_xor_b32 v14, 0x30000, v14
  v_mfma_f32_16x16x32_bf16 v[72:75], a[244:247], a[120:123], v[72:75]
  v_mfma_f32_16x16x32_bf16 v[72:75], a[248:251], a[136:139], v[72:75]
  v_mfma_f32_16x16x32_bf16 v[72:75], a[252:255], a[152:155], v[72:75]
  v_mfma_f32_16x16x32_bf16 v[76:79], a[240:243], a[108:111], v[76:79]
  v_mfma_f32_16x16x32_bf16 v[76:79], a[244:247], a[124:127], v[76:79]
  v_mfma_f32_16x16x32_bf16 v[76:79], a[248:251], a[140:143], v[76:79]
  s_add_u32 s53, s42, 4096
  v_mfma_f32_16x16x32_bf16 v[76:79], a[252:255], a[156:159], v[76:79]
  s_waitcnt lgkmcnt(0)
  buffer_store_dwordx4 v[208:211], v15, s[28:31], s53 offen sc1
  s_waitcnt vmcnt(22) lgkmcnt(0)
  s_barrier
  v_mfma_f32_16x16x32_bf16 v[80:83], a[224:227], a[96:99], v[80:83]
  ds_read_b64_tr_b16 a[240:241], v7 offset:0
  v_mfma_f32_16x16x32_bf16 v[80:83], a[228:231], a[112:115], v[80:83]
  ds_read_b64_tr_b16 a[242:243], v7 offset:1024
  v_mfma_f32_16x16x32_bf16 v[80:83], a[232:235], a[128:131], v[80:83]
  ds_read_b64_tr_b16 a[244:245], v7 offset:8192
  v_mfma_f32_16x16x32_bf16 v[80:83], a[236:239], a[144:147], v[80:83]
  ds_read_b64_tr_b16 a[246:247], v7 offset:9216
  v_mfma_f32_16x16x32_bf16 v[84:87], a[224:227], a[100:103], v[84:87]
  ds_read_b64_tr_b16 a[248:249], v7 offset:16384
  v_mfma_f32_16x16x32_bf16 v[84:87], a[228:231], a[116:119], v[84:87]
  ds_read_b64_tr_b16 a[250:251], v7 offset:17408
  v_mfma_f32_16x16x32_bf16 v[84:87], a[232:235], a[132:135], v[84:87]
  ds_read_b64_tr_b16 a[252:253], v7 offset:24576
  v_mfma_f32_16x16x32_bf16 v[84:87], a[236:239], a[148:151], v[84:87]
  ds_read_b64_tr_b16 a[254:255], v7 offset:25600
  v_mfma_f32_16x16x32_bf16 v[88:91], a[224:227], a[104:107], v[88:91]
  v_mfma_f32_16x16x32_bf16 v[88:91], a[228:231], a[120:123], v[88:91]
  v_mfma_f32_16x16x32_bf16 v[88:91], a[232:235], a[136:139], v[88:91]
  v_mfma_f32_16x16x32_bf16 v[88:91], a[236:239], a[152:155], v[88:91]
  v_mfma_f32_16x16x32_bf16 v[92:95], a[224:227], a[108:111], v[92:95]
  v_mfma_f32_16x16x32_bf16 v[92:95], a[228:231], a[124:127], v[92:95]
  v_mfma_f32_16x16x32_bf16 v[92:95], a[232:235], a[140:143], v[92:95]
  v_mfma_f32_16x16x32_bf16 v[92:95], a[236:239], a[156:159], v[92:95]
  s_waitcnt vmcnt(3) lgkmcnt(0)
  v_mfma_f32_16x16x32_bf16 v[32:35], a[240:243], a[160:163], v[32:35]
  s_add_u32 m0, s56, 101376
  ds_read_b64_tr_b16 a[224:225], v8 offset:0
  v_mfma_f32_16x16x32_bf16 v[32:35], a[244:247], a[176:179], v[32:35]
  s_add_u32 s51, s82, 4292608
  ds_read_b64_tr_b16 a[226:227], v8 offset:1024
  v_mfma_f32_16x16x32_bf16 v[32:35], a[248:251], a[192:195], v[32:35]
  ds_read_b64_tr_b16 a[228:229], v8 offset:8192
  buffer_load_dwordx4 v4, s[16:19], s51 offen lds
  v_mfma_f32_16x16x32_bf16 v[32:35], a[252:255], a[208:211], v[32:35]
  s_add_u32 m0, s56, 102400
  ds_read_b64_tr_b16 a[230:231], v8 offset:9216
  v_mfma_f32_16x16x32_bf16 v[36:39], a[240:243], a[164:167], v[36:39]
  s_add_u32 s51, s82, 4325376
  ds_read_b64_tr_b16 a[232:233], v8 offset:16384
  v_mfma_f32_16x16x32_bf16 v[36:39], a[244:247], a[180:183], v[36:39]
  ds_read_b64_tr_b16 a[234:235], v8 offset:17408
  buffer_load_dwordx4 v3, s[16:19], s51 offen lds
  v_mfma_f32_16x16x32_bf16 v[36:39], a[248:251], a[196:199], v[36:39]
  s_add_u32 m0, s56, 103424
  ds_read_b64_tr_b16 a[236:237], v8 offset:24576
  v_mfma_f32_16x16x32_bf16 v[36:39], a[252:255], a[212:215], v[36:39]
  s_add_u32 s51, s82, 4358144
  ds_read_b64_tr_b16 a[238:239], v8 offset:25600
  v_mfma_f32_16x16x32_bf16 v[40:43], a[240:243], a[168:171], v[40:43]
  buffer_load_dwordx4 v3, s[16:19], s51 offen lds
  v_mfma_f32_16x16x32_bf16 v[40:43], a[244:247], a[184:187], v[40:43]
  v_mfma_f32_16x16x32_bf16 v[40:43], a[248:251], a[200:203], v[40:43]
  s_add_u32 m0, s56, 104448
  v_mfma_f32_16x16x32_bf16 v[40:43], a[252:255], a[216:219], v[40:43]
  s_add_u32 s51, s82, 4390912
  v_mfma_f32_16x16x32_bf16 v[44:47], a[240:243], a[172:175], v[44:47]
  buffer_load_dwordx4 v4, s[16:19], s51 offen lds
  v_mfma_f32_16x16x32_bf16 v[44:47], a[244:247], a[188:191], v[44:47]
  v_mfma_f32_16x16x32_bf16 v[44:47], a[248:251], a[204:207], v[44:47]
  s_add_u32 m0, s56, 105472
  v_mfma_f32_16x16x32_bf16 v[44:47], a[252:255], a[220:223], v[44:47]
  s_waitcnt lgkmcnt(0)
  s_add_u32 s51, s82, 4423680
  v_mfma_f32_16x16x32_bf16 v[48:51], a[224:227], a[160:163], v[48:51]
  ds_read_b64_tr_b16 a[240:241], v9 offset:0
  buffer_load_dwordx4 v4, s[16:19], s51 offen lds
  v_mfma_f32_16x16x32_bf16 v[48:51], a[228:231], a[176:179], v[48:51]
  ds_read_b64_tr_b16 a[242:243], v9 offset:1024
  v_mfma_f32_16x16x32_bf16 v[48:51], a[232:235], a[192:195], v[48:51]
  ds_read_b64_tr_b16 a[244:245], v9 offset:8192
  v_mfma_f32_16x16x32_bf16 v[48:51], a[236:239], a[208:211], v[48:51]
  s_add_u32 s52, s70, 65536
  ds_read_b64_tr_b16 a[246:247], v9 offset:9216
  v_mfma_f32_16x16x32_bf16 v[52:55], a[224:227], a[164:167], v[52:55]
  ds_read_b64_tr_b16 a[248:249], v9 offset:16384
  buffer_load_dwordx4 a[96:99], v15, s[28:31], s52 offen offset:0 sc1
  v_mfma_f32_16x16x32_bf16 v[52:55], a[228:231], a[180:183], v[52:55]
  ds_read_b64_tr_b16 a[250:251], v9 offset:17408
  v_mfma_f32_16x16x32_bf16 v[52:55], a[232:235], a[196:199], v[52:55]
  ds_read_b64_tr_b16 a[252:253], v9 offset:24576
  v_mfma_f32_16x16x32_bf16 v[52:55], a[236:239], a[212:215], v[52:55]
  ds_read_b64_tr_b16 a[254:255], v9 offset:25600
  v_mfma_f32_16x16x32_bf16 v[56:59], a[224:227], a[168:171], v[56:59]
  buffer_load_dwordx4 a[100:103], v15, s[28:31], s52 offen offset:1024 sc1
  v_mfma_f32_16x16x32_bf16 v[56:59], a[228:231], a[184:187], v[56:59]
  v_mfma_f32_16x16x32_bf16 v[56:59], a[232:235], a[200:203], v[56:59]
  v_mfma_f32_16x16x32_bf16 v[56:59], a[236:239], a[216:219], v[56:59]
  v_mfma_f32_16x16x32_bf16 v[60:63], a[224:227], a[172:175], v[60:63]
  buffer_load_dwordx4 a[104:107], v15, s[28:31], s52 offen offset:2048 sc1
  v_mfma_f32_16x16x32_bf16 v[60:63], a[228:231], a[188:191], v[60:63]
  v_mfma_f32_16x16x32_bf16 v[60:63], a[232:235], a[204:207], v[60:63]
  v_mfma_f32_16x16x32_bf16 v[60:63], a[236:239], a[220:223], v[60:63]
  s_waitcnt lgkmcnt(0)
  v_mfma_f32_16x16x32_bf16 v[132:135], a[240:243], a[160:163], v[132:135]
  ds_read_b64_tr_b16 a[224:225], v10 offset:0
  buffer_load_dwordx4 a[108:111], v15, s[28:31], s52 offen offset:3072 sc1
  v_mfma_f32_16x16x32_bf16 v[132:135], a[244:247], a[176:179], v[132:135]
  ds_read_b64_tr_b16 a[226:227], v10 offset:1024
  v_mfma_f32_16x16x32_bf16 v[132:135], a[248:251], a[192:195], v[132:135]
  ds_read_b64_tr_b16 a[228:229], v10 offset:8192
  v_mfma_f32_16x16x32_bf16 v[132:135], a[252:255], a[208:211], v[132:135]
  s_add_u32 s52, s70, 69632
  ds_read_b64_tr_b16 a[230:231], v10 offset:9216
  v_mfma_f32_16x16x32_bf16 v[140:143], a[240:243], a[164:167], v[140:143]
  ds_read_b64_tr_b16 a[232:233], v10 offset:16384
  buffer_load_dwordx4 a[112:115], v15, s[28:31], s52 offen offset:0 sc1
  v_mfma_f32_16x16x32_bf16 v[140:143], a[244:247], a[180:183], v[140:143]
  ds_read_b64_tr_b16 a[234:235], v10 offset:17408
  v_mfma_f32_16x16x32_bf16 v[140:143], a[248:251], a[196:199], v[140:143]
  ds_read_b64_tr_b16 a[236:237], v10 offset:24576
  v_mfma_f32_16x16x32_bf16 v[140:143], a[252:255], a[212:215], v[140:143]
  ds_read_b64_tr_b16 a[238:239], v10 offset:25600
  v_mfma_f32_16x16x32_bf16 v[148:151], a[240:243], a[168:171], v[148:151]
  s_lshl_b32 s6, s49, 7
  buffer_load_dwordx4 a[116:119], v15, s[28:31], s52 offen offset:1024 sc1
  v_mfma_f32_16x16x32_bf16 v[148:151], a[244:247], a[184:187], v[148:151]
  s_add_u32 s6, s6, 460800
  v_mov_b32 v25, s6
  v_mfma_f32_16x16x32_bf16 v[148:151], a[248:251], a[200:203], v[148:151]
  s_lshr_b32 s6, s48, 1
  v_mfma_f32_16x16x32_bf16 v[148:151], a[252:255], a[216:219], v[148:151]
  s_lshl_b32 s7, s6, 14
  v_add_u32 v1, s7, v15
  v_add_u32 v2, 65536, v1
  v_mfma_f32_16x16x32_bf16 v[156:159], a[240:243], a[172:175], v[156:159]
  buffer_load_dwordx4 a[120:123], v15, s[28:31], s52 offen offset:2048 sc1
  v_mfma_f32_16x16x32_bf16 v[156:159], a[244:247], a[188:191], v[156:159]
  v_add_u32 v5, s56, v15
  v_mfma_f32_16x16x32_bf16 v[156:159], a[248:251], a[204:207], v[156:159]
  s_and_b32 s7, s48, 1
  v_mfma_f32_16x16x32_bf16 v[156:159], a[252:255], a[220:223], v[156:159]
  s_waitcnt lgkmcnt(0)
  s_lshl_b32 s7, s7, 14
  v_mfma_f32_16x16x32_bf16 v[164:167], a[224:227], a[160:163], v[164:167]
  s_add_u32 s7, s7, 65536
  ds_read_b64_tr_b16 a[240:241], v11 offset:0
  buffer_load_dwordx4 a[124:127], v15, s[28:31], s52 offen offset:3072 sc1
  v_mfma_f32_16x16x32_bf16 v[164:167], a[228:231], a[176:179], v[164:167]
  ds_read_b64_tr_b16 a[242:243], v11 offset:1024
  v_add_u32 v24, s7, v15
  v_mfma_f32_16x16x32_bf16 v[164:167], a[232:235], a[192:195], v[164:167]
  s_lshl_b32 s6, s6, 16
  ds_read_b64_tr_b16 a[244:245], v11 offset:8192
  v_add_u32 v6, s6, v24
  v_mfma_f32_16x16x32_bf16 v[164:167], a[236:239], a[208:211], v[164:167]
  s_add_u32 s52, s70, 73728
  ds_read_b64_tr_b16 a[246:247], v11 offset:9216
  v_mfma_f32_16x16x32_bf16 v[172:175], a[224:227], a[164:167], v[172:175]
  s_mov_b32 s57, s50
  ds_read_b64_tr_b16 a[248:249], v11 offset:16384
  buffer_load_dwordx4 a[128:131], v15, s[28:31], s52 offen offset:0 sc1
  v_mfma_f32_16x16x32_bf16 v[172:175], a[228:231], a[180:183], v[172:175]
  ds_read_b64_tr_b16 a[250:251], v11 offset:17408
  v_mfma_f32_16x16x32_bf16 v[172:175], a[232:235], a[196:199], v[172:175]
  ds_read_b64_tr_b16 a[252:253], v11 offset:24576
  v_mfma_f32_16x16x32_bf16 v[172:175], a[236:239], a[212:215], v[172:175]
  ds_read_b64_tr_b16 a[254:255], v11 offset:25600
  v_mfma_f32_16x16x32_bf16 v[180:183], a[224:227], a[168:171], v[180:183]
  buffer_load_dwordx4 a[132:135], v15, s[28:31], s52 offen offset:1024 sc1
  v_mfma_f32_16x16x32_bf16 v[180:183], a[228:231], a[184:187], v[180:183]
  v_mfma_f32_16x16x32_bf16 v[180:183], a[232:235], a[200:203], v[180:183]
  v_mfma_f32_16x16x32_bf16 v[180:183], a[236:239], a[216:219], v[180:183]
  v_mfma_f32_16x16x32_bf16 v[188:191], a[224:227], a[172:175], v[188:191]
  buffer_load_dwordx4 a[136:139], v15, s[28:31], s52 offen offset:2048 sc1
  v_mfma_f32_16x16x32_bf16 v[188:191], a[228:231], a[188:191], v[188:191]
  v_mfma_f32_16x16x32_bf16 v[188:191], a[232:235], a[204:207], v[188:191]
  v_mfma_f32_16x16x32_bf16 v[188:191], a[236:239], a[220:223], v[188:191]
  s_waitcnt lgkmcnt(0)
  v_mfma_f32_16x16x32_bf16 v[196:199], a[240:243], a[160:163], v[196:199]
  ds_read_b64_tr_b16 a[224:225], v12 offset:0
  buffer_load_dwordx4 a[140:143], v15, s[28:31], s52 offen offset:3072 sc1
  v_mfma_f32_16x16x32_bf16 v[196:199], a[244:247], a[176:179], v[196:199]
  ds_read_b64_tr_b16 a[226:227], v12 offset:1024
  v_mfma_f32_16x16x32_bf16 v[196:199], a[248:251], a[192:195], v[196:199]
  ds_read_b64_tr_b16 a[228:229], v12 offset:8192
  v_mfma_f32_16x16x32_bf16 v[196:199], a[252:255], a[208:211], v[196:199]
  s_add_u32 s52, s70, 77824
  ds_read_b64_tr_b16 a[230:231], v12 offset:9216
  v_mfma_f32_16x16x32_bf16 v[204:207], a[240:243], a[164:167], v[204:207]
  ds_read_b64_tr_b16 a[232:233], v12 offset:16384
  buffer_load_dwordx4 a[144:147], v15, s[28:31], s52 offen offset:0 sc1
  v_mfma_f32_16x16x32_bf16 v[204:207], a[244:247], a[180:183], v[204:207]
  ds_read_b64_tr_b16 a[234:235], v12 offset:17408
  v_mfma_f32_16x16x32_bf16 v[204:207], a[248:251], a[196:199], v[204:207]
  ds_read_b64_tr_b16 a[236:237], v12 offset:24576
  v_mfma_f32_16x16x32_bf16 v[204:207], a[252:255], a[212:215], v[204:207]
  ds_read_b64_tr_b16 a[238:239], v12 offset:25600
  v_mfma_f32_16x16x32_bf16 v[212:215], a[240:243], a[168:171], v[212:215]
  buffer_load_dwordx4 a[148:151], v15, s[28:31], s52 offen offset:1024 sc1
  v_mfma_f32_16x16x32_bf16 v[212:215], a[244:247], a[184:187], v[212:215]
  v_mfma_f32_16x16x32_bf16 v[212:215], a[248:251], a[200:203], v[212:215]
  v_mfma_f32_16x16x32_bf16 v[212:215], a[252:255], a[216:219], v[212:215]
  v_mfma_f32_16x16x32_bf16 v[220:223], a[240:243], a[172:175], v[220:223]
  buffer_load_dwordx4 a[152:155], v15, s[28:31], s52 offen offset:2048 sc1
  v_mfma_f32_16x16x32_bf16 v[220:223], a[244:247], a[188:191], v[220:223]
  v_mfma_f32_16x16x32_bf16 v[220:223], a[248:251], a[204:207], v[220:223]
  v_mfma_f32_16x16x32_bf16 v[220:223], a[252:255], a[220:223], v[220:223]
  s_waitcnt lgkmcnt(0)
  v_mfma_f32_16x16x32_bf16 v[228:231], a[224:227], a[160:163], v[228:231]
  ds_read_b64_tr_b16 a[240:241], v13 offset:0
  buffer_load_dwordx4 a[156:159], v15, s[28:31], s52 offen offset:3072 sc1
  v_mfma_f32_16x16x32_bf16 v[228:231], a[228:231], a[176:179], v[228:231]
  s_add_u32 s53, s43, 4096
  ds_read_b64_tr_b16 a[242:243], v13 offset:1024
  v_mfma_f32_16x16x32_bf16 v[228:231], a[232:235], a[192:195], v[228:231]
  ds_read_b64_tr_b16 a[244:245], v13 offset:8192
  buffer_store_dwordx4 v[216:219], v15, s[28:31], s53 offen sc1
  v_mfma_f32_16x16x32_bf16 v[228:231], a[236:239], a[208:211], v[228:231]
  ds_read_b64_tr_b16 a[246:247], v13 offset:9216
  v_mfma_f32_16x16x32_bf16 v[236:239], a[224:227], a[164:167], v[236:239]
  ds_read_b64_tr_b16 a[248:249], v13 offset:16384
  v_mfma_f32_16x16x32_bf16 v[236:239], a[228:231], a[180:183], v[236:239]
  ds_read_b64_tr_b16 a[250:251], v13 offset:17408
  v_mfma_f32_16x16x32_bf16 v[236:239], a[232:235], a[196:199], v[236:239]
  ds_read_b64_tr_b16 a[252:253], v13 offset:24576
  v_mfma_f32_16x16x32_bf16 v[236:239], a[236:239], a[212:215], v[236:239]
  ds_read_b64_tr_b16 a[254:255], v13 offset:25600
  v_mfma_f32_16x16x32_bf16 v[244:247], a[224:227], a[168:171], v[244:247]
  v_mfma_f32_16x16x32_bf16 v[244:247], a[228:231], a[184:187], v[244:247]
  v_mfma_f32_16x16x32_bf16 v[244:247], a[232:235], a[200:203], v[244:247]
  v_mfma_f32_16x16x32_bf16 v[244:247], a[236:239], a[216:219], v[244:247]
  v_mfma_f32_16x16x32_bf16 v[252:255], a[224:227], a[172:175], v[252:255]
  v_mfma_f32_16x16x32_bf16 v[252:255], a[228:231], a[188:191], v[252:255]
  v_mfma_f32_16x16x32_bf16 v[252:255], a[232:235], a[204:207], v[252:255]
  v_mfma_f32_16x16x32_bf16 v[252:255], a[236:239], a[220:223], v[252:255]
  s_waitcnt lgkmcnt(0)
  s_add_u32 s53, s42, 6144
  v_mfma_f32_16x16x32_bf16 v[64:67], a[240:243], a[160:163], v[64:67]
  ds_read_b64_tr_b16 a[224:225], v14 offset:0
  buffer_store_dwordx4 v[240:243], v15, s[28:31], s53 offen sc1
  v_mfma_f32_16x16x32_bf16 v[64:67], a[244:247], a[176:179], v[64:67]
  ds_read_b64_tr_b16 a[226:227], v14 offset:1024
  v_mfma_f32_16x16x32_bf16 v[64:67], a[248:251], a[192:195], v[64:67]
  ds_read_b64_tr_b16 a[228:229], v14 offset:8192
  v_mfma_f32_16x16x32_bf16 v[64:67], a[252:255], a[208:211], v[64:67]
  ds_read_b64_tr_b16 a[230:231], v14 offset:9216
  v_mfma_f32_16x16x32_bf16 v[68:71], a[240:243], a[164:167], v[68:71]
  ds_read_b64_tr_b16 a[232:233], v14 offset:16384
  v_mfma_f32_16x16x32_bf16 v[68:71], a[244:247], a[180:183], v[68:71]
  ds_read_b64_tr_b16 a[234:235], v14 offset:17408
  v_mfma_f32_16x16x32_bf16 v[68:71], a[248:251], a[196:199], v[68:71]
  ds_read_b64_tr_b16 a[236:237], v14 offset:24576
  v_mfma_f32_16x16x32_bf16 v[68:71], a[252:255], a[212:215], v[68:71]
  ds_read_b64_tr_b16 a[238:239], v14 offset:25600
  v_mfma_f32_16x16x32_bf16 v[72:75], a[240:243], a[168:171], v[72:75]
  v_mfma_f32_16x16x32_bf16 v[72:75], a[244:247], a[184:187], v[72:75]
  v_mfma_f32_16x16x32_bf16 v[72:75], a[248:251], a[200:203], v[72:75]
  v_mfma_f32_16x16x32_bf16 v[72:75], a[252:255], a[216:219], v[72:75]
  v_mfma_f32_16x16x32_bf16 v[76:79], a[240:243], a[172:175], v[76:79]
  v_mfma_f32_16x16x32_bf16 v[76:79], a[244:247], a[188:191], v[76:79]
  v_mfma_f32_16x16x32_bf16 v[76:79], a[248:251], a[204:207], v[76:79]
  s_add_u32 s53, s43, 6144
  v_mfma_f32_16x16x32_bf16 v[76:79], a[252:255], a[220:223], v[76:79]
  s_waitcnt lgkmcnt(0)
  buffer_store_dwordx4 v[248:251], v15, s[28:31], s53 offen sc1
  s_waitcnt vmcnt(19) lgkmcnt(0)
  s_barrier
  v_mfma_f32_16x16x32_bf16 v[80:83], a[224:227], a[160:163], v[80:83]
  ds_read_b64_tr_b16 a[240:241], v7 offset:32768
  v_mfma_f32_16x16x32_bf16 v[80:83], a[228:231], a[176:179], v[80:83]
  ds_read_b64_tr_b16 a[242:243], v7 offset:33792
  v_mfma_f32_16x16x32_bf16 v[80:83], a[232:235], a[192:195], v[80:83]
  ds_read_b64_tr_b16 a[244:245], v7 offset:40960
  v_mfma_f32_16x16x32_bf16 v[80:83], a[236:239], a[208:211], v[80:83]
  ds_read_b64_tr_b16 a[246:247], v7 offset:41984
  v_mfma_f32_16x16x32_bf16 v[84:87], a[224:227], a[164:167], v[84:87]
  ds_read_b64_tr_b16 a[248:249], v7 offset:49152
  v_mfma_f32_16x16x32_bf16 v[84:87], a[228:231], a[180:183], v[84:87]
  ds_read_b64_tr_b16 a[250:251], v7 offset:50176
  v_mfma_f32_16x16x32_bf16 v[84:87], a[232:235], a[196:199], v[84:87]
  ds_read_b64_tr_b16 a[252:253], v7 offset:57344
  v_mfma_f32_16x16x32_bf16 v[84:87], a[236:239], a[212:215], v[84:87]
  ds_read_b64_tr_b16 a[254:255], v7 offset:58368
  v_mfma_f32_16x16x32_bf16 v[88:91], a[224:227], a[168:171], v[88:91]
  v_mfma_f32_16x16x32_bf16 v[88:91], a[228:231], a[184:187], v[88:91]
  v_mfma_f32_16x16x32_bf16 v[88:91], a[232:235], a[200:203], v[88:91]
  v_mfma_f32_16x16x32_bf16 v[88:91], a[236:239], a[216:219], v[88:91]
  v_mfma_f32_16x16x32_bf16 v[92:95], a[224:227], a[172:175], v[92:95]
  v_mfma_f32_16x16x32_bf16 v[92:95], a[228:231], a[188:191], v[92:95]
  v_mfma_f32_16x16x32_bf16 v[92:95], a[232:235], a[204:207], v[92:95]
  s_getpc_b64 s[4:5]
L_pcq:
  s_lshr_b32 s6, s2, 3
  s_lshl_b32 s6, s6, 2
  s_add_u32 s6, s6, s48
  s_lshl_b32 s6, s6, 9
  v_and_b32 v27, 3, v0
  v_lshl_add_u32 v27, v27, 7, s6
  v_min_u32 v27, code_end - L_pcq - 4, v27
  global_load_dword v23, v27, s[4:5]
  v_mfma_f32_16x16x32_bf16 v[92:95], a[236:239], a[220:223], v[92:95]
  s_waitcnt vmcnt(4) lgkmcnt(0)
  v_mfma_f32_16x16x32_bf16 v[32:35], a[240:243], a[96:99], v[32:35]
  ds_read_b64_tr_b16 a[224:225], v8 offset:32768
  v_mfma_f32_16x16x32_bf16 v[32:35], a[244:247], a[112:115], v[32:35]
  ds_read_b64_tr_b16 a[226:227], v8 offset:33792
  v_mfma_f32_16x16x32_bf16 v[32:35], a[248:251], a[128:131], v[32:35]
  ds_read_b64_tr_b16 a[228:229], v8 offset:40960
  v_mfma_f32_16x16x32_bf16 v[32:35], a[252:255], a[144:147], v[32:35]
  ds_read_b64_tr_b16 a[230:231], v8 offset:41984
  v_mfma_f32_16x16x32_bf16 v[36:39], a[240:243], a[100:103], v[36:39]
  ds_read_b64_tr_b16 a[232:233], v8 offset:49152
  v_mfma_f32_16x16x32_bf16 v[36:39], a[244:247], a[116:119], v[36:39]
  ds_read_b64_tr_b16 a[234:235], v8 offset:50176
  v_mfma_f32_16x16x32_bf16 v[36:39], a[248:251], a[132:135], v[36:39]
  ds_read_b64_tr_b16 a[236:237], v8 offset:57344
  v_mfma_f32_16x16x32_bf16 v[36:39], a[252:255], a[148:151], v[36:39]
  ds_read_b64_tr_b16 a[238:239], v8 offset:58368
  v_mfma_f32_16x16x32_bf16 v[40:43], a[240:243], a[104:107], v[40:43]
  v_mfma_f32_16x16x32_bf16 v[40:43], a[244:247], a[120:123], v[40:43]
  v_cvt_pk_bf16_f32 v32, v32, v33
  v_cvt_pk_bf16_f32 v33, v34, v35
  v_mfma_f32_16x16x32_bf16 v[40:43], a[248:251], a[136:139], v[40:43]
  v_mfma_f32_16x16x32_bf16 v[40:43], a[252:255], a[152:155], v[40:43]
  v_mfma_f32_16x16x32_bf16 v[44:47], a[240:243], a[108:111], v[44:47]
  v_mfma_f32_16x16x32_bf16 v[44:47], a[244:247], a[124:127], v[44:47]
  v_cvt_pk_bf16_f32 v36, v36, v37
  v_cvt_pk_bf16_f32 v37, v38, v39
  v_mfma_f32_16x16x32_bf16 v[44:47], a[248:251], a[140:143], v[44:47]
  v_mfma_f32_16x16x32_bf16 v[44:47], a[252:255], a[156:159], v[44:47]
  s_waitcnt lgkmcnt(0)
  v_mfma_f32_16x16x32_bf16 v[48:51], a[224:227], a[96:99], v[48:51]
HS6:
  s_cbranch_execz HS10
  ds_read_b64_tr_b16 a[240:241], v9 offset:32768
  v_mfma_f32_16x16x32_bf16 v[48:51], a[228:231], a[112:115], v[48:51]
  ds_read_b64_tr_b16 a[242:243], v9 offset:33792
  v_cvt_pk_bf16_f32 v40, v40, v41
  v_mfma_f32_16x16x32_bf16 v[48:51], a[232:235], a[128:131], v[48:51]
  ds_read_b64_tr_b16 a[244:245], v9 offset:40960
  v_cvt_pk_bf16_f32 v41, v42, v43
  v_mfma_f32_16x16x32_bf16 v[48:51], a[236:239], a[144:147], v[48:51]
  ds_read_b64_tr_b16 a[246:247], v9 offset:41984
  v_mfma_f32_16x16x32_bf16 v[52:55], a[224:227], a[100:103], v[52:55]
  ds_read_b64_tr_b16 a[248:249], v9 offset:49152
  v_mfma_f32_16x16x32_bf16 v[52:55], a[228:231], a[116:119], v[52:55]
  ds_read_b64_tr_b16 a[250:251], v9 offset:50176
  v_cvt_pk_bf16_f32 v44, v44, v45
  v_mfma_f32_16x16x32_bf16 v[52:55], a[232:235], a[132:135], v[52:55]
  ds_read_b64_tr_b16 a[252:253], v9 offset:57344
  v_cvt_pk_bf16_f32 v45, v46, v47
  v_mfma_f32_16x16x32_bf16 v[52:55], a[236:239], a[148:151], v[52:55]
  ds_read_b64_tr_b16 a[254:255], v9 offset:58368
  v_mfma_f32_16x16x32_bf16 v[56:59], a[224:227], a[104:107], v[56:59]
  v_cvt_pk_bf16_f32 v34, v48, v49
  v_cvt_pk_bf16_f32 v35, v50, v51
  s_waitcnt vmcnt(1)
  v_mfma_f32_16x16x32_bf16 v[56:59], a[228:231], a[120:123], v[56:59]
  s_lshl_b32 s52, s49, 7
  ds_write_b128 v6, v[32:35] offset:0
  v_mfma_f32_16x16x32_bf16 v[56:59], a[232:235], a[136:139], v[56:59]
  s_add_u32 s52, s52, 460800
  buffer_atomic_add v20, v16, s[28:31], s52 offen offset:0
  v_mfma_f32_16x16x32_bf16 v[56:59], a[236:239], a[152:155], v[56:59]
  s_add_u32 s53, s36, 0
  v_mfma_f32_16x16x32_bf16 v[60:63], a[224:227], a[108:111], v[60:63]
  buffer_store_dwordx4 a[0:3], v15, s[28:31], s53 offen sc1
  v_mfma_f32_16x16x32_bf16 v[60:63], a[228:231], a[124:127], v[60:63]
  v_cvt_pk_bf16_f32 v38, v52, v53
  v_cvt_pk_bf16_f32 v39, v54, v55
  v_mfma_f32_16x16x32_bf16 v[60:63], a[232:235], a[140:143], v[60:63]
  s_mov_b32 s46, 0x500000
  ds_write_b128 v6, v[36:39] offset:1024
  v_mfma_f32_16x16x32_bf16 v[60:63], a[236:239], a[156:159], v[60:63]
  s_waitcnt lgkmcnt(2)
  s_mov_b32 s22, 0x21c000
  v_mfma_f32_16x16x32_bf16 v[132:135], a[240:243], a[96:99], v[132:135]
  s_mov_b32 s26, 0x10e000
  ds_read_b64_tr_b16 a[224:225], v10 offset:32768
  v_cvt_pk_bf16_f32 v42, v56, v57
  v_mfma_f32_16x16x32_bf16 v[132:135], a[244:247], a[112:115], v[132:135]
  s_mov_b32 s14, 0x800000
  ds_read_b64_tr_b16 a[226:227], v10 offset:33792
  v_cvt_pk_bf16_f32 v43, v58, v59
  v_mfma_f32_16x16x32_bf16 v[132:135], a[248:251], a[128:131], v[132:135]
  s_mov_b32 s34, 0x280000
  ds_read_b64_tr_b16 a[228:229], v10 offset:40960
  ds_write_b128 v6, v[40:43] offset:2048
  v_mfma_f32_16x16x32_bf16 v[132:135], a[252:255], a[144:147], v[132:135]
  s_lshl_b32 s63, s59, 15
  ds_read_b64_tr_b16 a[230:231], v10 offset:41984
  v_mfma_f32_16x16x32_bf16 v[140:143], a[240:243], a[100:103], v[140:143]
  s_add_u32 s63, s63, s64
  ds_read_b64_tr_b16 a[232:233], v10 offset:49152
  v_cvt_pk_bf16_f32 v46, v60, v61
  v_mfma_f32_16x16x32_bf16 v[140:143], a[244:247], a[116:119], v[140:143]
  s_add_u32 s53, s36, 4096
  ds_read_b64_tr_b16 a[234:235], v10 offset:50176
  v_cvt_pk_bf16_f32 v47, v62, v63
  v_mfma_f32_16x16x32_bf16 v[140:143], a[248:251], a[132:135], v[140:143]
  s_mov_b32 s78, s64
  ds_read_b64_tr_b16 a[236:237], v10 offset:57344
  buffer_store_dwordx4 a[4:7], v15, s[28:31], s53 offen sc1
  v_mfma_f32_16x16x32_bf16 v[140:143], a[252:255], a[148:151], v[140:143]
  s_mov_b32 s77, s56
  ds_read_b64_tr_b16 a[238:239], v10 offset:58368
  v_mfma_f32_16x16x32_bf16 v[148:151], a[240:243], a[104:107], v[148:151]
  s_mov_b32 s68, 0
  ds_write_b128 v6, v[44:47] offset:3072
  v_mfma_f32_16x16x32_bf16 v[148:151], a[244:247], a[120:123], v[148:151]
  s_lshr_b32 s6, s48, 1
  v_cvt_pk_bf16_f32 v132, v132, v133
  v_cvt_pk_bf16_f32 v133, v134, v135
  v_mfma_f32_16x16x32_bf16 v[148:151], a[248:251], a[136:139], v[148:151]
  s_lshl_b32 s6, s6, 11
  v_add_u32 v21, s6, v24
  v_xor_b32 v22, 0x800, v21
  v_mfma_f32_16x16x32_bf16 v[148:151], a[252:255], a[152:155], v[148:151]
  v_mov_b32 v3, v15
  v_mov_b32 v30, 0x3f803f80
  v_mfma_f32_16x16x32_bf16 v[156:159], a[240:243], a[108:111], v[156:159]
  v_accvgpr_write_b32 a160, v30
  v_accvgpr_write_b32 a161, v30
  v_mfma_f32_16x16x32_bf16 v[156:159], a[244:247], a[124:127], v[156:159]
  v_cvt_pk_bf16_f32 v140, v140, v141
  v_cvt_pk_bf16_f32 v141, v142, v143
  v_mfma_f32_16x16x32_bf16 v[156:159], a[248:251], a[140:143], v[156:159]
  v_accvgpr_write_b32 a162, v30
  v_accvgpr_write_b32 a163, v30
  v_mfma_f32_16x16x32_bf16 v[156:159], a[252:255], a[156:159], v[156:159]
  s_waitcnt lgkmcnt(1)
  v_mfma_f32_16x16x32_bf16 v[164:167], a[224:227], a[96:99], v[164:167]
  ds_read_b64_tr_b16 a[240:241], v11 offset:32768
  v_mfma_f32_16x16x32_bf16 v[164:167], a[228:231], a[112:115], v[164:167]
  s_add_u32 s53, s37, 0
  ds_read_b64_tr_b16 a[242:243], v11 offset:33792
  v_cvt_pk_bf16_f32 v148, v148, v149
  v_mfma_f32_16x16x32_bf16 v[164:167], a[232:235], a[128:131], v[164:167]
  ds_read_b64_tr_b16 a[244:245], v11 offset:40960
  buffer_store_dwordx4 a[8:11], v15, s[28:31], s53 offen sc1
  v_mfma_f32_16x16x32_bf16 v[164:167], a[236:239], a[144:147], v[164:167]
  ds_read_b64_tr_b16 a[246:247], v11 offset:41984
  v_cvt_pk_bf16_f32 v149, v150, v151
  v_mfma_f32_16x16x32_bf16 v[172:175], a[224:227], a[100:103], v[172:175]
  ds_read_b64_tr_b16 a[248:249], v11 offset:49152
  v_mfma_f32_16x16x32_bf16 v[172:175], a[228:231], a[116:119], v[172:175]
  ds_read_b64_tr_b16 a[250:251], v11 offset:50176
  v_cvt_pk_bf16_f32 v156, v156, v157
  v_mfma_f32_16x16x32_bf16 v[172:175], a[232:235], a[132:135], v[172:175]
  ds_read_b64_tr_b16 a[252:253], v11 offset:57344
  v_cvt_pk_bf16_f32 v157, v158, v159
  v_mfma_f32_16x16x32_bf16 v[172:175], a[236:239], a[148:151], v[172:175]
  ds_read_b64_tr_b16 a[254:255], v11 offset:58368
  v_mfma_f32_16x16x32_bf16 v[180:183], a[224:227], a[104:107], v[180:183]
  v_cvt_pk_bf16_f32 v134, v164, v165
  v_cvt_pk_bf16_f32 v135, v166, v167
  v_mfma_f32_16x16x32_bf16 v[180:183], a[228:231], a[120:123], v[180:183]
  ds_write_b128 v6, v[132:135] offset:4096
  v_mov_b32 v32, 0
  v_mfma_f32_16x16x32_bf16 v[180:183], a[232:235], a[136:139], v[180:183]
  v_mov_b32 v33, 0
  v_mov_b32 v34, 0
  v_mfma_f32_16x16x32_bf16 v[180:183], a[236:239], a[152:155], v[180:183]
  v_mov_b32 v35, 0
  v_mov_b32 v36, 0
  v_mfma_f32_16x16x32_bf16 v[188:191], a[224:227], a[108:111], v[188:191]
  v_cvt_pk_bf16_f32 v142, v172, v173
  v_cvt_pk_bf16_f32 v143, v174, v175
  v_mfma_f32_16x16x32_bf16 v[188:191], a[228:231], a[124:127], v[188:191]
  s_add_u32 s53, s37, 4096
  ds_write_b128 v6, v[140:143] offset:5120
  v_mov_b32 v37, 0
  v_mfma_f32_16x16x32_bf16 v[188:191], a[232:235], a[140:143], v[188:191]
  buffer_store_dwordx4 a[12:15], v15, s[28:31], s53 offen sc1
  v_mfma_f32_16x16x32_bf16 v[188:191], a[236:239], a[156:159], v[188:191]
  s_waitcnt lgkmcnt(2)
  v_mov_b32 v38, 0
  v_mov_b32 v39, 0
  v_mfma_f32_16x16x32_bf16 v[196:199], a[240:243], a[96:99], v[196:199]
  ds_read_b64_tr_b16 a[224:225], v12 offset:32768
  v_cvt_pk_bf16_f32 v150, v180, v181
  v_mfma_f32_16x16x32_bf16 v[196:199], a[244:247], a[112:115], v[196:199]
  ds_read_b64_tr_b16 a[226:227], v12 offset:33792
  v_cvt_pk_bf16_f32 v151, v182, v183
  v_mfma_f32_16x16x32_bf16 v[196:199], a[248:251], a[128:131], v[196:199]
  ds_read_b64_tr_b16 a[228:229], v12 offset:40960
  ds_write_b128 v6, v[148:151] offset:6144
  v_mfma_f32_16x16x32_bf16 v[196:199], a[252:255], a[144:147], v[196:199]
  ds_read_b64_tr_b16 a[230:231], v12 offset:41984
  v_mov_b32 v40, 0
  v_mfma_f32_16x16x32_bf16 v[204:207], a[240:243], a[100:103], v[204:207]
  ds_read_b64_tr_b16 a[232:233], v12 offset:49152
  v_cvt_pk_bf16_f32 v158, v188, v189
  v_mfma_f32_16x16x32_bf16 v[204:207], a[244:247], a[116:119], v[204:207]
  ds_read_b64_tr_b16 a[234:235], v12 offset:50176
  v_cvt_pk_bf16_f32 v159, v190, v191
  v_mfma_f32_16x16x32_bf16 v[204:207], a[248:251], a[132:135], v[204:207]
  ds_read_b64_tr_b16 a[236:237], v12 offset:57344
  v_mov_b32 v41, 0
  v_mfma_f32_16x16x32_bf16 v[204:207], a[252:255], a[148:151], v[204:207]
  ds_read_b64_tr_b16 a[238:239], v12 offset:58368
  v_mov_b32 v42, 0
  v_mfma_f32_16x16x32_bf16 v[212:215], a[240:243], a[104:107], v[212:215]
  ds_write_b128 v6, v[156:159] offset:7168
  v_mov_b32 v43, 0
  v_mfma_f32_16x16x32_bf16 v[212:215], a[244:247], a[120:123], v[212:215]
  s_add_u32 s53, s36, 1024
  v_cvt_pk_bf16_f32 v196, v196, v197
  v_cvt_pk_bf16_f32 v197, v198, v199
  v_mfma_f32_16x16x32_bf16 v[212:215], a[248:251], a[136:139], v[212:215]
  buffer_store_dwordx4 v[96:99], v15, s[28:31], s53 offen sc1
  v_mfma_f32_16x16x32_bf16 v[212:215], a[252:255], a[152:155], v[212:215]
  v_mov_b32 v44, 0
  v_mov_b32 v45, 0
  v_mfma_f32_16x16x32_bf16 v[220:223], a[240:243], a[108:111], v[220:223]
  v_mov_b32 v46, 0
  v_mov_b32 v47, 0
  v_mfma_f32_16x16x32_bf16 v[220:223], a[244:247], a[124:127], v[220:223]
  v_cvt_pk_bf16_f32 v204, v204, v205
  v_cvt_pk_bf16_f32 v205, v206, v207
  v_mfma_f32_16x16x32_bf16 v[220:223], a[248:251], a[140:143], v[220:223]
  v_lshrrev_b32 v28, 4, v0
  v_lshlrev_b32 v28, 2, v28
  v_mfma_f32_16x16x32_bf16 v[220:223], a[252:255], a[156:159], v[220:223]
  s_waitcnt lgkmcnt(1)
  v_and_b32 v29, 15, v0
  v_sub_u32 v28, v29, v28
  v_mfma_f32_16x16x32_bf16 v[228:231], a[224:227], a[96:99], v[228:231]
  s_and_b32 s7, s48, 1
  ds_read_b64_tr_b16 a[240:241], v13 offset:32768
  v_mfma_f32_16x16x32_bf16 v[228:231], a[228:231], a[112:115], v[228:231]
  s_lshl_b32 s7, s7, 4
  ds_read_b64_tr_b16 a[242:243], v13 offset:33792
  v_cvt_pk_bf16_f32 v212, v212, v213
  v_mfma_f32_16x16x32_bf16 v[228:231], a[232:235], a[128:131], v[228:231]
  ds_read_b64_tr_b16 a[244:245], v13 offset:40960
  v_cvt_pk_bf16_f32 v213, v214, v215
  v_mfma_f32_16x16x32_bf16 v[228:231], a[236:239], a[144:147], v[228:231]
  ds_read_b64_tr_b16 a[246:247], v13 offset:41984
  v_add_u32 v28, s7, v28
  v_mfma_f32_16x16x32_bf16 v[236:239], a[224:227], a[100:103], v[236:239]
  ds_read_b64_tr_b16 a[248:249], v13 offset:49152
  v_mov_b32 v29, 0xf149f2ca
  v_mfma_f32_16x16x32_bf16 v[236:239], a[228:231], a[116:119], v[236:239]
  s_add_u32 s53, s36, 5120
  ds_read_b64_tr_b16 a[250:251], v13 offset:50176
  v_cvt_pk_bf16_f32 v220, v220, v221
  v_mfma_f32_16x16x32_bf16 v[236:239], a[232:235], a[132:135], v[236:239]
  ds_read_b64_tr_b16 a[252:253], v13 offset:57344
  buffer_store_dwordx4 v[100:103], v15, s[28:31], s53 offen sc1
  v_mfma_f32_16x16x32_bf16 v[236:239], a[236:239], a[148:151], v[236:239]
  ds_read_b64_tr_b16 a[254:255], v13 offset:58368
  v_cvt_pk_bf16_f32 v221, v222, v223
  v_mfma_f32_16x16x32_bf16 v[244:247], a[224:227], a[104:107], v[244:247]
  v_cvt_pk_bf16_f32 v198, v228, v229
  v_cvt_pk_bf16_f32 v199, v230, v231
  v_mfma_f32_16x16x32_bf16 v[244:247], a[228:231], a[120:123], v[244:247]
  ds_write_b128 v6, v[196:199] offset:8192
  v_mfma_f32_16x16x32_bf16 v[244:247], a[232:235], a[136:139], v[244:247]
  ds_read_b128 a[64:67], v1 offset:0
  v_mfma_f32_16x16x32_bf16 v[244:247], a[236:239], a[152:155], v[244:247]
  ds_read_b128 a[68:71], v1 offset:1024
  v_mfma_f32_16x16x32_bf16 v[252:255], a[224:227], a[108:111], v[252:255]
  v_cvt_pk_bf16_f32 v206, v236, v237
  v_cvt_pk_bf16_f32 v207, v238, v239
  v_mfma_f32_16x16x32_bf16 v[252:255], a[228:231], a[124:127], v[252:255]
  ds_write_b128 v6, v[204:207] offset:9216
  v_mfma_f32_16x16x32_bf16 v[252:255], a[232:235], a[140:143], v[252:255]
  ds_read_b128 a[72:75], v1 offset:2048
  v_mfma_f32_16x16x32_bf16 v[252:255], a[236:239], a[156:159], v[252:255]
  s_waitcnt lgkmcnt(5)
  ds_read_b128 a[76:79], v1 offset:3072
  v_mfma_f32_16x16x32_bf16 v[64:67], a[240:243], a[96:99], v[64:67]
  ds_read_b64_tr_b16 a[224:225], v14 offset:32768
  v_cvt_pk_bf16_f32 v214, v244, v245
  v_mfma_f32_16x16x32_bf16 v[64:67], a[244:247], a[112:115], v[64:67]
  s_add_u32 s53, s37, 1024
  ds_read_b64_tr_b16 a[226:227], v14 offset:33792
  v_cvt_pk_bf16_f32 v215, v246, v247
  v_mfma_f32_16x16x32_bf16 v[64:67], a[248:251], a[128:131], v[64:67]
  ds_read_b64_tr_b16 a[228:229], v14 offset:40960
  buffer_store_dwordx4 v[104:107], v15, s[28:31], s53 offen sc1
  v_mfma_f32_16x16x32_bf16 v[64:67], a[252:255], a[144:147], v[64:67]
  ds_read_b64_tr_b16 a[230:231], v14 offset:41984
  ds_write_b128 v6, v[212:215] offset:10240
  v_mfma_f32_16x16x32_bf16 v[68:71], a[240:243], a[100:103], v[68:71]
  ds_read_b64_tr_b16 a[232:233], v14 offset:49152
  v_cvt_pk_bf16_f32 v222, v252, v253
  v_mfma_f32_16x16x32_bf16 v[68:71], a[244:247], a[116:119], v[68:71]
  ds_read_b64_tr_b16 a[234:235], v14 offset:50176
  v_cvt_pk_bf16_f32 v223, v254, v255
  v_mfma_f32_16x16x32_bf16 v[68:71], a[248:251], a[132:135], v[68:71]
  ds_read_b64_tr_b16 a[236:237], v14 offset:57344
  v_mfma_f32_16x16x32_bf16 v[68:71], a[252:255], a[148:151], v[68:71]
  ds_read_b64_tr_b16 a[238:239], v14 offset:58368
  v_mfma_f32_16x16x32_bf16 v[72:75], a[240:243], a[104:107], v[72:75]
  ds_write_b128 v6, v[220:223] offset:11264
  v_cmp_gt_i32 vcc, 0, v28
  v_mfma_f32_16x16x32_bf16 v[72:75], a[244:247], a[120:123], v[72:75]
  v_cvt_pk_bf16_f32 v64, v64, v65
  v_cvt_pk_bf16_f32 v65, v66, v67
  v_mfma_f32_16x16x32_bf16 v[72:75], a[248:251], a[136:139], v[72:75]
  v_cmp_gt_i32 s[72:73], 1, v28
  v_nop
  v_mfma_f32_16x16x32_bf16 v[72:75], a[252:255], a[152:155], v[72:75]
  v_cndmask_b32 v8, 0, v29, vcc
  v_cndmask_b32 v9, 0, v29, s[72:73]
  v_mfma_f32_16x16x32_bf16 v[76:79], a[240:243], a[108:111], v[76:79]
  v_cmp_gt_i32 vcc, 2, v28
  v_cmp_gt_i32 s[72:73], 3, v28
  v_mfma_f32_16x16x32_bf16 v[76:79], a[244:247], a[124:127], v[76:79]
  v_cvt_pk_bf16_f32 v68, v68, v69
  v_cvt_pk_bf16_f32 v69, v70, v71
  v_mfma_f32_16x16x32_bf16 v[76:79], a[248:251], a[140:143], v[76:79]
  v_nop
  v_cndmask_b32 v10, 0, v29, vcc
  v_mfma_f32_16x16x32_bf16 v[76:79], a[252:255], a[156:159], v[76:79]
  s_waitcnt lgkmcnt(1)
  v_cndmask_b32 v11, 0, v29, s[72:73]
  v_cmp_gt_i32 vcc, 16, v28
  s_waitcnt lgkmcnt(0)
  s_barrier
  v_mfma_f32_16x16x32_bf16 v[80:83], a[224:227], a[96:99], v[80:83]
  v_cmp_gt_i32 s[72:73], 17, v28
  v_nop
  ds_write_b128 v17, v[128:131] offset:32768
  v_mfma_f32_16x16x32_bf16 v[80:83], a[228:231], a[112:115], v[80:83]
  v_cvt_pk_bf16_f32 v72, v72, v73
  v_cvt_pk_bf16_f32 v73, v74, v75
  v_mfma_f32_16x16x32_bf16 v[80:83], a[232:235], a[128:131], v[80:83]
  v_cndmask_b32 v12, 0, v29, vcc
  v_cndmask_b32 v13, 0, v29, s[72:73]
  v_mfma_f32_16x16x32_bf16 v[80:83], a[236:239], a[144:147], v[80:83]
  v_cmp_gt_i32 vcc, 18, v28
  v_cmp_gt_i32 s[72:73], 19, v28
  v_mfma_f32_16x16x32_bf16 v[84:87], a[224:227], a[100:103], v[84:87]
  v_nop
  ds_write_b128 v19, v[136:139] offset:32768
  v_mfma_f32_16x16x32_bf16 v[84:87], a[228:231], a[116:119], v[84:87]
  v_cvt_pk_bf16_f32 v76, v76, v77
  v_cvt_pk_bf16_f32 v77, v78, v79
  v_mfma_f32_16x16x32_bf16 v[84:87], a[232:235], a[132:135], v[84:87]
  v_mfma_f32_16x16x32_bf16 v[84:87], a[236:239], a[148:151], v[84:87]
  v_mfma_f32_16x16x32_bf16 v[88:91], a[224:227], a[104:107], v[88:91]
  v_cvt_pk_bf16_f32 v66, v80, v81
  v_cvt_pk_bf16_f32 v67, v82, v83
  ds_write_b128 v17, v[160:163] offset:34816
  v_mfma_f32_16x16x32_bf16 v[88:91], a[228:231], a[120:123], v[88:91]
  ds_write_b128 v6, v[64:67] offset:12288
  v_mfma_f32_16x16x32_bf16 v[88:91], a[232:235], a[136:139], v[88:91]
  v_mfma_f32_16x16x32_bf16 v[88:91], a[236:239], a[152:155], v[88:91]
  v_mfma_f32_16x16x32_bf16 v[92:95], a[224:227], a[108:111], v[92:95]
  v_cvt_pk_bf16_f32 v70, v84, v85
  v_cvt_pk_bf16_f32 v71, v86, v87
  v_mfma_f32_16x16x32_bf16 v[92:95], a[228:231], a[124:127], v[92:95]
  ds_write_b128 v6, v[68:71] offset:13312
  v_mfma_f32_16x16x32_bf16 v[92:95], a[232:235], a[140:143], v[92:95]
  v_mfma_f32_16x16x32_bf16 v[92:95], a[236:239], a[156:159], v[92:95]
  s_nop 0
  v_cvt_pk_bf16_f32 v74, v88, v89
  v_cvt_pk_bf16_f32 v75, v90, v91
  ds_write_b128 v6, v[72:75] offset:14336
  s_nop 3
  v_cvt_pk_bf16_f32 v78, v92, v93
  v_cvt_pk_bf16_f32 v79, v94, v95
  ds_write_b128 v6, v[76:79] offset:15360
  s_add_u32 s53, s37, 5120
  buffer_store_dwordx4 v[108:111], v15, s[28:31], s53 offen sc1
  s_add_u32 s53, s40, 0
  buffer_store_dwordx4 v[128:131], v15, s[28:31], s53 offen sc1
  s_add_u32 s53, s41, 0
  buffer_store_dwordx4 v[136:139], v15, s[28:31], s53 offen sc1
  buffer_load_dword v26, v25, s[28:31], 0 offen sc1
  v_cndmask_b32 v14, 0, v29, vcc
  v_cndmask_b32 v15, 0, v29, s[72:73]
  v_mov_b32 v6, v25
  s_waitcnt lgkmcnt(0)
  s_barrier
  ds_read_b128 a[0:3], v21 offset:0
  ds_read_b128 a[16:19], v21 offset:4096
  ds_read_b128 a[32:35], v21 offset:8192
  ds_read_b128 a[48:51], v21 offset:12288
  ds_read_b128 a[4:7], v21 offset:1024
  ds_read_b128 a[20:23], v21 offset:5120
  ds_read_b128 a[36:39], v21 offset:9216
  ds_read_b128 a[52:55], v21 offset:13312
  ds_read_b128 a[8:11], v22 offset:0
  ds_read_b128 a[24:27], v22 offset:4096
  ds_read_b128 a[40:43], v22 offset:8192
  ds_read_b128 a[56:59], v22 offset:12288
  ds_read_b128 a[12:15], v22 offset:1024
  ds_read_b128 a[28:31], v22 offset:5120
  s_mov_b64 exec, 0
  s_cmp_eq_u32 s48, 0
  s_cbranch_scc1 HS15
  s_cmp_eq_u32 s48, 1
  s_cbranch_scc1 HS19
  s_cmp_eq_u32 s48, 2
  s_cbranch_scc1 HS22
  s_branch HS25
HOPR_b:
  s_mov_b64 exec, -1
  ds_read_b128 a[44:47], v22 offset:9216
  ds_read_b128 a[60:63], v22 offset:13312
  ds_write_b128 v19, v[168:171] offset:34816
  ds_write_b128 v17, v[192:195] offset:36864
  ds_write_b128 v19, v[200:203] offset:36864
  ds_write_b128 v17, v[224:227] offset:38912
  ds_write_b128 v19, v[232:235] offset:38912
  v_add_u32 v21, 65536, v21
  v_add_u32 v22, 65536, v22
L_blk:
  s_mov_b32 s69, 0
L_retry:
  s_mov_b32 s61, 0
  s_mov_b32 s62, s57
  s_cmp_eq_u32 s57, 0
  s_cselect_b32 s60, 1, 0
  s_cmp_ge_u32 s48, 2
  s_cbranch_scc1 L_d2
  v_add_f32 v48, v32, v8
  v_add_f32 v49, v33, v9
  v_add_f32 v50, v34, v10
  v_add_f32 v51, v35, v11
  s_waitcnt lgkmcnt(14)
  s_nop 0
  v_mfma_f32_16x16x32_bf16 v[48:51], a[64:67], a[0:3], v[48:51]
  ds_read_b128 a[80:83], v1 offset:4096
  v_mfma_f32_16x16x32_bf16 v[48:51], a[68:71], a[16:19], v[48:51]
  ds_read_b128 a[84:87], v1 offset:5120
  v_mfma_f32_16x16x32_bf16 v[48:51], a[72:75], a[32:35], v[48:51]
  ds_read_b128 a[88:91], v1 offset:6144
  v_mfma_f32_16x16x32_bf16 v[48:51], a[76:79], a[48:51], v[48:51]
  s_waitcnt lgkmcnt(14)
  ds_read_b128 a[92:95], v1 offset:7168
  v_mfma_f32_16x16x32_bf16 v[52:55], a[64:67], a[4:7], v[36:39]
  ds_read_b128 a[96:99], v1 offset:8192
  v_mfma_f32_16x16x32_bf16 v[52:55], a[68:71], a[20:23], v[52:55]
  ds_read_b128 a[100:103], v1 offset:9216
  v_mfma_f32_16x16x32_bf16 v[52:55], a[72:75], a[36:39], v[52:55]
  ds_read_b128 a[104:107], v1 offset:10240
  v_mfma_f32_16x16x32_bf16 v[52:55], a[76:79], a[52:55], v[52:55]
  s_waitcnt lgkmcnt(14)
  ds_read_b128 a[108:111], v1 offset:11264
  v_exp_f32 v48, v48
  v_mfma_f32_16x16x32_bf16 v[56:59], a[64:67], a[8:11], v[40:43]
  ds_read_b128 a[112:115], v1 offset:12288
  v_exp_f32 v49, v49
  v_mfma_f32_16x16x32_bf16 v[56:59], a[68:71], a[24:27], v[56:59]
  ds_read_b128 a[116:119], v1 offset:13312
  v_exp_f32 v50, v50
  v_mfma_f32_16x16x32_bf16 v[56:59], a[72:75], a[40:43], v[56:59]
  ds_read_b128 a[120:123], v1 offset:14336
  v_exp_f32 v51, v51
  v_cvt_pk_bf16_f32 v64, v48, v49
  v_mfma_f32_16x16x32_bf16 v[56:59], a[76:79], a[56:59], v[56:59]
  s_waitcnt lgkmcnt(14)
  ds_read_b128 a[124:127], v1 offset:15360
  v_exp_f32 v52, v52
  v_cvt_pk_bf16_f32 v65, v50, v51
  v_mfma_f32_16x16x32_bf16 v[60:63], a[64:67], a[12:15], v[44:47]
  v_exp_f32 v53, v53
  v_add_f32 v48, v32, v12
  v_add_f32 v49, v33, v13
  v_mfma_f32_16x16x32_bf16 v[60:63], a[68:71], a[28:31], v[60:63]
  v_exp_f32 v54, v54
  v_add_f32 v50, v34, v14
  v_add_f32 v51, v35, v15
  v_mfma_f32_16x16x32_bf16 v[60:63], a[72:75], a[44:47], v[60:63]
  s_mov_b32 s70, s62
  v_exp_f32 v55, v55
  v_cvt_pk_bf16_f32 v68, v52, v53
  v_mfma_f32_16x16x32_bf16 v[60:63], a[76:79], a[60:63], v[60:63]
  s_waitcnt lgkmcnt(8)
  s_mov_b32 s62, s60
  v_exp_f32 v56, v56
  v_cvt_pk_bf16_f32 v69, v54, v55
  v_mfma_f32_16x16x32_bf16 v[48:51], a[80:83], a[0:3], v[48:51]
  s_lshl_b32 s66, s60, 15
  v_exp_f32 v57, v57
  v_mfma_f32_16x16x32_bf16 v[48:51], a[84:87], a[16:19], v[48:51]
  s_add_u32 s66, s66, s64
  v_exp_f32 v58, v58
  v_mfma_f32_16x16x32_bf16 v[48:51], a[88:91], a[32:35], v[48:51]
  s_add_u32 s60, s60, 1
  v_exp_f32 v59, v59
  v_cvt_pk_bf16_f32 v72, v56, v57
  v_mfma_f32_16x16x32_bf16 v[48:51], a[92:95], a[48:51], v[48:51]
  s_cmp_eq_u32 s60, s57
  s_addc_u32 s60, s60, 0
  v_exp_f32 v60, v60
  v_cvt_pk_bf16_f32 v73, v58, v59
  v_mfma_f32_16x16x32_bf16 v[52:55], a[80:83], a[4:7], v[36:39]
  s_add_u32 s52, s61, 1
  v_exp_f32 v61, v61
  v_mfma_f32_16x16x32_bf16 v[52:55], a[84:87], a[20:23], v[52:55]
  s_cmp_gt_u32 s58, s52
  s_cselect_b32 s66, s66, s63
  v_exp_f32 v62, v62
  v_mfma_f32_16x16x32_bf16 v[52:55], a[88:91], a[36:39], v[52:55]
  s_cmp_gt_u32 s58, s52
  s_cselect_b32 s80, s56, s77
  v_exp_f32 v63, v63
  v_cvt_pk_bf16_f32 v76, v60, v61
  v_mfma_f32_16x16x32_bf16 v[52:55], a[92:95], a[52:55], v[52:55]
  v_exp_f32 v48, v48
  v_cvt_pk_bf16_f32 v77, v62, v63
  v_mfma_f32_16x16x32_bf16 v[56:59], a[80:83], a[8:11], v[40:43]
  v_exp_f32 v49, v49
  v_mfma_f32_16x16x32_bf16 v[56:59], a[84:87], a[24:27], v[56:59]
  v_exp_f32 v50, v50
  v_mfma_f32_16x16x32_bf16 v[56:59], a[88:91], a[40:43], v[56:59]
  v_exp_f32 v51, v51
  v_cvt_pk_bf16_f32 v66, v48, v49
  v_mfma_f32_16x16x32_bf16 v[56:59], a[92:95], a[56:59], v[56:59]
  v_exp_f32 v52, v52
  v_cvt_pk_bf16_f32 v67, v50, v51
  v_mfma_f32_16x16x32_bf16 v[60:63], a[80:83], a[12:15], v[44:47]
  v_exp_f32 v53, v53
  v_add_f32 v48, v44, v8
  v_add_f32 v49, v45, v9
  v_mfma_f32_16x16x32_bf16 v[60:63], a[84:87], a[28:31], v[60:63]
  v_exp_f32 v54, v54
  v_add_f32 v50, v46, v10
  v_add_f32 v51, v47, v11
  v_mfma_f32_16x16x32_bf16 v[60:63], a[88:91], a[44:47], v[60:63]
  v_exp_f32 v55, v55
  v_cvt_pk_bf16_f32 v70, v52, v53
  s_waitcnt vmcnt(8) lgkmcnt(0)
  s_barrier
  v_mfma_f32_16x16x32_bf16 v[60:63], a[92:95], a[60:63], v[60:63]
  ds_read_b128 a[64:67], v1 offset:32768
  v_exp_f32 v56, v56
  v_cvt_pk_bf16_f32 v71, v54, v55
  v_mfma_f32_16x16x32_bf16 v[48:51], a[96:99], a[12:15], v[48:51]
  ds_read_b128 a[128:131], v2 offset:32768
  v_exp_f32 v57, v57
  v_add_f32 v52, v44, v12
  v_add_f32 v53, v45, v13
  v_mfma_f32_16x16x32_bf16 v[48:51], a[100:103], a[28:31], v[48:51]
  ds_read_b128 a[68:71], v1 offset:33792
  v_exp_f32 v58, v58
  v_add_f32 v54, v46, v14
  v_add_f32 v55, v47, v15
  v_mfma_f32_16x16x32_bf16 v[48:51], a[104:107], a[44:47], v[48:51]
  ds_read_b128 a[132:135], v2 offset:33792
  v_exp_f32 v59, v59
  v_cvt_pk_bf16_f32 v74, v56, v57
  v_mfma_f32_16x16x32_bf16 v[48:51], a[108:111], a[60:63], v[48:51]
  ds_read_b128 a[72:75], v1 offset:34816
  v_exp_f32 v60, v60
  v_cvt_pk_bf16_f32 v75, v58, v59
  v_mfma_f32_16x16x32_bf16 v[52:55], a[112:115], a[12:15], v[52:55]
  ds_read_b128 a[136:139], v2 offset:34816
  v_exp_f32 v61, v61
  v_mfma_f32_16x16x32_bf16 v[52:55], a[116:119], a[28:31], v[52:55]
  ds_read_b128 a[76:79], v1 offset:35840
  v_exp_f32 v62, v62
  v_mfma_f32_16x16x32_bf16 v[52:55], a[120:123], a[44:47], v[52:55]
  ds_read_b128 a[140:143], v2 offset:35840
  v_exp_f32 v63, v63
  v_cvt_pk_bf16_f32 v78, v60, v61
  v_mfma_f32_16x16x32_bf16 v[52:55], a[124:127], a[60:63], v[52:55]
  v_exp_f32 v48, v48
  v_cvt_pk_bf16_f32 v79, v62, v63
  v_exp_f32 v49, v49
  v_exp_f32 v50, v50
  v_exp_f32 v51, v51
  v_cvt_pk_bf16_f32 v92, v48, v49
  v_cvt_pk_bf16_f32 v93, v50, v51
  s_nop 0
  v_exp_f32 v52, v52
  v_exp_f32 v53, v53
  v_exp_f32 v54, v54
  v_exp_f32 v55, v55
  v_cvt_pk_bf16_f32 v94, v52, v53
  v_cvt_pk_bf16_f32 v95, v54, v55
  s_or_b32 s52, s68, s69
  s_cmp_lg_u32 s52, 0
  s_cbranch_scc1 L_g0
  s_waitcnt vmcnt(0)
  v_cmp_gt_u32 vcc, 32, v26
  s_nop 0
  s_cbranch_vccnz L_pk0_w
L_pk0_ok:
  s_waitcnt lgkmcnt(7)
  v_mfma_f32_16x16x32_bf16 v[48:51], a[64:67], a[0:3], v[32:35]
  s_add_u32 m0, s80, 0
  ds_write_b128 v17, v[144:147] offset:0
  s_waitcnt lgkmcnt(6)
  v_mfma_f32_16x16x32_bf16 v[48:51], a[68:71], a[16:19], v[48:51]
  buffer_load_dwordx4 v5, s[28:31], s66 offen offset:0 sc1 lds
  s_waitcnt lgkmcnt(4)
  v_mfma_f32_16x16x32_bf16 v[48:51], a[72:75], a[32:35], v[48:51]
  ds_read_b128 a[80:83], v1 offset:36864
  s_waitcnt lgkmcnt(3)
  v_mfma_f32_16x16x32_bf16 v[48:51], a[76:79], a[48:51], v[48:51]
  ds_read_b128 a[144:147], v2 offset:36864
  v_mfma_f32_16x16x32_bf16 v[128:131], a[128:131], v[64:67], 0
  buffer_load_dwordx4 v5, s[28:31], s66 offen offset:1024 sc1 lds
  v_mfma_f32_16x16x32_bf16 v[132:135], a[128:131], v[68:71], 0
  ds_read_b128 a[84:87], v1 offset:37888
  v_mfma_f32_16x16x32_bf16 v[52:55], a[64:67], a[4:7], v[36:39]
  v_mfma_f32_16x16x32_bf16 v[52:55], a[68:71], a[20:23], v[52:55]
  ds_read_b128 a[148:151], v2 offset:37888
  v_exp_f32 v48, v48
  v_mfma_f32_16x16x32_bf16 v[52:55], a[72:75], a[36:39], v[52:55]
  buffer_load_dwordx4 v5, s[28:31], s66 offen offset:2048 sc1 lds
  v_exp_f32 v49, v49
  v_mfma_f32_16x16x32_bf16 v[52:55], a[76:79], a[52:55], v[52:55]
  ds_write_b128 v19, v[152:155] offset:0
  v_cvt_pk_bf16_f32 v96, v48, v49
  v_mfma_f32_16x16x32_bf16 v[140:143], a[128:131], v[76:79], 0
  v_exp_f32 v50, v50
  s_add_u32 s53, s40, 2048
  v_mfma_f32_16x16x32_bf16 v[140:143], a[132:135], v[92:95], v[140:143]
  buffer_store_dwordx4 v[160:163], v3, s[28:31], s53 offen sc1
  v_mfma_f32_16x16x32_bf16 v[136:139], a[128:131], v[72:75], 0
  ds_read_b128 a[88:91], v1 offset:38912
  v_exp_f32 v51, v51
  v_mfma_f32_16x16x32_bf16 v[56:59], a[64:67], a[8:11], v[40:43]
  buffer_load_dwordx4 v5, s[28:31], s66 offen offset:3072 sc1 lds
  v_cvt_pk_bf16_f32 v97, v50, v51
  v_mfma_f32_16x16x32_bf16 v[56:59], a[68:71], a[24:27], v[56:59]
  s_add_u32 m0, s80, 4096
  ds_read_b128 a[152:155], v2 offset:38912
  v_exp_f32 v52, v52
  v_mfma_f32_16x16x32_bf16 v[56:59], a[72:75], a[40:43], v[56:59]
  s_add_u32 s66, s66, 4096
  v_exp_f32 v53, v53
  v_mfma_f32_16x16x32_bf16 v[56:59], a[76:79], a[56:59], v[56:59]
  ds_write_b128 v17, v[176:179] offset:2048
  ds_read_b128 a[92:95], v1 offset:39936
  v_mfma_f32_16x16x32_bf16 v[144:147], a[136:139], v[64:67], 0
  v_exp_f32 v54, v54
  v_cvt_pk_bf16_f32 v100, v52, v53
  v_mfma_f32_16x16x32_bf16 v[148:151], a[136:139], v[68:71], 0
HS7:
  s_cbranch_execz HS11
  buffer_load_dwordx4 v5, s[28:31], s66 offen offset:0 sc1 lds
  v_mfma_f32_16x16x32_bf16 a[164:167], a[160:163], v[64:67], 0
  ds_read_b128 a[156:159], v2 offset:39936
  v_exp_f32 v55, v55
  v_mfma_f32_16x16x32_bf16 v[60:63], a[64:67], a[12:15], v[44:47]
  buffer_load_dwordx4 v5, s[28:31], s66 offen offset:1024 sc1 lds
  v_cvt_pk_bf16_f32 v101, v54, v55
  v_mfma_f32_16x16x32_bf16 v[60:63], a[68:71], a[28:31], v[60:63]
  v_exp_f32 v56, v56
  v_mfma_f32_16x16x32_bf16 v[60:63], a[72:75], a[44:47], v[60:63]
  v_exp_f32 v57, v57
  s_add_u32 s53, s41, 2048
  v_mfma_f32_16x16x32_bf16 v[60:63], a[76:79], a[60:63], v[60:63]
  buffer_store_dwordx4 v[168:171], v3, s[28:31], s53 offen sc1
  v_mfma_f32_16x16x32_bf16 v[156:159], a[136:139], v[76:79], 0
  buffer_load_dwordx4 v5, s[28:31], s66 offen offset:2048 sc1 lds
  v_exp_f32 v58, v58
  s_waitcnt lgkmcnt(11)
  v_mfma_f32_16x16x32_bf16 v[156:159], a[140:143], v[92:95], v[156:159]
  ds_write_b128 v19, v[184:187] offset:2048
  v_cvt_pk_bf16_f32 v104, v56, v57
  v_mfma_f32_16x16x32_bf16 v[152:155], a[136:139], v[72:75], 0
  s_waitcnt lgkmcnt(0)
  v_exp_f32 v59, v59
  v_mfma_f32_16x16x32_bf16 v[48:51], a[80:83], a[0:3], v[32:35]
  buffer_load_dwordx4 v5, s[28:31], s66 offen offset:3072 sc1 lds
  v_mfma_f32_16x16x32_bf16 v[48:51], a[84:87], a[16:19], v[48:51]
  ds_read_b128 a[96:99], v1 offset:40960
  v_exp_f32 v60, v60
  v_mfma_f32_16x16x32_bf16 v[48:51], a[88:91], a[32:35], v[48:51]
  v_exp_f32 v61, v61
  v_mfma_f32_16x16x32_bf16 v[48:51], a[92:95], a[48:51], v[48:51]
  ds_read_b128 a[128:131], v2 offset:40960
  v_cvt_pk_bf16_f32 v105, v58, v59
  v_mfma_f32_16x16x32_bf16 v[160:163], a[144:147], v[64:67], 0
  v_exp_f32 v62, v62
  v_mfma_f32_16x16x32_bf16 v[164:167], a[144:147], v[68:71], 0
  ds_read_b128 a[100:103], v1 offset:41984
  v_exp_f32 v63, v63
  v_mfma_f32_16x16x32_bf16 v[52:55], a[80:83], a[4:7], v[36:39]
  ds_write_b128 v17, v[208:211] offset:4096
  v_cvt_pk_bf16_f32 v108, v60, v61
  v_mfma_f32_16x16x32_bf16 v[52:55], a[84:87], a[20:23], v[52:55]
  v_exp_f32 v48, v48
  v_mfma_f32_16x16x32_bf16 v[52:55], a[88:91], a[36:39], v[52:55]
  v_exp_f32 v49, v49
  v_mfma_f32_16x16x32_bf16 v[52:55], a[92:95], a[52:55], v[52:55]
  ds_read_b128 a[132:135], v2 offset:41984
  v_cvt_pk_bf16_f32 v109, v62, v63
  v_cvt_pk_bf16_f32 v98, v48, v49
  v_mfma_f32_16x16x32_bf16 v[172:175], a[144:147], v[76:79], 0
  v_exp_f32 v50, v50
  s_add_u32 s53, s40, 4096
  v_mfma_f32_16x16x32_bf16 v[172:175], a[148:151], v[92:95], v[172:175]
  buffer_store_dwordx4 v[192:195], v3, s[28:31], s53 offen sc1
  v_mfma_f32_16x16x32_bf16 v[168:171], a[144:147], v[72:75], 0
  ds_read_b128 a[104:107], v1 offset:43008
  v_exp_f32 v51, v51
  v_mfma_f32_16x16x32_bf16 v[56:59], a[80:83], a[8:11], v[40:43]
  ds_write_b128 v19, v[216:219] offset:4096
  ds_read_b128 a[136:139], v2 offset:43008
  v_mfma_f32_16x16x32_bf16 v[56:59], a[84:87], a[24:27], v[56:59]
  v_exp_f32 v52, v52
  v_mfma_f32_16x16x32_bf16 v[56:59], a[88:91], a[40:43], v[56:59]
  v_exp_f32 v53, v53
  v_mfma_f32_16x16x32_bf16 v[56:59], a[92:95], a[56:59], v[56:59]
  ds_read_b128 a[108:111], v1 offset:44032
  v_cvt_pk_bf16_f32 v99, v50, v51
  v_mfma_f32_16x16x32_bf16 v[176:179], a[152:155], v[64:67], 0
  v_exp_f32 v54, v54
  v_mfma_f32_16x16x32_bf16 v[180:183], a[152:155], v[68:71], 0
  ds_read_b128 a[140:143], v2 offset:44032
  v_cvt_pk_bf16_f32 v102, v52, v53
  v_mfma_f32_16x16x32_bf16 a[168:171], a[160:163], v[68:71], 0
  v_exp_f32 v55, v55
  v_mfma_f32_16x16x32_bf16 v[60:63], a[80:83], a[12:15], v[44:47]
  v_cvt_pk_bf16_f32 v103, v54, v55
  v_mfma_f32_16x16x32_bf16 v[60:63], a[84:87], a[28:31], v[60:63]
  v_exp_f32 v56, v56
  v_mfma_f32_16x16x32_bf16 v[60:63], a[88:91], a[44:47], v[60:63]
  v_exp_f32 v57, v57
  v_mfma_f32_16x16x32_bf16 v[60:63], a[92:95], a[60:63], v[60:63]
  ds_write_b128 v17, v[240:243] offset:6144
  v_cvt_pk_bf16_f32 v106, v56, v57
  v_mfma_f32_16x16x32_bf16 v[188:191], a[152:155], v[76:79], 0
  v_exp_f32 v58, v58
  s_add_u32 s53, s41, 4096
  v_mfma_f32_16x16x32_bf16 v[188:191], a[156:159], v[92:95], v[188:191]
  buffer_store_dwordx4 v[200:203], v3, s[28:31], s53 offen sc1
  v_mfma_f32_16x16x32_bf16 v[184:187], a[152:155], v[72:75], 0
  s_waitcnt lgkmcnt(0)
  v_exp_f32 v59, v59
  v_mfma_f32_16x16x32_bf16 v[48:51], a[96:99], a[0:3], v[32:35]
  ds_read_b128 a[112:115], v1 offset:45056
  v_cvt_pk_bf16_f32 v107, v58, v59
  v_mfma_f32_16x16x32_bf16 v[48:51], a[100:103], a[16:19], v[48:51]
  v_exp_f32 v60, v60
  v_mfma_f32_16x16x32_bf16 v[48:51], a[104:107], a[32:35], v[48:51]
  ds_read_b128 a[144:147], v2 offset:45056
  v_exp_f32 v61, v61
  v_mfma_f32_16x16x32_bf16 v[48:51], a[108:111], a[48:51], v[48:51]
  ds_write_b128 v19, v[248:251] offset:6144
  v_cvt_pk_bf16_f32 v110, v60, v61
  v_mfma_f32_16x16x32_bf16 v[192:195], a[128:131], v[64:67], 0
  v_exp_f32 v62, v62
  v_mfma_f32_16x16x32_bf16 v[196:199], a[128:131], v[68:71], 0
  v_exp_f32 v63, v63
  s_add_u32 s53, s40, 6144
  v_mfma_f32_16x16x32_bf16 v[52:55], a[96:99], a[4:7], v[36:39]
  buffer_store_dwordx4 v[224:227], v3, s[28:31], s53 offen sc1
  v_mfma_f32_16x16x32_bf16 v[52:55], a[100:103], a[20:23], v[52:55]
  ds_read_b128 a[116:119], v1 offset:46080
  v_exp_f32 v48, v48
  v_mfma_f32_16x16x32_bf16 v[52:55], a[104:107], a[36:39], v[52:55]
  v_exp_f32 v49, v49
  v_mfma_f32_16x16x32_bf16 v[52:55], a[108:111], a[52:55], v[52:55]
  ds_read_b128 a[148:151], v2 offset:46080
  v_cvt_pk_bf16_f32 v111, v62, v63
  v_mfma_f32_16x16x32_bf16 v[204:207], a[128:131], v[76:79], 0
  v_exp_f32 v50, v50
  v_mfma_f32_16x16x32_bf16 v[204:207], a[132:135], v[92:95], v[204:207]
  ds_read_b128 a[120:123], v1 offset:47104
  v_cvt_pk_bf16_f32 v112, v48, v49
  v_mfma_f32_16x16x32_bf16 v[200:203], a[128:131], v[72:75], 0
  v_exp_f32 v51, v51
  v_mfma_f32_16x16x32_bf16 v[56:59], a[96:99], a[8:11], v[40:43]
  s_mov_b32 s70, s62
  ds_read_b128 a[152:155], v2 offset:47104
  v_cvt_pk_bf16_f32 v113, v50, v51
  v_mfma_f32_16x16x32_bf16 v[56:59], a[100:103], a[24:27], v[56:59]
  s_mov_b32 s62, s60
  v_exp_f32 v52, v52
  v_mfma_f32_16x16x32_bf16 v[56:59], a[104:107], a[40:43], v[56:59]
  s_lshl_b32 s66, s60, 15
  v_exp_f32 v53, v53
  s_add_u32 s53, s41, 6144
  v_mfma_f32_16x16x32_bf16 v[56:59], a[108:111], a[56:59], v[56:59]
  s_add_u32 s66, s66, s64
  buffer_store_dwordx4 v[232:235], v3, s[28:31], s53 offen sc1
  v_mfma_f32_16x16x32_bf16 v[208:211], a[136:139], v[64:67], 0
  s_add_u32 s60, s60, 1
  v_exp_f32 v54, v54
  v_mfma_f32_16x16x32_bf16 v[212:215], a[136:139], v[68:71], 0
  s_cmp_eq_u32 s60, s57
  s_addc_u32 s60, s60, 0
  ds_read_b128 a[124:127], v1 offset:48128
  v_cvt_pk_bf16_f32 v116, v52, v53
  v_mfma_f32_16x16x32_bf16 a[172:175], a[160:163], v[72:75], 0
  s_add_u32 s52, s61, 2
  v_exp_f32 v55, v55
  v_mfma_f32_16x16x32_bf16 v[60:63], a[96:99], a[12:15], v[44:47]
  s_cmp_gt_u32 s58, s52
  s_cselect_b32 s66, s66, s78
  ds_read_b128 a[156:159], v2 offset:48128
  v_mfma_f32_16x16x32_bf16 v[60:63], a[100:103], a[28:31], v[60:63]
  s_cmp_gt_u32 s58, s52
  s_cselect_b32 s80, s56, s77
  v_exp_f32 v56, v56
  v_mfma_f32_16x16x32_bf16 v[60:63], a[104:107], a[44:47], v[60:63]
  v_exp_f32 v57, v57
  v_mfma_f32_16x16x32_bf16 v[60:63], a[108:111], a[60:63], v[60:63]
  v_cvt_pk_bf16_f32 v117, v54, v55
  v_cvt_pk_bf16_f32 v120, v56, v57
  v_mfma_f32_16x16x32_bf16 v[220:223], a[136:139], v[76:79], 0
  v_exp_f32 v58, v58
  v_mfma_f32_16x16x32_bf16 v[220:223], a[140:143], v[92:95], v[220:223]
  v_mfma_f32_16x16x32_bf16 v[216:219], a[136:139], v[72:75], 0
  v_exp_f32 v59, v59
  s_waitcnt vmcnt(4) lgkmcnt(0)
  s_barrier
  v_mfma_f32_16x16x32_bf16 v[48:51], a[112:115], a[0:3], v[32:35]
  s_add_u32 m0, s80, 32768
  ds_read_b128 a[64:67], v1 offset:0
  v_cvt_pk_bf16_f32 v121, v58, v59
  v_mfma_f32_16x16x32_bf16 v[48:51], a[116:119], a[16:19], v[48:51]
  buffer_load_dwordx4 v5, s[28:31], s66 offen offset:0 sc1 lds
  v_exp_f32 v60, v60
  v_mfma_f32_16x16x32_bf16 v[48:51], a[120:123], a[32:35], v[48:51]
  v_exp_f32 v61, v61
  v_mfma_f32_16x16x32_bf16 v[48:51], a[124:127], a[48:51], v[48:51]
  ds_read_b128 a[128:131], v2 offset:0
  v_cvt_pk_bf16_f32 v124, v60, v61
  v_mfma_f32_16x16x32_bf16 v[224:227], a[144:147], v[64:67], 0
  buffer_load_dwordx4 v5, s[28:31], s66 offen offset:1024 sc1 lds
  v_exp_f32 v62, v62
  v_mfma_f32_16x16x32_bf16 v[228:231], a[144:147], v[68:71], 0
  v_exp_f32 v63, v63
  v_mfma_f32_16x16x32_bf16 v[52:55], a[112:115], a[4:7], v[36:39]
  ds_read_b128 a[68:71], v1 offset:1024
  v_cvt_pk_bf16_f32 v125, v62, v63
  v_mfma_f32_16x16x32_bf16 v[52:55], a[116:119], a[20:23], v[52:55]
  buffer_load_dwordx4 v5, s[28:31], s66 offen offset:2048 sc1 lds
  v_exp_f32 v48, v48
  v_mfma_f32_16x16x32_bf16 v[52:55], a[120:123], a[36:39], v[52:55]
  v_exp_f32 v49, v49
  v_mfma_f32_16x16x32_bf16 v[52:55], a[124:127], a[52:55], v[52:55]
  ds_read_b128 a[132:135], v2 offset:1024
  v_cvt_pk_bf16_f32 v114, v48, v49
  v_mfma_f32_16x16x32_bf16 v[236:239], a[144:147], v[76:79], 0
  v_exp_f32 v50, v50
  v_mfma_f32_16x16x32_bf16 v[236:239], a[148:151], v[92:95], v[236:239]
  buffer_load_dwordx4 v5, s[28:31], s66 offen offset:3072 sc1 lds
  v_mfma_f32_16x16x32_bf16 v[232:235], a[144:147], v[72:75], 0
  s_add_u32 m0, s80, 36864
  s_add_u32 s66, s66, 4096
  ds_read_b128 a[72:75], v1 offset:2048
  v_exp_f32 v51, v51
  v_mfma_f32_16x16x32_bf16 v[56:59], a[112:115], a[8:11], v[40:43]
  buffer_load_dwordx4 v5, s[28:31], s66 offen offset:0 sc1 lds
  v_mfma_f32_16x16x32_bf16 v[56:59], a[116:119], a[24:27], v[56:59]
  v_exp_f32 v52, v52
  v_mfma_f32_16x16x32_bf16 v[56:59], a[120:123], a[40:43], v[56:59]
  ds_read_b128 a[136:139], v2 offset:2048
  v_cvt_pk_bf16_f32 v115, v50, v51
  v_mfma_f32_16x16x32_bf16 v[56:59], a[124:127], a[56:59], v[56:59]
  ds_read_b128 a[76:79], v1 offset:3072
  v_exp_f32 v53, v53
  v_mfma_f32_16x16x32_bf16 v[240:243], a[152:155], v[64:67], 0
  buffer_load_dwordx4 v5, s[28:31], s66 offen offset:1024 sc1 lds
  v_mfma_f32_16x16x32_bf16 v[244:247], a[152:155], v[68:71], 0
  v_exp_f32 v54, v54
  v_mfma_f32_16x16x32_bf16 a[176:179], a[160:163], v[76:79], 0
  buffer_load_dwordx4 v5, s[28:31], s66 offen offset:2048 sc1 lds
  v_mfma_f32_16x16x32_bf16 a[176:179], a[160:163], v[92:95], a[176:179]
  v_exp_f32 v55, v55
  v_mfma_f32_16x16x32_bf16 v[60:63], a[112:115], a[12:15], v[44:47]
  ds_read_b128 a[140:143], v2 offset:3072
  v_cvt_pk_bf16_f32 v118, v52, v53
  v_mfma_f32_16x16x32_bf16 v[60:63], a[116:119], a[28:31], v[60:63]
  buffer_load_dwordx4 v5, s[28:31], s66 offen offset:3072 sc1 lds
  v_exp_f32 v56, v56
  v_mfma_f32_16x16x32_bf16 v[60:63], a[120:123], a[44:47], v[60:63]
  v_exp_f32 v57, v57
  v_mfma_f32_16x16x32_bf16 v[60:63], a[124:127], a[60:63], v[60:63]
  v_cvt_pk_bf16_f32 v119, v54, v55
  v_cvt_pk_bf16_f32 v122, v56, v57
  v_mfma_f32_16x16x32_bf16 v[252:255], a[152:155], v[76:79], 0
  v_exp_f32 v58, v58
  v_mfma_f32_16x16x32_bf16 v[252:255], a[156:159], v[92:95], v[252:255]
  s_add_u32 s61, s61, 1
  v_mfma_f32_16x16x32_bf16 v[248:251], a[152:155], v[72:75], 0
  s_waitcnt lgkmcnt(0)
  v_exp_f32 v59, v59
  s_nop 0
  v_cvt_pk_bf16_f32 v123, v58, v59
  s_branch L_it1
L_d2:
HS8:
  s_cbranch_execz HS12
  v_add_f32 v56, v44, v8
  v_add_f32 v57, v45, v9
  v_add_f32 v58, v46, v10
  v_add_f32 v59, v47, v11
  v_accvgpr_write_b32 a172, 0
  v_accvgpr_write_b32 a173, 0
  v_accvgpr_write_b32 a174, 0
  v_accvgpr_write_b32 a175, 0
  s_waitcnt lgkmcnt(14)
  v_mfma_f32_16x16x32_bf16 v[48:51], a[64:67], a[0:3], v[32:35]
  ds_read_b128 a[80:83], v1 offset:4096
  v_mfma_f32_16x16x32_bf16 v[48:51], a[68:71], a[16:19], v[48:51]
  ds_read_b128 a[84:87], v1 offset:5120
  v_mfma_f32_16x16x32_bf16 v[48:51], a[72:75], a[32:35], v[48:51]
  ds_read_b128 a[88:91], v1 offset:6144
  v_mfma_f32_16x16x32_bf16 v[48:51], a[76:79], a[48:51], v[48:51]
  s_waitcnt lgkmcnt(14)
  ds_read_b128 a[92:95], v1 offset:7168
  v_mfma_f32_16x16x32_bf16 v[52:55], a[64:67], a[4:7], v[36:39]
  ds_read_b128 a[96:99], v1 offset:8192
  v_mfma_f32_16x16x32_bf16 v[52:55], a[68:71], a[20:23], v[52:55]
  ds_read_b128 a[100:103], v1 offset:9216
  v_mfma_f32_16x16x32_bf16 v[52:55], a[72:75], a[36:39], v[52:55]
  ds_read_b128 a[104:107], v1 offset:10240
  v_mfma_f32_16x16x32_bf16 v[52:55], a[76:79], a[52:55], v[52:55]
  s_waitcnt lgkmcnt(12)
  ds_read_b128 a[108:111], v1 offset:11264
  v_exp_f32 v48, v48
  v_mfma_f32_16x16x32_bf16 v[56:59], a[64:67], a[12:15], v[56:59]
  ds_read_b128 a[112:115], v1 offset:12288
  v_exp_f32 v49, v49
  v_mfma_f32_16x16x32_bf16 v[56:59], a[68:71], a[28:31], v[56:59]
  ds_read_b128 a[116:119], v1 offset:13312
  v_exp_f32 v50, v50
  v_mfma_f32_16x16x32_bf16 v[56:59], a[72:75], a[44:47], v[56:59]
  ds_read_b128 a[120:123], v1 offset:14336
  v_exp_f32 v51, v51
  v_cvt_pk_bf16_f32 v64, v48, v49
  v_mfma_f32_16x16x32_bf16 v[56:59], a[76:79], a[60:63], v[56:59]
  s_waitcnt lgkmcnt(7)
  ds_read_b128 a[124:127], v1 offset:15360
  v_exp_f32 v52, v52
  v_cvt_pk_bf16_f32 v65, v50, v51
  v_mfma_f32_16x16x32_bf16 v[60:63], a[80:83], a[0:3], v[32:35]
  v_exp_f32 v53, v53
  v_mfma_f32_16x16x32_bf16 v[60:63], a[84:87], a[16:19], v[60:63]
  v_exp_f32 v54, v54
  v_mfma_f32_16x16x32_bf16 v[60:63], a[88:91], a[32:35], v[60:63]
  s_mov_b32 s70, s62
  v_exp_f32 v55, v55
  v_cvt_pk_bf16_f32 v68, v52, v53
  v_mfma_f32_16x16x32_bf16 v[60:63], a[92:95], a[48:51], v[60:63]
  s_mov_b32 s62, s60
  v_exp_f32 v56, v56
  v_cvt_pk_bf16_f32 v69, v54, v55
  v_mfma_f32_16x16x32_bf16 v[48:51], a[80:83], a[4:7], v[36:39]
  s_lshl_b32 s66, s60, 15
  v_exp_f32 v57, v57
  v_add_f32 v52, v44, v12
  v_add_f32 v53, v45, v13
  v_mfma_f32_16x16x32_bf16 v[48:51], a[84:87], a[20:23], v[48:51]
  s_add_u32 s66, s66, s64
  v_exp_f32 v58, v58
  v_add_f32 v54, v46, v14
  v_add_f32 v55, v47, v15
  v_mfma_f32_16x16x32_bf16 v[48:51], a[88:91], a[36:39], v[48:51]
  s_add_u32 s60, s60, 1
  v_exp_f32 v59, v59
  v_cvt_pk_bf16_f32 v76, v56, v57
  v_mfma_f32_16x16x32_bf16 v[48:51], a[92:95], a[52:55], v[48:51]
  s_cmp_eq_u32 s60, s57
  s_addc_u32 s60, s60, 0
  v_exp_f32 v60, v60
  v_cvt_pk_bf16_f32 v77, v58, v59
  v_mfma_f32_16x16x32_bf16 v[52:55], a[80:83], a[12:15], v[52:55]
  s_add_u32 s52, s61, 1
  v_exp_f32 v61, v61
  v_add_f32 v56, v32, v8
  v_add_f32 v57, v33, v9
  v_mfma_f32_16x16x32_bf16 v[52:55], a[84:87], a[28:31], v[52:55]
  s_cmp_gt_u32 s58, s52
  s_cselect_b32 s66, s66, s63
  v_exp_f32 v62, v62
  v_add_f32 v58, v34, v10
  v_add_f32 v59, v35, v11
  v_mfma_f32_16x16x32_bf16 v[52:55], a[88:91], a[44:47], v[52:55]
  s_cmp_gt_u32 s58, s52
  s_cselect_b32 s80, s56, s77
  v_exp_f32 v63, v63
  v_cvt_pk_bf16_f32 v66, v60, v61
  v_mfma_f32_16x16x32_bf16 v[52:55], a[92:95], a[60:63], v[52:55]
  s_waitcnt lgkmcnt(4)
  v_exp_f32 v48, v48
  v_cvt_pk_bf16_f32 v67, v62, v63
  v_mfma_f32_16x16x32_bf16 v[56:59], a[96:99], a[0:3], v[56:59]
  v_exp_f32 v49, v49
  v_mfma_f32_16x16x32_bf16 v[56:59], a[100:103], a[16:19], v[56:59]
  v_exp_f32 v50, v50
  v_mfma_f32_16x16x32_bf16 v[56:59], a[104:107], a[32:35], v[56:59]
  v_exp_f32 v51, v51
  v_cvt_pk_bf16_f32 v70, v48, v49
  v_mfma_f32_16x16x32_bf16 v[56:59], a[108:111], a[48:51], v[56:59]
  v_exp_f32 v52, v52
  v_cvt_pk_bf16_f32 v71, v50, v51
  v_mfma_f32_16x16x32_bf16 v[60:63], a[96:99], a[4:7], v[36:39]
  v_exp_f32 v53, v53
  v_add_f32 v48, v32, v12
  v_add_f32 v49, v33, v13
  v_mfma_f32_16x16x32_bf16 v[60:63], a[100:103], a[20:23], v[60:63]
  v_exp_f32 v54, v54
  v_add_f32 v50, v34, v14
  v_add_f32 v51, v35, v15
  v_mfma_f32_16x16x32_bf16 v[60:63], a[104:107], a[36:39], v[60:63]
  v_exp_f32 v55, v55
  v_cvt_pk_bf16_f32 v78, v52, v53
  s_waitcnt vmcnt(8) lgkmcnt(0)
  s_barrier
  v_mfma_f32_16x16x32_bf16 v[60:63], a[108:111], a[52:55], v[60:63]
  ds_read_b128 a[64:67], v1 offset:32768
  v_exp_f32 v56, v56
  v_cvt_pk_bf16_f32 v79, v54, v55
  v_mfma_f32_16x16x32_bf16 v[48:51], a[112:115], a[0:3], v[48:51]
  ds_read_b128 a[128:131], v2 offset:32768
  v_exp_f32 v57, v57
  v_mfma_f32_16x16x32_bf16 v[48:51], a[116:119], a[16:19], v[48:51]
  ds_read_b128 a[68:71], v1 offset:33792
  v_exp_f32 v58, v58
  v_mfma_f32_16x16x32_bf16 v[48:51], a[120:123], a[32:35], v[48:51]
  ds_read_b128 a[132:135], v2 offset:33792
  v_exp_f32 v59, v59
  v_cvt_pk_bf16_f32 v80, v56, v57
  v_mfma_f32_16x16x32_bf16 v[48:51], a[124:127], a[48:51], v[48:51]
  ds_read_b128 a[72:75], v1 offset:34816
  v_exp_f32 v60, v60
  v_cvt_pk_bf16_f32 v81, v58, v59
  v_mfma_f32_16x16x32_bf16 v[52:55], a[112:115], a[4:7], v[36:39]
  ds_read_b128 a[136:139], v2 offset:34816
  v_exp_f32 v61, v61
  v_mfma_f32_16x16x32_bf16 v[52:55], a[116:119], a[20:23], v[52:55]
  ds_read_b128 a[76:79], v1 offset:35840
  v_exp_f32 v62, v62
  v_mfma_f32_16x16x32_bf16 v[52:55], a[120:123], a[36:39], v[52:55]
  ds_read_b128 a[140:143], v2 offset:35840
  v_exp_f32 v63, v63
  v_cvt_pk_bf16_f32 v84, v60, v61
  v_mfma_f32_16x16x32_bf16 v[52:55], a[124:127], a[52:55], v[52:55]
  v_exp_f32 v48, v48
  v_cvt_pk_bf16_f32 v85, v62, v63
  v_exp_f32 v49, v49
  v_exp_f32 v50, v50
  v_exp_f32 v51, v51
  v_cvt_pk_bf16_f32 v82, v48, v49
  v_cvt_pk_bf16_f32 v83, v50, v51
  s_nop 0
  v_exp_f32 v52, v52
  v_exp_f32 v53, v53
  v_exp_f32 v54, v54
  v_exp_f32 v55, v55
  v_cvt_pk_bf16_f32 v86, v52, v53
  v_cvt_pk_bf16_f32 v87, v54, v55
  s_or_b32 s52, s68, s69
  s_cmp_lg_u32 s52, 0
  s_cbranch_scc1 L_g1
  s_waitcnt vmcnt(0)
  v_cmp_gt_u32 vcc, 32, v26
  s_nop 0
  s_cbranch_vccnz L_pk1_w
L_pk1_ok:
  s_waitcnt lgkmcnt(7)
  v_mfma_f32_16x16x32_bf16 v[48:51], a[64:67], a[0:3], v[32:35]
  s_add_u32 m0, s80, 0
  ds_write_b128 v17, v[144:147] offset:0
  s_waitcnt lgkmcnt(6)
  v_mfma_f32_16x16x32_bf16 v[48:51], a[68:71], a[16:19], v[48:51]
  buffer_load_dwordx4 v5, s[28:31], s66 offen offset:0 sc1 lds
  s_waitcnt lgkmcnt(4)
  v_mfma_f32_16x16x32_bf16 v[48:51], a[72:75], a[32:35], v[48:51]
  ds_read_b128 a[80:83], v1 offset:36864
  v_mov_b32 v136, 0
  v_mov_b32 v137, 0
  s_waitcnt lgkmcnt(3)
  v_mfma_f32_16x16x32_bf16 v[48:51], a[76:79], a[48:51], v[48:51]
  v_mov_b32 v138, 0
  v_mov_b32 v139, 0
  v_mfma_f32_16x16x32_bf16 v[132:135], a[128:131], v[68:71], 0
  buffer_load_dwordx4 v5, s[28:31], s66 offen offset:1024 sc1 lds
  v_mfma_f32_16x16x32_bf16 v[132:135], a[132:135], v[84:87], v[132:135]
  ds_read_b128 a[144:147], v2 offset:36864
  v_mfma_f32_16x16x32_bf16 v[140:143], a[128:131], v[76:79], 0
  ds_read_b128 a[84:87], v1 offset:37888
  v_mfma_f32_16x16x32_bf16 v[52:55], a[64:67], a[4:7], v[36:39]
  v_mfma_f32_16x16x32_bf16 v[52:55], a[68:71], a[20:23], v[52:55]
  buffer_load_dwordx4 v5, s[28:31], s66 offen offset:2048 sc1 lds
  v_exp_f32 v48, v48
  v_mfma_f32_16x16x32_bf16 v[52:55], a[72:75], a[36:39], v[52:55]
  ds_read_b128 a[148:151], v2 offset:37888
  v_exp_f32 v49, v49
  v_mfma_f32_16x16x32_bf16 v[52:55], a[76:79], a[52:55], v[52:55]
  ds_write_b128 v19, v[152:155] offset:0
  v_cvt_pk_bf16_f32 v96, v48, v49
  v_mfma_f32_16x16x32_bf16 v[128:131], a[128:131], v[64:67], 0
  ds_read_b128 a[88:91], v1 offset:38912
  v_exp_f32 v50, v50
  v_mfma_f32_16x16x32_bf16 v[128:131], a[132:135], v[80:83], v[128:131]
  v_exp_f32 v51, v51
  s_add_u32 s53, s40, 2048
  v_mfma_f32_16x16x32_bf16 v[56:59], a[64:67], a[8:11], v[40:43]
  buffer_store_dwordx4 v[160:163], v3, s[28:31], s53 offen sc1
  v_cvt_pk_bf16_f32 v97, v50, v51
  v_mfma_f32_16x16x32_bf16 v[56:59], a[68:71], a[24:27], v[56:59]
  ds_read_b128 a[152:155], v2 offset:38912
  v_exp_f32 v52, v52
  v_mfma_f32_16x16x32_bf16 v[56:59], a[72:75], a[40:43], v[56:59]
  buffer_load_dwordx4 v5, s[28:31], s66 offen offset:3072 sc1 lds
  v_mfma_f32_16x16x32_bf16 v[56:59], a[76:79], a[56:59], v[56:59]
  s_add_u32 m0, s80, 4096
  v_exp_f32 v53, v53
  v_mfma_f32_16x16x32_bf16 v[148:151], a[136:139], v[68:71], 0
  s_add_u32 s66, s66, 4096
  ds_write_b128 v17, v[176:179] offset:2048
  v_mov_b32 v152, 0
  s_waitcnt lgkmcnt(9)
  v_mfma_f32_16x16x32_bf16 v[148:151], a[140:143], v[84:87], v[148:151]
  ds_read_b128 a[92:95], v1 offset:39936
  v_exp_f32 v54, v54
  v_mfma_f32_16x16x32_bf16 v[156:159], a[136:139], v[76:79], 0
  buffer_load_dwordx4 v5, s[28:31], s66 offen offset:0 sc1 lds
  v_cvt_pk_bf16_f32 v100, v52, v53
  v_mfma_f32_16x16x32_bf16 a[164:167], a[160:163], v[64:67], 0
  ds_read_b128 a[156:159], v2 offset:39936
  v_exp_f32 v55, v55
  v_mfma_f32_16x16x32_bf16 a[164:167], a[160:163], v[80:83], a[164:167]
  buffer_load_dwordx4 v5, s[28:31], s66 offen offset:1024 sc1 lds
  v_cvt_pk_bf16_f32 v101, v54, v55
  v_mfma_f32_16x16x32_bf16 v[60:63], a[64:67], a[12:15], v[44:47]
  v_mov_b32 v153, 0
  v_mov_b32 v154, 0
  s_add_u32 s53, s41, 2048
  v_mfma_f32_16x16x32_bf16 v[60:63], a[68:71], a[28:31], v[60:63]
  buffer_store_dwordx4 v[168:171], v3, s[28:31], s53 offen sc1
  v_exp_f32 v56, v56
  v_mfma_f32_16x16x32_bf16 v[60:63], a[72:75], a[44:47], v[60:63]
  buffer_load_dwordx4 v5, s[28:31], s66 offen offset:2048 sc1 lds
  v_exp_f32 v57, v57
  v_mfma_f32_16x16x32_bf16 v[60:63], a[76:79], a[60:63], v[60:63]
  ds_write_b128 v19, v[184:187] offset:2048
  v_mov_b32 v155, 0
  v_cvt_pk_bf16_f32 v104, v56, v57
  v_mfma_f32_16x16x32_bf16 v[144:147], a[136:139], v[64:67], 0
  v_exp_f32 v58, v58
  v_mfma_f32_16x16x32_bf16 v[144:147], a[140:143], v[80:83], v[144:147]
  s_waitcnt lgkmcnt(0)
  v_exp_f32 v59, v59
  v_mfma_f32_16x16x32_bf16 v[48:51], a[80:83], a[0:3], v[32:35]
  buffer_load_dwordx4 v5, s[28:31], s66 offen offset:3072 sc1 lds
  v_cvt_pk_bf16_f32 v105, v58, v59
  v_mfma_f32_16x16x32_bf16 v[48:51], a[84:87], a[16:19], v[48:51]
  ds_read_b128 a[96:99], v1 offset:40960
  v_exp_f32 v60, v60
  v_mfma_f32_16x16x32_bf16 v[48:51], a[88:91], a[32:35], v[48:51]
  ds_read_b128 a[128:131], v2 offset:40960
  v_exp_f32 v61, v61
  v_mfma_f32_16x16x32_bf16 v[48:51], a[92:95], a[48:51], v[48:51]
  v_mov_b32 v168, 0
  v_mov_b32 v169, 0
  v_cvt_pk_bf16_f32 v108, v60, v61
  v_mfma_f32_16x16x32_bf16 v[164:167], a[144:147], v[68:71], 0
  v_exp_f32 v62, v62
  v_mfma_f32_16x16x32_bf16 v[164:167], a[148:151], v[84:87], v[164:167]
  ds_write_b128 v17, v[208:211] offset:4096
  v_mov_b32 v170, 0
  v_mfma_f32_16x16x32_bf16 v[172:175], a[144:147], v[76:79], 0
  ds_read_b128 a[100:103], v1 offset:41984
  v_exp_f32 v63, v63
  v_mfma_f32_16x16x32_bf16 v[52:55], a[80:83], a[4:7], v[36:39]
  v_mov_b32 v171, 0
  v_mov_b32 v184, 0
  v_cvt_pk_bf16_f32 v109, v62, v63
  v_mfma_f32_16x16x32_bf16 v[52:55], a[84:87], a[20:23], v[52:55]
  ds_read_b128 a[132:135], v2 offset:41984
  v_exp_f32 v48, v48
  v_mfma_f32_16x16x32_bf16 v[52:55], a[88:91], a[36:39], v[52:55]
  v_exp_f32 v49, v49
  v_mfma_f32_16x16x32_bf16 v[52:55], a[92:95], a[52:55], v[52:55]
  v_mov_b32 v185, 0
  v_mov_b32 v186, 0
  s_add_u32 s53, s40, 4096
  v_mfma_f32_16x16x32_bf16 v[160:163], a[144:147], v[64:67], 0
  buffer_store_dwordx4 v[192:195], v3, s[28:31], s53 offen sc1
  v_exp_f32 v50, v50
  v_mfma_f32_16x16x32_bf16 v[160:163], a[148:151], v[80:83], v[160:163]
  ds_read_b128 a[104:107], v1 offset:43008
  v_exp_f32 v51, v51
  v_mfma_f32_16x16x32_bf16 v[56:59], a[80:83], a[8:11], v[40:43]
  ds_write_b128 v19, v[216:219] offset:4096
  v_mov_b32 v187, 0
  v_cvt_pk_bf16_f32 v98, v48, v49
  v_mfma_f32_16x16x32_bf16 v[56:59], a[84:87], a[24:27], v[56:59]
  ds_read_b128 a[136:139], v2 offset:43008
  v_exp_f32 v52, v52
  v_mfma_f32_16x16x32_bf16 v[56:59], a[88:91], a[40:43], v[56:59]
  v_mov_b32 v216, 0
  v_mov_b32 v217, 0
  v_cvt_pk_bf16_f32 v99, v50, v51
  v_mfma_f32_16x16x32_bf16 v[56:59], a[92:95], a[56:59], v[56:59]
  v_exp_f32 v53, v53
  v_mfma_f32_16x16x32_bf16 v[180:183], a[152:155], v[68:71], 0
  v_mov_b32 v218, 0
  v_mov_b32 v219, 0
  v_mfma_f32_16x16x32_bf16 v[180:183], a[156:159], v[84:87], v[180:183]
  v_exp_f32 v54, v54
  v_mfma_f32_16x16x32_bf16 v[188:191], a[152:155], v[76:79], 0
  ds_read_b128 a[108:111], v1 offset:44032
  v_cvt_pk_bf16_f32 v102, v52, v53
  v_mfma_f32_16x16x32_bf16 a[168:171], a[160:163], v[68:71], 0
  v_exp_f32 v55, v55
  v_mfma_f32_16x16x32_bf16 a[168:171], a[160:163], v[84:87], a[168:171]
  ds_write_b128 v17, v[240:243] offset:6144
  v_cvt_pk_bf16_f32 v103, v54, v55
  v_mfma_f32_16x16x32_bf16 v[60:63], a[80:83], a[12:15], v[44:47]
  ds_read_b128 a[140:143], v2 offset:44032
  v_mfma_f32_16x16x32_bf16 v[60:63], a[84:87], a[28:31], v[60:63]
  v_exp_f32 v56, v56
  v_mfma_f32_16x16x32_bf16 v[60:63], a[88:91], a[44:47], v[60:63]
  v_exp_f32 v57, v57
  s_add_u32 s53, s41, 4096
  v_mfma_f32_16x16x32_bf16 v[60:63], a[92:95], a[60:63], v[60:63]
  buffer_store_dwordx4 v[200:203], v3, s[28:31], s53 offen sc1
  v_cvt_pk_bf16_f32 v106, v56, v57
  v_mfma_f32_16x16x32_bf16 v[176:179], a[152:155], v[64:67], 0
  v_exp_f32 v58, v58
  v_mfma_f32_16x16x32_bf16 v[176:179], a[156:159], v[80:83], v[176:179]
  s_waitcnt lgkmcnt(0)
  v_exp_f32 v59, v59
  v_mfma_f32_16x16x32_bf16 v[48:51], a[96:99], a[0:3], v[32:35]
  ds_write_b128 v19, v[248:251] offset:6144
  v_mov_b32 v200, 0
  v_cvt_pk_bf16_f32 v107, v58, v59
  v_mfma_f32_16x16x32_bf16 v[48:51], a[100:103], a[16:19], v[48:51]
  ds_read_b128 a[112:115], v1 offset:45056
  v_exp_f32 v60, v60
  v_mfma_f32_16x16x32_bf16 v[48:51], a[104:107], a[32:35], v[48:51]
  v_exp_f32 v61, v61
  s_add_u32 s53, s40, 6144
  v_mfma_f32_16x16x32_bf16 v[48:51], a[108:111], a[48:51], v[48:51]
  buffer_store_dwordx4 v[224:227], v3, s[28:31], s53 offen sc1
  v_cvt_pk_bf16_f32 v110, v60, v61
  v_mfma_f32_16x16x32_bf16 v[196:199], a[128:131], v[68:71], 0
  ds_read_b128 a[144:147], v2 offset:45056
  v_exp_f32 v62, v62
  v_mfma_f32_16x16x32_bf16 v[196:199], a[132:135], v[84:87], v[196:199]
  ds_read_b128 a[116:119], v1 offset:46080
  v_mov_b32 v201, 0
  v_mov_b32 v202, 0
  v_mfma_f32_16x16x32_bf16 v[204:207], a[128:131], v[76:79], 0
  v_exp_f32 v63, v63
  v_mfma_f32_16x16x32_bf16 v[52:55], a[96:99], a[4:7], v[36:39]
  ds_read_b128 a[148:151], v2 offset:46080
  v_mov_b32 v203, 0
  v_mov_b32 v248, 0
  v_mfma_f32_16x16x32_bf16 v[52:55], a[100:103], a[20:23], v[52:55]
  v_exp_f32 v48, v48
  v_cvt_pk_bf16_f32 v111, v62, v63
  v_mfma_f32_16x16x32_bf16 v[52:55], a[104:107], a[36:39], v[52:55]
  v_exp_f32 v49, v49
  v_mfma_f32_16x16x32_bf16 v[52:55], a[108:111], a[52:55], v[52:55]
  v_mov_b32 v249, 0
  v_mov_b32 v250, 0
  v_cvt_pk_bf16_f32 v112, v48, v49
  v_mfma_f32_16x16x32_bf16 v[192:195], a[128:131], v[64:67], 0
  v_exp_f32 v50, v50
  v_mfma_f32_16x16x32_bf16 v[192:195], a[132:135], v[80:83], v[192:195]
  v_exp_f32 v51, v51
  v_mfma_f32_16x16x32_bf16 v[56:59], a[96:99], a[8:11], v[40:43]
  s_mov_b32 s70, s62
  ds_read_b128 a[120:123], v1 offset:47104
  v_mov_b32 v251, 0
  v_cvt_pk_bf16_f32 v113, v50, v51
  v_mfma_f32_16x16x32_bf16 v[56:59], a[100:103], a[24:27], v[56:59]
  s_mov_b32 s62, s60
  ds_read_b128 a[152:155], v2 offset:47104
  v_exp_f32 v52, v52
  v_mfma_f32_16x16x32_bf16 v[56:59], a[104:107], a[40:43], v[56:59]
HS9:
  s_cbranch_execz HS13
  s_lshl_b32 s66, s60, 15
  ds_read_b128 a[124:127], v1 offset:48128
  v_exp_f32 v53, v53
  s_add_u32 s53, s41, 6144
  v_mfma_f32_16x16x32_bf16 v[56:59], a[108:111], a[56:59], v[56:59]
  s_add_u32 s66, s66, s64
  buffer_store_dwordx4 v[232:235], v3, s[28:31], s53 offen sc1
  v_cvt_pk_bf16_f32 v116, v52, v53
  v_mfma_f32_16x16x32_bf16 v[212:215], a[136:139], v[68:71], 0
  s_add_u32 s60, s60, 1
  v_exp_f32 v54, v54
  v_mfma_f32_16x16x32_bf16 v[212:215], a[140:143], v[84:87], v[212:215]
  s_cmp_eq_u32 s60, s57
  s_addc_u32 s60, s60, 0
  ds_read_b128 a[156:159], v2 offset:48128
  v_mov_b32 v232, 0
  v_mov_b32 v233, 0
  v_mfma_f32_16x16x32_bf16 v[220:223], a[136:139], v[76:79], 0
  s_add_u32 s52, s61, 2
  v_exp_f32 v55, v55
  v_mfma_f32_16x16x32_bf16 v[60:63], a[96:99], a[12:15], v[44:47]
  s_cmp_gt_u32 s58, s52
  s_cselect_b32 s66, s66, s78
  v_mov_b32 v234, 0
  v_mov_b32 v235, 0
  v_mfma_f32_16x16x32_bf16 v[60:63], a[100:103], a[28:31], v[60:63]
  s_cmp_gt_u32 s58, s52
  s_cselect_b32 s80, s56, s77
  v_exp_f32 v56, v56
  v_mfma_f32_16x16x32_bf16 v[60:63], a[104:107], a[44:47], v[60:63]
  v_exp_f32 v57, v57
  v_mfma_f32_16x16x32_bf16 v[60:63], a[108:111], a[60:63], v[60:63]
  v_cvt_pk_bf16_f32 v117, v54, v55
  v_cvt_pk_bf16_f32 v120, v56, v57
  v_mfma_f32_16x16x32_bf16 v[208:211], a[136:139], v[64:67], 0
  v_exp_f32 v58, v58
  v_mfma_f32_16x16x32_bf16 v[208:211], a[140:143], v[80:83], v[208:211]
  v_exp_f32 v59, v59
  s_waitcnt vmcnt(4) lgkmcnt(0)
  s_barrier
  v_mfma_f32_16x16x32_bf16 v[48:51], a[112:115], a[0:3], v[32:35]
  s_add_u32 m0, s80, 32768
  ds_read_b128 a[64:67], v1 offset:0
  v_cvt_pk_bf16_f32 v121, v58, v59
  v_mfma_f32_16x16x32_bf16 v[48:51], a[116:119], a[16:19], v[48:51]
  buffer_load_dwordx4 v5, s[28:31], s66 offen offset:0 sc1 lds
  v_exp_f32 v60, v60
  v_mfma_f32_16x16x32_bf16 v[48:51], a[120:123], a[32:35], v[48:51]
  v_exp_f32 v61, v61
  v_mfma_f32_16x16x32_bf16 v[48:51], a[124:127], a[48:51], v[48:51]
  buffer_load_dwordx4 v5, s[28:31], s66 offen offset:1024 sc1 lds
  v_cvt_pk_bf16_f32 v124, v60, v61
  v_mfma_f32_16x16x32_bf16 v[228:231], a[144:147], v[68:71], 0
  v_exp_f32 v62, v62
  v_mfma_f32_16x16x32_bf16 v[228:231], a[148:151], v[84:87], v[228:231]
  ds_read_b128 a[128:131], v2 offset:0
  ds_read_b128 a[68:71], v1 offset:1024
  v_mfma_f32_16x16x32_bf16 v[236:239], a[144:147], v[76:79], 0
  v_exp_f32 v63, v63
  v_mfma_f32_16x16x32_bf16 v[52:55], a[112:115], a[4:7], v[36:39]
  buffer_load_dwordx4 v5, s[28:31], s66 offen offset:2048 sc1 lds
  v_cvt_pk_bf16_f32 v125, v62, v63
  v_mfma_f32_16x16x32_bf16 v[52:55], a[116:119], a[20:23], v[52:55]
  ds_read_b128 a[132:135], v2 offset:1024
  v_exp_f32 v48, v48
  v_mfma_f32_16x16x32_bf16 v[52:55], a[120:123], a[36:39], v[52:55]
  v_exp_f32 v49, v49
  v_mfma_f32_16x16x32_bf16 v[52:55], a[124:127], a[52:55], v[52:55]
  buffer_load_dwordx4 v5, s[28:31], s66 offen offset:3072 sc1 lds
  v_cvt_pk_bf16_f32 v114, v48, v49
  v_mfma_f32_16x16x32_bf16 v[224:227], a[144:147], v[64:67], 0
  s_add_u32 m0, s80, 36864
  s_add_u32 s66, s66, 4096
  v_exp_f32 v50, v50
  v_mfma_f32_16x16x32_bf16 v[224:227], a[148:151], v[80:83], v[224:227]
  ds_read_b128 a[72:75], v1 offset:2048
  v_exp_f32 v51, v51
  v_mfma_f32_16x16x32_bf16 v[56:59], a[112:115], a[8:11], v[40:43]
  buffer_load_dwordx4 v5, s[28:31], s66 offen offset:0 sc1 lds
  v_cvt_pk_bf16_f32 v115, v50, v51
  v_mfma_f32_16x16x32_bf16 v[56:59], a[116:119], a[24:27], v[56:59]
  ds_read_b128 a[136:139], v2 offset:2048
  v_exp_f32 v52, v52
  v_mfma_f32_16x16x32_bf16 v[56:59], a[120:123], a[40:43], v[56:59]
  buffer_load_dwordx4 v5, s[28:31], s66 offen offset:1024 sc1 lds
  v_mfma_f32_16x16x32_bf16 v[56:59], a[124:127], a[56:59], v[56:59]
  v_exp_f32 v53, v53
  v_mfma_f32_16x16x32_bf16 v[244:247], a[152:155], v[68:71], 0
  ds_read_b128 a[76:79], v1 offset:3072
  v_cvt_pk_bf16_f32 v118, v52, v53
  v_mfma_f32_16x16x32_bf16 v[244:247], a[156:159], v[84:87], v[244:247]
  v_exp_f32 v54, v54
  v_mfma_f32_16x16x32_bf16 v[252:255], a[152:155], v[76:79], 0
  buffer_load_dwordx4 v5, s[28:31], s66 offen offset:2048 sc1 lds
  v_mfma_f32_16x16x32_bf16 a[176:179], a[160:163], v[76:79], 0
  ds_read_b128 a[140:143], v2 offset:3072
  v_exp_f32 v55, v55
  v_mfma_f32_16x16x32_bf16 v[60:63], a[112:115], a[12:15], v[44:47]
  buffer_load_dwordx4 v5, s[28:31], s66 offen offset:3072 sc1 lds
  v_mfma_f32_16x16x32_bf16 v[60:63], a[116:119], a[28:31], v[60:63]
  v_exp_f32 v56, v56
  v_mfma_f32_16x16x32_bf16 v[60:63], a[120:123], a[44:47], v[60:63]
  v_exp_f32 v57, v57
  v_mfma_f32_16x16x32_bf16 v[60:63], a[124:127], a[60:63], v[60:63]
  v_cvt_pk_bf16_f32 v119, v54, v55
  v_cvt_pk_bf16_f32 v122, v56, v57
  v_mfma_f32_16x16x32_bf16 v[240:243], a[152:155], v[64:67], 0
  s_add_u32 s61, s61, 1
  v_exp_f32 v58, v58
  v_mfma_f32_16x16x32_bf16 v[240:243], a[156:159], v[80:83], v[240:243]
  s_waitcnt lgkmcnt(0)
  v_exp_f32 v59, v59
  s_nop 0
  v_cvt_pk_bf16_f32 v123, v58, v59
L_it1:
HS10:
  s_cbranch_execz HS14
  v_mfma_f32_16x16x32_bf16 v[48:51], a[64:67], a[0:3], v[32:35]
  s_lshl_b32 s67, s70, 15
  v_exp_f32 v60, v60
  v_mfma_f32_16x16x32_bf16 v[48:51], a[68:71], a[16:19], v[48:51]
  s_add_u32 s67, s67, s65
  ds_read_b128 a[192:195], v21 offset:0
  v_mfma_f32_16x16x32_bf16 v[48:51], a[72:75], a[32:35], v[48:51]
  s_add_u32 m0, s56, 98304
  v_exp_f32 v61, v61
  v_mfma_f32_16x16x32_bf16 v[48:51], a[76:79], a[48:51], v[48:51]
  ds_read_b128 a[80:83], v1 offset:4096
  v_cvt_pk_bf16_f32 v126, v60, v61
  v_mfma_f32_16x16x32_bf16 v[128:131], a[128:131], v[96:99], v[128:131]
  ds_read_b128 a[252:255], v22 offset:13312
  v_exp_f32 v62, v62
  v_mfma_f32_16x16x32_bf16 v[128:131], a[132:135], v[112:115], v[128:131]
  buffer_load_dwordx4 v5, s[28:31], s67 offen offset:0 sc1 lds
  v_mfma_f32_16x16x32_bf16 v[132:135], a[128:131], v[100:103], v[132:135]
  v_exp_f32 v63, v63
  v_mfma_f32_16x16x32_bf16 v[132:135], a[132:135], v[116:119], v[132:135]
  ds_read_b128 a[84:87], v1 offset:5120
  v_cvt_pk_bf16_f32 v127, v62, v63
  v_mfma_f32_16x16x32_bf16 v[52:55], a[64:67], a[4:7], v[36:39]
  v_exp_f32 v48, v48
  v_mfma_f32_16x16x32_bf16 v[52:55], a[68:71], a[20:23], v[52:55]
  buffer_load_dwordx4 v5, s[28:31], s67 offen offset:1024 sc1 lds
  v_mfma_f32_16x16x32_bf16 v[52:55], a[72:75], a[36:39], v[52:55]
  v_exp_f32 v49, v49
  v_mfma_f32_16x16x32_bf16 v[52:55], a[76:79], a[52:55], v[52:55]
  ds_read_b128 a[88:91], v1 offset:6144
  v_cvt_pk_bf16_f32 v64, v48, v49
  v_mfma_f32_16x16x32_bf16 v[136:139], a[128:131], v[104:107], v[136:139]
  v_exp_f32 v50, v50
  v_mfma_f32_16x16x32_bf16 v[136:139], a[132:135], v[120:123], v[136:139]
  buffer_load_dwordx4 v5, s[28:31], s67 offen offset:2048 sc1 lds
  v_mfma_f32_16x16x32_bf16 v[140:143], a[128:131], v[108:111], v[140:143]
  v_exp_f32 v51, v51
  v_mfma_f32_16x16x32_bf16 v[140:143], a[132:135], v[124:127], v[140:143]
  ds_read_b128 a[92:95], v1 offset:7168
  v_cvt_pk_bf16_f32 v65, v50, v51
  v_mfma_f32_16x16x32_bf16 v[56:59], a[64:67], a[8:11], v[40:43]
  v_exp_f32 v52, v52
  v_mfma_f32_16x16x32_bf16 v[56:59], a[68:71], a[24:27], v[56:59]
  buffer_load_dwordx4 v5, s[28:31], s67 offen offset:3072 sc1 lds
  v_mfma_f32_16x16x32_bf16 v[56:59], a[72:75], a[40:43], v[56:59]
  v_exp_f32 v53, v53
  v_mfma_f32_16x16x32_bf16 v[56:59], a[76:79], a[56:59], v[56:59]
  ds_read_b128 a[144:147], v2 offset:4096
  v_cvt_pk_bf16_f32 v68, v52, v53
  v_mfma_f32_16x16x32_bf16 v[144:147], a[136:139], v[96:99], v[144:147]
  v_exp_f32 v54, v54
  v_mfma_f32_16x16x32_bf16 v[144:147], a[140:143], v[112:115], v[144:147]
  s_add_u32 m0, s56, 102400
  ds_read_b128 a[196:199], v21 offset:1024
  v_lshrrev_b32 v17, 3, v0
  v_mfma_f32_16x16x32_bf16 v[148:151], a[136:139], v[100:103], v[148:151]
  s_add_u32 s67, s67, 4096
  v_exp_f32 v55, v55
  v_mfma_f32_16x16x32_bf16 v[148:151], a[140:143], v[116:119], v[148:151]
  ds_read_b128 a[148:151], v2 offset:5120
  v_cvt_pk_bf16_f32 v69, v54, v55
  v_mfma_f32_16x16x32_bf16 a[164:167], a[160:163], v[96:99], a[164:167]
  buffer_load_dwordx4 v5, s[28:31], s67 offen offset:0 sc1 lds
  v_mfma_f32_16x16x32_bf16 a[164:167], a[160:163], v[112:115], a[164:167]
  ds_read_b128 a[200:203], v22 offset:0
  v_bfe_u32 v18, v0, 4, 2
  v_mfma_f32_16x16x32_bf16 v[60:63], a[64:67], a[12:15], v[44:47]
  v_exp_f32 v56, v56
  v_mfma_f32_16x16x32_bf16 v[60:63], a[68:71], a[28:31], v[60:63]
  ds_read_b128 a[204:207], v22 offset:1024
  v_lshlrev_b32 v18, 1, v18
  v_mfma_f32_16x16x32_bf16 v[60:63], a[72:75], a[44:47], v[60:63]
  v_exp_f32 v57, v57
  v_mfma_f32_16x16x32_bf16 v[60:63], a[76:79], a[60:63], v[60:63]
  ds_read_b128 a[152:155], v2 offset:6144
  v_cvt_pk_bf16_f32 v72, v56, v57
  v_mfma_f32_16x16x32_bf16 v[152:155], a[136:139], v[104:107], v[152:155]
  v_exp_f32 v58, v58
  v_mfma_f32_16x16x32_bf16 v[152:155], a[140:143], v[120:123], v[152:155]
  buffer_load_dwordx4 v5, s[28:31], s67 offen offset:1024 sc1 lds
  v_mfma_f32_16x16x32_bf16 v[156:159], a[136:139], v[108:111], v[156:159]
  v_exp_f32 v59, v59
  v_mfma_f32_16x16x32_bf16 v[156:159], a[140:143], v[124:127], v[156:159]
  s_waitcnt lgkmcnt(1)
  ds_read_b128 a[156:159], v2 offset:7168
  v_cvt_pk_bf16_f32 v73, v58, v59
  v_mfma_f32_16x16x32_bf16 v[48:51], a[80:83], a[0:3], v[32:35]
  v_exp_f32 v60, v60
  v_mfma_f32_16x16x32_bf16 v[48:51], a[84:87], a[16:19], v[48:51]
  buffer_load_dwordx4 v5, s[28:31], s67 offen offset:2048 sc1 lds
  v_mfma_f32_16x16x32_bf16 v[48:51], a[88:91], a[32:35], v[48:51]
  v_exp_f32 v61, v61
  v_mfma_f32_16x16x32_bf16 v[48:51], a[92:95], a[48:51], v[48:51]
  ds_read_b128 a[96:99], v1 offset:8192
  v_cvt_pk_bf16_f32 v76, v60, v61
  v_mfma_f32_16x16x32_bf16 v[160:163], a[144:147], v[96:99], v[160:163]
  v_exp_f32 v62, v62
  v_mfma_f32_16x16x32_bf16 v[160:163], a[148:151], v[112:115], v[160:163]
  buffer_load_dwordx4 v5, s[28:31], s67 offen offset:3072 sc1 lds
  v_mfma_f32_16x16x32_bf16 v[164:167], a[144:147], v[100:103], v[164:167]
  v_exp_f32 v63, v63
  v_mfma_f32_16x16x32_bf16 v[164:167], a[148:151], v[116:119], v[164:167]
  ds_read_b128 a[100:103], v1 offset:9216
  v_cvt_pk_bf16_f32 v77, v62, v63
  v_mfma_f32_16x16x32_bf16 v[52:55], a[80:83], a[4:7], v[36:39]
  v_exp_f32 v48, v48
  v_mfma_f32_16x16x32_bf16 v[52:55], a[84:87], a[20:23], v[52:55]
  ds_read_b128 a[208:211], v21 offset:4096
  v_and_b32 v4, 7, v0
  v_mfma_f32_16x16x32_bf16 v[52:55], a[88:91], a[36:39], v[52:55]
  v_exp_f32 v49, v49
  v_mfma_f32_16x16x32_bf16 v[52:55], a[92:95], a[52:55], v[52:55]
  ds_read_b128 a[104:107], v1 offset:10240
  v_cvt_pk_bf16_f32 v66, v48, v49
  v_mfma_f32_16x16x32_bf16 v[168:171], a[144:147], v[104:107], v[168:171]
  v_exp_f32 v50, v50
  v_mfma_f32_16x16x32_bf16 v[168:171], a[148:151], v[120:123], v[168:171]
  ds_read_b128 a[212:215], v21 offset:5120
  v_xor_b32 v18, v18, v4
  v_mfma_f32_16x16x32_bf16 v[172:175], a[144:147], v[108:111], v[172:175]
  v_exp_f32 v51, v51
  v_mfma_f32_16x16x32_bf16 v[172:175], a[148:151], v[124:127], v[172:175]
  ds_read_b128 a[108:111], v1 offset:11264
  v_cvt_pk_bf16_f32 v67, v50, v51
  v_mfma_f32_16x16x32_bf16 v[56:59], a[80:83], a[8:11], v[40:43]
  v_exp_f32 v52, v52
  v_mfma_f32_16x16x32_bf16 v[56:59], a[84:87], a[24:27], v[56:59]
  ds_read_b128 a[216:219], v22 offset:4096
  v_lshlrev_b32 v18, 4, v18
  v_mfma_f32_16x16x32_bf16 v[56:59], a[88:91], a[40:43], v[56:59]
  s_waitcnt lgkmcnt(7)
  s_lshl_b32 s8, s2, 2
  v_exp_f32 v53, v53
  v_mfma_f32_16x16x32_bf16 v[56:59], a[92:95], a[56:59], v[56:59]
  s_add_u32 s8, s8, s48
  ds_read_b128 a[128:131], v2 offset:8192
  v_cvt_pk_bf16_f32 v70, v52, v53
  v_mfma_f32_16x16x32_bf16 v[176:179], a[152:155], v[96:99], v[176:179]
  s_add_u32 s19, s56, 131072
  v_exp_f32 v54, v54
  v_mfma_f32_16x16x32_bf16 v[176:179], a[156:159], v[112:115], v[176:179]
  s_sub_u32 s53, s8, 540
  ds_read_b128 a[220:223], v22 offset:5120
  v_mfma_f32_16x16x32_bf16 v[180:183], a[152:155], v[100:103], v[180:183]
  s_cmp_lt_u32 s8, 540
  s_cselect_b32 s53, s8, s53
  v_exp_f32 v55, v55
  v_mfma_f32_16x16x32_bf16 v[180:183], a[156:159], v[116:119], v[180:183]
  s_cmp_lt_u32 s8, 540
  s_cselect_b32 s20, s20, s24
  ds_read_b128 a[132:135], v2 offset:9216
  v_cvt_pk_bf16_f32 v71, v54, v55
  v_mfma_f32_16x16x32_bf16 a[168:171], a[160:163], v[100:103], a[168:171]
  s_cmp_lt_u32 s8, 540
  s_cselect_b32 s21, s21, s25
  ds_read_b128 a[224:227], v21 offset:8192
  v_mfma_f32_16x16x32_bf16 a[168:171], a[160:163], v[116:119], a[168:171]
  s_cmp_lt_u32 s8, 540
  s_cselect_b32 s22, s22, s26
  ds_read_b128 a[228:231], v21 offset:9216
  v_mfma_f32_16x16x32_bf16 v[60:63], a[80:83], a[12:15], v[44:47]
  s_mov_b32 s9, 0x1999999a
  v_exp_f32 v56, v56
  v_mfma_f32_16x16x32_bf16 v[60:63], a[84:87], a[28:31], v[60:63]
  s_cmp_lt_u32 s8, 540
  s_cselect_b32 s9, 0x97b425f, s9
  ds_read_b128 a[232:235], v22 offset:8192
  v_mfma_f32_16x16x32_bf16 v[60:63], a[88:91], a[44:47], v[60:63]
  s_cmp_lt_u32 s8, 540
  s_cselect_b32 s10, 27, 10
  v_exp_f32 v57, v57
  v_mfma_f32_16x16x32_bf16 v[60:63], a[92:95], a[60:63], v[60:63]
  s_mov_b32 s17, 63963136
  ds_read_b128 a[136:139], v2 offset:10240
  v_cvt_pk_bf16_f32 v74, v56, v57
  v_mfma_f32_16x16x32_bf16 v[184:187], a[152:155], v[104:107], v[184:187]
  s_cmp_lt_u32 s8, 540
  s_cselect_b32 s17, 60817408, s17
  v_exp_f32 v58, v58
  v_mfma_f32_16x16x32_bf16 v[184:187], a[156:159], v[120:123], v[184:187]
  s_lshl_b32 s18, s10, 7
  ds_read_b128 a[236:239], v22 offset:9216
  v_mfma_f32_16x16x32_bf16 v[188:191], a[152:155], v[108:111], v[188:191]
  s_mul_hi_u32 s9, s53, s9
  v_exp_f32 v59, v59
  v_mfma_f32_16x16x32_bf16 v[188:191], a[156:159], v[124:127], v[188:191]
  s_waitcnt lgkmcnt(1)
  s_mul_i32 s10, s9, s10
  ds_read_b128 a[140:143], v2 offset:11264
  v_cvt_pk_bf16_f32 v75, v58, v59
  v_mfma_f32_16x16x32_bf16 v[48:51], a[96:99], a[0:3], v[32:35]
  s_sub_u32 s10, s53, s10
  v_exp_f32 v60, v60
  v_mfma_f32_16x16x32_bf16 v[48:51], a[100:103], a[16:19], v[48:51]
  s_lshl_b32 s53, s53, 12
  ds_read_b128 a[112:115], v1 offset:12288
  v_mfma_f32_16x16x32_bf16 v[48:51], a[104:107], a[32:35], v[48:51]
  s_add_u32 s17, s17, s53
  v_exp_f32 v61, v61
  v_mfma_f32_16x16x32_bf16 v[48:51], a[108:111], a[48:51], v[48:51]
  s_mul_i32 s16, s9, s18
  ds_read_b128 a[116:119], v1 offset:13312
  v_cvt_pk_bf16_f32 v78, v60, v61
  v_mfma_f32_16x16x32_bf16 v[192:195], a[128:131], v[96:99], v[192:195]
  s_lshl_b32 s16, s16, 5
  v_exp_f32 v62, v62
  v_mfma_f32_16x16x32_bf16 v[192:195], a[132:135], v[112:115], v[192:195]
  s_lshl_b32 s10, s10, 7
  ds_read_b128 a[240:243], v21 offset:12288
  v_mfma_f32_16x16x32_bf16 v[196:199], a[128:131], v[100:103], v[196:199]
  s_add_u32 s16, s16, s10
  v_exp_f32 v63, v63
  v_mfma_f32_16x16x32_bf16 v[196:199], a[132:135], v[116:119], v[196:199]
  s_cmp_lt_u32 s8, 810
  s_cselect_b32 s17, s17, 0x40000000
  ds_read_b128 a[120:123], v1 offset:14336
  v_cvt_pk_bf16_f32 v79, v62, v63
  v_mfma_f32_16x16x32_bf16 v[52:55], a[96:99], a[4:7], v[36:39]
  v_exp_f32 v48, v48
  v_mfma_f32_16x16x32_bf16 v[52:55], a[100:103], a[20:23], v[52:55]
  ds_read_b128 a[124:127], v1 offset:15360
  v_mfma_f32_16x16x32_bf16 v[52:55], a[104:107], a[36:39], v[52:55]
  v_exp_f32 v49, v49
  v_mfma_f32_16x16x32_bf16 v[52:55], a[108:111], a[52:55], v[52:55]
  ds_read_b128 a[144:147], v2 offset:12288
  v_cvt_pk_bf16_f32 v80, v48, v49
  v_mfma_f32_16x16x32_bf16 v[200:203], a[128:131], v[104:107], v[200:203]
  v_exp_f32 v50, v50
  v_mfma_f32_16x16x32_bf16 v[200:203], a[132:135], v[120:123], v[200:203]
  ds_read_b128 a[244:247], v21 offset:13312
  v_mfma_f32_16x16x32_bf16 v[204:207], a[128:131], v[108:111], v[204:207]
  v_exp_f32 v51, v51
  v_mfma_f32_16x16x32_bf16 v[204:207], a[132:135], v[124:127], v[204:207]
  ds_read_b128 a[148:151], v2 offset:13312
  v_cvt_pk_bf16_f32 v81, v50, v51
  v_mfma_f32_16x16x32_bf16 v[56:59], a[96:99], a[8:11], v[40:43]
  v_exp_f32 v52, v52
  v_mfma_f32_16x16x32_bf16 v[56:59], a[100:103], a[24:27], v[56:59]
  ds_read_b128 a[152:155], v2 offset:14336
  v_mfma_f32_16x16x32_bf16 v[56:59], a[104:107], a[40:43], v[56:59]
  s_waitcnt lgkmcnt(9)
  s_mov_b32 s70, s62
  v_exp_f32 v53, v53
  v_mfma_f32_16x16x32_bf16 v[56:59], a[108:111], a[56:59], v[56:59]
  s_mov_b32 s62, s60
  ds_read_b128 a[156:159], v2 offset:15360
  v_cvt_pk_bf16_f32 v84, v52, v53
  v_mfma_f32_16x16x32_bf16 v[208:211], a[136:139], v[96:99], v[208:211]
  s_lshl_b32 s66, s60, 15
  v_exp_f32 v54, v54
  v_mfma_f32_16x16x32_bf16 v[208:211], a[140:143], v[112:115], v[208:211]
  s_add_u32 s66, s66, s64
  ds_read_b128 a[248:251], v22 offset:12288
  v_mfma_f32_16x16x32_bf16 v[212:215], a[136:139], v[100:103], v[212:215]
  s_add_u32 s60, s60, 1
  v_exp_f32 v55, v55
  v_mfma_f32_16x16x32_bf16 v[212:215], a[140:143], v[116:119], v[212:215]
  s_cmp_eq_u32 s60, s57
  s_addc_u32 s60, s60, 0
  v_cvt_pk_bf16_f32 v85, v54, v55
  v_mfma_f32_16x16x32_bf16 a[172:175], a[160:163], v[104:107], a[172:175]
  s_add_u32 s52, s61, 2
  v_mfma_f32_16x16x32_bf16 a[172:175], a[160:163], v[120:123], a[172:175]
  s_cmp_gt_u32 s58, s52
  s_cselect_b32 s66, s66, s63
  v_mfma_f32_16x16x32_bf16 v[60:63], a[96:99], a[12:15], v[44:47]
  s_cmp_gt_u32 s58, s52
  s_cselect_b32 s80, s56, s77
  v_exp_f32 v56, v56
  v_mfma_f32_16x16x32_bf16 v[60:63], a[100:103], a[28:31], v[60:63]
  v_mfma_f32_16x16x32_bf16 v[60:63], a[104:107], a[44:47], v[60:63]
  v_exp_f32 v57, v57
  v_mfma_f32_16x16x32_bf16 v[60:63], a[108:111], a[60:63], v[60:63]
  v_cvt_pk_bf16_f32 v88, v56, v57
  v_mfma_f32_16x16x32_bf16 v[216:219], a[136:139], v[104:107], v[216:219]
  v_exp_f32 v58, v58
  v_mfma_f32_16x16x32_bf16 v[216:219], a[140:143], v[120:123], v[216:219]
  s_waitcnt vmcnt(0) lgkmcnt(0)
  s_barrier
  v_mfma_f32_16x16x32_bf16 v[220:223], a[136:139], v[108:111], v[220:223]
  s_add_u32 m0, s80, 0
  v_exp_f32 v59, v59
  v_mfma_f32_16x16x32_bf16 v[220:223], a[140:143], v[124:127], v[220:223]
  v_cvt_pk_bf16_f32 v89, v58, v59
  v_mfma_f32_16x16x32_bf16 v[48:51], a[112:115], a[0:3], v[32:35]
  v_exp_f32 v60, v60
  v_mfma_f32_16x16x32_bf16 v[48:51], a[116:119], a[16:19], v[48:51]
  buffer_load_dwordx4 v5, s[28:31], s66 offen offset:0 sc1 lds
  v_mfma_f32_16x16x32_bf16 v[48:51], a[120:123], a[32:35], v[48:51]
  v_exp_f32 v61, v61
  v_mfma_f32_16x16x32_bf16 v[48:51], a[124:127], a[48:51], v[48:51]
  ds_read_b128 a[64:67], v1 offset:32768
  v_cvt_pk_bf16_f32 v92, v60, v61
  v_mfma_f32_16x16x32_bf16 v[224:227], a[144:147], v[96:99], v[224:227]
  v_exp_f32 v62, v62
  v_mfma_f32_16x16x32_bf16 v[224:227], a[148:151], v[112:115], v[224:227]
  buffer_load_dwordx4 v5, s[28:31], s66 offen offset:1024 sc1 lds
  v_mfma_f32_16x16x32_bf16 v[228:231], a[144:147], v[100:103], v[228:231]
  v_exp_f32 v63, v63
  v_mfma_f32_16x16x32_bf16 v[228:231], a[148:151], v[116:119], v[228:231]
  ds_read_b128 a[68:71], v1 offset:33792
  v_cvt_pk_bf16_f32 v93, v62, v63
  v_mfma_f32_16x16x32_bf16 v[52:55], a[112:115], a[4:7], v[36:39]
  v_exp_f32 v48, v48
  v_mfma_f32_16x16x32_bf16 v[52:55], a[116:119], a[20:23], v[52:55]
  buffer_load_dwordx4 v5, s[28:31], s66 offen offset:2048 sc1 lds
  v_mfma_f32_16x16x32_bf16 v[52:55], a[120:123], a[36:39], v[52:55]
  v_exp_f32 v49, v49
  v_mfma_f32_16x16x32_bf16 v[52:55], a[124:127], a[52:55], v[52:55]
  ds_read_b128 a[72:75], v1 offset:34816
  v_cvt_pk_bf16_f32 v82, v48, v49
  v_mfma_f32_16x16x32_bf16 v[232:235], a[144:147], v[104:107], v[232:235]
  v_exp_f32 v50, v50
  v_mfma_f32_16x16x32_bf16 v[232:235], a[148:151], v[120:123], v[232:235]
  buffer_load_dwordx4 v5, s[28:31], s66 offen offset:3072 sc1 lds
  v_mfma_f32_16x16x32_bf16 v[236:239], a[144:147], v[108:111], v[236:239]
  v_exp_f32 v51, v51
  v_mfma_f32_16x16x32_bf16 v[236:239], a[148:151], v[124:127], v[236:239]
  s_add_u32 m0, s80, 4096
  ds_read_b128 a[76:79], v1 offset:35840
  v_cvt_pk_bf16_f32 v83, v50, v51
  v_mfma_f32_16x16x32_bf16 v[56:59], a[112:115], a[8:11], v[40:43]
  s_add_u32 s66, s66, 4096
  v_exp_f32 v52, v52
  v_mfma_f32_16x16x32_bf16 v[56:59], a[116:119], a[24:27], v[56:59]
  buffer_load_dwordx4 v5, s[28:31], s66 offen offset:0 sc1 lds
  v_mfma_f32_16x16x32_bf16 v[56:59], a[120:123], a[40:43], v[56:59]
  v_exp_f32 v53, v53
  v_mfma_f32_16x16x32_bf16 v[56:59], a[124:127], a[56:59], v[56:59]
  ds_read_b128 a[128:131], v2 offset:32768
  v_cvt_pk_bf16_f32 v86, v52, v53
  v_mfma_f32_16x16x32_bf16 v[240:243], a[152:155], v[96:99], v[240:243]
  v_exp_f32 v54, v54
  v_mfma_f32_16x16x32_bf16 v[240:243], a[156:159], v[112:115], v[240:243]
  buffer_load_dwordx4 v5, s[28:31], s66 offen offset:1024 sc1 lds
  v_mfma_f32_16x16x32_bf16 v[244:247], a[152:155], v[100:103], v[244:247]
  v_exp_f32 v55, v55
  v_mfma_f32_16x16x32_bf16 v[244:247], a[156:159], v[116:119], v[244:247]
  ds_read_b128 a[132:135], v2 offset:33792
  v_cvt_pk_bf16_f32 v87, v54, v55
  v_mfma_f32_16x16x32_bf16 a[176:179], a[160:163], v[108:111], a[176:179]
  buffer_load_dwordx4 v5, s[28:31], s66 offen offset:2048 sc1 lds
  v_mfma_f32_16x16x32_bf16 a[176:179], a[160:163], v[124:127], a[176:179]
  v_mfma_f32_16x16x32_bf16 v[60:63], a[112:115], a[12:15], v[44:47]
  v_exp_f32 v56, v56
  v_mfma_f32_16x16x32_bf16 v[60:63], a[116:119], a[28:31], v[60:63]
  buffer_load_dwordx4 v5, s[28:31], s66 offen offset:3072 sc1 lds
  v_mfma_f32_16x16x32_bf16 v[60:63], a[120:123], a[44:47], v[60:63]
  v_exp_f32 v57, v57
  v_mfma_f32_16x16x32_bf16 v[60:63], a[124:127], a[60:63], v[60:63]
  ds_read_b128 a[136:139], v2 offset:34816
  v_cvt_pk_bf16_f32 v90, v56, v57
  v_mfma_f32_16x16x32_bf16 v[248:251], a[152:155], v[104:107], v[248:251]
  v_exp_f32 v58, v58
  v_mfma_f32_16x16x32_bf16 v[248:251], a[156:159], v[120:123], v[248:251]
  v_mfma_f32_16x16x32_bf16 v[252:255], a[152:155], v[108:111], v[252:255]
  s_add_u32 s61, s61, 1
  v_exp_f32 v59, v59
  v_mfma_f32_16x16x32_bf16 v[252:255], a[156:159], v[124:127], v[252:255]
  s_waitcnt lgkmcnt(1)
  ds_read_b128 a[140:143], v2 offset:35840
  v_cvt_pk_bf16_f32 v91, v58, v59
  v_mfma_f32_16x16x32_bf16 v[48:51], a[64:67], a[0:3], v[32:35]
  s_lshl_b32 s67, s70, 15
  v_exp_f32 v60, v60
  v_mfma_f32_16x16x32_bf16 v[48:51], a[68:71], a[16:19], v[48:51]
  s_add_u32 s67, s67, s65
  v_mfma_f32_16x16x32_bf16 v[48:51], a[72:75], a[32:35], v[48:51]
  s_add_u32 m0, s56, 65536
  v_exp_f32 v61, v61
  v_mfma_f32_16x16x32_bf16 v[48:51], a[76:79], a[48:51], v[48:51]
  ds_read_b128 a[80:83], v1 offset:36864
  v_cvt_pk_bf16_f32 v94, v60, v61
  v_mfma_f32_16x16x32_bf16 v[128:131], a[128:131], v[64:67], v[128:131]
  v_exp_f32 v62, v62
  v_mfma_f32_16x16x32_bf16 v[128:131], a[132:135], v[80:83], v[128:131]
  buffer_load_dwordx4 v5, s[28:31], s67 offen offset:0 sc1 lds
  v_mfma_f32_16x16x32_bf16 v[132:135], a[128:131], v[68:71], v[132:135]
  v_exp_f32 v63, v63
  v_mfma_f32_16x16x32_bf16 v[132:135], a[132:135], v[84:87], v[132:135]
  ds_read_b128 a[84:87], v1 offset:37888
  v_cvt_pk_bf16_f32 v95, v62, v63
  v_mfma_f32_16x16x32_bf16 v[52:55], a[64:67], a[4:7], v[36:39]
  v_exp_f32 v48, v48
  v_mfma_f32_16x16x32_bf16 v[52:55], a[68:71], a[20:23], v[52:55]
  s_lshl_b32 s9, s49, 7
  buffer_load_dwordx4 v5, s[28:31], s67 offen offset:1024 sc1 lds
  v_mfma_f32_16x16x32_bf16 v[52:55], a[72:75], a[36:39], v[52:55]
  s_add_u32 s9, s9, 466944
  v_exp_f32 v49, v49
  v_mfma_f32_16x16x32_bf16 v[52:55], a[76:79], a[52:55], v[52:55]
  ds_read_b128 a[88:91], v1 offset:38912
  v_cvt_pk_bf16_f32 v96, v48, v49
  v_mfma_f32_16x16x32_bf16 v[136:139], a[128:131], v[72:75], v[136:139]
  v_exp_f32 v50, v50
  v_mfma_f32_16x16x32_bf16 v[136:139], a[132:135], v[88:91], v[136:139]
  buffer_load_dwordx4 v5, s[28:31], s67 offen offset:2048 sc1 lds
  v_mfma_f32_16x16x32_bf16 v[140:143], a[128:131], v[76:79], v[140:143]
  v_exp_f32 v51, v51
  v_mfma_f32_16x16x32_bf16 v[140:143], a[132:135], v[92:95], v[140:143]
  ds_read_b128 a[92:95], v1 offset:39936
  v_cvt_pk_bf16_f32 v97, v50, v51
  v_mfma_f32_16x16x32_bf16 v[56:59], a[64:67], a[8:11], v[40:43]
  v_exp_f32 v52, v52
  v_mfma_f32_16x16x32_bf16 v[56:59], a[68:71], a[24:27], v[56:59]
  buffer_load_dwordx4 v5, s[28:31], s67 offen offset:3072 sc1 lds
  v_mfma_f32_16x16x32_bf16 v[56:59], a[72:75], a[40:43], v[56:59]
  s_waitcnt lgkmcnt(4)
  v_exp_f32 v53, v53
  v_mfma_f32_16x16x32_bf16 v[56:59], a[76:79], a[56:59], v[56:59]
  ds_read_b128 a[144:147], v2 offset:36864
  v_cvt_pk_bf16_f32 v100, v52, v53
  v_mfma_f32_16x16x32_bf16 v[144:147], a[136:139], v[64:67], v[144:147]
  v_exp_f32 v54, v54
  v_mfma_f32_16x16x32_bf16 v[144:147], a[140:143], v[80:83], v[144:147]
  s_add_u32 m0, s56, 69632
  buffer_atomic_add v20, v16, s[28:31], s9 offen
  v_mfma_f32_16x16x32_bf16 v[148:151], a[136:139], v[68:71], v[148:151]
  s_add_u32 s67, s67, 4096
  v_exp_f32 v55, v55
  v_mfma_f32_16x16x32_bf16 v[148:151], a[140:143], v[84:87], v[148:151]
  ds_read_b128 a[148:151], v2 offset:37888
  v_cvt_pk_bf16_f32 v101, v54, v55
  v_mfma_f32_16x16x32_bf16 a[164:167], a[160:163], v[64:67], a[164:167]
  buffer_load_dwordx4 v5, s[28:31], s67 offen offset:0 sc1 lds
  v_mfma_f32_16x16x32_bf16 a[164:167], a[160:163], v[80:83], a[164:167]
  v_mfma_f32_16x16x32_bf16 v[60:63], a[64:67], a[12:15], v[44:47]
  v_exp_f32 v56, v56
  v_mfma_f32_16x16x32_bf16 v[60:63], a[68:71], a[28:31], v[60:63]
  v_mfma_f32_16x16x32_bf16 v[60:63], a[72:75], a[44:47], v[60:63]
  v_exp_f32 v57, v57
  v_mfma_f32_16x16x32_bf16 v[60:63], a[76:79], a[60:63], v[60:63]
  ds_read_b128 a[152:155], v2 offset:38912
  v_cvt_pk_bf16_f32 v104, v56, v57
  v_mfma_f32_16x16x32_bf16 v[152:155], a[136:139], v[72:75], v[152:155]
  v_exp_f32 v58, v58
  v_mfma_f32_16x16x32_bf16 v[152:155], a[140:143], v[88:91], v[152:155]
  buffer_load_dwordx4 v5, s[28:31], s67 offen offset:1024 sc1 lds
  v_mfma_f32_16x16x32_bf16 v[156:159], a[136:139], v[76:79], v[156:159]
  v_exp_f32 v59, v59
  v_mfma_f32_16x16x32_bf16 v[156:159], a[140:143], v[92:95], v[156:159]
  s_waitcnt lgkmcnt(1)
  ds_read_b128 a[156:159], v2 offset:39936
  v_cvt_pk_bf16_f32 v105, v58, v59
  v_mfma_f32_16x16x32_bf16 v[48:51], a[80:83], a[0:3], v[32:35]
  v_exp_f32 v60, v60
  v_mfma_f32_16x16x32_bf16 v[48:51], a[84:87], a[16:19], v[48:51]
  buffer_load_dwordx4 v5, s[28:31], s67 offen offset:2048 sc1 lds
  v_mfma_f32_16x16x32_bf16 v[48:51], a[88:91], a[32:35], v[48:51]
  v_exp_f32 v61, v61
  v_mfma_f32_16x16x32_bf16 v[48:51], a[92:95], a[48:51], v[48:51]
  ds_read_b128 a[96:99], v1 offset:40960
  v_cvt_pk_bf16_f32 v108, v60, v61
  v_mfma_f32_16x16x32_bf16 v[160:163], a[144:147], v[64:67], v[160:163]
  v_exp_f32 v62, v62
  v_mfma_f32_16x16x32_bf16 v[160:163], a[148:151], v[80:83], v[160:163]
  buffer_load_dwordx4 v5, s[28:31], s67 offen offset:3072 sc1 lds
  v_mfma_f32_16x16x32_bf16 v[164:167], a[144:147], v[68:71], v[164:167]
  v_exp_f32 v63, v63
  v_mfma_f32_16x16x32_bf16 v[164:167], a[148:151], v[84:87], v[164:167]
  ds_read_b128 a[100:103], v1 offset:41984
  v_cvt_pk_bf16_f32 v109, v62, v63
  v_mfma_f32_16x16x32_bf16 v[52:55], a[80:83], a[4:7], v[36:39]
  v_exp_f32 v48, v48
  v_mfma_f32_16x16x32_bf16 v[52:55], a[84:87], a[20:23], v[52:55]
  v_mad_u32_u24 v19, v17, s18, v18
  v_mfma_f32_16x16x32_bf16 v[52:55], a[88:91], a[36:39], v[52:55]
  s_lshl_b32 s18, s18, 3
  v_exp_f32 v49, v49
  v_mfma_f32_16x16x32_bf16 v[52:55], a[92:95], a[52:55], v[52:55]
  s_add_u32 m0, s19, 0
  ds_read_b128 a[104:107], v1 offset:43008
  v_cvt_pk_bf16_f32 v98, v48, v49
  v_mfma_f32_16x16x32_bf16 v[168:171], a[144:147], v[72:75], v[168:171]
  v_exp_f32 v50, v50
  v_mfma_f32_16x16x32_bf16 v[168:171], a[148:151], v[88:91], v[168:171]
  buffer_load_dwordx4 v19, s[20:23], s16 offen lds
  v_mfma_f32_16x16x32_bf16 v[172:175], a[144:147], v[76:79], v[172:175]
  v_exp_f32 v51, v51
  v_mfma_f32_16x16x32_bf16 v[172:175], a[148:151], v[92:95], v[172:175]
  ds_read_b128 a[108:111], v1 offset:44032
  v_cvt_pk_bf16_f32 v99, v50, v51
  v_mfma_f32_16x16x32_bf16 v[56:59], a[80:83], a[8:11], v[40:43]
  v_exp_f32 v52, v52
  v_mfma_f32_16x16x32_bf16 v[56:59], a[84:87], a[24:27], v[56:59]
  s_add_u32 s16, s16, s18
  v_mfma_f32_16x16x32_bf16 v[56:59], a[88:91], a[40:43], v[56:59]
  s_waitcnt lgkmcnt(4)
  s_add_u32 m0, s19, 1024
  v_exp_f32 v53, v53
  v_mfma_f32_16x16x32_bf16 v[56:59], a[92:95], a[56:59], v[56:59]
HS11:
  s_cbranch_execz HOPR_a
  ds_read_b128 a[128:131], v2 offset:40960
  v_cvt_pk_bf16_f32 v102, v52, v53
  v_mfma_f32_16x16x32_bf16 v[176:179], a[152:155], v[64:67], v[176:179]
  v_exp_f32 v54, v54
  v_mfma_f32_16x16x32_bf16 v[176:179], a[156:159], v[80:83], v[176:179]
  buffer_load_dwordx4 v19, s[20:23], s16 offen lds
  v_mfma_f32_16x16x32_bf16 v[180:183], a[152:155], v[68:71], v[180:183]
  v_exp_f32 v55, v55
  v_mfma_f32_16x16x32_bf16 v[180:183], a[156:159], v[84:87], v[180:183]
  ds_read_b128 a[132:135], v2 offset:41984
  v_cvt_pk_bf16_f32 v103, v54, v55
  v_mfma_f32_16x16x32_bf16 a[168:171], a[160:163], v[68:71], a[168:171]
  v_mfma_f32_16x16x32_bf16 a[168:171], a[160:163], v[84:87], a[168:171]
  s_add_u32 s16, s16, s18
  v_mfma_f32_16x16x32_bf16 v[60:63], a[80:83], a[12:15], v[44:47]
  s_add_u32 m0, s19, 2048
  v_exp_f32 v56, v56
  v_mfma_f32_16x16x32_bf16 v[60:63], a[84:87], a[28:31], v[60:63]
  buffer_load_dwordx4 v19, s[20:23], s16 offen lds
  v_mfma_f32_16x16x32_bf16 v[60:63], a[88:91], a[44:47], v[60:63]
  v_exp_f32 v57, v57
  v_mfma_f32_16x16x32_bf16 v[60:63], a[92:95], a[60:63], v[60:63]
  ds_read_b128 a[136:139], v2 offset:43008
  v_cvt_pk_bf16_f32 v106, v56, v57
  v_mfma_f32_16x16x32_bf16 v[184:187], a[152:155], v[72:75], v[184:187]
  v_exp_f32 v58, v58
  v_mfma_f32_16x16x32_bf16 v[184:187], a[156:159], v[88:91], v[184:187]
  s_add_u32 s16, s16, s18
  v_mfma_f32_16x16x32_bf16 v[188:191], a[152:155], v[76:79], v[188:191]
  s_add_u32 m0, s19, 3072
  v_exp_f32 v59, v59
  v_mfma_f32_16x16x32_bf16 v[188:191], a[156:159], v[92:95], v[188:191]
  s_waitcnt lgkmcnt(1)
  ds_read_b128 a[140:143], v2 offset:44032
  v_cvt_pk_bf16_f32 v107, v58, v59
  v_mfma_f32_16x16x32_bf16 v[48:51], a[96:99], a[0:3], v[32:35]
  v_exp_f32 v60, v60
  v_mfma_f32_16x16x32_bf16 v[48:51], a[100:103], a[16:19], v[48:51]
  ds_read_b128 a[112:115], v1 offset:45056
  v_mfma_f32_16x16x32_bf16 v[48:51], a[104:107], a[32:35], v[48:51]
  v_exp_f32 v61, v61
  v_mfma_f32_16x16x32_bf16 v[48:51], a[108:111], a[48:51], v[48:51]
  ds_read_b128 a[116:119], v1 offset:46080
  v_cvt_pk_bf16_f32 v110, v60, v61
  v_mfma_f32_16x16x32_bf16 v[192:195], a[128:131], v[64:67], v[192:195]
  v_exp_f32 v62, v62
  v_mfma_f32_16x16x32_bf16 v[192:195], a[132:135], v[80:83], v[192:195]
  buffer_load_dwordx4 v19, s[20:23], s16 offen lds
  v_mfma_f32_16x16x32_bf16 v[196:199], a[128:131], v[68:71], v[196:199]
  v_exp_f32 v63, v63
  v_mfma_f32_16x16x32_bf16 v[196:199], a[132:135], v[84:87], v[196:199]
  ds_read_b128 a[120:123], v1 offset:47104
  v_cvt_pk_bf16_f32 v111, v62, v63
  v_mfma_f32_16x16x32_bf16 v[52:55], a[96:99], a[4:7], v[36:39]
  v_exp_f32 v48, v48
  v_mfma_f32_16x16x32_bf16 v[52:55], a[100:103], a[20:23], v[52:55]
  ds_read_b128 a[124:127], v1 offset:48128
  v_and_b32 v21, 15, v0
  v_mfma_f32_16x16x32_bf16 v[52:55], a[104:107], a[36:39], v[52:55]
  v_exp_f32 v49, v49
  v_mfma_f32_16x16x32_bf16 v[52:55], a[108:111], a[52:55], v[52:55]
  ds_read_b128 a[144:147], v2 offset:45056
  v_cvt_pk_bf16_f32 v112, v48, v49
  v_mfma_f32_16x16x32_bf16 v[200:203], a[128:131], v[72:75], v[200:203]
  v_exp_f32 v50, v50
  v_mfma_f32_16x16x32_bf16 v[200:203], a[132:135], v[88:91], v[200:203]
  v_lshlrev_b32 v21, 3, v21
  v_bfe_u32 v22, v0, 4, 1
  v_mfma_f32_16x16x32_bf16 v[204:207], a[128:131], v[76:79], v[204:207]
  v_exp_f32 v51, v51
  v_mfma_f32_16x16x32_bf16 v[204:207], a[132:135], v[92:95], v[204:207]
  ds_read_b128 a[148:151], v2 offset:46080
  v_cvt_pk_bf16_f32 v113, v50, v51
  v_mfma_f32_16x16x32_bf16 v[56:59], a[96:99], a[8:11], v[40:43]
  v_exp_f32 v52, v52
  v_mfma_f32_16x16x32_bf16 v[56:59], a[100:103], a[24:27], v[56:59]
  ds_read_b128 a[152:155], v2 offset:47104
  v_mul_u32_u24 v22, 196608, v22
  v_mfma_f32_16x16x32_bf16 v[56:59], a[104:107], a[40:43], v[56:59]
  s_waitcnt lgkmcnt(7)
  s_mov_b32 s70, s62
  v_exp_f32 v53, v53
  v_mfma_f32_16x16x32_bf16 v[56:59], a[108:111], a[56:59], v[56:59]
  s_mov_b32 s62, s60
  ds_read_b128 a[156:159], v2 offset:48128
  v_cvt_pk_bf16_f32 v116, v52, v53
  v_mfma_f32_16x16x32_bf16 v[208:211], a[136:139], v[64:67], v[208:211]
  s_lshl_b32 s66, s60, 15
  v_exp_f32 v54, v54
  v_mfma_f32_16x16x32_bf16 v[208:211], a[140:143], v[80:83], v[208:211]
  s_add_u32 s66, s66, s64
  v_add_u32 v21, v21, v22
  v_mov_b32 v14, -1.0
  v_mfma_f32_16x16x32_bf16 v[212:215], a[136:139], v[68:71], v[212:215]
  s_add_u32 s60, s60, 1
  v_exp_f32 v55, v55
  v_mfma_f32_16x16x32_bf16 v[212:215], a[140:143], v[84:87], v[212:215]
  s_cmp_eq_u32 s60, s57
  s_addc_u32 s60, s60, 0
  v_cvt_pk_bf16_f32 v117, v54, v55
  v_mov_b32 v15, -1.0
  v_mfma_f32_16x16x32_bf16 a[172:175], a[160:163], v[72:75], a[172:175]
  s_add_u32 s52, s61, 2
  v_mfma_f32_16x16x32_bf16 a[172:175], a[160:163], v[88:91], a[172:175]
  s_cmp_gt_u32 s58, s52
  s_cselect_b32 s66, s66, s78
  v_mfma_f32_16x16x32_bf16 v[60:63], a[96:99], a[12:15], v[44:47]
  s_cmp_gt_u32 s58, s52
  s_cselect_b32 s80, s56, s77
  v_exp_f32 v56, v56
  v_mfma_f32_16x16x32_bf16 v[60:63], a[100:103], a[28:31], v[60:63]
  s_lshl_b32 s9, s8, 7
  v_mfma_f32_16x16x32_bf16 v[60:63], a[104:107], a[44:47], v[60:63]
  s_add_u32 s9, s9, 65536
  v_exp_f32 v57, v57
  v_mfma_f32_16x16x32_bf16 v[60:63], a[108:111], a[60:63], v[60:63]
  v_cvt_pk_bf16_f32 v120, v56, v57
  v_mfma_f32_16x16x32_bf16 v[216:219], a[136:139], v[72:75], v[216:219]
  v_exp_f32 v58, v58
  v_mfma_f32_16x16x32_bf16 v[216:219], a[140:143], v[88:91], v[216:219]
  s_waitcnt vmcnt(4) lgkmcnt(0)
  s_barrier
  buffer_store_dwordx2 v[14:15], v21, s[28:31], s9 offen sc1
  v_mfma_f32_16x16x32_bf16 v[220:223], a[136:139], v[76:79], v[220:223]
  s_add_u32 m0, s80, 32768
  v_exp_f32 v59, v59
  v_mfma_f32_16x16x32_bf16 v[220:223], a[140:143], v[92:95], v[220:223]
  v_cvt_pk_bf16_f32 v121, v58, v59
  v_lshrrev_b32 v4, 2, v0
  v_mfma_f32_16x16x32_bf16 v[48:51], a[112:115], a[0:3], v[32:35]
  v_exp_f32 v60, v60
  v_mfma_f32_16x16x32_bf16 v[48:51], a[116:119], a[16:19], v[48:51]
  buffer_load_dwordx4 v5, s[28:31], s66 offen offset:0 sc1 lds
  v_mfma_f32_16x16x32_bf16 v[48:51], a[120:123], a[32:35], v[48:51]
  v_exp_f32 v61, v61
  v_mfma_f32_16x16x32_bf16 v[48:51], a[124:127], a[48:51], v[48:51]
  ds_read_b128 a[64:67], v1 offset:0
  v_cvt_pk_bf16_f32 v124, v60, v61
  v_mfma_f32_16x16x32_bf16 v[224:227], a[144:147], v[64:67], v[224:227]
  v_exp_f32 v62, v62
  v_mfma_f32_16x16x32_bf16 v[224:227], a[148:151], v[80:83], v[224:227]
  buffer_load_dwordx4 v5, s[28:31], s66 offen offset:1024 sc1 lds
  v_mfma_f32_16x16x32_bf16 v[228:231], a[144:147], v[68:71], v[228:231]
  v_exp_f32 v63, v63
  v_mfma_f32_16x16x32_bf16 v[228:231], a[148:151], v[84:87], v[228:231]
  ds_read_b128 a[68:71], v1 offset:1024
  v_cvt_pk_bf16_f32 v125, v62, v63
  v_mfma_f32_16x16x32_bf16 v[52:55], a[112:115], a[4:7], v[36:39]
  v_exp_f32 v48, v48
  v_mfma_f32_16x16x32_bf16 v[52:55], a[116:119], a[20:23], v[52:55]
  buffer_load_dwordx4 v5, s[28:31], s66 offen offset:2048 sc1 lds
  v_mfma_f32_16x16x32_bf16 v[52:55], a[120:123], a[36:39], v[52:55]
  v_exp_f32 v49, v49
  v_mfma_f32_16x16x32_bf16 v[52:55], a[124:127], a[52:55], v[52:55]
  ds_read_b128 a[72:75], v1 offset:2048
  v_cvt_pk_bf16_f32 v114, v48, v49
  v_mfma_f32_16x16x32_bf16 v[232:235], a[144:147], v[72:75], v[232:235]
  v_exp_f32 v50, v50
  v_mfma_f32_16x16x32_bf16 v[232:235], a[148:151], v[88:91], v[232:235]
  buffer_load_dwordx4 v5, s[28:31], s66 offen offset:3072 sc1 lds
  v_mfma_f32_16x16x32_bf16 v[236:239], a[144:147], v[76:79], v[236:239]
  v_exp_f32 v51, v51
  v_mfma_f32_16x16x32_bf16 v[236:239], a[148:151], v[92:95], v[236:239]
  s_add_u32 m0, s80, 36864
  ds_read_b128 a[76:79], v1 offset:3072
  v_cvt_pk_bf16_f32 v115, v50, v51
  v_mfma_f32_16x16x32_bf16 v[56:59], a[112:115], a[8:11], v[40:43]
  s_add_u32 s66, s66, 4096
  v_exp_f32 v52, v52
  v_mfma_f32_16x16x32_bf16 v[56:59], a[116:119], a[24:27], v[56:59]
  buffer_load_dwordx4 v5, s[28:31], s66 offen offset:0 sc1 lds
  v_mfma_f32_16x16x32_bf16 v[56:59], a[120:123], a[40:43], v[56:59]
  v_exp_f32 v53, v53
  v_mfma_f32_16x16x32_bf16 v[56:59], a[124:127], a[56:59], v[56:59]
  ds_read_b128 a[128:131], v2 offset:0
  v_cvt_pk_bf16_f32 v118, v52, v53
  v_mfma_f32_16x16x32_bf16 v[240:243], a[152:155], v[64:67], v[240:243]
  v_exp_f32 v54, v54
  v_mfma_f32_16x16x32_bf16 v[240:243], a[156:159], v[80:83], v[240:243]
  buffer_load_dwordx4 v5, s[28:31], s66 offen offset:1024 sc1 lds
  v_mfma_f32_16x16x32_bf16 v[244:247], a[152:155], v[68:71], v[244:247]
  v_exp_f32 v55, v55
  v_mfma_f32_16x16x32_bf16 v[244:247], a[156:159], v[84:87], v[244:247]
  ds_read_b128 a[132:135], v2 offset:1024
  v_cvt_pk_bf16_f32 v119, v54, v55
  v_mfma_f32_16x16x32_bf16 a[176:179], a[160:163], v[76:79], a[176:179]
  buffer_load_dwordx4 v5, s[28:31], s66 offen offset:2048 sc1 lds
  v_mfma_f32_16x16x32_bf16 a[176:179], a[160:163], v[92:95], a[176:179]
  v_bfe_u32 v12, v0, 3, 2
  v_lshlrev_b32 v12, 5, v12
  v_mfma_f32_16x16x32_bf16 v[60:63], a[112:115], a[12:15], v[44:47]
  v_exp_f32 v56, v56
  v_mfma_f32_16x16x32_bf16 v[60:63], a[116:119], a[28:31], v[60:63]
  buffer_load_dwordx4 v5, s[28:31], s66 offen offset:3072 sc1 lds
  v_mfma_f32_16x16x32_bf16 v[60:63], a[120:123], a[44:47], v[60:63]
  v_exp_f32 v57, v57
  v_mfma_f32_16x16x32_bf16 v[60:63], a[124:127], a[60:63], v[60:63]
  ds_read_b128 a[136:139], v2 offset:2048
  v_cvt_pk_bf16_f32 v122, v56, v57
  v_mfma_f32_16x16x32_bf16 v[248:251], a[152:155], v[72:75], v[248:251]
  v_exp_f32 v58, v58
  v_mfma_f32_16x16x32_bf16 v[248:251], a[156:159], v[88:91], v[248:251]
  v_lshl_add_u32 v12, v4, 7, v12
  v_and_b32 v4, 3, v0
  v_mfma_f32_16x16x32_bf16 v[252:255], a[152:155], v[76:79], v[252:255]
  s_add_u32 s61, s61, 1
  v_exp_f32 v59, v59
  v_mfma_f32_16x16x32_bf16 v[252:255], a[156:159], v[92:95], v[252:255]
  s_waitcnt lgkmcnt(1)
  ds_read_b128 a[140:143], v2 offset:3072
  v_cvt_pk_bf16_f32 v123, v58, v59
  v_lshl_add_u32 v12, v4, 3, v12
  v_add_u32 v12, s19, v12
  v_xor_b32 v13, 32, v12
  v_xor_b32 v14, 64, v12
  v_xor_b32 v15, 96, v12
  v_mfma_f32_16x16x32_bf16 v[48:51], a[64:67], a[0:3], v[32:35]
  s_lshl_b32 s67, s70, 15
  v_exp_f32 v60, v60
  v_mfma_f32_16x16x32_bf16 v[48:51], a[68:71], a[16:19], v[48:51]
  s_add_u32 s67, s67, s65
  v_add_u32 v23, 0, v0
  v_mul_u32_u24 v19, 3277, v23
  v_mfma_f32_16x16x32_bf16 v[48:51], a[72:75], a[32:35], v[48:51]
  s_add_u32 m0, s56, 98304
  v_exp_f32 v61, v61
  v_mfma_f32_16x16x32_bf16 v[48:51], a[76:79], a[48:51], v[48:51]
  ds_read_b128 a[80:83], v1 offset:4096
  v_cvt_pk_bf16_f32 v126, v60, v61
  v_mfma_f32_16x16x32_bf16 v[128:131], a[128:131], v[96:99], v[128:131]
  v_exp_f32 v62, v62
  v_mfma_f32_16x16x32_bf16 v[128:131], a[132:135], v[112:115], v[128:131]
  buffer_load_dwordx4 v5, s[28:31], s67 offen offset:0 sc1 lds
  v_mfma_f32_16x16x32_bf16 v[132:135], a[128:131], v[100:103], v[132:135]
  v_exp_f32 v63, v63
  v_mfma_f32_16x16x32_bf16 v[132:135], a[132:135], v[116:119], v[132:135]
  ds_read_b128 a[84:87], v1 offset:5120
  v_cvt_pk_bf16_f32 v127, v62, v63
  v_mfma_f32_16x16x32_bf16 v[52:55], a[64:67], a[4:7], v[36:39]
  v_exp_f32 v48, v48
  v_mfma_f32_16x16x32_bf16 v[52:55], a[68:71], a[20:23], v[52:55]
  buffer_load_dwordx4 v5, s[28:31], s67 offen offset:1024 sc1 lds
  v_mfma_f32_16x16x32_bf16 v[52:55], a[72:75], a[36:39], v[52:55]
  v_exp_f32 v49, v49
  v_mfma_f32_16x16x32_bf16 v[52:55], a[76:79], a[52:55], v[52:55]
  ds_read_b128 a[88:91], v1 offset:6144
  v_cvt_pk_bf16_f32 v64, v48, v49
  v_mfma_f32_16x16x32_bf16 v[136:139], a[128:131], v[104:107], v[136:139]
  v_exp_f32 v50, v50
  v_mfma_f32_16x16x32_bf16 v[136:139], a[132:135], v[120:123], v[136:139]
  buffer_load_dwordx4 v5, s[28:31], s67 offen offset:2048 sc1 lds
  v_mfma_f32_16x16x32_bf16 v[140:143], a[128:131], v[108:111], v[140:143]
  v_exp_f32 v51, v51
  v_mfma_f32_16x16x32_bf16 v[140:143], a[132:135], v[124:127], v[140:143]
  ds_read_b128 a[92:95], v1 offset:7168
  v_cvt_pk_bf16_f32 v65, v50, v51
  v_mfma_f32_16x16x32_bf16 v[56:59], a[64:67], a[8:11], v[40:43]
  v_exp_f32 v52, v52
  v_mfma_f32_16x16x32_bf16 v[56:59], a[68:71], a[24:27], v[56:59]
  buffer_load_dwordx4 v5, s[28:31], s67 offen offset:3072 sc1 lds
  v_mfma_f32_16x16x32_bf16 v[56:59], a[72:75], a[40:43], v[56:59]
  s_waitcnt lgkmcnt(4)
  v_exp_f32 v53, v53
  v_mfma_f32_16x16x32_bf16 v[56:59], a[76:79], a[56:59], v[56:59]
  ds_read_b128 a[144:147], v2 offset:4096
  v_cvt_pk_bf16_f32 v68, v52, v53
  v_mfma_f32_16x16x32_bf16 v[144:147], a[136:139], v[96:99], v[144:147]
  v_exp_f32 v54, v54
  v_mfma_f32_16x16x32_bf16 v[144:147], a[140:143], v[112:115], v[144:147]
  s_waitcnt vmcnt(13)
  s_add_u32 m0, s56, 102400
  ds_read_b64_tr_b16 a[180:181], v12 offset:0
  v_lshrrev_b32 v19, 16, v19
  v_mfma_f32_16x16x32_bf16 v[148:151], a[136:139], v[100:103], v[148:151]
  s_add_u32 s67, s67, 4096
  v_exp_f32 v55, v55
  v_mfma_f32_16x16x32_bf16 v[148:151], a[140:143], v[116:119], v[148:151]
  ds_read_b128 a[148:151], v2 offset:5120
  v_cvt_pk_bf16_f32 v69, v54, v55
  v_mfma_f32_16x16x32_bf16 a[164:167], a[160:163], v[96:99], a[164:167]
  buffer_load_dwordx4 v5, s[28:31], s67 offen offset:0 sc1 lds
  v_mfma_f32_16x16x32_bf16 a[164:167], a[160:163], v[112:115], a[164:167]
  ds_read_b64_tr_b16 a[182:183], v12 offset:2048
  v_mul_u32_u24 v4, 20, v19
  v_mfma_f32_16x16x32_bf16 v[60:63], a[64:67], a[12:15], v[44:47]
  v_exp_f32 v56, v56
  v_mfma_f32_16x16x32_bf16 v[60:63], a[68:71], a[28:31], v[60:63]
  ds_read_b64_tr_b16 a[184:185], v13 offset:0
  v_sub_u32 v23, v23, v4
  v_mfma_f32_16x16x32_bf16 v[60:63], a[72:75], a[44:47], v[60:63]
  v_exp_f32 v57, v57
  v_mfma_f32_16x16x32_bf16 v[60:63], a[76:79], a[60:63], v[60:63]
  ds_read_b128 a[152:155], v2 offset:6144
  v_cvt_pk_bf16_f32 v72, v56, v57
  v_mfma_f32_16x16x32_bf16 v[152:155], a[136:139], v[104:107], v[152:155]
  v_exp_f32 v58, v58
  v_mfma_f32_16x16x32_bf16 v[152:155], a[140:143], v[120:123], v[152:155]
  buffer_load_dwordx4 v5, s[28:31], s67 offen offset:1024 sc1 lds
  v_mfma_f32_16x16x32_bf16 v[156:159], a[136:139], v[108:111], v[156:159]
  v_exp_f32 v59, v59
  v_mfma_f32_16x16x32_bf16 v[156:159], a[140:143], v[124:127], v[156:159]
  s_waitcnt lgkmcnt(1)
  ds_read_b128 a[156:159], v2 offset:7168
  v_cvt_pk_bf16_f32 v73, v58, v59
  v_mfma_f32_16x16x32_bf16 v[48:51], a[80:83], a[0:3], v[32:35]
  v_exp_f32 v60, v60
  v_mfma_f32_16x16x32_bf16 v[48:51], a[84:87], a[16:19], v[48:51]
  buffer_load_dwordx4 v5, s[28:31], s67 offen offset:2048 sc1 lds
  v_mfma_f32_16x16x32_bf16 v[48:51], a[88:91], a[32:35], v[48:51]
  v_exp_f32 v61, v61
  v_mfma_f32_16x16x32_bf16 v[48:51], a[92:95], a[48:51], v[48:51]
  ds_read_b128 a[96:99], v1 offset:8192
  v_cvt_pk_bf16_f32 v76, v60, v61
  v_mfma_f32_16x16x32_bf16 v[160:163], a[144:147], v[96:99], v[160:163]
  v_exp_f32 v62, v62
  v_mfma_f32_16x16x32_bf16 v[160:163], a[148:151], v[112:115], v[160:163]
  buffer_load_dwordx4 v5, s[28:31], s67 offen offset:3072 sc1 lds
  v_mfma_f32_16x16x32_bf16 v[164:167], a[144:147], v[100:103], v[164:167]
  s_lshr_b32 s9, s8, 5
  v_exp_f32 v63, v63
  v_mfma_f32_16x16x32_bf16 v[164:167], a[148:151], v[116:119], v[164:167]
  s_add_u32 s9, s9, 0
  ds_read_b128 a[100:103], v1 offset:9216
  v_cvt_pk_bf16_f32 v77, v62, v63
  v_mfma_f32_16x16x32_bf16 v[52:55], a[80:83], a[4:7], v[36:39]
  s_and_b32 s10, s8, 31
  v_exp_f32 v48, v48
  v_mfma_f32_16x16x32_bf16 v[52:55], a[84:87], a[20:23], v[52:55]
  s_lshl_b32 s16, s9, 17
  ds_read_b64_tr_b16 a[186:187], v13 offset:2048
  v_bfe_u32 v4, v19, 2, 1
  v_mfma_f32_16x16x32_bf16 v[52:55], a[88:91], a[36:39], v[52:55]
  s_lshl_b32 s10, s10, 7
  v_exp_f32 v49, v49
  v_mfma_f32_16x16x32_bf16 v[52:55], a[92:95], a[52:55], v[52:55]
  s_add_u32 s16, s16, s10
  ds_read_b128 a[104:107], v1 offset:10240
  v_cvt_pk_bf16_f32 v66, v48, v49
  v_mfma_f32_16x16x32_bf16 v[168:171], a[144:147], v[104:107], v[168:171]
  s_mov_b32 s18, 4096
  v_exp_f32 v50, v50
  v_mfma_f32_16x16x32_bf16 v[168:171], a[148:151], v[120:123], v[168:171]
  buffer_store_dwordx4 a[180:183], v3, s[28:31], s17 offen offset:0 sc1
  v_mfma_f32_16x16x32_bf16 v[172:175], a[144:147], v[108:111], v[172:175]
  v_exp_f32 v51, v51
  v_mfma_f32_16x16x32_bf16 v[172:175], a[148:151], v[124:127], v[172:175]
  ds_read_b128 a[108:111], v1 offset:11264
  v_cvt_pk_bf16_f32 v67, v50, v51
  v_mfma_f32_16x16x32_bf16 v[56:59], a[80:83], a[8:11], v[40:43]
  s_and_b32 s53, s49, 3
  v_exp_f32 v52, v52
  v_mfma_f32_16x16x32_bf16 v[56:59], a[84:87], a[24:27], v[56:59]
  s_mul_i32 s54, s53, 320
  ds_read_b64_tr_b16 a[188:189], v14 offset:0
  v_lshlrev_b32 v4, 1, v4
  v_mfma_f32_16x16x32_bf16 v[56:59], a[88:91], a[40:43], v[56:59]
  s_waitcnt lgkmcnt(6)
  s_mul_i32 s53, s48, 40960
  v_exp_f32 v53, v53
  v_mfma_f32_16x16x32_bf16 v[56:59], a[92:95], a[56:59], v[56:59]
  s_add_u32 s54, s54, s53
  ds_read_b128 a[128:131], v2 offset:8192
  v_cvt_pk_bf16_f32 v70, v52, v53
  v_mfma_f32_16x16x32_bf16 v[176:179], a[152:155], v[96:99], v[176:179]
  s_lshr_b32 s53, s49, 2
  v_exp_f32 v54, v54
  v_mfma_f32_16x16x32_bf16 v[176:179], a[156:159], v[112:115], v[176:179]
  s_mul_i32 s53, s53, 655360
  ds_read_b64_tr_b16 a[190:191], v14 offset:2048
  v_xor_b32 v23, v23, v4
  v_mfma_f32_16x16x32_bf16 v[180:183], a[152:155], v[100:103], v[180:183]
  s_add_u32 s54, s54, s53
  v_exp_f32 v55, v55
  v_mfma_f32_16x16x32_bf16 v[180:183], a[156:159], v[116:119], v[180:183]
  s_mov_b32 s40, 0x2b800000
  ds_read_b128 a[132:135], v2 offset:9216
  v_cvt_pk_bf16_f32 v71, v54, v55
  v_mfma_f32_16x16x32_bf16 a[168:171], a[160:163], v[100:103], a[168:171]
  s_mov_b32 s41, 0x53800000
  s_waitcnt lgkmcnt(6)
  buffer_store_dwordx4 a[184:187], v3, s[28:31], s17 offen offset:1024 sc1
  v_mfma_f32_16x16x32_bf16 a[168:171], a[160:163], v[116:119], a[168:171]
  s_bitcmp1_b32 s48, 0
  s_cselect_b64 s[42:43], -1, 0
  ds_read_b64_tr_b16 v[28:29], v15 offset:0
  v_mul_u32_u24 v19, 1280, v19
  v_mfma_f32_16x16x32_bf16 v[60:63], a[80:83], a[12:15], v[44:47]
  s_bitcmp1_b32 s48, 1
  s_cselect_b64 s[74:75], -1, 0
  v_exp_f32 v56, v56
  v_mfma_f32_16x16x32_bf16 v[60:63], a[84:87], a[28:31], v[60:63]
  s_mul_i32 s71, s48, 10240
  ds_read_b64_tr_b16 v[30:31], v15 offset:2048
  v_lshl_add_u32 v23, v23, 4, v19
  v_mfma_f32_16x16x32_bf16 v[60:63], a[88:91], a[44:47], v[60:63]
  s_lshr_b32 s81, s49, 2
  v_exp_f32 v57, v57
  v_mfma_f32_16x16x32_bf16 v[60:63], a[92:95], a[60:63], v[60:63]
  s_lshl_b32 s81, s81, 3
  ds_read_b128 a[136:139], v2 offset:10240
  v_cvt_pk_bf16_f32 v74, v56, v57
  v_mfma_f32_16x16x32_bf16 v[184:187], a[152:155], v[104:107], v[184:187]
  s_add_u32 s81, s81, s50
  v_exp_f32 v58, v58
  v_mfma_f32_16x16x32_bf16 v[184:187], a[156:159], v[120:123], v[184:187]
  s_lshl_b32 s81, s81, 2
  s_waitcnt lgkmcnt(4)
  buffer_store_dwordx4 a[188:191], v3, s[28:31], s17 offen offset:2048 sc1
  v_mfma_f32_16x16x32_bf16 v[188:191], a[152:155], v[108:111], v[188:191]
  s_add_u32 s82, s81, s48
  v_exp_f32 v59, v59
  v_mfma_f32_16x16x32_bf16 v[188:191], a[156:159], v[124:127], v[188:191]
  s_waitcnt lgkmcnt(1)
  s_lshl_b32 s81, s82, 2
  ds_read_b128 a[140:143], v2 offset:11264
  v_cvt_pk_bf16_f32 v75, v58, v59
  v_mfma_f32_16x16x32_bf16 v[48:51], a[96:99], a[0:3], v[32:35]
  s_and_b32 s53, s49, 3
  v_exp_f32 v60, v60
  v_mfma_f32_16x16x32_bf16 v[48:51], a[100:103], a[16:19], v[48:51]
  s_add_u32 s81, s81, s53
  ds_read_b128 a[112:115], v1 offset:12288
  v_mfma_f32_16x16x32_bf16 v[48:51], a[104:107], a[32:35], v[48:51]
  s_lshl_b32 s81, s81, 14
  v_exp_f32 v61, v61
  v_mfma_f32_16x16x32_bf16 v[48:51], a[108:111], a[48:51], v[48:51]
  s_add_u32 s81, s81, 37748736
  ds_read_b128 a[116:119], v1 offset:13312
  v_cvt_pk_bf16_f32 v78, v60, v61
  v_mfma_f32_16x16x32_bf16 v[192:195], a[128:131], v[96:99], v[192:195]
  v_exp_f32 v62, v62
  v_mfma_f32_16x16x32_bf16 v[192:195], a[132:135], v[112:115], v[192:195]
  v_add_u32 v24, 64, v0
  v_mul_u32_u24 v19, 3277, v24
  v_mfma_f32_16x16x32_bf16 v[196:199], a[128:131], v[100:103], v[196:199]
  v_exp_f32 v63, v63
  v_mfma_f32_16x16x32_bf16 v[196:199], a[132:135], v[116:119], v[196:199]
  ds_read_b128 a[120:123], v1 offset:14336
  v_cvt_pk_bf16_f32 v79, v62, v63
  v_mfma_f32_16x16x32_bf16 v[52:55], a[96:99], a[4:7], v[36:39]
  v_exp_f32 v48, v48
  v_mfma_f32_16x16x32_bf16 v[52:55], a[100:103], a[20:23], v[52:55]
  ds_read_b128 a[124:127], v1 offset:15360
  v_lshrrev_b32 v19, 16, v19
  v_mfma_f32_16x16x32_bf16 v[52:55], a[104:107], a[36:39], v[52:55]
  v_exp_f32 v49, v49
  v_mfma_f32_16x16x32_bf16 v[52:55], a[108:111], a[52:55], v[52:55]
  ds_read_b128 a[144:147], v2 offset:12288
  v_cvt_pk_bf16_f32 v80, v48, v49
  v_mfma_f32_16x16x32_bf16 v[200:203], a[128:131], v[104:107], v[200:203]
  v_exp_f32 v50, v50
  v_mfma_f32_16x16x32_bf16 v[200:203], a[132:135], v[120:123], v[200:203]
  buffer_store_dwordx4 v[28:31], v3, s[28:31], s17 offen offset:3072 sc1
  v_mfma_f32_16x16x32_bf16 v[204:207], a[128:131], v[108:111], v[204:207]
  v_exp_f32 v51, v51
  v_mfma_f32_16x16x32_bf16 v[204:207], a[132:135], v[124:127], v[204:207]
  ds_read_b128 a[148:151], v2 offset:13312
  v_cvt_pk_bf16_f32 v81, v50, v51
  v_mfma_f32_16x16x32_bf16 v[56:59], a[96:99], a[8:11], v[40:43]
  v_exp_f32 v52, v52
  v_mfma_f32_16x16x32_bf16 v[56:59], a[100:103], a[24:27], v[56:59]
  ds_read_b128 a[152:155], v2 offset:14336
  v_mul_u32_u24 v4, 20, v19
  v_mfma_f32_16x16x32_bf16 v[56:59], a[104:107], a[40:43], v[56:59]
  s_waitcnt lgkmcnt(7)
  s_mov_b32 s70, s62
  v_exp_f32 v53, v53
  v_mfma_f32_16x16x32_bf16 v[56:59], a[108:111], a[56:59], v[56:59]
  s_mov_b32 s62, s60
  ds_read_b128 a[156:159], v2 offset:15360
  v_cvt_pk_bf16_f32 v84, v52, v53
  v_mfma_f32_16x16x32_bf16 v[208:211], a[136:139], v[96:99], v[208:211]
  s_lshl_b32 s66, s60, 15
  v_exp_f32 v54, v54
  v_mfma_f32_16x16x32_bf16 v[208:211], a[140:143], v[112:115], v[208:211]
  s_add_u32 s66, s66, s64
  v_sub_u32 v24, v24, v4
  v_bfe_u32 v4, v19, 2, 1
  v_mfma_f32_16x16x32_bf16 v[212:215], a[136:139], v[100:103], v[212:215]
  s_add_u32 s60, s60, 1
  v_exp_f32 v55, v55
  v_mfma_f32_16x16x32_bf16 v[212:215], a[140:143], v[116:119], v[212:215]
  s_cmp_eq_u32 s60, s57
  s_addc_u32 s60, s60, 0
  v_cvt_pk_bf16_f32 v85, v54, v55
  v_lshlrev_b32 v4, 1, v4
  v_mfma_f32_16x16x32_bf16 a[172:175], a[160:163], v[104:107], a[172:175]
  s_add_u32 s52, s61, 2
  v_xor_b32 v24, v24, v4
  v_mul_u32_u24 v19, 1280, v19
  v_mfma_f32_16x16x32_bf16 a[172:175], a[160:163], v[120:123], a[172:175]
  s_cmp_gt_u32 s58, s52
  s_cselect_b32 s66, s66, s63
  v_lshl_add_u32 v24, v24, 4, v19
  v_mfma_f32_16x16x32_bf16 v[60:63], a[96:99], a[12:15], v[44:47]
  s_cmp_gt_u32 s58, s52
  s_cselect_b32 s80, s56, s77
  v_exp_f32 v56, v56
  v_mfma_f32_16x16x32_bf16 v[60:63], a[100:103], a[28:31], v[60:63]
  v_mfma_f32_16x16x32_bf16 v[60:63], a[104:107], a[44:47], v[60:63]
  v_exp_f32 v57, v57
  v_mfma_f32_16x16x32_bf16 v[60:63], a[108:111], a[60:63], v[60:63]
  v_cvt_pk_bf16_f32 v88, v56, v57
  v_mfma_f32_16x16x32_bf16 v[216:219], a[136:139], v[104:107], v[216:219]
  v_exp_f32 v58, v58
  v_mfma_f32_16x16x32_bf16 v[216:219], a[140:143], v[120:123], v[216:219]
  s_waitcnt vmcnt(4) lgkmcnt(0)
  s_barrier
  v_mfma_f32_16x16x32_bf16 v[220:223], a[136:139], v[108:111], v[220:223]
  s_add_u32 m0, s80, 0
  v_exp_f32 v59, v59
  v_mfma_f32_16x16x32_bf16 v[220:223], a[140:143], v[124:127], v[220:223]
  v_cvt_pk_bf16_f32 v89, v58, v59
  v_mfma_f32_16x16x32_bf16 v[48:51], a[112:115], a[0:3], v[32:35]
  v_exp_f32 v60, v60
  v_mfma_f32_16x16x32_bf16 v[48:51], a[116:119], a[16:19], v[48:51]
  buffer_load_dwordx4 v5, s[28:31], s66 offen offset:0 sc1 lds
  v_mfma_f32_16x16x32_bf16 v[48:51], a[120:123], a[32:35], v[48:51]
  v_exp_f32 v61, v61
  v_mfma_f32_16x16x32_bf16 v[48:51], a[124:127], a[48:51], v[48:51]
  ds_read_b128 a[64:67], v1 offset:32768
  v_cvt_pk_bf16_f32 v92, v60, v61
  v_mfma_f32_16x16x32_bf16 v[224:227], a[144:147], v[96:99], v[224:227]
  v_exp_f32 v62, v62
  v_mfma_f32_16x16x32_bf16 v[224:227], a[148:151], v[112:115], v[224:227]
  buffer_load_dwordx4 v5, s[28:31], s66 offen offset:1024 sc1 lds
  v_mfma_f32_16x16x32_bf16 v[228:231], a[144:147], v[100:103], v[228:231]
  v_exp_f32 v63, v63
  v_mfma_f32_16x16x32_bf16 v[228:231], a[148:151], v[116:119], v[228:231]
  ds_read_b128 a[68:71], v1 offset:33792
  v_cvt_pk_bf16_f32 v93, v62, v63
  v_mfma_f32_16x16x32_bf16 v[52:55], a[112:115], a[4:7], v[36:39]
  v_exp_f32 v48, v48
  v_mfma_f32_16x16x32_bf16 v[52:55], a[116:119], a[20:23], v[52:55]
  buffer_load_dwordx4 v5, s[28:31], s66 offen offset:2048 sc1 lds
  v_mfma_f32_16x16x32_bf16 v[52:55], a[120:123], a[36:39], v[52:55]
  v_exp_f32 v49, v49
  v_mfma_f32_16x16x32_bf16 v[52:55], a[124:127], a[52:55], v[52:55]
  ds_read_b128 a[72:75], v1 offset:34816
  v_cvt_pk_bf16_f32 v82, v48, v49
  v_mfma_f32_16x16x32_bf16 v[232:235], a[144:147], v[104:107], v[232:235]
  v_exp_f32 v50, v50
  v_mfma_f32_16x16x32_bf16 v[232:235], a[148:151], v[120:123], v[232:235]
  buffer_load_dwordx4 v5, s[28:31], s66 offen offset:3072 sc1 lds
  v_mfma_f32_16x16x32_bf16 v[236:239], a[144:147], v[108:111], v[236:239]
  v_exp_f32 v51, v51
  v_mfma_f32_16x16x32_bf16 v[236:239], a[148:151], v[124:127], v[236:239]
  s_add_u32 m0, s80, 4096
  ds_read_b128 a[76:79], v1 offset:35840
  v_cvt_pk_bf16_f32 v83, v50, v51
  v_mfma_f32_16x16x32_bf16 v[56:59], a[112:115], a[8:11], v[40:43]
  s_add_u32 s66, s66, 4096
  v_exp_f32 v52, v52
  v_mfma_f32_16x16x32_bf16 v[56:59], a[116:119], a[24:27], v[56:59]
  buffer_load_dwordx4 v5, s[28:31], s66 offen offset:0 sc1 lds
  v_mfma_f32_16x16x32_bf16 v[56:59], a[120:123], a[40:43], v[56:59]
  v_exp_f32 v53, v53
  v_mfma_f32_16x16x32_bf16 v[56:59], a[124:127], a[56:59], v[56:59]
  ds_read_b128 a[128:131], v2 offset:32768
  v_cvt_pk_bf16_f32 v86, v52, v53
  v_mfma_f32_16x16x32_bf16 v[240:243], a[152:155], v[96:99], v[240:243]
  v_exp_f32 v54, v54
  v_mfma_f32_16x16x32_bf16 v[240:243], a[156:159], v[112:115], v[240:243]
  buffer_load_dwordx4 v5, s[28:31], s66 offen offset:1024 sc1 lds
  v_mfma_f32_16x16x32_bf16 v[244:247], a[152:155], v[100:103], v[244:247]
  v_exp_f32 v55, v55
  v_mfma_f32_16x16x32_bf16 v[244:247], a[156:159], v[116:119], v[244:247]
  ds_read_b128 a[132:135], v2 offset:33792
  v_cvt_pk_bf16_f32 v87, v54, v55
  v_mfma_f32_16x16x32_bf16 a[176:179], a[160:163], v[108:111], a[176:179]
  buffer_load_dwordx4 v5, s[28:31], s66 offen offset:2048 sc1 lds
  v_mfma_f32_16x16x32_bf16 a[176:179], a[160:163], v[124:127], a[176:179]
  v_mfma_f32_16x16x32_bf16 v[60:63], a[112:115], a[12:15], v[44:47]
  v_exp_f32 v56, v56
  v_mfma_f32_16x16x32_bf16 v[60:63], a[116:119], a[28:31], v[60:63]
  buffer_load_dwordx4 v5, s[28:31], s66 offen offset:3072 sc1 lds
  v_mfma_f32_16x16x32_bf16 v[60:63], a[120:123], a[44:47], v[60:63]
  v_exp_f32 v57, v57
  v_mfma_f32_16x16x32_bf16 v[60:63], a[124:127], a[60:63], v[60:63]
  ds_read_b128 a[136:139], v2 offset:34816
  v_cvt_pk_bf16_f32 v90, v56, v57
  v_mfma_f32_16x16x32_bf16 v[248:251], a[152:155], v[104:107], v[248:251]
  v_exp_f32 v58, v58
  v_mfma_f32_16x16x32_bf16 v[248:251], a[156:159], v[120:123], v[248:251]
  v_mfma_f32_16x16x32_bf16 v[252:255], a[152:155], v[108:111], v[252:255]
  s_add_u32 s61, s61, 1
  v_exp_f32 v59, v59
  v_mfma_f32_16x16x32_bf16 v[252:255], a[156:159], v[124:127], v[252:255]
  s_waitcnt lgkmcnt(1)
  ds_read_b128 a[140:143], v2 offset:35840
  v_cvt_pk_bf16_f32 v91, v58, v59
  v_mfma_f32_16x16x32_bf16 v[48:51], a[64:67], a[0:3], v[32:35]
  s_lshl_b32 s67, s70, 15
  v_exp_f32 v60, v60
  v_mfma_f32_16x16x32_bf16 v[48:51], a[68:71], a[16:19], v[48:51]
  s_add_u32 s67, s67, s65
  v_mfma_f32_16x16x32_bf16 v[48:51], a[72:75], a[32:35], v[48:51]
  s_add_u32 m0, s56, 65536
  v_exp_f32 v61, v61
  v_mfma_f32_16x16x32_bf16 v[48:51], a[76:79], a[48:51], v[48:51]
  s_lshr_b32 s4, s8, 7
  ds_read_b128 a[80:83], v1 offset:36864
  v_cvt_pk_bf16_f32 v94, v60, v61
  v_mfma_f32_16x16x32_bf16 v[128:131], a[128:131], v[64:67], v[128:131]
  s_bfe_u32 s5, s8, 0x50002
  v_exp_f32 v62, v62
  v_mfma_f32_16x16x32_bf16 v[128:131], a[132:135], v[80:83], v[128:131]
  s_mul_i32 s6, s5, 20
  buffer_load_dwordx4 v5, s[28:31], s67 offen offset:0 sc1 lds
  v_mfma_f32_16x16x32_bf16 v[132:135], a[128:131], v[68:71], v[132:135]
  s_mul_i32 s7, s4, 5
  v_exp_f32 v63, v63
  v_mfma_f32_16x16x32_bf16 v[132:135], a[132:135], v[84:87], v[132:135]
HS12:
  s_cbranch_execz HOPR_a
  s_add_u32 s6, s6, s7
  ds_read_b128 a[84:87], v1 offset:37888
  v_cvt_pk_bf16_f32 v95, v62, v63
  v_mfma_f32_16x16x32_bf16 v[52:55], a[64:67], a[4:7], v[36:39]
  s_add_u32 s6, s6, 18434
  v_exp_f32 v48, v48
  v_mfma_f32_16x16x32_bf16 v[52:55], a[68:71], a[20:23], v[52:55]
  s_mul_i32 s5, s5, 27
  buffer_load_dwordx4 v5, s[28:31], s67 offen offset:1024 sc1 lds
  v_mfma_f32_16x16x32_bf16 v[52:55], a[72:75], a[36:39], v[52:55]
  s_mul_i32 s7, s4, 7
  v_exp_f32 v49, v49
  v_mfma_f32_16x16x32_bf16 v[52:55], a[76:79], a[52:55], v[52:55]
  s_add_u32 s5, s5, s7
  ds_read_b128 a[88:91], v1 offset:38912
  v_cvt_pk_bf16_f32 v96, v48, v49
  v_mfma_f32_16x16x32_bf16 v[136:139], a[128:131], v[72:75], v[136:139]
  s_add_u32 s5, s5, 23783
  v_exp_f32 v50, v50
  v_mfma_f32_16x16x32_bf16 v[136:139], a[132:135], v[88:91], v[136:139]
  s_cmp_lt_u32 s4, 4
  s_cselect_b32 s6, s6, s5
  buffer_load_dwordx4 v5, s[28:31], s67 offen offset:2048 sc1 lds
  v_mfma_f32_16x16x32_bf16 v[140:143], a[128:131], v[76:79], v[140:143]
  s_lshl_b32 s6, s6, 2
  v_exp_f32 v51, v51
  v_mfma_f32_16x16x32_bf16 v[140:143], a[132:135], v[92:95], v[140:143]
  s_add_u32 s6, s6, s48
  ds_read_b128 a[92:95], v1 offset:39936
  v_cvt_pk_bf16_f32 v97, v50, v51
  v_mfma_f32_16x16x32_bf16 v[56:59], a[64:67], a[8:11], v[40:43]
  s_lshl_b32 s6, s6, 10
  v_exp_f32 v52, v52
  v_mfma_f32_16x16x32_bf16 v[56:59], a[68:71], a[24:27], v[56:59]
  s_cmp_lt_u32 s4, 7
  s_cselect_b32 s6, s6, 0x40000000
  buffer_load_dwordx4 v5, s[28:31], s67 offen offset:3072 sc1 lds
  v_mfma_f32_16x16x32_bf16 v[56:59], a[72:75], a[40:43], v[56:59]
  s_waitcnt lgkmcnt(4)
  v_exp_f32 v53, v53
  v_mfma_f32_16x16x32_bf16 v[56:59], a[76:79], a[56:59], v[56:59]
  ds_read_b128 a[144:147], v2 offset:36864
  v_cvt_pk_bf16_f32 v100, v52, v53
  v_mfma_f32_16x16x32_bf16 v[144:147], a[136:139], v[64:67], v[144:147]
  s_lshr_b32 s17, s8, 6
  v_exp_f32 v54, v54
  v_mfma_f32_16x16x32_bf16 v[144:147], a[140:143], v[80:83], v[144:147]
  s_add_u32 m0, s56, 69632
  buffer_store_dwordx4 v[32:35], v3, s[28:31], s6 offen sc1
  v_mfma_f32_16x16x32_bf16 v[148:151], a[136:139], v[68:71], v[148:151]
  s_add_u32 s67, s67, 4096
  v_exp_f32 v55, v55
  v_mfma_f32_16x16x32_bf16 v[148:151], a[140:143], v[84:87], v[148:151]
  s_add_u32 s17, s17, 0
  ds_read_b128 a[148:151], v2 offset:37888
  v_cvt_pk_bf16_f32 v101, v54, v55
  v_mfma_f32_16x16x32_bf16 a[164:167], a[160:163], v[64:67], a[164:167]
  s_lshl_b32 s17, s17, 18
  buffer_load_dwordx4 v5, s[28:31], s67 offen offset:0 sc1 lds
  v_mfma_f32_16x16x32_bf16 a[164:167], a[160:163], v[80:83], a[164:167]
  s_and_b32 s11, s8, 31
  v_mfma_f32_16x16x32_bf16 v[60:63], a[64:67], a[12:15], v[44:47]
  s_lshl_b32 s11, s11, 13
  v_exp_f32 v56, v56
  v_mfma_f32_16x16x32_bf16 v[60:63], a[68:71], a[28:31], v[60:63]
  s_add_u32 s17, s17, s11
  v_mfma_f32_16x16x32_bf16 v[60:63], a[72:75], a[44:47], v[60:63]
  s_bfe_u32 s11, s8, 0x10005
  v_exp_f32 v57, v57
  v_mfma_f32_16x16x32_bf16 v[60:63], a[76:79], a[60:63], v[60:63]
  s_lshl_b32 s11, s11, 11
  ds_read_b128 a[152:155], v2 offset:38912
  v_cvt_pk_bf16_f32 v104, v56, v57
  v_mfma_f32_16x16x32_bf16 v[152:155], a[136:139], v[72:75], v[152:155]
  s_add_u32 s17, s17, s11
  v_exp_f32 v58, v58
  v_mfma_f32_16x16x32_bf16 v[152:155], a[140:143], v[88:91], v[152:155]
  s_add_u32 s17, s17, 67108864
  buffer_load_dwordx4 v5, s[28:31], s67 offen offset:1024 sc1 lds
  v_mfma_f32_16x16x32_bf16 v[156:159], a[136:139], v[76:79], v[156:159]
  s_add_u32 s11, s17, 4096
  v_exp_f32 v59, v59
  v_mfma_f32_16x16x32_bf16 v[156:159], a[140:143], v[92:95], v[156:159]
  s_waitcnt lgkmcnt(1)
  ds_read_b128 a[156:159], v2 offset:39936
  v_cvt_pk_bf16_f32 v105, v58, v59
  v_mfma_f32_16x16x32_bf16 v[48:51], a[80:83], a[0:3], v[32:35]
  v_exp_f32 v60, v60
  v_mfma_f32_16x16x32_bf16 v[48:51], a[84:87], a[16:19], v[48:51]
  buffer_load_dwordx4 v5, s[28:31], s67 offen offset:2048 sc1 lds
  v_mfma_f32_16x16x32_bf16 v[48:51], a[88:91], a[32:35], v[48:51]
  v_exp_f32 v61, v61
  v_mfma_f32_16x16x32_bf16 v[48:51], a[92:95], a[48:51], v[48:51]
  s_and_b32 s9, s2, 31
  ds_read_b128 a[96:99], v1 offset:40960
  v_cvt_pk_bf16_f32 v108, v60, v61
  v_mfma_f32_16x16x32_bf16 v[160:163], a[144:147], v[64:67], v[160:163]
  s_lshl_b32 s9, s9, 7
  v_exp_f32 v62, v62
  v_mfma_f32_16x16x32_bf16 v[160:163], a[148:151], v[80:83], v[160:163]
  s_add_u32 s9, s9, 471040
  buffer_load_dwordx4 v5, s[28:31], s67 offen offset:3072 sc1 lds
  v_mfma_f32_16x16x32_bf16 v[164:167], a[144:147], v[68:71], v[164:167]
  s_waitcnt vmcnt(17)
  v_exp_f32 v63, v63
  v_mfma_f32_16x16x32_bf16 v[164:167], a[148:151], v[84:87], v[164:167]
  ds_read_b128 a[100:103], v1 offset:41984
  v_cvt_pk_bf16_f32 v109, v62, v63
  v_mfma_f32_16x16x32_bf16 v[52:55], a[80:83], a[4:7], v[36:39]
  v_exp_f32 v48, v48
  v_mfma_f32_16x16x32_bf16 v[52:55], a[84:87], a[20:23], v[52:55]
  buffer_atomic_add v20, v16, s[28:31], s9 offen
  v_mfma_f32_16x16x32_bf16 v[52:55], a[88:91], a[36:39], v[52:55]
  v_exp_f32 v49, v49
  v_mfma_f32_16x16x32_bf16 v[52:55], a[92:95], a[52:55], v[52:55]
  ds_read_b128 a[104:107], v1 offset:43008
  v_cvt_pk_bf16_f32 v98, v48, v49
  v_mfma_f32_16x16x32_bf16 v[168:171], a[144:147], v[72:75], v[168:171]
  v_exp_f32 v50, v50
  v_mfma_f32_16x16x32_bf16 v[168:171], a[148:151], v[88:91], v[168:171]
  v_mad_u32_u24 v19, v17, s18, v18
  v_bfe_u32 v12, v0, 1, 2
  v_mfma_f32_16x16x32_bf16 v[172:175], a[144:147], v[76:79], v[172:175]
  s_lshl_b32 s18, s18, 3
  v_exp_f32 v51, v51
  v_mfma_f32_16x16x32_bf16 v[172:175], a[148:151], v[92:95], v[172:175]
  s_add_u32 m0, s19, 0
  ds_read_b128 a[108:111], v1 offset:44032
  v_cvt_pk_bf16_f32 v99, v50, v51
  v_mfma_f32_16x16x32_bf16 v[56:59], a[80:83], a[8:11], v[40:43]
  v_exp_f32 v52, v52
  v_mfma_f32_16x16x32_bf16 v[56:59], a[84:87], a[24:27], v[56:59]
  buffer_load_dwordx4 v19, s[12:15], s16 offen lds
  v_mfma_f32_16x16x32_bf16 v[56:59], a[88:91], a[40:43], v[56:59]
  s_waitcnt lgkmcnt(4)
  v_exp_f32 v53, v53
  v_mfma_f32_16x16x32_bf16 v[56:59], a[92:95], a[56:59], v[56:59]
  ds_read_b128 a[128:131], v2 offset:40960
  v_cvt_pk_bf16_f32 v102, v52, v53
  v_mfma_f32_16x16x32_bf16 v[176:179], a[152:155], v[64:67], v[176:179]
  v_exp_f32 v54, v54
  v_mfma_f32_16x16x32_bf16 v[176:179], a[156:159], v[80:83], v[176:179]
  s_add_u32 s16, s16, s18
  v_lshlrev_b32 v12, 5, v12
  v_and_b32 v4, 15, v0
  v_mfma_f32_16x16x32_bf16 v[180:183], a[152:155], v[68:71], v[180:183]
  s_add_u32 m0, s19, 1024
  v_exp_f32 v55, v55
  v_mfma_f32_16x16x32_bf16 v[180:183], a[156:159], v[84:87], v[180:183]
  ds_read_b128 a[132:135], v2 offset:41984
  v_cvt_pk_bf16_f32 v103, v54, v55
  v_mfma_f32_16x16x32_bf16 a[168:171], a[160:163], v[68:71], a[168:171]
  buffer_load_dwordx4 v19, s[12:15], s16 offen lds
  v_mfma_f32_16x16x32_bf16 a[168:171], a[160:163], v[84:87], a[168:171]
  v_lshl_add_u32 v12, v4, 7, v12
  v_lshrrev_b32 v4, 4, v0
  v_mfma_f32_16x16x32_bf16 v[60:63], a[80:83], a[12:15], v[44:47]
  v_exp_f32 v56, v56
  v_mfma_f32_16x16x32_bf16 v[60:63], a[84:87], a[28:31], v[60:63]
  v_lshl_add_u32 v12, v4, 3, v12
  v_add_u32 v12, s19, v12
  v_mfma_f32_16x16x32_bf16 v[60:63], a[88:91], a[44:47], v[60:63]
  s_add_u32 s16, s16, s18
  v_exp_f32 v57, v57
  v_mfma_f32_16x16x32_bf16 v[60:63], a[92:95], a[60:63], v[60:63]
  s_add_u32 m0, s19, 2048
  ds_read_b128 a[136:139], v2 offset:43008
  v_cvt_pk_bf16_f32 v106, v56, v57
  v_mfma_f32_16x16x32_bf16 v[184:187], a[152:155], v[72:75], v[184:187]
  v_exp_f32 v58, v58
  v_mfma_f32_16x16x32_bf16 v[184:187], a[156:159], v[88:91], v[184:187]
  buffer_load_dwordx4 v19, s[12:15], s16 offen lds
  v_mfma_f32_16x16x32_bf16 v[188:191], a[152:155], v[76:79], v[188:191]
  v_exp_f32 v59, v59
  v_mfma_f32_16x16x32_bf16 v[188:191], a[156:159], v[92:95], v[188:191]
  s_waitcnt lgkmcnt(1)
  ds_read_b128 a[140:143], v2 offset:44032
  v_cvt_pk_bf16_f32 v107, v58, v59
  v_mfma_f32_16x16x32_bf16 v[48:51], a[96:99], a[0:3], v[32:35]
  v_exp_f32 v60, v60
  v_mfma_f32_16x16x32_bf16 v[48:51], a[100:103], a[16:19], v[48:51]
  s_add_u32 s16, s16, s18
  ds_read_b128 a[112:115], v1 offset:45056
  v_xor_b32 v13, 32, v12
  v_mfma_f32_16x16x32_bf16 v[48:51], a[104:107], a[32:35], v[48:51]
  s_add_u32 m0, s19, 3072
  v_exp_f32 v61, v61
  v_mfma_f32_16x16x32_bf16 v[48:51], a[108:111], a[48:51], v[48:51]
  ds_read_b128 a[116:119], v1 offset:46080
  v_cvt_pk_bf16_f32 v110, v60, v61
  v_mfma_f32_16x16x32_bf16 v[192:195], a[128:131], v[64:67], v[192:195]
  v_exp_f32 v62, v62
  v_mfma_f32_16x16x32_bf16 v[192:195], a[132:135], v[80:83], v[192:195]
  buffer_load_dwordx4 v19, s[12:15], s16 offen lds
  v_mfma_f32_16x16x32_bf16 v[196:199], a[128:131], v[68:71], v[196:199]
  v_exp_f32 v63, v63
  v_mfma_f32_16x16x32_bf16 v[196:199], a[132:135], v[84:87], v[196:199]
  ds_read_b128 a[120:123], v1 offset:47104
  v_cvt_pk_bf16_f32 v111, v62, v63
  v_mfma_f32_16x16x32_bf16 v[52:55], a[96:99], a[4:7], v[36:39]
  v_exp_f32 v48, v48
  v_mfma_f32_16x16x32_bf16 v[52:55], a[100:103], a[20:23], v[52:55]
  ds_read_b128 a[124:127], v1 offset:48128
  v_xor_b32 v14, 64, v12
  v_mfma_f32_16x16x32_bf16 v[52:55], a[104:107], a[36:39], v[52:55]
  v_exp_f32 v49, v49
  v_mfma_f32_16x16x32_bf16 v[52:55], a[108:111], a[52:55], v[52:55]
  ds_read_b128 a[144:147], v2 offset:45056
  v_cvt_pk_bf16_f32 v112, v48, v49
  v_mfma_f32_16x16x32_bf16 v[200:203], a[128:131], v[72:75], v[200:203]
  v_exp_f32 v50, v50
  v_mfma_f32_16x16x32_bf16 v[200:203], a[132:135], v[88:91], v[200:203]
  v_xor_b32 v15, 96, v12
  v_mfma_f32_16x16x32_bf16 v[204:207], a[128:131], v[76:79], v[204:207]
  v_exp_f32 v51, v51
  v_mfma_f32_16x16x32_bf16 v[204:207], a[132:135], v[92:95], v[204:207]
  ds_read_b128 a[148:151], v2 offset:46080
  v_cvt_pk_bf16_f32 v113, v50, v51
  v_mfma_f32_16x16x32_bf16 v[56:59], a[96:99], a[8:11], v[40:43]
  v_exp_f32 v52, v52
  v_mfma_f32_16x16x32_bf16 v[56:59], a[100:103], a[24:27], v[56:59]
  ds_read_b128 a[152:155], v2 offset:47104
  v_mfma_f32_16x16x32_bf16 v[56:59], a[104:107], a[40:43], v[56:59]
  s_waitcnt lgkmcnt(7)
  s_mov_b32 s70, s62
  v_exp_f32 v53, v53
  v_mfma_f32_16x16x32_bf16 v[56:59], a[108:111], a[56:59], v[56:59]
  s_mov_b32 s62, s60
  ds_read_b128 a[156:159], v2 offset:48128
  v_cvt_pk_bf16_f32 v116, v52, v53
  v_mfma_f32_16x16x32_bf16 v[208:211], a[136:139], v[64:67], v[208:211]
  s_lshl_b32 s66, s60, 15
  v_exp_f32 v54, v54
  v_mfma_f32_16x16x32_bf16 v[208:211], a[140:143], v[80:83], v[208:211]
  s_add_u32 s66, s66, s64
  v_mfma_f32_16x16x32_bf16 v[212:215], a[136:139], v[68:71], v[212:215]
  s_add_u32 s60, s60, 1
  v_exp_f32 v55, v55
  v_mfma_f32_16x16x32_bf16 v[212:215], a[140:143], v[84:87], v[212:215]
  s_cmp_eq_u32 s60, s57
  s_addc_u32 s60, s60, 0
  v_cvt_pk_bf16_f32 v117, v54, v55
  v_mfma_f32_16x16x32_bf16 a[172:175], a[160:163], v[72:75], a[172:175]
  s_add_u32 s52, s61, 2
  v_mfma_f32_16x16x32_bf16 a[172:175], a[160:163], v[88:91], a[172:175]
  s_cmp_gt_u32 s58, s52
  s_cselect_b32 s66, s66, s78
  v_mfma_f32_16x16x32_bf16 v[60:63], a[96:99], a[12:15], v[44:47]
  s_cmp_gt_u32 s58, s52
  s_cselect_b32 s80, s56, s77
  v_exp_f32 v56, v56
  v_mfma_f32_16x16x32_bf16 v[60:63], a[100:103], a[28:31], v[60:63]
  v_mfma_f32_16x16x32_bf16 v[60:63], a[104:107], a[44:47], v[60:63]
  v_exp_f32 v57, v57
  v_mfma_f32_16x16x32_bf16 v[60:63], a[108:111], a[60:63], v[60:63]
  v_cvt_pk_bf16_f32 v120, v56, v57
  v_mfma_f32_16x16x32_bf16 v[216:219], a[136:139], v[72:75], v[216:219]
  v_exp_f32 v58, v58
  v_mfma_f32_16x16x32_bf16 v[216:219], a[140:143], v[88:91], v[216:219]
  s_waitcnt vmcnt(5) lgkmcnt(0)
  s_barrier
  v_mfma_f32_16x16x32_bf16 v[220:223], a[136:139], v[76:79], v[220:223]
  s_add_u32 m0, s80, 32768
  v_exp_f32 v59, v59
  v_mfma_f32_16x16x32_bf16 v[220:223], a[140:143], v[92:95], v[220:223]
  v_cvt_pk_bf16_f32 v121, v58, v59
  v_mfma_f32_16x16x32_bf16 v[48:51], a[112:115], a[0:3], v[32:35]
  v_exp_f32 v60, v60
  v_mfma_f32_16x16x32_bf16 v[48:51], a[116:119], a[16:19], v[48:51]
  buffer_load_dwordx4 v5, s[28:31], s66 offen offset:0 sc1 lds
  v_mfma_f32_16x16x32_bf16 v[48:51], a[120:123], a[32:35], v[48:51]
  v_exp_f32 v61, v61
  v_mfma_f32_16x16x32_bf16 v[48:51], a[124:127], a[48:51], v[48:51]
  ds_read_b128 a[64:67], v1 offset:0
  v_cvt_pk_bf16_f32 v124, v60, v61
  v_mfma_f32_16x16x32_bf16 v[224:227], a[144:147], v[64:67], v[224:227]
  v_exp_f32 v62, v62
  v_mfma_f32_16x16x32_bf16 v[224:227], a[148:151], v[80:83], v[224:227]
  buffer_load_dwordx4 v5, s[28:31], s66 offen offset:1024 sc1 lds
  v_mfma_f32_16x16x32_bf16 v[228:231], a[144:147], v[68:71], v[228:231]
  v_exp_f32 v63, v63
  v_mfma_f32_16x16x32_bf16 v[228:231], a[148:151], v[84:87], v[228:231]
  ds_read_b128 a[68:71], v1 offset:1024
  v_cvt_pk_bf16_f32 v125, v62, v63
  v_mfma_f32_16x16x32_bf16 v[52:55], a[112:115], a[4:7], v[36:39]
  v_exp_f32 v48, v48
  v_mfma_f32_16x16x32_bf16 v[52:55], a[116:119], a[20:23], v[52:55]
  buffer_load_dwordx4 v5, s[28:31], s66 offen offset:2048 sc1 lds
  v_mfma_f32_16x16x32_bf16 v[52:55], a[120:123], a[36:39], v[52:55]
  v_exp_f32 v49, v49
  v_mfma_f32_16x16x32_bf16 v[52:55], a[124:127], a[52:55], v[52:55]
  ds_read_b128 a[72:75], v1 offset:2048
  v_cvt_pk_bf16_f32 v114, v48, v49
  v_mfma_f32_16x16x32_bf16 v[232:235], a[144:147], v[72:75], v[232:235]
  v_exp_f32 v50, v50
  v_mfma_f32_16x16x32_bf16 v[232:235], a[148:151], v[88:91], v[232:235]
  buffer_load_dwordx4 v5, s[28:31], s66 offen offset:3072 sc1 lds
  v_mfma_f32_16x16x32_bf16 v[236:239], a[144:147], v[76:79], v[236:239]
  v_exp_f32 v51, v51
  v_mfma_f32_16x16x32_bf16 v[236:239], a[148:151], v[92:95], v[236:239]
  s_add_u32 m0, s80, 36864
  ds_read_b128 a[76:79], v1 offset:3072
  v_cvt_pk_bf16_f32 v115, v50, v51
  v_mfma_f32_16x16x32_bf16 v[56:59], a[112:115], a[8:11], v[40:43]
  s_add_u32 s66, s66, 4096
  v_exp_f32 v52, v52
  v_mfma_f32_16x16x32_bf16 v[56:59], a[116:119], a[24:27], v[56:59]
  buffer_load_dwordx4 v5, s[28:31], s66 offen offset:0 sc1 lds
  v_mfma_f32_16x16x32_bf16 v[56:59], a[120:123], a[40:43], v[56:59]
  v_exp_f32 v53, v53
  v_mfma_f32_16x16x32_bf16 v[56:59], a[124:127], a[56:59], v[56:59]
  ds_read_b128 a[128:131], v2 offset:0
  v_cvt_pk_bf16_f32 v118, v52, v53
  v_mfma_f32_16x16x32_bf16 v[240:243], a[152:155], v[64:67], v[240:243]
  v_exp_f32 v54, v54
  v_mfma_f32_16x16x32_bf16 v[240:243], a[156:159], v[80:83], v[240:243]
  buffer_load_dwordx4 v5, s[28:31], s66 offen offset:1024 sc1 lds
  v_mfma_f32_16x16x32_bf16 v[244:247], a[152:155], v[68:71], v[244:247]
  v_exp_f32 v55, v55
  v_mfma_f32_16x16x32_bf16 v[244:247], a[156:159], v[84:87], v[244:247]
  ds_read_b128 a[132:135], v2 offset:1024
  v_cvt_pk_bf16_f32 v119, v54, v55
  v_mfma_f32_16x16x32_bf16 a[176:179], a[160:163], v[76:79], a[176:179]
  buffer_load_dwordx4 v5, s[28:31], s66 offen offset:2048 sc1 lds
  v_mfma_f32_16x16x32_bf16 a[176:179], a[160:163], v[92:95], a[176:179]
  v_mfma_f32_16x16x32_bf16 v[60:63], a[112:115], a[12:15], v[44:47]
  v_exp_f32 v56, v56
  v_mfma_f32_16x16x32_bf16 v[60:63], a[116:119], a[28:31], v[60:63]
  buffer_load_dwordx4 v5, s[28:31], s66 offen offset:3072 sc1 lds
  v_mfma_f32_16x16x32_bf16 v[60:63], a[120:123], a[44:47], v[60:63]
  v_exp_f32 v57, v57
  v_mfma_f32_16x16x32_bf16 v[60:63], a[124:127], a[60:63], v[60:63]
  ds_read_b128 a[136:139], v2 offset:2048
  v_cvt_pk_bf16_f32 v122, v56, v57
  v_mfma_f32_16x16x32_bf16 v[248:251], a[152:155], v[72:75], v[248:251]
  v_exp_f32 v58, v58
  v_mfma_f32_16x16x32_bf16 v[248:251], a[156:159], v[88:91], v[248:251]
  v_mfma_f32_16x16x32_bf16 v[252:255], a[152:155], v[76:79], v[252:255]
  s_add_u32 s61, s61, 1
  v_exp_f32 v59, v59
  v_mfma_f32_16x16x32_bf16 v[252:255], a[156:159], v[92:95], v[252:255]
  s_waitcnt lgkmcnt(1)
  ds_read_b128 a[140:143], v2 offset:3072
  v_cvt_pk_bf16_f32 v123, v58, v59
  v_mfma_f32_16x16x32_bf16 v[48:51], a[64:67], a[0:3], v[32:35]
  s_lshl_b32 s67, s70, 15
  v_exp_f32 v60, v60
  v_mfma_f32_16x16x32_bf16 v[48:51], a[68:71], a[16:19], v[48:51]
  s_add_u32 s67, s67, s65
  v_add_u32 v25, 128, v0
  v_mul_u32_u24 v19, 3277, v25
  v_mfma_f32_16x16x32_bf16 v[48:51], a[72:75], a[32:35], v[48:51]
  s_add_u32 m0, s56, 98304
  v_exp_f32 v61, v61
  v_mfma_f32_16x16x32_bf16 v[48:51], a[76:79], a[48:51], v[48:51]
  ds_read_b128 a[80:83], v1 offset:4096
  v_cvt_pk_bf16_f32 v126, v60, v61
  v_mfma_f32_16x16x32_bf16 v[128:131], a[128:131], v[96:99], v[128:131]
  v_exp_f32 v62, v62
  v_mfma_f32_16x16x32_bf16 v[128:131], a[132:135], v[112:115], v[128:131]
  buffer_load_dwordx4 v5, s[28:31], s67 offen offset:0 sc1 lds
  v_mfma_f32_16x16x32_bf16 v[132:135], a[128:131], v[100:103], v[132:135]
  v_exp_f32 v63, v63
  v_mfma_f32_16x16x32_bf16 v[132:135], a[132:135], v[116:119], v[132:135]
  ds_read_b128 a[84:87], v1 offset:5120
  v_cvt_pk_bf16_f32 v127, v62, v63
  v_mfma_f32_16x16x32_bf16 v[52:55], a[64:67], a[4:7], v[36:39]
  v_exp_f32 v48, v48
  v_mfma_f32_16x16x32_bf16 v[52:55], a[68:71], a[20:23], v[52:55]
  buffer_load_dwordx4 v5, s[28:31], s67 offen offset:1024 sc1 lds
  v_mfma_f32_16x16x32_bf16 v[52:55], a[72:75], a[36:39], v[52:55]
  v_exp_f32 v49, v49
  v_mfma_f32_16x16x32_bf16 v[52:55], a[76:79], a[52:55], v[52:55]
  ds_read_b128 a[88:91], v1 offset:6144
  v_cvt_pk_bf16_f32 v64, v48, v49
  v_mfma_f32_16x16x32_bf16 v[136:139], a[128:131], v[104:107], v[136:139]
  v_exp_f32 v50, v50
  v_mfma_f32_16x16x32_bf16 v[136:139], a[132:135], v[120:123], v[136:139]
  buffer_load_dwordx4 v5, s[28:31], s67 offen offset:2048 sc1 lds
  v_mfma_f32_16x16x32_bf16 v[140:143], a[128:131], v[108:111], v[140:143]
  v_exp_f32 v51, v51
  v_mfma_f32_16x16x32_bf16 v[140:143], a[132:135], v[124:127], v[140:143]
  ds_read_b128 a[92:95], v1 offset:7168
  v_cvt_pk_bf16_f32 v65, v50, v51
  v_mfma_f32_16x16x32_bf16 v[56:59], a[64:67], a[8:11], v[40:43]
  v_exp_f32 v52, v52
  v_mfma_f32_16x16x32_bf16 v[56:59], a[68:71], a[24:27], v[56:59]
  buffer_load_dwordx4 v5, s[28:31], s67 offen offset:3072 sc1 lds
  v_mfma_f32_16x16x32_bf16 v[56:59], a[72:75], a[40:43], v[56:59]
  s_waitcnt lgkmcnt(4)
  v_exp_f32 v53, v53
  v_mfma_f32_16x16x32_bf16 v[56:59], a[76:79], a[56:59], v[56:59]
  ds_read_b128 a[144:147], v2 offset:4096
  v_cvt_pk_bf16_f32 v68, v52, v53
  v_mfma_f32_16x16x32_bf16 v[144:147], a[136:139], v[96:99], v[144:147]
  v_exp_f32 v54, v54
  v_mfma_f32_16x16x32_bf16 v[144:147], a[140:143], v[112:115], v[144:147]
  s_waitcnt vmcnt(12)
  s_add_u32 m0, s56, 102400
  ds_read_b64 a[180:181], v12 offset:0
  v_lshrrev_b32 v19, 16, v19
  v_mfma_f32_16x16x32_bf16 v[148:151], a[136:139], v[100:103], v[148:151]
  s_add_u32 s67, s67, 4096
  v_exp_f32 v55, v55
  v_mfma_f32_16x16x32_bf16 v[148:151], a[140:143], v[116:119], v[148:151]
  ds_read_b128 a[148:151], v2 offset:5120
  v_cvt_pk_bf16_f32 v69, v54, v55
  v_mfma_f32_16x16x32_bf16 a[164:167], a[160:163], v[96:99], a[164:167]
  buffer_load_dwordx4 v5, s[28:31], s67 offen offset:0 sc1 lds
  v_mfma_f32_16x16x32_bf16 a[164:167], a[160:163], v[112:115], a[164:167]
  ds_read_b64 a[182:183], v13 offset:0
  v_mul_u32_u24 v4, 20, v19
  v_mfma_f32_16x16x32_bf16 v[60:63], a[64:67], a[12:15], v[44:47]
  v_exp_f32 v56, v56
  v_mfma_f32_16x16x32_bf16 v[60:63], a[68:71], a[28:31], v[60:63]
  ds_read_b64 a[184:185], v12 offset:2048
  v_sub_u32 v25, v25, v4
  v_mfma_f32_16x16x32_bf16 v[60:63], a[72:75], a[44:47], v[60:63]
  v_exp_f32 v57, v57
  v_mfma_f32_16x16x32_bf16 v[60:63], a[76:79], a[60:63], v[60:63]
  ds_read_b128 a[152:155], v2 offset:6144
  v_cvt_pk_bf16_f32 v72, v56, v57
  v_mfma_f32_16x16x32_bf16 v[152:155], a[136:139], v[104:107], v[152:155]
  v_exp_f32 v58, v58
  v_mfma_f32_16x16x32_bf16 v[152:155], a[140:143], v[120:123], v[152:155]
  buffer_load_dwordx4 v5, s[28:31], s67 offen offset:1024 sc1 lds
  v_mfma_f32_16x16x32_bf16 v[156:159], a[136:139], v[108:111], v[156:159]
  v_exp_f32 v59, v59
  v_mfma_f32_16x16x32_bf16 v[156:159], a[140:143], v[124:127], v[156:159]
  s_waitcnt lgkmcnt(1)
  ds_read_b128 a[156:159], v2 offset:7168
  v_cvt_pk_bf16_f32 v73, v58, v59
  v_mfma_f32_16x16x32_bf16 v[48:51], a[80:83], a[0:3], v[32:35]
  v_exp_f32 v60, v60
  v_mfma_f32_16x16x32_bf16 v[48:51], a[84:87], a[16:19], v[48:51]
  buffer_load_dwordx4 v5, s[28:31], s67 offen offset:2048 sc1 lds
  v_mfma_f32_16x16x32_bf16 v[48:51], a[88:91], a[32:35], v[48:51]
  v_exp_f32 v61, v61
  v_mfma_f32_16x16x32_bf16 v[48:51], a[92:95], a[48:51], v[48:51]
  ds_read_b128 a[96:99], v1 offset:8192
  v_cvt_pk_bf16_f32 v76, v60, v61
  v_mfma_f32_16x16x32_bf16 v[160:163], a[144:147], v[96:99], v[160:163]
  v_exp_f32 v62, v62
  v_mfma_f32_16x16x32_bf16 v[160:163], a[148:151], v[112:115], v[160:163]
  buffer_load_dwordx4 v5, s[28:31], s67 offen offset:3072 sc1 lds
  v_mfma_f32_16x16x32_bf16 v[164:167], a[144:147], v[100:103], v[164:167]
  s_lshr_b32 s9, s8, 5
  v_exp_f32 v63, v63
  v_mfma_f32_16x16x32_bf16 v[164:167], a[148:151], v[116:119], v[164:167]
  s_add_u32 s9, s9, 32
  ds_read_b128 a[100:103], v1 offset:9216
  v_cvt_pk_bf16_f32 v77, v62, v63
  v_mfma_f32_16x16x32_bf16 v[52:55], a[80:83], a[4:7], v[36:39]
  s_and_b32 s10, s8, 31
  v_exp_f32 v48, v48
  v_mfma_f32_16x16x32_bf16 v[52:55], a[84:87], a[20:23], v[52:55]
  s_lshl_b32 s16, s9, 17
  ds_read_b64 a[186:187], v13 offset:2048
  v_bfe_u32 v4, v19, 2, 1
  v_mfma_f32_16x16x32_bf16 v[52:55], a[88:91], a[36:39], v[52:55]
  s_lshl_b32 s10, s10, 7
  v_exp_f32 v49, v49
  v_mfma_f32_16x16x32_bf16 v[52:55], a[92:95], a[52:55], v[52:55]
  s_add_u32 s16, s16, s10
  ds_read_b128 a[104:107], v1 offset:10240
  v_cvt_pk_bf16_f32 v66, v48, v49
  v_mfma_f32_16x16x32_bf16 v[168:171], a[144:147], v[104:107], v[168:171]
  s_mov_b32 s18, 4096
  v_exp_f32 v50, v50
  v_mfma_f32_16x16x32_bf16 v[168:171], a[148:151], v[120:123], v[168:171]
  buffer_store_dwordx4 a[180:183], v3, s[28:31], s17 offen offset:0 sc1
  v_mfma_f32_16x16x32_bf16 v[172:175], a[144:147], v[108:111], v[172:175]
  v_exp_f32 v51, v51
  v_mfma_f32_16x16x32_bf16 v[172:175], a[148:151], v[124:127], v[172:175]
  ds_read_b128 a[108:111], v1 offset:11264
  v_cvt_pk_bf16_f32 v67, v50, v51
  v_mfma_f32_16x16x32_bf16 v[56:59], a[80:83], a[8:11], v[40:43]
  v_exp_f32 v52, v52
  v_mfma_f32_16x16x32_bf16 v[56:59], a[84:87], a[24:27], v[56:59]
  ds_read_b64 a[188:189], v14 offset:0
  v_lshlrev_b32 v4, 1, v4
  v_mfma_f32_16x16x32_bf16 v[56:59], a[88:91], a[40:43], v[56:59]
  s_waitcnt lgkmcnt(6)
  v_exp_f32 v53, v53
  v_mfma_f32_16x16x32_bf16 v[56:59], a[92:95], a[56:59], v[56:59]
  ds_read_b128 a[128:131], v2 offset:8192
  v_cvt_pk_bf16_f32 v70, v52, v53
  v_mfma_f32_16x16x32_bf16 v[176:179], a[152:155], v[96:99], v[176:179]
  v_exp_f32 v54, v54
  v_mfma_f32_16x16x32_bf16 v[176:179], a[156:159], v[112:115], v[176:179]
  ds_read_b64 a[190:191], v15 offset:0
  v_xor_b32 v25, v25, v4
  v_mfma_f32_16x16x32_bf16 v[180:183], a[152:155], v[100:103], v[180:183]
  v_exp_f32 v55, v55
  v_mfma_f32_16x16x32_bf16 v[180:183], a[156:159], v[116:119], v[180:183]
  ds_read_b128 a[132:135], v2 offset:9216
  v_cvt_pk_bf16_f32 v71, v54, v55
  v_mfma_f32_16x16x32_bf16 a[168:171], a[160:163], v[100:103], a[168:171]
  s_waitcnt lgkmcnt(6)
  buffer_store_dwordx4 a[184:187], v3, s[28:31], s17 offen offset:1024 sc1
  v_mfma_f32_16x16x32_bf16 a[168:171], a[160:163], v[116:119], a[168:171]
  ds_read_b64 v[28:29], v14 offset:2048
  v_add_u32 v6, 6144, v6
  v_mfma_f32_16x16x32_bf16 v[60:63], a[80:83], a[12:15], v[44:47]
  v_exp_f32 v56, v56
  v_mfma_f32_16x16x32_bf16 v[60:63], a[84:87], a[28:31], v[60:63]
  ds_read_b64 v[30:31], v15 offset:2048
  v_mul_u32_u24 v19, 1280, v19
  v_mfma_f32_16x16x32_bf16 v[60:63], a[88:91], a[44:47], v[60:63]
  v_exp_f32 v57, v57
  v_mfma_f32_16x16x32_bf16 v[60:63], a[92:95], a[60:63], v[60:63]
  ds_read_b128 a[136:139], v2 offset:10240
  v_cvt_pk_bf16_f32 v74, v56, v57
  v_mfma_f32_16x16x32_bf16 v[184:187], a[152:155], v[104:107], v[184:187]
  v_exp_f32 v58, v58
  v_mfma_f32_16x16x32_bf16 v[184:187], a[156:159], v[120:123], v[184:187]
  s_waitcnt lgkmcnt(4)
  buffer_store_dwordx4 a[188:191], v3, s[28:31], s11 offen offset:0 sc1
  v_mfma_f32_16x16x32_bf16 v[188:191], a[152:155], v[108:111], v[188:191]
  v_exp_f32 v59, v59
  v_mfma_f32_16x16x32_bf16 v[188:191], a[156:159], v[124:127], v[188:191]
  s_waitcnt lgkmcnt(1)
  ds_read_b128 a[140:143], v2 offset:11264
  v_cvt_pk_bf16_f32 v75, v58, v59
  v_mfma_f32_16x16x32_bf16 v[48:51], a[96:99], a[0:3], v[32:35]
  v_exp_f32 v60, v60
  v_mfma_f32_16x16x32_bf16 v[48:51], a[100:103], a[16:19], v[48:51]
  ds_read_b128 a[112:115], v1 offset:12288
  v_lshl_add_u32 v25, v25, 4, v19
  v_mfma_f32_16x16x32_bf16 v[48:51], a[104:107], a[32:35], v[48:51]
  v_exp_f32 v61, v61
  v_mfma_f32_16x16x32_bf16 v[48:51], a[108:111], a[48:51], v[48:51]
  ds_read_b128 a[116:119], v1 offset:13312
  v_cvt_pk_bf16_f32 v78, v60, v61
  v_mfma_f32_16x16x32_bf16 v[192:195], a[128:131], v[96:99], v[192:195]
  v_exp_f32 v62, v62
  v_mfma_f32_16x16x32_bf16 v[192:195], a[132:135], v[112:115], v[192:195]
  buffer_load_dword v7, v6, s[28:31], 0 offen sc1
  v_mfma_f32_16x16x32_bf16 v[196:199], a[128:131], v[100:103], v[196:199]
  v_exp_f32 v63, v63
  v_mfma_f32_16x16x32_bf16 v[196:199], a[132:135], v[116:119], v[196:199]
  ds_read_b128 a[120:123], v1 offset:14336
  v_cvt_pk_bf16_f32 v79, v62, v63
  v_mfma_f32_16x16x32_bf16 v[52:55], a[96:99], a[4:7], v[36:39]
  v_exp_f32 v48, v48
  v_mfma_f32_16x16x32_bf16 v[52:55], a[100:103], a[20:23], v[52:55]
  ds_read_b128 a[124:127], v1 offset:15360
  v_mfma_f32_16x16x32_bf16 v[52:55], a[104:107], a[36:39], v[52:55]
  v_exp_f32 v49, v49
  v_mfma_f32_16x16x32_bf16 v[52:55], a[108:111], a[52:55], v[52:55]
  ds_read_b128 a[144:147], v2 offset:12288
  v_cvt_pk_bf16_f32 v80, v48, v49
  v_mfma_f32_16x16x32_bf16 v[200:203], a[128:131], v[104:107], v[200:203]
  v_exp_f32 v50, v50
  v_mfma_f32_16x16x32_bf16 v[200:203], a[132:135], v[120:123], v[200:203]
  buffer_store_dwordx4 v[28:31], v3, s[28:31], s11 offen offset:1024 sc1
  v_mfma_f32_16x16x32_bf16 v[204:207], a[128:131], v[108:111], v[204:207]
  v_exp_f32 v51, v51
  v_mfma_f32_16x16x32_bf16 v[204:207], a[132:135], v[124:127], v[204:207]
  ds_read_b128 a[148:151], v2 offset:13312
  v_cvt_pk_bf16_f32 v81, v50, v51
  v_mfma_f32_16x16x32_bf16 v[56:59], a[96:99], a[8:11], v[40:43]
  v_exp_f32 v52, v52
  v_mfma_f32_16x16x32_bf16 v[56:59], a[100:103], a[24:27], v[56:59]
  ds_read_b128 a[152:155], v2 offset:14336
  v_mfma_f32_16x16x32_bf16 v[56:59], a[104:107], a[40:43], v[56:59]
  s_waitcnt lgkmcnt(7)
  s_mov_b32 s70, s62
  v_exp_f32 v53, v53
  v_mfma_f32_16x16x32_bf16 v[56:59], a[108:111], a[56:59], v[56:59]
  s_mov_b32 s62, s60
  ds_read_b128 a[156:159], v2 offset:15360
  v_cvt_pk_bf16_f32 v84, v52, v53
  v_mfma_f32_16x16x32_bf16 v[208:211], a[136:139], v[96:99], v[208:211]
  s_lshl_b32 s66, s60, 15
  v_exp_f32 v54, v54
  v_mfma_f32_16x16x32_bf16 v[208:211], a[140:143], v[112:115], v[208:211]
  s_add_u32 s66, s66, s64
  v_mfma_f32_16x16x32_bf16 v[212:215], a[136:139], v[100:103], v[212:215]
  s_add_u32 s60, s60, 1
  v_exp_f32 v55, v55
  v_mfma_f32_16x16x32_bf16 v[212:215], a[140:143], v[116:119], v[212:215]
  s_cmp_eq_u32 s60, s57
  s_addc_u32 s60, s60, 0
  v_cvt_pk_bf16_f32 v85, v54, v55
  v_mfma_f32_16x16x32_bf16 a[172:175], a[160:163], v[104:107], a[172:175]
  s_add_u32 s52, s61, 2
  v_mfma_f32_16x16x32_bf16 a[172:175], a[160:163], v[120:123], a[172:175]
  s_cmp_gt_u32 s58, s52
  s_cselect_b32 s66, s66, s63
  v_mfma_f32_16x16x32_bf16 v[60:63], a[96:99], a[12:15], v[44:47]
  s_cmp_gt_u32 s58, s52
  s_cselect_b32 s80, s56, s77
  v_exp_f32 v56, v56
  v_mfma_f32_16x16x32_bf16 v[60:63], a[100:103], a[28:31], v[60:63]
  v_mfma_f32_16x16x32_bf16 v[60:63], a[104:107], a[44:47], v[60:63]
  v_exp_f32 v57, v57
  v_mfma_f32_16x16x32_bf16 v[60:63], a[108:111], a[60:63], v[60:63]
  v_cvt_pk_bf16_f32 v88, v56, v57
  v_mfma_f32_16x16x32_bf16 v[216:219], a[136:139], v[104:107], v[216:219]
  v_exp_f32 v58, v58
  v_mfma_f32_16x16x32_bf16 v[216:219], a[140:143], v[120:123], v[216:219]
  s_waitcnt vmcnt(5) lgkmcnt(0)
  s_barrier
  v_mfma_f32_16x16x32_bf16 v[220:223], a[136:139], v[108:111], v[220:223]
  s_add_u32 m0, s80, 0
  v_exp_f32 v59, v59
  v_mfma_f32_16x16x32_bf16 v[220:223], a[140:143], v[124:127], v[220:223]
  v_cvt_pk_bf16_f32 v89, v58, v59
  v_mfma_f32_16x16x32_bf16 v[48:51], a[112:115], a[0:3], v[32:35]
HS13:
  s_cbranch_execz HOPR_a
  v_exp_f32 v60, v60
  v_mfma_f32_16x16x32_bf16 v[48:51], a[116:119], a[16:19], v[48:51]
  buffer_load_dwordx4 v5, s[28:31], s66 offen offset:0 sc1 lds
  v_mfma_f32_16x16x32_bf16 v[48:51], a[120:123], a[32:35], v[48:51]
  v_exp_f32 v61, v61
  v_mfma_f32_16x16x32_bf16 v[48:51], a[124:127], a[48:51], v[48:51]
  ds_read_b128 a[64:67], v1 offset:32768
  v_cvt_pk_bf16_f32 v92, v60, v61
  v_mfma_f32_16x16x32_bf16 v[224:227], a[144:147], v[96:99], v[224:227]
  v_exp_f32 v62, v62
  v_mfma_f32_16x16x32_bf16 v[224:227], a[148:151], v[112:115], v[224:227]
  buffer_load_dwordx4 v5, s[28:31], s66 offen offset:1024 sc1 lds
  v_mfma_f32_16x16x32_bf16 v[228:231], a[144:147], v[100:103], v[228:231]
  v_exp_f32 v63, v63
  v_mfma_f32_16x16x32_bf16 v[228:231], a[148:151], v[116:119], v[228:231]
  ds_read_b128 a[68:71], v1 offset:33792
  v_cvt_pk_bf16_f32 v93, v62, v63
  v_mfma_f32_16x16x32_bf16 v[52:55], a[112:115], a[4:7], v[36:39]
  v_exp_f32 v48, v48
  v_mfma_f32_16x16x32_bf16 v[52:55], a[116:119], a[20:23], v[52:55]
  buffer_load_dwordx4 v5, s[28:31], s66 offen offset:2048 sc1 lds
  v_mfma_f32_16x16x32_bf16 v[52:55], a[120:123], a[36:39], v[52:55]
  v_exp_f32 v49, v49
  v_mfma_f32_16x16x32_bf16 v[52:55], a[124:127], a[52:55], v[52:55]
  ds_read_b128 a[72:75], v1 offset:34816
  v_cvt_pk_bf16_f32 v82, v48, v49
  v_mfma_f32_16x16x32_bf16 v[232:235], a[144:147], v[104:107], v[232:235]
  v_exp_f32 v50, v50
  v_mfma_f32_16x16x32_bf16 v[232:235], a[148:151], v[120:123], v[232:235]
  buffer_load_dwordx4 v5, s[28:31], s66 offen offset:3072 sc1 lds
  v_mfma_f32_16x16x32_bf16 v[236:239], a[144:147], v[108:111], v[236:239]
  v_exp_f32 v51, v51
  v_mfma_f32_16x16x32_bf16 v[236:239], a[148:151], v[124:127], v[236:239]
  s_add_u32 m0, s80, 4096
  ds_read_b128 a[76:79], v1 offset:35840
  v_cvt_pk_bf16_f32 v83, v50, v51
  v_mfma_f32_16x16x32_bf16 v[56:59], a[112:115], a[8:11], v[40:43]
  s_add_u32 s66, s66, 4096
  v_exp_f32 v52, v52
  v_mfma_f32_16x16x32_bf16 v[56:59], a[116:119], a[24:27], v[56:59]
  buffer_load_dwordx4 v5, s[28:31], s66 offen offset:0 sc1 lds
  v_mfma_f32_16x16x32_bf16 v[56:59], a[120:123], a[40:43], v[56:59]
  v_exp_f32 v53, v53
  v_mfma_f32_16x16x32_bf16 v[56:59], a[124:127], a[56:59], v[56:59]
  ds_read_b128 a[128:131], v2 offset:32768
  v_cvt_pk_bf16_f32 v86, v52, v53
  v_mfma_f32_16x16x32_bf16 v[240:243], a[152:155], v[96:99], v[240:243]
  v_exp_f32 v54, v54
  v_mfma_f32_16x16x32_bf16 v[240:243], a[156:159], v[112:115], v[240:243]
  buffer_load_dwordx4 v5, s[28:31], s66 offen offset:1024 sc1 lds
  v_mfma_f32_16x16x32_bf16 v[244:247], a[152:155], v[100:103], v[244:247]
  v_exp_f32 v55, v55
  v_mfma_f32_16x16x32_bf16 v[244:247], a[156:159], v[116:119], v[244:247]
  ds_read_b128 a[132:135], v2 offset:33792
  v_cvt_pk_bf16_f32 v87, v54, v55
  v_mfma_f32_16x16x32_bf16 a[176:179], a[160:163], v[108:111], a[176:179]
  buffer_load_dwordx4 v5, s[28:31], s66 offen offset:2048 sc1 lds
  v_mfma_f32_16x16x32_bf16 a[176:179], a[160:163], v[124:127], a[176:179]
  v_mfma_f32_16x16x32_bf16 v[60:63], a[112:115], a[12:15], v[44:47]
  v_exp_f32 v56, v56
  v_mfma_f32_16x16x32_bf16 v[60:63], a[116:119], a[28:31], v[60:63]
  buffer_load_dwordx4 v5, s[28:31], s66 offen offset:3072 sc1 lds
  v_mfma_f32_16x16x32_bf16 v[60:63], a[120:123], a[44:47], v[60:63]
  v_exp_f32 v57, v57
  v_mfma_f32_16x16x32_bf16 v[60:63], a[124:127], a[60:63], v[60:63]
  ds_read_b128 a[136:139], v2 offset:34816
  v_cvt_pk_bf16_f32 v90, v56, v57
  v_mfma_f32_16x16x32_bf16 v[248:251], a[152:155], v[104:107], v[248:251]
  v_exp_f32 v58, v58
  v_mfma_f32_16x16x32_bf16 v[248:251], a[156:159], v[120:123], v[248:251]
  v_mfma_f32_16x16x32_bf16 v[252:255], a[152:155], v[108:111], v[252:255]
  s_add_u32 s61, s61, 1
  v_exp_f32 v59, v59
  v_mfma_f32_16x16x32_bf16 v[252:255], a[156:159], v[124:127], v[252:255]
  s_waitcnt lgkmcnt(1)
  ds_read_b128 a[140:143], v2 offset:35840
  v_cvt_pk_bf16_f32 v91, v58, v59
  s_waitcnt vmcnt(9)
  v_cmp_gt_u32 vcc, 32, v7
  s_nop 0
  s_cbranch_vccnz L_p0_w
L_p0_ok:
  v_mfma_f32_16x16x32_bf16 v[48:51], a[64:67], a[0:3], v[32:35]
  s_lshl_b32 s67, s70, 15
  v_exp_f32 v60, v60
  v_mfma_f32_16x16x32_bf16 v[48:51], a[68:71], a[16:19], v[48:51]
  s_add_u32 s67, s67, s65
  v_mfma_f32_16x16x32_bf16 v[48:51], a[72:75], a[32:35], v[48:51]
  s_add_u32 m0, s56, 65536
  v_exp_f32 v61, v61
  v_mfma_f32_16x16x32_bf16 v[48:51], a[76:79], a[48:51], v[48:51]
  ds_read_b128 a[80:83], v1 offset:36864
  v_cvt_pk_bf16_f32 v94, v60, v61
  v_mfma_f32_16x16x32_bf16 v[128:131], a[128:131], v[64:67], v[128:131]
  s_lshr_b32 s17, s8, 6
  v_exp_f32 v62, v62
  v_mfma_f32_16x16x32_bf16 v[128:131], a[132:135], v[80:83], v[128:131]
  s_add_u32 s17, s17, 16
  buffer_load_dwordx4 v5, s[28:31], s67 offen offset:0 sc1 lds
  v_mfma_f32_16x16x32_bf16 v[132:135], a[128:131], v[68:71], v[132:135]
  s_lshl_b32 s17, s17, 18
  v_exp_f32 v63, v63
  v_mfma_f32_16x16x32_bf16 v[132:135], a[132:135], v[84:87], v[132:135]
  s_and_b32 s11, s8, 31
  ds_read_b128 a[84:87], v1 offset:37888
  v_cvt_pk_bf16_f32 v95, v62, v63
  v_mfma_f32_16x16x32_bf16 v[52:55], a[64:67], a[4:7], v[36:39]
  s_lshl_b32 s11, s11, 13
  v_exp_f32 v48, v48
  v_mfma_f32_16x16x32_bf16 v[52:55], a[68:71], a[20:23], v[52:55]
  s_add_u32 s17, s17, s11
  buffer_load_dwordx4 v5, s[28:31], s67 offen offset:1024 sc1 lds
  v_mfma_f32_16x16x32_bf16 v[52:55], a[72:75], a[36:39], v[52:55]
  s_bfe_u32 s11, s8, 0x10005
  v_exp_f32 v49, v49
  v_mfma_f32_16x16x32_bf16 v[52:55], a[76:79], a[52:55], v[52:55]
  s_lshl_b32 s11, s11, 11
  ds_read_b128 a[88:91], v1 offset:38912
  v_cvt_pk_bf16_f32 v96, v48, v49
  v_mfma_f32_16x16x32_bf16 v[136:139], a[128:131], v[72:75], v[136:139]
  s_add_u32 s17, s17, s11
  v_exp_f32 v50, v50
  v_mfma_f32_16x16x32_bf16 v[136:139], a[132:135], v[88:91], v[136:139]
  s_add_u32 s17, s17, 67108864
  buffer_load_dwordx4 v5, s[28:31], s67 offen offset:2048 sc1 lds
  v_mfma_f32_16x16x32_bf16 v[140:143], a[128:131], v[76:79], v[140:143]
  s_add_u32 s11, s17, 4096
  v_exp_f32 v51, v51
  v_mfma_f32_16x16x32_bf16 v[140:143], a[132:135], v[92:95], v[140:143]
  ds_read_b128 a[92:95], v1 offset:39936
  v_cvt_pk_bf16_f32 v97, v50, v51
  v_mfma_f32_16x16x32_bf16 v[56:59], a[64:67], a[8:11], v[40:43]
  v_exp_f32 v52, v52
  v_mfma_f32_16x16x32_bf16 v[56:59], a[68:71], a[24:27], v[56:59]
  buffer_load_dwordx4 v5, s[28:31], s67 offen offset:3072 sc1 lds
  v_mfma_f32_16x16x32_bf16 v[56:59], a[72:75], a[40:43], v[56:59]
  s_waitcnt lgkmcnt(4)
  v_exp_f32 v53, v53
  v_mfma_f32_16x16x32_bf16 v[56:59], a[76:79], a[56:59], v[56:59]
  ds_read_b128 a[144:147], v2 offset:36864
  v_cvt_pk_bf16_f32 v100, v52, v53
  v_mfma_f32_16x16x32_bf16 v[144:147], a[136:139], v[64:67], v[144:147]
  v_exp_f32 v54, v54
  v_mfma_f32_16x16x32_bf16 v[144:147], a[140:143], v[80:83], v[144:147]
  s_add_u32 m0, s56, 69632
  v_and_b32 v21, 31, v0
  v_lshlrev_b32 v21, 7, v21
  v_mfma_f32_16x16x32_bf16 v[148:151], a[136:139], v[68:71], v[148:151]
  s_add_u32 s67, s67, 4096
  v_exp_f32 v55, v55
  v_mfma_f32_16x16x32_bf16 v[148:151], a[140:143], v[84:87], v[148:151]
  ds_read_b128 a[148:151], v2 offset:37888
  v_cvt_pk_bf16_f32 v101, v54, v55
  v_mfma_f32_16x16x32_bf16 a[164:167], a[160:163], v[64:67], a[164:167]
  buffer_load_dwordx4 v5, s[28:31], s67 offen offset:0 sc1 lds
  v_mfma_f32_16x16x32_bf16 a[164:167], a[160:163], v[80:83], a[164:167]
  v_add_u32 v21, 471040, v21
  v_mfma_f32_16x16x32_bf16 v[60:63], a[64:67], a[12:15], v[44:47]
  v_exp_f32 v56, v56
  v_mfma_f32_16x16x32_bf16 v[60:63], a[68:71], a[28:31], v[60:63]
  buffer_load_dword v22, v21, s[28:31], 0 offen sc1
  v_mfma_f32_16x16x32_bf16 v[60:63], a[72:75], a[44:47], v[60:63]
  v_exp_f32 v57, v57
  v_mfma_f32_16x16x32_bf16 v[60:63], a[76:79], a[60:63], v[60:63]
  ds_read_b128 a[152:155], v2 offset:38912
  v_cvt_pk_bf16_f32 v104, v56, v57
  v_mfma_f32_16x16x32_bf16 v[152:155], a[136:139], v[72:75], v[152:155]
  v_exp_f32 v58, v58
  v_mfma_f32_16x16x32_bf16 v[152:155], a[140:143], v[88:91], v[152:155]
  buffer_load_dwordx4 v5, s[28:31], s67 offen offset:1024 sc1 lds
  v_mfma_f32_16x16x32_bf16 v[156:159], a[136:139], v[76:79], v[156:159]
  v_exp_f32 v59, v59
  v_mfma_f32_16x16x32_bf16 v[156:159], a[140:143], v[92:95], v[156:159]
  s_waitcnt lgkmcnt(1)
  ds_read_b128 a[156:159], v2 offset:39936
  v_cvt_pk_bf16_f32 v105, v58, v59
  v_mfma_f32_16x16x32_bf16 v[48:51], a[80:83], a[0:3], v[32:35]
  v_exp_f32 v60, v60
  v_mfma_f32_16x16x32_bf16 v[48:51], a[84:87], a[16:19], v[48:51]
  buffer_load_dwordx4 v5, s[28:31], s67 offen offset:2048 sc1 lds
  v_mfma_f32_16x16x32_bf16 v[48:51], a[88:91], a[32:35], v[48:51]
  v_exp_f32 v61, v61
  v_mfma_f32_16x16x32_bf16 v[48:51], a[92:95], a[48:51], v[48:51]
  ds_read_b128 a[96:99], v1 offset:40960
  v_cvt_pk_bf16_f32 v108, v60, v61
  v_mfma_f32_16x16x32_bf16 v[160:163], a[144:147], v[64:67], v[160:163]
  v_exp_f32 v62, v62
  v_mfma_f32_16x16x32_bf16 v[160:163], a[148:151], v[80:83], v[160:163]
  buffer_load_dwordx4 v5, s[28:31], s67 offen offset:3072 sc1 lds
  v_mfma_f32_16x16x32_bf16 v[164:167], a[144:147], v[68:71], v[164:167]
  v_exp_f32 v63, v63
  v_mfma_f32_16x16x32_bf16 v[164:167], a[148:151], v[84:87], v[164:167]
  ds_read_b128 a[100:103], v1 offset:41984
  v_cvt_pk_bf16_f32 v109, v62, v63
  v_mfma_f32_16x16x32_bf16 v[52:55], a[80:83], a[4:7], v[36:39]
  v_exp_f32 v48, v48
  v_mfma_f32_16x16x32_bf16 v[52:55], a[84:87], a[20:23], v[52:55]
  v_mad_u32_u24 v19, v17, s18, v18
  v_mfma_f32_16x16x32_bf16 v[52:55], a[88:91], a[36:39], v[52:55]
  s_lshl_b32 s18, s18, 3
  v_exp_f32 v49, v49
  v_mfma_f32_16x16x32_bf16 v[52:55], a[92:95], a[52:55], v[52:55]
  s_add_u32 m0, s19, 0
  ds_read_b128 a[104:107], v1 offset:43008
  v_cvt_pk_bf16_f32 v98, v48, v49
  v_mfma_f32_16x16x32_bf16 v[168:171], a[144:147], v[72:75], v[168:171]
  v_exp_f32 v50, v50
  v_mfma_f32_16x16x32_bf16 v[168:171], a[148:151], v[88:91], v[168:171]
  buffer_load_dwordx4 v19, s[12:15], s16 offen lds
  v_mfma_f32_16x16x32_bf16 v[172:175], a[144:147], v[76:79], v[172:175]
  v_exp_f32 v51, v51
  v_mfma_f32_16x16x32_bf16 v[172:175], a[148:151], v[92:95], v[172:175]
  ds_read_b128 a[108:111], v1 offset:44032
  v_cvt_pk_bf16_f32 v99, v50, v51
  v_mfma_f32_16x16x32_bf16 v[56:59], a[80:83], a[8:11], v[40:43]
  v_exp_f32 v52, v52
  v_mfma_f32_16x16x32_bf16 v[56:59], a[84:87], a[24:27], v[56:59]
  s_add_u32 s16, s16, s18
  v_mfma_f32_16x16x32_bf16 v[56:59], a[88:91], a[40:43], v[56:59]
  s_waitcnt lgkmcnt(4)
  s_add_u32 m0, s19, 1024
  v_exp_f32 v53, v53
  v_mfma_f32_16x16x32_bf16 v[56:59], a[92:95], a[56:59], v[56:59]
  ds_read_b128 a[128:131], v2 offset:40960
  v_cvt_pk_bf16_f32 v102, v52, v53
  v_mfma_f32_16x16x32_bf16 v[176:179], a[152:155], v[64:67], v[176:179]
  v_exp_f32 v54, v54
  v_mfma_f32_16x16x32_bf16 v[176:179], a[156:159], v[80:83], v[176:179]
  buffer_load_dwordx4 v19, s[12:15], s16 offen lds
  v_mfma_f32_16x16x32_bf16 v[180:183], a[152:155], v[68:71], v[180:183]
  v_exp_f32 v55, v55
  v_mfma_f32_16x16x32_bf16 v[180:183], a[156:159], v[84:87], v[180:183]
  ds_read_b128 a[132:135], v2 offset:41984
  v_cvt_pk_bf16_f32 v103, v54, v55
  v_mfma_f32_16x16x32_bf16 a[168:171], a[160:163], v[68:71], a[168:171]
  v_mfma_f32_16x16x32_bf16 a[168:171], a[160:163], v[84:87], a[168:171]
  s_add_u32 s16, s16, s18
  v_mfma_f32_16x16x32_bf16 v[60:63], a[80:83], a[12:15], v[44:47]
  s_add_u32 m0, s19, 2048
  v_exp_f32 v56, v56
  v_mfma_f32_16x16x32_bf16 v[60:63], a[84:87], a[28:31], v[60:63]
  buffer_load_dwordx4 v19, s[12:15], s16 offen lds
  v_mfma_f32_16x16x32_bf16 v[60:63], a[88:91], a[44:47], v[60:63]
  v_exp_f32 v57, v57
  v_mfma_f32_16x16x32_bf16 v[60:63], a[92:95], a[60:63], v[60:63]
  ds_read_b128 a[136:139], v2 offset:43008
  v_cvt_pk_bf16_f32 v106, v56, v57
  v_mfma_f32_16x16x32_bf16 v[184:187], a[152:155], v[72:75], v[184:187]
  v_exp_f32 v58, v58
  v_mfma_f32_16x16x32_bf16 v[184:187], a[156:159], v[88:91], v[184:187]
  s_add_u32 s16, s16, s18
  v_mfma_f32_16x16x32_bf16 v[188:191], a[152:155], v[76:79], v[188:191]
  s_add_u32 m0, s19, 3072
  v_exp_f32 v59, v59
  v_mfma_f32_16x16x32_bf16 v[188:191], a[156:159], v[92:95], v[188:191]
  s_waitcnt lgkmcnt(1)
  ds_read_b128 a[140:143], v2 offset:44032
  v_cvt_pk_bf16_f32 v107, v58, v59
  v_mfma_f32_16x16x32_bf16 v[48:51], a[96:99], a[0:3], v[32:35]
  v_exp_f32 v60, v60
  v_mfma_f32_16x16x32_bf16 v[48:51], a[100:103], a[16:19], v[48:51]
  ds_read_b128 a[112:115], v1 offset:45056
  v_mfma_f32_16x16x32_bf16 v[48:51], a[104:107], a[32:35], v[48:51]
  v_exp_f32 v61, v61
  v_mfma_f32_16x16x32_bf16 v[48:51], a[108:111], a[48:51], v[48:51]
  ds_read_b128 a[116:119], v1 offset:46080
  v_cvt_pk_bf16_f32 v110, v60, v61
  v_mfma_f32_16x16x32_bf16 v[192:195], a[128:131], v[64:67], v[192:195]
  v_exp_f32 v62, v62
  v_mfma_f32_16x16x32_bf16 v[192:195], a[132:135], v[80:83], v[192:195]
  buffer_load_dwordx4 v19, s[12:15], s16 offen lds
  v_mfma_f32_16x16x32_bf16 v[196:199], a[128:131], v[68:71], v[196:199]
  v_exp_f32 v63, v63
  s_getpc_b64 s[4:5]
L_pcs:
  v_mfma_f32_16x16x32_bf16 v[196:199], a[132:135], v[84:87], v[196:199]
  s_lshr_b32 s6, s2, 3
  ds_read_b128 a[120:123], v1 offset:47104
  v_cvt_pk_bf16_f32 v111, v62, v63
  v_mfma_f32_16x16x32_bf16 v[52:55], a[96:99], a[4:7], v[36:39]
  s_lshl_b32 s6, s6, 2
  v_exp_f32 v48, v48
  v_mfma_f32_16x16x32_bf16 v[52:55], a[100:103], a[20:23], v[52:55]
  s_add_u32 s6, s6, s48
  ds_read_b128 a[124:127], v1 offset:48128
  v_mfma_f32_16x16x32_bf16 v[52:55], a[104:107], a[36:39], v[52:55]
  s_lshl_b32 s6, s6, 9
  v_exp_f32 v49, v49
  v_mfma_f32_16x16x32_bf16 v[52:55], a[108:111], a[52:55], v[52:55]
  ds_read_b128 a[144:147], v2 offset:45056
  v_cvt_pk_bf16_f32 v112, v48, v49
  v_mfma_f32_16x16x32_bf16 v[200:203], a[128:131], v[72:75], v[200:203]
  v_exp_f32 v50, v50
  v_mfma_f32_16x16x32_bf16 v[200:203], a[132:135], v[88:91], v[200:203]
  v_and_b32 v4, 3, v0
  v_lshl_add_u32 v4, v4, 7, s6
  v_mfma_f32_16x16x32_bf16 v[204:207], a[128:131], v[76:79], v[204:207]
  v_exp_f32 v51, v51
  v_mfma_f32_16x16x32_bf16 v[204:207], a[132:135], v[92:95], v[204:207]
  ds_read_b128 a[148:151], v2 offset:46080
  v_cvt_pk_bf16_f32 v113, v50, v51
  v_mfma_f32_16x16x32_bf16 v[56:59], a[96:99], a[8:11], v[40:43]
  v_exp_f32 v52, v52
  v_mfma_f32_16x16x32_bf16 v[56:59], a[100:103], a[24:27], v[56:59]
  ds_read_b128 a[152:155], v2 offset:47104
  v_min_u32 v4, code_end - L_pcs - 4, v4
  v_mfma_f32_16x16x32_bf16 v[56:59], a[104:107], a[40:43], v[56:59]
  s_waitcnt lgkmcnt(7)
  s_mov_b32 s70, s62
  v_exp_f32 v53, v53
  v_mfma_f32_16x16x32_bf16 v[56:59], a[108:111], a[56:59], v[56:59]
  s_mov_b32 s62, s60
  ds_read_b128 a[156:159], v2 offset:48128
  v_cvt_pk_bf16_f32 v116, v52, v53
  v_mfma_f32_16x16x32_bf16 v[208:211], a[136:139], v[64:67], v[208:211]
  s_lshl_b32 s66, s60, 15
  v_exp_f32 v54, v54
  v_mfma_f32_16x16x32_bf16 v[208:211], a[140:143], v[80:83], v[208:211]
  s_add_u32 s66, s66, s64
  global_load_dword v28, v4, s[4:5]
  v_mfma_f32_16x16x32_bf16 v[212:215], a[136:139], v[68:71], v[212:215]
  s_add_u32 s60, s60, 1
  v_exp_f32 v55, v55
  v_mfma_f32_16x16x32_bf16 v[212:215], a[140:143], v[84:87], v[212:215]
  s_cmp_eq_u32 s60, s57
  s_addc_u32 s60, s60, 0
  v_cvt_pk_bf16_f32 v117, v54, v55
  v_mfma_f32_16x16x32_bf16 a[172:175], a[160:163], v[72:75], a[172:175]
  s_add_u32 s52, s61, 2
  v_mfma_f32_16x16x32_bf16 a[172:175], a[160:163], v[88:91], a[172:175]
  s_cmp_gt_u32 s58, s52
  s_cselect_b32 s66, s66, s78
  v_mfma_f32_16x16x32_bf16 v[60:63], a[96:99], a[12:15], v[44:47]
  s_cmp_gt_u32 s58, s52
  s_cselect_b32 s80, s56, s77
  v_exp_f32 v56, v56
  v_mfma_f32_16x16x32_bf16 v[60:63], a[100:103], a[28:31], v[60:63]
  v_mfma_f32_16x16x32_bf16 v[60:63], a[104:107], a[44:47], v[60:63]
  v_exp_f32 v57, v57
  v_mfma_f32_16x16x32_bf16 v[60:63], a[108:111], a[60:63], v[60:63]
  v_cvt_pk_bf16_f32 v120, v56, v57
  v_mfma_f32_16x16x32_bf16 v[216:219], a[136:139], v[72:75], v[216:219]
  v_exp_f32 v58, v58
  v_mfma_f32_16x16x32_bf16 v[216:219], a[140:143], v[88:91], v[216:219]
  s_waitcnt vmcnt(5) lgkmcnt(0)
  s_barrier
  v_mfma_f32_16x16x32_bf16 v[220:223], a[136:139], v[76:79], v[220:223]
  s_add_u32 m0, s80, 32768
  v_exp_f32 v59, v59
  v_mfma_f32_16x16x32_bf16 v[220:223], a[140:143], v[92:95], v[220:223]
  v_cvt_pk_bf16_f32 v121, v58, v59
  v_mfma_f32_16x16x32_bf16 v[48:51], a[112:115], a[0:3], v[32:35]
  v_exp_f32 v60, v60
  v_mfma_f32_16x16x32_bf16 v[48:51], a[116:119], a[16:19], v[48:51]
  buffer_load_dwordx4 v5, s[28:31], s66 offen offset:0 sc1 lds
  v_mfma_f32_16x16x32_bf16 v[48:51], a[120:123], a[32:35], v[48:51]
  v_exp_f32 v61, v61
  v_mfma_f32_16x16x32_bf16 v[48:51], a[124:127], a[48:51], v[48:51]
  ds_read_b128 a[64:67], v1 offset:0
  v_cvt_pk_bf16_f32 v124, v60, v61
  v_mfma_f32_16x16x32_bf16 v[224:227], a[144:147], v[64:67], v[224:227]
  v_exp_f32 v62, v62
  v_mfma_f32_16x16x32_bf16 v[224:227], a[148:151], v[80:83], v[224:227]
  buffer_load_dwordx4 v5, s[28:31], s66 offen offset:1024 sc1 lds
  v_mfma_f32_16x16x32_bf16 v[228:231], a[144:147], v[68:71], v[228:231]
  v_exp_f32 v63, v63
  v_mfma_f32_16x16x32_bf16 v[228:231], a[148:151], v[84:87], v[228:231]
  ds_read_b128 a[68:71], v1 offset:1024
  v_cvt_pk_bf16_f32 v125, v62, v63
  v_mfma_f32_16x16x32_bf16 v[52:55], a[112:115], a[4:7], v[36:39]
  v_exp_f32 v48, v48
  v_mfma_f32_16x16x32_bf16 v[52:55], a[116:119], a[20:23], v[52:55]
  buffer_load_dwordx4 v5, s[28:31], s66 offen offset:2048 sc1 lds
  v_mfma_f32_16x16x32_bf16 v[52:55], a[120:123], a[36:39], v[52:55]
  v_exp_f32 v49, v49
  v_mfma_f32_16x16x32_bf16 v[52:55], a[124:127], a[52:55], v[52:55]
  ds_read_b128 a[72:75], v1 offset:2048
  v_cvt_pk_bf16_f32 v114, v48, v49
  v_mfma_f32_16x16x32_bf16 v[232:235], a[144:147], v[72:75], v[232:235]
  v_exp_f32 v50, v50
  v_mfma_f32_16x16x32_bf16 v[232:235], a[148:151], v[88:91], v[232:235]
  buffer_load_dwordx4 v5, s[28:31], s66 offen offset:3072 sc1 lds
  v_mfma_f32_16x16x32_bf16 v[236:239], a[144:147], v[76:79], v[236:239]
  v_exp_f32 v51, v51
  v_mfma_f32_16x16x32_bf16 v[236:239], a[148:151], v[92:95], v[236:239]
  s_add_u32 m0, s80, 36864
  ds_read_b128 a[76:79], v1 offset:3072
  v_cvt_pk_bf16_f32 v115, v50, v51
  v_mfma_f32_16x16x32_bf16 v[56:59], a[112:115], a[8:11], v[40:43]
  s_add_u32 s66, s66, 4096
  v_exp_f32 v52, v52
  v_mfma_f32_16x16x32_bf16 v[56:59], a[116:119], a[24:27], v[56:59]
  buffer_load_dwordx4 v5, s[28:31], s66 offen offset:0 sc1 lds
  v_mfma_f32_16x16x32_bf16 v[56:59], a[120:123], a[40:43], v[56:59]
  v_exp_f32 v53, v53
  v_mfma_f32_16x16x32_bf16 v[56:59], a[124:127], a[56:59], v[56:59]
  ds_read_b128 a[128:131], v2 offset:0
  v_cvt_pk_bf16_f32 v118, v52, v53
  v_mfma_f32_16x16x32_bf16 v[240:243], a[152:155], v[64:67], v[240:243]
  v_exp_f32 v54, v54
  v_mfma_f32_16x16x32_bf16 v[240:243], a[156:159], v[80:83], v[240:243]
  buffer_load_dwordx4 v5, s[28:31], s66 offen offset:1024 sc1 lds
  v_mfma_f32_16x16x32_bf16 v[244:247], a[152:155], v[68:71], v[244:247]
  v_exp_f32 v55, v55
  v_mfma_f32_16x16x32_bf16 v[244:247], a[156:159], v[84:87], v[244:247]
  ds_read_b128 a[132:135], v2 offset:1024
  v_cvt_pk_bf16_f32 v119, v54, v55
  v_mfma_f32_16x16x32_bf16 a[176:179], a[160:163], v[76:79], a[176:179]
  buffer_load_dwordx4 v5, s[28:31], s66 offen offset:2048 sc1 lds
  v_mfma_f32_16x16x32_bf16 a[176:179], a[160:163], v[92:95], a[176:179]
  v_mfma_f32_16x16x32_bf16 v[60:63], a[112:115], a[12:15], v[44:47]
  v_exp_f32 v56, v56
  v_mfma_f32_16x16x32_bf16 v[60:63], a[116:119], a[28:31], v[60:63]
  buffer_load_dwordx4 v5, s[28:31], s66 offen offset:3072 sc1 lds
  v_mfma_f32_16x16x32_bf16 v[60:63], a[120:123], a[44:47], v[60:63]
  v_exp_f32 v57, v57
  v_mfma_f32_16x16x32_bf16 v[60:63], a[124:127], a[60:63], v[60:63]
  ds_read_b128 a[136:139], v2 offset:2048
  v_cvt_pk_bf16_f32 v122, v56, v57
  v_mfma_f32_16x16x32_bf16 v[248:251], a[152:155], v[72:75], v[248:251]
  v_exp_f32 v58, v58
  v_mfma_f32_16x16x32_bf16 v[248:251], a[156:159], v[88:91], v[248:251]
  v_mfma_f32_16x16x32_bf16 v[252:255], a[152:155], v[76:79], v[252:255]
  s_add_u32 s61, s61, 1
  v_exp_f32 v59, v59
  v_mfma_f32_16x16x32_bf16 v[252:255], a[156:159], v[92:95], v[252:255]
  s_waitcnt lgkmcnt(1)
  ds_read_b128 a[140:143], v2 offset:3072
  v_cvt_pk_bf16_f32 v123, v58, v59
  v_cmp_gt_u32 vcc, 32, v22
  s_nop 0
  s_cbranch_vccnz L_pt_w
L_pt_ok:
  v_mfma_f32_16x16x32_bf16 v[48:51], a[64:67], a[0:3], v[32:35]
  s_lshl_b32 s67, s70, 15
  v_exp_f32 v60, v60
  v_mfma_f32_16x16x32_bf16 v[48:51], a[68:71], a[16:19], v[48:51]
  s_add_u32 s67, s67, s65
  v_add_u32 v26, 192, v0
  v_mul_u32_u24 v19, 3277, v26
  v_mfma_f32_16x16x32_bf16 v[48:51], a[72:75], a[32:35], v[48:51]
  s_add_u32 m0, s56, 98304
  v_exp_f32 v61, v61
  v_mfma_f32_16x16x32_bf16 v[48:51], a[76:79], a[48:51], v[48:51]
  ds_read_b128 a[80:83], v1 offset:4096
  v_cvt_pk_bf16_f32 v126, v60, v61
  v_mfma_f32_16x16x32_bf16 v[128:131], a[128:131], v[96:99], v[128:131]
  v_exp_f32 v62, v62
  v_mfma_f32_16x16x32_bf16 v[128:131], a[132:135], v[112:115], v[128:131]
  buffer_load_dwordx4 v5, s[28:31], s67 offen offset:0 sc1 lds
  v_mfma_f32_16x16x32_bf16 v[132:135], a[128:131], v[100:103], v[132:135]
  v_exp_f32 v63, v63
  v_mfma_f32_16x16x32_bf16 v[132:135], a[132:135], v[116:119], v[132:135]
  ds_read_b128 a[84:87], v1 offset:5120
  v_cvt_pk_bf16_f32 v127, v62, v63
  v_mfma_f32_16x16x32_bf16 v[52:55], a[64:67], a[4:7], v[36:39]
  v_exp_f32 v48, v48
  v_mfma_f32_16x16x32_bf16 v[52:55], a[68:71], a[20:23], v[52:55]
  buffer_load_dwordx4 v5, s[28:31], s67 offen offset:1024 sc1 lds
  v_mfma_f32_16x16x32_bf16 v[52:55], a[72:75], a[36:39], v[52:55]
  v_exp_f32 v49, v49
  v_mfma_f32_16x16x32_bf16 v[52:55], a[76:79], a[52:55], v[52:55]
  ds_read_b128 a[88:91], v1 offset:6144
  v_cvt_pk_bf16_f32 v64, v48, v49
  v_mfma_f32_16x16x32_bf16 v[136:139], a[128:131], v[104:107], v[136:139]
  v_exp_f32 v50, v50
  v_mfma_f32_16x16x32_bf16 v[136:139], a[132:135], v[120:123], v[136:139]
  buffer_load_dwordx4 v5, s[28:31], s67 offen offset:2048 sc1 lds
  v_mfma_f32_16x16x32_bf16 v[140:143], a[128:131], v[108:111], v[140:143]
  v_exp_f32 v51, v51
  v_mfma_f32_16x16x32_bf16 v[140:143], a[132:135], v[124:127], v[140:143]
  ds_read_b128 a[92:95], v1 offset:7168
  v_cvt_pk_bf16_f32 v65, v50, v51
  v_mfma_f32_16x16x32_bf16 v[56:59], a[64:67], a[8:11], v[40:43]
  v_exp_f32 v52, v52
  v_mfma_f32_16x16x32_bf16 v[56:59], a[68:71], a[24:27], v[56:59]
  buffer_load_dwordx4 v5, s[28:31], s67 offen offset:3072 sc1 lds
  v_mfma_f32_16x16x32_bf16 v[56:59], a[72:75], a[40:43], v[56:59]
  s_waitcnt lgkmcnt(4)
  v_exp_f32 v53, v53
  v_mfma_f32_16x16x32_bf16 v[56:59], a[76:79], a[56:59], v[56:59]
  ds_read_b128 a[144:147], v2 offset:4096
  v_cvt_pk_bf16_f32 v68, v52, v53
  v_mfma_f32_16x16x32_bf16 v[144:147], a[136:139], v[96:99], v[144:147]
  v_exp_f32 v54, v54
  v_mfma_f32_16x16x32_bf16 v[144:147], a[140:143], v[112:115], v[144:147]
  s_waitcnt vmcnt(13)
  s_add_u32 m0, s56, 102400
  ds_read_b64 a[180:181], v12 offset:0
  v_lshrrev_b32 v19, 16, v19
  v_mfma_f32_16x16x32_bf16 v[148:151], a[136:139], v[100:103], v[148:151]
  s_add_u32 s67, s67, 4096
  v_exp_f32 v55, v55
  v_mfma_f32_16x16x32_bf16 v[148:151], a[140:143], v[116:119], v[148:151]
  ds_read_b128 a[148:151], v2 offset:5120
  v_cvt_pk_bf16_f32 v69, v54, v55
  v_mfma_f32_16x16x32_bf16 a[164:167], a[160:163], v[96:99], a[164:167]
  buffer_load_dwordx4 v5, s[28:31], s67 offen offset:0 sc1 lds
  v_mfma_f32_16x16x32_bf16 a[164:167], a[160:163], v[112:115], a[164:167]
  ds_read_b64 a[182:183], v13 offset:0
  v_mul_u32_u24 v4, 20, v19
  v_mfma_f32_16x16x32_bf16 v[60:63], a[64:67], a[12:15], v[44:47]
  v_exp_f32 v56, v56
  v_mfma_f32_16x16x32_bf16 v[60:63], a[68:71], a[28:31], v[60:63]
  ds_read_b64 a[184:185], v12 offset:2048
  v_sub_u32 v26, v26, v4
  v_mfma_f32_16x16x32_bf16 v[60:63], a[72:75], a[44:47], v[60:63]
  v_exp_f32 v57, v57
  v_mfma_f32_16x16x32_bf16 v[60:63], a[76:79], a[60:63], v[60:63]
  ds_read_b128 a[152:155], v2 offset:6144
  v_cvt_pk_bf16_f32 v72, v56, v57
  v_mfma_f32_16x16x32_bf16 v[152:155], a[136:139], v[104:107], v[152:155]
  v_exp_f32 v58, v58
  v_mfma_f32_16x16x32_bf16 v[152:155], a[140:143], v[120:123], v[152:155]
  buffer_load_dwordx4 v5, s[28:31], s67 offen offset:1024 sc1 lds
  v_mfma_f32_16x16x32_bf16 v[156:159], a[136:139], v[108:111], v[156:159]
  v_exp_f32 v59, v59
  v_mfma_f32_16x16x32_bf16 v[156:159], a[140:143], v[124:127], v[156:159]
  s_waitcnt lgkmcnt(1)
  ds_read_b128 a[156:159], v2 offset:7168
  v_cvt_pk_bf16_f32 v73, v58, v59
  v_mfma_f32_16x16x32_bf16 v[48:51], a[80:83], a[0:3], v[32:35]
  v_exp_f32 v60, v60
  v_mfma_f32_16x16x32_bf16 v[48:51], a[84:87], a[16:19], v[48:51]
  buffer_load_dwordx4 v5, s[28:31], s67 offen offset:2048 sc1 lds
  v_mfma_f32_16x16x32_bf16 v[48:51], a[88:91], a[32:35], v[48:51]
  v_exp_f32 v61, v61
  v_mfma_f32_16x16x32_bf16 v[48:51], a[92:95], a[48:51], v[48:51]
  ds_read_b128 a[96:99], v1 offset:8192
  v_cvt_pk_bf16_f32 v76, v60, v61
  v_mfma_f32_16x16x32_bf16 v[160:163], a[144:147], v[96:99], v[160:163]
  v_exp_f32 v62, v62
  v_mfma_f32_16x16x32_bf16 v[160:163], a[148:151], v[112:115], v[160:163]
  buffer_load_dwordx4 v5, s[28:31], s67 offen offset:3072 sc1 lds
  v_mfma_f32_16x16x32_bf16 v[164:167], a[144:147], v[100:103], v[164:167]
  v_exp_f32 v63, v63
  v_mfma_f32_16x16x32_bf16 v[164:167], a[148:151], v[116:119], v[164:167]
  ds_read_b128 a[100:103], v1 offset:9216
  v_cvt_pk_bf16_f32 v77, v62, v63
  v_mfma_f32_16x16x32_bf16 v[52:55], a[80:83], a[4:7], v[36:39]
  v_exp_f32 v48, v48
  v_mfma_f32_16x16x32_bf16 v[52:55], a[84:87], a[20:23], v[52:55]
  ds_read_b64 a[186:187], v13 offset:2048
  v_bfe_u32 v4, v19, 2, 1
  v_mfma_f32_16x16x32_bf16 v[52:55], a[88:91], a[36:39], v[52:55]
  v_exp_f32 v49, v49
  v_mfma_f32_16x16x32_bf16 v[52:55], a[92:95], a[52:55], v[52:55]
  ds_read_b128 a[104:107], v1 offset:10240
  v_cvt_pk_bf16_f32 v66, v48, v49
  v_mfma_f32_16x16x32_bf16 v[168:171], a[144:147], v[104:107], v[168:171]
  v_exp_f32 v50, v50
  v_mfma_f32_16x16x32_bf16 v[168:171], a[148:151], v[120:123], v[168:171]
  buffer_store_dwordx4 a[180:183], v3, s[28:31], s17 offen offset:0 sc1
  v_mfma_f32_16x16x32_bf16 v[172:175], a[144:147], v[108:111], v[172:175]
  v_exp_f32 v51, v51
  v_mfma_f32_16x16x32_bf16 v[172:175], a[148:151], v[124:127], v[172:175]
  ds_read_b128 a[108:111], v1 offset:11264
  v_cvt_pk_bf16_f32 v67, v50, v51
  v_mfma_f32_16x16x32_bf16 v[56:59], a[80:83], a[8:11], v[40:43]
  v_exp_f32 v52, v52
  v_mfma_f32_16x16x32_bf16 v[56:59], a[84:87], a[24:27], v[56:59]
  ds_read_b64 a[188:189], v14 offset:0
  v_lshlrev_b32 v4, 1, v4
  v_mfma_f32_16x16x32_bf16 v[56:59], a[88:91], a[40:43], v[56:59]
  s_waitcnt lgkmcnt(6)
  v_exp_f32 v53, v53
  v_mfma_f32_16x16x32_bf16 v[56:59], a[92:95], a[56:59], v[56:59]
  ds_read_b128 a[128:131], v2 offset:8192
  v_cvt_pk_bf16_f32 v70, v52, v53
  v_mfma_f32_16x16x32_bf16 v[176:179], a[152:155], v[96:99], v[176:179]
  v_exp_f32 v54, v54
  v_mfma_f32_16x16x32_bf16 v[176:179], a[156:159], v[112:115], v[176:179]
  ds_read_b64 a[190:191], v15 offset:0
  v_xor_b32 v26, v26, v4
  v_mfma_f32_16x16x32_bf16 v[180:183], a[152:155], v[100:103], v[180:183]
  v_exp_f32 v55, v55
  v_mfma_f32_16x16x32_bf16 v[180:183], a[156:159], v[116:119], v[180:183]
  ds_read_b128 a[132:135], v2 offset:9216
  v_cvt_pk_bf16_f32 v71, v54, v55
  v_mfma_f32_16x16x32_bf16 a[168:171], a[160:163], v[100:103], a[168:171]
  s_waitcnt lgkmcnt(6)
  buffer_store_dwordx4 a[184:187], v3, s[28:31], s17 offen offset:1024 sc1
  v_mfma_f32_16x16x32_bf16 a[168:171], a[160:163], v[116:119], a[168:171]
  s_waitcnt vmcnt(18)
  ds_read_b64 v[28:29], v14 offset:2048
  v_mul_u32_u24 v19, 1280, v19
  v_mfma_f32_16x16x32_bf16 v[60:63], a[80:83], a[12:15], v[44:47]
  s_and_b32 s9, s2, 31
  v_exp_f32 v56, v56
  v_mfma_f32_16x16x32_bf16 v[60:63], a[84:87], a[28:31], v[60:63]
  s_lshl_b32 s9, s9, 7
  ds_read_b64 v[30:31], v15 offset:2048
  v_lshl_add_u32 v26, v26, 4, v19
  v_mfma_f32_16x16x32_bf16 v[60:63], a[88:91], a[44:47], v[60:63]
  s_add_u32 s9, s9, 475136
  v_exp_f32 v57, v57
  v_mfma_f32_16x16x32_bf16 v[60:63], a[92:95], a[60:63], v[60:63]
  ds_read_b128 a[136:139], v2 offset:10240
  v_cvt_pk_bf16_f32 v74, v56, v57
  v_mfma_f32_16x16x32_bf16 v[184:187], a[152:155], v[104:107], v[184:187]
  v_exp_f32 v58, v58
  v_mfma_f32_16x16x32_bf16 v[184:187], a[156:159], v[120:123], v[184:187]
  s_waitcnt lgkmcnt(4)
  buffer_store_dwordx4 a[188:191], v3, s[28:31], s11 offen offset:0 sc1
  v_mfma_f32_16x16x32_bf16 v[188:191], a[152:155], v[108:111], v[188:191]
HS14:
  s_cbranch_execz HOPR_a
  v_exp_f32 v59, v59
  v_mfma_f32_16x16x32_bf16 v[188:191], a[156:159], v[124:127], v[188:191]
  s_waitcnt lgkmcnt(1)
  ds_read_b128 a[140:143], v2 offset:11264
  v_cvt_pk_bf16_f32 v75, v58, v59
  v_mfma_f32_16x16x32_bf16 v[48:51], a[96:99], a[0:3], v[32:35]
  v_exp_f32 v60, v60
  v_mfma_f32_16x16x32_bf16 v[48:51], a[100:103], a[16:19], v[48:51]
  ds_read_b128 a[112:115], v1 offset:12288
  v_mfma_f32_16x16x32_bf16 v[48:51], a[104:107], a[32:35], v[48:51]
  v_exp_f32 v61, v61
  v_mfma_f32_16x16x32_bf16 v[48:51], a[108:111], a[48:51], v[48:51]
  ds_read_b128 a[116:119], v1 offset:13312
  v_cvt_pk_bf16_f32 v78, v60, v61
  v_mfma_f32_16x16x32_bf16 v[192:195], a[128:131], v[96:99], v[192:195]
  v_exp_f32 v62, v62
  v_mfma_f32_16x16x32_bf16 v[192:195], a[132:135], v[112:115], v[192:195]
  v_add_u32 v27, 256, v0
  v_mul_u32_u24 v19, 3277, v27
  v_mfma_f32_16x16x32_bf16 v[196:199], a[128:131], v[100:103], v[196:199]
  v_exp_f32 v63, v63
  v_mfma_f32_16x16x32_bf16 v[196:199], a[132:135], v[116:119], v[196:199]
  ds_read_b128 a[120:123], v1 offset:14336
  v_cvt_pk_bf16_f32 v79, v62, v63
  v_mfma_f32_16x16x32_bf16 v[52:55], a[96:99], a[4:7], v[36:39]
  v_exp_f32 v48, v48
  v_mfma_f32_16x16x32_bf16 v[52:55], a[100:103], a[20:23], v[52:55]
  ds_read_b128 a[124:127], v1 offset:15360
  v_lshrrev_b32 v19, 16, v19
  v_mfma_f32_16x16x32_bf16 v[52:55], a[104:107], a[36:39], v[52:55]
  v_exp_f32 v49, v49
  v_mfma_f32_16x16x32_bf16 v[52:55], a[108:111], a[52:55], v[52:55]
  ds_read_b128 a[144:147], v2 offset:12288
  v_cvt_pk_bf16_f32 v80, v48, v49
  v_mfma_f32_16x16x32_bf16 v[200:203], a[128:131], v[104:107], v[200:203]
  v_exp_f32 v50, v50
  v_mfma_f32_16x16x32_bf16 v[200:203], a[132:135], v[120:123], v[200:203]
  buffer_store_dwordx4 v[28:31], v3, s[28:31], s11 offen offset:1024 sc1
  v_mfma_f32_16x16x32_bf16 v[204:207], a[128:131], v[108:111], v[204:207]
  v_exp_f32 v51, v51
  v_mfma_f32_16x16x32_bf16 v[204:207], a[132:135], v[124:127], v[204:207]
  ds_read_b128 a[148:151], v2 offset:13312
  v_cvt_pk_bf16_f32 v81, v50, v51
  v_mfma_f32_16x16x32_bf16 v[56:59], a[96:99], a[8:11], v[40:43]
  v_exp_f32 v52, v52
  v_mfma_f32_16x16x32_bf16 v[56:59], a[100:103], a[24:27], v[56:59]
  ds_read_b128 a[152:155], v2 offset:14336
  v_mul_u32_u24 v4, 20, v19
  v_mfma_f32_16x16x32_bf16 v[56:59], a[104:107], a[40:43], v[56:59]
  s_waitcnt lgkmcnt(7)
  s_mov_b32 s70, s62
  v_exp_f32 v53, v53
  v_mfma_f32_16x16x32_bf16 v[56:59], a[108:111], a[56:59], v[56:59]
  s_mov_b32 s62, s60
  ds_read_b128 a[156:159], v2 offset:15360
  v_cvt_pk_bf16_f32 v84, v52, v53
  v_mfma_f32_16x16x32_bf16 v[208:211], a[136:139], v[96:99], v[208:211]
  s_lshl_b32 s66, s60, 15
  v_exp_f32 v54, v54
  v_mfma_f32_16x16x32_bf16 v[208:211], a[140:143], v[112:115], v[208:211]
  s_add_u32 s66, s66, s64
  v_sub_u32 v27, v27, v4
  v_bfe_u32 v4, v19, 2, 1
  v_mfma_f32_16x16x32_bf16 v[212:215], a[136:139], v[100:103], v[212:215]
  s_add_u32 s60, s60, 1
  v_exp_f32 v55, v55
  v_mfma_f32_16x16x32_bf16 v[212:215], a[140:143], v[116:119], v[212:215]
  s_cmp_eq_u32 s60, s57
  s_addc_u32 s60, s60, 0
  v_cvt_pk_bf16_f32 v85, v54, v55
  v_lshlrev_b32 v4, 1, v4
  v_mfma_f32_16x16x32_bf16 a[172:175], a[160:163], v[104:107], a[172:175]
  s_add_u32 s52, s61, 2
  v_xor_b32 v27, v27, v4
  v_mul_u32_u24 v19, 1280, v19
  v_mfma_f32_16x16x32_bf16 a[172:175], a[160:163], v[120:123], a[172:175]
  s_cmp_gt_u32 s58, s52
  s_cselect_b32 s66, s66, s63
  v_lshl_add_u32 v27, v27, 4, v19
  v_mfma_f32_16x16x32_bf16 v[60:63], a[96:99], a[12:15], v[44:47]
  s_cmp_gt_u32 s58, s52
  s_cselect_b32 s80, s56, s77
  v_exp_f32 v56, v56
  v_mfma_f32_16x16x32_bf16 v[60:63], a[100:103], a[28:31], v[60:63]
  v_mfma_f32_16x16x32_bf16 v[60:63], a[104:107], a[44:47], v[60:63]
  v_exp_f32 v57, v57
  v_mfma_f32_16x16x32_bf16 v[60:63], a[108:111], a[60:63], v[60:63]
  v_cvt_pk_bf16_f32 v88, v56, v57
  v_mfma_f32_16x16x32_bf16 v[216:219], a[136:139], v[104:107], v[216:219]
  v_exp_f32 v58, v58
  v_mfma_f32_16x16x32_bf16 v[216:219], a[140:143], v[120:123], v[216:219]
  s_waitcnt vmcnt(4) lgkmcnt(0)
  s_barrier
  v_mfma_f32_16x16x32_bf16 v[220:223], a[136:139], v[108:111], v[220:223]
  s_add_u32 m0, s80, 0
  v_exp_f32 v59, v59
  v_mfma_f32_16x16x32_bf16 v[220:223], a[140:143], v[124:127], v[220:223]
  v_cvt_pk_bf16_f32 v89, v58, v59
  v_mfma_f32_16x16x32_bf16 v[48:51], a[112:115], a[0:3], v[32:35]
  v_exp_f32 v60, v60
  v_mfma_f32_16x16x32_bf16 v[48:51], a[116:119], a[16:19], v[48:51]
  buffer_load_dwordx4 v5, s[28:31], s66 offen offset:0 sc1 lds
  v_mfma_f32_16x16x32_bf16 v[48:51], a[120:123], a[32:35], v[48:51]
  v_exp_f32 v61, v61
  v_mfma_f32_16x16x32_bf16 v[48:51], a[124:127], a[48:51], v[48:51]
  ds_read_b128 a[64:67], v1 offset:32768
  v_cvt_pk_bf16_f32 v92, v60, v61
  v_mfma_f32_16x16x32_bf16 v[224:227], a[144:147], v[96:99], v[224:227]
  v_exp_f32 v62, v62
  v_mfma_f32_16x16x32_bf16 v[224:227], a[148:151], v[112:115], v[224:227]
  buffer_load_dwordx4 v5, s[28:31], s66 offen offset:1024 sc1 lds
  v_mfma_f32_16x16x32_bf16 v[228:231], a[144:147], v[100:103], v[228:231]
  v_exp_f32 v63, v63
  v_mfma_f32_16x16x32_bf16 v[228:231], a[148:151], v[116:119], v[228:231]
  ds_read_b128 a[68:71], v1 offset:33792
  v_cvt_pk_bf16_f32 v93, v62, v63
  v_mfma_f32_16x16x32_bf16 v[52:55], a[112:115], a[4:7], v[36:39]
  v_exp_f32 v48, v48
  v_mfma_f32_16x16x32_bf16 v[52:55], a[116:119], a[20:23], v[52:55]
  buffer_load_dwordx4 v5, s[28:31], s66 offen offset:2048 sc1 lds
  v_mfma_f32_16x16x32_bf16 v[52:55], a[120:123], a[36:39], v[52:55]
  v_exp_f32 v49, v49
  v_mfma_f32_16x16x32_bf16 v[52:55], a[124:127], a[52:55], v[52:55]
  ds_read_b128 a[72:75], v1 offset:34816
  v_cvt_pk_bf16_f32 v82, v48, v49
  v_mfma_f32_16x16x32_bf16 v[232:235], a[144:147], v[104:107], v[232:235]
  v_exp_f32 v50, v50
  v_mfma_f32_16x16x32_bf16 v[232:235], a[148:151], v[120:123], v[232:235]
  buffer_load_dwordx4 v5, s[28:31], s66 offen offset:3072 sc1 lds
  v_mfma_f32_16x16x32_bf16 v[236:239], a[144:147], v[108:111], v[236:239]
  v_exp_f32 v51, v51
  v_mfma_f32_16x16x32_bf16 v[236:239], a[148:151], v[124:127], v[236:239]
  s_add_u32 m0, s80, 4096
  ds_read_b128 a[76:79], v1 offset:35840
  v_cvt_pk_bf16_f32 v83, v50, v51
  v_mfma_f32_16x16x32_bf16 v[56:59], a[112:115], a[8:11], v[40:43]
  s_add_u32 s66, s66, 4096
  v_exp_f32 v52, v52
  v_mfma_f32_16x16x32_bf16 v[56:59], a[116:119], a[24:27], v[56:59]
  buffer_load_dwordx4 v5, s[28:31], s66 offen offset:0 sc1 lds
  v_mfma_f32_16x16x32_bf16 v[56:59], a[120:123], a[40:43], v[56:59]
  v_exp_f32 v53, v53
  v_mfma_f32_16x16x32_bf16 v[56:59], a[124:127], a[56:59], v[56:59]
  ds_read_b128 a[128:131], v2 offset:32768
  v_cvt_pk_bf16_f32 v86, v52, v53
  v_mfma_f32_16x16x32_bf16 v[240:243], a[152:155], v[96:99], v[240:243]
  v_exp_f32 v54, v54
  v_mfma_f32_16x16x32_bf16 v[240:243], a[156:159], v[112:115], v[240:243]
  buffer_load_dwordx4 v5, s[28:31], s66 offen offset:1024 sc1 lds
  v_mfma_f32_16x16x32_bf16 v[244:247], a[152:155], v[100:103], v[244:247]
  v_exp_f32 v55, v55
  v_mfma_f32_16x16x32_bf16 v[244:247], a[156:159], v[116:119], v[244:247]
  ds_read_b128 a[132:135], v2 offset:33792
  v_cvt_pk_bf16_f32 v87, v54, v55
  v_mfma_f32_16x16x32_bf16 a[176:179], a[160:163], v[108:111], a[176:179]
  buffer_load_dwordx4 v5, s[28:31], s66 offen offset:2048 sc1 lds
  v_mfma_f32_16x16x32_bf16 a[176:179], a[160:163], v[124:127], a[176:179]
  v_mfma_f32_16x16x32_bf16 v[60:63], a[112:115], a[12:15], v[44:47]
  v_exp_f32 v56, v56
  v_mfma_f32_16x16x32_bf16 v[60:63], a[116:119], a[28:31], v[60:63]
  buffer_load_dwordx4 v5, s[28:31], s66 offen offset:3072 sc1 lds
  v_mfma_f32_16x16x32_bf16 v[60:63], a[120:123], a[44:47], v[60:63]
  v_exp_f32 v57, v57
  v_mfma_f32_16x16x32_bf16 v[60:63], a[124:127], a[60:63], v[60:63]
  ds_read_b128 a[136:139], v2 offset:34816
  v_cvt_pk_bf16_f32 v90, v56, v57
  v_mfma_f32_16x16x32_bf16 v[248:251], a[152:155], v[104:107], v[248:251]
  v_exp_f32 v58, v58
  v_mfma_f32_16x16x32_bf16 v[248:251], a[156:159], v[120:123], v[248:251]
  s_waitcnt vmcnt(8)
  buffer_atomic_add v20, v16, s[28:31], s9 offen
  v_mfma_f32_16x16x32_bf16 v[252:255], a[152:155], v[108:111], v[252:255]
  s_add_u32 s61, s61, 1
  v_exp_f32 v59, v59
  v_mfma_f32_16x16x32_bf16 v[252:255], a[156:159], v[124:127], v[252:255]
  s_waitcnt lgkmcnt(1)
  s_cmp_eq_u32 s61, s58
  ds_read_b128 a[140:143], v2 offset:35840
  v_cvt_pk_bf16_f32 v91, v58, v59
  s_cbranch_scc1 L_pv0
.p2align 6
L_even:
  v_mfma_f32_16x16x32_bf16 v[48:51], a[64:67], a[0:3], v[32:35]
  v_exp_f32 v60, v60
  v_mfma_f32_16x16x32_bf16 v[48:51], a[68:71], a[16:19], v[48:51]
  v_mfma_f32_16x16x32_bf16 v[48:51], a[72:75], a[32:35], v[48:51]
  v_exp_f32 v61, v61
  v_mfma_f32_16x16x32_bf16 v[48:51], a[76:79], a[48:51], v[48:51]
  ds_read_b128 a[80:83], v1 offset:36864
  v_cvt_pk_bf16_f32 v94, v60, v61
  v_mfma_f32_16x16x32_bf16 v[128:131], a[128:131], v[64:67], v[128:131]
  s_lshl_b32 s67, s70, 15
  v_exp_f32 v62, v62
  v_mfma_f32_16x16x32_bf16 v[128:131], a[132:135], v[80:83], v[128:131]
  s_add_u32 s67, s67, s65
  v_mfma_f32_16x16x32_bf16 v[132:135], a[128:131], v[68:71], v[132:135]
  s_add_u32 m0, s56, 65536
  v_exp_f32 v63, v63
  v_mfma_f32_16x16x32_bf16 v[132:135], a[132:135], v[84:87], v[132:135]
  ds_read_b128 a[84:87], v1 offset:37888
  v_cvt_pk_bf16_f32 v95, v62, v63
  v_mfma_f32_16x16x32_bf16 v[52:55], a[64:67], a[4:7], v[36:39]
  v_exp_f32 v48, v48
  v_mfma_f32_16x16x32_bf16 v[52:55], a[68:71], a[20:23], v[52:55]
  buffer_load_dwordx4 v5, s[28:31], s67 offen offset:0 sc1 lds
  v_mfma_f32_16x16x32_bf16 v[52:55], a[72:75], a[36:39], v[52:55]
  v_exp_f32 v49, v49
  v_mfma_f32_16x16x32_bf16 v[52:55], a[76:79], a[52:55], v[52:55]
  ds_read_b128 a[88:91], v1 offset:38912
  v_cvt_pk_bf16_f32 v96, v48, v49
  v_mfma_f32_16x16x32_bf16 v[136:139], a[128:131], v[72:75], v[136:139]
  v_exp_f32 v50, v50
  v_mfma_f32_16x16x32_bf16 v[136:139], a[132:135], v[88:91], v[136:139]
  v_mfma_f32_16x16x32_bf16 v[140:143], a[128:131], v[76:79], v[140:143]
  v_exp_f32 v51, v51
  v_mfma_f32_16x16x32_bf16 v[140:143], a[132:135], v[92:95], v[140:143]
  ds_read_b128 a[92:95], v1 offset:39936
  v_cvt_pk_bf16_f32 v97, v50, v51
  v_mfma_f32_16x16x32_bf16 v[56:59], a[64:67], a[8:11], v[40:43]
  v_exp_f32 v52, v52
  v_mfma_f32_16x16x32_bf16 v[56:59], a[68:71], a[24:27], v[56:59]
  buffer_load_dwordx4 v5, s[28:31], s67 offen offset:1024 sc1 lds
  v_mfma_f32_16x16x32_bf16 v[56:59], a[72:75], a[40:43], v[56:59]
  s_waitcnt lgkmcnt(4)
  v_exp_f32 v53, v53
  v_mfma_f32_16x16x32_bf16 v[56:59], a[76:79], a[56:59], v[56:59]
  ds_read_b128 a[144:147], v2 offset:36864
  v_cvt_pk_bf16_f32 v100, v52, v53
  v_mfma_f32_16x16x32_bf16 v[144:147], a[136:139], v[64:67], v[144:147]
  v_exp_f32 v54, v54
  v_mfma_f32_16x16x32_bf16 v[144:147], a[140:143], v[80:83], v[144:147]
  v_mfma_f32_16x16x32_bf16 v[148:151], a[136:139], v[68:71], v[148:151]
  v_exp_f32 v55, v55
  v_mfma_f32_16x16x32_bf16 v[148:151], a[140:143], v[84:87], v[148:151]
  ds_read_b128 a[148:151], v2 offset:37888
  v_cvt_pk_bf16_f32 v101, v54, v55
  v_mfma_f32_16x16x32_bf16 a[164:167], a[160:163], v[64:67], a[164:167]
  buffer_load_dwordx4 v5, s[28:31], s67 offen offset:2048 sc1 lds
  v_mfma_f32_16x16x32_bf16 a[164:167], a[160:163], v[80:83], a[164:167]
  v_mfma_f32_16x16x32_bf16 v[60:63], a[64:67], a[12:15], v[44:47]
  v_exp_f32 v56, v56
  v_mfma_f32_16x16x32_bf16 v[60:63], a[68:71], a[28:31], v[60:63]
  v_mfma_f32_16x16x32_bf16 v[60:63], a[72:75], a[44:47], v[60:63]
  v_exp_f32 v57, v57
  v_mfma_f32_16x16x32_bf16 v[60:63], a[76:79], a[60:63], v[60:63]
  ds_read_b128 a[152:155], v2 offset:38912
  v_cvt_pk_bf16_f32 v104, v56, v57
  v_mfma_f32_16x16x32_bf16 v[152:155], a[136:139], v[72:75], v[152:155]
  v_exp_f32 v58, v58
  v_mfma_f32_16x16x32_bf16 v[152:155], a[140:143], v[88:91], v[152:155]
  buffer_load_dwordx4 v5, s[28:31], s67 offen offset:3072 sc1 lds
  v_mfma_f32_16x16x32_bf16 v[156:159], a[136:139], v[76:79], v[156:159]
  v_exp_f32 v59, v59
  v_mfma_f32_16x16x32_bf16 v[156:159], a[140:143], v[92:95], v[156:159]
  s_waitcnt lgkmcnt(1)
  ds_read_b128 a[156:159], v2 offset:39936
  v_cvt_pk_bf16_f32 v105, v58, v59
  v_mfma_f32_16x16x32_bf16 v[48:51], a[80:83], a[0:3], v[32:35]
  v_exp_f32 v60, v60
  v_mfma_f32_16x16x32_bf16 v[48:51], a[84:87], a[16:19], v[48:51]
  v_mfma_f32_16x16x32_bf16 v[48:51], a[88:91], a[32:35], v[48:51]
  v_exp_f32 v61, v61
  v_mfma_f32_16x16x32_bf16 v[48:51], a[92:95], a[48:51], v[48:51]
  s_add_u32 m0, s56, 69632
  ds_read_b128 a[96:99], v1 offset:40960
  v_cvt_pk_bf16_f32 v108, v60, v61
  v_mfma_f32_16x16x32_bf16 v[160:163], a[144:147], v[64:67], v[160:163]
  s_add_u32 s67, s67, 4096
  v_exp_f32 v62, v62
  v_mfma_f32_16x16x32_bf16 v[160:163], a[148:151], v[80:83], v[160:163]
  buffer_load_dwordx4 v5, s[28:31], s67 offen offset:0 sc1 lds
  v_mfma_f32_16x16x32_bf16 v[164:167], a[144:147], v[68:71], v[164:167]
  v_exp_f32 v63, v63
  v_mfma_f32_16x16x32_bf16 v[164:167], a[148:151], v[84:87], v[164:167]
  ds_read_b128 a[100:103], v1 offset:41984
  v_cvt_pk_bf16_f32 v109, v62, v63
  v_mfma_f32_16x16x32_bf16 v[52:55], a[80:83], a[4:7], v[36:39]
  v_exp_f32 v48, v48
  v_mfma_f32_16x16x32_bf16 v[52:55], a[84:87], a[20:23], v[52:55]
  v_mfma_f32_16x16x32_bf16 v[52:55], a[88:91], a[36:39], v[52:55]
  v_exp_f32 v49, v49
  v_mfma_f32_16x16x32_bf16 v[52:55], a[92:95], a[52:55], v[52:55]
  ds_read_b128 a[104:107], v1 offset:43008
  v_cvt_pk_bf16_f32 v98, v48, v49
  v_mfma_f32_16x16x32_bf16 v[168:171], a[144:147], v[72:75], v[168:171]
  v_exp_f32 v50, v50
  v_mfma_f32_16x16x32_bf16 v[168:171], a[148:151], v[88:91], v[168:171]
  buffer_load_dwordx4 v5, s[28:31], s67 offen offset:1024 sc1 lds
  v_mfma_f32_16x16x32_bf16 v[172:175], a[144:147], v[76:79], v[172:175]
  v_exp_f32 v51, v51
  v_mfma_f32_16x16x32_bf16 v[172:175], a[148:151], v[92:95], v[172:175]
  ds_read_b128 a[108:111], v1 offset:44032
  v_cvt_pk_bf16_f32 v99, v50, v51
  v_mfma_f32_16x16x32_bf16 v[56:59], a[80:83], a[8:11], v[40:43]
  v_exp_f32 v52, v52
  v_mfma_f32_16x16x32_bf16 v[56:59], a[84:87], a[24:27], v[56:59]
  v_mfma_f32_16x16x32_bf16 v[56:59], a[88:91], a[40:43], v[56:59]
  s_waitcnt lgkmcnt(4)
  v_exp_f32 v53, v53
  v_mfma_f32_16x16x32_bf16 v[56:59], a[92:95], a[56:59], v[56:59]
  ds_read_b128 a[128:131], v2 offset:40960
  v_cvt_pk_bf16_f32 v102, v52, v53
  v_mfma_f32_16x16x32_bf16 v[176:179], a[152:155], v[64:67], v[176:179]
  v_exp_f32 v54, v54
  v_mfma_f32_16x16x32_bf16 v[176:179], a[156:159], v[80:83], v[176:179]
  buffer_load_dwordx4 v5, s[28:31], s67 offen offset:2048 sc1 lds
  v_mfma_f32_16x16x32_bf16 v[180:183], a[152:155], v[68:71], v[180:183]
  v_exp_f32 v55, v55
  v_mfma_f32_16x16x32_bf16 v[180:183], a[156:159], v[84:87], v[180:183]
  ds_read_b128 a[132:135], v2 offset:41984
  v_cvt_pk_bf16_f32 v103, v54, v55
  v_mfma_f32_16x16x32_bf16 a[168:171], a[160:163], v[68:71], a[168:171]
  v_mfma_f32_16x16x32_bf16 a[168:171], a[160:163], v[84:87], a[168:171]
  v_mfma_f32_16x16x32_bf16 v[60:63], a[80:83], a[12:15], v[44:47]
  v_exp_f32 v56, v56
  v_mfma_f32_16x16x32_bf16 v[60:63], a[84:87], a[28:31], v[60:63]
  buffer_load_dwordx4 v5, s[28:31], s67 offen offset:3072 sc1 lds
  v_mfma_f32_16x16x32_bf16 v[60:63], a[88:91], a[44:47], v[60:63]
  v_exp_f32 v57, v57
  v_mfma_f32_16x16x32_bf16 v[60:63], a[92:95], a[60:63], v[60:63]
  ds_read_b128 a[136:139], v2 offset:43008
  v_cvt_pk_bf16_f32 v106, v56, v57
  v_mfma_f32_16x16x32_bf16 v[184:187], a[152:155], v[72:75], v[184:187]
  v_exp_f32 v58, v58
  v_mfma_f32_16x16x32_bf16 v[184:187], a[156:159], v[88:91], v[184:187]
  v_mfma_f32_16x16x32_bf16 v[188:191], a[152:155], v[76:79], v[188:191]
  v_exp_f32 v59, v59
  v_mfma_f32_16x16x32_bf16 v[188:191], a[156:159], v[92:95], v[188:191]
  s_waitcnt lgkmcnt(1)
  ds_read_b128 a[140:143], v2 offset:44032
  v_cvt_pk_bf16_f32 v107, v58, v59
  v_mfma_f32_16x16x32_bf16 v[48:51], a[96:99], a[0:3], v[32:35]
  v_exp_f32 v60, v60
  v_mfma_f32_16x16x32_bf16 v[48:51], a[100:103], a[16:19], v[48:51]
  ds_read_b128 a[112:115], v1 offset:45056
  v_mfma_f32_16x16x32_bf16 v[48:51], a[104:107], a[32:35], v[48:51]
  v_exp_f32 v61, v61
  v_mfma_f32_16x16x32_bf16 v[48:51], a[108:111], a[48:51], v[48:51]
  ds_read_b128 a[116:119], v1 offset:46080
  v_cvt_pk_bf16_f32 v110, v60, v61
  v_mfma_f32_16x16x32_bf16 v[192:195], a[128:131], v[64:67], v[192:195]
  v_exp_f32 v62, v62
  v_mfma_f32_16x16x32_bf16 v[192:195], a[132:135], v[80:83], v[192:195]
  v_mfma_f32_16x16x32_bf16 v[196:199], a[128:131], v[68:71], v[196:199]
  v_exp_f32 v63, v63
  v_mfma_f32_16x16x32_bf16 v[196:199], a[132:135], v[84:87], v[196:199]
  ds_read_b128 a[120:123], v1 offset:47104
  v_cvt_pk_bf16_f32 v111, v62, v63
  v_mfma_f32_16x16x32_bf16 v[52:55], a[96:99], a[4:7], v[36:39]
  v_exp_f32 v48, v48
  v_mfma_f32_16x16x32_bf16 v[52:55], a[100:103], a[20:23], v[52:55]
  ds_read_b128 a[124:127], v1 offset:48128
  v_mfma_f32_16x16x32_bf16 v[52:55], a[104:107], a[36:39], v[52:55]
  v_exp_f32 v49, v49
  v_mfma_f32_16x16x32_bf16 v[52:55], a[108:111], a[52:55], v[52:55]
  ds_read_b128 a[144:147], v2 offset:45056
  v_cvt_pk_bf16_f32 v112, v48, v49
  v_mfma_f32_16x16x32_bf16 v[200:203], a[128:131], v[72:75], v[200:203]
  v_exp_f32 v50, v50
  v_mfma_f32_16x16x32_bf16 v[200:203], a[132:135], v[88:91], v[200:203]
  v_mfma_f32_16x16x32_bf16 v[204:207], a[128:131], v[76:79], v[204:207]
  v_exp_f32 v51, v51
  v_mfma_f32_16x16x32_bf16 v[204:207], a[132:135], v[92:95], v[204:207]
  ds_read_b128 a[148:151], v2 offset:46080
  v_cvt_pk_bf16_f32 v113, v50, v51
  v_mfma_f32_16x16x32_bf16 v[56:59], a[96:99], a[8:11], v[40:43]
  v_exp_f32 v52, v52
  v_mfma_f32_16x16x32_bf16 v[56:59], a[100:103], a[24:27], v[56:59]
  ds_read_b128 a[152:155], v2 offset:47104
  v_mfma_f32_16x16x32_bf16 v[56:59], a[104:107], a[40:43], v[56:59]
  s_waitcnt lgkmcnt(7)
  s_mov_b32 s70, s62
  v_exp_f32 v53, v53
  v_mfma_f32_16x16x32_bf16 v[56:59], a[108:111], a[56:59], v[56:59]
  s_mov_b32 s62, s60
  ds_read_b128 a[156:159], v2 offset:48128
  v_cvt_pk_bf16_f32 v116, v52, v53
  v_mfma_f32_16x16x32_bf16 v[208:211], a[136:139], v[64:67], v[208:211]
  s_lshl_b32 s66, s60, 15
  v_exp_f32 v54, v54
  v_mfma_f32_16x16x32_bf16 v[208:211], a[140:143], v[80:83], v[208:211]
  s_add_u32 s66, s66, s64
  v_mfma_f32_16x16x32_bf16 v[212:215], a[136:139], v[68:71], v[212:215]
  s_add_u32 s60, s60, 1
  v_exp_f32 v55, v55
  v_mfma_f32_16x16x32_bf16 v[212:215], a[140:143], v[84:87], v[212:215]
  s_cmp_eq_u32 s60, s57
  s_addc_u32 s60, s60, 0
  v_cvt_pk_bf16_f32 v117, v54, v55
  v_mfma_f32_16x16x32_bf16 a[172:175], a[160:163], v[72:75], a[172:175]
  s_add_u32 s52, s61, 2
  v_mfma_f32_16x16x32_bf16 a[172:175], a[160:163], v[88:91], a[172:175]
  s_cmp_gt_u32 s58, s52
  s_cselect_b32 s66, s66, s78
  v_mfma_f32_16x16x32_bf16 v[60:63], a[96:99], a[12:15], v[44:47]
  s_cmp_gt_u32 s58, s52
  s_cselect_b32 s80, s56, s77
  v_exp_f32 v56, v56
  v_mfma_f32_16x16x32_bf16 v[60:63], a[100:103], a[28:31], v[60:63]
  v_mfma_f32_16x16x32_bf16 v[60:63], a[104:107], a[44:47], v[60:63]
  v_exp_f32 v57, v57
  v_mfma_f32_16x16x32_bf16 v[60:63], a[108:111], a[60:63], v[60:63]
  v_cvt_pk_bf16_f32 v120, v56, v57
  v_mfma_f32_16x16x32_bf16 v[216:219], a[136:139], v[72:75], v[216:219]
  v_exp_f32 v58, v58
  v_mfma_f32_16x16x32_bf16 v[216:219], a[140:143], v[88:91], v[216:219]
  s_waitcnt vmcnt(0) lgkmcnt(0)
  s_barrier
  v_mfma_f32_16x16x32_bf16 v[220:223], a[136:139], v[76:79], v[220:223]
  s_add_u32 m0, s80, 32768
  v_exp_f32 v59, v59
  v_mfma_f32_16x16x32_bf16 v[220:223], a[140:143], v[92:95], v[220:223]
  v_cvt_pk_bf16_f32 v121, v58, v59
  v_mfma_f32_16x16x32_bf16 v[48:51], a[112:115], a[0:3], v[32:35]
  v_exp_f32 v60, v60
  v_mfma_f32_16x16x32_bf16 v[48:51], a[116:119], a[16:19], v[48:51]
  buffer_load_dwordx4 v5, s[28:31], s66 offen offset:0 sc1 lds
  v_mfma_f32_16x16x32_bf16 v[48:51], a[120:123], a[32:35], v[48:51]
  v_exp_f32 v61, v61
  v_mfma_f32_16x16x32_bf16 v[48:51], a[124:127], a[48:51], v[48:51]
  ds_read_b128 a[64:67], v1 offset:0
  v_cvt_pk_bf16_f32 v124, v60, v61
  v_mfma_f32_16x16x32_bf16 v[224:227], a[144:147], v[64:67], v[224:227]
  v_exp_f32 v62, v62
  v_mfma_f32_16x16x32_bf16 v[224:227], a[148:151], v[80:83], v[224:227]
  buffer_load_dwordx4 v5, s[28:31], s66 offen offset:1024 sc1 lds
  v_mfma_f32_16x16x32_bf16 v[228:231], a[144:147], v[68:71], v[228:231]
  v_exp_f32 v63, v63
  v_mfma_f32_16x16x32_bf16 v[228:231], a[148:151], v[84:87], v[228:231]
  ds_read_b128 a[68:71], v1 offset:1024
  v_cvt_pk_bf16_f32 v125, v62, v63
  v_mfma_f32_16x16x32_bf16 v[52:55], a[112:115], a[4:7], v[36:39]
  v_exp_f32 v48, v48
  v_mfma_f32_16x16x32_bf16 v[52:55], a[116:119], a[20:23], v[52:55]
  buffer_load_dwordx4 v5, s[28:31], s66 offen offset:2048 sc1 lds
  v_mfma_f32_16x16x32_bf16 v[52:55], a[120:123], a[36:39], v[52:55]
  v_exp_f32 v49, v49
  v_mfma_f32_16x16x32_bf16 v[52:55], a[124:127], a[52:55], v[52:55]
  ds_read_b128 a[72:75], v1 offset:2048
  v_cvt_pk_bf16_f32 v114, v48, v49
  v_mfma_f32_16x16x32_bf16 v[232:235], a[144:147], v[72:75], v[232:235]
  v_exp_f32 v50, v50
  v_mfma_f32_16x16x32_bf16 v[232:235], a[148:151], v[88:91], v[232:235]
  buffer_load_dwordx4 v5, s[28:31], s66 offen offset:3072 sc1 lds
  v_mfma_f32_16x16x32_bf16 v[236:239], a[144:147], v[76:79], v[236:239]
  v_exp_f32 v51, v51
  v_mfma_f32_16x16x32_bf16 v[236:239], a[148:151], v[92:95], v[236:239]
  s_add_u32 m0, s80, 36864
  ds_read_b128 a[76:79], v1 offset:3072
  v_cvt_pk_bf16_f32 v115, v50, v51
  v_mfma_f32_16x16x32_bf16 v[56:59], a[112:115], a[8:11], v[40:43]
  s_add_u32 s66, s66, 4096
  v_exp_f32 v52, v52
  v_mfma_f32_16x16x32_bf16 v[56:59], a[116:119], a[24:27], v[56:59]
  buffer_load_dwordx4 v5, s[28:31], s66 offen offset:0 sc1 lds
  v_mfma_f32_16x16x32_bf16 v[56:59], a[120:123], a[40:43], v[56:59]
  v_exp_f32 v53, v53
  v_mfma_f32_16x16x32_bf16 v[56:59], a[124:127], a[56:59], v[56:59]
  ds_read_b128 a[128:131], v2 offset:0
  v_cvt_pk_bf16_f32 v118, v52, v53
  v_mfma_f32_16x16x32_bf16 v[240:243], a[152:155], v[64:67], v[240:243]
  v_exp_f32 v54, v54
  v_mfma_f32_16x16x32_bf16 v[240:243], a[156:159], v[80:83], v[240:243]
  buffer_load_dwordx4 v5, s[28:31], s66 offen offset:1024 sc1 lds
  v_mfma_f32_16x16x32_bf16 v[244:247], a[152:155], v[68:71], v[244:247]
  v_exp_f32 v55, v55
  v_mfma_f32_16x16x32_bf16 v[244:247], a[156:159], v[84:87], v[244:247]
  ds_read_b128 a[132:135], v2 offset:1024
  v_cvt_pk_bf16_f32 v119, v54, v55
  v_mfma_f32_16x16x32_bf16 a[176:179], a[160:163], v[76:79], a[176:179]
  buffer_load_dwordx4 v5, s[28:31], s66 offen offset:2048 sc1 lds
  v_mfma_f32_16x16x32_bf16 a[176:179], a[160:163], v[92:95], a[176:179]
  v_mfma_f32_16x16x32_bf16 v[60:63], a[112:115], a[12:15], v[44:47]
  v_exp_f32 v56, v56
  v_mfma_f32_16x16x32_bf16 v[60:63], a[116:119], a[28:31], v[60:63]
  buffer_load_dwordx4 v5, s[28:31], s66 offen offset:3072 sc1 lds
  v_mfma_f32_16x16x32_bf16 v[60:63], a[120:123], a[44:47], v[60:63]
  v_exp_f32 v57, v57
  v_mfma_f32_16x16x32_bf16 v[60:63], a[124:127], a[60:63], v[60:63]
  ds_read_b128 a[136:139], v2 offset:2048
  v_cvt_pk_bf16_f32 v122, v56, v57
  v_mfma_f32_16x16x32_bf16 v[248:251], a[152:155], v[72:75], v[248:251]
  v_exp_f32 v58, v58
  v_mfma_f32_16x16x32_bf16 v[248:251], a[156:159], v[88:91], v[248:251]
  v_mfma_f32_16x16x32_bf16 v[252:255], a[152:155], v[76:79], v[252:255]
  s_add_u32 s61, s61, 1
  v_exp_f32 v59, v59
  v_mfma_f32_16x16x32_bf16 v[252:255], a[156:159], v[92:95], v[252:255]
  s_waitcnt lgkmcnt(1)
  s_cmp_eq_u32 s61, s58
  ds_read_b128 a[140:143], v2 offset:3072
  v_cvt_pk_bf16_f32 v123, v58, v59
  s_cbranch_scc1 L_pv1
L_odd:
  v_mfma_f32_16x16x32_bf16 v[48:51], a[64:67], a[0:3], v[32:35]
  v_exp_f32 v60, v60
  v_mfma_f32_16x16x32_bf16 v[48:51], a[68:71], a[16:19], v[48:51]
  v_mfma_f32_16x16x32_bf16 v[48:51], a[72:75], a[32:35], v[48:51]
  v_exp_f32 v61, v61
  v_mfma_f32_16x16x32_bf16 v[48:51], a[76:79], a[48:51], v[48:51]
  ds_read_b128 a[80:83], v1 offset:4096
  v_cvt_pk_bf16_f32 v126, v60, v61
  v_mfma_f32_16x16x32_bf16 v[128:131], a[128:131], v[96:99], v[128:131]
  s_lshl_b32 s67, s70, 15
  v_exp_f32 v62, v62
  v_mfma_f32_16x16x32_bf16 v[128:131], a[132:135], v[112:115], v[128:131]
  s_add_u32 s67, s67, s65
  v_mfma_f32_16x16x32_bf16 v[132:135], a[128:131], v[100:103], v[132:135]
  s_add_u32 m0, s56, 98304
  v_exp_f32 v63, v63
  v_mfma_f32_16x16x32_bf16 v[132:135], a[132:135], v[116:119], v[132:135]
  ds_read_b128 a[84:87], v1 offset:5120
  v_cvt_pk_bf16_f32 v127, v62, v63
  v_mfma_f32_16x16x32_bf16 v[52:55], a[64:67], a[4:7], v[36:39]
  v_exp_f32 v48, v48
  v_mfma_f32_16x16x32_bf16 v[52:55], a[68:71], a[20:23], v[52:55]
  buffer_load_dwordx4 v5, s[28:31], s67 offen offset:0 sc1 lds
  v_mfma_f32_16x16x32_bf16 v[52:55], a[72:75], a[36:39], v[52:55]
  v_exp_f32 v49, v49
  v_mfma_f32_16x16x32_bf16 v[52:55], a[76:79], a[52:55], v[52:55]
  ds_read_b128 a[88:91], v1 offset:6144
  v_cvt_pk_bf16_f32 v64, v48, v49
  v_mfma_f32_16x16x32_bf16 v[136:139], a[128:131], v[104:107], v[136:139]
  v_exp_f32 v50, v50
  v_mfma_f32_16x16x32_bf16 v[136:139], a[132:135], v[120:123], v[136:139]
  v_mfma_f32_16x16x32_bf16 v[140:143], a[128:131], v[108:111], v[140:143]
  v_exp_f32 v51, v51
  v_mfma_f32_16x16x32_bf16 v[140:143], a[132:135], v[124:127], v[140:143]
  ds_read_b128 a[92:95], v1 offset:7168
  v_cvt_pk_bf16_f32 v65, v50, v51
  v_mfma_f32_16x16x32_bf16 v[56:59], a[64:67], a[8:11], v[40:43]
  v_exp_f32 v52, v52
  v_mfma_f32_16x16x32_bf16 v[56:59], a[68:71], a[24:27], v[56:59]
  buffer_load_dwordx4 v5, s[28:31], s67 offen offset:1024 sc1 lds
  v_mfma_f32_16x16x32_bf16 v[56:59], a[72:75], a[40:43], v[56:59]
  s_waitcnt lgkmcnt(4)
  v_exp_f32 v53, v53
  v_mfma_f32_16x16x32_bf16 v[56:59], a[76:79], a[56:59], v[56:59]
  ds_read_b128 a[144:147], v2 offset:4096
  v_cvt_pk_bf16_f32 v68, v52, v53
  v_mfma_f32_16x16x32_bf16 v[144:147], a[136:139], v[96:99], v[144:147]
  v_exp_f32 v54, v54
  v_mfma_f32_16x16x32_bf16 v[144:147], a[140:143], v[112:115], v[144:147]
  v_mfma_f32_16x16x32_bf16 v[148:151], a[136:139], v[100:103], v[148:151]
  v_exp_f32 v55, v55
  v_mfma_f32_16x16x32_bf16 v[148:151], a[140:143], v[116:119], v[148:151]
  ds_read_b128 a[148:151], v2 offset:5120
  v_cvt_pk_bf16_f32 v69, v54, v55
  v_mfma_f32_16x16x32_bf16 a[164:167], a[160:163], v[96:99], a[164:167]
  buffer_load_dwordx4 v5, s[28:31], s67 offen offset:2048 sc1 lds
  v_mfma_f32_16x16x32_bf16 a[164:167], a[160:163], v[112:115], a[164:167]
  v_mfma_f32_16x16x32_bf16 v[60:63], a[64:67], a[12:15], v[44:47]
  v_exp_f32 v56, v56
  v_mfma_f32_16x16x32_bf16 v[60:63], a[68:71], a[28:31], v[60:63]
  v_mfma_f32_16x16x32_bf16 v[60:63], a[72:75], a[44:47], v[60:63]
  v_exp_f32 v57, v57
  v_mfma_f32_16x16x32_bf16 v[60:63], a[76:79], a[60:63], v[60:63]
  ds_read_b128 a[152:155], v2 offset:6144
  v_cvt_pk_bf16_f32 v72, v56, v57
  v_mfma_f32_16x16x32_bf16 v[152:155], a[136:139], v[104:107], v[152:155]
  v_exp_f32 v58, v58
  v_mfma_f32_16x16x32_bf16 v[152:155], a[140:143], v[120:123], v[152:155]
  buffer_load_dwordx4 v5, s[28:31], s67 offen offset:3072 sc1 lds
  v_mfma_f32_16x16x32_bf16 v[156:159], a[136:139], v[108:111], v[156:159]
  v_exp_f32 v59, v59
  v_mfma_f32_16x16x32_bf16 v[156:159], a[140:143], v[124:127], v[156:159]
  s_waitcnt lgkmcnt(1)
  ds_read_b128 a[156:159], v2 offset:7168
  v_cvt_pk_bf16_f32 v73, v58, v59
  v_mfma_f32_16x16x32_bf16 v[48:51], a[80:83], a[0:3], v[32:35]
  v_exp_f32 v60, v60
  v_mfma_f32_16x16x32_bf16 v[48:51], a[84:87], a[16:19], v[48:51]
  v_mfma_f32_16x16x32_bf16 v[48:51], a[88:91], a[32:35], v[48:51]
  v_exp_f32 v61, v61
  v_mfma_f32_16x16x32_bf16 v[48:51], a[92:95], a[48:51], v[48:51]
  s_add_u32 m0, s56, 102400
  ds_read_b128 a[96:99], v1 offset:8192
  v_cvt_pk_bf16_f32 v76, v60, v61
  v_mfma_f32_16x16x32_bf16 v[160:163], a[144:147], v[96:99], v[160:163]
  s_add_u32 s67, s67, 4096
  v_exp_f32 v62, v62
  v_mfma_f32_16x16x32_bf16 v[160:163], a[148:151], v[112:115], v[160:163]
  buffer_load_dwordx4 v5, s[28:31], s67 offen offset:0 sc1 lds
  v_mfma_f32_16x16x32_bf16 v[164:167], a[144:147], v[100:103], v[164:167]
  v_exp_f32 v63, v63
  v_mfma_f32_16x16x32_bf16 v[164:167], a[148:151], v[116:119], v[164:167]
  ds_read_b128 a[100:103], v1 offset:9216
  v_cvt_pk_bf16_f32 v77, v62, v63
  v_mfma_f32_16x16x32_bf16 v[52:55], a[80:83], a[4:7], v[36:39]
  v_exp_f32 v48, v48
  v_mfma_f32_16x16x32_bf16 v[52:55], a[84:87], a[20:23], v[52:55]
  v_mfma_f32_16x16x32_bf16 v[52:55], a[88:91], a[36:39], v[52:55]
  v_exp_f32 v49, v49
  v_mfma_f32_16x16x32_bf16 v[52:55], a[92:95], a[52:55], v[52:55]
  ds_read_b128 a[104:107], v1 offset:10240
  v_cvt_pk_bf16_f32 v66, v48, v49
  v_mfma_f32_16x16x32_bf16 v[168:171], a[144:147], v[104:107], v[168:171]
  v_exp_f32 v50, v50
  v_mfma_f32_16x16x32_bf16 v[168:171], a[148:151], v[120:123], v[168:171]
  buffer_load_dwordx4 v5, s[28:31], s67 offen offset:1024 sc1 lds
  v_mfma_f32_16x16x32_bf16 v[172:175], a[144:147], v[108:111], v[172:175]
HS15:
  s_cbranch_execz HS26
  v_exp_f32 v51, v51
  v_mfma_f32_16x16x32_bf16 v[172:175], a[148:151], v[124:127], v[172:175]
  ds_read_b128 a[108:111], v1 offset:11264
  v_cvt_pk_bf16_f32 v67, v50, v51
  v_mfma_f32_16x16x32_bf16 v[56:59], a[80:83], a[8:11], v[40:43]
  v_exp_f32 v52, v52
  v_mfma_f32_16x16x32_bf16 v[56:59], a[84:87], a[24:27], v[56:59]
  v_mfma_f32_16x16x32_bf16 v[56:59], a[88:91], a[40:43], v[56:59]
  s_waitcnt lgkmcnt(4)
  v_exp_f32 v53, v53
  v_mfma_f32_16x16x32_bf16 v[56:59], a[92:95], a[56:59], v[56:59]
  ds_read_b128 a[128:131], v2 offset:8192
  v_cvt_pk_bf16_f32 v70, v52, v53
  v_mfma_f32_16x16x32_bf16 v[176:179], a[152:155], v[96:99], v[176:179]
  v_exp_f32 v54, v54
  v_mfma_f32_16x16x32_bf16 v[176:179], a[156:159], v[112:115], v[176:179]
  buffer_load_dwordx4 v5, s[28:31], s67 offen offset:2048 sc1 lds
  v_mfma_f32_16x16x32_bf16 v[180:183], a[152:155], v[100:103], v[180:183]
  v_exp_f32 v55, v55
  v_mfma_f32_16x16x32_bf16 v[180:183], a[156:159], v[116:119], v[180:183]
  ds_read_b128 a[132:135], v2 offset:9216
  v_cvt_pk_bf16_f32 v71, v54, v55
  v_mfma_f32_16x16x32_bf16 a[168:171], a[160:163], v[100:103], a[168:171]
  v_mfma_f32_16x16x32_bf16 a[168:171], a[160:163], v[116:119], a[168:171]
  v_mfma_f32_16x16x32_bf16 v[60:63], a[80:83], a[12:15], v[44:47]
  v_exp_f32 v56, v56
  v_mfma_f32_16x16x32_bf16 v[60:63], a[84:87], a[28:31], v[60:63]
  buffer_load_dwordx4 v5, s[28:31], s67 offen offset:3072 sc1 lds
  v_mfma_f32_16x16x32_bf16 v[60:63], a[88:91], a[44:47], v[60:63]
  v_exp_f32 v57, v57
  v_mfma_f32_16x16x32_bf16 v[60:63], a[92:95], a[60:63], v[60:63]
  ds_read_b128 a[136:139], v2 offset:10240
  v_cvt_pk_bf16_f32 v74, v56, v57
  v_mfma_f32_16x16x32_bf16 v[184:187], a[152:155], v[104:107], v[184:187]
  v_exp_f32 v58, v58
  v_mfma_f32_16x16x32_bf16 v[184:187], a[156:159], v[120:123], v[184:187]
  v_mfma_f32_16x16x32_bf16 v[188:191], a[152:155], v[108:111], v[188:191]
  v_exp_f32 v59, v59
  v_mfma_f32_16x16x32_bf16 v[188:191], a[156:159], v[124:127], v[188:191]
  s_waitcnt lgkmcnt(1)
  ds_read_b128 a[140:143], v2 offset:11264
  v_cvt_pk_bf16_f32 v75, v58, v59
  v_mfma_f32_16x16x32_bf16 v[48:51], a[96:99], a[0:3], v[32:35]
  v_exp_f32 v60, v60
  v_mfma_f32_16x16x32_bf16 v[48:51], a[100:103], a[16:19], v[48:51]
  ds_read_b128 a[112:115], v1 offset:12288
  v_mfma_f32_16x16x32_bf16 v[48:51], a[104:107], a[32:35], v[48:51]
  v_exp_f32 v61, v61
  v_mfma_f32_16x16x32_bf16 v[48:51], a[108:111], a[48:51], v[48:51]
  ds_read_b128 a[116:119], v1 offset:13312
  v_cvt_pk_bf16_f32 v78, v60, v61
  v_mfma_f32_16x16x32_bf16 v[192:195], a[128:131], v[96:99], v[192:195]
  v_exp_f32 v62, v62
  v_mfma_f32_16x16x32_bf16 v[192:195], a[132:135], v[112:115], v[192:195]
  v_mfma_f32_16x16x32_bf16 v[196:199], a[128:131], v[100:103], v[196:199]
  v_exp_f32 v63, v63
  v_mfma_f32_16x16x32_bf16 v[196:199], a[132:135], v[116:119], v[196:199]
  ds_read_b128 a[120:123], v1 offset:14336
  v_cvt_pk_bf16_f32 v79, v62, v63
  v_mfma_f32_16x16x32_bf16 v[52:55], a[96:99], a[4:7], v[36:39]
  v_exp_f32 v48, v48
  v_mfma_f32_16x16x32_bf16 v[52:55], a[100:103], a[20:23], v[52:55]
  ds_read_b128 a[124:127], v1 offset:15360
  v_mfma_f32_16x16x32_bf16 v[52:55], a[104:107], a[36:39], v[52:55]
  v_exp_f32 v49, v49
  v_mfma_f32_16x16x32_bf16 v[52:55], a[108:111], a[52:55], v[52:55]
  ds_read_b128 a[144:147], v2 offset:12288
  v_cvt_pk_bf16_f32 v80, v48, v49
  v_mfma_f32_16x16x32_bf16 v[200:203], a[128:131], v[104:107], v[200:203]
  v_exp_f32 v50, v50
  v_mfma_f32_16x16x32_bf16 v[200:203], a[132:135], v[120:123], v[200:203]
  v_mfma_f32_16x16x32_bf16 v[204:207], a[128:131], v[108:111], v[204:207]
  v_exp_f32 v51, v51
  v_mfma_f32_16x16x32_bf16 v[204:207], a[132:135], v[124:127], v[204:207]
  ds_read_b128 a[148:151], v2 offset:13312
  v_cvt_pk_bf16_f32 v81, v50, v51
  v_mfma_f32_16x16x32_bf16 v[56:59], a[96:99], a[8:11], v[40:43]
  v_exp_f32 v52, v52
  v_mfma_f32_16x16x32_bf16 v[56:59], a[100:103], a[24:27], v[56:59]
  ds_read_b128 a[152:155], v2 offset:14336
  v_mfma_f32_16x16x32_bf16 v[56:59], a[104:107], a[40:43], v[56:59]
  s_waitcnt lgkmcnt(7)
  s_mov_b32 s70, s62
  v_exp_f32 v53, v53
  v_mfma_f32_16x16x32_bf16 v[56:59], a[108:111], a[56:59], v[56:59]
  s_mov_b32 s62, s60
  ds_read_b128 a[156:159], v2 offset:15360
  v_cvt_pk_bf16_f32 v84, v52, v53
  v_mfma_f32_16x16x32_bf16 v[208:211], a[136:139], v[96:99], v[208:211]
  s_lshl_b32 s66, s60, 15
  v_exp_f32 v54, v54
  v_mfma_f32_16x16x32_bf16 v[208:211], a[140:143], v[112:115], v[208:211]
  s_add_u32 s66, s66, s64
  v_mfma_f32_16x16x32_bf16 v[212:215], a[136:139], v[100:103], v[212:215]
  s_add_u32 s60, s60, 1
  v_exp_f32 v55, v55
  v_mfma_f32_16x16x32_bf16 v[212:215], a[140:143], v[116:119], v[212:215]
  s_cmp_eq_u32 s60, s57
  s_addc_u32 s60, s60, 0
  v_cvt_pk_bf16_f32 v85, v54, v55
  v_mfma_f32_16x16x32_bf16 a[172:175], a[160:163], v[104:107], a[172:175]
  s_add_u32 s52, s61, 2
  v_mfma_f32_16x16x32_bf16 a[172:175], a[160:163], v[120:123], a[172:175]
  s_cmp_gt_u32 s58, s52
  s_cselect_b32 s66, s66, s63
  v_mfma_f32_16x16x32_bf16 v[60:63], a[96:99], a[12:15], v[44:47]
  s_cmp_gt_u32 s58, s52
  s_cselect_b32 s80, s56, s77
  v_exp_f32 v56, v56
  v_mfma_f32_16x16x32_bf16 v[60:63], a[100:103], a[28:31], v[60:63]
  v_mfma_f32_16x16x32_bf16 v[60:63], a[104:107], a[44:47], v[60:63]
  v_exp_f32 v57, v57
  v_mfma_f32_16x16x32_bf16 v[60:63], a[108:111], a[60:63], v[60:63]
  v_cvt_pk_bf16_f32 v88, v56, v57
  v_mfma_f32_16x16x32_bf16 v[216:219], a[136:139], v[104:107], v[216:219]
  v_exp_f32 v58, v58
  v_mfma_f32_16x16x32_bf16 v[216:219], a[140:143], v[120:123], v[216:219]
  s_waitcnt vmcnt(0) lgkmcnt(0)
  s_barrier
  v_mfma_f32_16x16x32_bf16 v[220:223], a[136:139], v[108:111], v[220:223]
  s_add_u32 m0, s80, 0
  v_exp_f32 v59, v59
  v_mfma_f32_16x16x32_bf16 v[220:223], a[140:143], v[124:127], v[220:223]
  v_cvt_pk_bf16_f32 v89, v58, v59
  v_mfma_f32_16x16x32_bf16 v[48:51], a[112:115], a[0:3], v[32:35]
  v_exp_f32 v60, v60
  v_mfma_f32_16x16x32_bf16 v[48:51], a[116:119], a[16:19], v[48:51]
  buffer_load_dwordx4 v5, s[28:31], s66 offen offset:0 sc1 lds
  v_mfma_f32_16x16x32_bf16 v[48:51], a[120:123], a[32:35], v[48:51]
  v_exp_f32 v61, v61
  v_mfma_f32_16x16x32_bf16 v[48:51], a[124:127], a[48:51], v[48:51]
  ds_read_b128 a[64:67], v1 offset:32768
  v_cvt_pk_bf16_f32 v92, v60, v61
  v_mfma_f32_16x16x32_bf16 v[224:227], a[144:147], v[96:99], v[224:227]
  v_exp_f32 v62, v62
  v_mfma_f32_16x16x32_bf16 v[224:227], a[148:151], v[112:115], v[224:227]
  buffer_load_dwordx4 v5, s[28:31], s66 offen offset:1024 sc1 lds
  v_mfma_f32_16x16x32_bf16 v[228:231], a[144:147], v[100:103], v[228:231]
  v_exp_f32 v63, v63
  v_mfma_f32_16x16x32_bf16 v[228:231], a[148:151], v[116:119], v[228:231]
  ds_read_b128 a[68:71], v1 offset:33792
  v_cvt_pk_bf16_f32 v93, v62, v63
  v_mfma_f32_16x16x32_bf16 v[52:55], a[112:115], a[4:7], v[36:39]
  v_exp_f32 v48, v48
  v_mfma_f32_16x16x32_bf16 v[52:55], a[116:119], a[20:23], v[52:55]
  buffer_load_dwordx4 v5, s[28:31], s66 offen offset:2048 sc1 lds
  v_mfma_f32_16x16x32_bf16 v[52:55], a[120:123], a[36:39], v[52:55]
  v_exp_f32 v49, v49
  v_mfma_f32_16x16x32_bf16 v[52:55], a[124:127], a[52:55], v[52:55]
  ds_read_b128 a[72:75], v1 offset:34816
  v_cvt_pk_bf16_f32 v82, v48, v49
  v_mfma_f32_16x16x32_bf16 v[232:235], a[144:147], v[104:107], v[232:235]
  v_exp_f32 v50, v50
  v_mfma_f32_16x16x32_bf16 v[232:235], a[148:151], v[120:123], v[232:235]
  buffer_load_dwordx4 v5, s[28:31], s66 offen offset:3072 sc1 lds
  v_mfma_f32_16x16x32_bf16 v[236:239], a[144:147], v[108:111], v[236:239]
  v_exp_f32 v51, v51
  v_mfma_f32_16x16x32_bf16 v[236:239], a[148:151], v[124:127], v[236:239]
  s_add_u32 m0, s80, 4096
  ds_read_b128 a[76:79], v1 offset:35840
  v_cvt_pk_bf16_f32 v83, v50, v51
  v_mfma_f32_16x16x32_bf16 v[56:59], a[112:115], a[8:11], v[40:43]
  s_add_u32 s66, s66, 4096
  v_exp_f32 v52, v52
  v_mfma_f32_16x16x32_bf16 v[56:59], a[116:119], a[24:27], v[56:59]
  buffer_load_dwordx4 v5, s[28:31], s66 offen offset:0 sc1 lds
  v_mfma_f32_16x16x32_bf16 v[56:59], a[120:123], a[40:43], v[56:59]
  v_exp_f32 v53, v53
  v_mfma_f32_16x16x32_bf16 v[56:59], a[124:127], a[56:59], v[56:59]
  ds_read_b128 a[128:131], v2 offset:32768
  v_cvt_pk_bf16_f32 v86, v52, v53
  v_mfma_f32_16x16x32_bf16 v[240:243], a[152:155], v[96:99], v[240:243]
  v_exp_f32 v54, v54
  v_mfma_f32_16x16x32_bf16 v[240:243], a[156:159], v[112:115], v[240:243]
  buffer_load_dwordx4 v5, s[28:31], s66 offen offset:1024 sc1 lds
  v_mfma_f32_16x16x32_bf16 v[244:247], a[152:155], v[100:103], v[244:247]
  v_exp_f32 v55, v55
  v_mfma_f32_16x16x32_bf16 v[244:247], a[156:159], v[116:119], v[244:247]
  ds_read_b128 a[132:135], v2 offset:33792
  v_cvt_pk_bf16_f32 v87, v54, v55
  v_mfma_f32_16x16x32_bf16 a[176:179], a[160:163], v[108:111], a[176:179]
  buffer_load_dwordx4 v5, s[28:31], s66 offen offset:2048 sc1 lds
  v_mfma_f32_16x16x32_bf16 a[176:179], a[160:163], v[124:127], a[176:179]
  v_mfma_f32_16x16x32_bf16 v[60:63], a[112:115], a[12:15], v[44:47]
  v_exp_f32 v56, v56
  v_mfma_f32_16x16x32_bf16 v[60:63], a[116:119], a[28:31], v[60:63]
  buffer_load_dwordx4 v5, s[28:31], s66 offen offset:3072 sc1 lds
  v_mfma_f32_16x16x32_bf16 v[60:63], a[120:123], a[44:47], v[60:63]
  v_exp_f32 v57, v57
  v_mfma_f32_16x16x32_bf16 v[60:63], a[124:127], a[60:63], v[60:63]
  ds_read_b128 a[136:139], v2 offset:34816
  v_cvt_pk_bf16_f32 v90, v56, v57
  v_mfma_f32_16x16x32_bf16 v[248:251], a[152:155], v[104:107], v[248:251]
  v_exp_f32 v58, v58
  v_mfma_f32_16x16x32_bf16 v[248:251], a[156:159], v[120:123], v[248:251]
  v_mfma_f32_16x16x32_bf16 v[252:255], a[152:155], v[108:111], v[252:255]
  s_add_u32 s61, s61, 1
  v_exp_f32 v59, v59
  v_mfma_f32_16x16x32_bf16 v[252:255], a[156:159], v[124:127], v[252:255]
  s_waitcnt lgkmcnt(1)
  s_cmp_eq_u32 s61, s58
  ds_read_b128 a[140:143], v2 offset:35840
  v_cvt_pk_bf16_f32 v91, v58, v59
  s_cbranch_scc0 L_even
  s_branch L_pv0
L_g0:
HS16:
  s_cbranch_execz HS21
  s_and_b32 s10, s2, 3
  s_lshl_b32 s10, s10, 7
  s_add_u32 s10, s10, 479232
  s_cmp_lt_u32 s9, 0x40000000
  s_cselect_b32 s10, s10, 0x40000000
  s_cmp_eq_u32 s69, 0
  s_cselect_b32 s10, s10, 0x40000000
  buffer_atomic_add v20, v16, s[28:31], s10 offen
  s_getpc_b64 s[4:5]
L_pcg0:
  s_lshr_b32 s6, s2, 3
  s_lshl_b32 s6, s6, 2
  s_add_u32 s6, s6, s48
  s_lshl_b32 s6, s6, 9
  v_and_b32 v21, 3, v0
  v_lshl_add_u32 v21, v21, 7, s6
  v_min_u32 v21, code_end - L_pcg0 - 4, v21
  global_load_dword v22, v21, s[4:5]
  s_cmp_eq_u32 s58, 0
  s_cbranch_scc1 L_pvd0
  s_waitcnt lgkmcnt(7)
  v_mfma_f32_16x16x32_bf16 v[48:51], a[64:67], a[0:3], v[32:35]
  s_add_u32 m0, s80, 0
  ds_read_b128 a[80:83], v1 offset:36864
  v_lshlrev_b32 v21, 7, v0
  s_waitcnt lgkmcnt(6)
  v_mfma_f32_16x16x32_bf16 v[48:51], a[68:71], a[16:19], v[48:51]
  buffer_load_dwordx4 v5, s[28:31], s66 offen offset:0 sc1 lds
  s_waitcnt lgkmcnt(4)
  v_mfma_f32_16x16x32_bf16 v[48:51], a[72:75], a[32:35], v[48:51]
  ds_read_b128 a[144:147], v2 offset:36864
  s_waitcnt lgkmcnt(3)
  v_mfma_f32_16x16x32_bf16 v[48:51], a[76:79], a[48:51], v[48:51]
  v_mfma_f32_16x16x32_bf16 v[128:131], a[128:131], v[64:67], 0
  buffer_load_dwordx4 v5, s[28:31], s66 offen offset:1024 sc1 lds
  v_mfma_f32_16x16x32_bf16 v[132:135], a[128:131], v[68:71], 0
  ds_read_b128 a[84:87], v1 offset:37888
  v_mfma_f32_16x16x32_bf16 v[52:55], a[64:67], a[4:7], v[36:39]
  v_mfma_f32_16x16x32_bf16 v[52:55], a[68:71], a[20:23], v[52:55]
  ds_read_b128 a[148:151], v2 offset:37888
  s_nop 0
  v_exp_f32 v48, v48
  v_mfma_f32_16x16x32_bf16 v[52:55], a[72:75], a[36:39], v[52:55]
  v_exp_f32 v49, v49
  v_mfma_f32_16x16x32_bf16 v[52:55], a[76:79], a[52:55], v[52:55]
  buffer_load_dwordx4 v5, s[28:31], s66 offen offset:2048 sc1 lds
  v_cvt_pk_bf16_f32 v96, v48, v49
  v_mfma_f32_16x16x32_bf16 v[140:143], a[128:131], v[76:79], 0
  v_exp_f32 v50, v50
  v_mfma_f32_16x16x32_bf16 v[140:143], a[132:135], v[92:95], v[140:143]
  buffer_load_dwordx4 v5, s[28:31], s66 offen offset:3072 sc1 lds
  v_mfma_f32_16x16x32_bf16 v[136:139], a[128:131], v[72:75], 0
  v_exp_f32 v51, v51
  v_mfma_f32_16x16x32_bf16 v[56:59], a[64:67], a[8:11], v[40:43]
  ds_read_b128 a[88:91], v1 offset:38912
  ds_read_b128 a[152:155], v2 offset:38912
  v_mfma_f32_16x16x32_bf16 v[56:59], a[68:71], a[24:27], v[56:59]
  s_add_u32 m0, s80, 4096
  v_exp_f32 v52, v52
  v_mfma_f32_16x16x32_bf16 v[56:59], a[72:75], a[40:43], v[56:59]
  s_add_u32 s66, s66, 4096
  v_exp_f32 v53, v53
  v_mfma_f32_16x16x32_bf16 v[56:59], a[76:79], a[56:59], v[56:59]
  buffer_load_dwordx4 v5, s[28:31], s66 offen offset:0 sc1 lds
  v_cvt_pk_bf16_f32 v97, v50, v51
  v_mfma_f32_16x16x32_bf16 v[144:147], a[136:139], v[64:67], 0
  ds_read_b128 a[92:95], v1 offset:39936
  v_exp_f32 v54, v54
  v_mfma_f32_16x16x32_bf16 v[148:151], a[136:139], v[68:71], 0
  buffer_load_dwordx4 v5, s[28:31], s66 offen offset:1024 sc1 lds
  v_mfma_f32_16x16x32_bf16 a[164:167], a[160:163], v[64:67], 0
  v_exp_f32 v55, v55
  v_mfma_f32_16x16x32_bf16 v[60:63], a[64:67], a[12:15], v[44:47]
  ds_read_b128 a[156:159], v2 offset:39936
  v_cvt_pk_bf16_f32 v100, v52, v53
  v_cvt_pk_bf16_f32 v101, v54, v55
  v_mfma_f32_16x16x32_bf16 v[60:63], a[68:71], a[28:31], v[60:63]
  v_exp_f32 v56, v56
  v_mfma_f32_16x16x32_bf16 v[60:63], a[72:75], a[44:47], v[60:63]
  v_exp_f32 v57, v57
  v_mfma_f32_16x16x32_bf16 v[60:63], a[76:79], a[60:63], v[60:63]
  buffer_load_dwordx4 v5, s[28:31], s66 offen offset:2048 sc1 lds
  v_mfma_f32_16x16x32_bf16 v[156:159], a[136:139], v[76:79], 0
  v_exp_f32 v58, v58
  s_waitcnt lgkmcnt(8)
  v_mfma_f32_16x16x32_bf16 v[156:159], a[140:143], v[92:95], v[156:159]
  buffer_load_dwordx4 v5, s[28:31], s66 offen offset:3072 sc1 lds
  v_mfma_f32_16x16x32_bf16 v[152:155], a[136:139], v[72:75], 0
  s_waitcnt lgkmcnt(0)
  v_exp_f32 v59, v59
  v_mfma_f32_16x16x32_bf16 v[48:51], a[80:83], a[0:3], v[32:35]
  ds_read_b128 a[96:99], v1 offset:40960
  v_cvt_pk_bf16_f32 v104, v56, v57
  v_mfma_f32_16x16x32_bf16 v[48:51], a[84:87], a[16:19], v[48:51]
  s_lshl_b32 s67, s70, 15
  v_exp_f32 v60, v60
  v_mfma_f32_16x16x32_bf16 v[48:51], a[88:91], a[32:35], v[48:51]
  s_add_u32 s67, s67, s65
  v_exp_f32 v61, v61
  v_mfma_f32_16x16x32_bf16 v[48:51], a[92:95], a[48:51], v[48:51]
  s_add_u32 m0, s56, 65536
  ds_read_b128 a[128:131], v2 offset:40960
  v_cvt_pk_bf16_f32 v105, v58, v59
  v_mfma_f32_16x16x32_bf16 v[160:163], a[144:147], v[64:67], 0
  v_exp_f32 v62, v62
  v_cvt_pk_bf16_f32 v108, v60, v61
  v_mfma_f32_16x16x32_bf16 v[164:167], a[144:147], v[68:71], 0
  ds_read_b128 a[100:103], v1 offset:41984
  v_exp_f32 v63, v63
  v_mfma_f32_16x16x32_bf16 v[52:55], a[80:83], a[4:7], v[36:39]
  buffer_load_dwordx4 v5, s[28:31], s67 offen offset:0 sc1 lds
  v_cvt_pk_bf16_f32 v109, v62, v63
  v_mfma_f32_16x16x32_bf16 v[52:55], a[84:87], a[20:23], v[52:55]
  ds_read_b128 a[132:135], v2 offset:41984
  v_exp_f32 v48, v48
  v_mfma_f32_16x16x32_bf16 v[52:55], a[88:91], a[36:39], v[52:55]
  v_exp_f32 v49, v49
  v_mfma_f32_16x16x32_bf16 v[52:55], a[92:95], a[52:55], v[52:55]
  buffer_load_dwordx4 v5, s[28:31], s67 offen offset:1024 sc1 lds
  v_cvt_pk_bf16_f32 v98, v48, v49
  v_mfma_f32_16x16x32_bf16 v[172:175], a[144:147], v[76:79], 0
  ds_read_b128 a[104:107], v1 offset:43008
  v_exp_f32 v50, v50
  v_mfma_f32_16x16x32_bf16 v[172:175], a[148:151], v[92:95], v[172:175]
  buffer_load_dwordx4 v5, s[28:31], s67 offen offset:2048 sc1 lds
  v_mfma_f32_16x16x32_bf16 v[168:171], a[144:147], v[72:75], 0
  v_exp_f32 v51, v51
  v_mfma_f32_16x16x32_bf16 v[56:59], a[80:83], a[8:11], v[40:43]
  buffer_load_dwordx4 v5, s[28:31], s67 offen offset:3072 sc1 lds
  v_mfma_f32_16x16x32_bf16 v[56:59], a[84:87], a[24:27], v[56:59]
  ds_read_b128 a[136:139], v2 offset:43008
  v_exp_f32 v52, v52
  v_mfma_f32_16x16x32_bf16 v[56:59], a[88:91], a[40:43], v[56:59]
  s_add_u32 m0, s56, 69632
  v_exp_f32 v53, v53
  v_mfma_f32_16x16x32_bf16 v[56:59], a[92:95], a[56:59], v[56:59]
  s_add_u32 s67, s67, 4096
  ds_read_b128 a[108:111], v1 offset:44032
  v_cvt_pk_bf16_f32 v99, v50, v51
  v_mfma_f32_16x16x32_bf16 v[176:179], a[152:155], v[64:67], 0
  v_exp_f32 v54, v54
  v_cvt_pk_bf16_f32 v102, v52, v53
  v_mfma_f32_16x16x32_bf16 v[180:183], a[152:155], v[68:71], 0
  buffer_load_dwordx4 v5, s[28:31], s67 offen offset:0 sc1 lds
  v_mfma_f32_16x16x32_bf16 a[168:171], a[160:163], v[68:71], 0
  ds_read_b128 a[140:143], v2 offset:44032
  v_exp_f32 v55, v55
  v_mfma_f32_16x16x32_bf16 v[60:63], a[80:83], a[12:15], v[44:47]
  buffer_load_dwordx4 v5, s[28:31], s67 offen offset:1024 sc1 lds
  v_cvt_pk_bf16_f32 v103, v54, v55
  v_mfma_f32_16x16x32_bf16 v[60:63], a[84:87], a[28:31], v[60:63]
  v_exp_f32 v56, v56
  v_mfma_f32_16x16x32_bf16 v[60:63], a[88:91], a[44:47], v[60:63]
  v_exp_f32 v57, v57
  v_mfma_f32_16x16x32_bf16 v[60:63], a[92:95], a[60:63], v[60:63]
  buffer_load_dwordx4 v5, s[28:31], s67 offen offset:2048 sc1 lds
  v_mfma_f32_16x16x32_bf16 v[188:191], a[152:155], v[76:79], 0
  v_exp_f32 v58, v58
  v_mfma_f32_16x16x32_bf16 v[188:191], a[156:159], v[92:95], v[188:191]
  v_cvt_pk_bf16_f32 v106, v56, v57
  v_mfma_f32_16x16x32_bf16 v[184:187], a[152:155], v[72:75], 0
  s_waitcnt lgkmcnt(0)
  v_exp_f32 v59, v59
  v_mfma_f32_16x16x32_bf16 v[48:51], a[96:99], a[0:3], v[32:35]
  buffer_load_dwordx4 v5, s[28:31], s67 offen offset:3072 sc1 lds
  v_cvt_pk_bf16_f32 v107, v58, v59
  v_mfma_f32_16x16x32_bf16 v[48:51], a[100:103], a[16:19], v[48:51]
  s_waitcnt vmcnt(18)
  ds_read_b128 a[112:115], v1 offset:45056
  v_exp_f32 v60, v60
  v_mfma_f32_16x16x32_bf16 v[48:51], a[104:107], a[32:35], v[48:51]
  ds_read_b128 a[144:147], v2 offset:45056
  v_exp_f32 v61, v61
  v_mfma_f32_16x16x32_bf16 v[48:51], a[108:111], a[48:51], v[48:51]
  buffer_load_dword v22, v21, s[28:31], s81 offen sc1
  v_mfma_f32_16x16x32_bf16 v[192:195], a[128:131], v[64:67], 0
  v_exp_f32 v62, v62
  v_mfma_f32_16x16x32_bf16 v[196:199], a[128:131], v[68:71], 0
  v_exp_f32 v63, v63
  v_mfma_f32_16x16x32_bf16 v[52:55], a[96:99], a[4:7], v[36:39]
  ds_read_b128 a[116:119], v1 offset:46080
  v_cvt_pk_bf16_f32 v110, v60, v61
  v_mfma_f32_16x16x32_bf16 v[52:55], a[100:103], a[20:23], v[52:55]
  v_exp_f32 v48, v48
  v_mfma_f32_16x16x32_bf16 v[52:55], a[104:107], a[36:39], v[52:55]
  v_exp_f32 v49, v49
  v_mfma_f32_16x16x32_bf16 v[52:55], a[108:111], a[52:55], v[52:55]
  ds_read_b128 a[148:151], v2 offset:46080
  v_cvt_pk_bf16_f32 v111, v62, v63
  v_mfma_f32_16x16x32_bf16 v[204:207], a[128:131], v[76:79], 0
  v_exp_f32 v50, v50
  v_mfma_f32_16x16x32_bf16 v[204:207], a[132:135], v[92:95], v[204:207]
  ds_read_b128 a[120:123], v1 offset:47104
  v_cvt_pk_bf16_f32 v112, v48, v49
  v_mfma_f32_16x16x32_bf16 v[200:203], a[128:131], v[72:75], 0
  v_exp_f32 v51, v51
  v_mfma_f32_16x16x32_bf16 v[56:59], a[96:99], a[8:11], v[40:43]
  s_mov_b32 s70, s62
  ds_read_b128 a[152:155], v2 offset:47104
  v_cvt_pk_bf16_f32 v113, v50, v51
  v_mfma_f32_16x16x32_bf16 v[56:59], a[100:103], a[24:27], v[56:59]
  s_mov_b32 s62, s60
  v_exp_f32 v52, v52
  v_mfma_f32_16x16x32_bf16 v[56:59], a[104:107], a[40:43], v[56:59]
  s_lshl_b32 s66, s60, 15
  v_exp_f32 v53, v53
  v_mfma_f32_16x16x32_bf16 v[56:59], a[108:111], a[56:59], v[56:59]
  s_add_u32 s66, s66, s64
  ds_read_b128 a[124:127], v1 offset:48128
  v_cvt_pk_bf16_f32 v116, v52, v53
  v_mfma_f32_16x16x32_bf16 v[208:211], a[136:139], v[64:67], 0
  s_add_u32 s60, s60, 1
  v_exp_f32 v54, v54
  v_mfma_f32_16x16x32_bf16 v[212:215], a[136:139], v[68:71], 0
  s_cmp_eq_u32 s60, s57
  s_addc_u32 s60, s60, 0
  ds_read_b128 a[156:159], v2 offset:48128
  v_mfma_f32_16x16x32_bf16 a[172:175], a[160:163], v[72:75], 0
  s_add_u32 s52, s61, 2
  v_exp_f32 v55, v55
  v_mfma_f32_16x16x32_bf16 v[60:63], a[96:99], a[12:15], v[44:47]
  s_cmp_gt_u32 s58, s52
  s_cselect_b32 s66, s66, s78
  v_cvt_pk_bf16_f32 v117, v54, v55
  v_mfma_f32_16x16x32_bf16 v[60:63], a[100:103], a[28:31], v[60:63]
  s_cmp_gt_u32 s58, s52
  s_cselect_b32 s80, s56, s77
  v_exp_f32 v56, v56
  v_mfma_f32_16x16x32_bf16 v[60:63], a[104:107], a[44:47], v[60:63]
  v_exp_f32 v57, v57
  v_mfma_f32_16x16x32_bf16 v[60:63], a[108:111], a[60:63], v[60:63]
  v_cvt_pk_bf16_f32 v120, v56, v57
  v_mfma_f32_16x16x32_bf16 v[220:223], a[136:139], v[76:79], 0
  v_exp_f32 v58, v58
  v_mfma_f32_16x16x32_bf16 v[220:223], a[140:143], v[92:95], v[220:223]
  v_mfma_f32_16x16x32_bf16 v[216:219], a[136:139], v[72:75], 0
  v_exp_f32 v59, v59
  s_waitcnt vmcnt(1) lgkmcnt(0)
  s_barrier
  v_mfma_f32_16x16x32_bf16 v[48:51], a[112:115], a[0:3], v[32:35]
  s_add_u32 m0, s80, 32768
  ds_read_b128 a[64:67], v1 offset:0
  v_cvt_pk_bf16_f32 v121, v58, v59
  v_mfma_f32_16x16x32_bf16 v[48:51], a[116:119], a[16:19], v[48:51]
  buffer_load_dwordx4 v5, s[28:31], s66 offen offset:0 sc1 lds
  v_exp_f32 v60, v60
  v_mfma_f32_16x16x32_bf16 v[48:51], a[120:123], a[32:35], v[48:51]
  v_exp_f32 v61, v61
  v_mfma_f32_16x16x32_bf16 v[48:51], a[124:127], a[48:51], v[48:51]
  ds_read_b128 a[128:131], v2 offset:0
  v_cvt_pk_bf16_f32 v124, v60, v61
  v_mfma_f32_16x16x32_bf16 v[224:227], a[144:147], v[64:67], 0
  buffer_load_dwordx4 v5, s[28:31], s66 offen offset:1024 sc1 lds
  v_exp_f32 v62, v62
  v_mfma_f32_16x16x32_bf16 v[228:231], a[144:147], v[68:71], 0
  v_exp_f32 v63, v63
  v_mfma_f32_16x16x32_bf16 v[52:55], a[112:115], a[4:7], v[36:39]
  ds_read_b128 a[68:71], v1 offset:1024
  v_cvt_pk_bf16_f32 v125, v62, v63
  v_mfma_f32_16x16x32_bf16 v[52:55], a[116:119], a[20:23], v[52:55]
  buffer_load_dwordx4 v5, s[28:31], s66 offen offset:2048 sc1 lds
  v_exp_f32 v48, v48
  v_mfma_f32_16x16x32_bf16 v[52:55], a[120:123], a[36:39], v[52:55]
  v_exp_f32 v49, v49
  v_mfma_f32_16x16x32_bf16 v[52:55], a[124:127], a[52:55], v[52:55]
  ds_read_b128 a[132:135], v2 offset:1024
  v_cvt_pk_bf16_f32 v114, v48, v49
  v_mfma_f32_16x16x32_bf16 v[236:239], a[144:147], v[76:79], 0
  v_exp_f32 v50, v50
  v_mfma_f32_16x16x32_bf16 v[236:239], a[148:151], v[92:95], v[236:239]
  buffer_load_dwordx4 v5, s[28:31], s66 offen offset:3072 sc1 lds
  v_mfma_f32_16x16x32_bf16 v[232:235], a[144:147], v[72:75], 0
  s_add_u32 m0, s80, 36864
  s_add_u32 s66, s66, 4096
  ds_read_b128 a[72:75], v1 offset:2048
  v_exp_f32 v51, v51
  v_mfma_f32_16x16x32_bf16 v[56:59], a[112:115], a[8:11], v[40:43]
  buffer_load_dwordx4 v5, s[28:31], s66 offen offset:0 sc1 lds
  v_mfma_f32_16x16x32_bf16 v[56:59], a[116:119], a[24:27], v[56:59]
  v_exp_f32 v52, v52
  v_mfma_f32_16x16x32_bf16 v[56:59], a[120:123], a[40:43], v[56:59]
  ds_read_b128 a[136:139], v2 offset:2048
  v_cvt_pk_bf16_f32 v115, v50, v51
  v_mfma_f32_16x16x32_bf16 v[56:59], a[124:127], a[56:59], v[56:59]
  ds_read_b128 a[76:79], v1 offset:3072
  v_exp_f32 v53, v53
  v_mfma_f32_16x16x32_bf16 v[240:243], a[152:155], v[64:67], 0
  buffer_load_dwordx4 v5, s[28:31], s66 offen offset:1024 sc1 lds
  v_mfma_f32_16x16x32_bf16 v[244:247], a[152:155], v[68:71], 0
  v_exp_f32 v54, v54
  v_mfma_f32_16x16x32_bf16 a[176:179], a[160:163], v[76:79], 0
  buffer_load_dwordx4 v5, s[28:31], s66 offen offset:2048 sc1 lds
  v_mfma_f32_16x16x32_bf16 a[176:179], a[160:163], v[92:95], a[176:179]
  v_exp_f32 v55, v55
  v_mfma_f32_16x16x32_bf16 v[60:63], a[112:115], a[12:15], v[44:47]
  ds_read_b128 a[140:143], v2 offset:3072
  v_cvt_pk_bf16_f32 v118, v52, v53
  v_mfma_f32_16x16x32_bf16 v[60:63], a[116:119], a[28:31], v[60:63]
  buffer_load_dwordx4 v5, s[28:31], s66 offen offset:3072 sc1 lds
  v_exp_f32 v56, v56
  v_mfma_f32_16x16x32_bf16 v[60:63], a[120:123], a[44:47], v[60:63]
  v_exp_f32 v57, v57
  v_mfma_f32_16x16x32_bf16 v[60:63], a[124:127], a[60:63], v[60:63]
  v_cvt_pk_bf16_f32 v119, v54, v55
  v_cvt_pk_bf16_f32 v122, v56, v57
  v_mfma_f32_16x16x32_bf16 v[252:255], a[152:155], v[76:79], 0
  v_exp_f32 v58, v58
  v_mfma_f32_16x16x32_bf16 v[252:255], a[156:159], v[92:95], v[252:255]
  s_add_u32 s61, s61, 1
  v_mfma_f32_16x16x32_bf16 v[248:251], a[152:155], v[72:75], 0
  s_waitcnt lgkmcnt(0)
  s_cmp_eq_u32 s61, s58
  v_exp_f32 v59, v59
  s_nop 0
  v_cvt_pk_bf16_f32 v123, v58, v59
  s_cbranch_scc1 L_pv1
  s_branch L_odd
L_g1:
HS17:
  s_cbranch_execz HS23
  s_getpc_b64 s[4:5]
L_pcg1:
  s_lshr_b32 s6, s2, 3
  s_lshl_b32 s6, s6, 2
  s_add_u32 s6, s6, s48
  s_lshl_b32 s6, s6, 9
  v_and_b32 v21, 3, v0
  v_lshl_add_u32 v21, v21, 7, s6
  v_min_u32 v21, code_end - L_pcg1 - 4, v21
  global_load_dword v22, v21, s[4:5]
  s_cmp_eq_u32 s58, 0
  s_cbranch_scc1 L_pvd1
  s_waitcnt lgkmcnt(7)
  v_mfma_f32_16x16x32_bf16 v[48:51], a[64:67], a[0:3], v[32:35]
  s_add_u32 m0, s80, 0
  ds_read_b128 a[80:83], v1 offset:36864
  v_lshlrev_b32 v21, 7, v0
  s_waitcnt lgkmcnt(6)
  v_mfma_f32_16x16x32_bf16 v[48:51], a[68:71], a[16:19], v[48:51]
  buffer_load_dwordx4 v5, s[28:31], s66 offen offset:0 sc1 lds
  s_waitcnt lgkmcnt(4)
  v_mfma_f32_16x16x32_bf16 v[48:51], a[72:75], a[32:35], v[48:51]
  ds_read_b128 a[144:147], v2 offset:36864
  v_mov_b32 v136, 0
  v_mov_b32 v137, 0
  s_waitcnt lgkmcnt(3)
  v_mfma_f32_16x16x32_bf16 v[48:51], a[76:79], a[48:51], v[48:51]
  v_mov_b32 v138, 0
  v_mov_b32 v139, 0
  v_mfma_f32_16x16x32_bf16 v[132:135], a[128:131], v[68:71], 0
  buffer_load_dwordx4 v5, s[28:31], s66 offen offset:1024 sc1 lds
  v_mfma_f32_16x16x32_bf16 v[132:135], a[132:135], v[84:87], v[132:135]
  ds_read_b128 a[84:87], v1 offset:37888
  v_mov_b32 v152, 0
  v_mov_b32 v153, 0
  v_mfma_f32_16x16x32_bf16 v[140:143], a[128:131], v[76:79], 0
  v_mov_b32 v154, 0
  v_mov_b32 v155, 0
  v_mfma_f32_16x16x32_bf16 v[52:55], a[64:67], a[4:7], v[36:39]
  v_mov_b32 v168, 0
  v_mov_b32 v169, 0
  v_mfma_f32_16x16x32_bf16 v[52:55], a[68:71], a[20:23], v[52:55]
  ds_read_b128 a[148:151], v2 offset:37888
  v_exp_f32 v48, v48
  v_mfma_f32_16x16x32_bf16 v[52:55], a[72:75], a[36:39], v[52:55]
  v_exp_f32 v49, v49
  v_mfma_f32_16x16x32_bf16 v[52:55], a[76:79], a[52:55], v[52:55]
  buffer_load_dwordx4 v5, s[28:31], s66 offen offset:2048 sc1 lds
  v_cvt_pk_bf16_f32 v96, v48, v49
  v_mfma_f32_16x16x32_bf16 v[128:131], a[128:131], v[64:67], 0
  ds_read_b128 a[88:91], v1 offset:38912
  v_exp_f32 v50, v50
  v_mfma_f32_16x16x32_bf16 v[128:131], a[132:135], v[80:83], v[128:131]
  v_exp_f32 v51, v51
  v_mfma_f32_16x16x32_bf16 v[56:59], a[64:67], a[8:11], v[40:43]
  buffer_load_dwordx4 v5, s[28:31], s66 offen offset:3072 sc1 lds
  v_cvt_pk_bf16_f32 v97, v50, v51
  v_mfma_f32_16x16x32_bf16 v[56:59], a[68:71], a[24:27], v[56:59]
  s_add_u32 m0, s80, 4096
  v_exp_f32 v52, v52
  v_mfma_f32_16x16x32_bf16 v[56:59], a[72:75], a[40:43], v[56:59]
  s_add_u32 s66, s66, 4096
  v_mov_b32 v170, 0
  v_mov_b32 v171, 0
  v_mfma_f32_16x16x32_bf16 v[56:59], a[76:79], a[56:59], v[56:59]
  ds_read_b128 a[152:155], v2 offset:38912
  v_exp_f32 v53, v53
  v_mfma_f32_16x16x32_bf16 v[148:151], a[136:139], v[68:71], 0
  buffer_load_dwordx4 v5, s[28:31], s66 offen offset:0 sc1 lds
  v_cvt_pk_bf16_f32 v100, v52, v53
  s_waitcnt lgkmcnt(6)
  v_mfma_f32_16x16x32_bf16 v[148:151], a[140:143], v[84:87], v[148:151]
  ds_read_b128 a[92:95], v1 offset:39936
  v_exp_f32 v54, v54
  v_mfma_f32_16x16x32_bf16 v[156:159], a[136:139], v[76:79], 0
  buffer_load_dwordx4 v5, s[28:31], s66 offen offset:1024 sc1 lds
  v_mfma_f32_16x16x32_bf16 a[164:167], a[160:163], v[64:67], 0
  ds_read_b128 a[156:159], v2 offset:39936
  v_exp_f32 v55, v55
  v_mfma_f32_16x16x32_bf16 a[164:167], a[160:163], v[80:83], a[164:167]
  v_mov_b32 v184, 0
  v_mov_b32 v185, 0
  v_cvt_pk_bf16_f32 v101, v54, v55
  v_mfma_f32_16x16x32_bf16 v[60:63], a[64:67], a[12:15], v[44:47]
  v_mov_b32 v186, 0
  v_mov_b32 v187, 0
  v_mfma_f32_16x16x32_bf16 v[60:63], a[68:71], a[28:31], v[60:63]
  v_exp_f32 v56, v56
  v_mfma_f32_16x16x32_bf16 v[60:63], a[72:75], a[44:47], v[60:63]
  v_exp_f32 v57, v57
  v_mfma_f32_16x16x32_bf16 v[60:63], a[76:79], a[60:63], v[60:63]
  buffer_load_dwordx4 v5, s[28:31], s66 offen offset:2048 sc1 lds
  v_cvt_pk_bf16_f32 v104, v56, v57
  v_mfma_f32_16x16x32_bf16 v[144:147], a[136:139], v[64:67], 0
  v_exp_f32 v58, v58
  v_mfma_f32_16x16x32_bf16 v[144:147], a[140:143], v[80:83], v[144:147]
  s_waitcnt lgkmcnt(0)
  v_exp_f32 v59, v59
  v_mfma_f32_16x16x32_bf16 v[48:51], a[80:83], a[0:3], v[32:35]
HS18:
  s_cbranch_execz HS24
  buffer_load_dwordx4 v5, s[28:31], s66 offen offset:3072 sc1 lds
  v_cvt_pk_bf16_f32 v105, v58, v59
  v_mfma_f32_16x16x32_bf16 v[48:51], a[84:87], a[16:19], v[48:51]
  s_lshl_b32 s67, s70, 15
  ds_read_b128 a[96:99], v1 offset:40960
  v_exp_f32 v60, v60
  v_mfma_f32_16x16x32_bf16 v[48:51], a[88:91], a[32:35], v[48:51]
  s_add_u32 s67, s67, s65
  v_exp_f32 v61, v61
  v_mfma_f32_16x16x32_bf16 v[48:51], a[92:95], a[48:51], v[48:51]
  s_add_u32 m0, s56, 65536
  v_mov_b32 v200, 0
  v_mov_b32 v201, 0
  v_mfma_f32_16x16x32_bf16 v[164:167], a[144:147], v[68:71], 0
  ds_read_b128 a[128:131], v2 offset:40960
  v_exp_f32 v62, v62
  v_mfma_f32_16x16x32_bf16 v[164:167], a[148:151], v[84:87], v[164:167]
  buffer_load_dwordx4 v5, s[28:31], s67 offen offset:0 sc1 lds
  v_cvt_pk_bf16_f32 v108, v60, v61
  v_mfma_f32_16x16x32_bf16 v[172:175], a[144:147], v[76:79], 0
  ds_read_b128 a[100:103], v1 offset:41984
  v_exp_f32 v63, v63
  v_mfma_f32_16x16x32_bf16 v[52:55], a[80:83], a[4:7], v[36:39]
  buffer_load_dwordx4 v5, s[28:31], s67 offen offset:1024 sc1 lds
  v_cvt_pk_bf16_f32 v109, v62, v63
  v_mfma_f32_16x16x32_bf16 v[52:55], a[84:87], a[20:23], v[52:55]
  ds_read_b128 a[132:135], v2 offset:41984
  v_exp_f32 v48, v48
  v_mfma_f32_16x16x32_bf16 v[52:55], a[88:91], a[36:39], v[52:55]
  v_exp_f32 v49, v49
  v_mfma_f32_16x16x32_bf16 v[52:55], a[92:95], a[52:55], v[52:55]
  buffer_load_dwordx4 v5, s[28:31], s67 offen offset:2048 sc1 lds
  v_cvt_pk_bf16_f32 v98, v48, v49
  v_mfma_f32_16x16x32_bf16 v[160:163], a[144:147], v[64:67], 0
  ds_read_b128 a[104:107], v1 offset:43008
  v_exp_f32 v50, v50
  v_mfma_f32_16x16x32_bf16 v[160:163], a[148:151], v[80:83], v[160:163]
  v_exp_f32 v51, v51
  v_mfma_f32_16x16x32_bf16 v[56:59], a[80:83], a[8:11], v[40:43]
  buffer_load_dwordx4 v5, s[28:31], s67 offen offset:3072 sc1 lds
  v_cvt_pk_bf16_f32 v99, v50, v51
  v_mfma_f32_16x16x32_bf16 v[56:59], a[84:87], a[24:27], v[56:59]
  ds_read_b128 a[136:139], v2 offset:43008
  v_exp_f32 v52, v52
  v_mfma_f32_16x16x32_bf16 v[56:59], a[88:91], a[40:43], v[56:59]
  v_mov_b32 v202, 0
  v_mov_b32 v203, 0
  v_mfma_f32_16x16x32_bf16 v[56:59], a[92:95], a[56:59], v[56:59]
  s_add_u32 m0, s56, 69632
  v_exp_f32 v53, v53
  v_mfma_f32_16x16x32_bf16 v[180:183], a[152:155], v[68:71], 0
  s_add_u32 s67, s67, 4096
  v_mov_b32 v216, 0
  v_mov_b32 v217, 0
  v_mfma_f32_16x16x32_bf16 v[180:183], a[156:159], v[84:87], v[180:183]
  ds_read_b128 a[108:111], v1 offset:44032
  v_exp_f32 v54, v54
  v_mfma_f32_16x16x32_bf16 v[188:191], a[152:155], v[76:79], 0
  buffer_load_dwordx4 v5, s[28:31], s67 offen offset:0 sc1 lds
  v_cvt_pk_bf16_f32 v102, v52, v53
  v_mfma_f32_16x16x32_bf16 a[168:171], a[160:163], v[68:71], 0
  ds_read_b128 a[140:143], v2 offset:44032
  v_exp_f32 v55, v55
  v_mfma_f32_16x16x32_bf16 a[168:171], a[160:163], v[84:87], a[168:171]
  buffer_load_dwordx4 v5, s[28:31], s67 offen offset:1024 sc1 lds
  v_cvt_pk_bf16_f32 v103, v54, v55
  v_mfma_f32_16x16x32_bf16 v[60:63], a[80:83], a[12:15], v[44:47]
  v_mov_b32 v218, 0
  v_mov_b32 v219, 0
  v_mfma_f32_16x16x32_bf16 v[60:63], a[84:87], a[28:31], v[60:63]
  v_exp_f32 v56, v56
  v_mfma_f32_16x16x32_bf16 v[60:63], a[88:91], a[44:47], v[60:63]
  v_exp_f32 v57, v57
  v_mfma_f32_16x16x32_bf16 v[60:63], a[92:95], a[60:63], v[60:63]
  buffer_load_dwordx4 v5, s[28:31], s67 offen offset:2048 sc1 lds
  v_cvt_pk_bf16_f32 v106, v56, v57
  v_mfma_f32_16x16x32_bf16 v[176:179], a[152:155], v[64:67], 0
  v_exp_f32 v58, v58
  v_mfma_f32_16x16x32_bf16 v[176:179], a[156:159], v[80:83], v[176:179]
  s_waitcnt lgkmcnt(0)
  v_exp_f32 v59, v59
  v_mfma_f32_16x16x32_bf16 v[48:51], a[96:99], a[0:3], v[32:35]
  buffer_load_dwordx4 v5, s[28:31], s67 offen offset:3072 sc1 lds
  v_cvt_pk_bf16_f32 v107, v58, v59
  v_mfma_f32_16x16x32_bf16 v[48:51], a[100:103], a[16:19], v[48:51]
  s_waitcnt vmcnt(17)
  ds_read_b128 a[112:115], v1 offset:45056
  v_exp_f32 v60, v60
  v_mfma_f32_16x16x32_bf16 v[48:51], a[104:107], a[32:35], v[48:51]
  ds_read_b128 a[144:147], v2 offset:45056
  v_exp_f32 v61, v61
  v_mfma_f32_16x16x32_bf16 v[48:51], a[108:111], a[48:51], v[48:51]
  buffer_load_dword v22, v21, s[28:31], s81 offen sc1
  v_cvt_pk_bf16_f32 v110, v60, v61
  v_mfma_f32_16x16x32_bf16 v[196:199], a[128:131], v[68:71], 0
  v_exp_f32 v62, v62
  v_mfma_f32_16x16x32_bf16 v[196:199], a[132:135], v[84:87], v[196:199]
  ds_read_b128 a[116:119], v1 offset:46080
  v_mov_b32 v232, 0
  v_mov_b32 v233, 0
  v_mfma_f32_16x16x32_bf16 v[204:207], a[128:131], v[76:79], 0
  v_exp_f32 v63, v63
  v_mfma_f32_16x16x32_bf16 v[52:55], a[96:99], a[4:7], v[36:39]
  ds_read_b128 a[148:151], v2 offset:46080
  v_mov_b32 v234, 0
  v_mov_b32 v235, 0
  v_mfma_f32_16x16x32_bf16 v[52:55], a[100:103], a[20:23], v[52:55]
  v_exp_f32 v48, v48
  v_cvt_pk_bf16_f32 v111, v62, v63
  v_mfma_f32_16x16x32_bf16 v[52:55], a[104:107], a[36:39], v[52:55]
  v_exp_f32 v49, v49
  v_mfma_f32_16x16x32_bf16 v[52:55], a[108:111], a[52:55], v[52:55]
  ds_read_b128 a[120:123], v1 offset:47104
  v_mov_b32 v248, 0
  v_mov_b32 v249, 0
  v_mfma_f32_16x16x32_bf16 v[192:195], a[128:131], v[64:67], 0
  v_exp_f32 v50, v50
  v_cvt_pk_bf16_f32 v112, v48, v49
  v_mfma_f32_16x16x32_bf16 v[192:195], a[132:135], v[80:83], v[192:195]
  v_exp_f32 v51, v51
  v_mfma_f32_16x16x32_bf16 v[56:59], a[96:99], a[8:11], v[40:43]
  s_mov_b32 s70, s62
  ds_read_b128 a[152:155], v2 offset:47104
  v_mov_b32 v250, 0
  v_mov_b32 v251, 0
  v_mfma_f32_16x16x32_bf16 v[56:59], a[100:103], a[24:27], v[56:59]
  s_mov_b32 s62, s60
  v_exp_f32 v52, v52
  v_mfma_f32_16x16x32_bf16 v[56:59], a[104:107], a[40:43], v[56:59]
  s_lshl_b32 s66, s60, 15
  v_exp_f32 v53, v53
  v_mfma_f32_16x16x32_bf16 v[56:59], a[108:111], a[56:59], v[56:59]
  s_add_u32 s66, s66, s64
  ds_read_b128 a[124:127], v1 offset:48128
  v_cvt_pk_bf16_f32 v113, v50, v51
  v_mfma_f32_16x16x32_bf16 v[212:215], a[136:139], v[68:71], 0
  s_add_u32 s60, s60, 1
  v_exp_f32 v54, v54
  v_mfma_f32_16x16x32_bf16 v[212:215], a[140:143], v[84:87], v[212:215]
  s_cmp_eq_u32 s60, s57
  s_addc_u32 s60, s60, 0
  ds_read_b128 a[156:159], v2 offset:48128
  v_mfma_f32_16x16x32_bf16 v[220:223], a[136:139], v[76:79], 0
  s_add_u32 s52, s61, 2
  v_exp_f32 v55, v55
  v_mfma_f32_16x16x32_bf16 v[60:63], a[96:99], a[12:15], v[44:47]
  s_cmp_gt_u32 s58, s52
  s_cselect_b32 s66, s66, s78
  v_cvt_pk_bf16_f32 v116, v52, v53
  v_mfma_f32_16x16x32_bf16 v[60:63], a[100:103], a[28:31], v[60:63]
  s_cmp_gt_u32 s58, s52
  s_cselect_b32 s80, s56, s77
  v_exp_f32 v56, v56
  v_mfma_f32_16x16x32_bf16 v[60:63], a[104:107], a[44:47], v[60:63]
  v_exp_f32 v57, v57
  v_mfma_f32_16x16x32_bf16 v[60:63], a[108:111], a[60:63], v[60:63]
  v_cvt_pk_bf16_f32 v117, v54, v55
  v_cvt_pk_bf16_f32 v120, v56, v57
  v_mfma_f32_16x16x32_bf16 v[208:211], a[136:139], v[64:67], 0
  v_exp_f32 v58, v58
  v_mfma_f32_16x16x32_bf16 v[208:211], a[140:143], v[80:83], v[208:211]
  v_exp_f32 v59, v59
  s_waitcnt vmcnt(1) lgkmcnt(0)
  s_barrier
  v_mfma_f32_16x16x32_bf16 v[48:51], a[112:115], a[0:3], v[32:35]
  s_add_u32 m0, s80, 32768
  ds_read_b128 a[64:67], v1 offset:0
  v_cvt_pk_bf16_f32 v121, v58, v59
  v_mfma_f32_16x16x32_bf16 v[48:51], a[116:119], a[16:19], v[48:51]
  buffer_load_dwordx4 v5, s[28:31], s66 offen offset:0 sc1 lds
  v_exp_f32 v60, v60
  v_mfma_f32_16x16x32_bf16 v[48:51], a[120:123], a[32:35], v[48:51]
  v_exp_f32 v61, v61
  v_mfma_f32_16x16x32_bf16 v[48:51], a[124:127], a[48:51], v[48:51]
  buffer_load_dwordx4 v5, s[28:31], s66 offen offset:1024 sc1 lds
  v_cvt_pk_bf16_f32 v124, v60, v61
  v_mfma_f32_16x16x32_bf16 v[228:231], a[144:147], v[68:71], 0
  v_exp_f32 v62, v62
  v_mfma_f32_16x16x32_bf16 v[228:231], a[148:151], v[84:87], v[228:231]
  ds_read_b128 a[128:131], v2 offset:0
  ds_read_b128 a[68:71], v1 offset:1024
  v_mfma_f32_16x16x32_bf16 v[236:239], a[144:147], v[76:79], 0
  v_exp_f32 v63, v63
  v_mfma_f32_16x16x32_bf16 v[52:55], a[112:115], a[4:7], v[36:39]
  buffer_load_dwordx4 v5, s[28:31], s66 offen offset:2048 sc1 lds
  v_cvt_pk_bf16_f32 v125, v62, v63
  v_mfma_f32_16x16x32_bf16 v[52:55], a[116:119], a[20:23], v[52:55]
  ds_read_b128 a[132:135], v2 offset:1024
  v_exp_f32 v48, v48
  v_mfma_f32_16x16x32_bf16 v[52:55], a[120:123], a[36:39], v[52:55]
  v_exp_f32 v49, v49
  v_mfma_f32_16x16x32_bf16 v[52:55], a[124:127], a[52:55], v[52:55]
  buffer_load_dwordx4 v5, s[28:31], s66 offen offset:3072 sc1 lds
  v_cvt_pk_bf16_f32 v114, v48, v49
  v_mfma_f32_16x16x32_bf16 v[224:227], a[144:147], v[64:67], 0
  s_add_u32 m0, s80, 36864
  s_add_u32 s66, s66, 4096
  v_exp_f32 v50, v50
  v_mfma_f32_16x16x32_bf16 v[224:227], a[148:151], v[80:83], v[224:227]
  ds_read_b128 a[72:75], v1 offset:2048
  v_exp_f32 v51, v51
  v_mfma_f32_16x16x32_bf16 v[56:59], a[112:115], a[8:11], v[40:43]
  buffer_load_dwordx4 v5, s[28:31], s66 offen offset:0 sc1 lds
  v_cvt_pk_bf16_f32 v115, v50, v51
  v_mfma_f32_16x16x32_bf16 v[56:59], a[116:119], a[24:27], v[56:59]
  ds_read_b128 a[136:139], v2 offset:2048
  v_exp_f32 v52, v52
  v_mfma_f32_16x16x32_bf16 v[56:59], a[120:123], a[40:43], v[56:59]
  buffer_load_dwordx4 v5, s[28:31], s66 offen offset:1024 sc1 lds
  v_mfma_f32_16x16x32_bf16 v[56:59], a[124:127], a[56:59], v[56:59]
  v_exp_f32 v53, v53
  v_mfma_f32_16x16x32_bf16 v[244:247], a[152:155], v[68:71], 0
  ds_read_b128 a[76:79], v1 offset:3072
  v_cvt_pk_bf16_f32 v118, v52, v53
  v_mfma_f32_16x16x32_bf16 v[244:247], a[156:159], v[84:87], v[244:247]
  v_exp_f32 v54, v54
  v_mfma_f32_16x16x32_bf16 v[252:255], a[152:155], v[76:79], 0
  buffer_load_dwordx4 v5, s[28:31], s66 offen offset:2048 sc1 lds
  v_mfma_f32_16x16x32_bf16 a[176:179], a[160:163], v[76:79], 0
  ds_read_b128 a[140:143], v2 offset:3072
  v_exp_f32 v55, v55
  v_mfma_f32_16x16x32_bf16 v[60:63], a[112:115], a[12:15], v[44:47]
  buffer_load_dwordx4 v5, s[28:31], s66 offen offset:3072 sc1 lds
  v_mfma_f32_16x16x32_bf16 v[60:63], a[116:119], a[28:31], v[60:63]
  v_exp_f32 v56, v56
  v_mfma_f32_16x16x32_bf16 v[60:63], a[120:123], a[44:47], v[60:63]
  v_exp_f32 v57, v57
  v_mfma_f32_16x16x32_bf16 v[60:63], a[124:127], a[60:63], v[60:63]
  v_cvt_pk_bf16_f32 v119, v54, v55
  v_cvt_pk_bf16_f32 v122, v56, v57
  v_mfma_f32_16x16x32_bf16 v[240:243], a[152:155], v[64:67], 0
  s_add_u32 s61, s61, 1
  v_exp_f32 v58, v58
  v_mfma_f32_16x16x32_bf16 v[240:243], a[156:159], v[80:83], v[240:243]
  s_waitcnt lgkmcnt(0)
  s_cmp_eq_u32 s61, s58
  v_exp_f32 v59, v59
  s_nop 0
  v_cvt_pk_bf16_f32 v123, v58, v59
  s_cbranch_scc1 L_pv1
  s_branch L_odd
L_pv0:
HS19:
  s_cbranch_execz HOPR_b
  s_cmp_eq_u32 s68, 1
  s_cbranch_scc1 L_pw0
  v_exp_f32 v60, v60
  v_exp_f32 v61, v61
  v_mfma_f32_16x16x32_bf16 v[128:131], a[128:131], v[64:67], v[128:131]
  s_mul_i32 s9, s48, 640
  ds_read_b128 a[144:147], v2 offset:36864
  v_exp_f32 v62, v62
  v_mfma_f32_16x16x32_bf16 v[128:131], a[132:135], v[80:83], v[128:131]
  s_add_u32 s9, s9, 16384
  v_exp_f32 v63, v63
  v_mfma_f32_16x16x32_bf16 v[132:135], a[128:131], v[68:71], v[132:135]
  s_mul_i32 s10, s48, 552960
  v_cvt_pk_bf16_f32 v94, v60, v61
  v_add_u32 v17, 131072, v5
  v_mfma_f32_16x16x32_bf16 v[132:135], a[132:135], v[84:87], v[132:135]
  s_lshl_b32 s11, s2, 10
  v_cvt_pk_bf16_f32 v95, v62, v63
  v_xor_b32 v4, 0x4000, v17
  v_mfma_f32_16x16x32_bf16 v[136:139], a[128:131], v[72:75], v[136:139]
  s_lshl_b32 s52, s48, 10
  s_add_u32 s10, s10, s11
  ds_read_b128 a[148:151], v2 offset:37888
  v_and_b32 v21, 15, v0
  v_mfma_f32_16x16x32_bf16 v[136:139], a[132:135], v[88:91], v[136:139]
  s_add_u32 s10, s10, 60665856
  v_lshrrev_b32 v22, 4, v0
  v_lshlrev_b32 v22, 4, v22
  v_add_u32 v18, 65536, v3
  v_add_u32 v19, s52, v18
  v_mfma_f32_16x16x32_bf16 v[140:143], a[128:131], v[76:79], v[140:143]
  s_cmp_ge_u32 s2, 148
  s_cselect_b32 s10, s10, 0x40000000
  v_lshl_add_u32 v22, v21, 6, v22
  v_cmp_gt_u32 vcc, 2, v21
  v_mfma_f32_16x16x32_bf16 v[140:143], a[132:135], v[92:95], v[140:143]
  v_cvt_pk_bf16_f32 v128, v128, v129
  v_cvt_pk_bf16_f32 v129, v130, v131
  v_mfma_f32_16x16x32_bf16 a[164:167], a[160:163], v[64:67], a[164:167]
  v_mov_b32 v21, 0x40000000
  v_cndmask_b32 v22, v21, v22, vcc
  v_mfma_f32_16x16x32_bf16 a[164:167], a[160:163], v[80:83], a[164:167]
  buffer_load_dwordx4 a[64:67], v3, s[28:31], s10 offen sc1
  v_cvt_pk_bf16_f32 v132, v132, v133
  v_cvt_pk_bf16_f32 v133, v134, v135
  s_waitcnt lgkmcnt(3)
  v_mfma_f32_16x16x32_bf16 v[144:147], a[136:139], v[64:67], v[144:147]
  s_lshr_b32 s11, s2, 3
  ds_read_b128 a[152:155], v2 offset:38912
  s_waitcnt lgkmcnt(3)
  v_mfma_f32_16x16x32_bf16 v[144:147], a[140:143], v[80:83], v[144:147]
  s_lshl_b32 s11, s11, 2
  v_mfma_f32_16x16x32_bf16 v[148:151], a[136:139], v[68:71], v[148:151]
  s_add_u32 s11, s11, s48
  buffer_load_dwordx4 a[68:71], v22, s[28:31], s9 offen offset:0 sc1
  v_mfma_f32_16x16x32_bf16 v[148:151], a[140:143], v[84:87], v[148:151]
  s_lshr_b32 s8, s49, 2
  v_lshrrev_b32 v96, 4, v0
  v_lshlrev_b32 v96, 2, v96
  v_mfma_f32_16x16x32_bf16 a[168:171], a[160:163], v[68:71], a[168:171]
  s_lshl_b32 s8, s8, 7
  v_and_b32 v97, 15, v0
  v_sub_u32 v96, v97, v96
  v_mfma_f32_16x16x32_bf16 a[168:171], a[160:163], v[84:87], a[168:171]
  s_add_u32 s10, s10, 110592
  v_mfma_f32_16x16x32_bf16 v[152:155], a[136:139], v[72:75], v[152:155]
  s_and_b32 s7, s48, 1
  ds_read_b128 a[156:159], v2 offset:39936
  v_cvt_pk_bf16_f32 v130, v144, v145
  v_mfma_f32_16x16x32_bf16 v[152:155], a[140:143], v[88:91], v[152:155]
  s_lshl_b32 s7, s7, 4
  buffer_load_dwordx4 a[72:75], v3, s[28:31], s10 offen sc1
  v_cvt_pk_bf16_f32 v131, v146, v147
  v_mfma_f32_16x16x32_bf16 v[156:159], a[136:139], v[76:79], v[156:159]
  s_add_u32 s11, s11, s8
  ds_write_b128 v17, v[128:131] offset:0
  v_add_u32 v96, s7, v96
  v_mfma_f32_16x16x32_bf16 v[156:159], a[140:143], v[92:95], v[156:159]
  s_mul_i32 s11, s11, 5120
  v_cvt_pk_bf16_f32 v134, v148, v149
  v_cvt_pk_bf16_f32 v135, v150, v151
  v_mfma_f32_16x16x32_bf16 a[172:175], a[160:163], v[72:75], a[172:175]
  ds_write_b128 v17, v[132:135] offset:4096
  v_mov_b32 v97, 0xf149f2ca
  v_mfma_f32_16x16x32_bf16 a[172:175], a[160:163], v[88:91], a[172:175]
  buffer_load_dwordx4 a[76:79], v22, s[28:31], s9 offen offset:128 sc1
  s_waitcnt lgkmcnt(5)
  v_mfma_f32_16x16x32_bf16 v[160:163], a[144:147], v[64:67], v[160:163]
  s_add_u32 s10, s10, 110592
  ds_read_b128 a[128:131], v2 offset:40960
  v_cmp_gt_i32 vcc, 16, v96
  s_waitcnt lgkmcnt(5)
  v_mfma_f32_16x16x32_bf16 v[160:163], a[148:151], v[80:83], v[160:163]
  buffer_load_dwordx4 a[80:83], v3, s[28:31], s10 offen sc1
  v_mfma_f32_16x16x32_bf16 v[164:167], a[144:147], v[68:71], v[164:167]
  v_cmp_gt_i32 s[72:73], 17, v96
  v_nop
  v_mfma_f32_16x16x32_bf16 v[164:167], a[148:151], v[84:87], v[164:167]
  v_cndmask_b32 v12, 0, v97, vcc
  v_cndmask_b32 v13, 0, v97, s[72:73]
  v_mfma_f32_16x16x32_bf16 a[176:179], a[160:163], v[76:79], a[176:179]
  v_cmp_gt_i32 vcc, 18, v96
  v_cmp_gt_i32 s[72:73], 19, v96
  v_mfma_f32_16x16x32_bf16 a[176:179], a[160:163], v[92:95], a[176:179]
  buffer_load_dwordx4 a[84:87], v22, s[28:31], s9 offen offset:256 sc1
  v_mfma_f32_16x16x32_bf16 v[168:171], a[144:147], v[72:75], v[168:171]
  ds_read_b128 a[132:135], v2 offset:41984
  v_nop
  v_mfma_f32_16x16x32_bf16 v[168:171], a[148:151], v[88:91], v[168:171]
  v_cvt_pk_bf16_f32 v160, v160, v161
  v_cvt_pk_bf16_f32 v161, v162, v163
  v_mfma_f32_16x16x32_bf16 v[172:175], a[144:147], v[76:79], v[172:175]
  s_add_u32 s10, s10, 110592
  v_cndmask_b32 v14, 0, v97, vcc
  v_cndmask_b32 v15, 0, v97, s[72:73]
  v_mfma_f32_16x16x32_bf16 v[172:175], a[148:151], v[92:95], v[172:175]
  buffer_load_dwordx4 a[88:91], v3, s[28:31], s10 offen sc1
  v_cvt_pk_bf16_f32 v164, v164, v165
  v_cvt_pk_bf16_f32 v165, v166, v167
  s_waitcnt lgkmcnt(5)
  v_mfma_f32_16x16x32_bf16 v[176:179], a[152:155], v[64:67], v[176:179]
  ds_read_b128 a[136:139], v2 offset:43008
  v_accvgpr_read_b32 v28, a164
  s_waitcnt lgkmcnt(5)
  v_mfma_f32_16x16x32_bf16 v[176:179], a[156:159], v[80:83], v[176:179]
  v_accvgpr_read_b32 v29, a168
  v_accvgpr_read_b32 v30, a172
  v_mfma_f32_16x16x32_bf16 v[180:183], a[152:155], v[68:71], v[180:183]
  buffer_load_dwordx4 a[92:95], v22, s[28:31], s9 offen offset:384 sc1
  v_accvgpr_read_b32 v31, a176
  v_mfma_f32_16x16x32_bf16 v[180:183], a[156:159], v[84:87], v[180:183]
  ds_write_b128 v19, v[28:31]
  v_lshrrev_b32 v100, 4, v0
  v_mfma_f32_16x16x32_bf16 v[184:187], a[152:155], v[72:75], v[184:187]
  ds_read_b128 a[140:143], v2 offset:44032
  v_lshlrev_b32 v100, 2, v100
  v_mfma_f32_16x16x32_bf16 v[184:187], a[156:159], v[88:91], v[184:187]
  s_add_u32 s10, s10, 110592
  v_and_b32 v101, 15, v0
  v_sub_u32 v100, v101, v100
  v_mfma_f32_16x16x32_bf16 v[188:191], a[152:155], v[76:79], v[188:191]
  buffer_load_dwordx4 a[96:99], v3, s[28:31], s10 offen sc1
  v_cvt_pk_bf16_f32 v162, v176, v177
  v_cvt_pk_bf16_f32 v163, v178, v179
  v_mfma_f32_16x16x32_bf16 v[188:191], a[156:159], v[92:95], v[188:191]
  ds_write_b128 v17, v[160:163] offset:1024
  v_lshlrev_b32 v101, 4, v100
  s_waitcnt lgkmcnt(5)
  v_mfma_f32_16x16x32_bf16 v[192:195], a[128:131], v[64:67], v[192:195]
  s_waitcnt lgkmcnt(2)
  s_barrier
  ds_read_b128 a[144:147], v2 offset:45056
  v_cvt_pk_bf16_f32 v166, v180, v181
  v_mfma_f32_16x16x32_bf16 v[192:195], a[132:135], v[80:83], v[192:195]
  ds_read_b128 v[48:51], v18 offset:0
  v_cvt_pk_bf16_f32 v167, v182, v183
  v_mfma_f32_16x16x32_bf16 v[196:199], a[128:131], v[68:71], v[196:199]
  ds_read_b128 v[52:55], v18 offset:1024
  buffer_load_dwordx4 a[100:103], v22, s[28:31], s9 offen offset:512 sc1
  v_mfma_f32_16x16x32_bf16 v[196:199], a[132:135], v[84:87], v[196:199]
  ds_read_b128 v[56:59], v18 offset:2048
  v_mov_b32 v102, 0x3f80
  v_mfma_f32_16x16x32_bf16 v[200:203], a[128:131], v[72:75], v[200:203]
  s_lshl_b32 s9, s2, 6
  ds_read_b128 a[148:151], v2 offset:46080
  v_lshlrev_b32 v101, v101, v102
  v_mfma_f32_16x16x32_bf16 v[200:203], a[132:135], v[88:91], v[200:203]
  s_add_u32 s9, s9, 23296
  ds_read_b128 v[60:63], v18 offset:3072
  v_lshrrev_b32 v100, 1, v100
  v_mfma_f32_16x16x32_bf16 v[204:207], a[128:131], v[76:79], v[204:207]
  s_cmp_ge_u32 s2, 148
  s_cselect_b32 s9, s9, 0x40000000
  ds_write_b128 v17, v[164:167] offset:5120
  v_cmp_eq_u32 vcc, 0, v100
  v_mfma_f32_16x16x32_bf16 v[204:207], a[132:135], v[92:95], v[204:207]
  s_cmp_eq_u32 s48, 0
  s_cselect_b32 s9, s9, 0x40000000
  v_cvt_pk_bf16_f32 v192, v192, v193
  v_cvt_pk_bf16_f32 v193, v194, v195
  v_mfma_f32_16x16x32_bf16 v[208:211], a[136:139], v[64:67], v[208:211]
  s_add_u32 s10, s9, 0x2000
  ds_read_b128 a[152:155], v2 offset:47104
  v_cmp_eq_u32 s[72:73], 1, v100
  s_waitcnt lgkmcnt(9)
  v_mfma_f32_16x16x32_bf16 v[208:211], a[140:143], v[80:83], v[208:211]
  v_cvt_pk_bf16_f32 v196, v196, v197
  v_cvt_pk_bf16_f32 v197, v198, v199
  v_mfma_f32_16x16x32_bf16 v[212:215], a[136:139], v[68:71], v[212:215]
  v_accvgpr_write_b32 a182, 0
  v_accvgpr_write_b32 a183, 0
  v_mfma_f32_16x16x32_bf16 v[212:215], a[140:143], v[84:87], v[212:215]
  s_waitcnt lgkmcnt(4)
  v_add_f32 v48, v48, v58
  v_add_f32 v49, v49, v59
  v_mfma_f32_16x16x32_bf16 v[216:219], a[136:139], v[72:75], v[216:219]
  ds_read_b128 a[156:159], v2 offset:48128
  v_add_f32 v50, v50, v56
  v_mfma_f32_16x16x32_bf16 v[216:219], a[140:143], v[88:91], v[216:219]
  v_add_f32 v51, v51, v57
  s_waitcnt lgkmcnt(3)
  v_add_f32 v52, v52, v62
  v_mfma_f32_16x16x32_bf16 v[220:223], a[136:139], v[76:79], v[220:223]
  v_cvt_pk_bf16_f32 v194, v208, v209
  v_cvt_pk_bf16_f32 v195, v210, v211
  v_mfma_f32_16x16x32_bf16 v[220:223], a[140:143], v[92:95], v[220:223]
  ds_write_b128 v17, v[192:195] offset:2048
  v_add_f32 v53, v53, v63
  v_mfma_f32_16x16x32_bf16 v[224:227], a[144:147], v[64:67], v[224:227]
  v_cvt_pk_bf16_f32 v198, v212, v213
  v_cvt_pk_bf16_f32 v199, v214, v215
  v_mfma_f32_16x16x32_bf16 v[224:227], a[148:151], v[80:83], v[224:227]
  ds_write_b128 v17, v[196:199] offset:6144
  v_add_f32 v54, v54, v60
  v_mfma_f32_16x16x32_bf16 v[228:231], a[144:147], v[68:71], v[228:231]
  v_add_f32 v55, v55, v61
  v_min3_f32 v56, v48, v49, v50
  v_mfma_f32_16x16x32_bf16 v[228:231], a[148:151], v[84:87], v[228:231]
  v_add_f32 v57, v48, v49
  v_min3_f32 v56, v56, v51, v52
  v_mfma_f32_16x16x32_bf16 v[232:235], a[144:147], v[72:75], v[232:235]
  v_add_f32 v58, v50, v51
  v_min3_f32 v56, v56, v53, v54
  v_mfma_f32_16x16x32_bf16 v[232:235], a[148:151], v[88:91], v[232:235]
  v_add_f32 v59, v52, v53
  v_min_f32 v56, v56, v55
  v_mfma_f32_16x16x32_bf16 v[236:239], a[144:147], v[76:79], v[236:239]
  v_add_f32 v60, v54, v55
  v_add_f32 v57, v57, v58
  v_mfma_f32_16x16x32_bf16 v[236:239], a[148:151], v[92:95], v[236:239]
  v_cvt_pk_bf16_f32 v224, v224, v225
  v_cvt_pk_bf16_f32 v225, v226, v227
  s_waitcnt lgkmcnt(3)
  v_mfma_f32_16x16x32_bf16 v[240:243], a[152:155], v[64:67], v[240:243]
  v_add_f32 v59, v59, v60
  v_add_f32 v57, v57, v59
  s_waitcnt lgkmcnt(2)
  v_mfma_f32_16x16x32_bf16 v[240:243], a[156:159], v[80:83], v[240:243]
  v_cvt_pk_bf16_f32 v228, v228, v229
  v_cvt_pk_bf16_f32 v229, v230, v231
  v_mfma_f32_16x16x32_bf16 v[244:247], a[152:155], v[68:71], v[244:247]
  v_cmp_nle_f32 s[36:37], s40, v56
  v_cmp_nge_f32 s[38:39], s41, v57
  v_mfma_f32_16x16x32_bf16 v[244:247], a[156:159], v[84:87], v[244:247]
  v_cndmask_b32 v48, v48, v52, s[42:43]
  v_cndmask_b32 v102, 0, v101, vcc
  v_mfma_f32_16x16x32_bf16 v[248:251], a[152:155], v[72:75], v[248:251]
  s_or_b64 s[36:37], s[36:37], s[38:39]
  v_cndmask_b32 v103, 0, v101, s[72:73]
  v_accvgpr_write_b32 a180, v102
  v_mfma_f32_16x16x32_bf16 v[248:251], a[156:159], v[88:91], v[248:251]
  s_cmp_lg_u64 s[36:37], 0
  s_cselect_b32 s36, 1, 0
  v_accvgpr_write_b32 a181, v103
  v_accvgpr_write_b32 a184, v102
  v_mfma_f32_16x16x32_bf16 v[252:255], a[152:155], v[76:79], v[252:255]
  s_cmp_gt_u32 s36, s69
  s_cbranch_scc1 L_slow
  v_cvt_pk_bf16_f32 v226, v240, v241
  v_cvt_pk_bf16_f32 v227, v242, v243
  v_mfma_f32_16x16x32_bf16 v[252:255], a[156:159], v[92:95], v[252:255]
  s_waitcnt vmcnt(8)
  v_mfma_f32_16x16x32_bf16 a[104:107], a[68:71], a[64:67], 0
  s_waitcnt vmcnt(6)
  v_mfma_f32_16x16x32_bf16 a[104:107], a[76:79], a[72:75], a[104:107]
  s_waitcnt vmcnt(4)
  v_mfma_f32_16x16x32_bf16 a[104:107], a[84:87], a[80:83], a[104:107]
  s_waitcnt vmcnt(2)
  v_mfma_f32_16x16x32_bf16 a[104:107], a[92:95], a[88:91], a[104:107]
  s_waitcnt vmcnt(0)
  v_mfma_f32_16x16x32_bf16 a[104:107], a[100:103], a[96:99], a[104:107]
  ds_write_b128 v17, v[224:227] offset:3072
  v_cndmask_b32 v49, v49, v53, s[42:43]
  v_cvt_pk_bf16_f32 v230, v244, v245
  v_cvt_pk_bf16_f32 v231, v246, v247
  ds_write_b128 v17, v[228:231] offset:7168
  v_cndmask_b32 v50, v50, v54, s[42:43]
  v_cndmask_b32 v51, v51, v55, s[42:43]
  v_cndmask_b32 v28, v50, v48, s[74:75]
  v_cndmask_b32 v30, v51, v49, s[74:75]
  v_rcp_f32 v28, v28
  v_rcp_f32 v30, v30
  v_accvgpr_write_b32 a185, v103
  v_lshlrev_b32 v96, 7, v0
  v_cmp_gt_u32 vcc, 40, v0
  s_nop 1
  v_cndmask_b32 v96, v21, v96, vcc
  buffer_load_dword a186, v96, s[44:47], s11 offen
  v_lshlrev_b32 v22, 2, v0
  v_cmp_gt_u32 vcc, 16, v0
  s_nop 1
  v_cndmask_b32 v22, v21, v22, vcc
  ds_write_b128 v19, a[104:107] offset:4096
  s_branch L_fin0
L_pw0:
HS20:
  s_cbranch_execz HS27
  v_exp_f32 v60, v60
  v_exp_f32 v61, v61
  v_mfma_f32_16x16x32_bf16 v[128:131], a[128:131], v[64:67], v[128:131]
  s_lshl_b32 s79, s82, 8
  ds_read_b128 a[144:147], v2 offset:36864
  v_exp_f32 v62, v62
  v_mfma_f32_16x16x32_bf16 v[128:131], a[132:135], v[80:83], v[128:131]
  s_add_u32 s79, s79, 524288
  v_exp_f32 v63, v63
  v_mfma_f32_16x16x32_bf16 v[132:135], a[128:131], v[68:71], v[132:135]
  s_cmp_eq_u32 s69, 0
  s_cselect_b32 s66, s79, 0x40000000
  v_cvt_pk_bf16_f32 v94, v60, v61
  v_add_u32 v17, 131072, v5
  v_mfma_f32_16x16x32_bf16 v[132:135], a[132:135], v[84:87], v[132:135]
  v_cvt_pk_bf16_f32 v95, v62, v63
  v_xor_b32 v4, 0x4000, v17
  v_mfma_f32_16x16x32_bf16 v[136:139], a[128:131], v[72:75], v[136:139]
  s_lshl_b32 s52, s48, 10
  ds_read_b128 a[148:151], v2 offset:37888
  v_mfma_f32_16x16x32_bf16 v[136:139], a[132:135], v[88:91], v[136:139]
  buffer_atomic_add v20, v16, s[28:31], s66 offen offset:128
  v_add_u32 v18, 65536, v3
  v_add_u32 v19, s52, v18
  v_mfma_f32_16x16x32_bf16 v[140:143], a[128:131], v[76:79], v[140:143]
  v_min_u32 v6, 35, v0
  v_lshlrev_b32 v6, 7, v6
  v_mfma_f32_16x16x32_bf16 v[140:143], a[132:135], v[92:95], v[140:143]
  v_cvt_pk_bf16_f32 v128, v128, v129
  v_cvt_pk_bf16_f32 v129, v130, v131
  v_mfma_f32_16x16x32_bf16 a[164:167], a[160:163], v[64:67], a[164:167]
  v_add_u32 v6, 475136, v6
  v_mfma_f32_16x16x32_bf16 a[164:167], a[160:163], v[80:83], a[164:167]
  buffer_load_dword v22, v6, s[28:31], 0 offen sc1
  v_cvt_pk_bf16_f32 v132, v132, v133
  v_cvt_pk_bf16_f32 v133, v134, v135
  s_waitcnt lgkmcnt(3)
  v_mfma_f32_16x16x32_bf16 v[144:147], a[136:139], v[64:67], v[144:147]
  s_add_u32 s55, s49, 0
  ds_read_b128 a[152:155], v2 offset:38912
  s_waitcnt lgkmcnt(3)
  v_mfma_f32_16x16x32_bf16 v[144:147], a[140:143], v[80:83], v[144:147]
  s_and_b32 s55, s55, 3
  v_mfma_f32_16x16x32_bf16 v[148:151], a[136:139], v[68:71], v[148:151]
  s_mul_i32 s55, s55, 163840
  v_mfma_f32_16x16x32_bf16 v[148:151], a[140:143], v[84:87], v[148:151]
  s_add_u32 s55, s55, s54
  v_mfma_f32_16x16x32_bf16 a[168:171], a[160:163], v[68:71], a[168:171]
  s_add_u32 m0, s71, 0
  v_mfma_f32_16x16x32_bf16 a[168:171], a[160:163], v[84:87], a[168:171]
  buffer_load_dwordx4 v23, s[44:47], s55 offen lds
  v_mfma_f32_16x16x32_bf16 v[152:155], a[136:139], v[72:75], v[152:155]
  s_add_u32 m0, s71, 1024
  ds_read_b128 a[156:159], v2 offset:39936
  v_cvt_pk_bf16_f32 v130, v144, v145
  v_mfma_f32_16x16x32_bf16 v[152:155], a[140:143], v[88:91], v[152:155]
  buffer_load_dwordx4 v24, s[44:47], s55 offen lds
  v_cvt_pk_bf16_f32 v131, v146, v147
  v_mfma_f32_16x16x32_bf16 v[156:159], a[136:139], v[76:79], v[156:159]
  ds_write_b128 v17, v[128:131] offset:0
  v_mfma_f32_16x16x32_bf16 v[156:159], a[140:143], v[92:95], v[156:159]
  v_cvt_pk_bf16_f32 v134, v148, v149
  v_cvt_pk_bf16_f32 v135, v150, v151
  v_mfma_f32_16x16x32_bf16 a[172:175], a[160:163], v[72:75], a[172:175]
  ds_write_b128 v17, v[132:135] offset:4096
  v_mfma_f32_16x16x32_bf16 a[172:175], a[160:163], v[88:91], a[172:175]
  s_add_u32 m0, s71, 2048
  s_waitcnt lgkmcnt(5)
  v_mfma_f32_16x16x32_bf16 v[160:163], a[144:147], v[64:67], v[160:163]
  ds_read_b128 a[128:131], v2 offset:40960
  s_waitcnt lgkmcnt(5)
  v_mfma_f32_16x16x32_bf16 v[160:163], a[148:151], v[80:83], v[160:163]
  buffer_load_dwordx4 v25, s[44:47], s55 offen lds
  v_mfma_f32_16x16x32_bf16 v[164:167], a[144:147], v[68:71], v[164:167]
  v_mfma_f32_16x16x32_bf16 v[164:167], a[148:151], v[84:87], v[164:167]
  v_mfma_f32_16x16x32_bf16 a[176:179], a[160:163], v[76:79], a[176:179]
  v_mfma_f32_16x16x32_bf16 a[176:179], a[160:163], v[92:95], a[176:179]
  s_add_u32 m0, s71, 3072
  v_mfma_f32_16x16x32_bf16 v[168:171], a[144:147], v[72:75], v[168:171]
HS21:
  s_cbranch_execz HOPR_d
  ds_read_b128 a[132:135], v2 offset:41984
  buffer_load_dwordx4 v26, s[44:47], s55 offen lds
  v_mfma_f32_16x16x32_bf16 v[168:171], a[148:151], v[88:91], v[168:171]
  v_cvt_pk_bf16_f32 v160, v160, v161
  v_cvt_pk_bf16_f32 v161, v162, v163
  v_mfma_f32_16x16x32_bf16 v[172:175], a[144:147], v[76:79], v[172:175]
  v_mfma_f32_16x16x32_bf16 v[172:175], a[148:151], v[92:95], v[172:175]
  v_cvt_pk_bf16_f32 v164, v164, v165
  v_cvt_pk_bf16_f32 v165, v166, v167
  s_waitcnt lgkmcnt(5)
  v_mfma_f32_16x16x32_bf16 v[176:179], a[152:155], v[64:67], v[176:179]
  ds_read_b128 a[136:139], v2 offset:43008
  v_accvgpr_read_b32 v28, a164
  s_waitcnt lgkmcnt(5)
  v_mfma_f32_16x16x32_bf16 v[176:179], a[156:159], v[80:83], v[176:179]
  s_add_u32 m0, s71, 4096
  v_accvgpr_read_b32 v29, a168
  v_accvgpr_read_b32 v30, a172
  v_mfma_f32_16x16x32_bf16 v[180:183], a[152:155], v[68:71], v[180:183]
  buffer_load_dwordx4 v27, s[44:47], s55 offen lds
  v_accvgpr_read_b32 v31, a176
  v_mfma_f32_16x16x32_bf16 v[180:183], a[156:159], v[84:87], v[180:183]
  ds_write_b128 v19, v[28:31]
  v_mfma_f32_16x16x32_bf16 v[184:187], a[152:155], v[72:75], v[184:187]
  ds_read_b128 a[140:143], v2 offset:44032
  v_mfma_f32_16x16x32_bf16 v[184:187], a[156:159], v[88:91], v[184:187]
  s_add_u32 s55, s55, 20480
  v_mfma_f32_16x16x32_bf16 v[188:191], a[152:155], v[76:79], v[188:191]
  s_add_u32 m0, s71, 5120
  v_cvt_pk_bf16_f32 v162, v176, v177
  v_cvt_pk_bf16_f32 v163, v178, v179
  v_mfma_f32_16x16x32_bf16 v[188:191], a[156:159], v[92:95], v[188:191]
  ds_write_b128 v17, v[160:163] offset:1024
  buffer_load_dwordx4 v23, s[44:47], s55 offen lds
  s_waitcnt lgkmcnt(5)
  v_mfma_f32_16x16x32_bf16 v[192:195], a[128:131], v[64:67], v[192:195]
  s_waitcnt lgkmcnt(2)
  s_barrier
  ds_read_b128 a[144:147], v2 offset:45056
  v_cvt_pk_bf16_f32 v166, v180, v181
  v_mfma_f32_16x16x32_bf16 v[192:195], a[132:135], v[80:83], v[192:195]
  ds_read_b128 v[48:51], v18 offset:0
  v_cvt_pk_bf16_f32 v167, v182, v183
  v_mfma_f32_16x16x32_bf16 v[196:199], a[128:131], v[68:71], v[196:199]
  ds_read_b128 v[52:55], v18 offset:1024
  v_mfma_f32_16x16x32_bf16 v[196:199], a[132:135], v[84:87], v[196:199]
  ds_read_b128 v[56:59], v18 offset:2048
  v_mfma_f32_16x16x32_bf16 v[200:203], a[128:131], v[72:75], v[200:203]
  s_add_u32 m0, s71, 6144
  ds_read_b128 a[148:151], v2 offset:46080
  v_mfma_f32_16x16x32_bf16 v[200:203], a[132:135], v[88:91], v[200:203]
  ds_read_b128 v[60:63], v18 offset:3072
  buffer_load_dwordx4 v24, s[44:47], s55 offen lds
  v_mfma_f32_16x16x32_bf16 v[204:207], a[128:131], v[76:79], v[204:207]
  ds_write_b128 v17, v[164:167] offset:5120
  v_mfma_f32_16x16x32_bf16 v[204:207], a[132:135], v[92:95], v[204:207]
  v_cvt_pk_bf16_f32 v192, v192, v193
  v_cvt_pk_bf16_f32 v193, v194, v195
  v_mfma_f32_16x16x32_bf16 v[208:211], a[136:139], v[64:67], v[208:211]
  ds_read_b128 a[152:155], v2 offset:47104
  s_waitcnt lgkmcnt(9)
  v_mfma_f32_16x16x32_bf16 v[208:211], a[140:143], v[80:83], v[208:211]
  v_cvt_pk_bf16_f32 v196, v196, v197
  v_cvt_pk_bf16_f32 v197, v198, v199
  v_mfma_f32_16x16x32_bf16 v[212:215], a[136:139], v[68:71], v[212:215]
  s_add_u32 m0, s71, 7168
  v_mfma_f32_16x16x32_bf16 v[212:215], a[140:143], v[84:87], v[212:215]
  buffer_load_dwordx4 v25, s[44:47], s55 offen lds
  s_waitcnt lgkmcnt(4)
  v_add_f32 v48, v48, v58
  v_add_f32 v49, v49, v59
  v_mfma_f32_16x16x32_bf16 v[216:219], a[136:139], v[72:75], v[216:219]
  ds_read_b128 a[156:159], v2 offset:48128
  v_add_f32 v50, v50, v56
  v_mfma_f32_16x16x32_bf16 v[216:219], a[140:143], v[88:91], v[216:219]
  v_add_f32 v51, v51, v57
  s_waitcnt lgkmcnt(3)
  v_add_f32 v52, v52, v62
  v_mfma_f32_16x16x32_bf16 v[220:223], a[136:139], v[76:79], v[220:223]
  v_cvt_pk_bf16_f32 v194, v208, v209
  v_cvt_pk_bf16_f32 v195, v210, v211
  v_mfma_f32_16x16x32_bf16 v[220:223], a[140:143], v[92:95], v[220:223]
  s_add_u32 m0, s71, 8192
  ds_write_b128 v17, v[192:195] offset:2048
  v_add_f32 v53, v53, v63
  v_mfma_f32_16x16x32_bf16 v[224:227], a[144:147], v[64:67], v[224:227]
  buffer_load_dwordx4 v26, s[44:47], s55 offen lds
  v_cvt_pk_bf16_f32 v198, v212, v213
  v_cvt_pk_bf16_f32 v199, v214, v215
  v_mfma_f32_16x16x32_bf16 v[224:227], a[148:151], v[80:83], v[224:227]
  ds_write_b128 v17, v[196:199] offset:6144
  v_add_f32 v54, v54, v60
  v_mfma_f32_16x16x32_bf16 v[228:231], a[144:147], v[68:71], v[228:231]
  v_add_f32 v55, v55, v61
  v_min3_f32 v56, v48, v49, v50
  v_mfma_f32_16x16x32_bf16 v[228:231], a[148:151], v[84:87], v[228:231]
  v_add_f32 v57, v48, v49
  v_min3_f32 v56, v56, v51, v52
  v_mfma_f32_16x16x32_bf16 v[232:235], a[144:147], v[72:75], v[232:235]
  v_add_f32 v58, v50, v51
  v_min3_f32 v56, v56, v53, v54
  v_mfma_f32_16x16x32_bf16 v[232:235], a[148:151], v[88:91], v[232:235]
  s_add_u32 m0, s71, 9216
  v_add_f32 v59, v52, v53
  v_min_f32 v56, v56, v55
  v_mfma_f32_16x16x32_bf16 v[236:239], a[144:147], v[76:79], v[236:239]
  buffer_load_dwordx4 v27, s[44:47], s55 offen lds
  v_add_f32 v60, v54, v55
  v_add_f32 v57, v57, v58
  v_mfma_f32_16x16x32_bf16 v[236:239], a[148:151], v[92:95], v[236:239]
  v_cvt_pk_bf16_f32 v224, v224, v225
  v_cvt_pk_bf16_f32 v225, v226, v227
  s_waitcnt lgkmcnt(3)
  v_mfma_f32_16x16x32_bf16 v[240:243], a[152:155], v[64:67], v[240:243]
  v_add_f32 v59, v59, v60
  v_add_f32 v57, v57, v59
  s_waitcnt lgkmcnt(2)
  v_mfma_f32_16x16x32_bf16 v[240:243], a[156:159], v[80:83], v[240:243]
  v_cvt_pk_bf16_f32 v228, v228, v229
  v_cvt_pk_bf16_f32 v229, v230, v231
  v_mfma_f32_16x16x32_bf16 v[244:247], a[152:155], v[68:71], v[244:247]
  v_cmp_nle_f32 s[36:37], s40, v56
  v_cmp_nge_f32 s[38:39], s41, v57
  v_mfma_f32_16x16x32_bf16 v[244:247], a[156:159], v[84:87], v[244:247]
  v_cndmask_b32 v48, v48, v52, s[42:43]
  v_mfma_f32_16x16x32_bf16 v[248:251], a[152:155], v[72:75], v[248:251]
  s_or_b64 s[36:37], s[36:37], s[38:39]
  v_mfma_f32_16x16x32_bf16 v[248:251], a[156:159], v[88:91], v[248:251]
  s_cmp_lg_u64 s[36:37], 0
  s_cselect_b32 s36, 1, 0
  v_mfma_f32_16x16x32_bf16 v[252:255], a[152:155], v[76:79], v[252:255]
  s_cmp_gt_u32 s36, s69
  s_cbranch_scc1 L_slow
  v_cvt_pk_bf16_f32 v226, v240, v241
  v_cvt_pk_bf16_f32 v227, v242, v243
  v_mfma_f32_16x16x32_bf16 v[252:255], a[156:159], v[92:95], v[252:255]
  ds_write_b128 v17, v[224:227] offset:3072
  v_cndmask_b32 v49, v49, v53, s[42:43]
  v_cvt_pk_bf16_f32 v230, v244, v245
  v_cvt_pk_bf16_f32 v231, v246, v247
  ds_write_b128 v17, v[228:231] offset:7168
  v_cndmask_b32 v50, v50, v54, s[42:43]
  v_cndmask_b32 v51, v51, v55, s[42:43]
  v_cndmask_b32 v28, v50, v48, s[74:75]
  v_cndmask_b32 v30, v51, v49, s[74:75]
  v_rcp_f32 v28, v28
  v_rcp_f32 v30, v30
  s_branch L_fin1
L_pv1:
HS22:
  s_cbranch_execz HOPR_b
  s_cmp_eq_u32 s68, 1
  s_cbranch_scc1 L_pw1
  v_exp_f32 v60, v60
  v_exp_f32 v61, v61
  v_mfma_f32_16x16x32_bf16 v[128:131], a[128:131], v[96:99], v[128:131]
  s_mul_i32 s9, s48, 640
  ds_read_b128 a[144:147], v2 offset:4096
  v_exp_f32 v62, v62
  v_mfma_f32_16x16x32_bf16 v[128:131], a[132:135], v[112:115], v[128:131]
  s_add_u32 s9, s9, 16384
  v_exp_f32 v63, v63
  v_mfma_f32_16x16x32_bf16 v[132:135], a[128:131], v[100:103], v[132:135]
  s_mul_i32 s10, s48, 552960
  v_cvt_pk_bf16_f32 v126, v60, v61
  v_add_u32 v17, 131072, v5
  v_mfma_f32_16x16x32_bf16 v[132:135], a[132:135], v[116:119], v[132:135]
  s_lshl_b32 s11, s2, 10
  v_cvt_pk_bf16_f32 v127, v62, v63
  v_xor_b32 v4, 0x4000, v17
  v_mfma_f32_16x16x32_bf16 v[136:139], a[128:131], v[104:107], v[136:139]
  s_lshl_b32 s52, s48, 10
  s_add_u32 s10, s10, s11
  ds_read_b128 a[148:151], v2 offset:5120
  v_and_b32 v21, 15, v0
  v_mfma_f32_16x16x32_bf16 v[136:139], a[132:135], v[120:123], v[136:139]
  s_add_u32 s10, s10, 60665856
  s_waitcnt vmcnt(8)
  v_lshrrev_b32 v22, 4, v0
  v_lshlrev_b32 v22, 4, v22
  v_add_u32 v18, 98304, v3
  v_add_u32 v19, s52, v18
  v_mfma_f32_16x16x32_bf16 v[140:143], a[128:131], v[108:111], v[140:143]
  s_cmp_ge_u32 s2, 148
  s_cselect_b32 s10, s10, 0x40000000
  v_lshl_add_u32 v22, v21, 6, v22
  v_cmp_gt_u32 vcc, 2, v21
  v_mfma_f32_16x16x32_bf16 v[140:143], a[132:135], v[124:127], v[140:143]
  v_cvt_pk_bf16_f32 v128, v128, v129
  v_cvt_pk_bf16_f32 v129, v130, v131
  v_mfma_f32_16x16x32_bf16 a[164:167], a[160:163], v[96:99], a[164:167]
  v_mov_b32 v21, 0x40000000
  v_cndmask_b32 v22, v21, v22, vcc
  v_mfma_f32_16x16x32_bf16 a[164:167], a[160:163], v[112:115], a[164:167]
  buffer_load_dwordx4 a[64:67], v3, s[28:31], s10 offen sc1
  v_cvt_pk_bf16_f32 v132, v132, v133
  v_cvt_pk_bf16_f32 v133, v134, v135
  s_waitcnt lgkmcnt(3)
  v_mfma_f32_16x16x32_bf16 v[144:147], a[136:139], v[96:99], v[144:147]
  s_lshr_b32 s11, s2, 3
  ds_read_b128 a[152:155], v2 offset:6144
  s_waitcnt lgkmcnt(3)
  v_mfma_f32_16x16x32_bf16 v[144:147], a[140:143], v[112:115], v[144:147]
  s_lshl_b32 s11, s11, 2
  v_mfma_f32_16x16x32_bf16 v[148:151], a[136:139], v[100:103], v[148:151]
  s_add_u32 s11, s11, s48
  buffer_load_dwordx4 a[68:71], v22, s[28:31], s9 offen offset:0 sc1
  v_mfma_f32_16x16x32_bf16 v[148:151], a[140:143], v[116:119], v[148:151]
  s_lshr_b32 s8, s49, 2
  v_lshrrev_b32 v64, 4, v0
  v_lshlrev_b32 v64, 2, v64
  v_mfma_f32_16x16x32_bf16 a[168:171], a[160:163], v[100:103], a[168:171]
  s_lshl_b32 s8, s8, 7
  v_and_b32 v65, 15, v0
  v_sub_u32 v64, v65, v64
  v_mfma_f32_16x16x32_bf16 a[168:171], a[160:163], v[116:119], a[168:171]
  s_add_u32 s10, s10, 110592
  v_mfma_f32_16x16x32_bf16 v[152:155], a[136:139], v[104:107], v[152:155]
  s_and_b32 s7, s48, 1
  ds_read_b128 a[156:159], v2 offset:7168
  v_cvt_pk_bf16_f32 v130, v144, v145
  v_mfma_f32_16x16x32_bf16 v[152:155], a[140:143], v[120:123], v[152:155]
  s_lshl_b32 s7, s7, 4
  buffer_load_dwordx4 a[72:75], v3, s[28:31], s10 offen sc1
  v_cvt_pk_bf16_f32 v131, v146, v147
  v_mfma_f32_16x16x32_bf16 v[156:159], a[136:139], v[108:111], v[156:159]
  s_add_u32 s11, s11, s8
  ds_write_b128 v17, v[128:131] offset:0
  v_add_u32 v64, s7, v64
  v_mfma_f32_16x16x32_bf16 v[156:159], a[140:143], v[124:127], v[156:159]
  s_mul_i32 s11, s11, 5120
  v_cvt_pk_bf16_f32 v134, v148, v149
  v_cvt_pk_bf16_f32 v135, v150, v151
  v_mfma_f32_16x16x32_bf16 a[172:175], a[160:163], v[104:107], a[172:175]
  ds_write_b128 v17, v[132:135] offset:4096
  v_mov_b32 v65, 0xf149f2ca
  v_mfma_f32_16x16x32_bf16 a[172:175], a[160:163], v[120:123], a[172:175]
  buffer_load_dwordx4 a[76:79], v22, s[28:31], s9 offen offset:128 sc1
  s_waitcnt lgkmcnt(5)
  v_mfma_f32_16x16x32_bf16 v[160:163], a[144:147], v[96:99], v[160:163]
  s_add_u32 s10, s10, 110592
  ds_read_b128 a[128:131], v2 offset:8192
  v_cmp_gt_i32 vcc, 16, v64
  s_waitcnt lgkmcnt(5)
  v_mfma_f32_16x16x32_bf16 v[160:163], a[148:151], v[112:115], v[160:163]
  buffer_load_dwordx4 a[80:83], v3, s[28:31], s10 offen sc1
  v_mfma_f32_16x16x32_bf16 v[164:167], a[144:147], v[100:103], v[164:167]
  v_cmp_gt_i32 s[72:73], 17, v64
  v_nop
  v_mfma_f32_16x16x32_bf16 v[164:167], a[148:151], v[116:119], v[164:167]
  v_cndmask_b32 v12, 0, v65, vcc
  v_cndmask_b32 v13, 0, v65, s[72:73]
  v_mfma_f32_16x16x32_bf16 a[176:179], a[160:163], v[108:111], a[176:179]
  v_cmp_gt_i32 vcc, 18, v64
  v_cmp_gt_i32 s[72:73], 19, v64
  v_mfma_f32_16x16x32_bf16 a[176:179], a[160:163], v[124:127], a[176:179]
  buffer_load_dwordx4 a[84:87], v22, s[28:31], s9 offen offset:256 sc1
  v_mfma_f32_16x16x32_bf16 v[168:171], a[144:147], v[104:107], v[168:171]
  ds_read_b128 a[132:135], v2 offset:9216
  v_nop
  v_mfma_f32_16x16x32_bf16 v[168:171], a[148:151], v[120:123], v[168:171]
  v_cvt_pk_bf16_f32 v160, v160, v161
  v_cvt_pk_bf16_f32 v161, v162, v163
  v_mfma_f32_16x16x32_bf16 v[172:175], a[144:147], v[108:111], v[172:175]
  s_add_u32 s10, s10, 110592
  v_cndmask_b32 v14, 0, v65, vcc
  v_cndmask_b32 v15, 0, v65, s[72:73]
  v_mfma_f32_16x16x32_bf16 v[172:175], a[148:151], v[124:127], v[172:175]
  buffer_load_dwordx4 a[88:91], v3, s[28:31], s10 offen sc1
  v_cvt_pk_bf16_f32 v164, v164, v165
  v_cvt_pk_bf16_f32 v165, v166, v167
  s_waitcnt lgkmcnt(5)
  v_mfma_f32_16x16x32_bf16 v[176:179], a[152:155], v[96:99], v[176:179]
  ds_read_b128 a[136:139], v2 offset:10240
  v_accvgpr_read_b32 v28, a164
  s_waitcnt lgkmcnt(5)
  v_mfma_f32_16x16x32_bf16 v[176:179], a[156:159], v[112:115], v[176:179]
  v_accvgpr_read_b32 v29, a168
  v_accvgpr_read_b32 v30, a172
  v_mfma_f32_16x16x32_bf16 v[180:183], a[152:155], v[100:103], v[180:183]
  buffer_load_dwordx4 a[92:95], v22, s[28:31], s9 offen offset:384 sc1
  v_accvgpr_read_b32 v31, a176
  v_mfma_f32_16x16x32_bf16 v[180:183], a[156:159], v[116:119], v[180:183]
  ds_write_b128 v19, v[28:31]
  v_lshrrev_b32 v68, 4, v0
  v_mfma_f32_16x16x32_bf16 v[184:187], a[152:155], v[104:107], v[184:187]
  ds_read_b128 a[140:143], v2 offset:11264
  v_lshlrev_b32 v68, 2, v68
  v_mfma_f32_16x16x32_bf16 v[184:187], a[156:159], v[120:123], v[184:187]
  s_add_u32 s10, s10, 110592
  v_and_b32 v69, 15, v0
  v_sub_u32 v68, v69, v68
  v_mfma_f32_16x16x32_bf16 v[188:191], a[152:155], v[108:111], v[188:191]
  buffer_load_dwordx4 a[96:99], v3, s[28:31], s10 offen sc1
  v_cvt_pk_bf16_f32 v162, v176, v177
  v_cvt_pk_bf16_f32 v163, v178, v179
  v_mfma_f32_16x16x32_bf16 v[188:191], a[156:159], v[124:127], v[188:191]
  ds_write_b128 v17, v[160:163] offset:1024
  v_lshlrev_b32 v69, 4, v68
  s_waitcnt lgkmcnt(5)
  v_mfma_f32_16x16x32_bf16 v[192:195], a[128:131], v[96:99], v[192:195]
  s_waitcnt lgkmcnt(2)
  s_barrier
  ds_read_b128 a[144:147], v2 offset:12288
  v_cvt_pk_bf16_f32 v166, v180, v181
  v_mfma_f32_16x16x32_bf16 v[192:195], a[132:135], v[112:115], v[192:195]
  ds_read_b128 v[48:51], v18 offset:0
  v_cvt_pk_bf16_f32 v167, v182, v183
  v_mfma_f32_16x16x32_bf16 v[196:199], a[128:131], v[100:103], v[196:199]
  ds_read_b128 v[52:55], v18 offset:1024
  buffer_load_dwordx4 a[100:103], v22, s[28:31], s9 offen offset:512 sc1
  v_mfma_f32_16x16x32_bf16 v[196:199], a[132:135], v[116:119], v[196:199]
  ds_read_b128 v[56:59], v18 offset:2048
  v_mov_b32 v70, 0x3f80
  v_mfma_f32_16x16x32_bf16 v[200:203], a[128:131], v[104:107], v[200:203]
  s_lshl_b32 s9, s2, 6
  ds_read_b128 a[148:151], v2 offset:13312
  v_lshlrev_b32 v69, v69, v70
  v_mfma_f32_16x16x32_bf16 v[200:203], a[132:135], v[120:123], v[200:203]
  s_add_u32 s9, s9, 23296
  ds_read_b128 v[60:63], v18 offset:3072
  v_lshrrev_b32 v68, 1, v68
  v_mfma_f32_16x16x32_bf16 v[204:207], a[128:131], v[108:111], v[204:207]
  s_cmp_ge_u32 s2, 148
  s_cselect_b32 s9, s9, 0x40000000
  ds_write_b128 v17, v[164:167] offset:5120
  v_cmp_eq_u32 vcc, 0, v68
  v_mfma_f32_16x16x32_bf16 v[204:207], a[132:135], v[124:127], v[204:207]
  s_cmp_eq_u32 s48, 0
  s_cselect_b32 s9, s9, 0x40000000
  v_cvt_pk_bf16_f32 v192, v192, v193
  v_cvt_pk_bf16_f32 v193, v194, v195
  v_mfma_f32_16x16x32_bf16 v[208:211], a[136:139], v[96:99], v[208:211]
  s_add_u32 s10, s9, 0x2000
  ds_read_b128 a[152:155], v2 offset:14336
  v_cmp_eq_u32 s[72:73], 1, v68
  s_waitcnt lgkmcnt(9)
  v_mfma_f32_16x16x32_bf16 v[208:211], a[140:143], v[112:115], v[208:211]
  v_cvt_pk_bf16_f32 v196, v196, v197
  v_cvt_pk_bf16_f32 v197, v198, v199
  v_mfma_f32_16x16x32_bf16 v[212:215], a[136:139], v[100:103], v[212:215]
  v_accvgpr_write_b32 a182, 0
  v_accvgpr_write_b32 a183, 0
  v_mfma_f32_16x16x32_bf16 v[212:215], a[140:143], v[116:119], v[212:215]
  s_waitcnt lgkmcnt(4)
  v_add_f32 v48, v48, v58
  v_add_f32 v49, v49, v59
  v_mfma_f32_16x16x32_bf16 v[216:219], a[136:139], v[104:107], v[216:219]
  ds_read_b128 a[156:159], v2 offset:15360
  v_add_f32 v50, v50, v56
  v_mfma_f32_16x16x32_bf16 v[216:219], a[140:143], v[120:123], v[216:219]
  v_add_f32 v51, v51, v57
  s_waitcnt lgkmcnt(3)
  v_add_f32 v52, v52, v62
  v_mfma_f32_16x16x32_bf16 v[220:223], a[136:139], v[108:111], v[220:223]
  v_cvt_pk_bf16_f32 v194, v208, v209
  v_cvt_pk_bf16_f32 v195, v210, v211
  v_mfma_f32_16x16x32_bf16 v[220:223], a[140:143], v[124:127], v[220:223]
  ds_write_b128 v17, v[192:195] offset:2048
  v_add_f32 v53, v53, v63
  v_mfma_f32_16x16x32_bf16 v[224:227], a[144:147], v[96:99], v[224:227]
  v_cvt_pk_bf16_f32 v198, v212, v213
  v_cvt_pk_bf16_f32 v199, v214, v215
  v_mfma_f32_16x16x32_bf16 v[224:227], a[148:151], v[112:115], v[224:227]
  ds_write_b128 v17, v[196:199] offset:6144
  v_add_f32 v54, v54, v60
  v_mfma_f32_16x16x32_bf16 v[228:231], a[144:147], v[100:103], v[228:231]
  v_add_f32 v55, v55, v61
  v_min3_f32 v56, v48, v49, v50
  v_mfma_f32_16x16x32_bf16 v[228:231], a[148:151], v[116:119], v[228:231]
  v_add_f32 v57, v48, v49
  v_min3_f32 v56, v56, v51, v52
  v_mfma_f32_16x16x32_bf16 v[232:235], a[144:147], v[104:107], v[232:235]
  v_add_f32 v58, v50, v51
  v_min3_f32 v56, v56, v53, v54
  v_mfma_f32_16x16x32_bf16 v[232:235], a[148:151], v[120:123], v[232:235]
  v_add_f32 v59, v52, v53
  v_min_f32 v56, v56, v55
  v_mfma_f32_16x16x32_bf16 v[236:239], a[144:147], v[108:111], v[236:239]
  v_add_f32 v60, v54, v55
  v_add_f32 v57, v57, v58
  v_mfma_f32_16x16x32_bf16 v[236:239], a[148:151], v[124:127], v[236:239]
  v_cvt_pk_bf16_f32 v224, v224, v225
  v_cvt_pk_bf16_f32 v225, v226, v227
  s_waitcnt lgkmcnt(3)
  v_mfma_f32_16x16x32_bf16 v[240:243], a[152:155], v[96:99], v[240:243]
  v_add_f32 v59, v59, v60
  v_add_f32 v57, v57, v59
  s_waitcnt lgkmcnt(2)
  v_mfma_f32_16x16x32_bf16 v[240:243], a[156:159], v[112:115], v[240:243]
  v_cvt_pk_bf16_f32 v228, v228, v229
  v_cvt_pk_bf16_f32 v229, v230, v231
  v_mfma_f32_16x16x32_bf16 v[244:247], a[152:155], v[100:103], v[244:247]
  v_cmp_nle_f32 s[36:37], s40, v56
  v_cmp_nge_f32 s[38:39], s41, v57
  v_mfma_f32_16x16x32_bf16 v[244:247], a[156:159], v[116:119], v[244:247]
  v_cndmask_b32 v48, v48, v52, s[42:43]
  v_cndmask_b32 v70, 0, v69, vcc
  v_mfma_f32_16x16x32_bf16 v[248:251], a[152:155], v[104:107], v[248:251]
  s_or_b64 s[36:37], s[36:37], s[38:39]
  v_cndmask_b32 v71, 0, v69, s[72:73]
  v_accvgpr_write_b32 a180, v70
  v_mfma_f32_16x16x32_bf16 v[248:251], a[156:159], v[120:123], v[248:251]
  s_cmp_lg_u64 s[36:37], 0
  s_cselect_b32 s36, 1, 0
  v_accvgpr_write_b32 a181, v71
  v_accvgpr_write_b32 a184, v70
  v_mfma_f32_16x16x32_bf16 v[252:255], a[152:155], v[108:111], v[252:255]
  s_cmp_gt_u32 s36, s69
  s_cbranch_scc1 L_slow
  v_cvt_pk_bf16_f32 v226, v240, v241
  v_cvt_pk_bf16_f32 v227, v242, v243
  v_mfma_f32_16x16x32_bf16 v[252:255], a[156:159], v[124:127], v[252:255]
  s_waitcnt vmcnt(8)
  v_mfma_f32_16x16x32_bf16 a[104:107], a[68:71], a[64:67], 0
  s_waitcnt vmcnt(6)
  v_mfma_f32_16x16x32_bf16 a[104:107], a[76:79], a[72:75], a[104:107]
  s_waitcnt vmcnt(4)
  v_mfma_f32_16x16x32_bf16 a[104:107], a[84:87], a[80:83], a[104:107]
  s_waitcnt vmcnt(2)
  v_mfma_f32_16x16x32_bf16 a[104:107], a[92:95], a[88:91], a[104:107]
  s_waitcnt vmcnt(0)
  v_mfma_f32_16x16x32_bf16 a[104:107], a[100:103], a[96:99], a[104:107]
  ds_write_b128 v17, v[224:227] offset:3072
  v_cndmask_b32 v49, v49, v53, s[42:43]
  v_cvt_pk_bf16_f32 v230, v244, v245
  v_cvt_pk_bf16_f32 v231, v246, v247
  ds_write_b128 v17, v[228:231] offset:7168
  v_cndmask_b32 v50, v50, v54, s[42:43]
  v_cndmask_b32 v51, v51, v55, s[42:43]
  v_cndmask_b32 v28, v50, v48, s[74:75]
  v_cndmask_b32 v30, v51, v49, s[74:75]
  v_rcp_f32 v28, v28
  v_rcp_f32 v30, v30
  v_accvgpr_write_b32 a185, v71
  v_lshlrev_b32 v64, 7, v0
  v_cmp_gt_u32 vcc, 40, v0
  s_nop 1
  v_cndmask_b32 v64, v21, v64, vcc
  buffer_load_dword a186, v64, s[44:47], s11 offen
  v_lshlrev_b32 v22, 2, v0
  v_cmp_gt_u32 vcc, 16, v0
  s_nop 1
  v_cndmask_b32 v22, v21, v22, vcc
  ds_write_b128 v19, a[104:107] offset:4096
  s_branch L_fin0
L_pw1:
HS23:
  s_cbranch_execz HOPR_d
  v_exp_f32 v60, v60
  v_exp_f32 v61, v61
  v_mfma_f32_16x16x32_bf16 v[128:131], a[128:131], v[96:99], v[128:131]
  s_lshl_b32 s79, s82, 8
  ds_read_b128 a[144:147], v2 offset:4096
  v_exp_f32 v62, v62
  v_mfma_f32_16x16x32_bf16 v[128:131], a[132:135], v[112:115], v[128:131]
  s_add_u32 s79, s79, 524288
  v_exp_f32 v63, v63
  v_mfma_f32_16x16x32_bf16 v[132:135], a[128:131], v[100:103], v[132:135]
  s_cmp_eq_u32 s69, 0
  s_cselect_b32 s66, s79, 0x40000000
  v_cvt_pk_bf16_f32 v126, v60, v61
  v_add_u32 v17, 131072, v5
  v_mfma_f32_16x16x32_bf16 v[132:135], a[132:135], v[116:119], v[132:135]
  v_cvt_pk_bf16_f32 v127, v62, v63
  v_xor_b32 v4, 0x4000, v17
  v_mfma_f32_16x16x32_bf16 v[136:139], a[128:131], v[104:107], v[136:139]
  s_lshl_b32 s52, s48, 10
  ds_read_b128 a[148:151], v2 offset:5120
  v_mfma_f32_16x16x32_bf16 v[136:139], a[132:135], v[120:123], v[136:139]
  buffer_atomic_add v20, v16, s[28:31], s66 offen offset:128
  v_add_u32 v18, 98304, v3
  v_add_u32 v19, s52, v18
  v_mfma_f32_16x16x32_bf16 v[140:143], a[128:131], v[108:111], v[140:143]
  v_min_u32 v6, 35, v0
  v_lshlrev_b32 v6, 7, v6
  v_mfma_f32_16x16x32_bf16 v[140:143], a[132:135], v[124:127], v[140:143]
  v_cvt_pk_bf16_f32 v128, v128, v129
  v_cvt_pk_bf16_f32 v129, v130, v131
  v_mfma_f32_16x16x32_bf16 a[164:167], a[160:163], v[96:99], a[164:167]
  v_add_u32 v6, 475136, v6
  v_mfma_f32_16x16x32_bf16 a[164:167], a[160:163], v[112:115], a[164:167]
  buffer_load_dword v22, v6, s[28:31], 0 offen sc1
  v_cvt_pk_bf16_f32 v132, v132, v133
  v_cvt_pk_bf16_f32 v133, v134, v135
  s_waitcnt lgkmcnt(3)
  v_mfma_f32_16x16x32_bf16 v[144:147], a[136:139], v[96:99], v[144:147]
  s_add_u32 s55, s49, 0
  ds_read_b128 a[152:155], v2 offset:6144
  s_waitcnt lgkmcnt(3)
  v_mfma_f32_16x16x32_bf16 v[144:147], a[140:143], v[112:115], v[144:147]
  s_and_b32 s55, s55, 3
  v_mfma_f32_16x16x32_bf16 v[148:151], a[136:139], v[100:103], v[148:151]
  s_mul_i32 s55, s55, 163840
  v_mfma_f32_16x16x32_bf16 v[148:151], a[140:143], v[116:119], v[148:151]
  s_add_u32 s55, s55, s54
  v_mfma_f32_16x16x32_bf16 a[168:171], a[160:163], v[100:103], a[168:171]
  s_add_u32 m0, s71, 0
  v_mfma_f32_16x16x32_bf16 a[168:171], a[160:163], v[116:119], a[168:171]
  buffer_load_dwordx4 v23, s[44:47], s55 offen lds
  v_mfma_f32_16x16x32_bf16 v[152:155], a[136:139], v[104:107], v[152:155]
  s_add_u32 m0, s71, 1024
  ds_read_b128 a[156:159], v2 offset:7168
  v_cvt_pk_bf16_f32 v130, v144, v145
  v_mfma_f32_16x16x32_bf16 v[152:155], a[140:143], v[120:123], v[152:155]
  buffer_load_dwordx4 v24, s[44:47], s55 offen lds
  v_cvt_pk_bf16_f32 v131, v146, v147
  v_mfma_f32_16x16x32_bf16 v[156:159], a[136:139], v[108:111], v[156:159]
  ds_write_b128 v17, v[128:131] offset:0
  v_mfma_f32_16x16x32_bf16 v[156:159], a[140:143], v[124:127], v[156:159]
  v_cvt_pk_bf16_f32 v134, v148, v149
  v_cvt_pk_bf16_f32 v135, v150, v151
  v_mfma_f32_16x16x32_bf16 a[172:175], a[160:163], v[104:107], a[172:175]
  ds_write_b128 v17, v[132:135] offset:4096
  v_mfma_f32_16x16x32_bf16 a[172:175], a[160:163], v[120:123], a[172:175]
  s_add_u32 m0, s71, 2048
  s_waitcnt lgkmcnt(5)
  v_mfma_f32_16x16x32_bf16 v[160:163], a[144:147], v[96:99], v[160:163]
  ds_read_b128 a[128:131], v2 offset:8192
  s_waitcnt lgkmcnt(5)
  v_mfma_f32_16x16x32_bf16 v[160:163], a[148:151], v[112:115], v[160:163]
  buffer_load_dwordx4 v25, s[44:47], s55 offen lds
  v_mfma_f32_16x16x32_bf16 v[164:167], a[144:147], v[100:103], v[164:167]
  v_mfma_f32_16x16x32_bf16 v[164:167], a[148:151], v[116:119], v[164:167]
  v_mfma_f32_16x16x32_bf16 a[176:179], a[160:163], v[108:111], a[176:179]
  v_mfma_f32_16x16x32_bf16 a[176:179], a[160:163], v[124:127], a[176:179]
  s_add_u32 m0, s71, 3072
  v_mfma_f32_16x16x32_bf16 v[168:171], a[144:147], v[104:107], v[168:171]
  ds_read_b128 a[132:135], v2 offset:9216
  buffer_load_dwordx4 v26, s[44:47], s55 offen lds
  v_mfma_f32_16x16x32_bf16 v[168:171], a[148:151], v[120:123], v[168:171]
  v_cvt_pk_bf16_f32 v160, v160, v161
  v_cvt_pk_bf16_f32 v161, v162, v163
  v_mfma_f32_16x16x32_bf16 v[172:175], a[144:147], v[108:111], v[172:175]
  v_mfma_f32_16x16x32_bf16 v[172:175], a[148:151], v[124:127], v[172:175]
  v_cvt_pk_bf16_f32 v164, v164, v165
  v_cvt_pk_bf16_f32 v165, v166, v167
  s_waitcnt lgkmcnt(5)
  v_mfma_f32_16x16x32_bf16 v[176:179], a[152:155], v[96:99], v[176:179]
  ds_read_b128 a[136:139], v2 offset:10240
  v_accvgpr_read_b32 v28, a164
  s_waitcnt lgkmcnt(5)
  v_mfma_f32_16x16x32_bf16 v[176:179], a[156:159], v[112:115], v[176:179]
  s_add_u32 m0, s71, 4096
  v_accvgpr_read_b32 v29, a168
  v_accvgpr_read_b32 v30, a172
  v_mfma_f32_16x16x32_bf16 v[180:183], a[152:155], v[100:103], v[180:183]
  buffer_load_dwordx4 v27, s[44:47], s55 offen lds
  v_accvgpr_read_b32 v31, a176
  v_mfma_f32_16x16x32_bf16 v[180:183], a[156:159], v[116:119], v[180:183]
  ds_write_b128 v19, v[28:31]
  v_mfma_f32_16x16x32_bf16 v[184:187], a[152:155], v[104:107], v[184:187]
  ds_read_b128 a[140:143], v2 offset:11264
  v_mfma_f32_16x16x32_bf16 v[184:187], a[156:159], v[120:123], v[184:187]
  s_add_u32 s55, s55, 20480
  v_mfma_f32_16x16x32_bf16 v[188:191], a[152:155], v[108:111], v[188:191]
  s_add_u32 m0, s71, 5120
  v_cvt_pk_bf16_f32 v162, v176, v177
  v_cvt_pk_bf16_f32 v163, v178, v179
  v_mfma_f32_16x16x32_bf16 v[188:191], a[156:159], v[124:127], v[188:191]
  ds_write_b128 v17, v[160:163] offset:1024
  buffer_load_dwordx4 v23, s[44:47], s55 offen lds
  s_waitcnt lgkmcnt(5)
  v_mfma_f32_16x16x32_bf16 v[192:195], a[128:131], v[96:99], v[192:195]
  s_waitcnt lgkmcnt(2)
  s_barrier
  ds_read_b128 a[144:147], v2 offset:12288
  v_cvt_pk_bf16_f32 v166, v180, v181
  v_mfma_f32_16x16x32_bf16 v[192:195], a[132:135], v[112:115], v[192:195]
  ds_read_b128 v[48:51], v18 offset:0
  v_cvt_pk_bf16_f32 v167, v182, v183
  v_mfma_f32_16x16x32_bf16 v[196:199], a[128:131], v[100:103], v[196:199]
  ds_read_b128 v[52:55], v18 offset:1024
  v_mfma_f32_16x16x32_bf16 v[196:199], a[132:135], v[116:119], v[196:199]
  ds_read_b128 v[56:59], v18 offset:2048
  v_mfma_f32_16x16x32_bf16 v[200:203], a[128:131], v[104:107], v[200:203]
  s_add_u32 m0, s71, 6144
  ds_read_b128 a[148:151], v2 offset:13312
  v_mfma_f32_16x16x32_bf16 v[200:203], a[132:135], v[120:123], v[200:203]
  ds_read_b128 v[60:63], v18 offset:3072
  buffer_load_dwordx4 v24, s[44:47], s55 offen lds
  v_mfma_f32_16x16x32_bf16 v[204:207], a[128:131], v[108:111], v[204:207]
  ds_write_b128 v17, v[164:167] offset:5120
  v_mfma_f32_16x16x32_bf16 v[204:207], a[132:135], v[124:127], v[204:207]
  v_cvt_pk_bf16_f32 v192, v192, v193
  v_cvt_pk_bf16_f32 v193, v194, v195
  v_mfma_f32_16x16x32_bf16 v[208:211], a[136:139], v[96:99], v[208:211]
  ds_read_b128 a[152:155], v2 offset:14336
  s_waitcnt lgkmcnt(9)
  v_mfma_f32_16x16x32_bf16 v[208:211], a[140:143], v[112:115], v[208:211]
  v_cvt_pk_bf16_f32 v196, v196, v197
  v_cvt_pk_bf16_f32 v197, v198, v199
  v_mfma_f32_16x16x32_bf16 v[212:215], a[136:139], v[100:103], v[212:215]
  s_add_u32 m0, s71, 7168
  v_mfma_f32_16x16x32_bf16 v[212:215], a[140:143], v[116:119], v[212:215]
  buffer_load_dwordx4 v25, s[44:47], s55 offen lds
  s_waitcnt lgkmcnt(4)
  v_add_f32 v48, v48, v58
  v_add_f32 v49, v49, v59
  v_mfma_f32_16x16x32_bf16 v[216:219], a[136:139], v[104:107], v[216:219]
HS24:
  s_cbranch_execz HOPR_d
  ds_read_b128 a[156:159], v2 offset:15360
  v_add_f32 v50, v50, v56
  v_mfma_f32_16x16x32_bf16 v[216:219], a[140:143], v[120:123], v[216:219]
  v_add_f32 v51, v51, v57
  s_waitcnt lgkmcnt(3)
  v_add_f32 v52, v52, v62
  v_mfma_f32_16x16x32_bf16 v[220:223], a[136:139], v[108:111], v[220:223]
  v_cvt_pk_bf16_f32 v194, v208, v209
  v_cvt_pk_bf16_f32 v195, v210, v211
  v_mfma_f32_16x16x32_bf16 v[220:223], a[140:143], v[124:127], v[220:223]
  s_add_u32 m0, s71, 8192
  ds_write_b128 v17, v[192:195] offset:2048
  v_add_f32 v53, v53, v63
  v_mfma_f32_16x16x32_bf16 v[224:227], a[144:147], v[96:99], v[224:227]
  buffer_load_dwordx4 v26, s[44:47], s55 offen lds
  v_cvt_pk_bf16_f32 v198, v212, v213
  v_cvt_pk_bf16_f32 v199, v214, v215
  v_mfma_f32_16x16x32_bf16 v[224:227], a[148:151], v[112:115], v[224:227]
  ds_write_b128 v17, v[196:199] offset:6144
  v_add_f32 v54, v54, v60
  v_mfma_f32_16x16x32_bf16 v[228:231], a[144:147], v[100:103], v[228:231]
  v_add_f32 v55, v55, v61
  v_min3_f32 v56, v48, v49, v50
  v_mfma_f32_16x16x32_bf16 v[228:231], a[148:151], v[116:119], v[228:231]
  v_add_f32 v57, v48, v49
  v_min3_f32 v56, v56, v51, v52
  v_mfma_f32_16x16x32_bf16 v[232:235], a[144:147], v[104:107], v[232:235]
  v_add_f32 v58, v50, v51
  v_min3_f32 v56, v56, v53, v54
  v_mfma_f32_16x16x32_bf16 v[232:235], a[148:151], v[120:123], v[232:235]
  s_add_u32 m0, s71, 9216
  v_add_f32 v59, v52, v53
  v_min_f32 v56, v56, v55
  v_mfma_f32_16x16x32_bf16 v[236:239], a[144:147], v[108:111], v[236:239]
  buffer_load_dwordx4 v27, s[44:47], s55 offen lds
  v_add_f32 v60, v54, v55
  v_add_f32 v57, v57, v58
  v_mfma_f32_16x16x32_bf16 v[236:239], a[148:151], v[124:127], v[236:239]
  v_cvt_pk_bf16_f32 v224, v224, v225
  v_cvt_pk_bf16_f32 v225, v226, v227
  s_waitcnt lgkmcnt(3)
  v_mfma_f32_16x16x32_bf16 v[240:243], a[152:155], v[96:99], v[240:243]
  v_add_f32 v59, v59, v60
  v_add_f32 v57, v57, v59
  s_waitcnt lgkmcnt(2)
  v_mfma_f32_16x16x32_bf16 v[240:243], a[156:159], v[112:115], v[240:243]
  v_cvt_pk_bf16_f32 v228, v228, v229
  v_cvt_pk_bf16_f32 v229, v230, v231
  v_mfma_f32_16x16x32_bf16 v[244:247], a[152:155], v[100:103], v[244:247]
  v_cmp_nle_f32 s[36:37], s40, v56
  v_cmp_nge_f32 s[38:39], s41, v57
  v_mfma_f32_16x16x32_bf16 v[244:247], a[156:159], v[116:119], v[244:247]
  v_cndmask_b32 v48, v48, v52, s[42:43]
  v_mfma_f32_16x16x32_bf16 v[248:251], a[152:155], v[104:107], v[248:251]
  s_or_b64 s[36:37], s[36:37], s[38:39]
  v_mfma_f32_16x16x32_bf16 v[248:251], a[156:159], v[120:123], v[248:251]
  s_cmp_lg_u64 s[36:37], 0
  s_cselect_b32 s36, 1, 0
  v_mfma_f32_16x16x32_bf16 v[252:255], a[152:155], v[108:111], v[252:255]
  s_cmp_gt_u32 s36, s69
  s_cbranch_scc1 L_slow
  v_cvt_pk_bf16_f32 v226, v240, v241
  v_cvt_pk_bf16_f32 v227, v242, v243
  v_mfma_f32_16x16x32_bf16 v[252:255], a[156:159], v[124:127], v[252:255]
  ds_write_b128 v17, v[224:227] offset:3072
  v_cndmask_b32 v49, v49, v53, s[42:43]
  v_cvt_pk_bf16_f32 v230, v244, v245
  v_cvt_pk_bf16_f32 v231, v246, v247
  ds_write_b128 v17, v[228:231] offset:7168
  v_cndmask_b32 v50, v50, v54, s[42:43]
  v_cndmask_b32 v51, v51, v55, s[42:43]
  v_cndmask_b32 v28, v50, v48, s[74:75]
  v_cndmask_b32 v30, v51, v49, s[74:75]
  v_rcp_f32 v28, v28
  v_rcp_f32 v30, v30
  s_branch L_fin1
L_pvd0:
  s_waitcnt lgkmcnt(6)
  v_mfma_f32_16x16x32_bf16 v[128:131], a[128:131], v[64:67], 0
  s_lshl_b32 s79, s82, 8
  ds_read_b128 a[144:147], v2 offset:36864
  v_mfma_f32_16x16x32_bf16 v[132:135], a[128:131], v[68:71], 0
  s_add_u32 s79, s79, 524288
  v_mfma_f32_16x16x32_bf16 v[136:139], a[128:131], v[72:75], 0
  s_cmp_eq_u32 s69, 0
  s_cselect_b32 s66, s79, 0x40000000
  ds_read_b128 a[148:151], v2 offset:37888
  v_add_u32 v17, 131072, v5
  v_mfma_f32_16x16x32_bf16 v[140:143], a[128:131], v[76:79], 0
  s_waitcnt vmcnt(2)
  v_xor_b32 v4, 0x4000, v17
  s_waitcnt lgkmcnt(6)
  v_mfma_f32_16x16x32_bf16 v[140:143], a[132:135], v[92:95], v[140:143]
  s_lshl_b32 s52, s48, 10
  buffer_atomic_add v20, v16, s[28:31], s66 offen offset:128
  v_mfma_f32_16x16x32_bf16 a[164:167], a[160:163], v[64:67], 0
  v_min_u32 v6, 35, v0
  v_lshlrev_b32 v6, 7, v6
  v_add_u32 v18, 65536, v3
  v_add_u32 v19, s52, v18
  s_waitcnt lgkmcnt(4)
  v_mfma_f32_16x16x32_bf16 v[144:147], a[136:139], v[64:67], 0
  ds_read_b128 a[152:155], v2 offset:38912
  v_cvt_pk_bf16_f32 v128, v128, v129
  v_mfma_f32_16x16x32_bf16 v[148:151], a[136:139], v[68:71], 0
  v_cvt_pk_bf16_f32 v129, v130, v131
  v_cvt_pk_bf16_f32 v132, v132, v133
  v_mfma_f32_16x16x32_bf16 a[168:171], a[160:163], v[68:71], 0
  v_cvt_pk_bf16_f32 v133, v134, v135
  v_add_u32 v6, 475136, v6
  v_mfma_f32_16x16x32_bf16 v[152:155], a[136:139], v[72:75], 0
  ds_read_b128 a[156:159], v2 offset:39936
  v_mfma_f32_16x16x32_bf16 v[156:159], a[136:139], v[76:79], 0
  buffer_load_dword v22, v6, s[28:31], 0 offen sc1
  s_waitcnt lgkmcnt(4)
  v_mfma_f32_16x16x32_bf16 v[156:159], a[140:143], v[92:95], v[156:159]
  v_cvt_pk_bf16_f32 v130, v144, v145
  v_cvt_pk_bf16_f32 v131, v146, v147
  v_mfma_f32_16x16x32_bf16 a[172:175], a[160:163], v[72:75], 0
  ds_write_b128 v17, v[128:131] offset:0
  v_lshlrev_b32 v21, 7, v0
  s_waitcnt lgkmcnt(4)
  v_mfma_f32_16x16x32_bf16 v[160:163], a[144:147], v[64:67], 0
  ds_read_b128 a[128:131], v2 offset:40960
  v_cvt_pk_bf16_f32 v134, v148, v149
  v_mfma_f32_16x16x32_bf16 v[164:167], a[144:147], v[68:71], 0
  buffer_load_dword a186, v21, s[28:31], s81 offen sc1
  v_cvt_pk_bf16_f32 v135, v150, v151
  v_mfma_f32_16x16x32_bf16 a[176:179], a[160:163], v[76:79], 0
  s_add_u32 s55, s49, 0
  ds_write_b128 v17, v[132:135] offset:4096
  v_mfma_f32_16x16x32_bf16 a[176:179], a[160:163], v[92:95], a[176:179]
  s_and_b32 s55, s55, 3
  v_mfma_f32_16x16x32_bf16 v[168:171], a[144:147], v[72:75], 0
  s_mul_i32 s55, s55, 163840
  ds_read_b128 a[132:135], v2 offset:41984
  v_mfma_f32_16x16x32_bf16 v[172:175], a[144:147], v[76:79], 0
  s_add_u32 s55, s55, s54
  s_waitcnt lgkmcnt(6)
  v_mfma_f32_16x16x32_bf16 v[172:175], a[148:151], v[92:95], v[172:175]
  s_add_u32 m0, s71, 0
  v_cvt_pk_bf16_f32 v160, v160, v161
  v_cvt_pk_bf16_f32 v161, v162, v163
  s_waitcnt lgkmcnt(5)
  v_mfma_f32_16x16x32_bf16 v[176:179], a[152:155], v[64:67], 0
  ds_read_b128 a[136:139], v2 offset:43008
  v_cvt_pk_bf16_f32 v164, v164, v165
  v_mfma_f32_16x16x32_bf16 v[180:183], a[152:155], v[68:71], 0
  buffer_load_dwordx4 v23, s[44:47], s55 offen lds
  v_accvgpr_read_b32 v28, a164
  v_accvgpr_read_b32 v29, a168
  v_mfma_f32_16x16x32_bf16 v[184:187], a[152:155], v[72:75], 0
  s_add_u32 m0, s71, 1024
  ds_read_b128 a[140:143], v2 offset:44032
  v_accvgpr_read_b32 v30, a172
  v_mfma_f32_16x16x32_bf16 v[188:191], a[152:155], v[76:79], 0
  buffer_load_dwordx4 v24, s[44:47], s55 offen lds
  v_accvgpr_read_b32 v31, a176
  v_cvt_pk_bf16_f32 v165, v166, v167
  s_waitcnt lgkmcnt(6)
  v_mfma_f32_16x16x32_bf16 v[188:191], a[156:159], v[92:95], v[188:191]
  s_add_u32 m0, s71, 2048
  ds_write_b128 v19, v[28:31]
  s_waitcnt lgkmcnt(5)
  v_mfma_f32_16x16x32_bf16 v[192:195], a[128:131], v[64:67], 0
  ds_read_b128 a[144:147], v2 offset:45056
  v_cvt_pk_bf16_f32 v162, v176, v177
  v_mfma_f32_16x16x32_bf16 v[196:199], a[128:131], v[68:71], 0
  buffer_load_dwordx4 v25, s[44:47], s55 offen lds
  v_cvt_pk_bf16_f32 v163, v178, v179
  v_mfma_f32_16x16x32_bf16 v[200:203], a[128:131], v[72:75], 0
  s_add_u32 m0, s71, 3072
  ds_read_b128 a[148:151], v2 offset:46080
  v_mfma_f32_16x16x32_bf16 v[204:207], a[128:131], v[76:79], 0
  ds_write_b128 v17, v[160:163] offset:1024
  s_waitcnt vmcnt(8)
  buffer_load_dwordx4 v26, s[44:47], s55 offen lds
  s_waitcnt lgkmcnt(6)
  v_mfma_f32_16x16x32_bf16 v[204:207], a[132:135], v[92:95], v[204:207]
  s_waitcnt lgkmcnt(3)
  s_barrier
  s_add_u32 m0, s71, 4096
  v_cvt_pk_bf16_f32 v166, v180, v181
  v_cvt_pk_bf16_f32 v167, v182, v183
  v_mfma_f32_16x16x32_bf16 v[208:211], a[136:139], v[64:67], 0
  ds_read_b128 a[152:155], v2 offset:47104
  buffer_load_dwordx4 v27, s[44:47], s55 offen lds
  v_mfma_f32_16x16x32_bf16 v[212:215], a[136:139], v[68:71], 0
  s_add_u32 s55, s55, 20480
  ds_read_b128 v[48:51], v18 offset:0
  v_cvt_pk_bf16_f32 v192, v192, v193
  v_mfma_f32_16x16x32_bf16 v[216:219], a[136:139], v[72:75], 0
  s_add_u32 m0, s71, 5120
  ds_read_b128 a[156:159], v2 offset:48128
  v_cvt_pk_bf16_f32 v193, v194, v195
  v_mfma_f32_16x16x32_bf16 v[220:223], a[136:139], v[76:79], 0
  ds_read_b128 v[52:55], v18 offset:1024
  buffer_load_dwordx4 v23, s[44:47], s55 offen lds
  v_cvt_pk_bf16_f32 v196, v196, v197
  v_mfma_f32_16x16x32_bf16 v[220:223], a[140:143], v[92:95], v[220:223]
  s_add_u32 m0, s71, 6144
  ds_read_b128 v[56:59], v18 offset:2048
  v_cvt_pk_bf16_f32 v197, v198, v199
  s_waitcnt lgkmcnt(7)
  v_mfma_f32_16x16x32_bf16 v[224:227], a[144:147], v[64:67], 0
  ds_read_b128 v[60:63], v18 offset:3072
  buffer_load_dwordx4 v24, s[44:47], s55 offen lds
  v_mfma_f32_16x16x32_bf16 v[228:231], a[144:147], v[68:71], 0
  s_add_u32 m0, s71, 7168
  ds_write_b128 v17, v[164:167] offset:5120
  v_mfma_f32_16x16x32_bf16 v[232:235], a[144:147], v[72:75], 0
  buffer_load_dwordx4 v25, s[44:47], s55 offen lds
  v_cvt_pk_bf16_f32 v194, v208, v209
  v_cvt_pk_bf16_f32 v195, v210, v211
  v_mfma_f32_16x16x32_bf16 v[236:239], a[144:147], v[76:79], 0
  s_add_u32 m0, s71, 8192
  ds_write_b128 v17, v[192:195] offset:2048
  s_waitcnt lgkmcnt(9)
  v_mfma_f32_16x16x32_bf16 v[236:239], a[148:151], v[92:95], v[236:239]
  buffer_load_dwordx4 v26, s[44:47], s55 offen lds
  v_cvt_pk_bf16_f32 v198, v212, v213
  v_cvt_pk_bf16_f32 v199, v214, v215
  s_waitcnt lgkmcnt(7)
  v_mfma_f32_16x16x32_bf16 v[240:243], a[152:155], v[64:67], 0
  s_add_u32 m0, s71, 9216
  ds_write_b128 v17, v[196:199] offset:6144
  v_mfma_f32_16x16x32_bf16 v[244:247], a[152:155], v[68:71], 0
  buffer_load_dwordx4 v27, s[44:47], s55 offen lds
  v_cvt_pk_bf16_f32 v224, v224, v225
  v_cvt_pk_bf16_f32 v225, v226, v227
  v_mfma_f32_16x16x32_bf16 v[248:251], a[152:155], v[72:75], 0
  v_cvt_pk_bf16_f32 v228, v228, v229
  v_cvt_pk_bf16_f32 v229, v230, v231
  v_mfma_f32_16x16x32_bf16 v[252:255], a[152:155], v[76:79], 0
  s_waitcnt lgkmcnt(4)
  v_add_f32 v48, v48, v58
  v_add_f32 v49, v49, v59
  v_mfma_f32_16x16x32_bf16 v[252:255], a[156:159], v[92:95], v[252:255]
  v_add_f32 v50, v50, v56
  v_add_f32 v51, v51, v57
  v_cvt_pk_bf16_f32 v226, v240, v241
  v_cvt_pk_bf16_f32 v227, v242, v243
  ds_write_b128 v17, v[224:227] offset:3072
  v_cvt_pk_bf16_f32 v230, v244, v245
  v_cvt_pk_bf16_f32 v231, v246, v247
  ds_write_b128 v17, v[228:231] offset:7168
  s_waitcnt lgkmcnt(5)
  v_add_f32 v52, v52, v62
  v_add_f32 v53, v53, v63
  v_add_f32 v54, v54, v60
  v_add_f32 v55, v55, v61
  v_min3_f32 v56, v48, v49, v50
  v_add_f32 v57, v48, v49
  v_min3_f32 v56, v56, v51, v52
  v_add_f32 v58, v50, v51
  v_min3_f32 v56, v56, v53, v54
  v_add_f32 v59, v52, v53
  v_min_f32 v56, v56, v55
  v_add_f32 v60, v54, v55
  v_add_f32 v57, v57, v58
  v_add_f32 v59, v59, v60
  v_add_f32 v57, v57, v59
  v_cmp_nle_f32 s[36:37], s40, v56
  v_cmp_nge_f32 s[38:39], s41, v57
  v_cndmask_b32 v48, v48, v52, s[42:43]
  s_or_b64 s[36:37], s[36:37], s[38:39]
  s_cmp_lg_u64 s[36:37], 0
  s_cselect_b32 s36, 1, 0
  s_cmp_gt_u32 s36, s69
  s_cbranch_scc1 L_slow
  v_cndmask_b32 v49, v49, v53, s[42:43]
  v_cndmask_b32 v50, v50, v54, s[42:43]
  v_cndmask_b32 v51, v51, v55, s[42:43]
  v_cndmask_b32 v28, v50, v48, s[74:75]
  v_cndmask_b32 v30, v51, v49, s[74:75]
  v_rcp_f32 v28, v28
  v_rcp_f32 v30, v30
  s_branch L_fin1
L_pvd1:
  s_waitcnt lgkmcnt(6)
  v_mfma_f32_16x16x32_bf16 v[128:131], a[128:131], v[64:67], 0
  s_lshl_b32 s79, s82, 8
  ds_read_b128 a[144:147], v2 offset:36864
  v_mov_b32 v136, 0
  s_waitcnt lgkmcnt(5)
  v_mfma_f32_16x16x32_bf16 v[128:131], a[132:135], v[80:83], v[128:131]
  s_add_u32 s79, s79, 524288
  v_mov_b32 v137, 0
  v_mfma_f32_16x16x32_bf16 v[132:135], a[128:131], v[68:71], 0
  s_cmp_eq_u32 s69, 0
  s_cselect_b32 s66, s79, 0x40000000
  v_mov_b32 v138, 0
  v_add_u32 v17, 131072, v5
  v_mfma_f32_16x16x32_bf16 v[132:135], a[132:135], v[84:87], v[132:135]
  s_waitcnt vmcnt(1)
  v_mov_b32 v139, 0
  v_xor_b32 v4, 0x4000, v17
  v_mfma_f32_16x16x32_bf16 v[140:143], a[128:131], v[76:79], 0
  s_lshl_b32 s52, s48, 10
  ds_read_b128 a[148:151], v2 offset:37888
  v_mov_b32 v152, 0
  v_mfma_f32_16x16x32_bf16 a[164:167], a[160:163], v[64:67], 0
  buffer_atomic_add v20, v16, s[28:31], s66 offen offset:128
  v_mov_b32 v153, 0
  v_add_u32 v18, 65536, v3
  v_add_u32 v19, s52, v18
  v_mfma_f32_16x16x32_bf16 a[164:167], a[160:163], v[80:83], a[164:167]
  v_min_u32 v6, 35, v0
  v_lshlrev_b32 v6, 7, v6
  v_mov_b32 v154, 0
  s_waitcnt lgkmcnt(4)
  v_mfma_f32_16x16x32_bf16 v[144:147], a[136:139], v[64:67], 0
  ds_read_b128 a[152:155], v2 offset:38912
  v_cvt_pk_bf16_f32 v128, v128, v129
  v_mov_b32 v155, 0
  s_waitcnt lgkmcnt(3)
  v_mfma_f32_16x16x32_bf16 v[144:147], a[140:143], v[80:83], v[144:147]
  v_cvt_pk_bf16_f32 v129, v130, v131
  v_add_u32 v6, 475136, v6
  v_mov_b32 v168, 0
  v_mfma_f32_16x16x32_bf16 v[148:151], a[136:139], v[68:71], 0
  v_cvt_pk_bf16_f32 v132, v132, v133
  v_cvt_pk_bf16_f32 v133, v134, v135
  v_mov_b32 v169, 0
  v_mfma_f32_16x16x32_bf16 v[148:151], a[140:143], v[84:87], v[148:151]
  buffer_load_dword v22, v6, s[28:31], 0 offen sc1
  v_mov_b32 v170, 0
  v_mfma_f32_16x16x32_bf16 a[168:171], a[160:163], v[68:71], 0
  v_lshlrev_b32 v21, 7, v0
  v_mov_b32 v171, 0
  v_mfma_f32_16x16x32_bf16 a[168:171], a[160:163], v[84:87], a[168:171]
  buffer_load_dword a186, v21, s[28:31], s81 offen sc1
  v_mov_b32 v184, 0
  v_mfma_f32_16x16x32_bf16 v[156:159], a[136:139], v[76:79], 0
  s_add_u32 s55, s49, 0
  ds_read_b128 a[156:159], v2 offset:39936
  v_cvt_pk_bf16_f32 v130, v144, v145
  v_mov_b32 v185, 0
  s_waitcnt lgkmcnt(3)
  v_mfma_f32_16x16x32_bf16 v[160:163], a[144:147], v[64:67], 0
  s_and_b32 s55, s55, 3
  ds_read_b128 a[128:131], v2 offset:40960
  v_cvt_pk_bf16_f32 v131, v146, v147
  v_mov_b32 v186, 0
  s_waitcnt lgkmcnt(3)
  v_mfma_f32_16x16x32_bf16 v[160:163], a[148:151], v[80:83], v[160:163]
  s_mul_i32 s55, s55, 163840
  ds_write_b128 v17, v[128:131] offset:0
  v_mov_b32 v187, 0
  v_mfma_f32_16x16x32_bf16 v[164:167], a[144:147], v[68:71], 0
  s_add_u32 s55, s55, s54
  v_cvt_pk_bf16_f32 v134, v148, v149
  v_cvt_pk_bf16_f32 v135, v150, v151
  v_mov_b32 v200, 0
  v_mfma_f32_16x16x32_bf16 v[164:167], a[148:151], v[84:87], v[164:167]
  s_add_u32 m0, s71, 0
  ds_write_b128 v17, v[132:135] offset:4096
  v_mov_b32 v201, 0
  v_mfma_f32_16x16x32_bf16 a[176:179], a[160:163], v[76:79], 0
  buffer_load_dwordx4 v23, s[44:47], s55 offen lds
  v_mov_b32 v202, 0
  v_mfma_f32_16x16x32_bf16 v[172:175], a[144:147], v[76:79], 0
  s_add_u32 m0, s71, 1024
  ds_read_b128 a[132:135], v2 offset:41984
  v_mov_b32 v203, 0
  s_waitcnt lgkmcnt(5)
  v_mfma_f32_16x16x32_bf16 v[176:179], a[152:155], v[64:67], 0
  ds_read_b128 a[136:139], v2 offset:43008
  v_mov_b32 v216, 0
  s_waitcnt lgkmcnt(5)
  v_mfma_f32_16x16x32_bf16 v[176:179], a[156:159], v[80:83], v[176:179]
  buffer_load_dwordx4 v24, s[44:47], s55 offen lds
  v_cvt_pk_bf16_f32 v160, v160, v161
  v_cvt_pk_bf16_f32 v161, v162, v163
  v_mov_b32 v217, 0
  v_mfma_f32_16x16x32_bf16 v[180:183], a[152:155], v[68:71], 0
  s_add_u32 m0, s71, 2048
  v_mov_b32 v218, 0
  v_mfma_f32_16x16x32_bf16 v[180:183], a[156:159], v[84:87], v[180:183]
  buffer_load_dwordx4 v25, s[44:47], s55 offen lds
  v_accvgpr_read_b32 v28, a164
  v_accvgpr_read_b32 v29, a168
  v_mov_b32 v219, 0
  v_mfma_f32_16x16x32_bf16 v[188:191], a[152:155], v[76:79], 0
  s_add_u32 m0, s71, 3072
  ds_read_b128 a[140:143], v2 offset:44032
  v_accvgpr_read_b32 v30, a172
  v_mov_b32 v232, 0
  s_waitcnt lgkmcnt(5)
  v_mfma_f32_16x16x32_bf16 v[192:195], a[128:131], v[64:67], 0
  ds_read_b128 a[144:147], v2 offset:45056
  s_waitcnt vmcnt(7)
  buffer_load_dwordx4 v26, s[44:47], s55 offen lds
  v_accvgpr_read_b32 v31, a176
  v_mov_b32 v233, 0
  s_waitcnt lgkmcnt(3)
  v_mfma_f32_16x16x32_bf16 v[192:195], a[132:135], v[80:83], v[192:195]
  s_add_u32 m0, s71, 4096
  ds_write_b128 v19, v[28:31]
  v_cvt_pk_bf16_f32 v162, v176, v177
  v_mov_b32 v234, 0
  v_mfma_f32_16x16x32_bf16 v[196:199], a[128:131], v[68:71], 0
  buffer_load_dwordx4 v27, s[44:47], s55 offen lds
  v_cvt_pk_bf16_f32 v163, v178, v179
  v_cvt_pk_bf16_f32 v164, v164, v165
  v_mov_b32 v235, 0
  v_mfma_f32_16x16x32_bf16 v[196:199], a[132:135], v[84:87], v[196:199]
  s_add_u32 s55, s55, 20480
  ds_write_b128 v17, v[160:163] offset:1024
  v_cvt_pk_bf16_f32 v165, v166, v167
  v_mov_b32 v248, 0
  v_mfma_f32_16x16x32_bf16 v[204:207], a[128:131], v[76:79], 0
  s_add_u32 m0, s71, 5120
  ds_read_b128 a[148:151], v2 offset:46080
  v_cvt_pk_bf16_f32 v166, v180, v181
  v_mov_b32 v249, 0
  s_waitcnt lgkmcnt(5)
  v_mfma_f32_16x16x32_bf16 v[208:211], a[136:139], v[64:67], 0
  ds_read_b128 a[152:155], v2 offset:47104
  v_cvt_pk_bf16_f32 v167, v182, v183
  v_mov_b32 v250, 0
  s_waitcnt lgkmcnt(5)
  v_mfma_f32_16x16x32_bf16 v[208:211], a[140:143], v[80:83], v[208:211]
  s_waitcnt lgkmcnt(3)
  s_barrier
  ds_write_b128 v17, v[164:167] offset:5120
  buffer_load_dwordx4 v23, s[44:47], s55 offen lds
  v_mov_b32 v251, 0
  v_mfma_f32_16x16x32_bf16 v[212:215], a[136:139], v[68:71], 0
  s_add_u32 m0, s71, 6144
  ds_read_b128 v[48:51], v18 offset:0
  v_cvt_pk_bf16_f32 v192, v192, v193
  v_mfma_f32_16x16x32_bf16 v[212:215], a[140:143], v[84:87], v[212:215]
  ds_read_b128 v[52:55], v18 offset:1024
  buffer_load_dwordx4 v24, s[44:47], s55 offen lds
  v_cvt_pk_bf16_f32 v193, v194, v195
  v_mfma_f32_16x16x32_bf16 v[220:223], a[136:139], v[76:79], 0
  s_add_u32 m0, s71, 7168
  ds_read_b128 a[156:159], v2 offset:48128
  v_cvt_pk_bf16_f32 v196, v196, v197
  v_mfma_f32_16x16x32_bf16 v[224:227], a[144:147], v[64:67], 0
  ds_read_b128 v[56:59], v18 offset:2048
  buffer_load_dwordx4 v25, s[44:47], s55 offen lds
  v_cvt_pk_bf16_f32 v197, v198, v199
  s_waitcnt lgkmcnt(6)
  v_mfma_f32_16x16x32_bf16 v[224:227], a[148:151], v[80:83], v[224:227]
  s_add_u32 m0, s71, 8192
  ds_read_b128 v[60:63], v18 offset:3072
  v_cvt_pk_bf16_f32 v194, v208, v209
  v_mfma_f32_16x16x32_bf16 v[228:231], a[144:147], v[68:71], 0
  buffer_load_dwordx4 v26, s[44:47], s55 offen lds
  v_cvt_pk_bf16_f32 v195, v210, v211
  v_mfma_f32_16x16x32_bf16 v[228:231], a[148:151], v[84:87], v[228:231]
  s_add_u32 m0, s71, 9216
  ds_write_b128 v17, v[192:195] offset:2048
  v_mfma_f32_16x16x32_bf16 v[236:239], a[144:147], v[76:79], 0
  buffer_load_dwordx4 v27, s[44:47], s55 offen lds
  v_cvt_pk_bf16_f32 v198, v212, v213
  v_cvt_pk_bf16_f32 v199, v214, v215
  s_waitcnt lgkmcnt(7)
  v_mfma_f32_16x16x32_bf16 v[240:243], a[152:155], v[64:67], 0
  ds_write_b128 v17, v[196:199] offset:6144
  s_waitcnt lgkmcnt(4)
  v_mfma_f32_16x16x32_bf16 v[240:243], a[156:159], v[80:83], v[240:243]
  v_mfma_f32_16x16x32_bf16 v[244:247], a[152:155], v[68:71], 0
  v_cvt_pk_bf16_f32 v224, v224, v225
  v_cvt_pk_bf16_f32 v225, v226, v227
  v_mfma_f32_16x16x32_bf16 v[244:247], a[156:159], v[84:87], v[244:247]
  s_waitcnt lgkmcnt(3)
  v_add_f32 v48, v48, v58
  v_add_f32 v49, v49, v59
  v_mfma_f32_16x16x32_bf16 v[252:255], a[152:155], v[76:79], 0
  v_cvt_pk_bf16_f32 v228, v228, v229
  v_cvt_pk_bf16_f32 v229, v230, v231
  v_cvt_pk_bf16_f32 v226, v240, v241
  v_cvt_pk_bf16_f32 v227, v242, v243
  ds_write_b128 v17, v[224:227] offset:3072
  v_cvt_pk_bf16_f32 v230, v244, v245
  v_cvt_pk_bf16_f32 v231, v246, v247
  ds_write_b128 v17, v[228:231] offset:7168
  v_add_f32 v50, v50, v56
  v_add_f32 v51, v51, v57
  s_waitcnt lgkmcnt(4)
  v_add_f32 v52, v52, v62
  v_add_f32 v53, v53, v63
  v_add_f32 v54, v54, v60
  v_add_f32 v55, v55, v61
  v_min3_f32 v56, v48, v49, v50
  v_add_f32 v57, v48, v49
  v_min3_f32 v56, v56, v51, v52
  v_add_f32 v58, v50, v51
  v_min3_f32 v56, v56, v53, v54
  v_add_f32 v59, v52, v53
  v_min_f32 v56, v56, v55
  v_add_f32 v60, v54, v55
  v_add_f32 v57, v57, v58
  v_add_f32 v59, v59, v60
  v_add_f32 v57, v57, v59
  v_cmp_nle_f32 s[36:37], s40, v56
  v_cmp_nge_f32 s[38:39], s41, v57
  v_cndmask_b32 v48, v48, v52, s[42:43]
  s_or_b64 s[36:37], s[36:37], s[38:39]
  s_cmp_lg_u64 s[36:37], 0
  s_cselect_b32 s36, 1, 0
  s_cmp_gt_u32 s36, s69
  s_cbranch_scc1 L_slow
  v_cndmask_b32 v49, v49, v53, s[42:43]
  v_cndmask_b32 v50, v50, v54, s[42:43]
  v_cndmask_b32 v51, v51, v55, s[42:43]
  v_cndmask_b32 v28, v50, v48, s[74:75]
  v_cndmask_b32 v30, v51, v49, s[74:75]
  v_rcp_f32 v28, v28
  v_rcp_f32 v30, v30
  s_branch L_fin1
L_fin0:
HS25:
  s_cbranch_execz HOPR_b
  s_mov_b32 s68, 1
  s_mov_b32 s58, s59
  s_mov_b32 s57, 0
  s_mov_b32 s63, 0x40000000
  s_mov_b32 s78, 0x40000000
  s_mov_b32 s77, 163840
  s_waitcnt lgkmcnt(0)
  s_barrier
  ds_read_b128 v[64:67], v4 offset:0
  ds_read_b128 v[68:71], v4 offset:4096
  ds_read_b128 v[72:75], v4 offset:1024
  ds_read_b128 v[76:79], v4 offset:5120
  ds_read_b128 v[80:83], v4 offset:2048
  ds_read_b128 v[84:87], v4 offset:6144
  ds_read_b128 v[88:91], v4 offset:3072
  ds_read_b128 v[92:95], v4 offset:7168
  ds_read_b64 v[56:57], v18 offset:4096
  ds_read_b64 v[58:59], v18 offset:5120
  ds_read_b64 v[60:61], v18 offset:6144
  ds_read_b64 v[62:63], v18 offset:7168
  s_mov_b64 exec, 0
  s_cmp_eq_u32 s48, 0
  s_cbranch_scc1 HS16
  s_cmp_eq_u32 s48, 1
  s_cbranch_scc1 HS17
  s_cmp_eq_u32 s48, 2
  s_cbranch_scc1 HS18
  s_branch HS20
HOPR_d:
  s_mov_b64 exec, -1
  ds_read_b128 a[64:67], v1 offset:0
  ds_read_b128 a[68:71], v1 offset:1024
  ds_read_b128 a[72:75], v1 offset:2048
  ds_read_b128 a[76:79], v1 offset:3072
  s_waitcnt lgkmcnt(6)
  v_pk_add_f32 v[56:57], v[56:57], v[58:59]
  s_waitcnt lgkmcnt(4)
  v_pk_add_f32 v[60:61], v[60:61], v[62:63]
  v_pk_add_f32 v[56:57], v[56:57], v[60:61]
  buffer_store_dword v56, v22, s[28:31], s9 offen sc1
  buffer_store_dword v57, v22, s[28:31], s10 offen sc1
  v_mfma_f32_16x16x32_bf16 v[136:139], a[180:183], v[64:67], v[136:139]
  s_lshl_b32 s67, s58, 15
  v_accvgpr_mov_b32 a0, a192
  v_accvgpr_mov_b32 a1, a193
  v_mfma_f32_16x16x32_bf16 v[152:155], a[182:185], v[64:67], v[152:155]
  s_add_u32 s67, s67, s65
  v_accvgpr_mov_b32 a2, a194
  v_accvgpr_mov_b32 a3, a195
  v_mfma_f32_16x16x32_bf16 v[140:143], a[180:183], v[68:71], v[140:143]
  s_add_u32 m0, s56, 98304
  v_accvgpr_mov_b32 a4, a196
  v_accvgpr_mov_b32 a5, a197
  v_mfma_f32_16x16x32_bf16 v[156:159], a[182:185], v[68:71], v[156:159]
  buffer_load_dwordx4 v5, s[28:31], s67 offen offset:0 sc1 lds
  v_mfma_f32_16x16x32_bf16 v[168:171], a[180:183], v[72:75], v[168:171]
  buffer_load_dwordx4 v5, s[28:31], s67 offen offset:1024 sc1 lds
  v_mfma_f32_16x16x32_bf16 v[184:187], a[182:185], v[72:75], v[184:187]
  v_accvgpr_mov_b32 a6, a198
  v_accvgpr_mov_b32 a7, a199
  v_mfma_f32_16x16x32_bf16 v[172:175], a[180:183], v[76:79], v[172:175]
  v_accvgpr_mov_b32 a8, a200
  v_accvgpr_mov_b32 a9, a201
  v_mfma_f32_16x16x32_bf16 v[188:191], a[182:185], v[76:79], v[188:191]
  v_accvgpr_mov_b32 a10, a202
  v_accvgpr_mov_b32 a11, a203
  v_mfma_f32_16x16x32_bf16 v[200:203], a[180:183], v[80:83], v[200:203]
  buffer_load_dwordx4 v5, s[28:31], s67 offen offset:2048 sc1 lds
  v_mfma_f32_16x16x32_bf16 v[216:219], a[182:185], v[80:83], v[216:219]
  v_accvgpr_mov_b32 a12, a204
  v_accvgpr_mov_b32 a13, a205
  v_mfma_f32_16x16x32_bf16 v[204:207], a[180:183], v[84:87], v[204:207]
  v_accvgpr_mov_b32 a14, a206
  v_accvgpr_mov_b32 a15, a207
  v_mfma_f32_16x16x32_bf16 v[220:223], a[182:185], v[84:87], v[220:223]
  v_accvgpr_mov_b32 a16, a208
  v_accvgpr_mov_b32 a17, a209
  v_mfma_f32_16x16x32_bf16 v[232:235], a[180:183], v[88:91], v[232:235]
  buffer_load_dwordx4 v5, s[28:31], s67 offen offset:3072 sc1 lds
  v_mfma_f32_16x16x32_bf16 v[248:251], a[182:185], v[88:91], v[248:251]
  v_accvgpr_mov_b32 a18, a210
  v_accvgpr_mov_b32 a19, a211
  v_mfma_f32_16x16x32_bf16 v[236:239], a[180:183], v[92:95], v[236:239]
  v_accvgpr_mov_b32 a20, a212
  v_accvgpr_mov_b32 a21, a213
  v_mfma_f32_16x16x32_bf16 v[252:255], a[182:185], v[92:95], v[252:255]
  v_accvgpr_mov_b32 a22, a214
  v_accvgpr_mov_b32 a23, a215
  s_add_u32 m0, s56, 102400
  s_add_u32 s67, s67, 4096
  buffer_load_dwordx4 v5, s[28:31], s67 offen offset:0 sc1 lds
  v_accvgpr_mov_b32 a24, a216
  v_accvgpr_mov_b32 a25, a217
  v_accvgpr_mov_b32 a26, a218
  v_accvgpr_mov_b32 a27, a219
  v_accvgpr_mov_b32 a28, a220
  v_accvgpr_mov_b32 a29, a221
  v_accvgpr_mov_b32 a30, a222
  v_accvgpr_mov_b32 a31, a223
  v_accvgpr_mov_b32 a32, a224
  v_accvgpr_mov_b32 a33, a225
  buffer_load_dwordx4 v5, s[28:31], s67 offen offset:1024 sc1 lds
  v_accvgpr_mov_b32 a34, a226
  v_accvgpr_mov_b32 a35, a227
  v_accvgpr_mov_b32 a36, a228
  v_accvgpr_mov_b32 a37, a229
  v_accvgpr_mov_b32 a38, a230
  v_accvgpr_mov_b32 a39, a231
  v_accvgpr_mov_b32 a40, a232
  v_accvgpr_mov_b32 a41, a233
  v_accvgpr_mov_b32 a42, a234
  v_accvgpr_mov_b32 a43, a235
  buffer_load_dwordx4 v5, s[28:31], s67 offen offset:2048 sc1 lds
  v_accvgpr_mov_b32 a44, a236
  v_accvgpr_mov_b32 a45, a237
  v_accvgpr_mov_b32 a46, a238
  v_accvgpr_mov_b32 a47, a239
  v_accvgpr_mov_b32 a48, a240
  v_accvgpr_mov_b32 a49, a241
  v_accvgpr_mov_b32 a50, a242
  v_accvgpr_mov_b32 a51, a243
  v_accvgpr_mov_b32 a52, a244
  v_accvgpr_mov_b32 a53, a245
  buffer_load_dwordx4 v5, s[28:31], s67 offen offset:3072 sc1 lds
HS26:
  s_cbranch_execz HOPR_b
  v_accvgpr_mov_b32 a54, a246
  v_accvgpr_mov_b32 a55, a247
  v_accvgpr_mov_b32 a56, a248
  v_accvgpr_mov_b32 a57, a249
  v_accvgpr_mov_b32 a58, a250
  v_accvgpr_mov_b32 a59, a251
  v_accvgpr_mov_b32 a60, a252
  v_accvgpr_mov_b32 a61, a253
  v_accvgpr_mov_b32 a62, a254
  v_accvgpr_mov_b32 a63, a255
  v_pk_mul_f32 v[136:137], v[136:137], v[28:29] op_sel_hi:[1,0]
  v_pk_mul_f32 v[138:139], v[138:139], v[28:29] op_sel_hi:[1,0]
  v_pk_mul_f32 v[152:153], v[152:153], v[28:29] op_sel_hi:[1,0]
  v_pk_mul_f32 v[154:155], v[154:155], v[28:29] op_sel_hi:[1,0]
  v_cvt_pk_bf16_f32 v136, v136, v137
  v_cvt_pk_bf16_f32 v137, v138, v139
  v_cvt_pk_bf16_f32 v138, v152, v153
  v_cvt_pk_bf16_f32 v139, v154, v155
  s_add_u32 s53, s81, 0
  buffer_store_dwordx4 v[136:139], v3, s[28:31], s53 offen offset:0 sc1
  v_accvgpr_write_b32 a192, v136
  v_accvgpr_write_b32 a193, v137
  v_accvgpr_write_b32 a194, v138
  v_accvgpr_write_b32 a195, v139
  v_pk_mul_f32 v[140:141], v[140:141], v[30:31] op_sel_hi:[1,0]
  v_pk_mul_f32 v[142:143], v[142:143], v[30:31] op_sel_hi:[1,0]
  v_pk_mul_f32 v[156:157], v[156:157], v[30:31] op_sel_hi:[1,0]
  v_pk_mul_f32 v[158:159], v[158:159], v[30:31] op_sel_hi:[1,0]
  v_cvt_pk_bf16_f32 v140, v140, v141
  v_cvt_pk_bf16_f32 v141, v142, v143
  v_cvt_pk_bf16_f32 v142, v156, v157
  v_cvt_pk_bf16_f32 v143, v158, v159
  buffer_store_dwordx4 v[140:143], v3, s[28:31], s53 offen offset:1024 sc1
  v_accvgpr_write_b32 a196, v140
  v_accvgpr_write_b32 a197, v141
  v_accvgpr_write_b32 a198, v142
  v_accvgpr_write_b32 a199, v143
  v_pk_mul_f32 v[168:169], v[168:169], v[28:29] op_sel_hi:[1,0]
  v_pk_mul_f32 v[170:171], v[170:171], v[28:29] op_sel_hi:[1,0]
  v_pk_mul_f32 v[184:185], v[184:185], v[28:29] op_sel_hi:[1,0]
  v_pk_mul_f32 v[186:187], v[186:187], v[28:29] op_sel_hi:[1,0]
  v_cvt_pk_bf16_f32 v168, v168, v169
  v_cvt_pk_bf16_f32 v169, v170, v171
  v_cvt_pk_bf16_f32 v170, v184, v185
  v_cvt_pk_bf16_f32 v171, v186, v187
  buffer_store_dwordx4 v[168:171], v3, s[28:31], s53 offen offset:2048 sc1
  v_accvgpr_write_b32 a200, v168
  v_accvgpr_write_b32 a201, v169
  v_accvgpr_write_b32 a202, v170
  v_accvgpr_write_b32 a203, v171
  v_pk_mul_f32 v[172:173], v[172:173], v[30:31] op_sel_hi:[1,0]
  v_pk_mul_f32 v[174:175], v[174:175], v[30:31] op_sel_hi:[1,0]
  v_pk_mul_f32 v[188:189], v[188:189], v[30:31] op_sel_hi:[1,0]
  v_pk_mul_f32 v[190:191], v[190:191], v[30:31] op_sel_hi:[1,0]
  v_cvt_pk_bf16_f32 v172, v172, v173
  v_cvt_pk_bf16_f32 v173, v174, v175
  v_cvt_pk_bf16_f32 v174, v188, v189
  v_cvt_pk_bf16_f32 v175, v190, v191
  buffer_store_dwordx4 v[172:175], v3, s[28:31], s53 offen offset:3072 sc1
  v_accvgpr_write_b32 a204, v172
  v_accvgpr_write_b32 a205, v173
  v_accvgpr_write_b32 a206, v174
  v_accvgpr_write_b32 a207, v175
  v_pk_mul_f32 v[200:201], v[200:201], v[28:29] op_sel_hi:[1,0]
  v_pk_mul_f32 v[202:203], v[202:203], v[28:29] op_sel_hi:[1,0]
  v_pk_mul_f32 v[216:217], v[216:217], v[28:29] op_sel_hi:[1,0]
  v_pk_mul_f32 v[218:219], v[218:219], v[28:29] op_sel_hi:[1,0]
  v_cvt_pk_bf16_f32 v200, v200, v201
  v_cvt_pk_bf16_f32 v201, v202, v203
  v_cvt_pk_bf16_f32 v202, v216, v217
  v_cvt_pk_bf16_f32 v203, v218, v219
  s_add_u32 s53, s81, 4096
  buffer_store_dwordx4 v[200:203], v3, s[28:31], s53 offen offset:0 sc1
  v_accvgpr_write_b32 a208, v200
  v_accvgpr_write_b32 a209, v201
  v_accvgpr_write_b32 a210, v202
  v_accvgpr_write_b32 a211, v203
  v_pk_mul_f32 v[204:205], v[204:205], v[30:31] op_sel_hi:[1,0]
  v_pk_mul_f32 v[206:207], v[206:207], v[30:31] op_sel_hi:[1,0]
  v_pk_mul_f32 v[220:221], v[220:221], v[30:31] op_sel_hi:[1,0]
  v_pk_mul_f32 v[222:223], v[222:223], v[30:31] op_sel_hi:[1,0]
  v_cvt_pk_bf16_f32 v204, v204, v205
  v_cvt_pk_bf16_f32 v205, v206, v207
  v_cvt_pk_bf16_f32 v206, v220, v221
  v_cvt_pk_bf16_f32 v207, v222, v223
  buffer_store_dwordx4 v[204:207], v3, s[28:31], s53 offen offset:1024 sc1
  v_accvgpr_write_b32 a212, v204
  v_accvgpr_write_b32 a213, v205
  v_accvgpr_write_b32 a214, v206
  v_accvgpr_write_b32 a215, v207
  v_pk_mul_f32 v[232:233], v[232:233], v[28:29] op_sel_hi:[1,0]
  v_pk_mul_f32 v[234:235], v[234:235], v[28:29] op_sel_hi:[1,0]
  v_pk_mul_f32 v[248:249], v[248:249], v[28:29] op_sel_hi:[1,0]
  v_pk_mul_f32 v[250:251], v[250:251], v[28:29] op_sel_hi:[1,0]
  v_cvt_pk_bf16_f32 v232, v232, v233
  v_cvt_pk_bf16_f32 v233, v234, v235
  v_cvt_pk_bf16_f32 v234, v248, v249
  v_cvt_pk_bf16_f32 v235, v250, v251
  buffer_store_dwordx4 v[232:235], v3, s[28:31], s53 offen offset:2048 sc1
  v_accvgpr_write_b32 a216, v232
  v_accvgpr_write_b32 a217, v233
  v_accvgpr_write_b32 a218, v234
  v_accvgpr_write_b32 a219, v235
  v_pk_mul_f32 v[236:237], v[236:237], v[30:31] op_sel_hi:[1,0]
  v_pk_mul_f32 v[238:239], v[238:239], v[30:31] op_sel_hi:[1,0]
  v_pk_mul_f32 v[252:253], v[252:253], v[30:31] op_sel_hi:[1,0]
  v_pk_mul_f32 v[254:255], v[254:255], v[30:31] op_sel_hi:[1,0]
  v_cvt_pk_bf16_f32 v236, v236, v237
  v_cvt_pk_bf16_f32 v237, v238, v239
  v_cvt_pk_bf16_f32 v238, v252, v253
  v_cvt_pk_bf16_f32 v239, v254, v255
  buffer_store_dwordx4 v[236:239], v3, s[28:31], s53 offen offset:3072 sc1
  v_accvgpr_write_b32 a220, v236
  v_accvgpr_write_b32 a221, v237
  v_accvgpr_write_b32 a222, v238
  v_accvgpr_write_b32 a223, v239
  s_cmp_eq_u32 s69, 0
  s_cbranch_scc1 L_nz
  v_mov_b32 v32, 0
  v_mov_b32 v33, 0
  v_mov_b32 v34, 0
  v_mov_b32 v35, 0
  v_mov_b32 v36, 0
  v_mov_b32 v37, 0
  v_mov_b32 v38, 0
  v_mov_b32 v39, 0
  v_mov_b32 v40, 0
  v_mov_b32 v41, 0
  v_mov_b32 v42, 0
  v_mov_b32 v43, 0
  v_mov_b32 v44, 0
  v_mov_b32 v45, 0
  v_mov_b32 v46, 0
  v_mov_b32 v47, 0
L_nz:
  s_waitcnt lgkmcnt(0)
  s_branch L_blk
L_fin1:
HS27:
  s_cbranch_execz HOPR_d
  v_mov_b32 v7, 0
  buffer_atomic_add v7, v16, s[28:31], s79 offen offset:128 sc0
  s_load_dwordx2 s[8:9], s[0:1], 72
  s_load_dwordx2 s[12:13], s[0:1], 104
  s_waitcnt lgkmcnt(0)
  s_barrier
  ds_read_b128 v[64:67], v4 offset:0
  ds_read_b128 v[68:71], v4 offset:4096
  ds_read_b128 v[72:75], v4 offset:1024
  ds_read_b128 v[76:79], v4 offset:5120
  ds_read_b128 v[80:83], v4 offset:2048
  ds_read_b128 v[84:87], v4 offset:6144
  ds_read_b128 v[88:91], v4 offset:3072
  ds_read_b128 v[92:95], v4 offset:7168
  s_add_u32 s55, s49, 1
  s_and_b32 s55, s55, 3
  s_mul_i32 s55, s55, 163840
  s_add_u32 s55, s55, s54
  s_add_u32 m0, s71, 40960
  s_nop 0
  buffer_load_dwordx4 v23, s[44:47], s55 offen lds
  s_add_u32 m0, s71, 41984
  s_nop 0
  buffer_load_dwordx4 v24, s[44:47], s55 offen lds
  s_add_u32 m0, s71, 43008
  s_nop 0
  buffer_load_dwordx4 v25, s[44:47], s55 offen lds
  s_add_u32 m0, s71, 44032
  s_nop 0
  buffer_load_dwordx4 v26, s[44:47], s55 offen lds
  s_add_u32 m0, s71, 45056
  s_nop 0
  buffer_load_dwordx4 v27, s[44:47], s55 offen lds
  s_add_u32 s55, s55, 20480
  s_add_u32 m0, s71, 46080
  s_nop 0
  buffer_load_dwordx4 v23, s[44:47], s55 offen lds
  s_mov_b64 exec, 0
  s_cmp_eq_u32 s48, 0
  s_cbranch_scc1 HS28
  s_cmp_eq_u32 s48, 1
  s_cbranch_scc1 HS29
  s_cmp_eq_u32 s48, 2
  s_cbranch_scc1 HS30
  s_branch HOPR_e
HOPR_e:
  s_mov_b64 exec, -1
L_op0:
  s_waitcnt lgkmcnt(7)
  v_mfma_f32_16x16x32_bf16 v[136:139], a[180:183], v[64:67], v[136:139]
  s_add_u32 m0, s71, 47104
  v_mfma_f32_16x16x32_bf16 v[152:155], a[182:185], v[64:67], v[152:155]
  buffer_load_dwordx4 v24, s[44:47], s55 offen lds
  s_waitcnt lgkmcnt(6)
  v_mfma_f32_16x16x32_bf16 v[140:143], a[180:183], v[68:71], v[140:143]
  s_add_u32 m0, s71, 48128
  v_mfma_f32_16x16x32_bf16 v[156:159], a[182:185], v[68:71], v[156:159]
  buffer_load_dwordx4 v25, s[44:47], s55 offen lds
  s_waitcnt lgkmcnt(5)
  v_mfma_f32_16x16x32_bf16 v[168:171], a[180:183], v[72:75], v[168:171]
  v_mfma_f32_16x16x32_bf16 v[184:187], a[182:185], v[72:75], v[184:187]
  s_waitcnt lgkmcnt(4)
  v_mfma_f32_16x16x32_bf16 v[172:175], a[180:183], v[76:79], v[172:175]
  v_mfma_f32_16x16x32_bf16 v[188:191], a[182:185], v[76:79], v[188:191]
  v_mul_f32 v136, v136, v28
  v_mul_f32 v137, v137, v28
  s_waitcnt lgkmcnt(3)
  v_mfma_f32_16x16x32_bf16 v[200:203], a[180:183], v[80:83], v[200:203]
  v_mul_f32 v138, v138, v28
  v_mul_f32 v139, v139, v28
  v_mfma_f32_16x16x32_bf16 v[216:219], a[182:185], v[80:83], v[216:219]
  v_mul_f32 v152, v152, v28
  v_mul_f32 v153, v153, v28
  s_waitcnt lgkmcnt(2)
  v_mfma_f32_16x16x32_bf16 v[204:207], a[180:183], v[84:87], v[204:207]
  v_mul_f32 v154, v154, v28
  v_mul_f32 v155, v155, v28
  v_mfma_f32_16x16x32_bf16 v[220:223], a[182:185], v[84:87], v[220:223]
  v_mul_f32 v140, v140, v30
  v_mul_f32 v141, v141, v30
  s_waitcnt lgkmcnt(1)
  v_mfma_f32_16x16x32_bf16 v[232:235], a[180:183], v[88:91], v[232:235]
  v_mul_f32 v142, v142, v30
  v_mul_f32 v143, v143, v30
  v_mfma_f32_16x16x32_bf16 v[248:251], a[182:185], v[88:91], v[248:251]
  v_mul_f32 v156, v156, v30
  v_mul_f32 v157, v157, v30
  s_waitcnt lgkmcnt(0)
  v_mfma_f32_16x16x32_bf16 v[236:239], a[180:183], v[92:95], v[236:239]
  v_mul_f32 v158, v158, v30
  v_mul_f32 v159, v159, v30
  v_mfma_f32_16x16x32_bf16 v[252:255], a[182:185], v[92:95], v[252:255]
  v_cvt_pk_bf16_f32 v32, v136, v137
  v_cvt_pk_bf16_f32 v33, v138, v139
  v_cvt_pk_bf16_f32 v34, v152, v153
  v_cvt_pk_bf16_f32 v35, v154, v155
  s_add_u32 s53, s81, 8192
  buffer_store_dwordx4 v[32:35], v3, s[28:31], s53 offen offset:0 sc1
  v_cvt_pk_bf16_f32 v36, v140, v141
  v_cvt_pk_bf16_f32 v37, v142, v143
  v_cvt_pk_bf16_f32 v38, v156, v157
  v_cvt_pk_bf16_f32 v39, v158, v159
  buffer_store_dwordx4 v[36:39], v3, s[28:31], s53 offen offset:1024 sc1
  v_pk_mul_f32 v[168:169], v[168:169], v[28:29] op_sel_hi:[1,0]
  v_pk_mul_f32 v[170:171], v[170:171], v[28:29] op_sel_hi:[1,0]
  v_pk_mul_f32 v[184:185], v[184:185], v[28:29] op_sel_hi:[1,0]
  v_pk_mul_f32 v[186:187], v[186:187], v[28:29] op_sel_hi:[1,0]
  v_cvt_pk_bf16_f32 v40, v168, v169
  v_cvt_pk_bf16_f32 v41, v170, v171
  v_cvt_pk_bf16_f32 v42, v184, v185
  v_cvt_pk_bf16_f32 v43, v186, v187
  buffer_store_dwordx4 v[40:43], v3, s[28:31], s53 offen offset:2048 sc1
  v_pk_mul_f32 v[172:173], v[172:173], v[30:31] op_sel_hi:[1,0]
  v_pk_mul_f32 v[174:175], v[174:175], v[30:31] op_sel_hi:[1,0]
  v_pk_mul_f32 v[188:189], v[188:189], v[30:31] op_sel_hi:[1,0]
  v_pk_mul_f32 v[190:191], v[190:191], v[30:31] op_sel_hi:[1,0]
  v_cvt_pk_bf16_f32 v44, v172, v173
  v_cvt_pk_bf16_f32 v45, v174, v175
  v_cvt_pk_bf16_f32 v46, v188, v189
  v_cvt_pk_bf16_f32 v47, v190, v191
  v_pk_mul_f32 v[200:201], v[200:201], v[28:29] op_sel_hi:[1,0]
  v_pk_mul_f32 v[202:203], v[202:203], v[28:29] op_sel_hi:[1,0]
  v_pk_mul_f32 v[216:217], v[216:217], v[28:29] op_sel_hi:[1,0]
  v_pk_mul_f32 v[218:219], v[218:219], v[28:29] op_sel_hi:[1,0]
  v_cvt_pk_bf16_f32 v48, v200, v201
  v_cvt_pk_bf16_f32 v49, v202, v203
  v_cvt_pk_bf16_f32 v50, v216, v217
  v_cvt_pk_bf16_f32 v51, v218, v219
  v_pk_mul_f32 v[204:205], v[204:205], v[30:31] op_sel_hi:[1,0]
  v_pk_mul_f32 v[206:207], v[206:207], v[30:31] op_sel_hi:[1,0]
  v_pk_mul_f32 v[220:221], v[220:221], v[30:31] op_sel_hi:[1,0]
  v_pk_mul_f32 v[222:223], v[222:223], v[30:31] op_sel_hi:[1,0]
  v_cvt_pk_bf16_f32 v52, v204, v205
  v_cvt_pk_bf16_f32 v53, v206, v207
  v_cvt_pk_bf16_f32 v54, v220, v221
  v_cvt_pk_bf16_f32 v55, v222, v223
  v_pk_mul_f32 v[232:233], v[232:233], v[28:29] op_sel_hi:[1,0]
  v_pk_mul_f32 v[234:235], v[234:235], v[28:29] op_sel_hi:[1,0]
  v_pk_mul_f32 v[248:249], v[248:249], v[28:29] op_sel_hi:[1,0]
  v_pk_mul_f32 v[250:251], v[250:251], v[28:29] op_sel_hi:[1,0]
  v_cvt_pk_bf16_f32 v56, v232, v233
  v_cvt_pk_bf16_f32 v57, v234, v235
  v_cvt_pk_bf16_f32 v58, v248, v249
  v_cvt_pk_bf16_f32 v59, v250, v251
  v_pk_mul_f32 v[236:237], v[236:237], v[30:31] op_sel_hi:[1,0]
  v_pk_mul_f32 v[238:239], v[238:239], v[30:31] op_sel_hi:[1,0]
  v_pk_mul_f32 v[252:253], v[252:253], v[30:31] op_sel_hi:[1,0]
  v_pk_mul_f32 v[254:255], v[254:255], v[30:31] op_sel_hi:[1,0]
  v_cvt_pk_bf16_f32 v60, v236, v237
  v_cvt_pk_bf16_f32 v61, v238, v239
  v_cvt_pk_bf16_f32 v62, v252, v253
  v_cvt_pk_bf16_f32 v63, v254, v255
  v_lshrrev_b32 v28, 2, v0
  v_mul_u32_u24 v28, 320, v28
  v_and_b32 v29, 3, v0
  v_lshl_add_u32 v28, v29, 3, v28
  v_bfe_u32 v29, v0, 4, 1
  v_lshlrev_b32 v29, 5, v29
  v_add_u32 v8, v28, v29
  v_sub_u32 v28, v28, v29
  v_add_u32 v9, 32, v28
  s_waitcnt vmcnt(12)
  s_barrier
  ds_read_b64_tr_b16 v[64:65], v8 offset:0
  ds_read_b64_tr_b16 v[66:67], v8 offset:5120
  ds_read_b64_tr_b16 v[68:69], v8 offset:10240
  ds_read_b64_tr_b16 v[70:71], v8 offset:15360
  ds_read_b64_tr_b16 v[72:73], v8 offset:20480
  ds_read_b64_tr_b16 v[74:75], v8 offset:25600
  ds_read_b64_tr_b16 v[76:77], v8 offset:30720
  ds_read_b64_tr_b16 v[78:79], v8 offset:35840
  s_waitcnt vmcnt(11)
  v_readfirstlane_b32 s3, v7
  s_nop 0
  s_cmp_lt_u32 s3, 4
  s_cbranch_scc1 L_pl_w
L_pl_ok:
  v_cmp_gt_u32 vcc, 32, v0
  s_nop 1
  v_cndmask_b32_e64 v21, 27, 32, vcc
  v_cmp_gt_u32 vcc, v21, v22
  s_nop 0
  s_cbranch_vccnz L_pr_w
L_pr_ok:
  s_waitcnt lgkmcnt(6)
  v_mfma_f32_16x16x32_bf16 v[96:99], v[64:67], a[192:195], 0
  ds_read_b64_tr_b16 v[80:81], v9 offset:0
  s_waitcnt lgkmcnt(5)
  v_mfma_f32_16x16x32_bf16 v[96:99], v[68:71], a[200:203], v[96:99]
  ds_read_b64_tr_b16 v[82:83], v9 offset:5120
  s_add_u32 m0, s71, 49152
  s_waitcnt lgkmcnt(4)
  v_mfma_f32_16x16x32_bf16 v[96:99], v[72:75], a[208:211], v[96:99]
  ds_read_b64_tr_b16 v[84:85], v9 offset:10240
  buffer_load_dwordx4 v26, s[44:47], s55 offen lds
  s_waitcnt lgkmcnt(3)
  v_mfma_f32_16x16x32_bf16 v[96:99], v[76:79], a[216:219], v[96:99]
  ds_read_b64_tr_b16 v[86:87], v9 offset:15360
  v_mfma_f32_16x16x32_bf16 v[100:103], v[64:67], a[196:199], 0
  ds_read_b64_tr_b16 v[88:89], v9 offset:20480
  v_mfma_f32_16x16x32_bf16 v[100:103], v[68:71], a[204:207], v[100:103]
  ds_read_b64_tr_b16 v[90:91], v9 offset:25600
  v_mfma_f32_16x16x32_bf16 v[100:103], v[72:75], a[212:215], v[100:103]
  ds_read_b64_tr_b16 v[92:93], v9 offset:30720
  s_add_u32 m0, s71, 50176
  v_mfma_f32_16x16x32_bf16 v[100:103], v[76:79], a[220:223], v[100:103]
  ds_read_b64_tr_b16 v[94:95], v9 offset:35840
  buffer_load_dwordx4 v27, s[44:47], s55 offen lds
  v_mfma_f32_16x16x32_bf16 v[104:107], v[64:67], v[32:35], 0
  v_add_u32 v10, 40960, v8
  v_add_u32 v11, 40960, v9
  v_mfma_f32_16x16x32_bf16 v[104:107], v[68:71], v[40:43], v[104:107]
  v_add_u32 v12, 81920, v8
  v_add_u32 v13, 81920, v9
  v_mfma_f32_16x16x32_bf16 v[104:107], v[72:75], v[48:51], v[104:107]
  s_lshr_b32 s53, s49, 2
  v_add_u32 v14, 122880, v8
  v_add_u32 v15, 122880, v9
  v_mfma_f32_16x16x32_bf16 v[104:107], v[76:79], v[56:59], v[104:107]
  s_mul_i32 s40, s53, 2621440
  s_add_u32 s66, s81, 8192
  v_mfma_f32_16x16x32_bf16 v[108:111], v[64:67], v[36:39], 0
  s_add_u32 s40, s40, 102842368
  buffer_store_dwordx4 v[44:47], v3, s[28:31], s66 offen offset:3072 sc1
  v_mfma_f32_16x16x32_bf16 v[108:111], v[68:71], v[44:47], v[108:111]
  s_lshr_b32 s53, s48, 1
  v_mfma_f32_16x16x32_bf16 v[108:111], v[72:75], v[52:55], v[108:111]
  s_mul_i32 s53, s53, 81920
  v_mfma_f32_16x16x32_bf16 v[108:111], v[76:79], v[60:63], v[108:111]
  s_waitcnt lgkmcnt(0)
  s_sub_u32 s40, s40, s53
  v_mfma_f32_16x16x32_bf16 v[112:115], v[80:83], a[192:195], 0
  s_and_b32 s53, s48, 1
  ds_read_b64_tr_b16 a[224:225], v8 offset:64
  v_mfma_f32_16x16x32_bf16 v[112:115], v[84:87], a[200:203], v[112:115]
  s_lshl_b32 s53, s53, 10
  ds_read_b64_tr_b16 a[226:227], v8 offset:5184
  v_mfma_f32_16x16x32_bf16 v[112:115], v[88:91], a[208:211], v[112:115]
  s_add_u32 s40, s40, s53
  ds_read_b64_tr_b16 a[228:229], v8 offset:10304
  v_mfma_f32_16x16x32_bf16 v[112:115], v[92:95], a[216:219], v[112:115]
  s_and_b32 s53, s49, 3
  ds_read_b64_tr_b16 a[230:231], v8 offset:15424
  v_mfma_f32_16x16x32_bf16 v[116:119], v[80:83], a[196:199], 0
  s_mul_i32 s53, s53, 20480
  ds_read_b64_tr_b16 a[232:233], v8 offset:20544
  v_mfma_f32_16x16x32_bf16 v[116:119], v[84:87], a[204:207], v[116:119]
  s_add_u32 s40, s40, s53
  ds_read_b64_tr_b16 a[234:235], v8 offset:25664
  s_add_u32 s58, s49, 1
  s_and_b32 s58, s58, 3
  s_lshl_b32 s52, s82, 2
  s_add_u32 s58, s58, s52
  s_lshl_b32 s58, s58, 14
  s_add_u32 s58, s58, 37748736
  s_add_u32 s52, s58, 0
  v_mfma_f32_16x16x32_bf16 v[116:119], v[88:91], a[212:215], v[116:119]
  s_mul_i32 s53, s50, 163840
  ds_read_b64_tr_b16 a[236:237], v8 offset:30784
  buffer_load_dwordx4 a[0:3], v3, s[28:31], s52 offen offset:0 sc1
  v_mfma_f32_16x16x32_bf16 v[116:119], v[92:95], a[220:223], v[116:119]
  s_add_u32 s41, s40, s53
  ds_read_b64_tr_b16 a[238:239], v8 offset:35904
  v_mfma_f32_16x16x32_bf16 v[120:123], v[80:83], v[32:35], 0
  s_sub_u32 s40, s40, s53
  v_mfma_f32_16x16x32_bf16 v[120:123], v[84:87], v[40:43], v[120:123]
  s_add_u32 s40, s40, 2457600
  v_mfma_f32_16x16x32_bf16 v[120:123], v[88:91], v[48:51], v[120:123]
  v_mfma_f32_16x16x32_bf16 v[120:123], v[92:95], v[56:59], v[120:123]
  buffer_load_dwordx4 a[4:7], v3, s[28:31], s52 offen offset:1024 sc1
  v_mfma_f32_16x16x32_bf16 v[124:127], v[80:83], v[36:39], 0
  v_mfma_f32_16x16x32_bf16 v[124:127], v[84:87], v[44:47], v[124:127]
  v_mfma_f32_16x16x32_bf16 v[124:127], v[88:91], v[52:55], v[124:127]
  v_mfma_f32_16x16x32_bf16 v[124:127], v[92:95], v[60:63], v[124:127]
  s_waitcnt lgkmcnt(0)
  s_add_u32 s66, s81, 12288
  v_mfma_f32_16x16x32_bf16 v[128:131], a[224:227], a[192:195], 0
  ds_read_b64_tr_b16 a[240:241], v9 offset:64
  buffer_store_dwordx4 v[48:51], v3, s[28:31], s66 offen offset:0 sc1
  v_mfma_f32_16x16x32_bf16 v[128:131], a[228:231], a[200:203], v[128:131]
  ds_read_b64_tr_b16 a[242:243], v9 offset:5184
  v_mfma_f32_16x16x32_bf16 v[128:131], a[232:235], a[208:211], v[128:131]
  ds_read_b64_tr_b16 a[244:245], v9 offset:10304
  v_mfma_f32_16x16x32_bf16 v[128:131], a[236:239], a[216:219], v[128:131]
  ds_read_b64_tr_b16 a[246:247], v9 offset:15424
  v_mfma_f32_16x16x32_bf16 v[132:135], a[224:227], a[196:199], 0
  ds_read_b64_tr_b16 a[248:249], v9 offset:20544
  v_mfma_f32_16x16x32_bf16 v[132:135], a[228:231], a[204:207], v[132:135]
  ds_read_b64_tr_b16 a[250:251], v9 offset:25664
  v_mfma_f32_16x16x32_bf16 v[132:135], a[232:235], a[212:215], v[132:135]
  ds_read_b64_tr_b16 a[252:253], v9 offset:30784
  v_mfma_f32_16x16x32_bf16 v[132:135], a[236:239], a[220:223], v[132:135]
  ds_read_b64_tr_b16 a[254:255], v9 offset:35904
  v_mfma_f32_16x16x32_bf16 v[136:139], a[224:227], v[32:35], 0
  s_lshl_b32 s75, s50, 2
  v_mfma_f32_16x16x32_bf16 v[136:139], a[228:231], v[40:43], v[136:139]
  s_and_b32 s74, s49, 3
  v_mfma_f32_16x16x32_bf16 v[136:139], a[232:235], v[48:51], v[136:139]
  s_add_u32 s75, s75, s74
  buffer_load_dwordx4 a[16:19], v3, s[28:31], s52 offen offset:2048 sc1
  v_mfma_f32_16x16x32_bf16 v[136:139], a[236:239], v[56:59], v[136:139]
  s_lshl_b32 s75, s75, 2
  v_mfma_f32_16x16x32_bf16 v[140:143], a[224:227], v[36:39], 0
  s_add_u32 s75, s75, s48
  v_mfma_f32_16x16x32_bf16 v[140:143], a[228:231], v[44:47], v[140:143]
  s_lshl_b32 s75, s75, 8
  v_mfma_f32_16x16x32_bf16 v[140:143], a[232:235], v[52:55], v[140:143]
  s_add_u32 s75, s75, 491520
  v_mfma_f32_16x16x32_bf16 v[140:143], a[236:239], v[60:63], v[140:143]
  s_waitcnt lgkmcnt(0)
  s_lshr_b32 s74, s49, 2
  buffer_load_dwordx4 a[20:23], v3, s[28:31], s52 offen offset:3072 sc1
  v_mfma_f32_16x16x32_bf16 v[144:147], a[240:243], a[192:195], 0
  s_lshl_b32 s74, 1, s74
  ds_read_b64_tr_b16 v[64:65], v8 offset:128
  v_mov_b32 v31, s74
  v_mfma_f32_16x16x32_bf16 v[144:147], a[244:247], a[200:203], v[144:147]
  ds_read_b64_tr_b16 v[66:67], v8 offset:5248
  v_mfma_f32_16x16x32_bf16 v[144:147], a[248:251], a[208:211], v[144:147]
  ds_read_b64_tr_b16 v[68:69], v8 offset:10368
  v_mfma_f32_16x16x32_bf16 v[144:147], a[252:255], a[216:219], v[144:147]
  ds_read_b64_tr_b16 v[70:71], v8 offset:15488
  s_add_u32 s66, s81, 12288
  v_mfma_f32_16x16x32_bf16 v[148:151], a[240:243], a[196:199], 0
  ds_read_b64_tr_b16 v[72:73], v8 offset:20608
  buffer_store_dwordx4 v[52:55], v3, s[28:31], s66 offen offset:1024 sc1
  v_mfma_f32_16x16x32_bf16 v[148:151], a[244:247], a[204:207], v[148:151]
  ds_read_b64_tr_b16 v[74:75], v8 offset:25728
  v_mfma_f32_16x16x32_bf16 v[148:151], a[248:251], a[212:215], v[148:151]
  ds_read_b64_tr_b16 v[76:77], v8 offset:30848
  v_mfma_f32_16x16x32_bf16 v[148:151], a[252:255], a[220:223], v[148:151]
  ds_read_b64_tr_b16 v[78:79], v8 offset:35968
  v_mfma_f32_16x16x32_bf16 v[152:155], a[240:243], v[32:35], 0
  v_mfma_f32_16x16x32_bf16 v[152:155], a[244:247], v[40:43], v[152:155]
  v_mfma_f32_16x16x32_bf16 v[152:155], a[248:251], v[48:51], v[152:155]
  v_mfma_f32_16x16x32_bf16 v[152:155], a[252:255], v[56:59], v[152:155]
  v_mfma_f32_16x16x32_bf16 v[156:159], a[240:243], v[36:39], 0
  v_mfma_f32_16x16x32_bf16 v[156:159], a[244:247], v[44:47], v[156:159]
  s_add_u32 s52, s58, 4096
  v_mfma_f32_16x16x32_bf16 v[156:159], a[248:251], v[52:55], v[156:159]
  buffer_load_dwordx4 a[32:35], v3, s[28:31], s52 offen offset:0 sc1
  v_mfma_f32_16x16x32_bf16 v[156:159], a[252:255], v[60:63], v[156:159]
  s_waitcnt lgkmcnt(0)
  v_mfma_f32_16x16x32_bf16 v[160:163], v[64:67], a[192:195], 0
  ds_read_b64_tr_b16 v[80:81], v9 offset:128
  v_mfma_f32_16x16x32_bf16 v[160:163], v[68:71], a[200:203], v[160:163]
  ds_read_b64_tr_b16 v[82:83], v9 offset:5248
  v_mfma_f32_16x16x32_bf16 v[160:163], v[72:75], a[208:211], v[160:163]
  ds_read_b64_tr_b16 v[84:85], v9 offset:10368
  v_mfma_f32_16x16x32_bf16 v[160:163], v[76:79], a[216:219], v[160:163]
  ds_read_b64_tr_b16 v[86:87], v9 offset:15488
  buffer_load_dwordx4 a[36:39], v3, s[28:31], s52 offen offset:1024 sc1
  v_mfma_f32_16x16x32_bf16 v[164:167], v[64:67], a[196:199], 0
  ds_read_b64_tr_b16 v[88:89], v9 offset:20608
  v_mfma_f32_16x16x32_bf16 v[164:167], v[68:71], a[204:207], v[164:167]
  ds_read_b64_tr_b16 v[90:91], v9 offset:25728
  v_mfma_f32_16x16x32_bf16 v[164:167], v[72:75], a[212:215], v[164:167]
  ds_read_b64_tr_b16 v[92:93], v9 offset:30848
  v_mfma_f32_16x16x32_bf16 v[164:167], v[76:79], a[220:223], v[164:167]
  ds_read_b64_tr_b16 v[94:95], v9 offset:35968
  s_add_u32 s66, s81, 12288
  v_mfma_f32_16x16x32_bf16 v[168:171], v[64:67], v[32:35], 0
  buffer_store_dwordx4 v[56:59], v3, s[28:31], s66 offen offset:2048 sc1
  v_mfma_f32_16x16x32_bf16 v[168:171], v[68:71], v[40:43], v[168:171]
  v_mfma_f32_16x16x32_bf16 v[168:171], v[72:75], v[48:51], v[168:171]
  v_mfma_f32_16x16x32_bf16 v[168:171], v[76:79], v[56:59], v[168:171]
  v_mfma_f32_16x16x32_bf16 v[172:175], v[64:67], v[36:39], 0
  v_mfma_f32_16x16x32_bf16 v[172:175], v[68:71], v[44:47], v[172:175]
  v_mfma_f32_16x16x32_bf16 v[172:175], v[72:75], v[52:55], v[172:175]
  v_mfma_f32_16x16x32_bf16 v[172:175], v[76:79], v[60:63], v[172:175]
  s_waitcnt lgkmcnt(0)
  v_mfma_f32_16x16x32_bf16 v[176:179], v[80:83], a[192:195], 0
  ds_read_b64_tr_b16 a[224:225], v8 offset:192
  v_mfma_f32_16x16x32_bf16 v[176:179], v[84:87], a[200:203], v[176:179]
  ds_read_b64_tr_b16 a[226:227], v8 offset:5312
  v_mfma_f32_16x16x32_bf16 v[176:179], v[88:91], a[208:211], v[176:179]
  ds_read_b64_tr_b16 a[228:229], v8 offset:10432
  buffer_load_dwordx4 a[48:51], v3, s[28:31], s52 offen offset:2048 sc1
  v_mfma_f32_16x16x32_bf16 v[176:179], v[92:95], a[216:219], v[176:179]
  ds_read_b64_tr_b16 a[230:231], v8 offset:15552
  v_mfma_f32_16x16x32_bf16 v[180:183], v[80:83], a[196:199], 0
  ds_read_b64_tr_b16 a[232:233], v8 offset:20672
  v_mfma_f32_16x16x32_bf16 v[180:183], v[84:87], a[204:207], v[180:183]
  ds_read_b64_tr_b16 a[234:235], v8 offset:25792
  v_mfma_f32_16x16x32_bf16 v[180:183], v[88:91], a[212:215], v[180:183]
  ds_read_b64_tr_b16 a[236:237], v8 offset:30912
  v_mfma_f32_16x16x32_bf16 v[180:183], v[92:95], a[220:223], v[180:183]
  ds_read_b64_tr_b16 a[238:239], v8 offset:36032
  v_mfma_f32_16x16x32_bf16 v[184:187], v[80:83], v[32:35], 0
  buffer_load_dwordx4 a[52:55], v3, s[28:31], s52 offen offset:3072 sc1
  v_mfma_f32_16x16x32_bf16 v[184:187], v[84:87], v[40:43], v[184:187]
  v_mfma_f32_16x16x32_bf16 v[184:187], v[88:91], v[48:51], v[184:187]
  v_mfma_f32_16x16x32_bf16 v[184:187], v[92:95], v[56:59], v[184:187]
  v_mfma_f32_16x16x32_bf16 v[188:191], v[80:83], v[36:39], 0
  s_add_u32 s66, s81, 12288
  v_mfma_f32_16x16x32_bf16 v[188:191], v[84:87], v[44:47], v[188:191]
  buffer_store_dwordx4 v[60:63], v3, s[28:31], s66 offen offset:3072 sc1
  v_mfma_f32_16x16x32_bf16 v[188:191], v[88:91], v[52:55], v[188:191]
  v_mfma_f32_16x16x32_bf16 v[188:191], v[92:95], v[60:63], v[188:191]
  s_waitcnt lgkmcnt(0)
  v_mfma_f32_16x16x32_bf16 v[192:195], a[224:227], a[192:195], 0
  ds_read_b64_tr_b16 a[240:241], v9 offset:192
  v_mfma_f32_16x16x32_bf16 v[192:195], a[228:231], a[200:203], v[192:195]
  ds_read_b64_tr_b16 a[242:243], v9 offset:5312
  v_mfma_f32_16x16x32_bf16 v[192:195], a[232:235], a[208:211], v[192:195]
  ds_read_b64_tr_b16 a[244:245], v9 offset:10432
  v_mfma_f32_16x16x32_bf16 v[192:195], a[236:239], a[216:219], v[192:195]
  ds_read_b64_tr_b16 a[246:247], v9 offset:15552
  v_mfma_f32_16x16x32_bf16 v[196:199], a[224:227], a[196:199], 0
  ds_read_b64_tr_b16 a[248:249], v9 offset:20672
  v_mfma_f32_16x16x32_bf16 v[196:199], a[228:231], a[204:207], v[196:199]
  ds_read_b64_tr_b16 a[250:251], v9 offset:25792
  v_mfma_f32_16x16x32_bf16 v[196:199], a[232:235], a[212:215], v[196:199]
  ds_read_b64_tr_b16 a[252:253], v9 offset:30912
  s_add_u32 s55, s49, 2
  s_and_b32 s55, s55, 3
  s_mul_i32 s55, s55, 163840
  s_add_u32 s55, s55, s54
  s_add_u32 m0, s71, 81920
  v_mfma_f32_16x16x32_bf16 v[196:199], a[236:239], a[220:223], v[196:199]
  ds_read_b64_tr_b16 a[254:255], v9 offset:36032
  v_mfma_f32_16x16x32_bf16 v[200:203], a[224:227], v[32:35], 0
  buffer_load_dwordx4 v23, s[44:47], s55 offen lds
  v_mfma_f32_16x16x32_bf16 v[200:203], a[228:231], v[40:43], v[200:203]
  v_mfma_f32_16x16x32_bf16 v[200:203], a[232:235], v[48:51], v[200:203]
  v_mfma_f32_16x16x32_bf16 v[200:203], a[236:239], v[56:59], v[200:203]
  v_mfma_f32_16x16x32_bf16 v[204:207], a[224:227], v[36:39], 0
  s_add_u32 m0, s71, 82944
  v_mfma_f32_16x16x32_bf16 v[204:207], a[228:231], v[44:47], v[204:207]
  buffer_load_dwordx4 v24, s[44:47], s55 offen lds
  v_mfma_f32_16x16x32_bf16 v[204:207], a[232:235], v[52:55], v[204:207]
  v_mfma_f32_16x16x32_bf16 v[204:207], a[236:239], v[60:63], v[204:207]
  s_waitcnt lgkmcnt(0)
  v_mfma_f32_16x16x32_bf16 v[208:211], a[240:243], a[192:195], 0
  ds_read_b64_tr_b16 v[64:65], v8 offset:256
  v_mfma_f32_16x16x32_bf16 v[208:211], a[244:247], a[200:203], v[208:211]
  ds_read_b64_tr_b16 v[66:67], v8 offset:5376
  s_add_u32 m0, s71, 83968
  v_mfma_f32_16x16x32_bf16 v[208:211], a[248:251], a[208:211], v[208:211]
  ds_read_b64_tr_b16 v[68:69], v8 offset:10496
  buffer_load_dwordx4 v25, s[44:47], s55 offen lds
  v_mfma_f32_16x16x32_bf16 v[208:211], a[252:255], a[216:219], v[208:211]
HS28:
  s_cbranch_execz HOPR_e
  ds_read_b64_tr_b16 v[70:71], v8 offset:15616
  v_mfma_f32_16x16x32_bf16 v[212:215], a[240:243], a[196:199], 0
  ds_read_b64_tr_b16 v[72:73], v8 offset:20736
  v_mfma_f32_16x16x32_bf16 v[212:215], a[244:247], a[204:207], v[212:215]
  ds_read_b64_tr_b16 v[74:75], v8 offset:25856
  v_mfma_f32_16x16x32_bf16 v[212:215], a[248:251], a[212:215], v[212:215]
  ds_read_b64_tr_b16 v[76:77], v8 offset:30976
  s_add_u32 m0, s71, 84992
  v_mfma_f32_16x16x32_bf16 v[212:215], a[252:255], a[220:223], v[212:215]
  ds_read_b64_tr_b16 v[78:79], v8 offset:36096
  v_mfma_f32_16x16x32_bf16 v[216:219], a[240:243], v[32:35], 0
  buffer_load_dwordx4 v26, s[44:47], s55 offen lds
  v_mfma_f32_16x16x32_bf16 v[216:219], a[244:247], v[40:43], v[216:219]
  v_mfma_f32_16x16x32_bf16 v[216:219], a[248:251], v[48:51], v[216:219]
  v_mfma_f32_16x16x32_bf16 v[216:219], a[252:255], v[56:59], v[216:219]
  v_mfma_f32_16x16x32_bf16 v[220:223], a[240:243], v[36:39], 0
  s_add_u32 m0, s71, 86016
  v_mfma_f32_16x16x32_bf16 v[220:223], a[244:247], v[44:47], v[220:223]
  buffer_load_dwordx4 v27, s[44:47], s55 offen lds
  v_mfma_f32_16x16x32_bf16 v[220:223], a[248:251], v[52:55], v[220:223]
  v_mfma_f32_16x16x32_bf16 v[220:223], a[252:255], v[60:63], v[220:223]
  s_waitcnt lgkmcnt(0)
  v_mfma_f32_16x16x32_bf16 v[224:227], v[64:67], a[192:195], 0
  ds_read_b64_tr_b16 v[80:81], v9 offset:256
  v_mfma_f32_16x16x32_bf16 v[224:227], v[68:71], a[200:203], v[224:227]
  ds_read_b64_tr_b16 v[82:83], v9 offset:5376
  s_add_u32 s55, s55, 20480
  s_add_u32 m0, s71, 87040
  v_mfma_f32_16x16x32_bf16 v[224:227], v[72:75], a[208:211], v[224:227]
  ds_read_b64_tr_b16 v[84:85], v9 offset:10496
  buffer_load_dwordx4 v23, s[44:47], s55 offen lds
  v_mfma_f32_16x16x32_bf16 v[224:227], v[76:79], a[216:219], v[224:227]
  ds_read_b64_tr_b16 v[86:87], v9 offset:15616
  v_mfma_f32_16x16x32_bf16 v[228:231], v[64:67], a[196:199], 0
  ds_read_b64_tr_b16 v[88:89], v9 offset:20736
  v_mfma_f32_16x16x32_bf16 v[228:231], v[68:71], a[204:207], v[228:231]
  ds_read_b64_tr_b16 v[90:91], v9 offset:25856
  v_mfma_f32_16x16x32_bf16 v[228:231], v[72:75], a[212:215], v[228:231]
  ds_read_b64_tr_b16 v[92:93], v9 offset:30976
  s_add_u32 m0, s71, 88064
  v_mfma_f32_16x16x32_bf16 v[228:231], v[76:79], a[220:223], v[228:231]
  ds_read_b64_tr_b16 v[94:95], v9 offset:36096
  v_mfma_f32_16x16x32_bf16 v[232:235], v[64:67], v[32:35], 0
  buffer_load_dwordx4 v24, s[44:47], s55 offen lds
  v_mfma_f32_16x16x32_bf16 v[232:235], v[68:71], v[40:43], v[232:235]
  v_mfma_f32_16x16x32_bf16 v[232:235], v[72:75], v[48:51], v[232:235]
  v_mfma_f32_16x16x32_bf16 v[232:235], v[76:79], v[56:59], v[232:235]
  v_mfma_f32_16x16x32_bf16 v[236:239], v[64:67], v[36:39], 0
  s_add_u32 m0, s71, 89088
  v_mfma_f32_16x16x32_bf16 v[236:239], v[68:71], v[44:47], v[236:239]
  buffer_load_dwordx4 v25, s[44:47], s55 offen lds
  v_mfma_f32_16x16x32_bf16 v[236:239], v[72:75], v[52:55], v[236:239]
  v_mfma_f32_16x16x32_bf16 v[236:239], v[76:79], v[60:63], v[236:239]
  s_waitcnt vmcnt(21) lgkmcnt(0)
  s_barrier
  v_mfma_f32_16x16x32_bf16 v[240:243], v[80:83], a[192:195], 0
  ds_read_b64_tr_b16 a[224:225], v10 offset:0
  v_mfma_f32_16x16x32_bf16 v[240:243], v[84:87], a[200:203], v[240:243]
  ds_read_b64_tr_b16 a[226:227], v10 offset:5120
  s_add_u32 m0, s71, 90112
  v_mfma_f32_16x16x32_bf16 v[240:243], v[88:91], a[208:211], v[240:243]
  ds_read_b64_tr_b16 a[228:229], v10 offset:10240
  buffer_load_dwordx4 v26, s[44:47], s55 offen lds
  v_mfma_f32_16x16x32_bf16 v[240:243], v[92:95], a[216:219], v[240:243]
  ds_read_b64_tr_b16 a[230:231], v10 offset:15360
  v_mfma_f32_16x16x32_bf16 v[244:247], v[80:83], a[196:199], 0
  ds_read_b64_tr_b16 a[232:233], v10 offset:20480
  v_mfma_f32_16x16x32_bf16 v[244:247], v[84:87], a[204:207], v[244:247]
  ds_read_b64_tr_b16 a[234:235], v10 offset:25600
  v_mfma_f32_16x16x32_bf16 v[244:247], v[88:91], a[212:215], v[244:247]
  ds_read_b64_tr_b16 a[236:237], v10 offset:30720
  s_add_u32 m0, s71, 91136
  v_mfma_f32_16x16x32_bf16 v[244:247], v[92:95], a[220:223], v[244:247]
  ds_read_b64_tr_b16 a[238:239], v10 offset:35840
  buffer_load_dwordx4 v27, s[44:47], s55 offen lds
  v_mfma_f32_16x16x32_bf16 v[248:251], v[80:83], v[32:35], 0
  ds_read_b64_tr_b16 a[240:241], v11 offset:0
  v_mfma_f32_16x16x32_bf16 v[248:251], v[84:87], v[40:43], v[248:251]
  ds_read_b64_tr_b16 a[242:243], v11 offset:5120
  v_mfma_f32_16x16x32_bf16 v[248:251], v[88:91], v[48:51], v[248:251]
  ds_read_b64_tr_b16 a[244:245], v11 offset:10240
  v_mfma_f32_16x16x32_bf16 v[248:251], v[92:95], v[56:59], v[248:251]
  ds_read_b64_tr_b16 a[246:247], v11 offset:15360
  s_waitcnt vmcnt(10)
  v_mfma_f32_16x16x32_bf16 v[252:255], v[80:83], v[36:39], 0
  ds_read_b64_tr_b16 a[248:249], v11 offset:20480
  buffer_atomic_add v20, v16, s[28:31], s79 offen
  v_mfma_f32_16x16x32_bf16 v[252:255], v[84:87], v[44:47], v[252:255]
  ds_read_b64_tr_b16 a[250:251], v11 offset:25600
  v_mfma_f32_16x16x32_bf16 v[252:255], v[88:91], v[52:55], v[252:255]
  ds_read_b64_tr_b16 a[252:253], v11 offset:30720
  v_mfma_f32_16x16x32_bf16 v[252:255], v[92:95], v[60:63], v[252:255]
  s_waitcnt lgkmcnt(7)
  ds_read_b64_tr_b16 a[254:255], v11 offset:35840
  v_mfma_f32_16x16x32_bf16 v[96:99], a[224:227], a[0:3], v[96:99]
  ds_read_b64_tr_b16 v[64:65], v10 offset:64
  s_add_u32 s58, s49, 2
  s_and_b32 s58, s58, 3
  s_lshl_b32 s52, s82, 2
  s_add_u32 s58, s58, s52
  s_lshl_b32 s58, s58, 14
  s_add_u32 s58, s58, 37748736
  s_add_u32 s52, s58, 0
  v_mfma_f32_16x16x32_bf16 v[96:99], a[228:231], a[16:19], v[96:99]
  ds_read_b64_tr_b16 v[66:67], v10 offset:5184
  buffer_load_dwordx4 a[64:67], v3, s[28:31], s52 offen offset:0 sc1
  v_mfma_f32_16x16x32_bf16 v[96:99], a[232:235], a[32:35], v[96:99]
  ds_read_b64_tr_b16 v[68:69], v10 offset:10304
  v_mfma_f32_16x16x32_bf16 v[96:99], a[236:239], a[48:51], v[96:99]
  ds_read_b64_tr_b16 v[70:71], v10 offset:15424
  v_mfma_f32_16x16x32_bf16 v[100:103], a[224:227], a[4:7], v[100:103]
  ds_read_b64_tr_b16 v[72:73], v10 offset:20544
  v_mfma_f32_16x16x32_bf16 v[100:103], a[228:231], a[20:23], v[100:103]
  ds_read_b64_tr_b16 v[74:75], v10 offset:25664
  v_mfma_f32_16x16x32_bf16 v[100:103], a[232:235], a[36:39], v[100:103]
  ds_read_b64_tr_b16 v[76:77], v10 offset:30784
  buffer_load_dwordx4 a[68:71], v3, s[28:31], s52 offen offset:1024 sc1
  v_mfma_f32_16x16x32_bf16 v[100:103], a[236:239], a[52:55], v[100:103]
  s_waitcnt lgkmcnt(7)
  ds_read_b64_tr_b16 v[78:79], v10 offset:35904
  v_mfma_f32_16x16x32_bf16 v[112:115], a[240:243], a[0:3], v[112:115]
  ds_read_b64_tr_b16 v[80:81], v11 offset:64
  v_mfma_f32_16x16x32_bf16 v[112:115], a[244:247], a[16:19], v[112:115]
  ds_read_b64_tr_b16 v[82:83], v11 offset:5184
  v_mfma_f32_16x16x32_bf16 v[112:115], a[248:251], a[32:35], v[112:115]
  ds_read_b64_tr_b16 v[84:85], v11 offset:10304
  v_mfma_f32_16x16x32_bf16 v[112:115], a[252:255], a[48:51], v[112:115]
  ds_read_b64_tr_b16 v[86:87], v11 offset:15424
  buffer_load_dwordx4 a[80:83], v3, s[28:31], s52 offen offset:2048 sc1
  v_mfma_f32_16x16x32_bf16 v[116:119], a[240:243], a[4:7], v[116:119]
  ds_read_b64_tr_b16 v[88:89], v11 offset:20544
  v_mfma_f32_16x16x32_bf16 v[116:119], a[244:247], a[20:23], v[116:119]
  ds_read_b64_tr_b16 v[90:91], v11 offset:25664
  v_mfma_f32_16x16x32_bf16 v[116:119], a[248:251], a[36:39], v[116:119]
  ds_read_b64_tr_b16 v[92:93], v11 offset:30784
  v_mfma_f32_16x16x32_bf16 v[116:119], a[252:255], a[52:55], v[116:119]
  s_waitcnt lgkmcnt(7)
  ds_read_b64_tr_b16 v[94:95], v11 offset:35904
  v_mfma_f32_16x16x32_bf16 v[128:131], v[64:67], a[0:3], v[128:131]
  ds_read_b64_tr_b16 a[224:225], v10 offset:128
  buffer_load_dwordx4 a[84:87], v3, s[28:31], s52 offen offset:3072 sc1
  v_mfma_f32_16x16x32_bf16 v[128:131], v[68:71], a[16:19], v[128:131]
  ds_read_b64_tr_b16 a[226:227], v10 offset:5248
  v_mfma_f32_16x16x32_bf16 v[128:131], v[72:75], a[32:35], v[128:131]
  ds_read_b64_tr_b16 a[228:229], v10 offset:10368
  v_mfma_f32_16x16x32_bf16 v[128:131], v[76:79], a[48:51], v[128:131]
  ds_read_b64_tr_b16 a[230:231], v10 offset:15488
  v_mfma_f32_16x16x32_bf16 v[132:135], v[64:67], a[4:7], v[132:135]
  ds_read_b64_tr_b16 a[232:233], v10 offset:20608
  s_add_u32 s52, s58, 4096
  v_mfma_f32_16x16x32_bf16 v[132:135], v[68:71], a[20:23], v[132:135]
  ds_read_b64_tr_b16 a[234:235], v10 offset:25728
  buffer_load_dwordx4 a[96:99], v3, s[28:31], s52 offen offset:0 sc1
  v_mfma_f32_16x16x32_bf16 v[132:135], v[72:75], a[36:39], v[132:135]
  ds_read_b64_tr_b16 a[236:237], v10 offset:30848
  v_mfma_f32_16x16x32_bf16 v[132:135], v[76:79], a[52:55], v[132:135]
  s_waitcnt lgkmcnt(7)
  ds_read_b64_tr_b16 a[238:239], v10 offset:35968
  v_mfma_f32_16x16x32_bf16 v[144:147], v[80:83], a[0:3], v[144:147]
  ds_read_b64_tr_b16 a[240:241], v11 offset:128
  v_mfma_f32_16x16x32_bf16 v[144:147], v[84:87], a[16:19], v[144:147]
  ds_read_b64_tr_b16 a[242:243], v11 offset:5248
  v_mfma_f32_16x16x32_bf16 v[144:147], v[88:91], a[32:35], v[144:147]
  ds_read_b64_tr_b16 a[244:245], v11 offset:10368
  buffer_load_dwordx4 a[100:103], v3, s[28:31], s52 offen offset:1024 sc1
  v_mfma_f32_16x16x32_bf16 v[144:147], v[92:95], a[48:51], v[144:147]
  ds_read_b64_tr_b16 a[246:247], v11 offset:15488
  v_mfma_f32_16x16x32_bf16 v[148:151], v[80:83], a[4:7], v[148:151]
  ds_read_b64_tr_b16 a[248:249], v11 offset:20608
  v_mfma_f32_16x16x32_bf16 v[148:151], v[84:87], a[20:23], v[148:151]
  ds_read_b64_tr_b16 a[250:251], v11 offset:25728
  v_mfma_f32_16x16x32_bf16 v[148:151], v[88:91], a[36:39], v[148:151]
  ds_read_b64_tr_b16 a[252:253], v11 offset:30848
  v_mfma_f32_16x16x32_bf16 v[148:151], v[92:95], a[52:55], v[148:151]
  s_waitcnt lgkmcnt(7)
  ds_read_b64_tr_b16 a[254:255], v11 offset:35968
  buffer_load_dwordx4 a[112:115], v3, s[28:31], s52 offen offset:2048 sc1
  v_mfma_f32_16x16x32_bf16 v[160:163], a[224:227], a[0:3], v[160:163]
  ds_read_b64_tr_b16 v[64:65], v10 offset:192
  v_mfma_f32_16x16x32_bf16 v[160:163], a[228:231], a[16:19], v[160:163]
  ds_read_b64_tr_b16 v[66:67], v10 offset:5312
  v_mfma_f32_16x16x32_bf16 v[160:163], a[232:235], a[32:35], v[160:163]
  ds_read_b64_tr_b16 v[68:69], v10 offset:10432
  v_mfma_f32_16x16x32_bf16 v[160:163], a[236:239], a[48:51], v[160:163]
  ds_read_b64_tr_b16 v[70:71], v10 offset:15552
  v_mfma_f32_16x16x32_bf16 v[164:167], a[224:227], a[4:7], v[164:167]
  ds_read_b64_tr_b16 v[72:73], v10 offset:20672
  buffer_load_dwordx4 a[116:119], v3, s[28:31], s52 offen offset:3072 sc1
  v_mfma_f32_16x16x32_bf16 v[164:167], a[228:231], a[20:23], v[164:167]
  ds_read_b64_tr_b16 v[74:75], v10 offset:25792
  v_mfma_f32_16x16x32_bf16 v[164:167], a[232:235], a[36:39], v[164:167]
  ds_read_b64_tr_b16 v[76:77], v10 offset:30912
  v_mfma_f32_16x16x32_bf16 v[164:167], a[236:239], a[52:55], v[164:167]
  s_waitcnt lgkmcnt(7)
  ds_read_b64_tr_b16 v[78:79], v10 offset:36032
  v_mfma_f32_16x16x32_bf16 v[176:179], a[240:243], a[0:3], v[176:179]
  ds_read_b64_tr_b16 v[80:81], v11 offset:192
  s_add_u32 s55, s49, 3
  s_and_b32 s55, s55, 3
  s_mul_i32 s55, s55, 163840
  s_add_u32 s55, s55, s54
  s_add_u32 m0, s71, 122880
  v_mfma_f32_16x16x32_bf16 v[176:179], a[244:247], a[16:19], v[176:179]
  ds_read_b64_tr_b16 v[82:83], v11 offset:5312
  buffer_load_dwordx4 v23, s[44:47], s55 offen lds
  v_mfma_f32_16x16x32_bf16 v[176:179], a[248:251], a[32:35], v[176:179]
  ds_read_b64_tr_b16 v[84:85], v11 offset:10432
  v_mfma_f32_16x16x32_bf16 v[176:179], a[252:255], a[48:51], v[176:179]
  ds_read_b64_tr_b16 v[86:87], v11 offset:15552
  v_mfma_f32_16x16x32_bf16 v[180:183], a[240:243], a[4:7], v[180:183]
  ds_read_b64_tr_b16 v[88:89], v11 offset:20672
  v_mfma_f32_16x16x32_bf16 v[180:183], a[244:247], a[20:23], v[180:183]
  ds_read_b64_tr_b16 v[90:91], v11 offset:25792
  s_add_u32 m0, s71, 123904
  v_mfma_f32_16x16x32_bf16 v[180:183], a[248:251], a[36:39], v[180:183]
  ds_read_b64_tr_b16 v[92:93], v11 offset:30912
  buffer_load_dwordx4 v24, s[44:47], s55 offen lds
  v_mfma_f32_16x16x32_bf16 v[180:183], a[252:255], a[52:55], v[180:183]
  s_waitcnt lgkmcnt(7)
  ds_read_b64_tr_b16 v[94:95], v11 offset:36032
  v_mfma_f32_16x16x32_bf16 v[192:195], v[64:67], a[0:3], v[192:195]
  ds_read_b64_tr_b16 a[224:225], v10 offset:256
  v_mfma_f32_16x16x32_bf16 v[192:195], v[68:71], a[16:19], v[192:195]
  ds_read_b64_tr_b16 a[226:227], v10 offset:5376
  v_mfma_f32_16x16x32_bf16 v[192:195], v[72:75], a[32:35], v[192:195]
  ds_read_b64_tr_b16 a[228:229], v10 offset:10496
  s_add_u32 m0, s71, 124928
  v_mfma_f32_16x16x32_bf16 v[192:195], v[76:79], a[48:51], v[192:195]
  ds_read_b64_tr_b16 a[230:231], v10 offset:15616
  buffer_load_dwordx4 v25, s[44:47], s55 offen lds
  v_mfma_f32_16x16x32_bf16 v[196:199], v[64:67], a[4:7], v[196:199]
  ds_read_b64_tr_b16 a[232:233], v10 offset:20736
  v_mfma_f32_16x16x32_bf16 v[196:199], v[68:71], a[20:23], v[196:199]
  ds_read_b64_tr_b16 a[234:235], v10 offset:25856
  v_mfma_f32_16x16x32_bf16 v[196:199], v[72:75], a[36:39], v[196:199]
  ds_read_b64_tr_b16 a[236:237], v10 offset:30976
  v_mfma_f32_16x16x32_bf16 v[196:199], v[76:79], a[52:55], v[196:199]
  s_waitcnt lgkmcnt(7)
  ds_read_b64_tr_b16 a[238:239], v10 offset:36096
  s_add_u32 m0, s71, 125952
  v_mfma_f32_16x16x32_bf16 v[208:211], v[80:83], a[0:3], v[208:211]
  ds_read_b64_tr_b16 a[240:241], v11 offset:256
  buffer_load_dwordx4 v26, s[44:47], s55 offen lds
  v_mfma_f32_16x16x32_bf16 v[208:211], v[84:87], a[16:19], v[208:211]
  ds_read_b64_tr_b16 a[242:243], v11 offset:5376
  v_mfma_f32_16x16x32_bf16 v[208:211], v[88:91], a[32:35], v[208:211]
  ds_read_b64_tr_b16 a[244:245], v11 offset:10496
  v_mfma_f32_16x16x32_bf16 v[208:211], v[92:95], a[48:51], v[208:211]
  ds_read_b64_tr_b16 a[246:247], v11 offset:15616
  v_mfma_f32_16x16x32_bf16 v[212:215], v[80:83], a[4:7], v[212:215]
  ds_read_b64_tr_b16 a[248:249], v11 offset:20736
  s_add_u32 m0, s71, 126976
  v_mfma_f32_16x16x32_bf16 v[212:215], v[84:87], a[20:23], v[212:215]
  ds_read_b64_tr_b16 a[250:251], v11 offset:25856
  buffer_load_dwordx4 v27, s[44:47], s55 offen lds
  v_mfma_f32_16x16x32_bf16 v[212:215], v[88:91], a[36:39], v[212:215]
  ds_read_b64_tr_b16 a[252:253], v11 offset:30976
  v_mfma_f32_16x16x32_bf16 v[212:215], v[92:95], a[52:55], v[212:215]
  s_waitcnt lgkmcnt(7)
  ds_read_b64_tr_b16 a[254:255], v11 offset:36096
  s_waitcnt vmcnt(14)
  s_barrier
  v_mfma_f32_16x16x32_bf16 v[224:227], a[224:227], a[0:3], v[224:227]
  ds_read_b64_tr_b16 v[64:65], v12 offset:0
  v_mfma_f32_16x16x32_bf16 v[224:227], a[228:231], a[16:19], v[224:227]
  ds_read_b64_tr_b16 v[66:67], v12 offset:5120
  s_add_u32 s55, s55, 20480
  s_add_u32 m0, s71, 128000
  v_mfma_f32_16x16x32_bf16 v[224:227], a[232:235], a[32:35], v[224:227]
  ds_read_b64_tr_b16 v[68:69], v12 offset:10240
  buffer_load_dwordx4 v23, s[44:47], s55 offen lds
  v_mfma_f32_16x16x32_bf16 v[224:227], a[236:239], a[48:51], v[224:227]
  ds_read_b64_tr_b16 v[70:71], v12 offset:15360
  v_mfma_f32_16x16x32_bf16 v[228:231], a[224:227], a[4:7], v[228:231]
  ds_read_b64_tr_b16 v[72:73], v12 offset:20480
  v_mfma_f32_16x16x32_bf16 v[228:231], a[228:231], a[20:23], v[228:231]
  ds_read_b64_tr_b16 v[74:75], v12 offset:25600
  v_mfma_f32_16x16x32_bf16 v[228:231], a[232:235], a[36:39], v[228:231]
  ds_read_b64_tr_b16 v[76:77], v12 offset:30720
  s_add_u32 m0, s71, 129024
  v_mfma_f32_16x16x32_bf16 v[228:231], a[236:239], a[52:55], v[228:231]
  s_waitcnt lgkmcnt(7)
  ds_read_b64_tr_b16 v[78:79], v12 offset:35840
  buffer_load_dwordx4 v24, s[44:47], s55 offen lds
  v_mfma_f32_16x16x32_bf16 v[240:243], a[240:243], a[0:3], v[240:243]
  ds_read_b64_tr_b16 v[80:81], v13 offset:0
  v_mfma_f32_16x16x32_bf16 v[240:243], a[244:247], a[16:19], v[240:243]
  ds_read_b64_tr_b16 v[82:83], v13 offset:5120
  v_mfma_f32_16x16x32_bf16 v[240:243], a[248:251], a[32:35], v[240:243]
  ds_read_b64_tr_b16 v[84:85], v13 offset:10240
  v_mfma_f32_16x16x32_bf16 v[240:243], a[252:255], a[48:51], v[240:243]
  ds_read_b64_tr_b16 v[86:87], v13 offset:15360
  s_add_u32 m0, s71, 130048
  v_mfma_f32_16x16x32_bf16 v[244:247], a[240:243], a[4:7], v[244:247]
  ds_read_b64_tr_b16 v[88:89], v13 offset:20480
  buffer_load_dwordx4 v25, s[44:47], s55 offen lds
  v_mfma_f32_16x16x32_bf16 v[244:247], a[244:247], a[20:23], v[244:247]
  ds_read_b64_tr_b16 v[90:91], v13 offset:25600
  v_mfma_f32_16x16x32_bf16 v[244:247], a[248:251], a[36:39], v[244:247]
  ds_read_b64_tr_b16 v[92:93], v13 offset:30720
  v_mfma_f32_16x16x32_bf16 v[244:247], a[252:255], a[52:55], v[244:247]
  s_waitcnt lgkmcnt(7)
  ds_read_b64_tr_b16 v[94:95], v13 offset:35840
  s_waitcnt vmcnt(15)
  v_mfma_f32_16x16x32_bf16 v[96:99], v[64:67], a[64:67], v[96:99]
  ds_read_b64_tr_b16 a[224:225], v12 offset:64
  s_add_u32 m0, s71, 131072
  s_waitcnt vmcnt(13)
  v_mfma_f32_16x16x32_bf16 v[96:99], v[68:71], a[80:83], v[96:99]
  ds_read_b64_tr_b16 a[226:227], v12 offset:5184
  buffer_load_dwordx4 v26, s[44:47], s55 offen lds
  s_waitcnt vmcnt(12)
  v_mfma_f32_16x16x32_bf16 v[96:99], v[72:75], a[96:99], v[96:99]
  ds_read_b64_tr_b16 a[228:229], v12 offset:10304
  s_waitcnt vmcnt(10)
  v_mfma_f32_16x16x32_bf16 v[96:99], v[76:79], a[112:115], v[96:99]
  ds_read_b64_tr_b16 a[230:231], v12 offset:15424
  v_mfma_f32_16x16x32_bf16 v[100:103], v[64:67], a[68:71], v[100:103]
  ds_read_b64_tr_b16 a[232:233], v12 offset:20544
  v_mfma_f32_16x16x32_bf16 v[100:103], v[68:71], a[84:87], v[100:103]
  ds_read_b64_tr_b16 a[234:235], v12 offset:25664
  s_add_u32 m0, s71, 132096
  v_mfma_f32_16x16x32_bf16 v[100:103], v[72:75], a[100:103], v[100:103]
  ds_read_b64_tr_b16 a[236:237], v12 offset:30784
  buffer_load_dwordx4 v27, s[44:47], s55 offen lds
  s_waitcnt vmcnt(10)
  v_mfma_f32_16x16x32_bf16 v[100:103], v[76:79], a[116:119], v[100:103]
  s_waitcnt lgkmcnt(7)
  ds_read_b64_tr_b16 a[238:239], v12 offset:35904
  v_mfma_f32_16x16x32_bf16 v[112:115], v[80:83], a[64:67], v[112:115]
  ds_read_b64_tr_b16 a[240:241], v13 offset:64
  v_mfma_f32_16x16x32_bf16 v[112:115], v[84:87], a[80:83], v[112:115]
  ds_read_b64_tr_b16 a[242:243], v13 offset:5184
  v_mfma_f32_16x16x32_bf16 v[112:115], v[88:91], a[96:99], v[112:115]
  ds_read_b64_tr_b16 a[244:245], v13 offset:10304
  v_mov_b32 v18, 0
  v_mfma_f32_16x16x32_bf16 v[112:115], v[92:95], a[112:115], v[112:115]
  ds_read_b64_tr_b16 a[246:247], v13 offset:15424
  buffer_atomic_add v18, v16, s[28:31], s79 offen sc0
  v_mfma_f32_16x16x32_bf16 v[116:119], v[80:83], a[68:71], v[116:119]
  ds_read_b64_tr_b16 a[248:249], v13 offset:20544
  v_mfma_f32_16x16x32_bf16 v[116:119], v[84:87], a[84:87], v[116:119]
  ds_read_b64_tr_b16 a[250:251], v13 offset:25664
  s_add_u32 s58, s49, 3
  s_and_b32 s58, s58, 3
  s_lshl_b32 s52, s82, 2
  s_add_u32 s58, s58, s52
  s_lshl_b32 s58, s58, 14
  s_add_u32 s58, s58, 37748736
  s_add_u32 s52, s58, 0
  v_mfma_f32_16x16x32_bf16 v[116:119], v[88:91], a[100:103], v[116:119]
  ds_read_b64_tr_b16 a[252:253], v13 offset:30784
  buffer_load_dwordx4 a[128:131], v3, s[28:31], s52 offen offset:0 sc1
  v_mfma_f32_16x16x32_bf16 v[116:119], v[92:95], a[116:119], v[116:119]
  s_waitcnt lgkmcnt(7)
  ds_read_b64_tr_b16 a[254:255], v13 offset:35904
  v_mfma_f32_16x16x32_bf16 v[128:131], a[224:227], a[64:67], v[128:131]
  ds_read_b64_tr_b16 v[64:65], v12 offset:128
  v_mfma_f32_16x16x32_bf16 v[128:131], a[228:231], a[80:83], v[128:131]
  ds_read_b64_tr_b16 v[66:67], v12 offset:5248
  v_mfma_f32_16x16x32_bf16 v[128:131], a[232:235], a[96:99], v[128:131]
  ds_read_b64_tr_b16 v[68:69], v12 offset:10368
  buffer_load_dwordx4 a[132:135], v3, s[28:31], s52 offen offset:1024 sc1
  v_mfma_f32_16x16x32_bf16 v[128:131], a[236:239], a[112:115], v[128:131]
  ds_read_b64_tr_b16 v[70:71], v12 offset:15488
  v_mfma_f32_16x16x32_bf16 v[132:135], a[224:227], a[68:71], v[132:135]
  ds_read_b64_tr_b16 v[72:73], v12 offset:20608
  v_mfma_f32_16x16x32_bf16 v[132:135], a[228:231], a[84:87], v[132:135]
  ds_read_b64_tr_b16 v[74:75], v12 offset:25728
  v_mfma_f32_16x16x32_bf16 v[132:135], a[232:235], a[100:103], v[132:135]
  ds_read_b64_tr_b16 v[76:77], v12 offset:30848
  buffer_load_dwordx4 a[144:147], v3, s[28:31], s52 offen offset:2048 sc1
  v_mfma_f32_16x16x32_bf16 v[132:135], a[236:239], a[116:119], v[132:135]
  s_waitcnt lgkmcnt(7)
  ds_read_b64_tr_b16 v[78:79], v12 offset:35968
  v_mfma_f32_16x16x32_bf16 v[144:147], a[240:243], a[64:67], v[144:147]
  ds_read_b64_tr_b16 v[80:81], v13 offset:128
  v_mfma_f32_16x16x32_bf16 v[144:147], a[244:247], a[80:83], v[144:147]
  ds_read_b64_tr_b16 v[82:83], v13 offset:5248
  v_mfma_f32_16x16x32_bf16 v[144:147], a[248:251], a[96:99], v[144:147]
  ds_read_b64_tr_b16 v[84:85], v13 offset:10368
  buffer_load_dwordx4 a[148:151], v3, s[28:31], s52 offen offset:3072 sc1
  v_mfma_f32_16x16x32_bf16 v[144:147], a[252:255], a[112:115], v[144:147]
  ds_read_b64_tr_b16 v[86:87], v13 offset:15488
  v_mfma_f32_16x16x32_bf16 v[148:151], a[240:243], a[68:71], v[148:151]
  ds_read_b64_tr_b16 v[88:89], v13 offset:20608
  v_mfma_f32_16x16x32_bf16 v[148:151], a[244:247], a[84:87], v[148:151]
  ds_read_b64_tr_b16 v[90:91], v13 offset:25728
  s_add_u32 s52, s58, 4096
  v_mfma_f32_16x16x32_bf16 v[148:151], a[248:251], a[100:103], v[148:151]
  ds_read_b64_tr_b16 v[92:93], v13 offset:30848
  buffer_load_dwordx4 a[160:163], v3, s[28:31], s52 offen offset:0 sc1
  v_mfma_f32_16x16x32_bf16 v[148:151], a[252:255], a[116:119], v[148:151]
  s_waitcnt lgkmcnt(7)
  ds_read_b64_tr_b16 v[94:95], v13 offset:35968
  v_mfma_f32_16x16x32_bf16 v[160:163], v[64:67], a[64:67], v[160:163]
  ds_read_b64_tr_b16 a[224:225], v12 offset:192
  v_mfma_f32_16x16x32_bf16 v[160:163], v[68:71], a[80:83], v[160:163]
  ds_read_b64_tr_b16 a[226:227], v12 offset:5312
  v_mfma_f32_16x16x32_bf16 v[160:163], v[72:75], a[96:99], v[160:163]
  ds_read_b64_tr_b16 a[228:229], v12 offset:10432
  buffer_load_dwordx4 a[164:167], v3, s[28:31], s52 offen offset:1024 sc1
  v_mfma_f32_16x16x32_bf16 v[160:163], v[76:79], a[112:115], v[160:163]
  ds_read_b64_tr_b16 a[230:231], v12 offset:15552
  v_mfma_f32_16x16x32_bf16 v[164:167], v[64:67], a[68:71], v[164:167]
  ds_read_b64_tr_b16 a[232:233], v12 offset:20672
  v_mfma_f32_16x16x32_bf16 v[164:167], v[68:71], a[84:87], v[164:167]
  ds_read_b64_tr_b16 a[234:235], v12 offset:25792
  v_mfma_f32_16x16x32_bf16 v[164:167], v[72:75], a[100:103], v[164:167]
  ds_read_b64_tr_b16 a[236:237], v12 offset:30912
  buffer_load_dwordx4 a[176:179], v3, s[28:31], s52 offen offset:2048 sc1
  v_mfma_f32_16x16x32_bf16 v[164:167], v[76:79], a[116:119], v[164:167]
  s_waitcnt lgkmcnt(7)
  ds_read_b64_tr_b16 a[238:239], v12 offset:36032
  v_mfma_f32_16x16x32_bf16 v[176:179], v[80:83], a[64:67], v[176:179]
  ds_read_b64_tr_b16 a[240:241], v13 offset:192
  v_mfma_f32_16x16x32_bf16 v[176:179], v[84:87], a[80:83], v[176:179]
  ds_read_b64_tr_b16 a[242:243], v13 offset:5312
  v_mfma_f32_16x16x32_bf16 v[176:179], v[88:91], a[96:99], v[176:179]
  ds_read_b64_tr_b16 a[244:245], v13 offset:10432
  buffer_load_dwordx4 a[180:183], v3, s[28:31], s52 offen offset:3072 sc1
  v_mfma_f32_16x16x32_bf16 v[176:179], v[92:95], a[112:115], v[176:179]
  ds_read_b64_tr_b16 a[246:247], v13 offset:15552
  v_mfma_f32_16x16x32_bf16 v[180:183], v[80:83], a[68:71], v[180:183]
  ds_read_b64_tr_b16 a[248:249], v13 offset:20672
  v_mfma_f32_16x16x32_bf16 v[180:183], v[84:87], a[84:87], v[180:183]
  ds_read_b64_tr_b16 a[250:251], v13 offset:25792
  v_mfma_f32_16x16x32_bf16 v[180:183], v[88:91], a[100:103], v[180:183]
  ds_read_b64_tr_b16 a[252:253], v13 offset:30912
  s_waitcnt vmcnt(8)
  v_readfirstlane_b32 s3, v18
  s_nop 0
  s_cmp_lt_u32 s3, 4
  s_cbranch_scc1 L_pc_w
L_pc_ok:
  v_mfma_f32_16x16x32_bf16 v[180:183], v[92:95], a[116:119], v[180:183]
  s_waitcnt lgkmcnt(7)
  ds_read_b64_tr_b16 a[254:255], v13 offset:36032
  s_add_u32 s58, s49, 1
  s_and_b32 s58, s58, 3
  s_lshl_b32 s52, s82, 2
  s_add_u32 s58, s58, s52
  s_lshl_b32 s58, s58, 14
  s_add_u32 s58, s58, 37748736
  s_add_u32 s52, s58, 8192
  v_mfma_f32_16x16x32_bf16 v[192:195], a[224:227], a[64:67], v[192:195]
  ds_read_b64_tr_b16 v[64:65], v12 offset:256
  buffer_load_dwordx4 a[8:11], v3, s[28:31], s52 offen offset:0 sc1
  v_mfma_f32_16x16x32_bf16 v[192:195], a[228:231], a[80:83], v[192:195]
  ds_read_b64_tr_b16 v[66:67], v12 offset:5376
  v_mfma_f32_16x16x32_bf16 v[192:195], a[232:235], a[96:99], v[192:195]
  ds_read_b64_tr_b16 v[68:69], v12 offset:10496
  v_mfma_f32_16x16x32_bf16 v[192:195], a[236:239], a[112:115], v[192:195]
  ds_read_b64_tr_b16 v[70:71], v12 offset:15616
  v_mfma_f32_16x16x32_bf16 v[196:199], a[224:227], a[68:71], v[196:199]
  ds_read_b64_tr_b16 v[72:73], v12 offset:20736
  v_mfma_f32_16x16x32_bf16 v[196:199], a[228:231], a[84:87], v[196:199]
  ds_read_b64_tr_b16 v[74:75], v12 offset:25856
  buffer_load_dwordx4 a[12:15], v3, s[28:31], s52 offen offset:1024 sc1
  v_mfma_f32_16x16x32_bf16 v[196:199], a[232:235], a[100:103], v[196:199]
  ds_read_b64_tr_b16 v[76:77], v12 offset:30976
  v_mfma_f32_16x16x32_bf16 v[196:199], a[236:239], a[116:119], v[196:199]
  s_waitcnt lgkmcnt(7)
  ds_read_b64_tr_b16 v[78:79], v12 offset:36096
  v_mfma_f32_16x16x32_bf16 v[208:211], a[240:243], a[64:67], v[208:211]
  ds_read_b64_tr_b16 v[80:81], v13 offset:256
  v_mfma_f32_16x16x32_bf16 v[208:211], a[244:247], a[80:83], v[208:211]
  ds_read_b64_tr_b16 v[82:83], v13 offset:5376
  v_mfma_f32_16x16x32_bf16 v[208:211], a[248:251], a[96:99], v[208:211]
  ds_read_b64_tr_b16 v[84:85], v13 offset:10496
  buffer_load_dwordx4 a[24:27], v3, s[28:31], s52 offen offset:2048 sc1
  v_mfma_f32_16x16x32_bf16 v[208:211], a[252:255], a[112:115], v[208:211]
  ds_read_b64_tr_b16 v[86:87], v13 offset:15616
  v_mfma_f32_16x16x32_bf16 v[212:215], a[240:243], a[68:71], v[212:215]
  ds_read_b64_tr_b16 v[88:89], v13 offset:20736
  v_mfma_f32_16x16x32_bf16 v[212:215], a[244:247], a[84:87], v[212:215]
  ds_read_b64_tr_b16 v[90:91], v13 offset:25856
  v_mfma_f32_16x16x32_bf16 v[212:215], a[248:251], a[100:103], v[212:215]
  ds_read_b64_tr_b16 v[92:93], v13 offset:30976
  v_mfma_f32_16x16x32_bf16 v[212:215], a[252:255], a[116:119], v[212:215]
  s_waitcnt lgkmcnt(7)
  ds_read_b64_tr_b16 v[94:95], v13 offset:36096
  buffer_load_dwordx4 a[28:31], v3, s[28:31], s52 offen offset:3072 sc1
  s_barrier
  v_mfma_f32_16x16x32_bf16 v[224:227], v[64:67], a[64:67], v[224:227]
  ds_read_b64_tr_b16 a[224:225], v14 offset:0
  v_mfma_f32_16x16x32_bf16 v[224:227], v[68:71], a[80:83], v[224:227]
  ds_read_b64_tr_b16 a[226:227], v14 offset:5120
  v_mfma_f32_16x16x32_bf16 v[224:227], v[72:75], a[96:99], v[224:227]
  ds_read_b64_tr_b16 a[228:229], v14 offset:10240
  v_mfma_f32_16x16x32_bf16 v[224:227], v[76:79], a[112:115], v[224:227]
  ds_read_b64_tr_b16 a[230:231], v14 offset:15360
  s_add_u32 s52, s58, 12288
  v_mfma_f32_16x16x32_bf16 v[228:231], v[64:67], a[68:71], v[228:231]
  ds_read_b64_tr_b16 a[232:233], v14 offset:20480
  buffer_load_dwordx4 a[40:43], v3, s[28:31], s52 offen offset:0 sc1
  v_mfma_f32_16x16x32_bf16 v[228:231], v[68:71], a[84:87], v[228:231]
  ds_read_b64_tr_b16 a[234:235], v14 offset:25600
  v_mfma_f32_16x16x32_bf16 v[228:231], v[72:75], a[100:103], v[228:231]
  s_and_b32 s43, s2, 1
  ds_read_b64_tr_b16 a[236:237], v14 offset:30720
  v_mfma_f32_16x16x32_bf16 v[228:231], v[76:79], a[116:119], v[228:231]
  s_waitcnt lgkmcnt(7)
  s_lshl_b32 s43, s43, 2
  ds_read_b64_tr_b16 a[238:239], v14 offset:35840
  v_mfma_f32_16x16x32_bf16 v[240:243], v[80:83], a[64:67], v[240:243]
  s_bfe_u32 s6, s2, 0x20003
  ds_read_b64_tr_b16 a[240:241], v15 offset:0
  v_mfma_f32_16x16x32_bf16 v[240:243], v[84:87], a[80:83], v[240:243]
  s_add_u32 s43, s43, s6
  ds_read_b64_tr_b16 a[242:243], v15 offset:5120
  buffer_load_dwordx4 a[44:47], v3, s[28:31], s52 offen offset:1024 sc1
  v_mfma_f32_16x16x32_bf16 v[240:243], v[88:91], a[96:99], v[240:243]
  s_bfe_u32 s42, s2, 0x20001
  ds_read_b64_tr_b16 a[244:245], v15 offset:10240
  v_mfma_f32_16x16x32_bf16 v[240:243], v[92:95], a[112:115], v[240:243]
  s_lshl_b32 s42, s42, 2
  ds_read_b64_tr_b16 a[246:247], v15 offset:15360
  v_mfma_f32_16x16x32_bf16 v[244:247], v[80:83], a[68:71], v[244:247]
  s_bfe_u32 s6, s2, 0x20005
  ds_read_b64_tr_b16 a[248:249], v15 offset:20480
  v_mfma_f32_16x16x32_bf16 v[244:247], v[84:87], a[84:87], v[244:247]
  s_add_u32 s42, s42, s6
  ds_read_b64_tr_b16 a[250:251], v15 offset:25600
  v_mfma_f32_16x16x32_bf16 v[244:247], v[88:91], a[100:103], v[244:247]
  s_lshr_b32 s6, s2, 7
  ds_read_b64_tr_b16 a[252:253], v15 offset:30720
  buffer_load_dwordx4 a[56:59], v3, s[28:31], s52 offen offset:2048 sc1
  v_mfma_f32_16x16x32_bf16 v[244:247], v[92:95], a[116:119], v[244:247]
  s_waitcnt lgkmcnt(7)
  s_lshl_b32 s6, s6, 4
  ds_read_b64_tr_b16 a[254:255], v15 offset:35840
  s_waitcnt vmcnt(14)
  v_mfma_f32_16x16x32_bf16 v[96:99], a[224:227], a[128:131], v[96:99]
  s_add_u32 s42, s42, s6
  ds_read_b64_tr_b16 v[64:65], v14 offset:64
  s_waitcnt vmcnt(12)
  v_mfma_f32_16x16x32_bf16 v[96:99], a[228:231], a[144:147], v[96:99]
  s_lshr_b32 s6, s43, 1
  ds_read_b64_tr_b16 v[66:67], v14 offset:5184
  s_waitcnt vmcnt(10)
  v_mfma_f32_16x16x32_bf16 v[96:99], a[232:235], a[160:163], v[96:99]
  s_mul_i32 s6, s6, 10
  ds_read_b64_tr_b16 v[68:69], v14 offset:10304
  s_waitcnt vmcnt(8)
  v_mfma_f32_16x16x32_bf16 v[96:99], a[236:239], a[176:179], v[96:99]
  s_and_b32 s7, s43, 1
  ds_read_b64_tr_b16 v[70:71], v14 offset:15424
  buffer_load_dwordx4 a[60:63], v3, s[28:31], s52 offen offset:3072 sc1
  v_mfma_f32_16x16x32_bf16 v[100:103], a[224:227], a[132:135], v[100:103]
HS29:
  s_cbranch_execz HOPR_e
  s_add_u32 s37, s6, 4
  ds_read_b64_tr_b16 v[72:73], v14 offset:20544
  v_mfma_f32_16x16x32_bf16 v[100:103], a[228:231], a[148:151], v[100:103]
  s_add_u32 s37, s37, s7
  ds_read_b64_tr_b16 v[74:75], v14 offset:25664
  v_mfma_f32_16x16x32_bf16 v[100:103], a[232:235], a[164:167], v[100:103]
  s_mul_i32 s7, s7, 6
  ds_read_b64_tr_b16 v[76:77], v14 offset:30784
  s_waitcnt vmcnt(8)
  v_mfma_f32_16x16x32_bf16 v[100:103], a[236:239], a[180:183], v[100:103]
  s_waitcnt lgkmcnt(7)
  s_add_u32 s36, s6, s7
  ds_read_b64_tr_b16 v[78:79], v14 offset:35904
  s_add_u32 s58, s49, 2
  s_and_b32 s58, s58, 3
  s_lshl_b32 s52, s82, 2
  s_add_u32 s58, s58, s52
  s_lshl_b32 s58, s58, 14
  s_add_u32 s58, s58, 37748736
  s_add_u32 s52, s58, 8192
  v_mfma_f32_16x16x32_bf16 v[112:115], a[240:243], a[128:131], v[112:115]
  s_mul_i32 s59, s42, 81920
  ds_read_b64_tr_b16 v[80:81], v15 offset:64
  buffer_load_dwordx4 a[72:75], v3, s[28:31], s52 offen offset:0 sc1
  v_mfma_f32_16x16x32_bf16 v[112:115], a[244:247], a[144:147], v[112:115]
  s_lshl_b32 s6, s48, 10
  ds_read_b64_tr_b16 v[82:83], v15 offset:5184
  v_cvt_pk_bf16_f32 v96, v96, v97
  v_mfma_f32_16x16x32_bf16 v[112:115], a[248:251], a[160:163], v[112:115]
  s_add_u32 s59, s59, s6
  ds_read_b64_tr_b16 v[84:85], v15 offset:10304
  v_cvt_pk_bf16_f32 v97, v98, v99
  v_mfma_f32_16x16x32_bf16 v[112:115], a[252:255], a[176:179], v[112:115]
  s_add_u32 s38, s59, 102760448
  ds_read_b64_tr_b16 v[86:87], v15 offset:15424
  v_mfma_f32_16x16x32_bf16 v[116:119], a[240:243], a[132:135], v[116:119]
  s_add_u32 s59, s59, 75497472
  ds_read_b64_tr_b16 v[88:89], v15 offset:20544
  v_mfma_f32_16x16x32_bf16 v[116:119], a[244:247], a[148:151], v[116:119]
  s_lshl_b32 s6, s36, 11
  ds_read_b64_tr_b16 v[90:91], v15 offset:25664
  v_cvt_pk_bf16_f32 v100, v100, v101
  v_mfma_f32_16x16x32_bf16 v[116:119], a[248:251], a[164:167], v[116:119]
  ds_read_b64_tr_b16 v[92:93], v15 offset:30784
  buffer_load_dwordx4 a[76:79], v3, s[28:31], s52 offen offset:1024 sc1
  v_mfma_f32_16x16x32_bf16 v[116:119], a[252:255], a[180:183], v[116:119]
  s_waitcnt lgkmcnt(7)
  ds_read_b64_tr_b16 v[94:95], v15 offset:35904
  v_cvt_pk_bf16_f32 v101, v102, v103
  v_mfma_f32_16x16x32_bf16 v[128:131], v[64:67], a[128:131], v[128:131]
  ds_read_b64_tr_b16 a[224:225], v14 offset:128
  v_add_u32 v28, s6, v3
  v_mfma_f32_16x16x32_bf16 v[128:131], v[68:71], a[144:147], v[128:131]
  ds_read_b64_tr_b16 a[226:227], v14 offset:5248
  v_add_u32 v29, 4096, v28
  v_mfma_f32_16x16x32_bf16 v[128:131], v[72:75], a[160:163], v[128:131]
  s_lshr_b32 s6, s37, 1
  ds_read_b64_tr_b16 a[228:229], v14 offset:10368
  v_cvt_pk_bf16_f32 v98, v112, v113
  v_mfma_f32_16x16x32_bf16 v[128:131], v[76:79], a[176:179], v[128:131]
  s_lshl_b32 s6, s6, 12
  ds_read_b64_tr_b16 a[230:231], v14 offset:15488
  v_cvt_pk_bf16_f32 v99, v114, v115
  v_mfma_f32_16x16x32_bf16 v[132:135], v[64:67], a[132:135], v[132:135]
  s_add_u32 s53, s40, 0
  ds_read_b64_tr_b16 a[232:233], v14 offset:20608
  buffer_load_dwordx4 a[88:91], v3, s[28:31], s52 offen offset:2048 sc1
  v_mfma_f32_16x16x32_bf16 v[132:135], v[68:71], a[148:151], v[132:135]
  ds_read_b64_tr_b16 a[234:235], v14 offset:25728
  buffer_store_dwordx4 v[96:99], v3, s[28:31], s53 offen offset:0 sc1
  v_mfma_f32_16x16x32_bf16 v[132:135], v[72:75], a[164:167], v[132:135]
  ds_read_b64_tr_b16 a[236:237], v14 offset:30848
  v_add_u32 v30, s6, v3
  v_mfma_f32_16x16x32_bf16 v[132:135], v[76:79], a[180:183], v[132:135]
  s_waitcnt lgkmcnt(7)
  s_lshr_b32 s6, s42, 1
  ds_read_b64_tr_b16 a[238:239], v14 offset:35968
  v_mfma_f32_16x16x32_bf16 v[144:147], v[80:83], a[128:131], v[144:147]
  s_sub_u32 s7, 15, s6
  ds_read_b64_tr_b16 a[240:241], v15 offset:128
  v_mfma_f32_16x16x32_bf16 v[144:147], v[84:87], a[144:147], v[144:147]
  s_min_u32 s6, s6, s7
  ds_read_b64_tr_b16 a[242:243], v15 offset:5248
  v_cvt_pk_bf16_f32 v128, v128, v129
  v_mfma_f32_16x16x32_bf16 v[144:147], v[88:91], a[160:163], v[144:147]
  s_lshl_b32 s6, s6, 2
  ds_read_b64_tr_b16 a[244:245], v15 offset:10368
  buffer_load_dwordx4 a[92:95], v3, s[28:31], s52 offen offset:3072 sc1
  v_mfma_f32_16x16x32_bf16 v[144:147], v[92:95], a[176:179], v[144:147]
  s_lshr_b32 s7, s43, 1
  ds_read_b64_tr_b16 a[246:247], v15 offset:15488
  v_cvt_pk_bf16_f32 v129, v130, v131
  v_mfma_f32_16x16x32_bf16 v[148:151], v[80:83], a[132:135], v[148:151]
  s_add_u32 s6, s6, s7
  ds_read_b64_tr_b16 a[248:249], v15 offset:20608
  v_mfma_f32_16x16x32_bf16 v[148:151], v[84:87], a[148:151], v[148:151]
  s_lshl_b32 s6, s6, 1
  ds_read_b64_tr_b16 a[250:251], v15 offset:25728
  v_cvt_pk_bf16_f32 v132, v132, v133
  v_mfma_f32_16x16x32_bf16 v[148:151], v[88:91], a[164:167], v[148:151]
  s_and_b32 s7, s42, 1
  ds_read_b64_tr_b16 a[252:253], v15 offset:30848
  v_cvt_pk_bf16_f32 v133, v134, v135
  v_mfma_f32_16x16x32_bf16 v[148:151], v[92:95], a[180:183], v[148:151]
  s_waitcnt lgkmcnt(7)
  s_xor_b32 s7, s7, 1
  ds_read_b64_tr_b16 a[254:255], v15 offset:35968
  v_cvt_pk_bf16_f32 v102, v116, v117
  s_add_u32 s52, s58, 12288
  v_mfma_f32_16x16x32_bf16 v[160:163], a[224:227], a[128:131], v[160:163]
  s_add_u32 s6, s6, s7
  ds_read_b64_tr_b16 v[64:65], v14 offset:192
  buffer_load_dwordx4 a[104:107], v3, s[28:31], s52 offen offset:0 sc1
  v_mfma_f32_16x16x32_bf16 v[160:163], a[228:231], a[144:147], v[160:163]
  s_lshl_b32 s6, s6, 1
  ds_read_b64_tr_b16 v[66:67], v14 offset:5312
  v_cvt_pk_bf16_f32 v103, v118, v119
  v_mfma_f32_16x16x32_bf16 v[160:163], a[232:235], a[160:163], v[160:163]
  s_add_u32 s53, s40, 0
  ds_read_b64_tr_b16 v[68:69], v14 offset:10432
  v_mfma_f32_16x16x32_bf16 v[160:163], a[236:239], a[176:179], v[160:163]
  s_and_b32 s7, s48, 1
  ds_read_b64_tr_b16 v[70:71], v14 offset:15552
  buffer_store_dwordx4 v[100:103], v3, s[28:31], s53 offen offset:2048 sc1
  v_mfma_f32_16x16x32_bf16 v[164:167], a[224:227], a[132:135], v[164:167]
  s_add_u32 s6, s6, s7
  ds_read_b64_tr_b16 v[72:73], v14 offset:20672
  v_mfma_f32_16x16x32_bf16 v[164:167], a[228:231], a[148:151], v[164:167]
  s_lshl_b32 s6, s6, 1
  ds_read_b64_tr_b16 v[74:75], v14 offset:25792
  v_mfma_f32_16x16x32_bf16 v[164:167], a[232:235], a[164:167], v[164:167]
  s_lshr_b32 s7, s42, 4
  ds_read_b64_tr_b16 v[76:77], v14 offset:30912
  buffer_load_dwordx4 a[108:111], v3, s[28:31], s52 offen offset:1024 sc1
  v_mfma_f32_16x16x32_bf16 v[164:167], a[236:239], a[180:183], v[164:167]
  s_waitcnt lgkmcnt(7)
  s_add_u32 s6, s6, s7
  ds_read_b64_tr_b16 v[78:79], v14 offset:36032
  v_mfma_f32_16x16x32_bf16 v[176:179], a[240:243], a[128:131], v[176:179]
  s_lshl_b32 s6, s6, 7
  ds_read_b64_tr_b16 v[80:81], v15 offset:192
  v_mfma_f32_16x16x32_bf16 v[176:179], a[244:247], a[144:147], v[176:179]
  s_add_u32 s39, s6, 491520
  ds_read_b64_tr_b16 v[82:83], v15 offset:5312
  v_cvt_pk_bf16_f32 v160, v160, v161
  v_mfma_f32_16x16x32_bf16 v[176:179], a[248:251], a[160:163], v[176:179]
  s_cmp_eq_u32 s7, 2
  s_cselect_b32 s83, 0x40000000, s39
  ds_read_b64_tr_b16 v[84:85], v15 offset:10432
  v_cvt_pk_bf16_f32 v161, v162, v163
  v_mfma_f32_16x16x32_bf16 v[176:179], a[252:255], a[176:179], v[176:179]
  s_mov_b32 s10, 0x1000
  ds_read_b64_tr_b16 v[86:87], v15 offset:15552
  v_mfma_f32_16x16x32_bf16 v[180:183], a[240:243], a[132:135], v[180:183]
  s_mov_b32 s11, 0x20000
  ds_read_b64_tr_b16 v[88:89], v15 offset:20672
  buffer_load_dwordx4 a[120:123], v3, s[28:31], s52 offen offset:2048 sc1
  v_mfma_f32_16x16x32_bf16 v[180:183], a[244:247], a[148:151], v[180:183]
  s_mov_b32 s14, 0x280000
  ds_read_b64_tr_b16 v[90:91], v15 offset:25792
  v_cvt_pk_bf16_f32 v130, v144, v145
  v_mfma_f32_16x16x32_bf16 v[180:183], a[248:251], a[164:167], v[180:183]
  s_mov_b32 s15, 0x20000
  ds_read_b64_tr_b16 v[92:93], v15 offset:30912
  v_cvt_pk_bf16_f32 v131, v146, v147
  v_mfma_f32_16x16x32_bf16 v[180:183], a[252:255], a[180:183], v[180:183]
  s_waitcnt lgkmcnt(7)
  s_add_u32 s53, s40, 4096
  ds_read_b64_tr_b16 v[94:95], v15 offset:36032
  v_cvt_pk_bf16_f32 v164, v164, v165
  v_mfma_f32_16x16x32_bf16 v[192:195], v[64:67], a[128:131], v[192:195]
  ds_read_b64_tr_b16 a[224:225], v14 offset:256
  buffer_store_dwordx4 v[128:131], v3, s[28:31], s53 offen offset:0 sc1
  v_mfma_f32_16x16x32_bf16 v[192:195], v[68:71], a[144:147], v[192:195]
  ds_read_b64_tr_b16 a[226:227], v14 offset:5376
  v_cvt_pk_bf16_f32 v165, v166, v167
  v_mfma_f32_16x16x32_bf16 v[192:195], v[72:75], a[160:163], v[192:195]
  ds_read_b64_tr_b16 a[228:229], v14 offset:10496
  buffer_load_dwordx4 a[124:127], v3, s[28:31], s52 offen offset:3072 sc1
  v_mfma_f32_16x16x32_bf16 v[192:195], v[76:79], a[176:179], v[192:195]
  ds_read_b64_tr_b16 a[230:231], v14 offset:15616
  v_lshrrev_b32 v2, 4, v0
  v_mfma_f32_16x16x32_bf16 v[196:199], v[64:67], a[132:135], v[196:199]
  ds_read_b64_tr_b16 a[232:233], v14 offset:20736
  v_and_b32 v1, 15, v0
  v_mfma_f32_16x16x32_bf16 v[196:199], v[68:71], a[148:151], v[196:199]
  s_lshr_b32 s6, s43, 1
  ds_read_b64_tr_b16 a[234:235], v14 offset:25856
  v_mfma_f32_16x16x32_bf16 v[196:199], v[72:75], a[164:167], v[196:199]
  s_mul_i32 s6, s6, 14
  ds_read_b64_tr_b16 a[236:237], v14 offset:30976
  v_mfma_f32_16x16x32_bf16 v[196:199], v[76:79], a[180:183], v[196:199]
  s_waitcnt lgkmcnt(7)
  s_and_b32 s7, s43, 1
  ds_read_b64_tr_b16 a[238:239], v14 offset:36096
  s_add_u32 s58, s49, 3
  s_and_b32 s58, s58, 3
  s_lshl_b32 s52, s82, 2
  s_add_u32 s58, s58, s52
  s_lshl_b32 s58, s58, 14
  s_add_u32 s58, s58, 37748736
  s_add_u32 s52, s58, 8192
  v_mfma_f32_16x16x32_bf16 v[208:211], v[80:83], a[128:131], v[208:211]
  s_add_u32 s57, s6, 6
  ds_read_b64_tr_b16 a[240:241], v15 offset:256
  buffer_load_dwordx4 a[136:139], v3, s[28:31], s52 offen offset:0 sc1
  v_mfma_f32_16x16x32_bf16 v[208:211], v[84:87], a[144:147], v[208:211]
  s_add_u32 s57, s57, s7
  ds_read_b64_tr_b16 a[242:243], v15 offset:5376
  v_cvt_pk_bf16_f32 v192, v192, v193
  v_mfma_f32_16x16x32_bf16 v[208:211], v[88:91], a[160:163], v[208:211]
  s_mul_i32 s7, s7, 8
  ds_read_b64_tr_b16 a[244:245], v15 offset:10496
  v_cvt_pk_bf16_f32 v134, v148, v149
  v_mfma_f32_16x16x32_bf16 v[208:211], v[92:95], a[176:179], v[208:211]
  s_add_u32 s56, s6, s7
  ds_read_b64_tr_b16 a[246:247], v15 offset:15616
  v_cvt_pk_bf16_f32 v135, v150, v151
  v_mfma_f32_16x16x32_bf16 v[212:215], v[80:83], a[132:135], v[212:215]
  s_add_u32 s53, s40, 4096
  ds_read_b64_tr_b16 a[248:249], v15 offset:20736
  v_cvt_pk_bf16_f32 v193, v194, v195
  v_mfma_f32_16x16x32_bf16 v[212:215], v[84:87], a[148:151], v[212:215]
  s_cmp_eq_u32 s43, 7
  s_cselect_b32 s56, 48, s56
  ds_read_b64_tr_b16 a[250:251], v15 offset:25856
  buffer_store_dwordx4 v[132:135], v3, s[28:31], s53 offen offset:2048 sc1
  v_mfma_f32_16x16x32_bf16 v[212:215], v[88:91], a[164:167], v[212:215]
  ds_read_b64_tr_b16 a[252:253], v15 offset:30976
  buffer_load_dwordx4 a[140:143], v3, s[28:31], s52 offen offset:1024 sc1
  v_mfma_f32_16x16x32_bf16 v[212:215], v[92:95], a[180:183], v[212:215]
  s_waitcnt lgkmcnt(7)
  ds_read_b64_tr_b16 a[254:255], v15 offset:36096
  v_cvt_pk_bf16_f32 v196, v196, v197
  v_mfma_f32_16x16x32_bf16 v[224:227], a[224:227], a[128:131], v[224:227]
  ds_read_b64_tr_b16 v[64:65], v10 offset:0
  v_cvt_pk_bf16_f32 v197, v198, v199
  v_mfma_f32_16x16x32_bf16 v[224:227], a[228:231], a[144:147], v[224:227]
  ds_read_b64_tr_b16 v[66:67], v10 offset:5120
  v_add_u32 v4, 1024, v3
  v_mfma_f32_16x16x32_bf16 v[224:227], a[232:235], a[160:163], v[224:227]
  ds_read_b64_tr_b16 v[68:69], v10 offset:10240
  v_add_u32 v5, 5120, v3
  v_mfma_f32_16x16x32_bf16 v[224:227], a[236:239], a[176:179], v[224:227]
  s_sub_u32 s6, s37, s36
  ds_read_b64_tr_b16 v[70:71], v10 offset:15360
  v_mfma_f32_16x16x32_bf16 v[228:231], a[224:227], a[132:135], v[228:231]
  s_add_u32 s6, s6, 1
  ds_read_b64_tr_b16 v[72:73], v10 offset:20480
  buffer_load_dwordx4 a[152:155], v3, s[28:31], s52 offen offset:2048 sc1
  v_mfma_f32_16x16x32_bf16 v[228:231], a[228:231], a[148:151], v[228:231]
  s_mul_i32 s6, s6, 1024
  ds_read_b64_tr_b16 v[74:75], v10 offset:25600
  v_add_u32 v6, s6, v3
  v_mfma_f32_16x16x32_bf16 v[228:231], a[232:235], a[164:167], v[228:231]
  ds_read_b64_tr_b16 v[76:77], v10 offset:30720
  v_add_u32 v4, 1024, v3
  v_mfma_f32_16x16x32_bf16 v[228:231], a[236:239], a[180:183], v[228:231]
  s_waitcnt lgkmcnt(7)
  ds_read_b64_tr_b16 v[78:79], v10 offset:35840
  v_cvt_pk_bf16_f32 v162, v176, v177
  v_mfma_f32_16x16x32_bf16 v[240:243], a[240:243], a[128:131], v[240:243]
  ds_read_b64_tr_b16 v[80:81], v11 offset:0
  v_cvt_pk_bf16_f32 v163, v178, v179
  v_mfma_f32_16x16x32_bf16 v[240:243], a[244:247], a[144:147], v[240:243]
  s_add_u32 s53, s40, 8192
  ds_read_b64_tr_b16 v[82:83], v11 offset:5120
  v_cvt_pk_bf16_f32 v224, v224, v225
  v_mfma_f32_16x16x32_bf16 v[240:243], a[248:251], a[160:163], v[240:243]
  ds_read_b64_tr_b16 v[84:85], v11 offset:10240
  buffer_load_dwordx4 a[156:159], v3, s[28:31], s52 offen offset:3072 sc1
  v_mfma_f32_16x16x32_bf16 v[240:243], a[252:255], a[176:179], v[240:243]
  ds_read_b64_tr_b16 v[86:87], v11 offset:15360
  buffer_store_dwordx4 v[160:163], v3, s[28:31], s53 offen offset:0 sc1
  v_mfma_f32_16x16x32_bf16 v[244:247], a[240:243], a[132:135], v[244:247]
  ds_read_b64_tr_b16 v[88:89], v11 offset:20480
  v_cvt_pk_bf16_f32 v225, v226, v227
  v_mfma_f32_16x16x32_bf16 v[244:247], a[244:247], a[148:151], v[244:247]
  ds_read_b64_tr_b16 v[90:91], v11 offset:25600
  v_cvt_pk_bf16_f32 v228, v228, v229
  v_mfma_f32_16x16x32_bf16 v[244:247], a[248:251], a[164:167], v[244:247]
  ds_read_b64_tr_b16 v[92:93], v11 offset:30720
  v_cvt_pk_bf16_f32 v229, v230, v231
  v_mfma_f32_16x16x32_bf16 v[244:247], a[252:255], a[180:183], v[244:247]
  s_waitcnt lgkmcnt(7)
  ds_read_b64_tr_b16 v[94:95], v11 offset:35840
  v_add_u32 v5, 5120, v3
  s_add_u32 s52, s58, 12288
  s_waitcnt vmcnt(24)
  v_mfma_f32_16x16x32_bf16 v[104:107], v[64:67], a[8:11], v[104:107]
  s_sub_u32 s6, s57, s56
  ds_read_b64_tr_b16 a[224:225], v10 offset:64
  buffer_load_dwordx4 a[168:171], v3, s[28:31], s52 offen offset:0 sc1
  s_waitcnt vmcnt(23)
  v_mfma_f32_16x16x32_bf16 v[104:107], v[68:71], a[24:27], v[104:107]
  s_add_u32 s6, s6, 1
  ds_read_b64_tr_b16 a[226:227], v10 offset:5184
  s_waitcnt vmcnt(21)
  v_mfma_f32_16x16x32_bf16 v[104:107], v[72:75], a[40:43], v[104:107]
  s_mul_i32 s6, s6, 1024
  ds_read_b64_tr_b16 a[228:229], v10 offset:10304
  s_waitcnt vmcnt(19)
  v_mfma_f32_16x16x32_bf16 v[104:107], v[76:79], a[56:59], v[104:107]
  s_cmp_ge_u32 s43, 6
  s_cselect_b32 s6, 0x40000000, s6
  ds_read_b64_tr_b16 a[230:231], v10 offset:15424
  v_add_u32 v7, s6, v3
  v_mfma_f32_16x16x32_bf16 v[108:111], v[64:67], a[12:15], v[108:111]
  s_mul_i32 s60, s48, 110592
  ds_read_b64_tr_b16 a[232:233], v10 offset:20544
  v_mfma_f32_16x16x32_bf16 v[108:111], v[68:71], a[28:31], v[108:111]
  s_lshl_b32 s6, s56, 10
  ds_read_b64_tr_b16 a[234:235], v10 offset:25664
  v_cvt_pk_bf16_f32 v166, v180, v181
  v_mfma_f32_16x16x32_bf16 v[108:111], v[72:75], a[44:47], v[108:111]
  s_add_u32 s60, s60, s6
  ds_read_b64_tr_b16 a[236:237], v10 offset:30784
  buffer_load_dwordx4 a[172:175], v3, s[28:31], s52 offen offset:1024 sc1
  s_waitcnt vmcnt(19)
  v_mfma_f32_16x16x32_bf16 v[108:111], v[76:79], a[60:63], v[108:111]
  s_waitcnt lgkmcnt(7)
  s_add_u32 s60, s60, 60816384
  ds_read_b64_tr_b16 a[238:239], v10 offset:35904
  v_cvt_pk_bf16_f32 v167, v182, v183
  v_mfma_f32_16x16x32_bf16 v[120:123], v[80:83], a[8:11], v[120:123]
  s_add_u32 s53, s40, 8192
  ds_read_b64_tr_b16 a[240:241], v11 offset:64
  v_mfma_f32_16x16x32_bf16 v[120:123], v[84:87], a[24:27], v[120:123]
  s_add_u32 s61, s60, 55296
  ds_read_b64_tr_b16 a[242:243], v11 offset:5184
  buffer_store_dwordx4 v[164:167], v3, s[28:31], s53 offen offset:2048 sc1
  v_mfma_f32_16x16x32_bf16 v[120:123], v[88:91], a[40:43], v[120:123]
  s_mul_i32 s76, s48, 7168
  ds_read_b64_tr_b16 a[244:245], v11 offset:10304
  v_mfma_f32_16x16x32_bf16 v[120:123], v[92:95], a[56:59], v[120:123]
  s_lshl_b32 s62, s42, 2
  ds_read_b64_tr_b16 a[246:247], v11 offset:15424
  v_mfma_f32_16x16x32_bf16 v[124:127], v[80:83], a[12:15], v[124:127]
  s_add_u32 s62, s62, s48
  ds_read_b64_tr_b16 a[248:249], v11 offset:20544
  buffer_load_dwordx4 a[184:187], v3, s[28:31], s52 offen offset:2048 sc1
  v_mfma_f32_16x16x32_bf16 v[124:127], v[84:87], a[28:31], v[124:127]
  ds_read_b64_tr_b16 a[250:251], v11 offset:25664
  v_mov_b32 v39, 0x40000000
  v_mfma_f32_16x16x32_bf16 v[124:127], v[88:91], a[44:47], v[124:127]
  ds_read_b64_tr_b16 a[252:253], v11 offset:30784
  v_mov_b32 v40, 0x40000000
  v_mfma_f32_16x16x32_bf16 v[124:127], v[92:95], a[60:63], v[124:127]
  s_waitcnt lgkmcnt(7)
  ds_read_b64_tr_b16 a[254:255], v11 offset:35904
  v_writelane_b32 v40, 0, 0
  v_mfma_f32_16x16x32_bf16 v[136:139], a[224:227], a[8:11], v[136:139]
  s_mul_i32 s68, s62, 20480
  ds_read_b64_tr_b16 v[64:65], v10 offset:128
  v_mfma_f32_16x16x32_bf16 v[136:139], a[228:231], a[24:27], v[136:139]
  s_lshl_b32 s69, s37, 5
  ds_read_b64_tr_b16 v[66:67], v10 offset:5248
  v_mfma_f32_16x16x32_bf16 v[136:139], a[232:235], a[40:43], v[136:139]
  s_add_u32 s69, s69, s68
  ds_read_b64_tr_b16 v[68:69], v10 offset:10368
  buffer_load_dwordx4 a[188:191], v3, s[28:31], s52 offen offset:3072 sc1
  v_mfma_f32_16x16x32_bf16 v[136:139], a[236:239], a[56:59], v[136:139]
  s_lshl_b32 s70, s36, 5
  ds_read_b64_tr_b16 v[70:71], v10 offset:15488
  v_cvt_pk_bf16_f32 v194, v208, v209
  v_mfma_f32_16x16x32_bf16 v[140:143], a[224:227], a[12:15], v[140:143]
  s_add_u32 s68, s68, s70
  ds_read_b64_tr_b16 v[72:73], v10 offset:20608
  v_cvt_pk_bf16_f32 v195, v210, v211
  v_mfma_f32_16x16x32_bf16 v[140:143], a[228:231], a[28:31], v[140:143]
  s_add_u32 s53, s40, 12288
  ds_read_b64_tr_b16 v[74:75], v10 offset:25728
  v_lshlrev_b32 v37, 6, v1
  v_mfma_f32_16x16x32_bf16 v[140:143], a[232:235], a[44:47], v[140:143]
  ds_read_b64_tr_b16 v[76:77], v10 offset:30848
  buffer_store_dwordx4 v[192:195], v3, s[28:31], s53 offen offset:0 sc1
  v_mfma_f32_16x16x32_bf16 v[140:143], a[236:239], a[60:63], v[140:143]
  s_waitcnt lgkmcnt(7)
  ds_read_b64_tr_b16 v[78:79], v10 offset:35968
  v_cmp_eq_u32 s[4:5], 0, v2
  v_mfma_f32_16x16x32_bf16 v[152:155], a[240:243], a[8:11], v[152:155]
  ds_read_b64_tr_b16 v[80:81], v11 offset:128
  v_cndmask_b32 v36, v39, v37, s[4:5]
  v_mfma_f32_16x16x32_bf16 v[152:155], a[244:247], a[24:27], v[152:155]
  ds_read_b64_tr_b16 v[82:83], v11 offset:5248
  v_lshl_add_u32 v37, v2, 4, v37
  v_mfma_f32_16x16x32_bf16 v[152:155], a[248:251], a[40:43], v[152:155]
  s_lshl_b32 s63, s62, 10
  ds_read_b64_tr_b16 v[84:85], v11 offset:10368
  v_mfma_f32_16x16x32_bf16 v[152:155], a[252:255], a[56:59], v[152:155]
  s_lshl_b32 s7, s43, 3
  ds_read_b64_tr_b16 v[86:87], v11 offset:15488
  v_mfma_f32_16x16x32_bf16 v[156:159], a[240:243], a[12:15], v[156:159]
  s_add_u32 s64, s63, s7
  ds_read_b64_tr_b16 v[88:89], v11 offset:20608
  v_mfma_f32_16x16x32_bf16 v[156:159], a[244:247], a[28:31], v[156:159]
  s_lshl_b32 s77, s42, 18
  ds_read_b64_tr_b16 v[90:91], v11 offset:25728
  v_mfma_f32_16x16x32_bf16 v[156:159], a[248:251], a[44:47], v[156:159]
  s_add_u32 s77, s77, 67108864
  ds_read_b64_tr_b16 v[92:93], v11 offset:30848
  v_lshlrev_b32 v38, 4, v2
  v_mfma_f32_16x16x32_bf16 v[156:159], a[252:255], a[60:63], v[156:159]
  s_waitcnt lgkmcnt(7)
  ds_read_b64_tr_b16 v[94:95], v11 offset:35968
  v_add_u32 v38, 159744, v38
  v_mfma_f32_16x16x32_bf16 v[168:171], v[64:67], a[8:11], v[168:171]
  s_lshr_b32 s6, s42, 2
  ds_read_b64_tr_b16 a[224:225], v10 offset:192
  v_cvt_pk_bf16_f32 v198, v212, v213
  v_mfma_f32_16x16x32_bf16 v[168:171], v[68:71], a[24:27], v[168:171]
  s_add_u32 s6, s6, 1
  ds_read_b64_tr_b16 a[226:227], v10 offset:5312
  v_cvt_pk_bf16_f32 v199, v214, v215
  v_mfma_f32_16x16x32_bf16 v[168:171], v[72:75], a[40:43], v[168:171]
  s_add_u32 s53, s40, 12288
  ds_read_b64_tr_b16 a[228:229], v10 offset:10432
  v_mfma_f32_16x16x32_bf16 v[168:171], v[76:79], a[56:59], v[168:171]
  s_and_b32 s6, s6, 3
  ds_read_b64_tr_b16 a[230:231], v10 offset:15552
  buffer_store_dwordx4 v[196:199], v3, s[28:31], s53 offen offset:2048 sc1
  v_mfma_f32_16x16x32_bf16 v[172:175], v[64:67], a[12:15], v[172:175]
  s_lshl_b32 s6, s6, 2
  ds_read_b64_tr_b16 a[232:233], v10 offset:20672
  v_mfma_f32_16x16x32_bf16 v[172:175], v[68:71], a[28:31], v[172:175]
  s_add_u32 s16, s6, s48
  ds_read_b64_tr_b16 a[234:235], v10 offset:25792
  v_mfma_f32_16x16x32_bf16 v[172:175], v[72:75], a[44:47], v[172:175]
  s_lshl_b32 s6, s16, 13
  ds_read_b64_tr_b16 a[236:237], v10 offset:30912
  v_mfma_f32_16x16x32_bf16 v[172:175], v[76:79], a[60:63], v[172:175]
  s_waitcnt lgkmcnt(7)
  s_add_u32 s20, s6, s77
  ds_read_b64_tr_b16 a[238:239], v10 offset:36032
  v_mfma_f32_16x16x32_bf16 v[184:187], v[80:83], a[8:11], v[184:187]
  s_lshr_b32 s6, s42, 2
  ds_read_b64_tr_b16 a[240:241], v11 offset:192
  v_mfma_f32_16x16x32_bf16 v[184:187], v[84:87], a[24:27], v[184:187]
  s_add_u32 s6, s6, 2
  ds_read_b64_tr_b16 a[242:243], v11 offset:5312
  v_mfma_f32_16x16x32_bf16 v[184:187], v[88:91], a[40:43], v[184:187]
  s_and_b32 s6, s6, 3
  ds_read_b64_tr_b16 a[244:245], v11 offset:10432
  v_mfma_f32_16x16x32_bf16 v[184:187], v[92:95], a[56:59], v[184:187]
  s_lshl_b32 s6, s6, 2
  ds_read_b64_tr_b16 a[246:247], v11 offset:15552
  v_mfma_f32_16x16x32_bf16 v[188:191], v[80:83], a[12:15], v[188:191]
  s_add_u32 s17, s6, s48
  ds_read_b64_tr_b16 a[248:249], v11 offset:20672
  v_mfma_f32_16x16x32_bf16 v[188:191], v[84:87], a[28:31], v[188:191]
  s_lshl_b32 s6, s17, 13
  ds_read_b64_tr_b16 a[250:251], v11 offset:25792
  v_cvt_pk_bf16_f32 v226, v240, v241
  v_mfma_f32_16x16x32_bf16 v[188:191], v[88:91], a[44:47], v[188:191]
  s_add_u32 s21, s6, s77
  ds_read_b64_tr_b16 a[252:253], v11 offset:30912
  v_cvt_pk_bf16_f32 v227, v242, v243
  v_mfma_f32_16x16x32_bf16 v[188:191], v[92:95], a[60:63], v[188:191]
  s_waitcnt lgkmcnt(7)
  s_add_u32 s53, s40, 16384
  ds_read_b64_tr_b16 a[254:255], v11 offset:36032
  v_mfma_f32_16x16x32_bf16 v[200:203], a[224:227], a[8:11], v[200:203]
  s_lshr_b32 s6, s42, 2
  ds_read_b64_tr_b16 v[64:65], v10 offset:256
  buffer_store_dwordx4 v[224:227], v3, s[28:31], s53 offen offset:0 sc1
  v_mfma_f32_16x16x32_bf16 v[200:203], a[228:231], a[24:27], v[200:203]
  s_add_u32 s6, s6, 3
  ds_read_b64_tr_b16 v[66:67], v10 offset:5376
  v_mfma_f32_16x16x32_bf16 v[200:203], a[232:235], a[40:43], v[200:203]
  s_and_b32 s6, s6, 3
  ds_read_b64_tr_b16 v[68:69], v10 offset:10496
  v_mfma_f32_16x16x32_bf16 v[200:203], a[236:239], a[56:59], v[200:203]
  s_lshl_b32 s6, s6, 2
  ds_read_b64_tr_b16 v[70:71], v10 offset:15616
  v_mfma_f32_16x16x32_bf16 v[204:207], a[224:227], a[12:15], v[204:207]
  s_add_u32 s18, s6, s48
  ds_read_b64_tr_b16 v[72:73], v10 offset:20736
  v_mfma_f32_16x16x32_bf16 v[204:207], a[228:231], a[28:31], v[204:207]
  s_lshl_b32 s6, s18, 13
  ds_read_b64_tr_b16 v[74:75], v10 offset:25856
  v_mfma_f32_16x16x32_bf16 v[204:207], a[232:235], a[44:47], v[204:207]
  s_add_u32 s22, s6, s77
  ds_read_b64_tr_b16 v[76:77], v10 offset:30976
  v_mfma_f32_16x16x32_bf16 v[204:207], a[236:239], a[60:63], v[204:207]
  s_waitcnt lgkmcnt(7)
  s_lshr_b32 s6, s42, 2
  ds_read_b64_tr_b16 v[78:79], v10 offset:36096
  v_mfma_f32_16x16x32_bf16 v[216:219], a[240:243], a[8:11], v[216:219]
  s_add_u32 s6, s6, 4
  ds_read_b64_tr_b16 v[80:81], v11 offset:256
  v_mfma_f32_16x16x32_bf16 v[216:219], a[244:247], a[24:27], v[216:219]
  s_and_b32 s6, s6, 3
  ds_read_b64_tr_b16 v[82:83], v11 offset:5376
  v_mfma_f32_16x16x32_bf16 v[216:219], a[248:251], a[40:43], v[216:219]
  s_lshl_b32 s6, s6, 2
  ds_read_b64_tr_b16 v[84:85], v11 offset:10496
  v_cvt_pk_bf16_f32 v230, v244, v245
  v_mfma_f32_16x16x32_bf16 v[216:219], a[252:255], a[56:59], v[216:219]
  s_add_u32 s19, s6, s48
  ds_read_b64_tr_b16 v[86:87], v11 offset:15616
  v_cvt_pk_bf16_f32 v231, v246, v247
  v_mfma_f32_16x16x32_bf16 v[220:223], a[240:243], a[12:15], v[220:223]
  s_add_u32 s53, s40, 16384
  ds_read_b64_tr_b16 v[88:89], v11 offset:20736
  v_mfma_f32_16x16x32_bf16 v[220:223], a[244:247], a[28:31], v[220:223]
  s_lshl_b32 s6, s19, 13
  ds_read_b64_tr_b16 v[90:91], v11 offset:25856
  buffer_store_dwordx4 v[228:231], v3, s[28:31], s53 offen offset:2048 sc1
  v_mfma_f32_16x16x32_bf16 v[220:223], a[248:251], a[44:47], v[220:223]
  s_add_u32 s23, s6, s77
  ds_read_b64_tr_b16 v[92:93], v11 offset:30976
  v_mul_u32_u24 v44, 52, v0
  v_mfma_f32_16x16x32_bf16 v[220:223], a[252:255], a[60:63], v[220:223]
  s_waitcnt lgkmcnt(7)
  ds_read_b64_tr_b16 v[94:95], v11 offset:36096
  v_lshrrev_b32 v44, 10, v44
  v_mfma_f32_16x16x32_bf16 v[232:235], v[64:67], a[8:11], v[232:235]
  ds_read_b64_tr_b16 a[224:225], v12 offset:0
  v_mul_u32_u24 v45, 20, v44
  v_mfma_f32_16x16x32_bf16 v[232:235], v[68:71], a[24:27], v[232:235]
  ds_read_b64_tr_b16 a[226:227], v12 offset:5120
  v_sub_u32 v45, v0, v45
  v_mfma_f32_16x16x32_bf16 v[232:235], v[72:75], a[40:43], v[232:235]
  ds_read_b64_tr_b16 a[228:229], v12 offset:10240
  v_lshlrev_b32 v46, 4, v45
  v_mfma_f32_16x16x32_bf16 v[232:235], v[76:79], a[56:59], v[232:235]
  s_lshl_b32 s6, s36, 6
  ds_read_b64_tr_b16 a[230:231], v12 offset:15360
  v_mfma_f32_16x16x32_bf16 v[236:239], v[64:67], a[12:15], v[236:239]
  s_sub_u32 s7, s37, 4
  ds_read_b64_tr_b16 a[232:233], v12 offset:20480
  v_mfma_f32_16x16x32_bf16 v[236:239], v[68:71], a[28:31], v[236:239]
  s_lshl_b32 s7, s7, 6
  ds_read_b64_tr_b16 a[234:235], v12 offset:25600
  v_mov_b32 v47, s6
  v_mfma_f32_16x16x32_bf16 v[236:239], v[72:75], a[44:47], v[236:239]
  ds_read_b64_tr_b16 a[236:237], v12 offset:30720
  v_mov_b32 v42, s7
  v_mfma_f32_16x16x32_bf16 v[236:239], v[76:79], a[60:63], v[236:239]
  s_waitcnt lgkmcnt(7)
  ds_read_b64_tr_b16 a[238:239], v12 offset:35840
  v_cmp_gt_u32 s[4:5], 16, v45
  v_mfma_f32_16x16x32_bf16 v[248:251], v[80:83], a[8:11], v[248:251]
  ds_read_b64_tr_b16 a[240:241], v14 offset:0
  v_cndmask_b32 v47, v42, v47, s[4:5]
  v_mfma_f32_16x16x32_bf16 v[248:251], v[84:87], a[24:27], v[248:251]
  ds_read_b64_tr_b16 a[242:243], v14 offset:5120
  v_add_u32 v46, v46, v47
  v_mfma_f32_16x16x32_bf16 v[248:251], v[88:91], a[40:43], v[248:251]
  ds_read_b64_tr_b16 a[244:245], v14 offset:10240
  v_mov_b32 v42, v39
  v_mfma_f32_16x16x32_bf16 v[248:251], v[92:95], a[56:59], v[248:251]
  ds_read_b64_tr_b16 a[246:247], v14 offset:15360
  v_add_u32 v47, 5120, v46
  v_mfma_f32_16x16x32_bf16 v[252:255], v[80:83], a[12:15], v[252:255]
  ds_read_b64_tr_b16 a[248:249], v14 offset:20480
  v_cmp_eq_u32 s[4:5], 0, v44
  v_mfma_f32_16x16x32_bf16 v[252:255], v[84:87], a[28:31], v[252:255]
  ds_read_b64_tr_b16 a[250:251], v14 offset:25600
  v_cndmask_b32 v42, v42, v47, s[4:5]
  v_mfma_f32_16x16x32_bf16 v[252:255], v[88:91], a[44:47], v[252:255]
  ds_read_b64_tr_b16 a[252:253], v14 offset:30720
  v_add_u32 v47, 10240, v46
  v_mfma_f32_16x16x32_bf16 v[252:255], v[92:95], a[60:63], v[252:255]
  s_waitcnt lgkmcnt(7)
  ds_read_b64_tr_b16 a[254:255], v14 offset:35840
  v_cmp_eq_u32 s[4:5], 1, v44
  s_waitcnt vmcnt(25)
  v_mfma_f32_16x16x32_bf16 v[104:107], a[224:227], a[72:75], v[104:107]
  ds_read_b64_tr_b16 v[64:65], v13 offset:0
  v_cndmask_b32 v42, v42, v47, s[4:5]
  s_waitcnt vmcnt(23)
  v_mfma_f32_16x16x32_bf16 v[104:107], a[228:231], a[88:91], v[104:107]
  ds_read_b64_tr_b16 v[66:67], v13 offset:5120
  v_add_u32 v47, 12800, v46
  s_waitcnt vmcnt(20)
  v_mfma_f32_16x16x32_bf16 v[104:107], a[232:235], a[104:107], v[104:107]
  ds_read_b64_tr_b16 v[68:69], v13 offset:10240
  v_cmp_eq_u32 s[4:5], 2, v44
  s_waitcnt vmcnt(17)
  v_mfma_f32_16x16x32_bf16 v[104:107], a[236:239], a[120:123], v[104:107]
  ds_read_b64_tr_b16 v[70:71], v13 offset:15360
  v_cndmask_b32 v42, v42, v47, s[4:5]
  v_mfma_f32_16x16x32_bf16 v[108:111], a[224:227], a[76:79], v[108:111]
HS30:
  s_cbranch_execz HOPR_e
  ds_read_b64_tr_b16 v[72:73], v13 offset:20480
  v_mul_u32_u24 v44, 37, v0
  v_mfma_f32_16x16x32_bf16 v[108:111], a[228:231], a[92:95], v[108:111]
  ds_read_b64_tr_b16 v[74:75], v13 offset:25600
  v_lshrrev_b32 v44, 10, v44
  v_mfma_f32_16x16x32_bf16 v[108:111], a[232:235], a[108:111], v[108:111]
  ds_read_b64_tr_b16 v[76:77], v13 offset:30720
  v_mul_u32_u24 v45, 28, v44
  s_waitcnt vmcnt(15)
  v_mfma_f32_16x16x32_bf16 v[108:111], a[236:239], a[124:127], v[108:111]
  s_waitcnt lgkmcnt(7)
  ds_read_b64_tr_b16 v[78:79], v13 offset:35840
  v_sub_u32 v45, v0, v45
  s_waitcnt vmcnt(14)
  v_mfma_f32_16x16x32_bf16 v[104:107], a[240:243], a[136:139], v[104:107]
  ds_read_b64_tr_b16 v[80:81], v15 offset:0
  v_lshlrev_b32 v46, 4, v45
  s_waitcnt vmcnt(11)
  v_mfma_f32_16x16x32_bf16 v[104:107], a[244:247], a[152:155], v[104:107]
  s_lshl_b32 s6, s56, 6
  ds_read_b64_tr_b16 v[82:83], v15 offset:5120
  s_waitcnt vmcnt(8)
  v_mfma_f32_16x16x32_bf16 v[104:107], a[248:251], a[168:171], v[104:107]
  s_sub_u32 s7, s57, 6
  ds_read_b64_tr_b16 v[84:85], v15 offset:10240
  s_waitcnt vmcnt(5)
  v_mfma_f32_16x16x32_bf16 v[104:107], a[252:255], a[184:187], v[104:107]
  s_lshl_b32 s7, s7, 6
  ds_read_b64_tr_b16 v[86:87], v15 offset:15360
  v_mfma_f32_16x16x32_bf16 v[108:111], a[240:243], a[140:143], v[108:111]
  s_cmp_ge_u32 s43, 6
  s_cselect_b32 s7, 0x40000000, s7
  ds_read_b64_tr_b16 v[88:89], v15 offset:20480
  v_mov_b32 v47, s6
  v_mfma_f32_16x16x32_bf16 v[108:111], a[244:247], a[156:159], v[108:111]
  ds_read_b64_tr_b16 v[90:91], v15 offset:25600
  v_mov_b32 v41, s7
  v_mfma_f32_16x16x32_bf16 v[108:111], a[248:251], a[172:175], v[108:111]
  ds_read_b64_tr_b16 v[92:93], v15 offset:30720
  v_cmp_gt_u32 s[4:5], 24, v45
  s_waitcnt vmcnt(4)
  v_mfma_f32_16x16x32_bf16 v[108:111], a[252:255], a[188:191], v[108:111]
  s_waitcnt lgkmcnt(7)
  ds_read_b64_tr_b16 v[94:95], v15 offset:35840
  v_cndmask_b32 v47, v41, v47, s[4:5]
  v_mfma_f32_16x16x32_bf16 v[120:123], v[64:67], a[72:75], v[120:123]
  ds_read_b64_tr_b16 a[224:225], v12 offset:64
  v_add_u32 v46, v46, v47
  v_mfma_f32_16x16x32_bf16 v[120:123], v[68:71], a[88:91], v[120:123]
  ds_read_b64_tr_b16 a[226:227], v12 offset:5184
  v_cvt_pk_bf16_f32 v104, v104, v105
  v_mfma_f32_16x16x32_bf16 v[120:123], v[72:75], a[104:107], v[120:123]
  ds_read_b64_tr_b16 a[228:229], v12 offset:10304
  v_cvt_pk_bf16_f32 v105, v106, v107
  v_mfma_f32_16x16x32_bf16 v[120:123], v[76:79], a[120:123], v[120:123]
  ds_read_b64_tr_b16 a[230:231], v12 offset:15424
  v_mov_b32 v41, v39
  v_mfma_f32_16x16x32_bf16 v[124:127], v[64:67], a[76:79], v[124:127]
  ds_read_b64_tr_b16 a[232:233], v12 offset:20544
  v_add_u32 v47, 32768, v46
  v_mfma_f32_16x16x32_bf16 v[124:127], v[68:71], a[92:95], v[124:127]
  ds_read_b64_tr_b16 a[234:235], v12 offset:25664
  v_cvt_pk_bf16_f32 v108, v108, v109
  v_mfma_f32_16x16x32_bf16 v[124:127], v[72:75], a[108:111], v[124:127]
  ds_read_b64_tr_b16 a[236:237], v12 offset:30784
  v_cvt_pk_bf16_f32 v109, v110, v111
  v_mfma_f32_16x16x32_bf16 v[124:127], v[76:79], a[124:127], v[124:127]
  s_waitcnt lgkmcnt(7)
  ds_read_b64_tr_b16 a[238:239], v12 offset:35904
  v_cmp_eq_u32 s[4:5], 0, v44
  v_mfma_f32_16x16x32_bf16 v[120:123], v[80:83], a[136:139], v[120:123]
  ds_read_b64_tr_b16 a[240:241], v14 offset:64
  v_cndmask_b32 v41, v41, v47, s[4:5]
  v_mfma_f32_16x16x32_bf16 v[120:123], v[84:87], a[152:155], v[120:123]
  ds_read_b64_tr_b16 a[242:243], v14 offset:5184
  v_add_u32 v47, 40960, v46
  s_waitcnt vmcnt(0)
  v_mfma_f32_16x16x32_bf16 v[120:123], v[88:91], a[168:171], v[120:123]
  ds_read_b64_tr_b16 a[244:245], v14 offset:10304
  buffer_atomic_add v31, v16, s[28:31], s75 offen offset:128
  v_mfma_f32_16x16x32_bf16 v[120:123], v[92:95], a[184:187], v[120:123]
  ds_read_b64_tr_b16 a[246:247], v14 offset:15424
  v_cmp_eq_u32 s[4:5], 1, v44
  v_mfma_f32_16x16x32_bf16 v[124:127], v[80:83], a[140:143], v[124:127]
  ds_read_b64_tr_b16 a[248:249], v14 offset:20544
  v_cndmask_b32 v41, v41, v47, s[4:5]
  v_mfma_f32_16x16x32_bf16 v[124:127], v[84:87], a[156:159], v[124:127]
  ds_read_b64_tr_b16 a[250:251], v14 offset:25664
  v_add_u32 v44, 0, v0
  v_mfma_f32_16x16x32_bf16 v[124:127], v[88:91], a[172:175], v[124:127]
  ds_read_b64_tr_b16 a[252:253], v14 offset:30784
  v_mul_u32_u24 v45, 205, v44
  v_mfma_f32_16x16x32_bf16 v[124:127], v[92:95], a[188:191], v[124:127]
  s_waitcnt lgkmcnt(7)
  ds_read_b64_tr_b16 a[254:255], v14 offset:35904
  v_lshrrev_b32 v45, 11, v45
  v_mfma_f32_16x16x32_bf16 v[136:139], a[224:227], a[72:75], v[136:139]
  ds_read_b64_tr_b16 v[64:65], v13 offset:64
  v_mul_u32_u24 v45, 1280 - 160, v45
  v_mfma_f32_16x16x32_bf16 v[136:139], a[228:231], a[88:91], v[136:139]
  ds_read_b64_tr_b16 v[66:67], v13 offset:5184
  v_lshl_add_u32 v60, v44, 4, v45
  v_mfma_f32_16x16x32_bf16 v[136:139], a[232:235], a[104:107], v[136:139]
  ds_read_b64_tr_b16 v[68:69], v13 offset:10304
  v_cvt_pk_bf16_f32 v106, v120, v121
  v_mfma_f32_16x16x32_bf16 v[136:139], a[236:239], a[120:123], v[136:139]
  ds_read_b64_tr_b16 v[70:71], v13 offset:15424
  v_cvt_pk_bf16_f32 v107, v122, v123
  v_mfma_f32_16x16x32_bf16 v[140:143], a[224:227], a[76:79], v[140:143]
  s_add_u32 s53, s41, 0
  ds_read_b64_tr_b16 v[72:73], v13 offset:20544
  v_add_u32 v44, 64, v0
  v_mfma_f32_16x16x32_bf16 v[140:143], a[228:231], a[92:95], v[140:143]
  ds_read_b64_tr_b16 v[74:75], v13 offset:25664
  buffer_store_dwordx4 v[104:107], v3, s[28:31], s53 offen offset:0 sc1
  v_mfma_f32_16x16x32_bf16 v[140:143], a[232:235], a[108:111], v[140:143]
  ds_read_b64_tr_b16 v[76:77], v13 offset:30784
  v_mul_u32_u24 v45, 205, v44
  v_mfma_f32_16x16x32_bf16 v[140:143], a[236:239], a[124:127], v[140:143]
  s_waitcnt lgkmcnt(7)
  ds_read_b64_tr_b16 v[78:79], v13 offset:35904
  v_lshrrev_b32 v45, 11, v45
  v_mfma_f32_16x16x32_bf16 v[136:139], a[240:243], a[136:139], v[136:139]
  ds_read_b64_tr_b16 v[80:81], v15 offset:64
  v_mul_u32_u24 v45, 1280 - 160, v45
  v_mfma_f32_16x16x32_bf16 v[136:139], a[244:247], a[152:155], v[136:139]
  ds_read_b64_tr_b16 v[82:83], v15 offset:5184
  v_lshl_add_u32 v61, v44, 4, v45
  v_mfma_f32_16x16x32_bf16 v[136:139], a[248:251], a[168:171], v[136:139]
  ds_read_b64_tr_b16 v[84:85], v15 offset:10304
  v_add_u32 v44, 128, v0
  v_mfma_f32_16x16x32_bf16 v[136:139], a[252:255], a[184:187], v[136:139]
  ds_read_b64_tr_b16 v[86:87], v15 offset:15424
  v_mul_u32_u24 v45, 205, v44
  v_mfma_f32_16x16x32_bf16 v[140:143], a[240:243], a[140:143], v[140:143]
  ds_read_b64_tr_b16 v[88:89], v15 offset:20544
  v_lshrrev_b32 v45, 11, v45
  v_mfma_f32_16x16x32_bf16 v[140:143], a[244:247], a[156:159], v[140:143]
  ds_read_b64_tr_b16 v[90:91], v15 offset:25664
  v_mul_u32_u24 v45, 1280 - 160, v45
  v_mfma_f32_16x16x32_bf16 v[140:143], a[248:251], a[172:175], v[140:143]
  ds_read_b64_tr_b16 v[92:93], v15 offset:30784
  v_lshl_add_u32 v62, v44, 4, v45
  v_mfma_f32_16x16x32_bf16 v[140:143], a[252:255], a[188:191], v[140:143]
  s_waitcnt lgkmcnt(7)
  ds_read_b64_tr_b16 v[94:95], v15 offset:35904
  v_cvt_pk_bf16_f32 v110, v124, v125
  v_mfma_f32_16x16x32_bf16 v[152:155], v[64:67], a[72:75], v[152:155]
  ds_read_b64_tr_b16 a[224:225], v12 offset:128
  v_cvt_pk_bf16_f32 v111, v126, v127
  v_mfma_f32_16x16x32_bf16 v[152:155], v[68:71], a[88:91], v[152:155]
  s_add_u32 s53, s41, 0
  ds_read_b64_tr_b16 a[226:227], v12 offset:5248
  v_cvt_pk_bf16_f32 v136, v136, v137
  v_mfma_f32_16x16x32_bf16 v[152:155], v[72:75], a[104:107], v[152:155]
  ds_read_b64_tr_b16 a[228:229], v12 offset:10368
  buffer_store_dwordx4 v[108:111], v3, s[28:31], s53 offen offset:2048 sc1
  v_mfma_f32_16x16x32_bf16 v[152:155], v[76:79], a[120:123], v[152:155]
  ds_read_b64_tr_b16 a[230:231], v12 offset:15488
  v_cvt_pk_bf16_f32 v137, v138, v139
  v_mfma_f32_16x16x32_bf16 v[156:159], v[64:67], a[76:79], v[156:159]
  ds_read_b64_tr_b16 a[232:233], v12 offset:20608
  v_cmp_gt_u32 s[4:5], 32, v0
  v_mfma_f32_16x16x32_bf16 v[156:159], v[68:71], a[92:95], v[156:159]
  ds_read_b64_tr_b16 a[234:235], v12 offset:25728
  v_cvt_pk_bf16_f32 v140, v140, v141
  v_mfma_f32_16x16x32_bf16 v[156:159], v[72:75], a[108:111], v[156:159]
  ds_read_b64_tr_b16 a[236:237], v12 offset:30848
  v_cvt_pk_bf16_f32 v141, v142, v143
  v_mfma_f32_16x16x32_bf16 v[156:159], v[76:79], a[124:127], v[156:159]
  s_waitcnt lgkmcnt(7)
  ds_read_b64_tr_b16 a[238:239], v12 offset:35968
  v_cndmask_b32 v62, v39, v62, s[4:5]
  v_mfma_f32_16x16x32_bf16 v[152:155], v[80:83], a[136:139], v[152:155]
  s_mul_i32 s72, s62, 20480
  ds_read_b64_tr_b16 a[240:241], v14 offset:128
  v_mfma_f32_16x16x32_bf16 v[152:155], v[84:87], a[152:155], v[152:155]
  s_mul_i32 s6, s43, 160
  ds_read_b64_tr_b16 a[242:243], v14 offset:5248
  v_mfma_f32_16x16x32_bf16 v[152:155], v[88:91], a[168:171], v[152:155]
  s_add_u32 s72, s72, s6
  ds_read_b64_tr_b16 a[244:245], v14 offset:10368
  v_mfma_f32_16x16x32_bf16 v[152:155], v[92:95], a[184:187], v[152:155]
  s_mul_i32 s73, s48, 3072
  ds_read_b64_tr_b16 a[246:247], v14 offset:15488
  v_mfma_f32_16x16x32_bf16 v[156:159], v[80:83], a[140:143], v[156:159]
  s_add_u32 s73, s73, 143360
  ds_read_b64_tr_b16 a[248:249], v14 offset:20608
  v_mul_u32_u24 v44, 160, v1
  v_mfma_f32_16x16x32_bf16 v[156:159], v[84:87], a[156:159], v[156:159]
  ds_read_b64_tr_b16 a[250:251], v14 offset:25728
  v_lshl_add_u32 v44, v2, 3, v44
  v_mfma_f32_16x16x32_bf16 v[156:159], v[88:91], a[172:175], v[156:159]
  s_and_b32 s6, s43, 1
  ds_read_b64_tr_b16 a[252:253], v14 offset:30848
  v_mfma_f32_16x16x32_bf16 v[156:159], v[92:95], a[188:191], v[156:159]
  s_waitcnt lgkmcnt(7)
  s_lshl_b32 s7, s6, 5
  ds_read_b64_tr_b16 a[254:255], v14 offset:35968
  v_mfma_f32_16x16x32_bf16 v[168:171], a[224:227], a[72:75], v[168:171]
  s_add_u32 s7, s7, s73
  ds_read_b64_tr_b16 v[64:65], v13 offset:128
  v_add_u32 v63, s7, v44
  v_mfma_f32_16x16x32_bf16 v[168:171], a[228:231], a[88:91], v[168:171]
  s_lshl_b32 s6, s6, 7
  ds_read_b64_tr_b16 v[66:67], v13 offset:5248
  v_mfma_f32_16x16x32_bf16 v[168:171], a[232:235], a[104:107], v[168:171]
  s_sub_u32 s6, s73, s6
  ds_read_b64_tr_b16 v[68:69], v13 offset:10368
  v_cvt_pk_bf16_f32 v138, v152, v153
  v_mfma_f32_16x16x32_bf16 v[168:171], a[236:239], a[120:123], v[168:171]
  ds_read_b64_tr_b16 v[70:71], v13 offset:15488
  v_cvt_pk_bf16_f32 v139, v154, v155
  v_mfma_f32_16x16x32_bf16 v[172:175], a[224:227], a[76:79], v[172:175]
  s_add_u32 s53, s41, 4096
  ds_read_b64_tr_b16 v[72:73], v13 offset:20608
  v_add_u32 v59, s6, v44
  v_mfma_f32_16x16x32_bf16 v[172:175], a[228:231], a[92:95], v[172:175]
  ds_read_b64_tr_b16 v[74:75], v13 offset:25728
  buffer_store_dwordx4 v[136:139], v3, s[28:31], s53 offen offset:0 sc1
  v_mfma_f32_16x16x32_bf16 v[172:175], a[232:235], a[108:111], v[172:175]
  ds_read_b64_tr_b16 v[76:77], v13 offset:30848
  v_lshlrev_b32 v56, 2, v2
  v_mfma_f32_16x16x32_bf16 v[172:175], a[236:239], a[124:127], v[172:175]
  s_waitcnt lgkmcnt(7)
  ds_read_b64_tr_b16 v[78:79], v13 offset:35968
  v_sub_u32 v56, v1, v56
  v_mfma_f32_16x16x32_bf16 v[168:171], a[240:243], a[136:139], v[168:171]
  ds_read_b64_tr_b16 v[80:81], v15 offset:128
  v_mov_b32 v57, 0x3f80
  v_mfma_f32_16x16x32_bf16 v[168:171], a[244:247], a[152:155], v[168:171]
  ds_read_b64_tr_b16 v[82:83], v15 offset:5248
  v_mov_b32 v58, 0x3f800000
  v_mfma_f32_16x16x32_bf16 v[168:171], a[248:251], a[168:171], v[168:171]
  ds_read_b64_tr_b16 v[84:85], v15 offset:10368
  v_cmp_eq_u32 s[4:5], 0, v56
  v_mfma_f32_16x16x32_bf16 v[168:171], a[252:255], a[184:187], v[168:171]
  ds_read_b64_tr_b16 v[86:87], v15 offset:15488
  v_cndmask_b32 v44, 0, v57, s[4:5]
  v_mfma_f32_16x16x32_bf16 v[172:175], a[240:243], a[140:143], v[172:175]
  ds_read_b64_tr_b16 v[88:89], v15 offset:20608
  v_cmp_eq_u32 s[4:5], 1, v56
  v_mfma_f32_16x16x32_bf16 v[172:175], a[244:247], a[156:159], v[172:175]
  ds_read_b64_tr_b16 v[90:91], v15 offset:25728
  v_cndmask_b32 v44, v44, v58, s[4:5]
  v_mfma_f32_16x16x32_bf16 v[172:175], a[248:251], a[172:175], v[172:175]
  ds_read_b64_tr_b16 v[92:93], v15 offset:30848
  v_cmp_eq_u32 s[4:5], 2, v56
  v_mfma_f32_16x16x32_bf16 v[172:175], a[252:255], a[188:191], v[172:175]
  s_waitcnt lgkmcnt(7)
  ds_read_b64_tr_b16 v[94:95], v15 offset:35968
  v_cvt_pk_bf16_f32 v142, v156, v157
  v_mfma_f32_16x16x32_bf16 v[184:187], v[64:67], a[72:75], v[184:187]
  ds_read_b64_tr_b16 a[224:225], v12 offset:192
  v_cvt_pk_bf16_f32 v143, v158, v159
  v_mfma_f32_16x16x32_bf16 v[184:187], v[68:71], a[88:91], v[184:187]
  s_add_u32 s53, s41, 4096
  ds_read_b64_tr_b16 a[226:227], v12 offset:5312
  v_cvt_pk_bf16_f32 v168, v168, v169
  v_mfma_f32_16x16x32_bf16 v[184:187], v[72:75], a[104:107], v[184:187]
  ds_read_b64_tr_b16 a[228:229], v12 offset:10432
  buffer_store_dwordx4 v[140:143], v3, s[28:31], s53 offen offset:2048 sc1
  v_mfma_f32_16x16x32_bf16 v[184:187], v[76:79], a[120:123], v[184:187]
  ds_read_b64_tr_b16 a[230:231], v12 offset:15552
  v_cvt_pk_bf16_f32 v169, v170, v171
  v_mfma_f32_16x16x32_bf16 v[188:191], v[64:67], a[76:79], v[188:191]
  ds_read_b64_tr_b16 a[232:233], v12 offset:20672
  v_cndmask_b32 v45, 0, v57, s[4:5]
  v_mfma_f32_16x16x32_bf16 v[188:191], v[68:71], a[92:95], v[188:191]
  ds_read_b64_tr_b16 a[234:235], v12 offset:25792
  v_cvt_pk_bf16_f32 v172, v172, v173
  v_mfma_f32_16x16x32_bf16 v[188:191], v[72:75], a[108:111], v[188:191]
  ds_read_b64_tr_b16 a[236:237], v12 offset:30912
  v_cvt_pk_bf16_f32 v173, v174, v175
  v_mfma_f32_16x16x32_bf16 v[188:191], v[76:79], a[124:127], v[188:191]
  s_waitcnt lgkmcnt(7)
  ds_read_b64_tr_b16 a[238:239], v12 offset:36032
  v_cmp_eq_u32 s[4:5], 3, v56
  v_mfma_f32_16x16x32_bf16 v[184:187], v[80:83], a[136:139], v[184:187]
  ds_read_b64_tr_b16 a[240:241], v14 offset:192
  v_cndmask_b32 v45, v45, v58, s[4:5]
  v_mfma_f32_16x16x32_bf16 v[184:187], v[84:87], a[152:155], v[184:187]
  ds_read_b64_tr_b16 a[242:243], v14 offset:5312
  v_mov_b32 v46, 0
  v_mfma_f32_16x16x32_bf16 v[184:187], v[88:91], a[168:171], v[184:187]
  ds_read_b64_tr_b16 a[244:245], v14 offset:10432
  v_mov_b32 v47, 0
  v_mfma_f32_16x16x32_bf16 v[184:187], v[92:95], a[184:187], v[184:187]
  ds_read_b64_tr_b16 a[246:247], v14 offset:15552
  v_mov_b32 v48, 0
  v_mfma_f32_16x16x32_bf16 v[188:191], v[80:83], a[140:143], v[188:191]
  ds_read_b64_tr_b16 a[248:249], v14 offset:20672
  v_mov_b32 v49, 0
  v_mfma_f32_16x16x32_bf16 v[188:191], v[84:87], a[156:159], v[188:191]
  ds_read_b64_tr_b16 a[250:251], v14 offset:25792
  v_mov_b32 v50, v44
  v_mfma_f32_16x16x32_bf16 v[188:191], v[88:91], a[172:175], v[188:191]
  ds_read_b64_tr_b16 a[252:253], v14 offset:30912
  v_mov_b32 v51, v45
  v_mfma_f32_16x16x32_bf16 v[188:191], v[92:95], a[188:191], v[188:191]
  s_waitcnt lgkmcnt(7)
  s_bitcmp1_b32 s37, 0
  s_cselect_b64 s[4:5], -1, 0
  ds_read_b64_tr_b16 a[254:255], v14 offset:36032
  v_cndmask_b32 v52, v44, v48, s[4:5]
  v_mfma_f32_16x16x32_bf16 v[200:203], a[224:227], a[72:75], v[200:203]
  ds_read_b64_tr_b16 v[64:65], v13 offset:192
  v_cndmask_b32 v53, v45, v49, s[4:5]
  v_mfma_f32_16x16x32_bf16 v[200:203], a[228:231], a[88:91], v[200:203]
  ds_read_b64_tr_b16 v[66:67], v13 offset:5312
  v_cndmask_b32 v54, v46, v50, s[4:5]
  v_mfma_f32_16x16x32_bf16 v[200:203], a[232:235], a[104:107], v[200:203]
  ds_read_b64_tr_b16 v[68:69], v13 offset:10432
  v_cvt_pk_bf16_f32 v170, v184, v185
  v_mfma_f32_16x16x32_bf16 v[200:203], a[236:239], a[120:123], v[200:203]
  ds_read_b64_tr_b16 v[70:71], v13 offset:15552
  v_cvt_pk_bf16_f32 v171, v186, v187
  v_mfma_f32_16x16x32_bf16 v[204:207], a[224:227], a[76:79], v[204:207]
  s_add_u32 s53, s41, 8192
  ds_read_b64_tr_b16 v[72:73], v13 offset:20672
  v_cndmask_b32 v55, v47, v51, s[4:5]
  v_mfma_f32_16x16x32_bf16 v[204:207], a[228:231], a[92:95], v[204:207]
  s_mov_b32 s65, 0
  ds_read_b64_tr_b16 v[74:75], v13 offset:25792
  buffer_store_dwordx4 v[168:171], v3, s[28:31], s53 offen offset:0 sc1
  v_mfma_f32_16x16x32_bf16 v[204:207], a[232:235], a[108:111], v[204:207]
  s_mov_b32 s66, 0
  ds_read_b64_tr_b16 v[76:77], v13 offset:30912
  v_mfma_f32_16x16x32_bf16 v[204:207], a[236:239], a[124:127], v[204:207]
  s_waitcnt lgkmcnt(7)
  s_mov_b32 s70, s61
  ds_read_b64_tr_b16 v[78:79], v13 offset:36032
  v_mfma_f32_16x16x32_bf16 v[200:203], a[240:243], a[136:139], v[200:203]
  ds_read_b64_tr_b16 v[80:81], v15 offset:192
  v_mfma_f32_16x16x32_bf16 v[200:203], a[244:247], a[152:155], v[200:203]
  ds_read_b64_tr_b16 v[82:83], v15 offset:5312
  v_mfma_f32_16x16x32_bf16 v[200:203], a[248:251], a[168:171], v[200:203]
  ds_read_b64_tr_b16 v[84:85], v15 offset:10432
  v_mfma_f32_16x16x32_bf16 v[200:203], a[252:255], a[184:187], v[200:203]
  ds_read_b64_tr_b16 v[86:87], v15 offset:15552
  v_mfma_f32_16x16x32_bf16 v[204:207], a[240:243], a[140:143], v[204:207]
  ds_read_b64_tr_b16 v[88:89], v15 offset:20672
  v_mfma_f32_16x16x32_bf16 v[204:207], a[244:247], a[156:159], v[204:207]
  ds_read_b64_tr_b16 v[90:91], v15 offset:25792
  v_mfma_f32_16x16x32_bf16 v[204:207], a[248:251], a[172:175], v[204:207]
  ds_read_b64_tr_b16 v[92:93], v15 offset:30912
  v_mfma_f32_16x16x32_bf16 v[204:207], a[252:255], a[188:191], v[204:207]
  s_waitcnt lgkmcnt(7)
  ds_read_b64_tr_b16 v[94:95], v15 offset:36032
  v_cvt_pk_bf16_f32 v174, v188, v189
  v_mfma_f32_16x16x32_bf16 v[216:219], v[64:67], a[72:75], v[216:219]
  ds_read_b64_tr_b16 a[224:225], v12 offset:256
  v_cvt_pk_bf16_f32 v175, v190, v191
  v_mfma_f32_16x16x32_bf16 v[216:219], v[68:71], a[88:91], v[216:219]
  s_add_u32 s53, s41, 8192
  ds_read_b64_tr_b16 a[226:227], v12 offset:5376
  v_cvt_pk_bf16_f32 v200, v200, v201
  v_mfma_f32_16x16x32_bf16 v[216:219], v[72:75], a[104:107], v[216:219]
  ds_read_b64_tr_b16 a[228:229], v12 offset:10496
  buffer_store_dwordx4 v[172:175], v3, s[28:31], s53 offen offset:2048 sc1
  v_mfma_f32_16x16x32_bf16 v[216:219], v[76:79], a[120:123], v[216:219]
  ds_read_b64_tr_b16 a[230:231], v12 offset:15616
  v_cvt_pk_bf16_f32 v201, v202, v203
  v_mov_b32 v18, 0
  v_mfma_f32_16x16x32_bf16 v[220:223], v[64:67], a[76:79], v[220:223]
  ds_read_b64_tr_b16 a[232:233], v12 offset:20736
  buffer_atomic_add v18, v16, s[28:31], s83 offen sc0
  v_mfma_f32_16x16x32_bf16 v[220:223], v[68:71], a[92:95], v[220:223]
  ds_read_b64_tr_b16 a[234:235], v12 offset:25856
  v_cvt_pk_bf16_f32 v204, v204, v205
  v_mfma_f32_16x16x32_bf16 v[220:223], v[72:75], a[108:111], v[220:223]
  ds_read_b64_tr_b16 a[236:237], v12 offset:30976
  v_cvt_pk_bf16_f32 v205, v206, v207
  v_mfma_f32_16x16x32_bf16 v[220:223], v[76:79], a[124:127], v[220:223]
  s_waitcnt lgkmcnt(7)
  ds_read_b64_tr_b16 a[238:239], v12 offset:36096
  v_mfma_f32_16x16x32_bf16 v[216:219], v[80:83], a[136:139], v[216:219]
  ds_read_b64_tr_b16 a[240:241], v14 offset:256
  v_mfma_f32_16x16x32_bf16 v[216:219], v[84:87], a[152:155], v[216:219]
  ds_read_b64_tr_b16 a[242:243], v14 offset:5376
  v_mfma_f32_16x16x32_bf16 v[216:219], v[88:91], a[168:171], v[216:219]
  ds_read_b64_tr_b16 a[244:245], v14 offset:10496
  v_mfma_f32_16x16x32_bf16 v[216:219], v[92:95], a[184:187], v[216:219]
  ds_read_b64_tr_b16 a[246:247], v14 offset:15616
  v_mfma_f32_16x16x32_bf16 v[220:223], v[80:83], a[140:143], v[220:223]
  ds_read_b64_tr_b16 a[248:249], v14 offset:20736
  v_mfma_f32_16x16x32_bf16 v[220:223], v[84:87], a[156:159], v[220:223]
  ds_read_b64_tr_b16 a[250:251], v14 offset:25856
  v_mfma_f32_16x16x32_bf16 v[220:223], v[88:91], a[172:175], v[220:223]
  ds_read_b64_tr_b16 a[252:253], v14 offset:30976
  v_mfma_f32_16x16x32_bf16 v[220:223], v[92:95], a[188:191], v[220:223]
  s_waitcnt lgkmcnt(7)
  ds_read_b64_tr_b16 a[254:255], v14 offset:36096
  v_mfma_f32_16x16x32_bf16 v[232:235], a[224:227], a[72:75], v[232:235]
  ds_read_b64_tr_b16 v[64:65], v13 offset:256
  v_mfma_f32_16x16x32_bf16 v[232:235], a[228:231], a[88:91], v[232:235]
  ds_read_b64_tr_b16 v[66:67], v13 offset:5376
  v_mfma_f32_16x16x32_bf16 v[232:235], a[232:235], a[104:107], v[232:235]
  ds_read_b64_tr_b16 v[68:69], v13 offset:10496
  v_cvt_pk_bf16_f32 v202, v216, v217
  v_mfma_f32_16x16x32_bf16 v[232:235], a[236:239], a[120:123], v[232:235]
  ds_read_b64_tr_b16 v[70:71], v13 offset:15616
  v_cvt_pk_bf16_f32 v203, v218, v219
  v_mfma_f32_16x16x32_bf16 v[236:239], a[224:227], a[76:79], v[236:239]
  s_add_u32 s53, s41, 12288
  ds_read_b64_tr_b16 v[72:73], v13 offset:20736
  v_mfma_f32_16x16x32_bf16 v[236:239], a[228:231], a[92:95], v[236:239]
  ds_read_b64_tr_b16 v[74:75], v13 offset:25856
  buffer_store_dwordx4 v[200:203], v3, s[28:31], s53 offen offset:0 sc1
  v_mfma_f32_16x16x32_bf16 v[236:239], a[232:235], a[108:111], v[236:239]
  ds_read_b64_tr_b16 v[76:77], v13 offset:30976
  v_mfma_f32_16x16x32_bf16 v[236:239], a[236:239], a[124:127], v[236:239]
  s_waitcnt lgkmcnt(7)
  ds_read_b64_tr_b16 v[78:79], v13 offset:36096
  v_cvt_pk_bf16_f32 v206, v220, v221
  v_mfma_f32_16x16x32_bf16 v[232:235], a[240:243], a[136:139], v[232:235]
  ds_read_b64_tr_b16 v[80:81], v15 offset:256
  v_cvt_pk_bf16_f32 v207, v222, v223
  v_mfma_f32_16x16x32_bf16 v[232:235], a[244:247], a[152:155], v[232:235]
  s_add_u32 s53, s41, 12288
  ds_read_b64_tr_b16 v[82:83], v15 offset:5376
  v_mfma_f32_16x16x32_bf16 v[232:235], a[248:251], a[168:171], v[232:235]
  ds_read_b64_tr_b16 v[84:85], v15 offset:10496
  buffer_store_dwordx4 v[204:207], v3, s[28:31], s53 offen offset:2048 sc1
  v_mfma_f32_16x16x32_bf16 v[232:235], a[252:255], a[184:187], v[232:235]
  ds_read_b64_tr_b16 v[86:87], v15 offset:15616
  v_mfma_f32_16x16x32_bf16 v[236:239], a[240:243], a[140:143], v[236:239]
  ds_read_b64_tr_b16 v[88:89], v15 offset:20736
  v_mfma_f32_16x16x32_bf16 v[236:239], a[244:247], a[156:159], v[236:239]
  ds_read_b64_tr_b16 v[90:91], v15 offset:25856
  v_mfma_f32_16x16x32_bf16 v[236:239], a[248:251], a[172:175], v[236:239]
  ds_read_b64_tr_b16 v[92:93], v15 offset:30976
  v_mfma_f32_16x16x32_bf16 v[236:239], a[252:255], a[188:191], v[236:239]
  s_waitcnt lgkmcnt(7)
  ds_read_b64_tr_b16 v[94:95], v15 offset:36096
  v_mfma_f32_16x16x32_bf16 v[248:251], v[64:67], a[72:75], v[248:251]
  v_mfma_f32_16x16x32_bf16 v[248:251], v[68:71], a[88:91], v[248:251]
  v_cvt_pk_bf16_f32 v232, v232, v233
  v_cvt_pk_bf16_f32 v233, v234, v235
  v_mfma_f32_16x16x32_bf16 v[248:251], v[72:75], a[104:107], v[248:251]
  v_mfma_f32_16x16x32_bf16 v[248:251], v[76:79], a[120:123], v[248:251]
  v_mfma_f32_16x16x32_bf16 v[252:255], v[64:67], a[76:79], v[252:255]
  v_mfma_f32_16x16x32_bf16 v[252:255], v[68:71], a[92:95], v[252:255]
  v_cvt_pk_bf16_f32 v236, v236, v237
  v_cvt_pk_bf16_f32 v237, v238, v239
  v_mfma_f32_16x16x32_bf16 v[252:255], v[72:75], a[108:111], v[252:255]
  v_mfma_f32_16x16x32_bf16 v[252:255], v[76:79], a[124:127], v[252:255]
  s_waitcnt lgkmcnt(0)
  v_mfma_f32_16x16x32_bf16 v[248:251], v[80:83], a[136:139], v[248:251]
  v_mfma_f32_16x16x32_bf16 v[248:251], v[84:87], a[152:155], v[248:251]
  v_mfma_f32_16x16x32_bf16 v[248:251], v[88:91], a[168:171], v[248:251]
  v_mfma_f32_16x16x32_bf16 v[248:251], v[92:95], a[184:187], v[248:251]
  v_mfma_f32_16x16x32_bf16 v[252:255], v[80:83], a[140:143], v[252:255]
  v_mfma_f32_16x16x32_bf16 v[252:255], v[84:87], a[156:159], v[252:255]
  v_mfma_f32_16x16x32_bf16 v[252:255], v[88:91], a[172:175], v[252:255]
  v_mfma_f32_16x16x32_bf16 v[252:255], v[92:95], a[188:191], v[252:255]
  s_nop 3
  v_cvt_pk_bf16_f32 v234, v248, v249
  v_cvt_pk_bf16_f32 v235, v250, v251
  s_add_u32 s53, s41, 16384
  buffer_store_dwordx4 v[232:235], v3, s[28:31], s53 offen offset:0 sc1
  v_cvt_pk_bf16_f32 v238, v252, v253
  v_cvt_pk_bf16_f32 v239, v254, v255
  s_add_u32 s53, s41, 16384
  buffer_store_dwordx4 v[236:239], v3, s[28:31], s53 offen offset:2048 sc1
  s_waitcnt vmcnt(4)
  v_readfirstlane_b32 s67, v18
  v_mov_b32 v14, v18
  s_and_b32 s67, s67, 3
  s_cmp_lg_u32 s67, 3
  s_cbranch_scc1 L_t_ne
  s_add_u32 s51, s38, 0
  buffer_load_dwordx4 a[0:3], v28, s[28:31], s51 offen sc1
  buffer_load_dwordx4 a[4:7], v29, s[28:31], s51 offen sc1
  buffer_load_dwordx4 a[8:11], v30, s[28:31], s51 offen sc1
  s_add_u32 s51, s38, 2621440
  buffer_load_dwordx4 a[12:15], v28, s[28:31], s51 offen sc1
  buffer_load_dwordx4 a[16:19], v29, s[28:31], s51 offen sc1
  buffer_load_dwordx4 a[20:23], v30, s[28:31], s51 offen sc1
  s_mov_b32 s66, 3
L_t_ne:
  s_mov_b64 exec, 0
  s_cmp_eq_u32 s48, 0
  s_cbranch_scc1 HS31
  s_cmp_eq_u32 s48, 1
  s_cbranch_scc1 HS32
  s_cmp_eq_u32 s48, 2
  s_cbranch_scc1 HS33
  s_branch HS34
HOPR_c:
  s_mov_b64 exec, -1
  v_mov_b32 v12, 1
  s_mov_b32 s71, s76
  s_mov_b32 s3, 0
  s_barrier
  s_waitcnt vmcnt(6)
  s_cmp_lg_u32 s66, 0
  s_cbranch_scc1 L_t_ak
  s_waitcnt vmcnt(0)
L_t_ak:
  buffer_atomic_add v31, v16, s[28:31], s75 offen
  s_mov_b32 m0, 159744
  s_nop 0
  buffer_load_dwordx4 v42, s[28:31], 0 offen sc1 lds
  s_mov_b32 m0, 160768
  s_mov_b32 s51, 0
  buffer_load_dwordx4 v41, s[28:31], s51 offen sc1 lds
  s_mov_b32 m0, 161792
  s_mov_b32 s51, 3456
  buffer_load_dwordx4 v41, s[28:31], s51 offen sc1 lds
  s_add_u32 m0, s73, 0
  s_nop 0
  buffer_load_dwordx4 v60, s[32:35], s72 offen lds
  s_add_u32 m0, s73, 1024
  s_nop 0
  buffer_load_dwordx4 v61, s[32:35], s72 offen lds
  s_add_u32 m0, s73, 2048
  s_nop 0
  buffer_load_dwordx4 v62, s[32:35], s72 offen lds
  s_add_u32 s51, s48, 0
  s_and_b32 s51, s51, 3
  s_lshl_b32 s51, s51, 10
  v_add_u32 v170, s51, v3
  s_add_u32 s51, s48, 1
  s_and_b32 s51, s51, 3
  s_lshl_b32 s51, s51, 10
  v_add_u32 v171, s51, v3
  s_add_u32 s51, s48, 2
  s_and_b32 s51, s51, 3
  s_lshl_b32 s51, s51, 10
  v_add_u32 v172, s51, v3
  s_add_u32 s51, s48, 3
  s_and_b32 s51, s51, 3
  s_lshl_b32 s51, s51, 10
  v_add_u32 v173, s51, v3
L_t_pl:
  v_readfirstlane_b32 s67, v14
  s_nop 0
  s_andn2_b32 s67, s67, s66
  s_or_b32 s66, s66, s67
  s_bitcmp0_b32 s67, 0
  s_cbranch_scc1 L_t_px0
  s_add_u32 s51, s38, 0
  buffer_load_dwordx4 a[0:3], v28, s[28:31], s51 offen sc1
  buffer_load_dwordx4 a[4:7], v29, s[28:31], s51 offen sc1
  buffer_load_dwordx4 a[8:11], v30, s[28:31], s51 offen sc1
L_t_px0:
  s_bitcmp0_b32 s67, 1
  s_cbranch_scc1 L_t_px1
  s_add_u32 s51, s38, 2621440
  buffer_load_dwordx4 a[12:15], v28, s[28:31], s51 offen sc1
  buffer_load_dwordx4 a[16:19], v29, s[28:31], s51 offen sc1
  buffer_load_dwordx4 a[20:23], v30, s[28:31], s51 offen sc1
L_t_px1:
  s_bitcmp0_b32 s67, 2
  s_cbranch_scc1 L_t_px2
  s_add_u32 s51, s38, 5242880
  buffer_load_dwordx4 a[24:27], v28, s[28:31], s51 offen sc1
  buffer_load_dwordx4 a[28:31], v29, s[28:31], s51 offen sc1
  buffer_load_dwordx4 a[32:35], v30, s[28:31], s51 offen sc1
L_t_px2:
  s_bitcmp0_b32 s67, 3
  s_cbranch_scc1 L_t_px3
  s_add_u32 s51, s38, 7864320
  buffer_load_dwordx4 a[36:39], v28, s[28:31], s51 offen sc1
  buffer_load_dwordx4 a[40:43], v29, s[28:31], s51 offen sc1
  buffer_load_dwordx4 a[44:47], v30, s[28:31], s51 offen sc1
  s_cmp_ge_u32 s65, 5
  s_cbranch_scc1 L_t_px3
  s_add_u32 s52, s70, 0
  s_add_u32 m0, s71, 0
  s_nop 0
  buffer_load_dwordx4 v4, s[28:31], s52 offen offset:0 sc1 lds
  buffer_load_dwordx4 v4, s[28:31], s52 offen offset:1024 sc1 lds
  buffer_load_dwordx4 v4, s[28:31], s52 offen offset:2048 sc1 lds
  buffer_load_dwordx4 v4, s[28:31], s52 offen offset:3072 sc1 lds
  s_add_u32 m0, s71, 4096
  s_nop 0
  buffer_load_dwordx4 v5, s[28:31], s52 offen offset:0 sc1 lds
  buffer_load_dwordx4 v5, s[28:31], s52 offen offset:1024 sc1 lds
  s_add_u32 m0, s71, 6144
  s_nop 0
  buffer_load_dwordx4 v7, s[28:31], s52 offen offset:0 sc1 lds
  s_add_u32 s70, s70, 442368
  s_add_u32 s71, s71, 28672
  s_add_u32 s65, s65, 1
L_t_px3:
  s_bitcmp0_b32 s67, 4
  s_cbranch_scc1 L_t_px4
  s_add_u32 s51, s38, 10485760
  buffer_load_dwordx4 a[48:51], v28, s[28:31], s51 offen sc1
  buffer_load_dwordx4 a[52:55], v29, s[28:31], s51 offen sc1
  buffer_load_dwordx4 a[56:59], v30, s[28:31], s51 offen sc1
L_t_px4:
  s_bitcmp0_b32 s67, 5
HS31:
  s_cbranch_execz HS35
  s_cbranch_scc1 L_t_px5
  s_add_u32 s51, s38, 13107200
  buffer_load_dwordx4 a[60:63], v28, s[28:31], s51 offen sc1
  buffer_load_dwordx4 a[64:67], v29, s[28:31], s51 offen sc1
  buffer_load_dwordx4 a[68:71], v30, s[28:31], s51 offen sc1
  s_cmp_ge_u32 s65, 5
  s_cbranch_scc1 L_t_px5
  s_add_u32 s52, s70, 0
  s_add_u32 m0, s71, 0
  s_nop 0
  buffer_load_dwordx4 v4, s[28:31], s52 offen offset:0 sc1 lds
  buffer_load_dwordx4 v4, s[28:31], s52 offen offset:1024 sc1 lds
  buffer_load_dwordx4 v4, s[28:31], s52 offen offset:2048 sc1 lds
  buffer_load_dwordx4 v4, s[28:31], s52 offen offset:3072 sc1 lds
  s_add_u32 m0, s71, 4096
  s_nop 0
  buffer_load_dwordx4 v5, s[28:31], s52 offen offset:0 sc1 lds
  buffer_load_dwordx4 v5, s[28:31], s52 offen offset:1024 sc1 lds
  s_add_u32 m0, s71, 6144
  s_nop 0
  buffer_load_dwordx4 v7, s[28:31], s52 offen offset:0 sc1 lds
  s_add_u32 s70, s70, 442368
  s_add_u32 s71, s71, 28672
  s_add_u32 s65, s65, 1
L_t_px5:
  s_bitcmp0_b32 s67, 6
  s_cbranch_scc1 L_t_px6
  s_add_u32 s51, s38, 15728640
  buffer_load_dwordx4 a[72:75], v28, s[28:31], s51 offen sc1
  buffer_load_dwordx4 a[76:79], v29, s[28:31], s51 offen sc1
  buffer_load_dwordx4 a[80:83], v30, s[28:31], s51 offen sc1
L_t_px6:
  s_bitcmp0_b32 s67, 7
  s_cbranch_scc1 L_t_px7
  s_add_u32 s51, s38, 18350080
  buffer_load_dwordx4 a[84:87], v28, s[28:31], s51 offen sc1
  buffer_load_dwordx4 a[88:91], v29, s[28:31], s51 offen sc1
  buffer_load_dwordx4 a[92:95], v30, s[28:31], s51 offen sc1
L_t_px7:
  s_cmp_eq_u32 s66, 0xff
  s_cbranch_scc1 L_t_po
  s_add_u32 s3, s3, 1
  s_cmp_gt_u32 s3, 1000000
  s_cbranch_scc1 L_t_po
  s_cmp_ge_u32 s65, 5
  s_cbranch_scc1 L_t_pn
  s_add_u32 s52, s70, 0
  s_add_u32 m0, s71, 0
  s_nop 0
  buffer_load_dwordx4 v4, s[28:31], s52 offen offset:0 sc1 lds
  buffer_load_dwordx4 v4, s[28:31], s52 offen offset:1024 sc1 lds
  buffer_load_dwordx4 v4, s[28:31], s52 offen offset:2048 sc1 lds
  buffer_load_dwordx4 v4, s[28:31], s52 offen offset:3072 sc1 lds
  s_add_u32 m0, s71, 4096
  s_nop 0
  buffer_load_dwordx4 v5, s[28:31], s52 offen offset:0 sc1 lds
  buffer_load_dwordx4 v5, s[28:31], s52 offen offset:1024 sc1 lds
  s_add_u32 m0, s71, 6144
  s_nop 0
  buffer_load_dwordx4 v7, s[28:31], s52 offen offset:0 sc1 lds
  s_add_u32 s70, s70, 442368
  s_add_u32 s71, s71, 28672
  s_add_u32 s65, s65, 1
L_t_pn:
  s_sleep 12
  v_mov_b32 v14, 0
  buffer_atomic_add v14, v40, s[28:31], s39 offen sc0
  s_waitcnt vmcnt(0)
  s_branch L_t_pl
L_t_po:
  s_cmp_ge_u32 s65, 5
  s_cbranch_scc1 L_t_pw
  s_add_u32 s52, s70, 0
  s_add_u32 m0, s71, 0
  s_nop 0
  buffer_load_dwordx4 v4, s[28:31], s52 offen offset:0 sc1 lds
  buffer_load_dwordx4 v4, s[28:31], s52 offen offset:1024 sc1 lds
  buffer_load_dwordx4 v4, s[28:31], s52 offen offset:2048 sc1 lds
  buffer_load_dwordx4 v4, s[28:31], s52 offen offset:3072 sc1 lds
  s_add_u32 m0, s71, 4096
  s_nop 0
  buffer_load_dwordx4 v5, s[28:31], s52 offen offset:0 sc1 lds
  buffer_load_dwordx4 v5, s[28:31], s52 offen offset:1024 sc1 lds
  s_add_u32 m0, s71, 6144
  s_nop 0
  buffer_load_dwordx4 v7, s[28:31], s52 offen offset:0 sc1 lds
  s_add_u32 s70, s70, 442368
  s_add_u32 s71, s71, 28672
  s_add_u32 s65, s65, 1
  s_waitcnt vmcnt(7)
  s_branch L_t_pz
L_t_pw:
  s_waitcnt vmcnt(0)
L_t_pz:
  ds_read_b64 v[96:97], v63 offset:0
  ds_read_b64 v[98:99], v63 offset:32
  ds_read_b64 v[100:101], v63 offset:64
  ds_read_b64 v[102:103], v63 offset:96
  ds_read_b64 v[104:105], v59 offset:128
  ds_read_b128 v[56:59], v38 offset:0
  ds_read_b128 v[76:79], v38 offset:320
  ds_read_b128 v[60:63], v38 offset:64
  ds_read_b128 v[80:83], v38 offset:384
  ds_read_b128 v[64:67], v38 offset:128
  ds_read_b128 v[84:87], v38 offset:448
  ds_read_b128 v[68:71], v38 offset:192
  ds_read_b128 v[88:91], v38 offset:512
  ds_read_b128 v[72:75], v38 offset:256
  ds_read_b128 v[92:95], v38 offset:576
  v_mfma_f32_16x16x32_bf16 v[16:19], v[44:47], a[0:3], 0
  v_mfma_f32_16x16x32_bf16 v[16:19], v[44:47], a[12:15], v[16:19]
  v_mfma_f32_16x16x32_bf16 v[16:19], v[44:47], a[24:27], v[16:19]
  v_mfma_f32_16x16x32_bf16 v[16:19], v[44:47], a[36:39], v[16:19]
  s_waitcnt lgkmcnt(14)
  v_lshlrev_b32 v112, 16, v96
  v_and_b32 v113, 0xffff0000, v96
  v_mfma_f32_16x16x32_bf16 v[16:19], v[44:47], a[48:51], v[16:19]
  v_lshlrev_b32 v114, 16, v97
  v_and_b32 v115, 0xffff0000, v97
  v_mfma_f32_16x16x32_bf16 v[16:19], v[44:47], a[60:63], v[16:19]
  s_waitcnt lgkmcnt(13)
  v_lshlrev_b32 v116, 16, v98
  v_and_b32 v117, 0xffff0000, v98
  v_mfma_f32_16x16x32_bf16 v[16:19], v[44:47], a[72:75], v[16:19]
  v_lshlrev_b32 v118, 16, v99
  v_and_b32 v119, 0xffff0000, v99
  v_mfma_f32_16x16x32_bf16 v[16:19], v[44:47], a[84:87], v[16:19]
  s_waitcnt lgkmcnt(12)
  v_lshlrev_b32 v120, 16, v100
  v_and_b32 v121, 0xffff0000, v100
  v_mfma_f32_16x16x32_bf16 v[20:23], v[48:51], a[0:3], 0
  v_lshlrev_b32 v122, 16, v101
  v_and_b32 v123, 0xffff0000, v101
  v_mfma_f32_16x16x32_bf16 v[20:23], v[48:51], a[12:15], v[20:23]
  s_waitcnt lgkmcnt(11)
  v_lshlrev_b32 v124, 16, v102
  v_and_b32 v125, 0xffff0000, v102
  v_mfma_f32_16x16x32_bf16 v[20:23], v[48:51], a[24:27], v[20:23]
  v_lshlrev_b32 v126, 16, v103
  v_and_b32 v127, 0xffff0000, v103
  v_mfma_f32_16x16x32_bf16 v[20:23], v[48:51], a[36:39], v[20:23]
  s_waitcnt lgkmcnt(10)
  v_lshlrev_b32 v128, 16, v104
  v_and_b32 v129, 0xffff0000, v104
  v_mfma_f32_16x16x32_bf16 v[20:23], v[48:51], a[48:51], v[20:23]
  v_lshlrev_b32 v130, 16, v105
  v_and_b32 v131, 0xffff0000, v105
  v_mfma_f32_16x16x32_bf16 v[20:23], v[48:51], a[60:63], v[20:23]
  v_mfma_f32_16x16x32_bf16 v[20:23], v[48:51], a[72:75], v[20:23]
  s_waitcnt lgkmcnt(9)
  v_fma_f32 v16, v16, v56, v112
  v_fma_f32 v17, v17, v57, v113
  v_mfma_f32_16x16x32_bf16 v[20:23], v[48:51], a[84:87], v[20:23]
  v_fma_f32 v18, v18, v58, v114
  v_fma_f32 v19, v19, v59, v115
  v_mfma_f32_16x16x32_bf16 v[24:27], v[44:47], a[4:7], 0
  s_waitcnt lgkmcnt(8)
  v_mul_f32 v56, v16, v76
  v_mul_f32 v57, v17, v77
  v_mfma_f32_16x16x32_bf16 v[24:27], v[44:47], a[16:19], v[24:27]
  v_mul_f32 v58, v18, v78
  v_mul_f32 v59, v19, v79
  v_mfma_f32_16x16x32_bf16 v[24:27], v[44:47], a[28:31], v[24:27]
  v_mfma_f32_16x16x32_bf16 v[24:27], v[44:47], a[40:43], v[24:27]
  v_mfma_f32_16x16x32_bf16 v[24:27], v[44:47], a[52:55], v[24:27]
  s_waitcnt lgkmcnt(7)
  v_fma_f32 v20, v20, v60, v116
  v_fma_f32 v21, v21, v61, v117
  v_mfma_f32_16x16x32_bf16 v[24:27], v[44:47], a[64:67], v[24:27]
  v_fma_f32 v22, v22, v62, v118
  v_fma_f32 v23, v23, v63, v119
  v_mfma_f32_16x16x32_bf16 v[24:27], v[44:47], a[76:79], v[24:27]
  s_waitcnt lgkmcnt(6)
  v_mul_f32 v60, v20, v80
  v_mul_f32 v61, v21, v81
  v_mfma_f32_16x16x32_bf16 v[24:27], v[44:47], a[88:91], v[24:27]
  v_mul_f32 v62, v22, v82
  v_mul_f32 v63, v23, v83
  v_mfma_f32_16x16x32_bf16 v[28:31], v[48:51], a[4:7], 0
  v_mfma_f32_16x16x32_bf16 v[28:31], v[48:51], a[16:19], v[28:31]
  v_mfma_f32_16x16x32_bf16 v[28:31], v[48:51], a[28:31], v[28:31]
  v_mfma_f32_16x16x32_bf16 v[28:31], v[48:51], a[40:43], v[28:31]
  v_mfma_f32_16x16x32_bf16 v[28:31], v[48:51], a[52:55], v[28:31]
  s_waitcnt lgkmcnt(5)
  v_fma_f32 v24, v24, v64, v120
  v_fma_f32 v25, v25, v65, v121
  v_mfma_f32_16x16x32_bf16 v[28:31], v[48:51], a[64:67], v[28:31]
  v_fma_f32 v26, v26, v66, v122
  v_fma_f32 v27, v27, v67, v123
  v_mfma_f32_16x16x32_bf16 v[28:31], v[48:51], a[76:79], v[28:31]
  s_waitcnt lgkmcnt(4)
  v_mul_f32 v64, v24, v84
  v_mul_f32 v65, v25, v85
  v_mfma_f32_16x16x32_bf16 v[28:31], v[48:51], a[88:91], v[28:31]
  v_mul_f32 v66, v26, v86
  v_mul_f32 v67, v27, v87
  v_mfma_f32_16x16x32_bf16 v[32:35], v[52:55], a[8:11], 0
  v_mfma_f32_16x16x32_bf16 v[32:35], v[52:55], a[20:23], v[32:35]
  v_mfma_f32_16x16x32_bf16 v[32:35], v[52:55], a[32:35], v[32:35]
  v_mfma_f32_16x16x32_bf16 v[32:35], v[52:55], a[44:47], v[32:35]
  v_mfma_f32_16x16x32_bf16 v[32:35], v[52:55], a[56:59], v[32:35]
  s_waitcnt lgkmcnt(3)
  v_fma_f32 v28, v28, v68, v124
  v_fma_f32 v29, v29, v69, v125
  v_mfma_f32_16x16x32_bf16 v[32:35], v[52:55], a[68:71], v[32:35]
  v_fma_f32 v30, v30, v70, v126
  v_fma_f32 v31, v31, v71, v127
  v_mfma_f32_16x16x32_bf16 v[32:35], v[52:55], a[80:83], v[32:35]
  s_waitcnt lgkmcnt(2)
  v_mul_f32 v68, v28, v88
  v_mul_f32 v69, v29, v89
  v_mfma_f32_16x16x32_bf16 v[32:35], v[52:55], a[92:95], v[32:35]
  v_mul_f32 v70, v30, v90
  v_mul_f32 v71, v31, v91
  s_waitcnt lgkmcnt(1)
  s_nop 4
  v_pk_fma_f32 v[32:33], v[32:33], v[72:73], v[128:129]
  v_pk_fma_f32 v[34:35], v[34:35], v[74:75], v[130:131]
  s_waitcnt lgkmcnt(0)
  v_pk_mul_f32 v[72:73], v[32:33], v[92:93]
  v_pk_mul_f32 v[74:75], v[34:35], v[94:95]
  v_cvt_pk_bf16_f32 v56, v56, v57
  v_cvt_pk_bf16_f32 v57, v58, v59
  v_cvt_pk_bf16_f32 v58, v60, v61
  v_cvt_pk_bf16_f32 v59, v62, v63
  v_cvt_pk_bf16_f32 v60, v64, v65
  v_cvt_pk_bf16_f32 v61, v66, v67
  v_cvt_pk_bf16_f32 v62, v68, v69
  v_cvt_pk_bf16_f32 v63, v70, v71
  v_cvt_pk_bf16_f32 v64, v72, v73
  v_cvt_pk_bf16_f32 v65, v74, v75
  s_mul_i32 s51, s42, 81920
  s_lshl_b32 s52, s48, 10
  s_add_u32 s51, s51, s52
  s_add_u32 s51, s51, 75497472
  s_lshl_b32 s52, s36, 11
  s_add_u32 s52, s52, s51
  buffer_store_dwordx4 v[56:59], v3, s[28:31], s52 offen sc1
  s_add_u32 s52, s52, 4096
  buffer_store_dwordx4 v[60:63], v3, s[28:31], s52 offen sc1
  s_add_u32 s52, s52, 4096
  s_lshr_b32 s52, s37, 1
  s_lshl_b32 s52, s52, 12
  s_add_u32 s51, s51, s52
  s_and_b32 s52, s37, 1
  s_lshl_b32 s52, s52, 3
  s_add_u32 s51, s51, s52
  buffer_store_dwordx2 v[64:65], v3, s[28:31], s51 offen sc1
  v_pk_add_f32 v[112:113], v[16:17], v[18:19]
  v_pk_mul_f32 v[114:115], v[16:17], v[16:17]
  v_pk_fma_f32 v[114:115], v[18:19], v[18:19], v[114:115]
  v_pk_add_f32 v[112:113], v[112:113], v[20:21]
  v_pk_fma_f32 v[114:115], v[20:21], v[20:21], v[114:115]
  v_pk_add_f32 v[112:113], v[112:113], v[22:23]
  v_pk_fma_f32 v[114:115], v[22:23], v[22:23], v[114:115]
  v_pk_add_f32 v[112:113], v[112:113], v[24:25]
  v_pk_fma_f32 v[114:115], v[24:25], v[24:25], v[114:115]
  v_pk_add_f32 v[112:113], v[112:113], v[26:27]
  v_pk_fma_f32 v[114:115], v[26:27], v[26:27], v[114:115]
  v_pk_add_f32 v[112:113], v[112:113], v[28:29]
  v_pk_fma_f32 v[114:115], v[28:29], v[28:29], v[114:115]
  v_pk_add_f32 v[112:113], v[112:113], v[30:31]
  v_pk_fma_f32 v[114:115], v[30:31], v[30:31], v[114:115]
  v_pk_add_f32 v[112:113], v[112:113], v[32:33]
  v_pk_fma_f32 v[114:115], v[32:33], v[32:33], v[114:115]
  v_pk_add_f32 v[112:113], v[112:113], v[34:35]
  v_pk_fma_f32 v[114:115], v[34:35], v[34:35], v[114:115]
  v_add_f32 v116, v112, v113
  v_add_f32 v117, v114, v115
  v_mov_b32 v112, v116
  s_nop 1
  v_permlane16_swap_b32 v116, v112
  v_add_f32 v116, v116, v112
  v_mov_b32 v112, v116
  s_nop 1
  v_permlane32_swap_b32 v116, v112
  v_add_f32 v116, v116, v112
  v_mov_b32 v113, v117
  s_nop 1
  v_permlane16_swap_b32 v117, v113
  v_add_f32 v117, v117, v113
  v_mov_b32 v113, v117
  s_nop 1
  v_permlane32_swap_b32 v117, v113
  v_add_f32 v117, v117, v113
  s_add_u32 s51, s64, 65536
  buffer_store_dwordx2 v[116:117], v36, s[28:31], s51 offen sc1
  s_add_u32 s39, s62, 0
  s_lshl_b32 s39, s39, 7
  s_add_u32 s39, s39, 589824
  v_mov_b32 v14, 1
  s_waitcnt vmcnt(1)
  buffer_atomic_add v14, v40, s[28:31], s39 offen sc0
  s_cmp_ge_u32 s65, 5
  s_cbranch_scc1 L_t_wa
  s_add_u32 s52, s70, 0
  s_add_u32 m0, s71, 0
  s_nop 0
  buffer_load_dwordx4 v4, s[28:31], s52 offen offset:0 sc1 lds
  buffer_load_dwordx4 v4, s[28:31], s52 offen offset:1024 sc1 lds
  buffer_load_dwordx4 v4, s[28:31], s52 offen offset:2048 sc1 lds
  buffer_load_dwordx4 v4, s[28:31], s52 offen offset:3072 sc1 lds
  s_add_u32 m0, s71, 4096
  s_nop 0
  buffer_load_dwordx4 v5, s[28:31], s52 offen offset:0 sc1 lds
  buffer_load_dwordx4 v5, s[28:31], s52 offen offset:1024 sc1 lds
  s_add_u32 m0, s71, 6144
  s_nop 0
  buffer_load_dwordx4 v7, s[28:31], s52 offen offset:0 sc1 lds
  s_add_u32 s70, s70, 442368
  s_add_u32 s71, s71, 28672
  s_add_u32 s65, s65, 1
L_t_wa:
  s_cmp_ge_u32 s65, 5
  s_cbranch_scc1 L_t_wb
  s_add_u32 s52, s70, 0
  s_add_u32 m0, s71, 0
  s_nop 0
  buffer_load_dwordx4 v4, s[28:31], s52 offen offset:0 sc1 lds
  buffer_load_dwordx4 v4, s[28:31], s52 offen offset:1024 sc1 lds
  buffer_load_dwordx4 v4, s[28:31], s52 offen offset:2048 sc1 lds
  buffer_load_dwordx4 v4, s[28:31], s52 offen offset:3072 sc1 lds
  s_add_u32 m0, s71, 4096
  s_nop 0
  buffer_load_dwordx4 v5, s[28:31], s52 offen offset:0 sc1 lds
  buffer_load_dwordx4 v5, s[28:31], s52 offen offset:1024 sc1 lds
  s_add_u32 m0, s71, 6144
  s_nop 0
  buffer_load_dwordx4 v7, s[28:31], s52 offen offset:0 sc1 lds
  s_add_u32 s70, s70, 442368
  s_add_u32 s71, s71, 28672
  s_add_u32 s65, s65, 1
L_t_wb:
  s_cmp_ge_u32 s65, 5
  s_cbranch_scc1 L_t_wc
  s_add_u32 s52, s70, 0
  s_add_u32 m0, s71, 0
  s_nop 0
  buffer_load_dwordx4 v4, s[28:31], s52 offen offset:0 sc1 lds
  buffer_load_dwordx4 v4, s[28:31], s52 offen offset:1024 sc1 lds
  buffer_load_dwordx4 v4, s[28:31], s52 offen offset:2048 sc1 lds
  buffer_load_dwordx4 v4, s[28:31], s52 offen offset:3072 sc1 lds
  s_add_u32 m0, s71, 4096
  s_nop 0
  buffer_load_dwordx4 v5, s[28:31], s52 offen offset:0 sc1 lds
  buffer_load_dwordx4 v5, s[28:31], s52 offen offset:1024 sc1 lds
  s_add_u32 m0, s71, 6144
  s_nop 0
  buffer_load_dwordx4 v7, s[28:31], s52 offen offset:0 sc1 lds
  s_add_u32 s70, s70, 442368
  s_add_u32 s71, s71, 28672
  s_add_u32 s65, s65, 1
L_t_wc:
  s_cmp_ge_u32 s65, 5
  s_cbranch_scc1 L_t_wd
  s_add_u32 s52, s70, 0
  s_add_u32 m0, s71, 0
  s_nop 0
  buffer_load_dwordx4 v4, s[28:31], s52 offen offset:0 sc1 lds
  buffer_load_dwordx4 v4, s[28:31], s52 offen offset:1024 sc1 lds
  buffer_load_dwordx4 v4, s[28:31], s52 offen offset:2048 sc1 lds
  buffer_load_dwordx4 v4, s[28:31], s52 offen offset:3072 sc1 lds
  s_add_u32 m0, s71, 4096
  s_nop 0
  buffer_load_dwordx4 v5, s[28:31], s52 offen offset:0 sc1 lds
  buffer_load_dwordx4 v5, s[28:31], s52 offen offset:1024 sc1 lds
  s_add_u32 m0, s71, 6144
  s_nop 0
  buffer_load_dwordx4 v7, s[28:31], s52 offen offset:0 sc1 lds
  s_add_u32 s70, s70, 442368
  s_add_u32 s71, s71, 28672
  s_add_u32 s65, s65, 1
L_t_wd:
  s_add_u32 s51, s20, 131072
  buffer_load_dwordx4 a[240:243], v170, s[28:31], s51 offen sc1
  buffer_load_dwordx4 a[244:247], v171, s[28:31], s51 offen sc1
  buffer_load_dwordx4 a[248:251], v172, s[28:31], s51 offen sc1
  buffer_load_dwordx4 a[252:255], v173, s[28:31], s51 offen sc1
  s_add_u32 s51, s20, 135168
  buffer_load_dwordx4 a[224:227], v170, s[28:31], s51 offen sc1
  buffer_load_dwordx4 a[228:231], v171, s[28:31], s51 offen sc1
  buffer_load_dwordx4 a[232:235], v172, s[28:31], s51 offen sc1
  buffer_load_dwordx4 a[236:239], v173, s[28:31], s51 offen sc1
  s_add_u32 s51, s20, 0
  buffer_load_dwordx4 a[208:211], v170, s[28:31], s51 offen sc1
  buffer_load_dwordx4 a[212:215], v171, s[28:31], s51 offen sc1
  buffer_load_dwordx4 a[216:219], v172, s[28:31], s51 offen sc1
  buffer_load_dwordx4 a[220:223], v173, s[28:31], s51 offen sc1
  v_mov_b32 v44, 0xc0135761
  v_mov_b32 v45, 0xc0135761
  v_mov_b32 v46, 0xbdd2d3e8
  v_mov_b32 v47, 0xbdd2d3e8
  v_add_u32 v8, 65536, v3
  v_add_u32 v9, 131072, v3
  s_waitcnt vmcnt(12)
  s_barrier
  ds_read_b128 v[176:179], v3 offset:0
  ds_read_b128 v[180:183], v3 offset:7168
  ds_read_b128 v[184:187], v3 offset:14336
  ds_read_b128 v[188:191], v3 offset:21504
  ds_read_b128 v[192:195], v3 offset:1024
  ds_read_b128 v[196:199], v3 offset:8192
  ds_read_b128 v[200:203], v3 offset:15360
  ds_read_b128 v[204:207], v3 offset:22528
  ds_read_b128 v[208:211], v3 offset:2048
  ds_read_b128 v[212:215], v3 offset:9216
  s_waitcnt vmcnt(12)
  v_readfirstlane_b32 s51, v14
  s_nop 0
  s_cmp_ge_u32 s51, 7
  s_cbranch_scc1 L_t_pa_ok
  s_mov_b32 s53, 0
L_t_pa_spin:
  v_mov_b32 v14, 0
  buffer_atomic_add v14, v40, s[28:31], s39 offen sc0
  s_add_u32 s53, s53, 1
  s_cmp_gt_u32 s53, 1000000
  s_waitcnt vmcnt(0)
  s_cbranch_scc1 L_t_pa_ok
  v_readfirstlane_b32 s51, v14
  s_nop 0
  s_cmp_lt_u32 s51, 8
  s_cbranch_scc1 L_t_pa_spin
L_t_pa_ok:
  s_add_u32 s51, s59, 0
  s_nop 0
  buffer_load_dwordx4 a[32:35], v3, s[28:31], s51 offen sc1
  s_add_u32 s51, s59, 4096
  buffer_load_dwordx4 a[36:39], v3, s[28:31], s51 offen sc1
  s_add_u32 s51, s59, 8192
  buffer_load_dwordx4 a[40:43], v3, s[28:31], s51 offen sc1
  s_add_u32 s51, s59, 12288
  buffer_load_dwordx4 a[44:47], v3, s[28:31], s51 offen sc1
  s_add_u32 s51, s59, 16384
  buffer_load_dwordx4 a[48:51], v3, s[28:31], s51 offen sc1
  s_add_u32 s51, s59, 20480
  buffer_load_dwordx4 a[52:55], v3, s[28:31], s51 offen sc1
  s_add_u32 s51, s59, 24576
  buffer_load_dwordx4 a[56:59], v3, s[28:31], s51 offen sc1
  s_add_u32 s51, s59, 28672
  buffer_load_dwordx4 a[60:63], v3, s[28:31], s51 offen sc1
  s_waitcnt vmcnt(7) lgkmcnt(9)
  v_mfma_f32_16x16x32_bf16 v[132:135], v[176:179], a[32:35], 0
  ds_read_b128 v[216:219], v3 offset:16384
  s_add_u32 s51, s59, 32768
  s_waitcnt vmcnt(6) lgkmcnt(9)
  v_mfma_f32_16x16x32_bf16 v[132:135], v[180:183], a[36:39], v[132:135]
  s_waitcnt lgkmcnt(7)
  ds_read_b128 v[220:223], v3 offset:23552
  buffer_load_dwordx4 a[64:67], v3, s[28:31], s51 offen sc1
  s_waitcnt vmcnt(6)
  v_mfma_f32_16x16x32_bf16 v[132:135], v[184:187], a[40:43], v[132:135]
  ds_read_b128 v[176:179], v3 offset:3072
  s_waitcnt vmcnt(5)
  v_mfma_f32_16x16x32_bf16 v[132:135], v[188:191], a[44:47], v[132:135]
  s_waitcnt lgkmcnt(7)
  ds_read_b128 v[180:183], v3 offset:10240
  v_mfma_f32_16x16x32_bf16 v[136:139], v[192:195], a[32:35], 0
  ds_read_b128 v[184:187], v3 offset:17408
  s_add_u32 s51, s59, 36864
  v_mfma_f32_16x16x32_bf16 v[136:139], v[196:199], a[36:39], v[136:139]
  s_waitcnt lgkmcnt(7)
  ds_read_b128 v[188:191], v3 offset:24576
  buffer_load_dwordx4 a[68:71], v3, s[28:31], s51 offen sc1
  v_mfma_f32_16x16x32_bf16 v[136:139], v[200:203], a[40:43], v[136:139]
  ds_read_b128 v[192:195], v3 offset:4096
  v_mfma_f32_16x16x32_bf16 v[136:139], v[204:207], a[44:47], v[136:139]
  s_waitcnt lgkmcnt(7)
  ds_read_b128 v[196:199], v3 offset:11264
  v_mfma_f32_16x16x32_bf16 v[140:143], v[208:211], a[32:35], 0
  ds_read_b128 v[200:203], v3 offset:18432
  s_add_u32 s51, s59, 40960
  v_mfma_f32_16x16x32_bf16 v[140:143], v[212:215], a[36:39], v[140:143]
  s_waitcnt lgkmcnt(7)
  ds_read_b128 v[204:207], v3 offset:25600
  buffer_load_dwordx4 a[72:75], v3, s[28:31], s51 offen sc1
  v_mfma_f32_16x16x32_bf16 v[140:143], v[216:219], a[40:43], v[140:143]
  ds_read_b128 v[208:211], v3 offset:5120
  v_mfma_f32_16x16x32_bf16 v[140:143], v[220:223], a[44:47], v[140:143]
  s_waitcnt lgkmcnt(7)
  ds_read_b128 v[212:215], v3 offset:12288
  v_mfma_f32_16x16x32_bf16 v[144:147], v[176:179], a[32:35], 0
  ds_read_b128 v[216:219], v3 offset:19456
  s_add_u32 s51, s59, 45056
  v_mfma_f32_16x16x32_bf16 v[144:147], v[180:183], a[36:39], v[144:147]
  s_waitcnt lgkmcnt(7)
  ds_read_b128 v[220:223], v3 offset:26624
  buffer_load_dwordx4 a[76:79], v3, s[28:31], s51 offen sc1
  v_mfma_f32_16x16x32_bf16 v[144:147], v[184:187], a[40:43], v[144:147]
  ds_read_b128 v[176:179], v3 offset:6144
  v_mfma_f32_16x16x32_bf16 v[144:147], v[188:191], a[44:47], v[144:147]
  s_waitcnt lgkmcnt(7)
  ds_read_b128 v[180:183], v3 offset:13312
  v_mfma_f32_16x16x32_bf16 v[148:151], v[192:195], a[32:35], 0
  ds_read_b128 v[184:187], v3 offset:20480
  s_add_u32 s51, s59, 49152
  v_mfma_f32_16x16x32_bf16 v[148:151], v[196:199], a[36:39], v[148:151]
  s_waitcnt lgkmcnt(7)
  ds_read_b128 v[188:191], v3 offset:27648
  buffer_load_dwordx4 a[0:3], v3, s[28:31], s51 offen sc1
  v_mfma_f32_16x16x32_bf16 v[148:151], v[200:203], a[40:43], v[148:151]
  ds_read_b128 v[192:195], v3 offset:28672
  v_mfma_f32_16x16x32_bf16 v[148:151], v[204:207], a[44:47], v[148:151]
  s_waitcnt lgkmcnt(7)
  ds_read_b128 v[196:199], v3 offset:35840
  v_mfma_f32_16x16x32_bf16 v[152:155], v[208:211], a[32:35], 0
  ds_read_b128 v[200:203], v3 offset:43008
  s_add_u32 s51, s59, 53248
  v_mfma_f32_16x16x32_bf16 v[152:155], v[212:215], a[36:39], v[152:155]
  s_waitcnt lgkmcnt(7)
  ds_read_b128 v[204:207], v3 offset:50176
  buffer_load_dwordx4 a[4:7], v3, s[28:31], s51 offen sc1
  v_mfma_f32_16x16x32_bf16 v[152:155], v[216:219], a[40:43], v[152:155]
  ds_read_b128 v[208:211], v3 offset:29696
  v_mfma_f32_16x16x32_bf16 v[152:155], v[220:223], a[44:47], v[152:155]
  s_waitcnt lgkmcnt(7)
  ds_read_b128 v[212:215], v3 offset:36864
  v_mfma_f32_16x16x32_bf16 v[156:159], v[176:179], a[32:35], 0
  ds_read_b128 v[216:219], v3 offset:44032
  s_add_u32 s51, s59, 57344
  v_mfma_f32_16x16x32_bf16 v[156:159], v[180:183], a[36:39], v[156:159]
  s_waitcnt lgkmcnt(7)
  ds_read_b128 v[220:223], v3 offset:51200
  buffer_load_dwordx4 a[8:11], v3, s[28:31], s51 offen sc1
  v_mfma_f32_16x16x32_bf16 v[156:159], v[184:187], a[40:43], v[156:159]
  ds_read_b128 v[176:179], v3 offset:30720
  v_mfma_f32_16x16x32_bf16 v[156:159], v[188:191], a[44:47], v[156:159]
  s_waitcnt lgkmcnt(7)
  ds_read_b128 v[180:183], v3 offset:37888
  s_waitcnt vmcnt(10)
  v_mfma_f32_16x16x32_bf16 v[132:135], v[192:195], a[48:51], v[132:135]
  ds_read_b128 v[184:187], v3 offset:45056
  s_add_u32 s51, s59, 61440
  s_waitcnt vmcnt(9)
  v_mfma_f32_16x16x32_bf16 v[132:135], v[196:199], a[52:55], v[132:135]
  s_waitcnt lgkmcnt(7)
  ds_read_b128 v[188:191], v3 offset:52224
  buffer_load_dwordx4 a[12:15], v3, s[28:31], s51 offen sc1
  s_waitcnt vmcnt(9)
  v_mfma_f32_16x16x32_bf16 v[132:135], v[200:203], a[56:59], v[132:135]
  ds_read_b128 v[192:195], v3 offset:31744
  s_waitcnt vmcnt(8)
  v_mfma_f32_16x16x32_bf16 v[132:135], v[204:207], a[60:63], v[132:135]
  s_waitcnt lgkmcnt(7)
  ds_read_b128 v[196:199], v3 offset:38912
  v_mfma_f32_16x16x32_bf16 v[136:139], v[208:211], a[48:51], v[136:139]
  ds_read_b128 v[200:203], v3 offset:46080
  s_add_u32 s51, s59, 65536
  v_mfma_f32_16x16x32_bf16 v[136:139], v[212:215], a[52:55], v[136:139]
  s_waitcnt lgkmcnt(7)
  ds_read_b128 v[204:207], v3 offset:53248
  buffer_load_dwordx4 a[16:19], v3, s[28:31], s51 offen sc1
  v_mfma_f32_16x16x32_bf16 v[136:139], v[216:219], a[56:59], v[136:139]
  ds_read_b128 v[208:211], v3 offset:32768
  v_mfma_f32_16x16x32_bf16 v[136:139], v[220:223], a[60:63], v[136:139]
  s_waitcnt lgkmcnt(7)
  ds_read_b128 v[212:215], v3 offset:39936
  v_mfma_f32_16x16x32_bf16 v[140:143], v[176:179], a[48:51], v[140:143]
  ds_read_b128 v[216:219], v3 offset:47104
  s_add_u32 s51, s59, 69632
  v_mfma_f32_16x16x32_bf16 v[140:143], v[180:183], a[52:55], v[140:143]
  s_waitcnt lgkmcnt(7)
  ds_read_b128 v[220:223], v3 offset:54272
  buffer_load_dwordx4 a[20:23], v3, s[28:31], s51 offen sc1
  v_mfma_f32_16x16x32_bf16 v[140:143], v[184:187], a[56:59], v[140:143]
  ds_read_b128 v[176:179], v3 offset:33792
  v_mfma_f32_16x16x32_bf16 v[140:143], v[188:191], a[60:63], v[140:143]
  s_waitcnt lgkmcnt(7)
  ds_read_b128 v[180:183], v3 offset:40960
  v_mfma_f32_16x16x32_bf16 v[144:147], v[192:195], a[48:51], v[144:147]
  ds_read_b128 v[184:187], v3 offset:48128
  s_add_u32 s51, s59, 73728
  v_mfma_f32_16x16x32_bf16 v[144:147], v[196:199], a[52:55], v[144:147]
  s_waitcnt lgkmcnt(7)
  ds_read_b128 v[188:191], v3 offset:55296
  buffer_load_dwordx4 a[24:27], v3, s[28:31], s51 offen sc1
  v_mfma_f32_16x16x32_bf16 v[144:147], v[200:203], a[56:59], v[144:147]
  ds_read_b128 v[192:195], v3 offset:34816
  v_mfma_f32_16x16x32_bf16 v[144:147], v[204:207], a[60:63], v[144:147]
  s_waitcnt lgkmcnt(7)
  ds_read_b128 v[196:199], v3 offset:41984
  v_mfma_f32_16x16x32_bf16 v[148:151], v[208:211], a[48:51], v[148:151]
  ds_read_b128 v[200:203], v3 offset:49152
  s_add_u32 s51, s59, 77824
  v_mfma_f32_16x16x32_bf16 v[148:151], v[212:215], a[52:55], v[148:151]
  s_waitcnt lgkmcnt(7)
  ds_read_b128 v[204:207], v3 offset:56320
  buffer_load_dwordx4 a[28:31], v3, s[28:31], s51 offen sc1
  v_mfma_f32_16x16x32_bf16 v[148:151], v[216:219], a[56:59], v[148:151]
  ds_read_b128 v[208:211], v3 offset:57344
  v_mfma_f32_16x16x32_bf16 v[148:151], v[220:223], a[60:63], v[148:151]
  s_waitcnt lgkmcnt(7)
  ds_read_b128 v[212:215], v3 offset:64512
  v_mfma_f32_16x16x32_bf16 v[152:155], v[176:179], a[48:51], v[152:155]
  ds_read_b128 v[216:219], v8 offset:6144
  s_add_u32 s66, s63, 65536
  v_mfma_f32_16x16x32_bf16 v[152:155], v[180:183], a[52:55], v[152:155]
  s_waitcnt lgkmcnt(7)
  ds_read_b128 v[220:223], v8 offset:13312
  buffer_load_dwordx4 v[160:163], v37, s[28:31], s66 offen sc1
  v_mfma_f32_16x16x32_bf16 v[152:155], v[184:187], a[56:59], v[152:155]
  ds_read_b128 v[176:179], v3 offset:58368
  v_mfma_f32_16x16x32_bf16 v[152:155], v[188:191], a[60:63], v[152:155]
  s_waitcnt lgkmcnt(7)
  ds_read_b128 v[180:183], v8 offset:0
  v_mfma_f32_16x16x32_bf16 v[156:159], v[192:195], a[48:51], v[156:159]
  ds_read_b128 v[184:187], v8 offset:7168
  v_mfma_f32_16x16x32_bf16 v[156:159], v[196:199], a[52:55], v[156:159]
  s_waitcnt lgkmcnt(7)
  ds_read_b128 v[188:191], v8 offset:14336
  v_mfma_f32_16x16x32_bf16 v[156:159], v[200:203], a[56:59], v[156:159]
  ds_read_b128 v[192:195], v3 offset:59392
  v_mfma_f32_16x16x32_bf16 v[156:159], v[204:207], a[60:63], v[156:159]
  s_waitcnt lgkmcnt(7)
  ds_read_b128 v[196:199], v8 offset:1024
  s_waitcnt vmcnt(12)
  v_mfma_f32_16x16x32_bf16 v[132:135], v[208:211], a[64:67], v[132:135]
  ds_read_b128 v[200:203], v8 offset:8192
  s_waitcnt vmcnt(11)
  v_mfma_f32_16x16x32_bf16 v[132:135], v[212:215], a[68:71], v[132:135]
  s_waitcnt lgkmcnt(7)
  s_barrier
  ds_read_b128 v[204:207], v8 offset:15360
  s_waitcnt vmcnt(10)
  v_mfma_f32_16x16x32_bf16 v[132:135], v[216:219], a[72:75], v[132:135]
HS32:
  s_cbranch_execz HS36
  ds_read_b128 v[208:211], v3 offset:60416
  s_add_u32 s52, s60, 0
  s_add_u32 m0, s76, 0
  s_waitcnt vmcnt(9)
  v_mfma_f32_16x16x32_bf16 v[132:135], v[220:223], a[76:79], v[132:135]
  s_waitcnt lgkmcnt(7)
  ds_read_b128 v[212:215], v8 offset:2048
  buffer_load_dwordx4 v4, s[28:31], s52 offen offset:0 sc1 lds
  v_mfma_f32_16x16x32_bf16 v[136:139], v[176:179], a[64:67], v[136:139]
  ds_read_b128 v[216:219], v8 offset:9216
  v_mfma_f32_16x16x32_bf16 v[136:139], v[180:183], a[68:71], v[136:139]
  s_waitcnt lgkmcnt(7)
  ds_read_b128 v[220:223], v8 offset:16384
  v_mfma_f32_16x16x32_bf16 v[136:139], v[184:187], a[72:75], v[136:139]
  ds_read_b128 v[176:179], v3 offset:61440
  v_mfma_f32_16x16x32_bf16 v[136:139], v[188:191], a[76:79], v[136:139]
  s_waitcnt lgkmcnt(7)
  ds_read_b128 v[180:183], v8 offset:3072
  v_mfma_f32_16x16x32_bf16 v[140:143], v[192:195], a[64:67], v[140:143]
  ds_read_b128 v[184:187], v8 offset:10240
  buffer_load_dwordx4 v4, s[28:31], s52 offen offset:1024 sc1 lds
  v_mfma_f32_16x16x32_bf16 v[140:143], v[196:199], a[68:71], v[140:143]
  s_waitcnt lgkmcnt(7)
  ds_read_b128 v[188:191], v8 offset:17408
  v_mfma_f32_16x16x32_bf16 v[140:143], v[200:203], a[72:75], v[140:143]
  ds_read_b128 v[192:195], v3 offset:62464
  v_mfma_f32_16x16x32_bf16 v[140:143], v[204:207], a[76:79], v[140:143]
  s_waitcnt lgkmcnt(7)
  ds_read_b128 v[196:199], v8 offset:4096
  v_mfma_f32_16x16x32_bf16 v[144:147], v[208:211], a[64:67], v[144:147]
  ds_read_b128 v[200:203], v8 offset:11264
  v_mfma_f32_16x16x32_bf16 v[144:147], v[212:215], a[68:71], v[144:147]
  s_waitcnt lgkmcnt(7)
  ds_read_b128 v[204:207], v8 offset:18432
  buffer_load_dwordx4 v4, s[28:31], s52 offen offset:2048 sc1 lds
  v_mfma_f32_16x16x32_bf16 v[144:147], v[216:219], a[72:75], v[144:147]
  ds_read_b128 v[208:211], v3 offset:63488
  v_mfma_f32_16x16x32_bf16 v[144:147], v[220:223], a[76:79], v[144:147]
  s_waitcnt lgkmcnt(7)
  ds_read_b128 v[212:215], v8 offset:5120
  v_mfma_f32_16x16x32_bf16 v[148:151], v[176:179], a[64:67], v[148:151]
  ds_read_b128 v[216:219], v8 offset:12288
  v_mfma_f32_16x16x32_bf16 v[148:151], v[180:183], a[68:71], v[148:151]
  s_waitcnt lgkmcnt(7)
  ds_read_b128 v[220:223], v8 offset:19456
  v_mfma_f32_16x16x32_bf16 v[148:151], v[184:187], a[72:75], v[148:151]
  ds_read_b128 v[176:179], v8 offset:20480
  buffer_load_dwordx4 v4, s[28:31], s52 offen offset:3072 sc1 lds
  v_mfma_f32_16x16x32_bf16 v[148:151], v[188:191], a[76:79], v[148:151]
  s_waitcnt lgkmcnt(7)
  ds_read_b128 v[180:183], v8 offset:27648
  v_mfma_f32_16x16x32_bf16 v[152:155], v[192:195], a[64:67], v[152:155]
  ds_read_b128 v[184:187], v8 offset:34816
  v_mfma_f32_16x16x32_bf16 v[152:155], v[196:199], a[68:71], v[152:155]
  s_waitcnt lgkmcnt(7)
  ds_read_b128 v[188:191], v8 offset:41984
  v_mfma_f32_16x16x32_bf16 v[152:155], v[200:203], a[72:75], v[152:155]
  ds_read_b128 v[192:195], v8 offset:21504
  s_add_u32 m0, s76, 4096
  v_mfma_f32_16x16x32_bf16 v[152:155], v[204:207], a[76:79], v[152:155]
  s_waitcnt lgkmcnt(7)
  ds_read_b128 v[196:199], v8 offset:28672
  buffer_load_dwordx4 v5, s[28:31], s52 offen offset:0 sc1 lds
  v_mfma_f32_16x16x32_bf16 v[156:159], v[208:211], a[64:67], v[156:159]
  ds_read_b128 v[200:203], v8 offset:35840
  v_mfma_f32_16x16x32_bf16 v[156:159], v[212:215], a[68:71], v[156:159]
  s_waitcnt lgkmcnt(7)
  ds_read_b128 v[204:207], v8 offset:43008
  v_mfma_f32_16x16x32_bf16 v[156:159], v[216:219], a[72:75], v[156:159]
  ds_read_b128 v[208:211], v8 offset:22528
  v_mfma_f32_16x16x32_bf16 v[156:159], v[220:223], a[76:79], v[156:159]
  s_waitcnt lgkmcnt(7)
  ds_read_b128 v[212:215], v8 offset:29696
  s_waitcnt vmcnt(13)
  v_mfma_f32_16x16x32_bf16 v[132:135], v[176:179], a[0:3], v[132:135]
  ds_read_b128 v[216:219], v8 offset:36864
  buffer_load_dwordx4 v5, s[28:31], s52 offen offset:1024 sc1 lds
  s_waitcnt vmcnt(13)
  v_mfma_f32_16x16x32_bf16 v[132:135], v[180:183], a[4:7], v[132:135]
  s_waitcnt lgkmcnt(7)
  ds_read_b128 v[220:223], v8 offset:44032
  s_waitcnt vmcnt(12)
  v_mfma_f32_16x16x32_bf16 v[132:135], v[184:187], a[8:11], v[132:135]
  ds_read_b128 v[176:179], v8 offset:23552
  s_waitcnt vmcnt(11)
  v_mfma_f32_16x16x32_bf16 v[132:135], v[188:191], a[12:15], v[132:135]
  s_waitcnt lgkmcnt(7)
  ds_read_b128 v[180:183], v8 offset:30720
  v_mfma_f32_16x16x32_bf16 v[136:139], v[192:195], a[0:3], v[136:139]
  ds_read_b128 v[184:187], v8 offset:37888
  s_add_u32 m0, s76, 6144
  v_mfma_f32_16x16x32_bf16 v[136:139], v[196:199], a[4:7], v[136:139]
  s_waitcnt lgkmcnt(7)
  ds_read_b128 v[188:191], v8 offset:45056
  buffer_load_dwordx4 v7, s[28:31], s52 offen offset:0 sc1 lds
  v_mfma_f32_16x16x32_bf16 v[136:139], v[200:203], a[8:11], v[136:139]
  ds_read_b128 v[192:195], v8 offset:24576
  v_mfma_f32_16x16x32_bf16 v[136:139], v[204:207], a[12:15], v[136:139]
  s_waitcnt lgkmcnt(7)
  ds_read_b128 v[196:199], v8 offset:31744
  v_mfma_f32_16x16x32_bf16 v[140:143], v[208:211], a[0:3], v[140:143]
  ds_read_b128 v[200:203], v8 offset:38912
  v_mfma_f32_16x16x32_bf16 v[140:143], v[212:215], a[4:7], v[140:143]
  s_waitcnt lgkmcnt(7)
  ds_read_b128 v[204:207], v8 offset:46080
  s_add_u32 s52, s60, 442368
  s_add_u32 m0, s76, 28672
  v_mfma_f32_16x16x32_bf16 v[140:143], v[216:219], a[8:11], v[140:143]
  ds_read_b128 v[208:211], v8 offset:25600
  buffer_load_dwordx4 v4, s[28:31], s52 offen offset:0 sc1 lds
  v_mfma_f32_16x16x32_bf16 v[140:143], v[220:223], a[12:15], v[140:143]
  s_waitcnt lgkmcnt(7)
  ds_read_b128 v[212:215], v8 offset:32768
  v_mfma_f32_16x16x32_bf16 v[144:147], v[176:179], a[0:3], v[144:147]
  ds_read_b128 v[216:219], v8 offset:39936
  v_mfma_f32_16x16x32_bf16 v[144:147], v[180:183], a[4:7], v[144:147]
  s_waitcnt lgkmcnt(7)
  ds_read_b128 v[220:223], v8 offset:47104
  v_mfma_f32_16x16x32_bf16 v[144:147], v[184:187], a[8:11], v[144:147]
  ds_read_b128 v[176:179], v8 offset:26624
  v_mfma_f32_16x16x32_bf16 v[144:147], v[188:191], a[12:15], v[144:147]
  s_waitcnt lgkmcnt(7)
  ds_read_b128 v[180:183], v8 offset:33792
  buffer_load_dwordx4 v4, s[28:31], s52 offen offset:1024 sc1 lds
  v_mfma_f32_16x16x32_bf16 v[148:151], v[192:195], a[0:3], v[148:151]
  ds_read_b128 v[184:187], v8 offset:40960
  v_mfma_f32_16x16x32_bf16 v[148:151], v[196:199], a[4:7], v[148:151]
  s_waitcnt lgkmcnt(7)
  ds_read_b128 v[188:191], v8 offset:48128
  v_mfma_f32_16x16x32_bf16 v[148:151], v[200:203], a[8:11], v[148:151]
  ds_read_b128 v[192:195], v8 offset:49152
  v_mfma_f32_16x16x32_bf16 v[148:151], v[204:207], a[12:15], v[148:151]
  s_waitcnt lgkmcnt(7)
  ds_read_b128 v[196:199], v8 offset:56320
  v_mfma_f32_16x16x32_bf16 v[152:155], v[208:211], a[0:3], v[152:155]
  ds_read_b128 v[200:203], v8 offset:63488
  buffer_load_dwordx4 v4, s[28:31], s52 offen offset:2048 sc1 lds
  v_mfma_f32_16x16x32_bf16 v[152:155], v[212:215], a[4:7], v[152:155]
  s_waitcnt lgkmcnt(7)
  ds_read_b128 v[204:207], v9 offset:5120
  v_mfma_f32_16x16x32_bf16 v[152:155], v[216:219], a[8:11], v[152:155]
  ds_read_b128 v[208:211], v8 offset:50176
  v_mfma_f32_16x16x32_bf16 v[152:155], v[220:223], a[12:15], v[152:155]
  s_waitcnt lgkmcnt(7)
  ds_read_b128 v[212:215], v8 offset:57344
  v_mfma_f32_16x16x32_bf16 v[156:159], v[176:179], a[0:3], v[156:159]
  ds_read_b128 v[216:219], v8 offset:64512
  v_mfma_f32_16x16x32_bf16 v[156:159], v[180:183], a[4:7], v[156:159]
  s_waitcnt lgkmcnt(7)
  ds_read_b128 v[220:223], v9 offset:6144
  buffer_load_dwordx4 v4, s[28:31], s52 offen offset:3072 sc1 lds
  v_mfma_f32_16x16x32_bf16 v[156:159], v[184:187], a[8:11], v[156:159]
  ds_read_b128 v[176:179], v8 offset:51200
  v_mfma_f32_16x16x32_bf16 v[156:159], v[188:191], a[12:15], v[156:159]
  s_waitcnt lgkmcnt(7)
  ds_read_b128 v[180:183], v8 offset:58368
  s_waitcnt vmcnt(15)
  v_mfma_f32_16x16x32_bf16 v[132:135], v[192:195], a[16:19], v[132:135]
  ds_read_b128 v[184:187], v9 offset:0
  s_waitcnt vmcnt(14)
  v_mfma_f32_16x16x32_bf16 v[132:135], v[196:199], a[20:23], v[132:135]
  s_waitcnt lgkmcnt(7)
  ds_read_b128 v[188:191], v9 offset:7168
  s_add_u32 m0, s76, 32768
  s_waitcnt vmcnt(13)
  v_mfma_f32_16x16x32_bf16 v[132:135], v[200:203], a[24:27], v[132:135]
  ds_read_b128 v[192:195], v8 offset:52224
  buffer_load_dwordx4 v5, s[28:31], s52 offen offset:0 sc1 lds
  s_waitcnt vmcnt(13)
  v_mfma_f32_16x16x32_bf16 v[132:135], v[204:207], a[28:31], v[132:135]
  s_waitcnt lgkmcnt(7)
  ds_read_b128 v[196:199], v8 offset:59392
  v_mfma_f32_16x16x32_bf16 v[136:139], v[208:211], a[16:19], v[136:139]
  ds_read_b128 v[200:203], v9 offset:1024
  v_mfma_f32_16x16x32_bf16 v[136:139], v[212:215], a[20:23], v[136:139]
  s_waitcnt lgkmcnt(7)
  ds_read_b128 v[204:207], v9 offset:8192
  v_mfma_f32_16x16x32_bf16 v[136:139], v[216:219], a[24:27], v[136:139]
  ds_read_b128 v[208:211], v8 offset:53248
  v_mfma_f32_16x16x32_bf16 v[136:139], v[220:223], a[28:31], v[136:139]
  s_waitcnt lgkmcnt(7)
  ds_read_b128 v[212:215], v8 offset:60416
  buffer_load_dwordx4 v5, s[28:31], s52 offen offset:1024 sc1 lds
  v_mfma_f32_16x16x32_bf16 v[140:143], v[176:179], a[16:19], v[140:143]
  ds_read_b128 v[216:219], v9 offset:2048
  v_mfma_f32_16x16x32_bf16 v[140:143], v[180:183], a[20:23], v[140:143]
  s_waitcnt lgkmcnt(7)
  ds_read_b128 v[220:223], v9 offset:9216
  v_mfma_f32_16x16x32_bf16 v[140:143], v[184:187], a[24:27], v[140:143]
  ds_read_b128 v[176:179], v8 offset:54272
  ds_read_b128 v[76:79], v38 offset:2048
  v_mfma_f32_16x16x32_bf16 v[140:143], v[188:191], a[28:31], v[140:143]
  s_waitcnt lgkmcnt(8)
  ds_read_b128 v[180:183], v8 offset:61440
  s_add_u32 m0, s76, 34816
  ds_read_b128 v[104:107], v38 offset:2496
  v_mfma_f32_16x16x32_bf16 v[144:147], v[192:195], a[16:19], v[144:147]
  ds_read_b128 v[184:187], v9 offset:3072
  buffer_load_dwordx4 v7, s[28:31], s52 offen offset:0 sc1 lds
  ds_read_b128 v[80:83], v38 offset:2112
  v_mfma_f32_16x16x32_bf16 v[144:147], v[196:199], a[20:23], v[144:147]
  s_waitcnt lgkmcnt(10)
  ds_read_b128 v[188:191], v9 offset:10240
  ds_read_b128 v[108:111], v38 offset:2560
  v_mfma_f32_16x16x32_bf16 v[144:147], v[200:203], a[24:27], v[144:147]
  ds_read_b128 v[192:195], v8 offset:55296
  ds_read_b128 v[84:87], v38 offset:2176
  v_mfma_f32_16x16x32_bf16 v[144:147], v[204:207], a[28:31], v[144:147]
  s_waitcnt lgkmcnt(12)
  ds_read_b128 v[196:199], v8 offset:62464
  ds_read_b128 v[112:115], v38 offset:2624
  v_mfma_f32_16x16x32_bf16 v[148:151], v[208:211], a[16:19], v[148:151]
  ds_read_b128 v[200:203], v9 offset:4096
  ds_read_b128 v[88:91], v38 offset:2240
  v_mfma_f32_16x16x32_bf16 v[148:151], v[212:215], a[20:23], v[148:151]
  s_waitcnt lgkmcnt(14)
  ds_read_b128 v[204:207], v9 offset:11264
  ds_read_b128 v[116:119], v38 offset:2688
  v_mfma_f32_16x16x32_bf16 v[148:151], v[216:219], a[24:27], v[148:151]
  ds_read_b128 v[92:95], v38 offset:2304
  v_mfma_f32_16x16x32_bf16 v[148:151], v[220:223], a[28:31], v[148:151]
  s_waitcnt lgkmcnt(14)
  ds_read_b128 v[120:123], v38 offset:2752
  v_mfma_f32_16x16x32_bf16 v[152:155], v[176:179], a[16:19], v[152:155]
  ds_read_b128 v[96:99], v38 offset:2368
  v_mfma_f32_16x16x32_bf16 v[152:155], v[180:183], a[20:23], v[152:155]
  s_waitcnt lgkmcnt(12)
  ds_read_b128 v[124:127], v38 offset:2816
  v_mfma_f32_16x16x32_bf16 v[152:155], v[184:187], a[24:27], v[152:155]
  ds_read_b128 v[100:103], v38 offset:2432
  v_mfma_f32_16x16x32_bf16 v[152:155], v[188:191], a[28:31], v[152:155]
  s_waitcnt lgkmcnt(10)
  ds_read_b128 v[128:131], v38 offset:2880
  v_mfma_f32_16x16x32_bf16 v[156:159], v[192:195], a[16:19], v[156:159]
  v_mfma_f32_16x16x32_bf16 v[156:159], v[196:199], a[20:23], v[156:159]
  s_waitcnt lgkmcnt(7)
  v_mfma_f32_16x16x32_bf16 v[156:159], v[200:203], a[24:27], v[156:159]
  v_mfma_f32_16x16x32_bf16 v[156:159], v[204:207], a[28:31], v[156:159]
  s_barrier
  s_waitcnt vmcnt(14)
  v_cmp_gt_f32 vcc, 0, v161
  v_cmp_gt_f32 s[72:73], 0, v163
  s_nop 0
  s_or_b64 vcc, vcc, s[72:73]
  s_cbranch_vccnz L_t_p1_w
L_t_p1_ok:
  v_pk_add_f32 v[160:161], v[160:161], v[162:163]
  v_mov_b32 v164, v160
  s_nop 1
  v_permlane16_swap_b32 v160, v164
  v_add_f32 v160, v160, v164
  v_mov_b32 v164, v160
  s_nop 1
  v_permlane32_swap_b32 v160, v164
  v_add_f32 v160, v160, v164
  v_mov_b32 v165, v161
  s_nop 1
  v_permlane16_swap_b32 v161, v165
  s_add_u32 s52, s60, 884736
  s_add_u32 m0, s76, 57344
  s_nop 0
  buffer_load_dwordx4 v4, s[28:31], s52 offen offset:0 sc1 lds
  v_add_f32 v161, v161, v165
  v_mov_b32 v165, v161
  s_nop 1
  v_permlane32_swap_b32 v161, v165
  v_add_f32 v161, v161, v165
  v_mul_f32 v160, 0xbacccccd, v160
  v_mov_b32 v162, 0x3727c5ac
  v_fmac_f32 v162, 0x3acccccd, v161
  v_fma_f32 v162, -v160, v160, v162
  v_max_f32 v162, 0x3727c5ac, v162
  buffer_load_dwordx4 v4, s[28:31], s52 offen offset:1024 sc1 lds
  v_rsq_f32 v162, v162
  v_pk_fma_f32 v[132:133], v[76:77], v[160:161], v[132:133] op_sel_hi:[1,0,1]
  v_pk_fma_f32 v[134:135], v[78:79], v[160:161], v[134:135] op_sel_hi:[1,0,1]
  v_pk_fma_f32 v[136:137], v[80:81], v[160:161], v[136:137] op_sel_hi:[1,0,1]
  v_pk_fma_f32 v[138:139], v[82:83], v[160:161], v[138:139] op_sel_hi:[1,0,1]
  v_pk_fma_f32 v[140:141], v[84:85], v[160:161], v[140:141] op_sel_hi:[1,0,1]
  v_pk_fma_f32 v[142:143], v[86:87], v[160:161], v[142:143] op_sel_hi:[1,0,1]
  v_pk_fma_f32 v[144:145], v[88:89], v[160:161], v[144:145] op_sel_hi:[1,0,1]
  v_pk_fma_f32 v[146:147], v[90:91], v[160:161], v[146:147] op_sel_hi:[1,0,1]
  buffer_load_dwordx4 v4, s[28:31], s52 offen offset:2048 sc1 lds
  s_waitcnt lgkmcnt(5)
  v_pk_fma_f32 v[148:149], v[92:93], v[160:161], v[148:149] op_sel_hi:[1,0,1]
  v_pk_fma_f32 v[150:151], v[94:95], v[160:161], v[150:151] op_sel_hi:[1,0,1]
  s_waitcnt lgkmcnt(3)
  v_pk_fma_f32 v[152:153], v[96:97], v[160:161], v[152:153] op_sel_hi:[1,0,1]
  v_pk_fma_f32 v[154:155], v[98:99], v[160:161], v[154:155] op_sel_hi:[1,0,1]
  s_waitcnt lgkmcnt(1)
  v_pk_fma_f32 v[156:157], v[100:101], v[160:161], v[156:157] op_sel_hi:[1,0,1]
  v_pk_fma_f32 v[158:159], v[102:103], v[160:161], v[158:159] op_sel_hi:[1,0,1]
  v_pk_fma_f32 v[132:133], v[132:133], v[162:163], v[104:105] op_sel_hi:[1,0,1]
  v_pk_fma_f32 v[134:135], v[134:135], v[162:163], v[106:107] op_sel_hi:[1,0,1]
  v_pk_fma_f32 v[136:137], v[136:137], v[162:163], v[108:109] op_sel_hi:[1,0,1]
  buffer_load_dwordx4 v4, s[28:31], s52 offen offset:3072 sc1 lds
  v_pk_fma_f32 v[138:139], v[138:139], v[162:163], v[110:111] op_sel_hi:[1,0,1]
  v_pk_fma_f32 v[140:141], v[140:141], v[162:163], v[112:113] op_sel_hi:[1,0,1]
  v_pk_fma_f32 v[142:143], v[142:143], v[162:163], v[114:115] op_sel_hi:[1,0,1]
  v_pk_fma_f32 v[144:145], v[144:145], v[162:163], v[116:117] op_sel_hi:[1,0,1]
  v_pk_fma_f32 v[146:147], v[146:147], v[162:163], v[118:119] op_sel_hi:[1,0,1]
  v_pk_fma_f32 v[148:149], v[148:149], v[162:163], v[120:121] op_sel_hi:[1,0,1]
  v_pk_fma_f32 v[150:151], v[150:151], v[162:163], v[122:123] op_sel_hi:[1,0,1]
  v_pk_fma_f32 v[152:153], v[152:153], v[162:163], v[124:125] op_sel_hi:[1,0,1]
  v_pk_fma_f32 v[154:155], v[154:155], v[162:163], v[126:127] op_sel_hi:[1,0,1]
  s_add_u32 m0, s76, 61440
  s_nop 0
  buffer_load_dwordx4 v5, s[28:31], s52 offen offset:0 sc1 lds
  v_pk_fma_f32 v[156:157], v[156:157], v[162:163], v[128:129] op_sel_hi:[1,0,1]
  v_pk_fma_f32 v[158:159], v[158:159], v[162:163], v[130:131] op_sel_hi:[1,0,1]
  v_pk_mul_f32 v[104:105], v[132:133], v[132:133]
  v_pk_mul_f32 v[106:107], v[134:135], v[134:135]
  v_pk_mul_f32 v[108:109], v[136:137], v[136:137]
  v_pk_mul_f32 v[110:111], v[138:139], v[138:139]
  v_pk_mul_f32 v[112:113], v[140:141], v[140:141]
  v_pk_mul_f32 v[114:115], v[142:143], v[142:143]
  v_pk_mul_f32 v[116:117], v[144:145], v[144:145]
  buffer_load_dwordx4 v5, s[28:31], s52 offen offset:1024 sc1 lds
  v_pk_mul_f32 v[118:119], v[146:147], v[146:147]
  v_pk_mul_f32 v[120:121], v[148:149], v[148:149]
  v_pk_mul_f32 v[122:123], v[150:151], v[150:151]
  v_pk_mul_f32 v[124:125], v[152:153], v[152:153]
  v_pk_mul_f32 v[126:127], v[154:155], v[154:155]
  s_waitcnt lgkmcnt(0)
  v_pk_mul_f32 v[128:129], v[156:157], v[156:157]
  v_pk_mul_f32 v[130:131], v[158:159], v[158:159]
  v_pk_fma_f32 v[104:105], v[104:105], v[46:47], v[44:45]
  v_pk_fma_f32 v[106:107], v[106:107], v[46:47], v[44:45]
  s_add_u32 m0, s76, 63488
  s_nop 0
  buffer_load_dwordx4 v7, s[28:31], s52 offen offset:0 sc1 lds
  v_pk_fma_f32 v[108:109], v[108:109], v[46:47], v[44:45]
  v_pk_fma_f32 v[110:111], v[110:111], v[46:47], v[44:45]
  v_pk_fma_f32 v[112:113], v[112:113], v[46:47], v[44:45]
  v_pk_fma_f32 v[114:115], v[114:115], v[46:47], v[44:45]
  v_pk_fma_f32 v[116:117], v[116:117], v[46:47], v[44:45]
  v_pk_fma_f32 v[118:119], v[118:119], v[46:47], v[44:45]
  v_pk_fma_f32 v[120:121], v[120:121], v[46:47], v[44:45]
  v_pk_fma_f32 v[122:123], v[122:123], v[46:47], v[44:45]
  v_pk_fma_f32 v[124:125], v[124:125], v[46:47], v[44:45]
  s_add_u32 s52, s60, 1327104
  s_add_u32 m0, s76, 86016
  s_nop 0
  buffer_load_dwordx4 v4, s[28:31], s52 offen offset:0 sc1 lds
  v_pk_fma_f32 v[126:127], v[126:127], v[46:47], v[44:45]
  v_pk_fma_f32 v[128:129], v[128:129], v[46:47], v[44:45]
  v_pk_fma_f32 v[130:131], v[130:131], v[46:47], v[44:45]
  v_pk_mul_f32 v[104:105], v[104:105], v[132:133]
  v_pk_mul_f32 v[106:107], v[106:107], v[134:135]
  v_pk_mul_f32 v[108:109], v[108:109], v[136:137]
  v_pk_mul_f32 v[110:111], v[110:111], v[138:139]
  v_pk_mul_f32 v[112:113], v[112:113], v[140:141]
  v_pk_mul_f32 v[114:115], v[114:115], v[142:143]
  buffer_load_dwordx4 v4, s[28:31], s52 offen offset:1024 sc1 lds
  v_pk_mul_f32 v[116:117], v[116:117], v[144:145]
  v_pk_mul_f32 v[118:119], v[118:119], v[146:147]
  v_pk_mul_f32 v[120:121], v[120:121], v[148:149]
  v_pk_mul_f32 v[122:123], v[122:123], v[150:151]
  v_pk_mul_f32 v[124:125], v[124:125], v[152:153]
  v_pk_mul_f32 v[126:127], v[126:127], v[154:155]
  v_pk_mul_f32 v[128:129], v[128:129], v[156:157]
  v_pk_mul_f32 v[130:131], v[130:131], v[158:159]
  v_exp_f32 v104, v104
  buffer_load_dwordx4 v4, s[28:31], s52 offen offset:2048 sc1 lds
  v_exp_f32 v105, v105
  v_exp_f32 v106, v106
  v_exp_f32 v107, v107
  v_exp_f32 v108, v108
  v_exp_f32 v109, v109
  v_exp_f32 v110, v110
  v_exp_f32 v111, v111
  v_exp_f32 v112, v112
  v_exp_f32 v113, v113
  buffer_load_dwordx4 v4, s[28:31], s52 offen offset:3072 sc1 lds
  v_exp_f32 v114, v114
  v_exp_f32 v115, v115
  v_exp_f32 v116, v116
  v_exp_f32 v117, v117
  v_exp_f32 v118, v118
  v_exp_f32 v119, v119
  v_exp_f32 v120, v120
  v_exp_f32 v121, v121
  v_exp_f32 v122, v122
  s_add_u32 m0, s76, 90112
  s_nop 0
  buffer_load_dwordx4 v5, s[28:31], s52 offen offset:0 sc1 lds
  v_exp_f32 v123, v123
  v_exp_f32 v124, v124
  v_exp_f32 v125, v125
  v_exp_f32 v126, v126
  v_exp_f32 v127, v127
  v_exp_f32 v128, v128
  v_exp_f32 v129, v129
  v_exp_f32 v130, v130
  v_exp_f32 v131, v131
  buffer_load_dwordx4 v5, s[28:31], s52 offen offset:1024 sc1 lds
  v_pk_add_f32 v[104:105], v[104:105], 1.0 op_sel_hi:[1,0]
  v_pk_add_f32 v[106:107], v[106:107], 1.0 op_sel_hi:[1,0]
  v_pk_add_f32 v[108:109], v[108:109], 1.0 op_sel_hi:[1,0]
  v_pk_add_f32 v[110:111], v[110:111], 1.0 op_sel_hi:[1,0]
  v_pk_add_f32 v[112:113], v[112:113], 1.0 op_sel_hi:[1,0]
  v_pk_add_f32 v[114:115], v[114:115], 1.0 op_sel_hi:[1,0]
  v_pk_add_f32 v[116:117], v[116:117], 1.0 op_sel_hi:[1,0]
  v_pk_add_f32 v[118:119], v[118:119], 1.0 op_sel_hi:[1,0]
  v_pk_add_f32 v[120:121], v[120:121], 1.0 op_sel_hi:[1,0]
  s_add_u32 m0, s76, 92160
  s_nop 0
  buffer_load_dwordx4 v7, s[28:31], s52 offen offset:0 sc1 lds
  v_pk_add_f32 v[122:123], v[122:123], 1.0 op_sel_hi:[1,0]
  v_pk_add_f32 v[124:125], v[124:125], 1.0 op_sel_hi:[1,0]
  v_pk_add_f32 v[126:127], v[126:127], 1.0 op_sel_hi:[1,0]
  v_pk_add_f32 v[128:129], v[128:129], 1.0 op_sel_hi:[1,0]
  v_pk_add_f32 v[130:131], v[130:131], 1.0 op_sel_hi:[1,0]
  v_rcp_f32 v104, v104
  v_rcp_f32 v105, v105
  v_rcp_f32 v106, v106
  v_rcp_f32 v107, v107
  s_add_u32 s52, s60, 1769472
  s_add_u32 m0, s76, 114688
  s_nop 0
  buffer_load_dwordx4 v4, s[28:31], s52 offen offset:0 sc1 lds
  v_rcp_f32 v108, v108
  v_rcp_f32 v109, v109
  v_rcp_f32 v110, v110
  v_rcp_f32 v111, v111
  v_rcp_f32 v112, v112
  v_rcp_f32 v113, v113
  v_rcp_f32 v114, v114
  v_rcp_f32 v115, v115
  v_rcp_f32 v116, v116
  buffer_load_dwordx4 v4, s[28:31], s52 offen offset:1024 sc1 lds
  v_rcp_f32 v117, v117
  v_rcp_f32 v118, v118
  v_rcp_f32 v119, v119
  v_rcp_f32 v120, v120
  v_rcp_f32 v121, v121
  v_rcp_f32 v122, v122
  v_rcp_f32 v123, v123
  v_rcp_f32 v124, v124
  v_rcp_f32 v125, v125
  buffer_load_dwordx4 v4, s[28:31], s52 offen offset:2048 sc1 lds
  v_rcp_f32 v126, v126
  v_rcp_f32 v127, v127
  v_rcp_f32 v128, v128
  v_rcp_f32 v129, v129
  v_rcp_f32 v130, v130
  v_rcp_f32 v131, v131
  v_pk_mul_f32 v[132:133], v[132:133], v[104:105]
  v_pk_mul_f32 v[134:135], v[134:135], v[106:107]
  v_pk_mul_f32 v[136:137], v[136:137], v[108:109]
  buffer_load_dwordx4 v4, s[28:31], s52 offen offset:3072 sc1 lds
  v_pk_mul_f32 v[138:139], v[138:139], v[110:111]
  v_pk_mul_f32 v[140:141], v[140:141], v[112:113]
  v_pk_mul_f32 v[142:143], v[142:143], v[114:115]
  v_pk_mul_f32 v[144:145], v[144:145], v[116:117]
  v_pk_mul_f32 v[146:147], v[146:147], v[118:119]
  v_pk_mul_f32 v[148:149], v[148:149], v[120:121]
  v_pk_mul_f32 v[150:151], v[150:151], v[122:123]
  v_pk_mul_f32 v[152:153], v[152:153], v[124:125]
  v_pk_mul_f32 v[154:155], v[154:155], v[126:127]
  s_add_u32 m0, s76, 118784
  s_nop 0
  buffer_load_dwordx4 v5, s[28:31], s52 offen offset:0 sc1 lds
  v_pk_mul_f32 v[156:157], v[156:157], v[128:129]
  v_pk_mul_f32 v[158:159], v[158:159], v[130:131]
  v_pk_add_f32 v[104:105], v[132:133], v[134:135]
  v_pk_mul_f32 v[106:107], v[132:133], v[132:133]
  v_pk_fma_f32 v[106:107], v[134:135], v[134:135], v[106:107]
  v_pk_add_f32 v[104:105], v[104:105], v[136:137]
  v_pk_fma_f32 v[106:107], v[136:137], v[136:137], v[106:107]
  v_pk_add_f32 v[104:105], v[104:105], v[138:139]
  v_pk_fma_f32 v[106:107], v[138:139], v[138:139], v[106:107]
  buffer_load_dwordx4 v5, s[28:31], s52 offen offset:1024 sc1 lds
  v_pk_add_f32 v[104:105], v[104:105], v[140:141]
  v_pk_fma_f32 v[106:107], v[140:141], v[140:141], v[106:107]
  v_pk_add_f32 v[104:105], v[104:105], v[142:143]
  v_pk_fma_f32 v[106:107], v[142:143], v[142:143], v[106:107]
  v_pk_add_f32 v[104:105], v[104:105], v[144:145]
  v_pk_fma_f32 v[106:107], v[144:145], v[144:145], v[106:107]
  v_pk_add_f32 v[104:105], v[104:105], v[146:147]
  v_pk_fma_f32 v[106:107], v[146:147], v[146:147], v[106:107]
  v_pk_add_f32 v[104:105], v[104:105], v[148:149]
  s_add_u32 m0, s76, 120832
  s_nop 0
  buffer_load_dwordx4 v7, s[28:31], s52 offen offset:0 sc1 lds
  v_pk_fma_f32 v[106:107], v[148:149], v[148:149], v[106:107]
  v_pk_add_f32 v[104:105], v[104:105], v[150:151]
  v_pk_fma_f32 v[106:107], v[150:151], v[150:151], v[106:107]
  v_pk_add_f32 v[104:105], v[104:105], v[152:153]
  v_pk_fma_f32 v[106:107], v[152:153], v[152:153], v[106:107]
  v_pk_add_f32 v[104:105], v[104:105], v[154:155]
  v_pk_fma_f32 v[106:107], v[154:155], v[154:155], v[106:107]
  v_pk_add_f32 v[104:105], v[104:105], v[156:157]
  v_pk_fma_f32 v[106:107], v[156:157], v[156:157], v[106:107]
  v_pk_add_f32 v[104:105], v[104:105], v[158:159]
  v_pk_fma_f32 v[106:107], v[158:159], v[158:159], v[106:107]
  v_add_f32 v164, v104, v105
  v_add_f32 v165, v106, v107
  v_mov_b32 v104, v164
  s_nop 1
  v_permlane16_swap_b32 v164, v104
  v_add_f32 v164, v164, v104
  v_mov_b32 v104, v164
  s_nop 1
  v_permlane32_swap_b32 v164, v104
  v_add_f32 v164, v164, v104
  v_mov_b32 v105, v165
  s_nop 1
  v_permlane16_swap_b32 v165, v105
  v_add_f32 v165, v165, v105
  v_mov_b32 v105, v165
  s_nop 1
  v_permlane32_swap_b32 v165, v105
  v_add_f32 v165, v165, v105
  s_add_u32 s51, s64, 262144
  buffer_store_dwordx2 v[164:165], v36, s[28:31], s51 offen sc1
  s_add_u32 s39, s62, 512
  s_lshl_b32 s39, s39, 7
  s_add_u32 s39, s39, 589824
  v_mov_b32 v14, 1
  buffer_atomic_add v14, v40, s[28:31], s39 offen sc0
  s_add_u32 s66, s63, 262144
  s_add_u32 s51, s20, 4096
  buffer_load_dwordx4 a[192:195], v170, s[28:31], s51 offen sc1
  buffer_load_dwordx4 a[196:199], v171, s[28:31], s51 offen sc1
  buffer_load_dwordx4 a[200:203], v172, s[28:31], s51 offen sc1
  buffer_load_dwordx4 a[204:207], v173, s[28:31], s51 offen sc1
  s_add_u32 s51, s21, 131072
  buffer_load_dwordx4 a[176:179], v170, s[28:31], s51 offen sc1
  buffer_load_dwordx4 a[180:183], v171, s[28:31], s51 offen sc1
  buffer_load_dwordx4 a[184:187], v172, s[28:31], s51 offen sc1
  buffer_load_dwordx4 a[188:191], v173, s[28:31], s51 offen sc1
  v_lshlrev_b32 v168, 5, v1
  v_lshl_add_u32 v168, v2, 3, v168
  s_lshl_b32 s51, s48, 9
  s_add_u32 s51, s51, 143360
  v_add_u32 v174, s51, v168
  s_and_b32 s51, s48, 1
  s_lshr_b32 s52, s48, 1
  s_lshl_b32 s53, s51, 10
  s_lshl_b32 s65, s52, 13
  s_add_u32 s53, s53, s65
  s_add_u32 s53, s53, 143360
  v_lshl_add_u32 v175, v0, 3, s53
  s_lshl_b32 s65, s42, 1
  s_add_u32 s65, s65, s51
  s_mul_i32 s65, s65, 55296
  s_add_u32 s65, s65, 93323264
  s_lshl_b32 s70, s52, 2
  s_add_u32 s70, s70, s56
  s_lshl_b32 s70, s70, 10
  s_add_u32 s70, s70, s65
  s_lshl_b32 s67, s57, 10
  s_add_u32 s67, s67, s65
  s_cmp_ge_u32 s43, 6
  s_cselect_b32 s67, 0x40000000, s67
  s_add_u32 s74, s70, 2048
  s_add_u32 s75, s70, 3072
  s_cmp_eq_u32 s52, 1
  s_cselect_b32 s74, s67, s74
  s_cselect_b32 s75, 0x40000000, s75
  s_waitcnt vmcnt(8)
  v_readfirstlane_b32 s51, v14
  s_nop 0
  s_cmp_ge_u32 s51, 7
  s_cbranch_scc1 L_t_pb_ok
  s_mov_b32 s53, 0
L_t_pb_spin:
  v_mov_b32 v14, 0
  buffer_atomic_add v14, v40, s[28:31], s39 offen sc0
  s_add_u32 s53, s53, 1
  s_cmp_gt_u32 s53, 1000000
  s_waitcnt vmcnt(0)
  s_cbranch_scc1 L_t_pb_ok
  v_readfirstlane_b32 s51, v14
  s_nop 0
  s_cmp_lt_u32 s51, 8
  s_cbranch_scc1 L_t_pb_spin
L_t_pb_ok:
  buffer_load_dwordx4 v[164:167], v37, s[28:31], s66 offen sc1
  s_add_u32 s51, s21, 135168
  buffer_load_dwordx4 a[160:163], v170, s[28:31], s51 offen sc1
  buffer_load_dwordx4 a[164:167], v171, s[28:31], s51 offen sc1
  buffer_load_dwordx4 a[168:171], v172, s[28:31], s51 offen sc1
  buffer_load_dwordx4 a[172:175], v173, s[28:31], s51 offen sc1
  s_add_u32 s51, s21, 0
  buffer_load_dwordx4 a[144:147], v170, s[28:31], s51 offen sc1
  buffer_load_dwordx4 a[148:151], v171, s[28:31], s51 offen sc1
  buffer_load_dwordx4 a[152:155], v172, s[28:31], s51 offen sc1
  buffer_load_dwordx4 a[156:159], v173, s[28:31], s51 offen sc1
  s_waitcnt vmcnt(8)
  v_cmp_gt_f32 vcc, 0, v165
  v_cmp_gt_f32 s[72:73], 0, v167
  s_nop 0
  s_or_b64 vcc, vcc, s[72:73]
  s_cbranch_vccnz L_t_p2_w
L_t_p2_ok:
  v_pk_add_f32 v[164:165], v[164:165], v[166:167]
  v_mov_b32 v168, v164
  s_nop 1
  v_permlane16_swap_b32 v164, v168
  v_add_f32 v164, v164, v168
  v_mov_b32 v168, v164
  s_nop 1
  v_permlane32_swap_b32 v164, v168
  s_add_u32 s51, s21, 4096
  buffer_load_dwordx4 a[128:131], v170, s[28:31], s51 offen sc1
  v_add_f32 v164, v164, v168
  v_mov_b32 v169, v165
  s_nop 1
  v_permlane16_swap_b32 v165, v169
  v_add_f32 v165, v165, v169
  v_mov_b32 v169, v165
  s_nop 1
  v_permlane32_swap_b32 v165, v169
  buffer_load_dwordx4 a[132:135], v171, s[28:31], s51 offen sc1
  v_add_f32 v165, v165, v169
  v_mul_f32 v164, 0xba97b426, v164
  v_mov_b32 v166, 0x3727c5ac
  v_fmac_f32 v166, 0x3a97b426, v165
  v_fma_f32 v166, -v164, v164, v166
  v_max_f32 v166, 0x3727c5ac, v166
  buffer_load_dwordx4 a[136:139], v172, s[28:31], s51 offen sc1
  v_rsq_f32 v166, v166
  s_nop 0
  v_mul_f32 v164, v164, v166
  v_pk_fma_f32 v[132:133], v[132:133], v[166:167], v[164:165] op_sel_hi:[1,0,0]
  v_pk_fma_f32 v[134:135], v[134:135], v[166:167], v[164:165] op_sel_hi:[1,0,0]
  v_cvt_pk_bf16_f32 v76, v132, v133
HS33:
  s_cbranch_execz HOPR_c
  v_cvt_pk_bf16_f32 v77, v134, v135
  buffer_load_dwordx4 a[140:143], v173, s[28:31], s51 offen sc1
  ds_write_b64 v174, v[76:77] offset:0
  v_pk_fma_f32 v[136:137], v[136:137], v[166:167], v[164:165] op_sel_hi:[1,0,0]
  v_pk_fma_f32 v[138:139], v[138:139], v[166:167], v[164:165] op_sel_hi:[1,0,0]
  v_cvt_pk_bf16_f32 v78, v136, v137
  v_cvt_pk_bf16_f32 v79, v138, v139
  ds_write_b64 v174, v[78:79] offset:2048
  s_add_u32 s51, s22, 131072
  buffer_load_dwordx4 a[112:115], v170, s[28:31], s51 offen sc1
  v_pk_fma_f32 v[140:141], v[140:141], v[166:167], v[164:165] op_sel_hi:[1,0,0]
  v_pk_fma_f32 v[142:143], v[142:143], v[166:167], v[164:165] op_sel_hi:[1,0,0]
  v_cvt_pk_bf16_f32 v80, v140, v141
  v_cvt_pk_bf16_f32 v81, v142, v143
  ds_write_b64 v174, v[80:81] offset:4096
  v_pk_fma_f32 v[144:145], v[144:145], v[166:167], v[164:165] op_sel_hi:[1,0,0]
  buffer_load_dwordx4 a[116:119], v171, s[28:31], s51 offen sc1
  v_pk_fma_f32 v[146:147], v[146:147], v[166:167], v[164:165] op_sel_hi:[1,0,0]
  v_cvt_pk_bf16_f32 v82, v144, v145
  v_cvt_pk_bf16_f32 v83, v146, v147
  ds_write_b64 v174, v[82:83] offset:6144
  v_pk_fma_f32 v[148:149], v[148:149], v[166:167], v[164:165] op_sel_hi:[1,0,0]
  v_pk_fma_f32 v[150:151], v[150:151], v[166:167], v[164:165] op_sel_hi:[1,0,0]
  buffer_load_dwordx4 a[120:123], v172, s[28:31], s51 offen sc1
  v_cvt_pk_bf16_f32 v84, v148, v149
  v_cvt_pk_bf16_f32 v85, v150, v151
  ds_write_b64 v174, v[84:85] offset:8192
  v_pk_fma_f32 v[152:153], v[152:153], v[166:167], v[164:165] op_sel_hi:[1,0,0]
  v_pk_fma_f32 v[154:155], v[154:155], v[166:167], v[164:165] op_sel_hi:[1,0,0]
  v_cvt_pk_bf16_f32 v86, v152, v153
  buffer_load_dwordx4 a[124:127], v173, s[28:31], s51 offen sc1
  v_cvt_pk_bf16_f32 v87, v154, v155
  ds_write_b64 v174, v[86:87] offset:10240
  v_pk_fma_f32 v[156:157], v[156:157], v[166:167], v[164:165] op_sel_hi:[1,0,0]
  v_pk_fma_f32 v[158:159], v[158:159], v[166:167], v[164:165] op_sel_hi:[1,0,0]
  v_cvt_pk_bf16_f32 v88, v156, v157
  v_cvt_pk_bf16_f32 v89, v158, v159
  ds_write_b64 v174, v[88:89] offset:12288
  s_waitcnt lgkmcnt(0)
  s_barrier
  ds_read_b64_tr_b16 v[104:105], v175 offset:0
  ds_read_b64_tr_b16 v[106:107], v175 offset:512
  ds_read_b64_tr_b16 v[108:109], v175 offset:2048
  ds_read_b64_tr_b16 v[110:111], v175 offset:2560
  ds_read_b64_tr_b16 v[112:113], v175 offset:4096
  ds_read_b64_tr_b16 v[114:115], v175 offset:4608
  ds_read_b64_tr_b16 v[116:117], v175 offset:6144
  ds_read_b64_tr_b16 v[118:119], v175 offset:6656
  ds_read_b128 v[176:179], v3 offset:0
  ds_read_b128 v[180:183], v3 offset:7168
  ds_read_b128 v[184:187], v3 offset:14336
  ds_read_b128 v[188:191], v3 offset:21504
  ds_read_b128 v[192:195], v3 offset:1024
  ds_read_b128 v[196:199], v3 offset:8192
  s_waitcnt lgkmcnt(12)
  buffer_store_dwordx4 v[104:107], v3, s[28:31], s70 offen offset:0 sc1
  s_waitcnt lgkmcnt(10)
  buffer_store_dwordx4 v[108:111], v3, s[28:31], s70 offen offset:1024 sc1
  s_waitcnt lgkmcnt(8)
  buffer_store_dwordx4 v[112:115], v3, s[28:31], s74 offen offset:0 sc1
  s_waitcnt lgkmcnt(6)
  buffer_store_dwordx4 v[116:119], v3, s[28:31], s75 offen offset:0 sc1
  ds_read_b128 v[200:203], v3 offset:15360
  ds_read_b128 v[204:207], v3 offset:22528
  ds_read_b128 v[208:211], v3 offset:2048
  ds_read_b128 v[212:215], v3 offset:9216
  s_waitcnt lgkmcnt(9)
  v_mfma_f32_16x16x32_bf16 v[48:51], v[176:179], a[32:35], 0
  ds_read_b128 v[216:219], v3 offset:16384
  s_add_u32 s51, s22, 135168
  s_waitcnt lgkmcnt(9)
  v_mfma_f32_16x16x32_bf16 v[48:51], v[180:183], a[36:39], v[48:51]
  s_waitcnt lgkmcnt(7)
  ds_read_b128 v[220:223], v3 offset:23552
  buffer_load_dwordx4 a[96:99], v170, s[28:31], s51 offen sc1
  v_mfma_f32_16x16x32_bf16 v[48:51], v[184:187], a[40:43], v[48:51]
  ds_read_b128 v[176:179], v3 offset:3072
  v_mfma_f32_16x16x32_bf16 v[48:51], v[188:191], a[44:47], v[48:51]
  s_waitcnt lgkmcnt(7)
  ds_read_b128 v[180:183], v3 offset:10240
  v_mfma_f32_16x16x32_bf16 v[52:55], v[192:195], a[32:35], 0
  ds_read_b128 v[184:187], v3 offset:17408
  v_mfma_f32_16x16x32_bf16 v[52:55], v[196:199], a[36:39], v[52:55]
  s_waitcnt lgkmcnt(7)
  ds_read_b128 v[188:191], v3 offset:24576
  buffer_load_dwordx4 a[100:103], v171, s[28:31], s51 offen sc1
  v_mfma_f32_16x16x32_bf16 v[52:55], v[200:203], a[40:43], v[52:55]
  ds_read_b128 v[192:195], v3 offset:4096
  v_mfma_f32_16x16x32_bf16 v[52:55], v[204:207], a[44:47], v[52:55]
  s_waitcnt lgkmcnt(7)
  ds_read_b128 v[196:199], v3 offset:11264
  v_mfma_f32_16x16x32_bf16 v[56:59], v[208:211], a[32:35], 0
  ds_read_b128 v[200:203], v3 offset:18432
  v_mfma_f32_16x16x32_bf16 v[56:59], v[212:215], a[36:39], v[56:59]
  s_waitcnt lgkmcnt(7)
  ds_read_b128 v[204:207], v3 offset:25600
  buffer_load_dwordx4 a[104:107], v172, s[28:31], s51 offen sc1
  v_mfma_f32_16x16x32_bf16 v[56:59], v[216:219], a[40:43], v[56:59]
  ds_read_b128 v[208:211], v3 offset:5120
  s_lshl_b32 s65, s56, 10
  s_add_u32 s58, s65, 93322240
  s_mul_i32 s24, s16, 110592
  s_mul_i32 s25, s17, 110592
  s_mul_i32 s26, s18, 110592
  s_mul_i32 s27, s19, 110592
  s_add_u32 s24, s24, s58
  s_add_u32 s25, s25, s58
  s_add_u32 s26, s26, s58
  s_add_u32 s27, s27, s58
  s_mul_i32 s60, s48, 40960
  s_lshl_b32 s65, s36, 10
  s_add_u32 s60, s60, s65
  s_add_u32 s60, s60, 63962112
  s_mul_i32 s76, s48, 5120
  s_mov_b32 s70, 0xbdd2d3e8
  v_mfma_f32_16x16x32_bf16 v[56:59], v[220:223], a[44:47], v[56:59]
  s_waitcnt lgkmcnt(7)
  ds_read_b128 v[212:215], v3 offset:12288
  v_mfma_f32_16x16x32_bf16 v[60:63], v[176:179], a[32:35], 0
  ds_read_b128 v[216:219], v3 offset:19456
  v_mfma_f32_16x16x32_bf16 v[60:63], v[180:183], a[36:39], v[60:63]
  s_waitcnt lgkmcnt(7)
  ds_read_b128 v[220:223], v3 offset:26624
  buffer_load_dwordx4 a[108:111], v173, s[28:31], s51 offen sc1
  v_mfma_f32_16x16x32_bf16 v[60:63], v[184:187], a[40:43], v[60:63]
  ds_read_b128 v[176:179], v3 offset:6144
  v_mfma_f32_16x16x32_bf16 v[60:63], v[188:191], a[44:47], v[60:63]
  s_waitcnt lgkmcnt(7)
  ds_read_b128 v[180:183], v3 offset:13312
  v_mfma_f32_16x16x32_bf16 v[64:67], v[192:195], a[32:35], 0
  ds_read_b128 v[184:187], v3 offset:20480
  v_mfma_f32_16x16x32_bf16 v[64:67], v[196:199], a[36:39], v[64:67]
  s_waitcnt lgkmcnt(7)
  ds_read_b128 v[188:191], v3 offset:27648
  v_mfma_f32_16x16x32_bf16 v[64:67], v[200:203], a[40:43], v[64:67]
  ds_read_b128 v[192:195], v3 offset:28672
  v_mfma_f32_16x16x32_bf16 v[64:67], v[204:207], a[44:47], v[64:67]
  s_waitcnt lgkmcnt(7)
  ds_read_b128 v[196:199], v3 offset:35840
  v_mfma_f32_16x16x32_bf16 v[68:71], v[208:211], a[32:35], 0
  ds_read_b128 v[200:203], v3 offset:43008
  v_mfma_f32_16x16x32_bf16 v[68:71], v[212:215], a[36:39], v[68:71]
  s_waitcnt lgkmcnt(7)
  ds_read_b128 v[204:207], v3 offset:50176
  v_mfma_f32_16x16x32_bf16 v[68:71], v[216:219], a[40:43], v[68:71]
  ds_read_b128 v[208:211], v3 offset:29696
  v_mfma_f32_16x16x32_bf16 v[68:71], v[220:223], a[44:47], v[68:71]
  s_waitcnt lgkmcnt(7)
  ds_read_b128 v[212:215], v3 offset:36864
  v_mfma_f32_16x16x32_bf16 v[72:75], v[176:179], a[32:35], 0
  ds_read_b128 v[216:219], v3 offset:44032
  v_mfma_f32_16x16x32_bf16 v[72:75], v[180:183], a[36:39], v[72:75]
  s_waitcnt lgkmcnt(7)
  ds_read_b128 v[220:223], v3 offset:51200
  v_mfma_f32_16x16x32_bf16 v[72:75], v[184:187], a[40:43], v[72:75]
  ds_read_b128 v[176:179], v3 offset:30720
  v_mfma_f32_16x16x32_bf16 v[72:75], v[188:191], a[44:47], v[72:75]
  s_waitcnt lgkmcnt(7)
  ds_read_b128 v[180:183], v3 offset:37888
  v_mfma_f32_16x16x32_bf16 v[48:51], v[192:195], a[48:51], v[48:51]
  ds_read_b128 v[184:187], v3 offset:45056
  v_mfma_f32_16x16x32_bf16 v[48:51], v[196:199], a[52:55], v[48:51]
  s_waitcnt lgkmcnt(7)
  ds_read_b128 v[188:191], v3 offset:52224
  s_lshl_b32 s51, s43, 4
  s_and_b32 s52, s42, 15
  s_add_u32 s51, s51, s52
  s_add_u32 s51, s51, 256
  s_lshl_b32 s51, s51, 7
  s_add_u32 s51, s51, 589824
  s_waitcnt vmcnt(4)
  v_mfma_f32_16x16x32_bf16 v[48:51], v[200:203], a[56:59], v[48:51]
  ds_read_b128 v[192:195], v3 offset:31744
  buffer_atomic_add v12, v40, s[28:31], s51 offen
  v_mfma_f32_16x16x32_bf16 v[48:51], v[204:207], a[60:63], v[48:51]
  s_waitcnt lgkmcnt(7)
  ds_read_b128 v[196:199], v3 offset:38912
  v_mfma_f32_16x16x32_bf16 v[52:55], v[208:211], a[48:51], v[52:55]
  ds_read_b128 v[200:203], v3 offset:46080
  v_mfma_f32_16x16x32_bf16 v[52:55], v[212:215], a[52:55], v[52:55]
  s_waitcnt lgkmcnt(7)
  ds_read_b128 v[204:207], v3 offset:53248
  s_add_u32 s51, s22, 0
  v_mfma_f32_16x16x32_bf16 v[52:55], v[216:219], a[56:59], v[52:55]
  ds_read_b128 v[208:211], v3 offset:32768
  buffer_load_dwordx4 a[80:83], v170, s[28:31], s51 offen sc1
  v_mfma_f32_16x16x32_bf16 v[52:55], v[220:223], a[60:63], v[52:55]
  s_waitcnt lgkmcnt(7)
  ds_read_b128 v[212:215], v3 offset:39936
  v_mfma_f32_16x16x32_bf16 v[56:59], v[176:179], a[48:51], v[56:59]
  ds_read_b128 v[216:219], v3 offset:47104
  v_mfma_f32_16x16x32_bf16 v[56:59], v[180:183], a[52:55], v[56:59]
  s_waitcnt lgkmcnt(7)
  ds_read_b128 v[220:223], v3 offset:54272
  v_mfma_f32_16x16x32_bf16 v[56:59], v[184:187], a[56:59], v[56:59]
  ds_read_b128 v[176:179], v3 offset:33792
  buffer_load_dwordx4 a[84:87], v171, s[28:31], s51 offen sc1
  v_mfma_f32_16x16x32_bf16 v[56:59], v[188:191], a[60:63], v[56:59]
  s_waitcnt lgkmcnt(7)
  ds_read_b128 v[180:183], v3 offset:40960
  v_mfma_f32_16x16x32_bf16 v[60:63], v[192:195], a[48:51], v[60:63]
  ds_read_b128 v[184:187], v3 offset:48128
  v_mfma_f32_16x16x32_bf16 v[60:63], v[196:199], a[52:55], v[60:63]
  s_waitcnt lgkmcnt(7)
  ds_read_b128 v[188:191], v3 offset:55296
  v_mfma_f32_16x16x32_bf16 v[60:63], v[200:203], a[56:59], v[60:63]
  ds_read_b128 v[192:195], v3 offset:34816
  buffer_load_dwordx4 a[88:91], v172, s[28:31], s51 offen sc1
  v_mfma_f32_16x16x32_bf16 v[60:63], v[204:207], a[60:63], v[60:63]
  s_waitcnt lgkmcnt(7)
  ds_read_b128 v[196:199], v3 offset:41984
  v_mfma_f32_16x16x32_bf16 v[64:67], v[208:211], a[48:51], v[64:67]
  ds_read_b128 v[200:203], v3 offset:49152
  v_mfma_f32_16x16x32_bf16 v[64:67], v[212:215], a[52:55], v[64:67]
  s_waitcnt lgkmcnt(7)
  ds_read_b128 v[204:207], v3 offset:56320
  v_mfma_f32_16x16x32_bf16 v[64:67], v[216:219], a[56:59], v[64:67]
  ds_read_b128 v[208:211], v3 offset:57344
  buffer_load_dwordx4 a[92:95], v173, s[28:31], s51 offen sc1
  v_mfma_f32_16x16x32_bf16 v[64:67], v[220:223], a[60:63], v[64:67]
  s_waitcnt lgkmcnt(7)
  ds_read_b128 v[212:215], v3 offset:64512
  v_mfma_f32_16x16x32_bf16 v[68:71], v[176:179], a[48:51], v[68:71]
  ds_read_b128 v[216:219], v8 offset:6144
  v_mfma_f32_16x16x32_bf16 v[68:71], v[180:183], a[52:55], v[68:71]
  s_waitcnt lgkmcnt(7)
  ds_read_b128 v[220:223], v8 offset:13312
  s_add_u32 s51, s22, 4096
  v_mfma_f32_16x16x32_bf16 v[68:71], v[184:187], a[56:59], v[68:71]
  ds_read_b128 v[176:179], v3 offset:58368
  buffer_load_dwordx4 a[32:35], v170, s[28:31], s51 offen sc1
  v_mfma_f32_16x16x32_bf16 v[68:71], v[188:191], a[60:63], v[68:71]
  s_waitcnt lgkmcnt(7)
  ds_read_b128 v[180:183], v8 offset:0
  v_mfma_f32_16x16x32_bf16 v[72:75], v[192:195], a[48:51], v[72:75]
  ds_read_b128 v[184:187], v8 offset:7168
  v_mfma_f32_16x16x32_bf16 v[72:75], v[196:199], a[52:55], v[72:75]
  s_waitcnt lgkmcnt(7)
  ds_read_b128 v[188:191], v8 offset:14336
  v_mfma_f32_16x16x32_bf16 v[72:75], v[200:203], a[56:59], v[72:75]
  ds_read_b128 v[192:195], v3 offset:59392
  buffer_load_dwordx4 a[36:39], v171, s[28:31], s51 offen sc1
  v_mfma_f32_16x16x32_bf16 v[72:75], v[204:207], a[60:63], v[72:75]
  s_waitcnt lgkmcnt(7)
  ds_read_b128 v[196:199], v8 offset:1024
  v_mfma_f32_16x16x32_bf16 v[48:51], v[208:211], a[64:67], v[48:51]
  ds_read_b128 v[200:203], v8 offset:8192
  v_mfma_f32_16x16x32_bf16 v[48:51], v[212:215], a[68:71], v[48:51]
  s_waitcnt lgkmcnt(7)
  ds_read_b128 v[204:207], v8 offset:15360
  v_mfma_f32_16x16x32_bf16 v[48:51], v[216:219], a[72:75], v[48:51]
  ds_read_b128 v[208:211], v3 offset:60416
  buffer_load_dwordx4 a[40:43], v172, s[28:31], s51 offen sc1
  v_mfma_f32_16x16x32_bf16 v[48:51], v[220:223], a[76:79], v[48:51]
  s_waitcnt lgkmcnt(7)
  ds_read_b128 v[212:215], v8 offset:2048
  v_mfma_f32_16x16x32_bf16 v[52:55], v[176:179], a[64:67], v[52:55]
  ds_read_b128 v[216:219], v8 offset:9216
  v_mfma_f32_16x16x32_bf16 v[52:55], v[180:183], a[68:71], v[52:55]
  s_waitcnt lgkmcnt(7)
  ds_read_b128 v[220:223], v8 offset:16384
  v_mfma_f32_16x16x32_bf16 v[52:55], v[184:187], a[72:75], v[52:55]
  ds_read_b128 v[176:179], v3 offset:61440
  buffer_load_dwordx4 a[44:47], v173, s[28:31], s51 offen sc1
  v_mfma_f32_16x16x32_bf16 v[52:55], v[188:191], a[76:79], v[52:55]
  s_waitcnt lgkmcnt(7)
  ds_read_b128 v[180:183], v8 offset:3072
  v_mfma_f32_16x16x32_bf16 v[56:59], v[192:195], a[64:67], v[56:59]
  ds_read_b128 v[184:187], v8 offset:10240
  v_mfma_f32_16x16x32_bf16 v[56:59], v[196:199], a[68:71], v[56:59]
  s_waitcnt lgkmcnt(7)
  ds_read_b128 v[188:191], v8 offset:17408
  s_lshl_b32 s39, s43, 4
  s_add_u32 s39, s39, s16
  s_lshl_b32 s39, s39, 7
  s_add_u32 s39, s39, 622592
  v_mov_b32 v13, s39
  v_mfma_f32_16x16x32_bf16 v[56:59], v[200:203], a[72:75], v[56:59]
  ds_read_b128 v[192:195], v3 offset:62464
  buffer_load_dword v14, v13, s[28:31], 0 offen sc1
  v_mfma_f32_16x16x32_bf16 v[56:59], v[204:207], a[76:79], v[56:59]
  s_waitcnt lgkmcnt(7)
  ds_read_b128 v[196:199], v8 offset:4096
  v_mfma_f32_16x16x32_bf16 v[60:63], v[208:211], a[64:67], v[60:63]
  ds_read_b128 v[200:203], v8 offset:11264
  v_mfma_f32_16x16x32_bf16 v[60:63], v[212:215], a[68:71], v[60:63]
  s_waitcnt lgkmcnt(7)
  ds_read_b128 v[204:207], v8 offset:18432
  s_add_u32 s51, s23, 131072
  v_mfma_f32_16x16x32_bf16 v[60:63], v[216:219], a[72:75], v[60:63]
  ds_read_b128 v[208:211], v3 offset:63488
  buffer_load_dwordx4 a[48:51], v170, s[28:31], s51 offen sc1
  v_mfma_f32_16x16x32_bf16 v[60:63], v[220:223], a[76:79], v[60:63]
  s_waitcnt lgkmcnt(7)
  ds_read_b128 v[212:215], v8 offset:5120
  v_mfma_f32_16x16x32_bf16 v[64:67], v[176:179], a[64:67], v[64:67]
  ds_read_b128 v[216:219], v8 offset:12288
  v_mfma_f32_16x16x32_bf16 v[64:67], v[180:183], a[68:71], v[64:67]
  s_waitcnt lgkmcnt(7)
  ds_read_b128 v[220:223], v8 offset:19456
  v_mfma_f32_16x16x32_bf16 v[64:67], v[184:187], a[72:75], v[64:67]
  ds_read_b128 v[176:179], v8 offset:20480
  buffer_load_dwordx4 a[52:55], v171, s[28:31], s51 offen sc1
  v_mfma_f32_16x16x32_bf16 v[64:67], v[188:191], a[76:79], v[64:67]
  s_waitcnt lgkmcnt(7)
  ds_read_b128 v[180:183], v8 offset:27648
  v_mfma_f32_16x16x32_bf16 v[68:71], v[192:195], a[64:67], v[68:71]
  ds_read_b128 v[184:187], v8 offset:34816
  v_mfma_f32_16x16x32_bf16 v[68:71], v[196:199], a[68:71], v[68:71]
  s_waitcnt lgkmcnt(7)
  ds_read_b128 v[188:191], v8 offset:41984
  v_mfma_f32_16x16x32_bf16 v[68:71], v[200:203], a[72:75], v[68:71]
  ds_read_b128 v[192:195], v8 offset:21504
  buffer_load_dwordx4 a[56:59], v172, s[28:31], s51 offen sc1
  v_mfma_f32_16x16x32_bf16 v[68:71], v[204:207], a[76:79], v[68:71]
  s_waitcnt lgkmcnt(7)
  ds_read_b128 v[196:199], v8 offset:28672
  v_mfma_f32_16x16x32_bf16 v[72:75], v[208:211], a[64:67], v[72:75]
  ds_read_b128 v[200:203], v8 offset:35840
  v_mfma_f32_16x16x32_bf16 v[72:75], v[212:215], a[68:71], v[72:75]
  s_waitcnt lgkmcnt(7)
  ds_read_b128 v[204:207], v8 offset:43008
  v_mfma_f32_16x16x32_bf16 v[72:75], v[216:219], a[72:75], v[72:75]
  ds_read_b128 v[208:211], v8 offset:22528
  buffer_load_dwordx4 a[60:63], v173, s[28:31], s51 offen sc1
  v_mfma_f32_16x16x32_bf16 v[72:75], v[220:223], a[76:79], v[72:75]
  s_waitcnt lgkmcnt(7)
  ds_read_b128 v[212:215], v8 offset:29696
  v_mfma_f32_16x16x32_bf16 v[48:51], v[176:179], a[0:3], v[48:51]
  ds_read_b128 v[216:219], v8 offset:36864
  v_mfma_f32_16x16x32_bf16 v[48:51], v[180:183], a[4:7], v[48:51]
  s_waitcnt lgkmcnt(7)
  ds_read_b128 v[220:223], v8 offset:44032
  s_add_u32 s51, s23, 135168
  v_mfma_f32_16x16x32_bf16 v[48:51], v[184:187], a[8:11], v[48:51]
  ds_read_b128 v[176:179], v8 offset:23552
  buffer_load_dwordx4 a[64:67], v170, s[28:31], s51 offen sc1
  v_mfma_f32_16x16x32_bf16 v[48:51], v[188:191], a[12:15], v[48:51]
  s_waitcnt lgkmcnt(7)
  ds_read_b128 v[180:183], v8 offset:30720
  v_mfma_f32_16x16x32_bf16 v[52:55], v[192:195], a[0:3], v[52:55]
  ds_read_b128 v[184:187], v8 offset:37888
  v_mfma_f32_16x16x32_bf16 v[52:55], v[196:199], a[4:7], v[52:55]
  s_waitcnt lgkmcnt(7)
  ds_read_b128 v[188:191], v8 offset:45056
  v_mfma_f32_16x16x32_bf16 v[52:55], v[200:203], a[8:11], v[52:55]
  ds_read_b128 v[192:195], v8 offset:24576
  buffer_load_dwordx4 a[68:71], v171, s[28:31], s51 offen sc1
  v_mfma_f32_16x16x32_bf16 v[52:55], v[204:207], a[12:15], v[52:55]
  s_waitcnt lgkmcnt(7)
  ds_read_b128 v[196:199], v8 offset:31744
  v_mfma_f32_16x16x32_bf16 v[56:59], v[208:211], a[0:3], v[56:59]
  ds_read_b128 v[200:203], v8 offset:38912
  v_mfma_f32_16x16x32_bf16 v[56:59], v[212:215], a[4:7], v[56:59]
  s_waitcnt lgkmcnt(7)
  ds_read_b128 v[204:207], v8 offset:46080
  v_mfma_f32_16x16x32_bf16 v[56:59], v[216:219], a[8:11], v[56:59]
  ds_read_b128 v[208:211], v8 offset:25600
  buffer_load_dwordx4 a[72:75], v172, s[28:31], s51 offen sc1
  v_mfma_f32_16x16x32_bf16 v[56:59], v[220:223], a[12:15], v[56:59]
  s_waitcnt lgkmcnt(7)
  ds_read_b128 v[212:215], v8 offset:32768
  v_mfma_f32_16x16x32_bf16 v[60:63], v[176:179], a[0:3], v[60:63]
  ds_read_b128 v[216:219], v8 offset:39936
  v_mfma_f32_16x16x32_bf16 v[60:63], v[180:183], a[4:7], v[60:63]
  s_waitcnt lgkmcnt(7)
  ds_read_b128 v[220:223], v8 offset:47104
  v_mfma_f32_16x16x32_bf16 v[60:63], v[184:187], a[8:11], v[60:63]
  ds_read_b128 v[176:179], v8 offset:26624
  buffer_load_dwordx4 a[76:79], v173, s[28:31], s51 offen sc1
  v_mfma_f32_16x16x32_bf16 v[60:63], v[188:191], a[12:15], v[60:63]
  s_waitcnt lgkmcnt(7)
  ds_read_b128 v[180:183], v8 offset:33792
  v_mfma_f32_16x16x32_bf16 v[64:67], v[192:195], a[0:3], v[64:67]
  ds_read_b128 v[184:187], v8 offset:40960
  v_mfma_f32_16x16x32_bf16 v[64:67], v[196:199], a[4:7], v[64:67]
  s_waitcnt lgkmcnt(7)
  ds_read_b128 v[188:191], v8 offset:48128
  s_lshl_b32 s51, s62, 5
  v_lshlrev_b32 v42, 1, v1
  v_mfma_f32_16x16x32_bf16 v[64:67], v[200:203], a[8:11], v[64:67]
  ds_read_b128 v[192:195], v8 offset:49152
  buffer_load_ushort v42, v42, s[8:11], s51 offen
  v_mfma_f32_16x16x32_bf16 v[64:67], v[204:207], a[12:15], v[64:67]
  s_waitcnt lgkmcnt(7)
  ds_read_b128 v[196:199], v8 offset:56320
  v_mfma_f32_16x16x32_bf16 v[68:71], v[208:211], a[0:3], v[68:71]
  ds_read_b128 v[200:203], v8 offset:63488
  s_waitcnt vmcnt(9)
  v_cmp_gt_u32 vcc, 8, v14
  s_nop 0
  s_cbranch_vccnz L_t_pc_w
L_t_pc_ok:
  v_mfma_f32_16x16x32_bf16 v[68:71], v[212:215], a[4:7], v[68:71]
  s_waitcnt lgkmcnt(7)
  ds_read_b128 v[204:207], v9 offset:5120
  s_add_u32 s52, s24, 1769472
  v_mfma_f32_16x16x32_bf16 v[68:71], v[216:219], a[8:11], v[68:71]
  ds_read_b128 v[208:211], v8 offset:50176
  buffer_load_dwordx4 v[76:79], v4, s[28:31], s52 offen offset:0 sc1
  v_mfma_f32_16x16x32_bf16 v[68:71], v[220:223], a[12:15], v[68:71]
  s_waitcnt lgkmcnt(7)
  ds_read_b128 v[212:215], v8 offset:57344
  v_mfma_f32_16x16x32_bf16 v[72:75], v[176:179], a[0:3], v[72:75]
  ds_read_b128 v[216:219], v8 offset:64512
  v_mfma_f32_16x16x32_bf16 v[72:75], v[180:183], a[4:7], v[72:75]
  s_waitcnt lgkmcnt(7)
  ds_read_b128 v[220:223], v9 offset:6144
  buffer_load_dwordx4 v[80:83], v4, s[28:31], s52 offen offset:1024 sc1
  v_mfma_f32_16x16x32_bf16 v[72:75], v[184:187], a[8:11], v[72:75]
  ds_read_b128 v[176:179], v8 offset:51200
  v_mfma_f32_16x16x32_bf16 v[72:75], v[188:191], a[12:15], v[72:75]
  s_waitcnt lgkmcnt(7)
  ds_read_b128 v[180:183], v8 offset:58368
  v_mfma_f32_16x16x32_bf16 v[48:51], v[192:195], a[16:19], v[48:51]
  ds_read_b128 v[184:187], v9 offset:0
  buffer_load_dwordx4 v[84:87], v4, s[28:31], s52 offen offset:2048 sc1
  v_mfma_f32_16x16x32_bf16 v[48:51], v[196:199], a[20:23], v[48:51]
  s_waitcnt lgkmcnt(7)
  ds_read_b128 v[188:191], v9 offset:7168
  v_mfma_f32_16x16x32_bf16 v[48:51], v[200:203], a[24:27], v[48:51]
  ds_read_b128 v[192:195], v8 offset:52224
  v_mfma_f32_16x16x32_bf16 v[48:51], v[204:207], a[28:31], v[48:51]
  s_waitcnt lgkmcnt(7)
  ds_read_b128 v[196:199], v8 offset:59392
  buffer_load_dwordx4 v[88:91], v4, s[28:31], s52 offen offset:3072 sc1
  v_mfma_f32_16x16x32_bf16 v[52:55], v[208:211], a[16:19], v[52:55]
  ds_read_b128 v[200:203], v9 offset:1024
  v_mfma_f32_16x16x32_bf16 v[52:55], v[212:215], a[20:23], v[52:55]
  s_waitcnt lgkmcnt(7)
  ds_read_b128 v[204:207], v9 offset:8192
  v_mfma_f32_16x16x32_bf16 v[52:55], v[216:219], a[24:27], v[52:55]
  ds_read_b128 v[208:211], v8 offset:53248
  buffer_load_dwordx4 v[92:95], v5, s[28:31], s52 offen offset:0 sc1
  v_mfma_f32_16x16x32_bf16 v[52:55], v[220:223], a[28:31], v[52:55]
  s_waitcnt lgkmcnt(7)
  ds_read_b128 v[212:215], v8 offset:60416
  v_mfma_f32_16x16x32_bf16 v[56:59], v[176:179], a[16:19], v[56:59]
  ds_read_b128 v[216:219], v9 offset:2048
  v_mfma_f32_16x16x32_bf16 v[56:59], v[180:183], a[20:23], v[56:59]
  s_waitcnt lgkmcnt(7)
  ds_read_b128 v[220:223], v9 offset:9216
  buffer_load_dwordx4 v[96:99], v5, s[28:31], s52 offen offset:1024 sc1
  v_mfma_f32_16x16x32_bf16 v[56:59], v[184:187], a[24:27], v[56:59]
  ds_read_b128 v[176:179], v8 offset:54272
  v_mfma_f32_16x16x32_bf16 v[56:59], v[188:191], a[28:31], v[56:59]
  s_waitcnt lgkmcnt(7)
  ds_read_b128 v[180:183], v8 offset:61440
  v_mfma_f32_16x16x32_bf16 v[60:63], v[192:195], a[16:19], v[60:63]
  ds_read_b128 v[184:187], v9 offset:3072
  buffer_load_dwordx4 v[100:103], v7, s[28:31], s52 offen offset:0 sc1
  v_mfma_f32_16x16x32_bf16 v[60:63], v[196:199], a[20:23], v[60:63]
  s_waitcnt lgkmcnt(7)
  ds_read_b128 v[188:191], v9 offset:10240
  v_mfma_f32_16x16x32_bf16 v[60:63], v[200:203], a[24:27], v[60:63]
  ds_read_b128 v[192:195], v8 offset:55296
  s_add_u32 s52, s24, 1824768
  v_mfma_f32_16x16x32_bf16 v[60:63], v[204:207], a[28:31], v[60:63]
  s_waitcnt lgkmcnt(7)
  ds_read_b128 v[196:199], v8 offset:62464
  buffer_load_dwordx4 v[104:107], v4, s[28:31], s52 offen offset:0 sc1
  v_mfma_f32_16x16x32_bf16 v[64:67], v[208:211], a[16:19], v[64:67]
  ds_read_b128 v[200:203], v9 offset:4096
  v_mfma_f32_16x16x32_bf16 v[64:67], v[212:215], a[20:23], v[64:67]
  s_waitcnt lgkmcnt(7)
  ds_read_b128 v[204:207], v9 offset:11264
  v_mfma_f32_16x16x32_bf16 v[64:67], v[216:219], a[24:27], v[64:67]
  buffer_load_dwordx4 v[108:111], v4, s[28:31], s52 offen offset:1024 sc1
  v_mfma_f32_16x16x32_bf16 v[64:67], v[220:223], a[28:31], v[64:67]
  s_waitcnt lgkmcnt(6)
  v_mfma_f32_16x16x32_bf16 v[68:71], v[176:179], a[16:19], v[68:71]
  v_mfma_f32_16x16x32_bf16 v[68:71], v[180:183], a[20:23], v[68:71]
  s_waitcnt lgkmcnt(4)
  buffer_load_dwordx4 v[112:115], v4, s[28:31], s52 offen offset:2048 sc1
  v_mfma_f32_16x16x32_bf16 v[68:71], v[184:187], a[24:27], v[68:71]
  v_mfma_f32_16x16x32_bf16 v[68:71], v[188:191], a[28:31], v[68:71]
  s_waitcnt lgkmcnt(2)
  v_mfma_f32_16x16x32_bf16 v[72:75], v[192:195], a[16:19], v[72:75]
  buffer_load_dwordx4 v[116:119], v4, s[28:31], s52 offen offset:3072 sc1
  v_mfma_f32_16x16x32_bf16 v[72:75], v[196:199], a[20:23], v[72:75]
  s_waitcnt lgkmcnt(0)
  v_mfma_f32_16x16x32_bf16 v[72:75], v[200:203], a[24:27], v[72:75]
  v_mfma_f32_16x16x32_bf16 v[72:75], v[204:207], a[28:31], v[72:75]
  buffer_load_dwordx4 v[120:123], v5, s[28:31], s52 offen offset:0 sc1
  buffer_load_dwordx4 v[124:127], v5, s[28:31], s52 offen offset:1024 sc1
  buffer_load_dwordx4 v[128:131], v7, s[28:31], s52 offen offset:0 sc1
  ds_read_b128 v[164:167], v38 offset:1024
  ds_read_b128 v[8:11], v38 offset:1472
  s_waitcnt vmcnt(13)
  v_mfma_f32_16x16x32_bf16 a[0:3], v[76:79], a[240:243], 0
  s_lshl_b32 s39, s43, 4
  s_waitcnt lgkmcnt(1)
  v_fmac_f32 v48, v164, v160
  v_fmac_f32 v49, v165, v160
  v_mfma_f32_16x16x32_bf16 v[176:179], v[76:79], a[244:247], 0
  s_add_u32 s39, s39, s17
  v_fmac_f32 v50, v166, v160
  v_fmac_f32 v51, v167, v160
  v_mfma_f32_16x16x32_bf16 v[204:207], v[76:79], a[248:251], 0
  s_lshl_b32 s39, s39, 7
  s_waitcnt lgkmcnt(0)
  v_fma_f32 v48, v48, v162, v8
  v_fma_f32 v49, v49, v162, v9
  v_mfma_f32_16x16x32_bf16 v[232:235], v[76:79], a[252:255], 0
  s_add_u32 s39, s39, 622592
  v_mov_b32 v13, s39
  v_fma_f32 v50, v50, v162, v10
  s_waitcnt vmcnt(12)
  v_mfma_f32_16x16x32_bf16 a[4:7], v[80:83], a[240:243], 0
  buffer_load_dword v14, v13, s[28:31], 0 offen sc1
  v_mfma_f32_16x16x32_bf16 v[180:183], v[80:83], a[244:247], 0
  v_fma_f32 v51, v51, v162, v11
  v_mfma_f32_16x16x32_bf16 v[208:211], v[80:83], a[248:251], 0
  s_add_u32 s52, s24, 0
  buffer_load_dwordx4 v[132:135], v4, s[28:31], s52 offen offset:0 sc1
  v_mfma_f32_16x16x32_bf16 v[236:239], v[80:83], a[252:255], 0
  ds_read_b128 v[164:167], v38 offset:1088
  s_waitcnt vmcnt(13)
  v_mfma_f32_16x16x32_bf16 a[8:11], v[84:87], a[240:243], 0
  buffer_load_dwordx4 v[136:139], v4, s[28:31], s52 offen offset:1024 sc1
  v_mfma_f32_16x16x32_bf16 v[184:187], v[84:87], a[244:247], 0
  ds_read_b128 v[8:11], v38 offset:1536
  v_mul_f32 v168, v48, v48
  v_mfma_f32_16x16x32_bf16 v[212:215], v[84:87], a[248:251], 0
  buffer_load_dwordx4 v[140:143], v4, s[28:31], s52 offen offset:2048 sc1
  v_mfma_f32_16x16x32_bf16 v[240:243], v[84:87], a[252:255], 0
  v_mul_f32 v169, v49, v49
  v_mul_f32 v174, v50, v50
  s_waitcnt vmcnt(14)
  v_mfma_f32_16x16x32_bf16 a[12:15], v[88:91], a[240:243], 0
  buffer_load_dwordx4 v[144:147], v4, s[28:31], s52 offen offset:3072 sc1
  v_mfma_f32_16x16x32_bf16 v[188:191], v[88:91], a[244:247], 0
  v_mul_f32 v175, v51, v51
  v_fma_f32 v168, v168, s70, v44
  v_mfma_f32_16x16x32_bf16 v[216:219], v[88:91], a[248:251], 0
  buffer_load_dwordx4 v[148:151], v5, s[28:31], s52 offen offset:0 sc1
  v_mfma_f32_16x16x32_bf16 v[244:247], v[88:91], a[252:255], 0
  v_fma_f32 v169, v169, s70, v44
  v_fma_f32 v174, v174, s70, v44
  s_waitcnt vmcnt(15)
  v_mfma_f32_16x16x32_bf16 a[16:19], v[92:95], a[240:243], 0
  buffer_load_dwordx4 v[152:155], v5, s[28:31], s52 offen offset:1024 sc1
  v_mfma_f32_16x16x32_bf16 v[192:195], v[92:95], a[244:247], 0
  v_fma_f32 v175, v175, s70, v44
  v_mul_f32 v168, v168, v48
  v_mfma_f32_16x16x32_bf16 v[220:223], v[92:95], a[248:251], 0
  buffer_load_dwordx4 v[156:159], v7, s[28:31], s52 offen offset:0 sc1
  v_mfma_f32_16x16x32_bf16 v[248:251], v[92:95], a[252:255], 0
  v_mul_f32 v169, v169, v49
  v_mul_f32 v174, v174, v50
  s_waitcnt vmcnt(16)
  v_mfma_f32_16x16x32_bf16 a[20:23], v[96:99], a[240:243], 0
  v_mul_f32 v175, v175, v51
  v_mfma_f32_16x16x32_bf16 v[196:199], v[96:99], a[244:247], 0
  v_mfma_f32_16x16x32_bf16 v[224:227], v[96:99], a[248:251], 0
  v_mfma_f32_16x16x32_bf16 v[252:255], v[96:99], a[252:255], 0
  s_waitcnt vmcnt(15)
  v_mfma_f32_16x16x32_bf16 a[24:27], v[100:103], a[240:243], 0
  v_mfma_f32_16x16x32_bf16 v[200:203], v[100:103], a[244:247], 0
  v_mfma_f32_16x16x32_bf16 v[228:231], v[100:103], a[248:251], 0
  v_mfma_f32_16x16x32_bf16 a[28:31], v[100:103], a[252:255], 0
  s_waitcnt vmcnt(14)
  v_mfma_f32_16x16x32_bf16 a[0:3], v[104:107], a[224:227], a[0:3]
  s_add_u32 s52, s24, 55296
  buffer_load_dwordx4 v[76:79], v4, s[28:31], s52 offen offset:0 sc1
  v_mfma_f32_16x16x32_bf16 v[176:179], v[104:107], a[228:231], v[176:179]
  v_exp_f32 v168, v168
  v_mfma_f32_16x16x32_bf16 v[204:207], v[104:107], a[232:235], v[204:207]
  buffer_load_dwordx4 v[80:83], v4, s[28:31], s52 offen offset:1024 sc1
  v_mfma_f32_16x16x32_bf16 v[232:235], v[104:107], a[236:239], v[232:235]
  v_exp_f32 v169, v169
  s_waitcnt vmcnt(15)
  v_mfma_f32_16x16x32_bf16 a[4:7], v[108:111], a[224:227], a[4:7]
HS34:
  s_cbranch_execz HOPR_c
  buffer_load_dwordx4 v[84:87], v4, s[28:31], s52 offen offset:2048 sc1
  v_mfma_f32_16x16x32_bf16 v[180:183], v[108:111], a[228:231], v[180:183]
  v_exp_f32 v174, v174
  v_mfma_f32_16x16x32_bf16 v[208:211], v[108:111], a[232:235], v[208:211]
  buffer_load_dwordx4 v[88:91], v4, s[28:31], s52 offen offset:3072 sc1
  v_mfma_f32_16x16x32_bf16 v[236:239], v[108:111], a[236:239], v[236:239]
  v_exp_f32 v175, v175
  s_waitcnt vmcnt(16)
  v_mfma_f32_16x16x32_bf16 a[8:11], v[112:115], a[224:227], a[8:11]
  buffer_load_dwordx4 v[92:95], v5, s[28:31], s52 offen offset:0 sc1
  v_mfma_f32_16x16x32_bf16 v[184:187], v[112:115], a[228:231], v[184:187]
  v_add_f32 v168, 1.0, v168
  v_add_f32 v169, 1.0, v169
  v_mfma_f32_16x16x32_bf16 v[212:215], v[112:115], a[232:235], v[212:215]
  buffer_load_dwordx4 v[96:99], v5, s[28:31], s52 offen offset:1024 sc1
  v_mfma_f32_16x16x32_bf16 v[240:243], v[112:115], a[236:239], v[240:243]
  v_add_f32 v174, 1.0, v174
  v_add_f32 v175, 1.0, v175
  s_waitcnt vmcnt(17)
  v_mfma_f32_16x16x32_bf16 a[12:15], v[116:119], a[224:227], a[12:15]
  buffer_load_dwordx4 v[100:103], v7, s[28:31], s52 offen offset:0 sc1
  v_mfma_f32_16x16x32_bf16 v[188:191], v[116:119], a[228:231], v[188:191]
  v_rcp_f32 v168, v168
  v_mfma_f32_16x16x32_bf16 v[216:219], v[116:119], a[232:235], v[216:219]
  v_rcp_f32 v169, v169
  v_mfma_f32_16x16x32_bf16 v[244:247], v[116:119], a[236:239], v[244:247]
  v_rcp_f32 v174, v174
  s_waitcnt vmcnt(17)
  v_mfma_f32_16x16x32_bf16 a[16:19], v[120:123], a[224:227], a[16:19]
  v_rcp_f32 v175, v175
  v_mfma_f32_16x16x32_bf16 v[192:195], v[120:123], a[228:231], v[192:195]
  v_mul_f32 v48, v48, v168
  v_mul_f32 v49, v49, v169
  v_mfma_f32_16x16x32_bf16 v[220:223], v[120:123], a[232:235], v[220:223]
  v_mul_f32 v50, v50, v174
  v_mul_f32 v51, v51, v175
  v_mfma_f32_16x16x32_bf16 v[248:251], v[120:123], a[236:239], v[248:251]
  s_waitcnt vmcnt(16)
  v_mfma_f32_16x16x32_bf16 a[20:23], v[124:127], a[224:227], a[20:23]
  v_mfma_f32_16x16x32_bf16 v[196:199], v[124:127], a[228:231], v[196:199]
  v_mfma_f32_16x16x32_bf16 v[224:227], v[124:127], a[232:235], v[224:227]
  v_mfma_f32_16x16x32_bf16 v[252:255], v[124:127], a[236:239], v[252:255]
  s_waitcnt vmcnt(15)
  v_mfma_f32_16x16x32_bf16 a[24:27], v[128:131], a[224:227], a[24:27]
  v_mfma_f32_16x16x32_bf16 v[200:203], v[128:131], a[228:231], v[200:203]
  v_mfma_f32_16x16x32_bf16 v[228:231], v[128:131], a[232:235], v[228:231]
  v_mfma_f32_16x16x32_bf16 a[28:31], v[128:131], a[236:239], a[28:31]
  s_waitcnt vmcnt(14)
  v_cmp_gt_u32 vcc, 8, v14
  s_nop 0
  s_cbranch_vccnz L_t_pe2_w
L_t_pe2_ok:
  s_waitcnt vmcnt(13)
  v_mfma_f32_16x16x32_bf16 a[0:3], v[132:135], a[208:211], a[0:3]
  s_add_u32 s52, s25, 1769472
  buffer_load_dwordx4 v[104:107], v4, s[28:31], s52 offen offset:0 sc1
  v_mfma_f32_16x16x32_bf16 v[176:179], v[132:135], a[212:215], v[176:179]
  s_waitcnt lgkmcnt(1)
  v_fmac_f32 v52, v164, v160
  v_fmac_f32 v53, v165, v160
  v_mfma_f32_16x16x32_bf16 v[204:207], v[132:135], a[216:219], v[204:207]
  buffer_load_dwordx4 v[108:111], v4, s[28:31], s52 offen offset:1024 sc1
  v_mfma_f32_16x16x32_bf16 v[232:235], v[132:135], a[220:223], v[232:235]
  v_fmac_f32 v54, v166, v160
  v_fmac_f32 v55, v167, v160
  s_waitcnt vmcnt(14)
  v_mfma_f32_16x16x32_bf16 a[4:7], v[136:139], a[208:211], a[4:7]
  buffer_load_dwordx4 v[112:115], v4, s[28:31], s52 offen offset:2048 sc1
  v_mfma_f32_16x16x32_bf16 v[180:183], v[136:139], a[212:215], v[180:183]
  s_waitcnt lgkmcnt(0)
  v_fma_f32 v52, v52, v162, v8
  v_fma_f32 v53, v53, v162, v9
  v_mfma_f32_16x16x32_bf16 v[208:211], v[136:139], a[216:219], v[208:211]
  buffer_load_dwordx4 v[116:119], v4, s[28:31], s52 offen offset:3072 sc1
  v_mfma_f32_16x16x32_bf16 v[236:239], v[136:139], a[220:223], v[236:239]
  v_fma_f32 v54, v54, v162, v10
  v_fma_f32 v55, v55, v162, v11
  s_waitcnt vmcnt(15)
  v_mfma_f32_16x16x32_bf16 a[8:11], v[140:143], a[208:211], a[8:11]
  buffer_load_dwordx4 v[120:123], v5, s[28:31], s52 offen offset:0 sc1
  v_mfma_f32_16x16x32_bf16 v[184:187], v[140:143], a[212:215], v[184:187]
  ds_read_b128 v[164:167], v38 offset:1152
  v_mfma_f32_16x16x32_bf16 v[212:215], v[140:143], a[216:219], v[212:215]
  buffer_load_dwordx4 v[124:127], v5, s[28:31], s52 offen offset:1024 sc1
  v_mfma_f32_16x16x32_bf16 v[240:243], v[140:143], a[220:223], v[240:243]
  ds_read_b128 v[8:11], v38 offset:1600
  v_mul_f32 v168, v52, v52
  s_waitcnt vmcnt(16)
  v_mfma_f32_16x16x32_bf16 a[12:15], v[144:147], a[208:211], a[12:15]
  buffer_load_dwordx4 v[128:131], v7, s[28:31], s52 offen offset:0 sc1
  v_mfma_f32_16x16x32_bf16 v[188:191], v[144:147], a[212:215], v[188:191]
  v_mul_f32 v169, v53, v53
  v_mul_f32 v174, v54, v54
  v_mfma_f32_16x16x32_bf16 v[216:219], v[144:147], a[216:219], v[216:219]
  v_mul_f32 v175, v55, v55
  v_fma_f32 v168, v168, s70, v44
  v_mfma_f32_16x16x32_bf16 v[244:247], v[144:147], a[220:223], v[244:247]
  v_fma_f32 v169, v169, s70, v44
  v_fma_f32 v174, v174, s70, v44
  s_waitcnt vmcnt(16)
  v_mfma_f32_16x16x32_bf16 a[16:19], v[148:151], a[208:211], a[16:19]
  v_fma_f32 v175, v175, s70, v44
  v_mul_f32 v168, v168, v52
  v_mfma_f32_16x16x32_bf16 v[192:195], v[148:151], a[212:215], v[192:195]
  v_mul_f32 v169, v169, v53
  v_mul_f32 v174, v174, v54
  v_mfma_f32_16x16x32_bf16 v[220:223], v[148:151], a[216:219], v[220:223]
  v_mul_f32 v175, v175, v55
  v_mfma_f32_16x16x32_bf16 v[248:251], v[148:151], a[220:223], v[248:251]
  s_waitcnt vmcnt(15)
  v_mfma_f32_16x16x32_bf16 a[20:23], v[152:155], a[208:211], a[20:23]
  v_mfma_f32_16x16x32_bf16 v[196:199], v[152:155], a[212:215], v[196:199]
  v_mfma_f32_16x16x32_bf16 v[224:227], v[152:155], a[216:219], v[224:227]
  v_mfma_f32_16x16x32_bf16 v[252:255], v[152:155], a[220:223], v[252:255]
  s_waitcnt vmcnt(14)
  v_mfma_f32_16x16x32_bf16 a[24:27], v[156:159], a[208:211], a[24:27]
  v_mfma_f32_16x16x32_bf16 v[200:203], v[156:159], a[212:215], v[200:203]
  v_mfma_f32_16x16x32_bf16 v[228:231], v[156:159], a[216:219], v[228:231]
  v_mfma_f32_16x16x32_bf16 a[28:31], v[156:159], a[220:223], a[28:31]
  s_waitcnt vmcnt(13)
  v_mfma_f32_16x16x32_bf16 a[0:3], v[76:79], a[192:195], a[0:3]
  s_add_u32 s52, s25, 1824768
  buffer_load_dwordx4 v[132:135], v4, s[28:31], s52 offen offset:0 sc1
  v_mfma_f32_16x16x32_bf16 v[176:179], v[76:79], a[196:199], v[176:179]
  v_exp_f32 v168, v168
  v_mfma_f32_16x16x32_bf16 v[204:207], v[76:79], a[200:203], v[204:207]
  buffer_load_dwordx4 v[136:139], v4, s[28:31], s52 offen offset:1024 sc1
  v_mfma_f32_16x16x32_bf16 v[232:235], v[76:79], a[204:207], v[232:235]
  v_exp_f32 v169, v169
  s_waitcnt vmcnt(14)
  v_mfma_f32_16x16x32_bf16 a[4:7], v[80:83], a[192:195], a[4:7]
  buffer_load_dwordx4 v[140:143], v4, s[28:31], s52 offen offset:2048 sc1
  v_mfma_f32_16x16x32_bf16 v[180:183], v[80:83], a[196:199], v[180:183]
  v_exp_f32 v174, v174
  v_mfma_f32_16x16x32_bf16 v[208:211], v[80:83], a[200:203], v[208:211]
  buffer_load_dwordx4 v[144:147], v4, s[28:31], s52 offen offset:3072 sc1
  v_mfma_f32_16x16x32_bf16 v[236:239], v[80:83], a[204:207], v[236:239]
  v_exp_f32 v175, v175
  s_waitcnt vmcnt(15)
  v_mfma_f32_16x16x32_bf16 a[8:11], v[84:87], a[192:195], a[8:11]
  buffer_load_dwordx4 v[148:151], v5, s[28:31], s52 offen offset:0 sc1
  v_mfma_f32_16x16x32_bf16 v[184:187], v[84:87], a[196:199], v[184:187]
  v_add_f32 v168, 1.0, v168
  v_add_f32 v169, 1.0, v169
  v_mfma_f32_16x16x32_bf16 v[212:215], v[84:87], a[200:203], v[212:215]
  buffer_load_dwordx4 v[152:155], v5, s[28:31], s52 offen offset:1024 sc1
  v_mfma_f32_16x16x32_bf16 v[240:243], v[84:87], a[204:207], v[240:243]
  v_add_f32 v174, 1.0, v174
  v_add_f32 v175, 1.0, v175
  s_waitcnt vmcnt(16)
  v_mfma_f32_16x16x32_bf16 a[12:15], v[88:91], a[192:195], a[12:15]
  buffer_load_dwordx4 v[156:159], v7, s[28:31], s52 offen offset:0 sc1
  v_mfma_f32_16x16x32_bf16 v[188:191], v[88:91], a[196:199], v[188:191]
  v_rcp_f32 v168, v168
  v_mfma_f32_16x16x32_bf16 v[216:219], v[88:91], a[200:203], v[216:219]
  v_rcp_f32 v169, v169
  v_mfma_f32_16x16x32_bf16 v[244:247], v[88:91], a[204:207], v[244:247]
  v_rcp_f32 v174, v174
  s_waitcnt vmcnt(16)
  v_mfma_f32_16x16x32_bf16 a[16:19], v[92:95], a[192:195], a[16:19]
  v_rcp_f32 v175, v175
  v_mfma_f32_16x16x32_bf16 v[192:195], v[92:95], a[196:199], v[192:195]
  v_mul_f32 v52, v52, v168
  v_mul_f32 v53, v53, v169
  v_mfma_f32_16x16x32_bf16 v[220:223], v[92:95], a[200:203], v[220:223]
  v_mul_f32 v54, v54, v174
  v_mul_f32 v55, v55, v175
  v_mfma_f32_16x16x32_bf16 v[248:251], v[92:95], a[204:207], v[248:251]
  s_waitcnt vmcnt(15)
  v_mfma_f32_16x16x32_bf16 a[20:23], v[96:99], a[192:195], a[20:23]
  v_mfma_f32_16x16x32_bf16 v[196:199], v[96:99], a[196:199], v[196:199]
  v_mfma_f32_16x16x32_bf16 v[224:227], v[96:99], a[200:203], v[224:227]
  v_mfma_f32_16x16x32_bf16 v[252:255], v[96:99], a[204:207], v[252:255]
  s_waitcnt vmcnt(14)
  v_mfma_f32_16x16x32_bf16 a[24:27], v[100:103], a[192:195], a[24:27]
  v_mfma_f32_16x16x32_bf16 v[200:203], v[100:103], a[196:199], v[200:203]
  v_mfma_f32_16x16x32_bf16 v[228:231], v[100:103], a[200:203], v[228:231]
  v_mfma_f32_16x16x32_bf16 a[28:31], v[100:103], a[204:207], a[28:31]
  s_waitcnt vmcnt(13)
  v_mfma_f32_16x16x32_bf16 a[0:3], v[104:107], a[176:179], a[0:3]
  s_lshl_b32 s39, s43, 4
  s_waitcnt lgkmcnt(1)
  v_fmac_f32 v56, v164, v160
  v_fmac_f32 v57, v165, v160
  v_mfma_f32_16x16x32_bf16 v[176:179], v[104:107], a[180:183], v[176:179]
  s_add_u32 s39, s39, s18
  v_fmac_f32 v58, v166, v160
  v_fmac_f32 v59, v167, v160
  v_mfma_f32_16x16x32_bf16 v[204:207], v[104:107], a[184:187], v[204:207]
  s_lshl_b32 s39, s39, 7
  s_waitcnt lgkmcnt(0)
  v_fma_f32 v56, v56, v162, v8
  v_fma_f32 v57, v57, v162, v9
  v_mfma_f32_16x16x32_bf16 v[232:235], v[104:107], a[188:191], v[232:235]
  s_add_u32 s39, s39, 622592
  v_mov_b32 v13, s39
  v_fma_f32 v58, v58, v162, v10
  s_waitcnt vmcnt(12)
  v_mfma_f32_16x16x32_bf16 a[4:7], v[108:111], a[176:179], a[4:7]
  buffer_load_dword v14, v13, s[28:31], 0 offen sc1
  v_mfma_f32_16x16x32_bf16 v[180:183], v[108:111], a[180:183], v[180:183]
  v_fma_f32 v59, v59, v162, v11
  v_mfma_f32_16x16x32_bf16 v[208:211], v[108:111], a[184:187], v[208:211]
  s_add_u32 s52, s25, 0
  buffer_load_dwordx4 v[76:79], v4, s[28:31], s52 offen offset:0 sc1
  v_mfma_f32_16x16x32_bf16 v[236:239], v[108:111], a[188:191], v[236:239]
  ds_read_b128 v[164:167], v38 offset:1216
  s_waitcnt vmcnt(13)
  v_mfma_f32_16x16x32_bf16 a[8:11], v[112:115], a[176:179], a[8:11]
  buffer_load_dwordx4 v[80:83], v4, s[28:31], s52 offen offset:1024 sc1
  v_mfma_f32_16x16x32_bf16 v[184:187], v[112:115], a[180:183], v[184:187]
  ds_read_b128 v[8:11], v38 offset:1664
  v_mul_f32 v168, v56, v56
  v_mfma_f32_16x16x32_bf16 v[212:215], v[112:115], a[184:187], v[212:215]
  buffer_load_dwordx4 v[84:87], v4, s[28:31], s52 offen offset:2048 sc1
  v_mfma_f32_16x16x32_bf16 v[240:243], v[112:115], a[188:191], v[240:243]
  v_mul_f32 v169, v57, v57
  v_mul_f32 v174, v58, v58
  s_waitcnt vmcnt(14)
  v_mfma_f32_16x16x32_bf16 a[12:15], v[116:119], a[176:179], a[12:15]
  buffer_load_dwordx4 v[88:91], v4, s[28:31], s52 offen offset:3072 sc1
  v_mfma_f32_16x16x32_bf16 v[188:191], v[116:119], a[180:183], v[188:191]
  v_mul_f32 v175, v59, v59
  v_fma_f32 v168, v168, s70, v44
  v_mfma_f32_16x16x32_bf16 v[216:219], v[116:119], a[184:187], v[216:219]
  buffer_load_dwordx4 v[92:95], v5, s[28:31], s52 offen offset:0 sc1
  v_mfma_f32_16x16x32_bf16 v[244:247], v[116:119], a[188:191], v[244:247]
  v_fma_f32 v169, v169, s70, v44
  v_fma_f32 v174, v174, s70, v44
  s_waitcnt vmcnt(15)
  v_mfma_f32_16x16x32_bf16 a[16:19], v[120:123], a[176:179], a[16:19]
  buffer_load_dwordx4 v[96:99], v5, s[28:31], s52 offen offset:1024 sc1
  v_mfma_f32_16x16x32_bf16 v[192:195], v[120:123], a[180:183], v[192:195]
  v_fma_f32 v175, v175, s70, v44
  v_mul_f32 v168, v168, v56
  v_mfma_f32_16x16x32_bf16 v[220:223], v[120:123], a[184:187], v[220:223]
  buffer_load_dwordx4 v[100:103], v7, s[28:31], s52 offen offset:0 sc1
  v_mfma_f32_16x16x32_bf16 v[248:251], v[120:123], a[188:191], v[248:251]
  v_mul_f32 v169, v169, v57
  v_mul_f32 v174, v174, v58
  s_waitcnt vmcnt(16)
  v_mfma_f32_16x16x32_bf16 a[20:23], v[124:127], a[176:179], a[20:23]
  v_mul_f32 v175, v175, v59
  v_mfma_f32_16x16x32_bf16 v[196:199], v[124:127], a[180:183], v[196:199]
  v_mfma_f32_16x16x32_bf16 v[224:227], v[124:127], a[184:187], v[224:227]
  v_mfma_f32_16x16x32_bf16 v[252:255], v[124:127], a[188:191], v[252:255]
  s_waitcnt vmcnt(15)
  v_mfma_f32_16x16x32_bf16 a[24:27], v[128:131], a[176:179], a[24:27]
  v_mfma_f32_16x16x32_bf16 v[200:203], v[128:131], a[180:183], v[200:203]
  v_mfma_f32_16x16x32_bf16 v[228:231], v[128:131], a[184:187], v[228:231]
  v_mfma_f32_16x16x32_bf16 a[28:31], v[128:131], a[188:191], a[28:31]
  s_waitcnt vmcnt(14)
  v_mfma_f32_16x16x32_bf16 a[0:3], v[132:135], a[160:163], a[0:3]
  s_add_u32 s52, s25, 55296
  buffer_load_dwordx4 v[104:107], v4, s[28:31], s52 offen offset:0 sc1
  v_mfma_f32_16x16x32_bf16 v[176:179], v[132:135], a[164:167], v[176:179]
  v_exp_f32 v168, v168
  v_mfma_f32_16x16x32_bf16 v[204:207], v[132:135], a[168:171], v[204:207]
  buffer_load_dwordx4 v[108:111], v4, s[28:31], s52 offen offset:1024 sc1
  v_mfma_f32_16x16x32_bf16 v[232:235], v[132:135], a[172:175], v[232:235]
  v_exp_f32 v169, v169
  s_waitcnt vmcnt(15)
  v_mfma_f32_16x16x32_bf16 a[4:7], v[136:139], a[160:163], a[4:7]
  buffer_load_dwordx4 v[112:115], v4, s[28:31], s52 offen offset:2048 sc1
  v_mfma_f32_16x16x32_bf16 v[180:183], v[136:139], a[164:167], v[180:183]
  v_exp_f32 v174, v174
  v_mfma_f32_16x16x32_bf16 v[208:211], v[136:139], a[168:171], v[208:211]
  buffer_load_dwordx4 v[116:119], v4, s[28:31], s52 offen offset:3072 sc1
  v_mfma_f32_16x16x32_bf16 v[236:239], v[136:139], a[172:175], v[236:239]
  v_exp_f32 v175, v175
  s_waitcnt vmcnt(16)
  v_mfma_f32_16x16x32_bf16 a[8:11], v[140:143], a[160:163], a[8:11]
  buffer_load_dwordx4 v[120:123], v5, s[28:31], s52 offen offset:0 sc1
  v_mfma_f32_16x16x32_bf16 v[184:187], v[140:143], a[164:167], v[184:187]
  v_add_f32 v168, 1.0, v168
  v_add_f32 v169, 1.0, v169
  v_mfma_f32_16x16x32_bf16 v[212:215], v[140:143], a[168:171], v[212:215]
  buffer_load_dwordx4 v[124:127], v5, s[28:31], s52 offen offset:1024 sc1
  v_mfma_f32_16x16x32_bf16 v[240:243], v[140:143], a[172:175], v[240:243]
  v_add_f32 v174, 1.0, v174
  v_add_f32 v175, 1.0, v175
  s_waitcnt vmcnt(17)
  v_mfma_f32_16x16x32_bf16 a[12:15], v[144:147], a[160:163], a[12:15]
  buffer_load_dwordx4 v[128:131], v7, s[28:31], s52 offen offset:0 sc1
  v_mfma_f32_16x16x32_bf16 v[188:191], v[144:147], a[164:167], v[188:191]
  v_rcp_f32 v168, v168
  v_mfma_f32_16x16x32_bf16 v[216:219], v[144:147], a[168:171], v[216:219]
  v_rcp_f32 v169, v169
  v_mfma_f32_16x16x32_bf16 v[244:247], v[144:147], a[172:175], v[244:247]
  v_rcp_f32 v174, v174
  s_waitcnt vmcnt(17)
  v_mfma_f32_16x16x32_bf16 a[16:19], v[148:151], a[160:163], a[16:19]
  v_rcp_f32 v175, v175
  v_mfma_f32_16x16x32_bf16 v[192:195], v[148:151], a[164:167], v[192:195]
  v_mul_f32 v56, v56, v168
  v_mul_f32 v57, v57, v169
  v_mfma_f32_16x16x32_bf16 v[220:223], v[148:151], a[168:171], v[220:223]
  v_mul_f32 v58, v58, v174
  v_mul_f32 v59, v59, v175
  v_mfma_f32_16x16x32_bf16 v[248:251], v[148:151], a[172:175], v[248:251]
  s_waitcnt vmcnt(16)
  v_mfma_f32_16x16x32_bf16 a[20:23], v[152:155], a[160:163], a[20:23]
  v_mfma_f32_16x16x32_bf16 v[196:199], v[152:155], a[164:167], v[196:199]
  v_mfma_f32_16x16x32_bf16 v[224:227], v[152:155], a[168:171], v[224:227]
  v_mfma_f32_16x16x32_bf16 v[252:255], v[152:155], a[172:175], v[252:255]
  s_waitcnt vmcnt(15)
  v_mfma_f32_16x16x32_bf16 a[24:27], v[156:159], a[160:163], a[24:27]
  v_mfma_f32_16x16x32_bf16 v[200:203], v[156:159], a[164:167], v[200:203]
  v_mfma_f32_16x16x32_bf16 v[228:231], v[156:159], a[168:171], v[228:231]
  v_mfma_f32_16x16x32_bf16 a[28:31], v[156:159], a[172:175], a[28:31]
  s_waitcnt vmcnt(14)
  v_cmp_gt_u32 vcc, 8, v14
  s_nop 0
  s_cbranch_vccnz L_t_pe6_w
L_t_pe6_ok:
  s_waitcnt vmcnt(13)
  v_mfma_f32_16x16x32_bf16 a[0:3], v[76:79], a[144:147], a[0:3]
  s_add_u32 s52, s26, 1769472
  buffer_load_dwordx4 v[132:135], v4, s[28:31], s52 offen offset:0 sc1
  v_mfma_f32_16x16x32_bf16 v[176:179], v[76:79], a[148:151], v[176:179]
  s_waitcnt lgkmcnt(1)
  v_fmac_f32 v60, v164, v160
  v_fmac_f32 v61, v165, v160
  v_mfma_f32_16x16x32_bf16 v[204:207], v[76:79], a[152:155], v[204:207]
  buffer_load_dwordx4 v[136:139], v4, s[28:31], s52 offen offset:1024 sc1
  v_mfma_f32_16x16x32_bf16 v[232:235], v[76:79], a[156:159], v[232:235]
  v_fmac_f32 v62, v166, v160
  v_fmac_f32 v63, v167, v160
  s_waitcnt vmcnt(14)
  v_mfma_f32_16x16x32_bf16 a[4:7], v[80:83], a[144:147], a[4:7]
  buffer_load_dwordx4 v[140:143], v4, s[28:31], s52 offen offset:2048 sc1
  v_mfma_f32_16x16x32_bf16 v[180:183], v[80:83], a[148:151], v[180:183]
  s_waitcnt lgkmcnt(0)
  v_fma_f32 v60, v60, v162, v8
  v_fma_f32 v61, v61, v162, v9
  v_mfma_f32_16x16x32_bf16 v[208:211], v[80:83], a[152:155], v[208:211]
  buffer_load_dwordx4 v[144:147], v4, s[28:31], s52 offen offset:3072 sc1
  v_mfma_f32_16x16x32_bf16 v[236:239], v[80:83], a[156:159], v[236:239]
  v_fma_f32 v62, v62, v162, v10
  v_fma_f32 v63, v63, v162, v11
  s_waitcnt vmcnt(15)
  v_mfma_f32_16x16x32_bf16 a[8:11], v[84:87], a[144:147], a[8:11]
  buffer_load_dwordx4 v[148:151], v5, s[28:31], s52 offen offset:0 sc1
  v_mfma_f32_16x16x32_bf16 v[184:187], v[84:87], a[148:151], v[184:187]
  ds_read_b128 v[164:167], v38 offset:1280
  v_mfma_f32_16x16x32_bf16 v[212:215], v[84:87], a[152:155], v[212:215]
  buffer_load_dwordx4 v[152:155], v5, s[28:31], s52 offen offset:1024 sc1
  v_mfma_f32_16x16x32_bf16 v[240:243], v[84:87], a[156:159], v[240:243]
  ds_read_b128 v[8:11], v38 offset:1728
  v_mul_f32 v168, v60, v60
  s_waitcnt vmcnt(16)
  v_mfma_f32_16x16x32_bf16 a[12:15], v[88:91], a[144:147], a[12:15]
  buffer_load_dwordx4 v[156:159], v7, s[28:31], s52 offen offset:0 sc1
  v_mfma_f32_16x16x32_bf16 v[188:191], v[88:91], a[148:151], v[188:191]
  v_mul_f32 v169, v61, v61
  v_mul_f32 v174, v62, v62
  v_mfma_f32_16x16x32_bf16 v[216:219], v[88:91], a[152:155], v[216:219]
  v_mul_f32 v175, v63, v63
  v_fma_f32 v168, v168, s70, v44
  v_mfma_f32_16x16x32_bf16 v[244:247], v[88:91], a[156:159], v[244:247]
  v_fma_f32 v169, v169, s70, v44
  v_fma_f32 v174, v174, s70, v44
  s_waitcnt vmcnt(16)
  v_mfma_f32_16x16x32_bf16 a[16:19], v[92:95], a[144:147], a[16:19]
  v_fma_f32 v175, v175, s70, v44
  v_mul_f32 v168, v168, v60
  v_mfma_f32_16x16x32_bf16 v[192:195], v[92:95], a[148:151], v[192:195]
  v_mul_f32 v169, v169, v61
  v_mul_f32 v174, v174, v62
  v_mfma_f32_16x16x32_bf16 v[220:223], v[92:95], a[152:155], v[220:223]
  v_mul_f32 v175, v175, v63
  v_mfma_f32_16x16x32_bf16 v[248:251], v[92:95], a[156:159], v[248:251]
  s_waitcnt vmcnt(15)
  v_mfma_f32_16x16x32_bf16 a[20:23], v[96:99], a[144:147], a[20:23]
  v_mfma_f32_16x16x32_bf16 v[196:199], v[96:99], a[148:151], v[196:199]
  v_mfma_f32_16x16x32_bf16 v[224:227], v[96:99], a[152:155], v[224:227]
  v_mfma_f32_16x16x32_bf16 v[252:255], v[96:99], a[156:159], v[252:255]
  s_waitcnt vmcnt(14)
  v_mfma_f32_16x16x32_bf16 a[24:27], v[100:103], a[144:147], a[24:27]
  v_mfma_f32_16x16x32_bf16 v[200:203], v[100:103], a[148:151], v[200:203]
  v_mfma_f32_16x16x32_bf16 v[228:231], v[100:103], a[152:155], v[228:231]
  v_mfma_f32_16x16x32_bf16 a[28:31], v[100:103], a[156:159], a[28:31]
  s_waitcnt vmcnt(13)
  v_mfma_f32_16x16x32_bf16 a[0:3], v[104:107], a[128:131], a[0:3]
  s_add_u32 s52, s26, 1824768
  buffer_load_dwordx4 v[76:79], v4, s[28:31], s52 offen offset:0 sc1
  v_mfma_f32_16x16x32_bf16 v[176:179], v[104:107], a[132:135], v[176:179]
  v_exp_f32 v168, v168
  v_mfma_f32_16x16x32_bf16 v[204:207], v[104:107], a[136:139], v[204:207]
  buffer_load_dwordx4 v[80:83], v4, s[28:31], s52 offen offset:1024 sc1
  v_mfma_f32_16x16x32_bf16 v[232:235], v[104:107], a[140:143], v[232:235]
  v_exp_f32 v169, v169
  s_waitcnt vmcnt(14)
  v_mfma_f32_16x16x32_bf16 a[4:7], v[108:111], a[128:131], a[4:7]
  buffer_load_dwordx4 v[84:87], v4, s[28:31], s52 offen offset:2048 sc1
  v_mfma_f32_16x16x32_bf16 v[180:183], v[108:111], a[132:135], v[180:183]
  v_exp_f32 v174, v174
  v_mfma_f32_16x16x32_bf16 v[208:211], v[108:111], a[136:139], v[208:211]
  buffer_load_dwordx4 v[88:91], v4, s[28:31], s52 offen offset:3072 sc1
  v_mfma_f32_16x16x32_bf16 v[236:239], v[108:111], a[140:143], v[236:239]
  v_exp_f32 v175, v175
  s_waitcnt vmcnt(15)
  v_mfma_f32_16x16x32_bf16 a[8:11], v[112:115], a[128:131], a[8:11]
  buffer_load_dwordx4 v[92:95], v5, s[28:31], s52 offen offset:0 sc1
  v_mfma_f32_16x16x32_bf16 v[184:187], v[112:115], a[132:135], v[184:187]
  v_add_f32 v168, 1.0, v168
  v_add_f32 v169, 1.0, v169
  v_mfma_f32_16x16x32_bf16 v[212:215], v[112:115], a[136:139], v[212:215]
  buffer_load_dwordx4 v[96:99], v5, s[28:31], s52 offen offset:1024 sc1
  v_mfma_f32_16x16x32_bf16 v[240:243], v[112:115], a[140:143], v[240:243]
  v_add_f32 v174, 1.0, v174
  v_add_f32 v175, 1.0, v175
  s_waitcnt vmcnt(16)
  v_mfma_f32_16x16x32_bf16 a[12:15], v[116:119], a[128:131], a[12:15]
  buffer_load_dwordx4 v[100:103], v7, s[28:31], s52 offen offset:0 sc1
  v_mfma_f32_16x16x32_bf16 v[188:191], v[116:119], a[132:135], v[188:191]
  v_rcp_f32 v168, v168
  v_mfma_f32_16x16x32_bf16 v[216:219], v[116:119], a[136:139], v[216:219]
  v_rcp_f32 v169, v169
  v_mfma_f32_16x16x32_bf16 v[244:247], v[116:119], a[140:143], v[244:247]
  v_rcp_f32 v174, v174
  s_waitcnt vmcnt(16)
  v_mfma_f32_16x16x32_bf16 a[16:19], v[120:123], a[128:131], a[16:19]
  v_rcp_f32 v175, v175
  v_mfma_f32_16x16x32_bf16 v[192:195], v[120:123], a[132:135], v[192:195]
  v_mul_f32 v60, v60, v168
  v_mul_f32 v61, v61, v169
  v_mfma_f32_16x16x32_bf16 v[220:223], v[120:123], a[136:139], v[220:223]
  v_mul_f32 v62, v62, v174
  v_mul_f32 v63, v63, v175
  v_mfma_f32_16x16x32_bf16 v[248:251], v[120:123], a[140:143], v[248:251]
  s_waitcnt vmcnt(15)
  v_mfma_f32_16x16x32_bf16 a[20:23], v[124:127], a[128:131], a[20:23]
  v_mfma_f32_16x16x32_bf16 v[196:199], v[124:127], a[132:135], v[196:199]
  v_mfma_f32_16x16x32_bf16 v[224:227], v[124:127], a[136:139], v[224:227]
  v_mfma_f32_16x16x32_bf16 v[252:255], v[124:127], a[140:143], v[252:255]
  s_waitcnt vmcnt(14)
  v_mfma_f32_16x16x32_bf16 a[24:27], v[128:131], a[128:131], a[24:27]
  v_mfma_f32_16x16x32_bf16 v[200:203], v[128:131], a[132:135], v[200:203]
  v_mfma_f32_16x16x32_bf16 v[228:231], v[128:131], a[136:139], v[228:231]
  v_mfma_f32_16x16x32_bf16 a[28:31], v[128:131], a[140:143], a[28:31]
  s_waitcnt vmcnt(13)
  v_mfma_f32_16x16x32_bf16 a[0:3], v[132:135], a[112:115], a[0:3]
  s_lshl_b32 s39, s43, 4
  s_waitcnt lgkmcnt(1)
  v_fmac_f32 v64, v164, v160
  v_fmac_f32 v65, v165, v160
  v_mfma_f32_16x16x32_bf16 v[176:179], v[132:135], a[116:119], v[176:179]
  s_add_u32 s39, s39, s19
  v_fmac_f32 v66, v166, v160
  v_fmac_f32 v67, v167, v160
  v_mfma_f32_16x16x32_bf16 v[204:207], v[132:135], a[120:123], v[204:207]
  s_lshl_b32 s39, s39, 7
  s_waitcnt lgkmcnt(0)
  v_fma_f32 v64, v64, v162, v8
  v_fma_f32 v65, v65, v162, v9
  v_mfma_f32_16x16x32_bf16 v[232:235], v[132:135], a[124:127], v[232:235]
  s_add_u32 s39, s39, 622592
  v_mov_b32 v13, s39
  v_fma_f32 v66, v66, v162, v10
  s_waitcnt vmcnt(12)
  v_mfma_f32_16x16x32_bf16 a[4:7], v[136:139], a[112:115], a[4:7]
  buffer_load_dword v14, v13, s[28:31], 0 offen sc1
  v_mfma_f32_16x16x32_bf16 v[180:183], v[136:139], a[116:119], v[180:183]
  v_fma_f32 v67, v67, v162, v11
  v_mfma_f32_16x16x32_bf16 v[208:211], v[136:139], a[120:123], v[208:211]
  s_add_u32 s52, s26, 0
  buffer_load_dwordx4 v[104:107], v4, s[28:31], s52 offen offset:0 sc1
  v_mfma_f32_16x16x32_bf16 v[236:239], v[136:139], a[124:127], v[236:239]
  ds_read_b128 v[164:167], v38 offset:1344
  s_waitcnt vmcnt(13)
  v_mfma_f32_16x16x32_bf16 a[8:11], v[140:143], a[112:115], a[8:11]
  buffer_load_dwordx4 v[108:111], v4, s[28:31], s52 offen offset:1024 sc1
  v_mfma_f32_16x16x32_bf16 v[184:187], v[140:143], a[116:119], v[184:187]
  ds_read_b128 v[8:11], v38 offset:1792
  v_mul_f32 v168, v64, v64
  v_mfma_f32_16x16x32_bf16 v[212:215], v[140:143], a[120:123], v[212:215]
  buffer_load_dwordx4 v[112:115], v4, s[28:31], s52 offen offset:2048 sc1
  v_mfma_f32_16x16x32_bf16 v[240:243], v[140:143], a[124:127], v[240:243]
  v_mul_f32 v169, v65, v65
  v_mul_f32 v174, v66, v66
  s_waitcnt vmcnt(14)
  v_mfma_f32_16x16x32_bf16 a[12:15], v[144:147], a[112:115], a[12:15]
  buffer_load_dwordx4 v[116:119], v4, s[28:31], s52 offen offset:3072 sc1
  v_mfma_f32_16x16x32_bf16 v[188:191], v[144:147], a[116:119], v[188:191]
  v_mul_f32 v175, v67, v67
  v_fma_f32 v168, v168, s70, v44
  v_mfma_f32_16x16x32_bf16 v[216:219], v[144:147], a[120:123], v[216:219]
  buffer_load_dwordx4 v[120:123], v5, s[28:31], s52 offen offset:0 sc1
  v_mfma_f32_16x16x32_bf16 v[244:247], v[144:147], a[124:127], v[244:247]
  v_fma_f32 v169, v169, s70, v44
  v_fma_f32 v174, v174, s70, v44
  s_waitcnt vmcnt(15)
  v_mfma_f32_16x16x32_bf16 a[16:19], v[148:151], a[112:115], a[16:19]
  buffer_load_dwordx4 v[124:127], v5, s[28:31], s52 offen offset:1024 sc1
  v_mfma_f32_16x16x32_bf16 v[192:195], v[148:151], a[116:119], v[192:195]
  v_fma_f32 v175, v175, s70, v44
  v_mul_f32 v168, v168, v64
  v_mfma_f32_16x16x32_bf16 v[220:223], v[148:151], a[120:123], v[220:223]
  buffer_load_dwordx4 v[128:131], v7, s[28:31], s52 offen offset:0 sc1
  v_mfma_f32_16x16x32_bf16 v[248:251], v[148:151], a[124:127], v[248:251]
  v_mul_f32 v169, v169, v65
  v_mul_f32 v174, v174, v66
  s_waitcnt vmcnt(16)
  v_mfma_f32_16x16x32_bf16 a[20:23], v[152:155], a[112:115], a[20:23]
  v_mul_f32 v175, v175, v67
  v_mfma_f32_16x16x32_bf16 v[196:199], v[152:155], a[116:119], v[196:199]
  v_mfma_f32_16x16x32_bf16 v[224:227], v[152:155], a[120:123], v[224:227]
  v_mfma_f32_16x16x32_bf16 v[252:255], v[152:155], a[124:127], v[252:255]
  s_waitcnt vmcnt(15)
  v_mfma_f32_16x16x32_bf16 a[24:27], v[156:159], a[112:115], a[24:27]
  v_mfma_f32_16x16x32_bf16 v[200:203], v[156:159], a[116:119], v[200:203]
  v_mfma_f32_16x16x32_bf16 v[228:231], v[156:159], a[120:123], v[228:231]
  v_mfma_f32_16x16x32_bf16 a[28:31], v[156:159], a[124:127], a[28:31]
  s_waitcnt vmcnt(14)
  v_mfma_f32_16x16x32_bf16 a[0:3], v[76:79], a[96:99], a[0:3]
  s_add_u32 s52, s26, 55296
  buffer_load_dwordx4 v[132:135], v4, s[28:31], s52 offen offset:0 sc1
  v_mfma_f32_16x16x32_bf16 v[176:179], v[76:79], a[100:103], v[176:179]
  v_exp_f32 v168, v168
  v_mfma_f32_16x16x32_bf16 v[204:207], v[76:79], a[104:107], v[204:207]
  buffer_load_dwordx4 v[136:139], v4, s[28:31], s52 offen offset:1024 sc1
  v_mfma_f32_16x16x32_bf16 v[232:235], v[76:79], a[108:111], v[232:235]
  v_exp_f32 v169, v169
  s_waitcnt vmcnt(15)
  v_mfma_f32_16x16x32_bf16 a[4:7], v[80:83], a[96:99], a[4:7]
  buffer_load_dwordx4 v[140:143], v4, s[28:31], s52 offen offset:2048 sc1
  v_mfma_f32_16x16x32_bf16 v[180:183], v[80:83], a[100:103], v[180:183]
  v_exp_f32 v174, v174
  v_mfma_f32_16x16x32_bf16 v[208:211], v[80:83], a[104:107], v[208:211]
  buffer_load_dwordx4 v[144:147], v4, s[28:31], s52 offen offset:3072 sc1
  v_mfma_f32_16x16x32_bf16 v[236:239], v[80:83], a[108:111], v[236:239]
  v_exp_f32 v175, v175
  s_waitcnt vmcnt(16)
  v_mfma_f32_16x16x32_bf16 a[8:11], v[84:87], a[96:99], a[8:11]
  buffer_load_dwordx4 v[148:151], v5, s[28:31], s52 offen offset:0 sc1
  v_mfma_f32_16x16x32_bf16 v[184:187], v[84:87], a[100:103], v[184:187]
  v_add_f32 v168, 1.0, v168
  v_add_f32 v169, 1.0, v169
  v_mfma_f32_16x16x32_bf16 v[212:215], v[84:87], a[104:107], v[212:215]
  buffer_load_dwordx4 v[152:155], v5, s[28:31], s52 offen offset:1024 sc1
  v_mfma_f32_16x16x32_bf16 v[240:243], v[84:87], a[108:111], v[240:243]
  v_add_f32 v174, 1.0, v174
  v_add_f32 v175, 1.0, v175
  s_waitcnt vmcnt(17)
  v_mfma_f32_16x16x32_bf16 a[12:15], v[88:91], a[96:99], a[12:15]
  buffer_load_dwordx4 v[156:159], v7, s[28:31], s52 offen offset:0 sc1
  v_mfma_f32_16x16x32_bf16 v[188:191], v[88:91], a[100:103], v[188:191]
  v_rcp_f32 v168, v168
  v_mfma_f32_16x16x32_bf16 v[216:219], v[88:91], a[104:107], v[216:219]
  s_add_u32 s51, s23, 0
  buffer_load_dwordx4 a[240:243], v170, s[28:31], s51 offen sc1
  v_mfma_f32_16x16x32_bf16 v[244:247], v[88:91], a[108:111], v[244:247]
  v_rcp_f32 v169, v169
  s_waitcnt vmcnt(18)
  v_mfma_f32_16x16x32_bf16 a[16:19], v[92:95], a[96:99], a[16:19]
  buffer_load_dwordx4 a[244:247], v171, s[28:31], s51 offen sc1
  v_mfma_f32_16x16x32_bf16 v[192:195], v[92:95], a[100:103], v[192:195]
  v_rcp_f32 v174, v174
  v_mfma_f32_16x16x32_bf16 v[220:223], v[92:95], a[104:107], v[220:223]
  buffer_load_dwordx4 a[248:251], v172, s[28:31], s51 offen sc1
  v_mfma_f32_16x16x32_bf16 v[248:251], v[92:95], a[108:111], v[248:251]
  v_rcp_f32 v175, v175
  s_waitcnt vmcnt(19)
  v_mfma_f32_16x16x32_bf16 a[20:23], v[96:99], a[96:99], a[20:23]
  buffer_load_dwordx4 a[252:255], v173, s[28:31], s51 offen sc1
  v_mfma_f32_16x16x32_bf16 v[196:199], v[96:99], a[100:103], v[196:199]
  v_mul_f32 v64, v64, v168
  v_mul_f32 v65, v65, v169
  v_mfma_f32_16x16x32_bf16 v[224:227], v[96:99], a[104:107], v[224:227]
  v_mul_f32 v66, v66, v174
  v_mul_f32 v67, v67, v175
  v_mfma_f32_16x16x32_bf16 v[252:255], v[96:99], a[108:111], v[252:255]
  s_waitcnt vmcnt(19)
  v_mfma_f32_16x16x32_bf16 a[24:27], v[100:103], a[96:99], a[24:27]
  v_mfma_f32_16x16x32_bf16 v[200:203], v[100:103], a[100:103], v[200:203]
  v_mfma_f32_16x16x32_bf16 v[228:231], v[100:103], a[104:107], v[228:231]
  v_mfma_f32_16x16x32_bf16 a[28:31], v[100:103], a[108:111], a[28:31]
  s_waitcnt vmcnt(18)
  v_cmp_gt_u32 vcc, 8, v14
  s_nop 0
  s_cbranch_vccnz L_t_pe10_w
L_t_pe10_ok:
  s_waitcnt vmcnt(17)
  v_mfma_f32_16x16x32_bf16 a[0:3], v[104:107], a[80:83], a[0:3]
  s_add_u32 s52, s27, 1769472
  buffer_load_dwordx4 v[76:79], v4, s[28:31], s52 offen offset:0 sc1
  v_mfma_f32_16x16x32_bf16 v[176:179], v[104:107], a[84:87], v[176:179]
  s_waitcnt lgkmcnt(1)
  v_fmac_f32 v68, v164, v160
  v_fmac_f32 v69, v165, v160
  v_mfma_f32_16x16x32_bf16 v[204:207], v[104:107], a[88:91], v[204:207]
  buffer_load_dwordx4 v[80:83], v4, s[28:31], s52 offen offset:1024 sc1
  v_mfma_f32_16x16x32_bf16 v[232:235], v[104:107], a[92:95], v[232:235]
  v_fmac_f32 v70, v166, v160
  v_fmac_f32 v71, v167, v160
  s_waitcnt vmcnt(18)
  v_mfma_f32_16x16x32_bf16 a[4:7], v[108:111], a[80:83], a[4:7]
  buffer_load_dwordx4 v[84:87], v4, s[28:31], s52 offen offset:2048 sc1
  v_mfma_f32_16x16x32_bf16 v[180:183], v[108:111], a[84:87], v[180:183]
  s_waitcnt lgkmcnt(0)
  v_fma_f32 v68, v68, v162, v8
  v_fma_f32 v69, v69, v162, v9
  v_mfma_f32_16x16x32_bf16 v[208:211], v[108:111], a[88:91], v[208:211]
  buffer_load_dwordx4 v[88:91], v4, s[28:31], s52 offen offset:3072 sc1
  v_mfma_f32_16x16x32_bf16 v[236:239], v[108:111], a[92:95], v[236:239]
  v_fma_f32 v70, v70, v162, v10
  v_fma_f32 v71, v71, v162, v11
  s_waitcnt vmcnt(19)
  v_mfma_f32_16x16x32_bf16 a[8:11], v[112:115], a[80:83], a[8:11]
  buffer_load_dwordx4 v[92:95], v5, s[28:31], s52 offen offset:0 sc1
  v_mfma_f32_16x16x32_bf16 v[184:187], v[112:115], a[84:87], v[184:187]
  ds_read_b128 v[164:167], v38 offset:1408
  v_mfma_f32_16x16x32_bf16 v[212:215], v[112:115], a[88:91], v[212:215]
  buffer_load_dwordx4 v[96:99], v5, s[28:31], s52 offen offset:1024 sc1
  v_mfma_f32_16x16x32_bf16 v[240:243], v[112:115], a[92:95], v[240:243]
  ds_read_b128 v[8:11], v38 offset:1856
  v_mul_f32 v168, v68, v68
  s_waitcnt vmcnt(20)
  v_mfma_f32_16x16x32_bf16 a[12:15], v[116:119], a[80:83], a[12:15]
  buffer_load_dwordx4 v[100:103], v7, s[28:31], s52 offen offset:0 sc1
  v_mfma_f32_16x16x32_bf16 v[188:191], v[116:119], a[84:87], v[188:191]
  v_mul_f32 v169, v69, v69
  v_mul_f32 v174, v70, v70
  v_mfma_f32_16x16x32_bf16 v[216:219], v[116:119], a[88:91], v[216:219]
  s_add_u32 s51, s23, 4096
  buffer_load_dwordx4 a[224:227], v170, s[28:31], s51 offen sc1
  v_mfma_f32_16x16x32_bf16 v[244:247], v[116:119], a[92:95], v[244:247]
  v_mul_f32 v175, v71, v71
  v_fma_f32 v168, v168, s70, v44
  s_waitcnt vmcnt(21)
  v_mfma_f32_16x16x32_bf16 a[16:19], v[120:123], a[80:83], a[16:19]
HS35:
  s_cbranch_execz HOPR_c
  buffer_load_dwordx4 a[228:231], v171, s[28:31], s51 offen sc1
  v_mfma_f32_16x16x32_bf16 v[192:195], v[120:123], a[84:87], v[192:195]
  v_fma_f32 v169, v169, s70, v44
  v_fma_f32 v174, v174, s70, v44
  v_mfma_f32_16x16x32_bf16 v[220:223], v[120:123], a[88:91], v[220:223]
  buffer_load_dwordx4 a[232:235], v172, s[28:31], s51 offen sc1
  v_mfma_f32_16x16x32_bf16 v[248:251], v[120:123], a[92:95], v[248:251]
  v_fma_f32 v175, v175, s70, v44
  v_mul_f32 v168, v168, v68
  s_waitcnt vmcnt(22)
  v_mfma_f32_16x16x32_bf16 a[20:23], v[124:127], a[80:83], a[20:23]
  buffer_load_dwordx4 a[236:239], v173, s[28:31], s51 offen sc1
  v_mfma_f32_16x16x32_bf16 v[196:199], v[124:127], a[84:87], v[196:199]
  v_mul_f32 v169, v169, v69
  v_mul_f32 v174, v174, v70
  v_mfma_f32_16x16x32_bf16 v[224:227], v[124:127], a[88:91], v[224:227]
  v_mul_f32 v175, v175, v71
  v_mfma_f32_16x16x32_bf16 v[252:255], v[124:127], a[92:95], v[252:255]
  s_waitcnt vmcnt(22)
  v_mfma_f32_16x16x32_bf16 a[24:27], v[128:131], a[80:83], a[24:27]
  v_mfma_f32_16x16x32_bf16 v[200:203], v[128:131], a[84:87], v[200:203]
  v_mfma_f32_16x16x32_bf16 v[228:231], v[128:131], a[88:91], v[228:231]
  v_mfma_f32_16x16x32_bf16 a[28:31], v[128:131], a[92:95], a[28:31]
  s_waitcnt vmcnt(21)
  v_mfma_f32_16x16x32_bf16 a[0:3], v[132:135], a[32:35], a[0:3]
  s_add_u32 s52, s27, 1824768
  buffer_load_dwordx4 v[104:107], v4, s[28:31], s52 offen offset:0 sc1
  v_mfma_f32_16x16x32_bf16 v[176:179], v[132:135], a[36:39], v[176:179]
  v_exp_f32 v168, v168
  v_mfma_f32_16x16x32_bf16 v[204:207], v[132:135], a[40:43], v[204:207]
  buffer_load_dwordx4 v[108:111], v4, s[28:31], s52 offen offset:1024 sc1
  v_mfma_f32_16x16x32_bf16 v[232:235], v[132:135], a[44:47], v[232:235]
  v_exp_f32 v169, v169
  s_waitcnt vmcnt(22)
  v_mfma_f32_16x16x32_bf16 a[4:7], v[136:139], a[32:35], a[4:7]
  buffer_load_dwordx4 v[112:115], v4, s[28:31], s52 offen offset:2048 sc1
  v_mfma_f32_16x16x32_bf16 v[180:183], v[136:139], a[36:39], v[180:183]
  v_exp_f32 v174, v174
  v_mfma_f32_16x16x32_bf16 v[208:211], v[136:139], a[40:43], v[208:211]
  buffer_load_dwordx4 v[116:119], v4, s[28:31], s52 offen offset:3072 sc1
  v_mfma_f32_16x16x32_bf16 v[236:239], v[136:139], a[44:47], v[236:239]
  v_exp_f32 v175, v175
  s_waitcnt vmcnt(23)
  v_mfma_f32_16x16x32_bf16 a[8:11], v[140:143], a[32:35], a[8:11]
  buffer_load_dwordx4 v[120:123], v5, s[28:31], s52 offen offset:0 sc1
  v_mfma_f32_16x16x32_bf16 v[184:187], v[140:143], a[36:39], v[184:187]
  v_add_f32 v168, 1.0, v168
  v_add_f32 v169, 1.0, v169
  v_mfma_f32_16x16x32_bf16 v[212:215], v[140:143], a[40:43], v[212:215]
  buffer_load_dwordx4 v[124:127], v5, s[28:31], s52 offen offset:1024 sc1
  v_mfma_f32_16x16x32_bf16 v[240:243], v[140:143], a[44:47], v[240:243]
  v_add_f32 v174, 1.0, v174
  v_add_f32 v175, 1.0, v175
  s_waitcnt vmcnt(24)
  v_mfma_f32_16x16x32_bf16 a[12:15], v[144:147], a[32:35], a[12:15]
  buffer_load_dwordx4 v[128:131], v7, s[28:31], s52 offen offset:0 sc1
  v_mfma_f32_16x16x32_bf16 v[188:191], v[144:147], a[36:39], v[188:191]
  v_rcp_f32 v168, v168
  v_mfma_f32_16x16x32_bf16 v[216:219], v[144:147], a[40:43], v[216:219]
  v_rcp_f32 v169, v169
  v_mfma_f32_16x16x32_bf16 v[244:247], v[144:147], a[44:47], v[244:247]
  v_rcp_f32 v174, v174
  s_waitcnt vmcnt(24)
  v_mfma_f32_16x16x32_bf16 a[16:19], v[148:151], a[32:35], a[16:19]
  v_rcp_f32 v175, v175
  v_mfma_f32_16x16x32_bf16 v[192:195], v[148:151], a[36:39], v[192:195]
  v_mul_f32 v68, v68, v168
  v_mul_f32 v69, v69, v169
  v_mfma_f32_16x16x32_bf16 v[220:223], v[148:151], a[40:43], v[220:223]
  v_mul_f32 v70, v70, v174
  v_mul_f32 v71, v71, v175
  v_mfma_f32_16x16x32_bf16 v[248:251], v[148:151], a[44:47], v[248:251]
  s_waitcnt vmcnt(23)
  v_mfma_f32_16x16x32_bf16 a[20:23], v[152:155], a[32:35], a[20:23]
  v_mfma_f32_16x16x32_bf16 v[196:199], v[152:155], a[36:39], v[196:199]
  v_mfma_f32_16x16x32_bf16 v[224:227], v[152:155], a[40:43], v[224:227]
  v_mfma_f32_16x16x32_bf16 v[252:255], v[152:155], a[44:47], v[252:255]
  s_waitcnt vmcnt(22)
  v_mfma_f32_16x16x32_bf16 a[24:27], v[156:159], a[32:35], a[24:27]
  v_mfma_f32_16x16x32_bf16 v[200:203], v[156:159], a[36:39], v[200:203]
  v_mfma_f32_16x16x32_bf16 v[228:231], v[156:159], a[40:43], v[228:231]
  v_mfma_f32_16x16x32_bf16 a[28:31], v[156:159], a[44:47], a[28:31]
  s_waitcnt vmcnt(17)
  v_mfma_f32_16x16x32_bf16 a[0:3], v[76:79], a[48:51], a[0:3]
  s_add_u32 s52, s27, 0
  buffer_load_dwordx4 v[132:135], v4, s[28:31], s52 offen offset:0 sc1
  v_mfma_f32_16x16x32_bf16 v[176:179], v[76:79], a[52:55], v[176:179]
  s_waitcnt lgkmcnt(1)
  v_fmac_f32 v72, v164, v160
  v_fmac_f32 v73, v165, v160
  v_mfma_f32_16x16x32_bf16 v[204:207], v[76:79], a[56:59], v[204:207]
  buffer_load_dwordx4 v[136:139], v4, s[28:31], s52 offen offset:1024 sc1
  v_mfma_f32_16x16x32_bf16 v[232:235], v[76:79], a[60:63], v[232:235]
  v_fmac_f32 v74, v166, v160
  v_fmac_f32 v75, v167, v160
  s_waitcnt vmcnt(18)
  v_mfma_f32_16x16x32_bf16 a[4:7], v[80:83], a[48:51], a[4:7]
  buffer_load_dwordx4 v[140:143], v4, s[28:31], s52 offen offset:2048 sc1
  v_mfma_f32_16x16x32_bf16 v[180:183], v[80:83], a[52:55], v[180:183]
  s_waitcnt lgkmcnt(0)
  v_fma_f32 v72, v72, v162, v8
  v_fma_f32 v73, v73, v162, v9
  v_mfma_f32_16x16x32_bf16 v[208:211], v[80:83], a[56:59], v[208:211]
  buffer_load_dwordx4 v[144:147], v4, s[28:31], s52 offen offset:3072 sc1
  v_mfma_f32_16x16x32_bf16 v[236:239], v[80:83], a[60:63], v[236:239]
  v_fma_f32 v74, v74, v162, v10
  v_fma_f32 v75, v75, v162, v11
  s_waitcnt vmcnt(19)
  v_mfma_f32_16x16x32_bf16 a[8:11], v[84:87], a[48:51], a[8:11]
  buffer_load_dwordx4 v[148:151], v5, s[28:31], s52 offen offset:0 sc1
  v_mfma_f32_16x16x32_bf16 v[184:187], v[84:87], a[52:55], v[184:187]
  v_mul_f32 v168, v72, v72
  v_mul_f32 v169, v73, v73
  v_mfma_f32_16x16x32_bf16 v[212:215], v[84:87], a[56:59], v[212:215]
  buffer_load_dwordx4 v[152:155], v5, s[28:31], s52 offen offset:1024 sc1
  v_mfma_f32_16x16x32_bf16 v[240:243], v[84:87], a[60:63], v[240:243]
  v_mul_f32 v174, v74, v74
  v_mul_f32 v175, v75, v75
  s_waitcnt vmcnt(20)
  v_mfma_f32_16x16x32_bf16 a[12:15], v[88:91], a[48:51], a[12:15]
  buffer_load_dwordx4 v[156:159], v7, s[28:31], s52 offen offset:0 sc1
  v_mfma_f32_16x16x32_bf16 v[188:191], v[88:91], a[52:55], v[188:191]
  v_fma_f32 v168, v168, s70, v44
  v_fma_f32 v169, v169, s70, v44
  v_mfma_f32_16x16x32_bf16 v[216:219], v[88:91], a[56:59], v[216:219]
  v_fma_f32 v174, v174, s70, v44
  v_fma_f32 v175, v175, s70, v44
  v_mfma_f32_16x16x32_bf16 v[244:247], v[88:91], a[60:63], v[244:247]
  v_mul_f32 v168, v168, v72
  v_mul_f32 v169, v169, v73
  s_waitcnt vmcnt(20)
  v_mfma_f32_16x16x32_bf16 a[16:19], v[92:95], a[48:51], a[16:19]
  v_mul_f32 v174, v174, v74
  v_mul_f32 v175, v175, v75
  v_mfma_f32_16x16x32_bf16 v[192:195], v[92:95], a[52:55], v[192:195]
  v_mfma_f32_16x16x32_bf16 v[220:223], v[92:95], a[56:59], v[220:223]
  v_mfma_f32_16x16x32_bf16 v[248:251], v[92:95], a[60:63], v[248:251]
  s_waitcnt vmcnt(19)
  v_mfma_f32_16x16x32_bf16 a[20:23], v[96:99], a[48:51], a[20:23]
  v_mfma_f32_16x16x32_bf16 v[196:199], v[96:99], a[52:55], v[196:199]
  v_mfma_f32_16x16x32_bf16 v[224:227], v[96:99], a[56:59], v[224:227]
  v_mfma_f32_16x16x32_bf16 v[252:255], v[96:99], a[60:63], v[252:255]
  s_waitcnt vmcnt(18)
  v_mfma_f32_16x16x32_bf16 a[24:27], v[100:103], a[48:51], a[24:27]
  v_mfma_f32_16x16x32_bf16 v[200:203], v[100:103], a[52:55], v[200:203]
  v_mfma_f32_16x16x32_bf16 v[228:231], v[100:103], a[56:59], v[228:231]
  v_mfma_f32_16x16x32_bf16 a[28:31], v[100:103], a[60:63], a[28:31]
  s_waitcnt vmcnt(13)
  v_mfma_f32_16x16x32_bf16 a[0:3], v[104:107], a[64:67], a[0:3]
  s_add_u32 s52, s27, 55296
  buffer_load_dwordx4 v[76:79], v4, s[28:31], s52 offen offset:0 sc1
  v_mfma_f32_16x16x32_bf16 v[176:179], v[104:107], a[68:71], v[176:179]
  v_exp_f32 v168, v168
  v_mfma_f32_16x16x32_bf16 v[204:207], v[104:107], a[72:75], v[204:207]
  buffer_load_dwordx4 v[80:83], v4, s[28:31], s52 offen offset:1024 sc1
  v_mfma_f32_16x16x32_bf16 v[232:235], v[104:107], a[76:79], v[232:235]
  v_exp_f32 v169, v169
  s_waitcnt vmcnt(14)
  v_mfma_f32_16x16x32_bf16 a[4:7], v[108:111], a[64:67], a[4:7]
  buffer_load_dwordx4 v[84:87], v4, s[28:31], s52 offen offset:2048 sc1
  v_mfma_f32_16x16x32_bf16 v[180:183], v[108:111], a[68:71], v[180:183]
  v_exp_f32 v174, v174
  v_mfma_f32_16x16x32_bf16 v[208:211], v[108:111], a[72:75], v[208:211]
  buffer_load_dwordx4 v[88:91], v4, s[28:31], s52 offen offset:3072 sc1
  v_mfma_f32_16x16x32_bf16 v[236:239], v[108:111], a[76:79], v[236:239]
  v_exp_f32 v175, v175
  s_waitcnt vmcnt(15)
  v_mfma_f32_16x16x32_bf16 a[8:11], v[112:115], a[64:67], a[8:11]
  buffer_load_dwordx4 v[92:95], v5, s[28:31], s52 offen offset:0 sc1
  v_mfma_f32_16x16x32_bf16 v[184:187], v[112:115], a[68:71], v[184:187]
  v_add_f32 v168, 1.0, v168
  v_add_f32 v169, 1.0, v169
  v_mfma_f32_16x16x32_bf16 v[212:215], v[112:115], a[72:75], v[212:215]
  buffer_load_dwordx4 v[96:99], v5, s[28:31], s52 offen offset:1024 sc1
  v_mfma_f32_16x16x32_bf16 v[240:243], v[112:115], a[76:79], v[240:243]
  v_add_f32 v174, 1.0, v174
  v_add_f32 v175, 1.0, v175
  s_waitcnt vmcnt(16)
  v_mfma_f32_16x16x32_bf16 a[12:15], v[116:119], a[64:67], a[12:15]
  buffer_load_dwordx4 v[100:103], v7, s[28:31], s52 offen offset:0 sc1
  v_mfma_f32_16x16x32_bf16 v[188:191], v[116:119], a[68:71], v[188:191]
  v_rcp_f32 v168, v168
  v_mfma_f32_16x16x32_bf16 v[216:219], v[116:119], a[72:75], v[216:219]
  v_rcp_f32 v169, v169
  v_mfma_f32_16x16x32_bf16 v[244:247], v[116:119], a[76:79], v[244:247]
  v_rcp_f32 v174, v174
  s_waitcnt vmcnt(16)
  v_mfma_f32_16x16x32_bf16 a[16:19], v[120:123], a[64:67], a[16:19]
  v_rcp_f32 v175, v175
  v_mfma_f32_16x16x32_bf16 v[192:195], v[120:123], a[68:71], v[192:195]
  v_mul_f32 v72, v72, v168
  v_mul_f32 v73, v73, v169
  v_mfma_f32_16x16x32_bf16 v[220:223], v[120:123], a[72:75], v[220:223]
  v_mul_f32 v74, v74, v174
  v_mul_f32 v75, v75, v175
  v_mfma_f32_16x16x32_bf16 v[248:251], v[120:123], a[76:79], v[248:251]
  s_waitcnt vmcnt(15)
  v_mfma_f32_16x16x32_bf16 a[20:23], v[124:127], a[64:67], a[20:23]
  v_mfma_f32_16x16x32_bf16 v[196:199], v[124:127], a[68:71], v[196:199]
  v_mfma_f32_16x16x32_bf16 v[224:227], v[124:127], a[72:75], v[224:227]
  v_mfma_f32_16x16x32_bf16 v[252:255], v[124:127], a[76:79], v[252:255]
  s_waitcnt vmcnt(14)
  v_mfma_f32_16x16x32_bf16 a[24:27], v[128:131], a[64:67], a[24:27]
  v_mfma_f32_16x16x32_bf16 v[200:203], v[128:131], a[68:71], v[200:203]
  v_mfma_f32_16x16x32_bf16 v[228:231], v[128:131], a[72:75], v[228:231]
  v_mfma_f32_16x16x32_bf16 a[28:31], v[128:131], a[76:79], a[28:31]
  s_barrier
  s_waitcnt vmcnt(13)
  v_mfma_f32_16x16x32_bf16 a[0:3], v[132:135], a[240:243], a[0:3]
  s_add_u32 s52, s60, 0
  v_lshlrev_b32 v168, 2, v2
  v_sub_u32 v168, v1, v168
  v_mfma_f32_16x16x32_bf16 v[176:179], v[132:135], a[244:247], v[176:179]
  s_add_u32 m0, s76, 49152
  v_mov_b32 v169, 0x3f80
  v_mov_b32 v174, 0x3f800000
  v_mfma_f32_16x16x32_bf16 v[204:207], v[132:135], a[248:251], v[204:207]
  s_add_u32 s65, s48, 1
  buffer_load_dwordx4 v4, s[28:31], s52 offen offset:0 sc1 lds
  v_mfma_f32_16x16x32_bf16 v[232:235], v[132:135], a[252:255], v[232:235]
  s_and_b32 s65, s65, 3
  v_cmp_eq_u32 vcc, 0, v168
  s_waitcnt vmcnt(13)
  v_mfma_f32_16x16x32_bf16 a[4:7], v[136:139], a[240:243], a[4:7]
  s_mul_i32 s65, s65, 12288
  v_cndmask_b32 v164, 0, v169, vcc
  v_cmp_eq_u32 vcc, 1, v168
  v_mfma_f32_16x16x32_bf16 v[180:183], v[136:139], a[244:247], v[180:183]
  s_add_u32 s65, s65, 0
  v_add_u32 v161, s65, v3
  v_cndmask_b32 v164, v164, v174, vcc
  v_mfma_f32_16x16x32_bf16 v[208:211], v[136:139], a[248:251], v[208:211]
  s_add_u32 s65, s48, 2
  buffer_load_dwordx4 v4, s[28:31], s52 offen offset:1024 sc1 lds
  v_mfma_f32_16x16x32_bf16 v[236:239], v[136:139], a[252:255], v[236:239]
  s_and_b32 s65, s65, 3
  v_cmp_eq_u32 vcc, 2, v168
  s_waitcnt vmcnt(13)
  v_mfma_f32_16x16x32_bf16 a[8:11], v[140:143], a[240:243], a[8:11]
  s_mul_i32 s65, s65, 12288
  v_cndmask_b32 v165, 0, v169, vcc
  v_cmp_eq_u32 vcc, 3, v168
  v_mfma_f32_16x16x32_bf16 v[184:187], v[140:143], a[244:247], v[184:187]
  s_add_u32 s65, s65, 4096
  v_add_u32 v162, s65, v3
  v_cndmask_b32 v165, v165, v174, vcc
  v_mfma_f32_16x16x32_bf16 v[212:215], v[140:143], a[248:251], v[212:215]
  s_add_u32 s65, s48, 3
  buffer_load_dwordx4 v4, s[28:31], s52 offen offset:2048 sc1 lds
  v_mfma_f32_16x16x32_bf16 v[240:243], v[140:143], a[252:255], v[240:243]
  s_and_b32 s65, s65, 3
  v_mov_b32 v166, 0
  v_mov_b32 v167, 0
  s_waitcnt vmcnt(13)
  v_mfma_f32_16x16x32_bf16 a[12:15], v[144:147], a[240:243], a[12:15]
  s_mul_i32 s65, s65, 12288
  v_mov_b32 v44, 0
  v_mov_b32 v45, 0
  v_mfma_f32_16x16x32_bf16 v[188:191], v[144:147], a[244:247], v[188:191]
  s_add_u32 s65, s65, 8192
  v_add_u32 v163, s65, v3
  v_mov_b32 v46, v164
  v_mfma_f32_16x16x32_bf16 v[216:219], v[144:147], a[248:251], v[216:219]
  s_mul_i32 s65, s48, 12288
  buffer_load_dwordx4 v4, s[28:31], s52 offen offset:3072 sc1 lds
  v_mfma_f32_16x16x32_bf16 v[244:247], v[144:147], a[252:255], v[244:247]
  v_add_u32 v160, s65, v3
  v_add_u32 v8, 65536, v3
  s_waitcnt vmcnt(13)
  v_mfma_f32_16x16x32_bf16 a[16:19], v[148:151], a[240:243], a[16:19]
  v_add_u32 v9, 131072, v3
  v_mov_b32 v47, v165
  v_mfma_f32_16x16x32_bf16 v[192:195], v[148:151], a[244:247], v[192:195]
  v_lshlrev_b32 v42, 16, v42
  v_mfma_f32_16x16x32_bf16 v[220:223], v[148:151], a[248:251], v[220:223]
  s_add_u32 m0, s76, 53248
  v_mfma_f32_16x16x32_bf16 v[248:251], v[148:151], a[252:255], v[248:251]
  buffer_load_dwordx4 v6, s[28:31], s52 offen offset:0 sc1 lds
  s_waitcnt vmcnt(13)
  v_mfma_f32_16x16x32_bf16 a[20:23], v[152:155], a[240:243], a[20:23]
  v_mfma_f32_16x16x32_bf16 v[196:199], v[152:155], a[244:247], v[196:199]
  v_mfma_f32_16x16x32_bf16 v[224:227], v[152:155], a[248:251], v[224:227]
  v_mfma_f32_16x16x32_bf16 v[252:255], v[152:155], a[252:255], v[252:255]
  s_add_u32 s52, s60, 163840
  s_waitcnt vmcnt(12)
  v_mfma_f32_16x16x32_bf16 a[24:27], v[156:159], a[240:243], a[24:27]
  s_add_u32 m0, s76, 69632
  v_mfma_f32_16x16x32_bf16 v[200:203], v[156:159], a[244:247], v[200:203]
  buffer_load_dwordx4 v4, s[28:31], s52 offen offset:0 sc1 lds
  v_mfma_f32_16x16x32_bf16 v[228:231], v[156:159], a[248:251], v[228:231]
  v_mfma_f32_16x16x32_bf16 a[28:31], v[156:159], a[252:255], a[28:31]
  buffer_load_dwordx4 v4, s[28:31], s52 offen offset:1024 sc1 lds
  s_waitcnt vmcnt(13)
  v_mfma_f32_16x16x32_bf16 v[232:235], v[76:79], a[236:239], v[232:235]
  buffer_load_dwordx4 v4, s[28:31], s52 offen offset:2048 sc1 lds
  s_waitcnt vmcnt(13)
  v_mfma_f32_16x16x32_bf16 v[236:239], v[80:83], a[236:239], v[236:239]
  s_waitcnt vmcnt(12)
  v_mfma_f32_16x16x32_bf16 v[240:243], v[84:87], a[236:239], v[240:243]
  s_waitcnt vmcnt(11)
  v_mfma_f32_16x16x32_bf16 v[244:247], v[88:91], a[236:239], v[244:247]
  s_waitcnt vmcnt(10)
  v_mfma_f32_16x16x32_bf16 v[248:251], v[92:95], a[236:239], v[248:251]
  buffer_load_dwordx4 v4, s[28:31], s52 offen offset:3072 sc1 lds
  s_waitcnt vmcnt(10)
  v_mfma_f32_16x16x32_bf16 v[252:255], v[96:99], a[236:239], v[252:255]
  s_waitcnt vmcnt(9)
  v_mfma_f32_16x16x32_bf16 a[28:31], v[100:103], a[236:239], a[28:31]
  v_cvt_pk_bf16_f32 v232, v232, v233
  v_cvt_pk_bf16_f32 v233, v234, v235
  v_mfma_f32_16x16x32_bf16 v[176:179], v[76:79], a[228:231], v[176:179]
  v_cvt_pk_bf16_f32 v234, v236, v237
  v_cvt_pk_bf16_f32 v235, v238, v239
  v_mfma_f32_16x16x32_bf16 v[180:183], v[80:83], a[228:231], v[180:183]
  s_add_u32 m0, s76, 73728
  ds_write_b128 v163, v[232:235] offset:0
  v_mfma_f32_16x16x32_bf16 v[184:187], v[84:87], a[228:231], v[184:187]
  buffer_load_dwordx4 v6, s[28:31], s52 offen offset:0 sc1 lds
  v_mfma_f32_16x16x32_bf16 v[188:191], v[88:91], a[228:231], v[188:191]
  v_cvt_pk_bf16_f32 v240, v240, v241
  v_cvt_pk_bf16_f32 v241, v242, v243
  v_mfma_f32_16x16x32_bf16 v[192:195], v[92:95], a[228:231], v[192:195]
  v_cvt_pk_bf16_f32 v242, v244, v245
  v_cvt_pk_bf16_f32 v243, v246, v247
  v_mfma_f32_16x16x32_bf16 v[196:199], v[96:99], a[228:231], v[196:199]
  ds_write_b128 v163, v[240:243] offset:1024
  v_mfma_f32_16x16x32_bf16 v[200:203], v[100:103], a[228:231], v[200:203]
  s_add_u32 s52, s60, 327680
  v_cvt_pk_bf16_f32 v248, v248, v249
  v_cvt_pk_bf16_f32 v249, v250, v251
  v_mfma_f32_16x16x32_bf16 v[204:207], v[76:79], a[232:235], v[204:207]
  s_add_u32 m0, s76, 90112
  v_cvt_pk_bf16_f32 v250, v252, v253
  v_cvt_pk_bf16_f32 v251, v254, v255
  v_mfma_f32_16x16x32_bf16 v[208:211], v[80:83], a[232:235], v[208:211]
  buffer_load_dwordx4 v4, s[28:31], s52 offen offset:0 sc1 lds
  v_mfma_f32_16x16x32_bf16 v[212:215], v[84:87], a[232:235], v[212:215]
  ds_write_b128 v163, v[248:251] offset:2048
  v_mfma_f32_16x16x32_bf16 v[216:219], v[88:91], a[232:235], v[216:219]
  v_accvgpr_read_b32 v104, a28
  v_accvgpr_read_b32 v105, a29
  v_mfma_f32_16x16x32_bf16 v[220:223], v[92:95], a[232:235], v[220:223]
  v_accvgpr_read_b32 v106, a30
  v_accvgpr_read_b32 v107, a31
  v_mfma_f32_16x16x32_bf16 v[224:227], v[96:99], a[232:235], v[224:227]
  buffer_load_dwordx4 v4, s[28:31], s52 offen offset:1024 sc1 lds
  v_mfma_f32_16x16x32_bf16 v[228:231], v[100:103], a[232:235], v[228:231]
  v_cvt_pk_bf16_f32 v104, v104, v105
  v_cvt_pk_bf16_f32 v105, v106, v107
  v_mfma_f32_16x16x32_bf16 a[0:3], v[76:79], a[224:227], a[0:3]
  v_mov_b32 v106, 0
  v_mov_b32 v107, 0
  v_mfma_f32_16x16x32_bf16 a[4:7], v[80:83], a[224:227], a[4:7]
  ds_write_b128 v163, v[104:107] offset:3072
  v_mfma_f32_16x16x32_bf16 a[8:11], v[84:87], a[224:227], a[8:11]
  buffer_load_dwordx4 v4, s[28:31], s52 offen offset:2048 sc1 lds
  v_mfma_f32_16x16x32_bf16 a[12:15], v[88:91], a[224:227], a[12:15]
  v_cvt_pk_bf16_f32 v176, v176, v177
  v_cvt_pk_bf16_f32 v177, v178, v179
  v_mfma_f32_16x16x32_bf16 a[16:19], v[92:95], a[224:227], a[16:19]
  v_cvt_pk_bf16_f32 v178, v180, v181
  v_cvt_pk_bf16_f32 v179, v182, v183
  v_mfma_f32_16x16x32_bf16 a[20:23], v[96:99], a[224:227], a[20:23]
  ds_write_b128 v161, v[176:179] offset:0
  v_mfma_f32_16x16x32_bf16 a[24:27], v[100:103], a[224:227], a[24:27]
  buffer_load_dwordx4 v4, s[28:31], s52 offen offset:3072 sc1 lds
  v_cvt_pk_bf16_f32 v184, v184, v185
  v_cvt_pk_bf16_f32 v185, v186, v187
  v_cvt_pk_bf16_f32 v186, v188, v189
  v_cvt_pk_bf16_f32 v187, v190, v191
  ds_write_b128 v161, v[184:187] offset:1024
  s_add_u32 m0, s76, 94208
  s_nop 0
  buffer_load_dwordx4 v6, s[28:31], s52 offen offset:0 sc1 lds
  v_cvt_pk_bf16_f32 v192, v192, v193
  v_cvt_pk_bf16_f32 v193, v194, v195
  v_cvt_pk_bf16_f32 v194, v196, v197
  v_cvt_pk_bf16_f32 v195, v198, v199
  ds_write_b128 v161, v[192:195] offset:2048
  s_add_u32 s52, s60, 491520
  s_add_u32 m0, s76, 110592
  s_nop 0
  buffer_load_dwordx4 v4, s[28:31], s52 offen offset:0 sc1 lds
  v_cvt_pk_bf16_f32 v200, v200, v201
  v_cvt_pk_bf16_f32 v201, v202, v203
  v_mov_b32 v202, 0
  v_mov_b32 v203, 0
  ds_write_b128 v161, v[200:203] offset:3072
  buffer_load_dwordx4 v4, s[28:31], s52 offen offset:1024 sc1 lds
  v_cvt_pk_bf16_f32 v204, v204, v205
  v_cvt_pk_bf16_f32 v205, v206, v207
  v_cvt_pk_bf16_f32 v206, v208, v209
  v_cvt_pk_bf16_f32 v207, v210, v211
  ds_write_b128 v162, v[204:207] offset:0
  buffer_load_dwordx4 v4, s[28:31], s52 offen offset:2048 sc1 lds
  v_cvt_pk_bf16_f32 v212, v212, v213
  v_cvt_pk_bf16_f32 v213, v214, v215
  v_cvt_pk_bf16_f32 v214, v216, v217
  v_cvt_pk_bf16_f32 v215, v218, v219
  ds_write_b128 v162, v[212:215] offset:1024
  buffer_load_dwordx4 v4, s[28:31], s52 offen offset:3072 sc1 lds
  v_cvt_pk_bf16_f32 v220, v220, v221
  v_cvt_pk_bf16_f32 v221, v222, v223
  v_cvt_pk_bf16_f32 v222, v224, v225
  v_cvt_pk_bf16_f32 v223, v226, v227
  ds_write_b128 v162, v[220:223] offset:2048
  s_add_u32 m0, s76, 114688
  s_nop 0
  buffer_load_dwordx4 v6, s[28:31], s52 offen offset:0 sc1 lds
  v_cvt_pk_bf16_f32 v228, v228, v229
  v_cvt_pk_bf16_f32 v229, v230, v231
  v_mov_b32 v230, 0
  v_mov_b32 v231, 0
  ds_write_b128 v162, v[228:231] offset:3072
  s_add_u32 s52, s60, 655360
  s_add_u32 m0, s76, 131072
  s_nop 0
  buffer_load_dwordx4 v4, s[28:31], s52 offen offset:0 sc1 lds
  s_waitcnt lgkmcnt(0)
  s_barrier
  ds_read_b128 v[108:111], v160 offset:0
  ds_read_b128 v[124:127], v160 offset:4096
  ds_read_b128 v[140:143], v160 offset:8192
  ds_read_b128 v[112:115], v160 offset:1024
  ds_read_b128 v[128:131], v160 offset:5120
  ds_read_b128 v[144:147], v160 offset:9216
  ds_read_b128 v[116:119], v160 offset:2048
  ds_read_b128 v[132:135], v160 offset:6144
  ds_read_b128 v[148:151], v160 offset:10240
  ds_read_b128 v[120:123], v160 offset:3072
  ds_read_b128 v[136:139], v160 offset:7168
  ds_read_b128 v[152:155], v160 offset:11264
  s_waitcnt lgkmcnt(11)
  v_mfma_f32_16x16x32_bf16 a[0:3], v[164:167], v[108:111], a[0:3]
  s_waitcnt lgkmcnt(10)
  v_mfma_f32_16x16x32_bf16 a[0:3], v[164:167], v[124:127], a[0:3]
  buffer_load_dwordx4 v4, s[28:31], s52 offen offset:1024 sc1 lds
  s_waitcnt lgkmcnt(9)
  v_mfma_f32_16x16x32_bf16 a[0:3], v[164:167], v[140:143], a[0:3]
  v_mfma_f32_16x16x32_bf16 a[4:7], v[44:47], v[108:111], a[4:7]
  v_mfma_f32_16x16x32_bf16 a[4:7], v[44:47], v[124:127], a[4:7]
  buffer_load_dwordx4 v4, s[28:31], s52 offen offset:2048 sc1 lds
  v_mfma_f32_16x16x32_bf16 a[4:7], v[44:47], v[140:143], a[4:7]
  s_waitcnt lgkmcnt(8)
  v_mfma_f32_16x16x32_bf16 a[8:11], v[164:167], v[112:115], a[8:11]
  s_waitcnt lgkmcnt(7)
  v_mfma_f32_16x16x32_bf16 a[8:11], v[164:167], v[128:131], a[8:11]
  buffer_load_dwordx4 v4, s[28:31], s52 offen offset:3072 sc1 lds
  s_waitcnt lgkmcnt(6)
  v_mfma_f32_16x16x32_bf16 a[8:11], v[164:167], v[144:147], a[8:11]
  v_accvgpr_read_b32 v176, a0
  v_accvgpr_read_b32 v177, a1
  v_mfma_f32_16x16x32_bf16 a[12:15], v[44:47], v[112:115], a[12:15]
  v_accvgpr_read_b32 v178, a2
  v_accvgpr_read_b32 v179, a3
  s_add_u32 m0, s76, 135168
  v_mfma_f32_16x16x32_bf16 a[12:15], v[44:47], v[128:131], a[12:15]
  buffer_load_dwordx4 v6, s[28:31], s52 offen offset:0 sc1 lds
  v_mfma_f32_16x16x32_bf16 a[12:15], v[44:47], v[144:147], a[12:15]
  v_accvgpr_read_b32 v180, a4
  v_accvgpr_read_b32 v181, a5
  s_waitcnt lgkmcnt(5)
  v_mfma_f32_16x16x32_bf16 a[16:19], v[164:167], v[116:119], a[16:19]
  v_accvgpr_read_b32 v182, a6
  v_accvgpr_read_b32 v183, a7
  s_waitcnt lgkmcnt(4)
  v_mfma_f32_16x16x32_bf16 a[16:19], v[164:167], v[132:135], a[16:19]
  s_waitcnt lgkmcnt(3)
  v_mfma_f32_16x16x32_bf16 a[16:19], v[164:167], v[148:151], a[16:19]
  v_accvgpr_read_b32 v184, a8
  v_accvgpr_read_b32 v185, a9
  v_mfma_f32_16x16x32_bf16 a[20:23], v[44:47], v[116:119], a[20:23]
  v_accvgpr_read_b32 v186, a10
  v_accvgpr_read_b32 v187, a11
  v_mfma_f32_16x16x32_bf16 a[20:23], v[44:47], v[132:135], a[20:23]
  v_mfma_f32_16x16x32_bf16 a[20:23], v[44:47], v[148:151], a[20:23]
  v_accvgpr_read_b32 v188, a12
  v_accvgpr_read_b32 v189, a13
  s_waitcnt lgkmcnt(2)
  v_mfma_f32_16x16x32_bf16 a[24:27], v[164:167], v[120:123], a[24:27]
  v_accvgpr_read_b32 v190, a14
  v_accvgpr_read_b32 v191, a15
  s_waitcnt lgkmcnt(1)
  v_mfma_f32_16x16x32_bf16 a[24:27], v[164:167], v[136:139], a[24:27]
  s_waitcnt lgkmcnt(0)
  v_mfma_f32_16x16x32_bf16 a[24:27], v[164:167], v[152:155], a[24:27]
  v_accvgpr_read_b32 v192, a16
  v_accvgpr_read_b32 v193, a17
  v_accvgpr_read_b32 v194, a18
  v_accvgpr_read_b32 v195, a19
  v_accvgpr_read_b32 v196, a20
  v_accvgpr_read_b32 v197, a21
  v_accvgpr_read_b32 v198, a22
  v_accvgpr_read_b32 v199, a23
  v_accvgpr_read_b32 v200, a24
  v_accvgpr_read_b32 v201, a25
  v_accvgpr_read_b32 v202, a26
  v_accvgpr_read_b32 v203, a27
  s_barrier
  v_pk_add_f32 v[176:177], v[176:177], v[42:43] op_sel_hi:[1,0]
  v_pk_add_f32 v[178:179], v[178:179], v[42:43] op_sel_hi:[1,0]
  v_pk_add_f32 v[180:181], v[180:181], v[42:43] op_sel_hi:[1,0]
  v_pk_add_f32 v[182:183], v[182:183], v[42:43] op_sel_hi:[1,0]
  v_pk_add_f32 v[184:185], v[184:185], v[42:43] op_sel_hi:[1,0]
  v_pk_add_f32 v[186:187], v[186:187], v[42:43] op_sel_hi:[1,0]
  v_pk_add_f32 v[188:189], v[188:189], v[42:43] op_sel_hi:[1,0]
  v_pk_add_f32 v[190:191], v[190:191], v[42:43] op_sel_hi:[1,0]
  v_pk_add_f32 v[192:193], v[192:193], v[42:43] op_sel_hi:[1,0]
  v_pk_add_f32 v[194:195], v[194:195], v[42:43] op_sel_hi:[1,0]
  v_pk_add_f32 v[196:197], v[196:197], v[42:43] op_sel_hi:[1,0]
  v_pk_add_f32 v[198:199], v[198:199], v[42:43] op_sel_hi:[1,0]
  v_pk_add_f32 v[200:201], v[200:201], v[42:43] op_sel_hi:[1,0]
  v_pk_add_f32 v[202:203], v[202:203], v[42:43] op_sel_hi:[1,0]
  v_pk_mul_f32 v[176:177], v[176:177], v[48:49]
  v_pk_mul_f32 v[178:179], v[178:179], v[50:51]
  v_pk_mul_f32 v[180:181], v[180:181], v[52:53]
  v_pk_mul_f32 v[182:183], v[182:183], v[54:55]
  v_pk_mul_f32 v[184:185], v[184:185], v[56:57]
  v_pk_mul_f32 v[186:187], v[186:187], v[58:59]
  v_pk_mul_f32 v[188:189], v[188:189], v[60:61]
  v_pk_mul_f32 v[190:191], v[190:191], v[62:63]
  v_pk_mul_f32 v[192:193], v[192:193], v[64:65]
  v_pk_mul_f32 v[194:195], v[194:195], v[66:67]
  v_pk_mul_f32 v[196:197], v[196:197], v[68:69]
  v_pk_mul_f32 v[198:199], v[198:199], v[70:71]
  v_pk_mul_f32 v[200:201], v[200:201], v[72:73]
  v_pk_mul_f32 v[202:203], v[202:203], v[74:75]
  v_cvt_pk_bf16_f32 v176, v176, v177
  v_cvt_pk_bf16_f32 v177, v178, v179
  v_cvt_pk_bf16_f32 v178, v180, v181
  v_cvt_pk_bf16_f32 v179, v182, v183
  v_cvt_pk_bf16_f32 v180, v184, v185
  v_cvt_pk_bf16_f32 v181, v186, v187
  v_cvt_pk_bf16_f32 v182, v188, v189
  v_cvt_pk_bf16_f32 v183, v190, v191
  v_cvt_pk_bf16_f32 v184, v192, v193
  v_cvt_pk_bf16_f32 v185, v194, v195
  v_cvt_pk_bf16_f32 v186, v196, v197
  v_cvt_pk_bf16_f32 v187, v198, v199
  v_cvt_pk_bf16_f32 v188, v200, v201
  v_cvt_pk_bf16_f32 v189, v202, v203
  s_mul_i32 s51, s42, 110592
  s_lshl_b32 s52, s48, 10
  s_add_u32 s51, s51, s52
  s_add_u32 s51, s51, 97517568
  s_lshl_b32 s52, s56, 11
  s_add_u32 s52, s52, s51
  buffer_store_dwordx4 v[176:179], v3, s[28:31], s52 offen sc1
  s_add_u32 s52, s52, 4096
  buffer_store_dwordx4 v[180:183], v3, s[28:31], s52 offen sc1
  s_add_u32 s52, s52, 4096
  buffer_store_dwordx4 v[184:187], v3, s[28:31], s52 offen sc1
  s_add_u32 s52, s52, 4096
  s_lshr_b32 s52, s57, 1
  s_lshl_b32 s52, s52, 12
  s_add_u32 s51, s51, s52
  s_and_b32 s52, s57, 1
  s_lshl_b32 s52, s52, 3
  s_add_u32 s51, s51, s52
  s_cmp_ge_u32 s43, 6
  s_cselect_b32 s51, 0x40000000, s51
  buffer_store_dwordx2 v[188:189], v3, s[28:31], s51 offen sc1
  s_add_u32 s52, s60, 819200
  s_add_u32 m0, s76, 0
  s_nop 0
  buffer_load_dwordx4 v4, s[28:31], s52 offen offset:0 sc1 lds
  buffer_load_dwordx4 v4, s[28:31], s52 offen offset:1024 sc1 lds
  buffer_load_dwordx4 v4, s[28:31], s52 offen offset:2048 sc1 lds
  buffer_load_dwordx4 v4, s[28:31], s52 offen offset:3072 sc1 lds
  s_add_u32 m0, s76, 4096
  s_nop 0
  buffer_load_dwordx4 v6, s[28:31], s52 offen offset:0 sc1 lds
  s_add_u32 s39, s62, 128
  s_lshl_b32 s39, s39, 7
  s_add_u32 s39, s39, 589824
  v_mov_b32 v14, 1
  s_waitcnt vmcnt(5)
  buffer_atomic_add v14, v40, s[28:31], s39 offen sc0
  s_add_u32 s52, s60, 983040
  s_cmp_lt_u32 s48, 3
  s_cselect_b32 s52, s52, 0x40000000
  s_add_u32 m0, s76, 20480
  s_nop 0
  buffer_load_dwordx4 v4, s[28:31], s52 offen offset:0 sc1 lds
  buffer_load_dwordx4 v4, s[28:31], s52 offen offset:1024 sc1 lds
  buffer_load_dwordx4 v4, s[28:31], s52 offen offset:2048 sc1 lds
  buffer_load_dwordx4 v4, s[28:31], s52 offen offset:3072 sc1 lds
  s_add_u32 m0, s76, 24576
  s_nop 0
  buffer_load_dwordx4 v6, s[28:31], s52 offen offset:0 sc1 lds
  ds_read_b128 v[48:51], v38 offset:640
  ds_read_b128 v[52:55], v38 offset:704
  ds_read_b128 v[56:59], v38 offset:768
  ds_read_b128 v[60:63], v38 offset:832
  ds_read_b128 v[64:67], v38 offset:896
  s_mul_i32 s59, s42, 110592
  s_lshl_b32 s51, s48, 10
  s_add_u32 s59, s59, s51
  s_add_u32 s59, s59, 97517568
HS36:
  s_cbranch_execz HOPR_c
  s_waitcnt vmcnt(0)
  s_barrier
  ds_read_b128 v[176:179], v3 offset:49152
  ds_read_b128 v[180:183], v3 offset:54272
  ds_read_b128 v[184:187], v3 offset:59392
  ds_read_b128 v[188:191], v3 offset:50176
  ds_read_b128 v[192:195], v3 offset:55296
  ds_read_b128 v[196:199], v3 offset:60416
  ds_read_b128 v[200:203], v3 offset:51200
  ds_read_b128 v[204:207], v3 offset:56320
  ds_read_b128 v[208:211], v3 offset:61440
  ds_read_b128 v[212:215], v3 offset:52224
  v_readfirstlane_b32 s51, v14
  s_nop 0
  s_cmp_ge_u32 s51, 7
  s_cbranch_scc1 L_t_pd_ok
  s_mov_b32 s53, 0
L_t_pd_spin:
  v_mov_b32 v14, 0
  buffer_atomic_add v14, v40, s[28:31], s39 offen sc0
  s_add_u32 s53, s53, 1
  s_cmp_gt_u32 s53, 1000000
  s_waitcnt vmcnt(0)
  s_cbranch_scc1 L_t_pd_ok
  v_readfirstlane_b32 s51, v14
  s_nop 0
  s_cmp_lt_u32 s51, 8
  s_cbranch_scc1 L_t_pd_spin
L_t_pd_ok:
  s_add_u32 s51, s59, 0
  s_nop 0
  buffer_load_dwordx4 a[0:3], v3, s[28:31], s51 offen sc1
  s_add_u32 s51, s59, 4096
  buffer_load_dwordx4 a[4:7], v3, s[28:31], s51 offen sc1
  s_add_u32 s51, s59, 8192
  buffer_load_dwordx4 a[8:11], v3, s[28:31], s51 offen sc1
  s_add_u32 s51, s59, 12288
  buffer_load_dwordx4 a[12:15], v3, s[28:31], s51 offen sc1
  s_add_u32 s51, s59, 16384
  buffer_load_dwordx4 a[16:19], v3, s[28:31], s51 offen sc1
  s_add_u32 s51, s59, 20480
  buffer_load_dwordx4 a[20:23], v3, s[28:31], s51 offen sc1
  s_add_u32 s51, s59, 24576
  buffer_load_dwordx4 a[24:27], v3, s[28:31], s51 offen sc1
  s_add_u32 s51, s59, 28672
  buffer_load_dwordx4 a[28:31], v3, s[28:31], s51 offen sc1
  s_add_u32 s51, s59, 32768
  buffer_load_dwordx4 a[32:35], v3, s[28:31], s51 offen sc1
  s_waitcnt vmcnt(8) lgkmcnt(9)
  v_mfma_f32_16x16x32_bf16 v[76:79], v[176:179], a[0:3], 0
  ds_read_b128 v[216:219], v3 offset:57344
  s_add_u32 s51, s59, 36864
  s_waitcnt vmcnt(7) lgkmcnt(9)
  v_mfma_f32_16x16x32_bf16 v[76:79], v[180:183], a[4:7], v[76:79]
  s_waitcnt lgkmcnt(7)
  ds_read_b128 v[220:223], v3 offset:62464
  buffer_load_dwordx4 a[36:39], v3, s[28:31], s51 offen sc1
  s_waitcnt vmcnt(7)
  v_mfma_f32_16x16x32_bf16 v[76:79], v[184:187], a[8:11], v[76:79]
  ds_read_b128 v[176:179], v3 offset:53248
  v_mfma_f32_16x16x32_bf16 v[80:83], v[188:191], a[0:3], 0
  s_waitcnt lgkmcnt(7)
  ds_read_b128 v[180:183], v3 offset:58368
  v_mfma_f32_16x16x32_bf16 v[80:83], v[192:195], a[4:7], v[80:83]
  ds_read_b128 v[184:187], v3 offset:63488
  s_add_u32 s51, s59, 40960
  v_mfma_f32_16x16x32_bf16 v[80:83], v[196:199], a[8:11], v[80:83]
  s_waitcnt lgkmcnt(7)
  ds_read_b128 v[188:191], v3 offset:64512
  buffer_load_dwordx4 a[40:43], v3, s[28:31], s51 offen sc1
  v_mfma_f32_16x16x32_bf16 v[84:87], v[200:203], a[0:3], 0
  ds_read_b128 v[192:195], v8 offset:4096
  v_mfma_f32_16x16x32_bf16 v[84:87], v[204:207], a[4:7], v[84:87]
  s_waitcnt lgkmcnt(7)
  ds_read_b128 v[196:199], v8 offset:9216
  v_mfma_f32_16x16x32_bf16 v[84:87], v[208:211], a[8:11], v[84:87]
  ds_read_b128 v[200:203], v8 offset:0
  s_add_u32 s51, s59, 45056
  v_mfma_f32_16x16x32_bf16 v[88:91], v[212:215], a[0:3], 0
  s_waitcnt lgkmcnt(7)
  ds_read_b128 v[204:207], v8 offset:5120
  buffer_load_dwordx4 a[44:47], v3, s[28:31], s51 offen sc1
  v_mfma_f32_16x16x32_bf16 v[88:91], v[216:219], a[4:7], v[88:91]
  ds_read_b128 v[208:211], v8 offset:10240
  v_mfma_f32_16x16x32_bf16 v[88:91], v[220:223], a[8:11], v[88:91]
  s_waitcnt lgkmcnt(7)
  ds_read_b128 v[212:215], v8 offset:1024
  v_mfma_f32_16x16x32_bf16 v[92:95], v[176:179], a[0:3], 0
  ds_read_b128 v[216:219], v8 offset:6144
  s_add_u32 s51, s59, 49152
  v_mfma_f32_16x16x32_bf16 v[92:95], v[180:183], a[4:7], v[92:95]
  s_waitcnt lgkmcnt(7)
  ds_read_b128 v[220:223], v8 offset:11264
  buffer_load_dwordx4 a[48:51], v3, s[28:31], s51 offen sc1
  v_mfma_f32_16x16x32_bf16 v[92:95], v[184:187], a[8:11], v[92:95]
  ds_read_b128 v[176:179], v8 offset:2048
  s_waitcnt vmcnt(9)
  v_mfma_f32_16x16x32_bf16 v[76:79], v[188:191], a[12:15], v[76:79]
  s_waitcnt lgkmcnt(7)
  ds_read_b128 v[180:183], v8 offset:7168
  s_waitcnt vmcnt(8)
  v_mfma_f32_16x16x32_bf16 v[76:79], v[192:195], a[16:19], v[76:79]
  ds_read_b128 v[184:187], v8 offset:12288
  s_add_u32 s51, s59, 53248
  s_waitcnt vmcnt(7)
  v_mfma_f32_16x16x32_bf16 v[76:79], v[196:199], a[20:23], v[76:79]
  s_waitcnt lgkmcnt(7)
  ds_read_b128 v[188:191], v8 offset:3072
  buffer_load_dwordx4 a[52:55], v3, s[28:31], s51 offen sc1
  v_mfma_f32_16x16x32_bf16 v[80:83], v[200:203], a[12:15], v[80:83]
  ds_read_b128 v[192:195], v8 offset:8192
  v_mfma_f32_16x16x32_bf16 v[80:83], v[204:207], a[16:19], v[80:83]
  s_waitcnt lgkmcnt(7)
  ds_read_b128 v[196:199], v8 offset:13312
  v_mfma_f32_16x16x32_bf16 v[80:83], v[208:211], a[20:23], v[80:83]
  ds_read_b128 v[200:203], v8 offset:14336
  s_add_u32 s51, s59, 57344
  v_mfma_f32_16x16x32_bf16 v[84:87], v[212:215], a[12:15], v[84:87]
  s_waitcnt lgkmcnt(7)
  ds_read_b128 v[204:207], v8 offset:19456
  buffer_load_dwordx4 a[56:59], v3, s[28:31], s51 offen sc1
  v_mfma_f32_16x16x32_bf16 v[84:87], v[216:219], a[16:19], v[84:87]
  ds_read_b128 v[208:211], v8 offset:24576
  v_mfma_f32_16x16x32_bf16 v[84:87], v[220:223], a[20:23], v[84:87]
  s_waitcnt lgkmcnt(7)
  ds_read_b128 v[212:215], v8 offset:15360
  v_mfma_f32_16x16x32_bf16 v[88:91], v[176:179], a[12:15], v[88:91]
  ds_read_b128 v[216:219], v8 offset:20480
  s_add_u32 s51, s59, 61440
  v_mfma_f32_16x16x32_bf16 v[88:91], v[180:183], a[16:19], v[88:91]
  s_waitcnt lgkmcnt(7)
  ds_read_b128 v[220:223], v8 offset:25600
  buffer_load_dwordx4 a[60:63], v3, s[28:31], s51 offen sc1
  v_mfma_f32_16x16x32_bf16 v[88:91], v[184:187], a[20:23], v[88:91]
  ds_read_b128 v[176:179], v8 offset:16384
  v_mfma_f32_16x16x32_bf16 v[92:95], v[188:191], a[12:15], v[92:95]
  s_waitcnt lgkmcnt(7)
  ds_read_b128 v[180:183], v8 offset:21504
  v_mfma_f32_16x16x32_bf16 v[92:95], v[192:195], a[16:19], v[92:95]
  ds_read_b128 v[184:187], v8 offset:26624
  s_add_u32 s51, s59, 65536
  v_mfma_f32_16x16x32_bf16 v[92:95], v[196:199], a[20:23], v[92:95]
  s_waitcnt lgkmcnt(7)
  ds_read_b128 v[188:191], v8 offset:17408
  buffer_load_dwordx4 a[64:67], v3, s[28:31], s51 offen sc1
  s_waitcnt vmcnt(10)
  v_mfma_f32_16x16x32_bf16 v[76:79], v[200:203], a[24:27], v[76:79]
  ds_read_b128 v[192:195], v8 offset:22528
  s_waitcnt vmcnt(9)
  v_mfma_f32_16x16x32_bf16 v[76:79], v[204:207], a[28:31], v[76:79]
  s_waitcnt lgkmcnt(7)
  ds_read_b128 v[196:199], v8 offset:27648
  s_waitcnt vmcnt(8)
  v_mfma_f32_16x16x32_bf16 v[76:79], v[208:211], a[32:35], v[76:79]
  ds_read_b128 v[200:203], v8 offset:18432
  s_add_u32 s51, s59, 69632
  v_mfma_f32_16x16x32_bf16 v[80:83], v[212:215], a[24:27], v[80:83]
  s_waitcnt lgkmcnt(7)
  ds_read_b128 v[204:207], v8 offset:23552
  buffer_load_dwordx4 a[68:71], v3, s[28:31], s51 offen sc1
  v_mfma_f32_16x16x32_bf16 v[80:83], v[216:219], a[28:31], v[80:83]
  ds_read_b128 v[208:211], v8 offset:28672
  v_mfma_f32_16x16x32_bf16 v[80:83], v[220:223], a[32:35], v[80:83]
  s_waitcnt lgkmcnt(7)
  ds_read_b128 v[212:215], v8 offset:29696
  v_mfma_f32_16x16x32_bf16 v[84:87], v[176:179], a[24:27], v[84:87]
  ds_read_b128 v[216:219], v8 offset:34816
  s_add_u32 s51, s59, 73728
  v_mfma_f32_16x16x32_bf16 v[84:87], v[180:183], a[28:31], v[84:87]
  s_waitcnt lgkmcnt(7)
  ds_read_b128 v[220:223], v8 offset:39936
  buffer_load_dwordx4 a[72:75], v3, s[28:31], s51 offen sc1
  v_mfma_f32_16x16x32_bf16 v[84:87], v[184:187], a[32:35], v[84:87]
  ds_read_b128 v[176:179], v8 offset:30720
  v_mfma_f32_16x16x32_bf16 v[88:91], v[188:191], a[24:27], v[88:91]
  s_waitcnt lgkmcnt(7)
  ds_read_b128 v[180:183], v8 offset:35840
  v_mfma_f32_16x16x32_bf16 v[88:91], v[192:195], a[28:31], v[88:91]
  ds_read_b128 v[184:187], v8 offset:40960
  s_add_u32 s51, s59, 77824
  v_mfma_f32_16x16x32_bf16 v[88:91], v[196:199], a[32:35], v[88:91]
  s_waitcnt lgkmcnt(7)
  ds_read_b128 v[188:191], v8 offset:31744
  buffer_load_dwordx4 a[76:79], v3, s[28:31], s51 offen sc1
  v_mfma_f32_16x16x32_bf16 v[92:95], v[200:203], a[24:27], v[92:95]
  ds_read_b128 v[192:195], v8 offset:36864
  v_mfma_f32_16x16x32_bf16 v[92:95], v[204:207], a[28:31], v[92:95]
  s_waitcnt lgkmcnt(7)
  ds_read_b128 v[196:199], v8 offset:41984
  v_mfma_f32_16x16x32_bf16 v[92:95], v[208:211], a[32:35], v[92:95]
  ds_read_b128 v[200:203], v8 offset:32768
  s_add_u32 s51, s59, 81920
  s_waitcnt vmcnt(10)
  v_mfma_f32_16x16x32_bf16 v[76:79], v[212:215], a[36:39], v[76:79]
  s_waitcnt lgkmcnt(7)
  ds_read_b128 v[204:207], v8 offset:37888
  buffer_load_dwordx4 a[80:83], v3, s[28:31], s51 offen sc1
  s_waitcnt vmcnt(10)
  v_mfma_f32_16x16x32_bf16 v[76:79], v[216:219], a[40:43], v[76:79]
  ds_read_b128 v[208:211], v8 offset:43008
  s_waitcnt vmcnt(9)
  v_mfma_f32_16x16x32_bf16 v[76:79], v[220:223], a[44:47], v[76:79]
  s_waitcnt lgkmcnt(7)
  ds_read_b128 v[212:215], v8 offset:33792
  v_mfma_f32_16x16x32_bf16 v[80:83], v[176:179], a[36:39], v[80:83]
  ds_read_b128 v[216:219], v8 offset:38912
  s_add_u32 s51, s59, 86016
  v_mfma_f32_16x16x32_bf16 v[80:83], v[180:183], a[40:43], v[80:83]
  s_waitcnt lgkmcnt(7)
  ds_read_b128 v[220:223], v8 offset:44032
  buffer_load_dwordx4 a[84:87], v3, s[28:31], s51 offen sc1
  v_mfma_f32_16x16x32_bf16 v[80:83], v[184:187], a[44:47], v[80:83]
  ds_read_b128 v[176:179], v8 offset:45056
  v_mfma_f32_16x16x32_bf16 v[84:87], v[188:191], a[36:39], v[84:87]
  s_waitcnt lgkmcnt(7)
  ds_read_b128 v[180:183], v8 offset:50176
  v_mfma_f32_16x16x32_bf16 v[84:87], v[192:195], a[40:43], v[84:87]
  ds_read_b128 v[184:187], v8 offset:55296
  s_add_u32 s51, s59, 90112
  v_mfma_f32_16x16x32_bf16 v[84:87], v[196:199], a[44:47], v[84:87]
  s_waitcnt lgkmcnt(7)
  ds_read_b128 v[188:191], v8 offset:46080
  buffer_load_dwordx4 a[88:91], v3, s[28:31], s51 offen sc1
  v_mfma_f32_16x16x32_bf16 v[88:91], v[200:203], a[36:39], v[88:91]
  ds_read_b128 v[192:195], v8 offset:51200
  v_mfma_f32_16x16x32_bf16 v[88:91], v[204:207], a[40:43], v[88:91]
  s_waitcnt lgkmcnt(7)
  ds_read_b128 v[196:199], v8 offset:56320
  v_mfma_f32_16x16x32_bf16 v[88:91], v[208:211], a[44:47], v[88:91]
  ds_read_b128 v[200:203], v8 offset:47104
  s_add_u32 s51, s59, 94208
  v_mfma_f32_16x16x32_bf16 v[92:95], v[212:215], a[36:39], v[92:95]
  s_waitcnt lgkmcnt(7)
  ds_read_b128 v[204:207], v8 offset:52224
  buffer_load_dwordx4 a[92:95], v3, s[28:31], s51 offen sc1
  v_mfma_f32_16x16x32_bf16 v[92:95], v[216:219], a[40:43], v[92:95]
  ds_read_b128 v[208:211], v8 offset:57344
  v_mfma_f32_16x16x32_bf16 v[92:95], v[220:223], a[44:47], v[92:95]
  s_waitcnt lgkmcnt(7)
  ds_read_b128 v[212:215], v8 offset:48128
  s_waitcnt vmcnt(11)
  v_mfma_f32_16x16x32_bf16 v[76:79], v[176:179], a[48:51], v[76:79]
  ds_read_b128 v[216:219], v8 offset:53248
  s_add_u32 s51, s59, 98304
  s_waitcnt vmcnt(10)
  v_mfma_f32_16x16x32_bf16 v[76:79], v[180:183], a[52:55], v[76:79]
  s_waitcnt lgkmcnt(7)
  ds_read_b128 v[220:223], v8 offset:58368
  buffer_load_dwordx4 a[96:99], v3, s[28:31], s51 offen sc1
  s_waitcnt vmcnt(10)
  v_mfma_f32_16x16x32_bf16 v[76:79], v[184:187], a[56:59], v[76:79]
  ds_read_b128 v[176:179], v8 offset:49152
  v_mfma_f32_16x16x32_bf16 v[80:83], v[188:191], a[48:51], v[80:83]
  s_waitcnt lgkmcnt(7)
  ds_read_b128 v[180:183], v8 offset:54272
  v_mfma_f32_16x16x32_bf16 v[80:83], v[192:195], a[52:55], v[80:83]
  ds_read_b128 v[184:187], v8 offset:59392
  s_add_u32 s51, s59, 102400
  v_mfma_f32_16x16x32_bf16 v[80:83], v[196:199], a[56:59], v[80:83]
  s_waitcnt lgkmcnt(7)
  ds_read_b128 v[188:191], v8 offset:60416
  buffer_load_dwordx4 a[100:103], v3, s[28:31], s51 offen sc1
  v_mfma_f32_16x16x32_bf16 v[84:87], v[200:203], a[48:51], v[84:87]
  ds_read_b128 v[192:195], v9 offset:0
  v_mfma_f32_16x16x32_bf16 v[84:87], v[204:207], a[52:55], v[84:87]
  s_waitcnt lgkmcnt(7)
  ds_read_b128 v[196:199], v9 offset:5120
  v_mfma_f32_16x16x32_bf16 v[84:87], v[208:211], a[56:59], v[84:87]
  ds_read_b128 v[200:203], v8 offset:61440
  s_add_u32 s51, s59, 106496
  v_mfma_f32_16x16x32_bf16 v[88:91], v[212:215], a[48:51], v[88:91]
  s_waitcnt lgkmcnt(7)
  ds_read_b128 v[204:207], v9 offset:1024
  buffer_load_dwordx4 a[104:107], v3, s[28:31], s51 offen sc1
  v_mfma_f32_16x16x32_bf16 v[88:91], v[216:219], a[52:55], v[88:91]
  ds_read_b128 v[208:211], v9 offset:6144
  v_mfma_f32_16x16x32_bf16 v[88:91], v[220:223], a[56:59], v[88:91]
  s_waitcnt lgkmcnt(7)
  ds_read_b128 v[212:215], v8 offset:62464
  v_mfma_f32_16x16x32_bf16 v[92:95], v[176:179], a[48:51], v[92:95]
  ds_read_b128 v[216:219], v9 offset:2048
  v_mfma_f32_16x16x32_bf16 v[92:95], v[180:183], a[52:55], v[92:95]
  s_waitcnt lgkmcnt(7)
  ds_read_b128 v[220:223], v9 offset:7168
  v_mfma_f32_16x16x32_bf16 v[92:95], v[184:187], a[56:59], v[92:95]
  ds_read_b128 v[176:179], v8 offset:63488
  s_waitcnt vmcnt(11)
  v_mfma_f32_16x16x32_bf16 v[76:79], v[188:191], a[60:63], v[76:79]
  s_waitcnt lgkmcnt(7)
  ds_read_b128 v[180:183], v9 offset:3072
  s_waitcnt vmcnt(10)
  v_mfma_f32_16x16x32_bf16 v[76:79], v[192:195], a[64:67], v[76:79]
  ds_read_b128 v[184:187], v9 offset:8192
  s_waitcnt vmcnt(9)
  v_mfma_f32_16x16x32_bf16 v[76:79], v[196:199], a[68:71], v[76:79]
  s_waitcnt lgkmcnt(7)
  ds_read_b128 v[188:191], v8 offset:64512
  v_mfma_f32_16x16x32_bf16 v[80:83], v[200:203], a[60:63], v[80:83]
  ds_read_b128 v[192:195], v9 offset:4096
  v_mfma_f32_16x16x32_bf16 v[80:83], v[204:207], a[64:67], v[80:83]
  s_waitcnt lgkmcnt(7)
  ds_read_b128 v[196:199], v9 offset:9216
  v_mfma_f32_16x16x32_bf16 v[80:83], v[208:211], a[68:71], v[80:83]
  ds_read_b128 v[200:203], v9 offset:10240
  v_mfma_f32_16x16x32_bf16 v[84:87], v[212:215], a[60:63], v[84:87]
  s_waitcnt lgkmcnt(7)
  ds_read_b128 v[204:207], v9 offset:15360
  v_mfma_f32_16x16x32_bf16 v[84:87], v[216:219], a[64:67], v[84:87]
  ds_read_b128 v[208:211], v3 offset:0
  v_mfma_f32_16x16x32_bf16 v[84:87], v[220:223], a[68:71], v[84:87]
  s_waitcnt lgkmcnt(7)
  ds_read_b128 v[212:215], v9 offset:11264
  v_mfma_f32_16x16x32_bf16 v[88:91], v[176:179], a[60:63], v[88:91]
  ds_read_b128 v[216:219], v9 offset:16384
  v_mfma_f32_16x16x32_bf16 v[88:91], v[180:183], a[64:67], v[88:91]
  s_waitcnt lgkmcnt(7)
  ds_read_b128 v[220:223], v3 offset:1024
  v_mfma_f32_16x16x32_bf16 v[88:91], v[184:187], a[68:71], v[88:91]
  ds_read_b128 v[176:179], v9 offset:12288
  v_mfma_f32_16x16x32_bf16 v[92:95], v[188:191], a[60:63], v[92:95]
  s_waitcnt lgkmcnt(7)
  ds_read_b128 v[180:183], v9 offset:17408
  v_mfma_f32_16x16x32_bf16 v[92:95], v[192:195], a[64:67], v[92:95]
  ds_read_b128 v[184:187], v3 offset:2048
  v_mfma_f32_16x16x32_bf16 v[92:95], v[196:199], a[68:71], v[92:95]
  s_waitcnt lgkmcnt(7)
  ds_read_b128 v[188:191], v9 offset:13312
  s_waitcnt vmcnt(8)
  v_mfma_f32_16x16x32_bf16 v[76:79], v[200:203], a[72:75], v[76:79]
  ds_read_b128 v[192:195], v9 offset:18432
  v_mul_u32_u24 v10, 1280, v1
  s_waitcnt vmcnt(7)
  v_mfma_f32_16x16x32_bf16 v[76:79], v[204:207], a[76:79], v[76:79]
  s_waitcnt lgkmcnt(7)
  ds_read_b128 v[196:199], v3 offset:3072
  v_and_b32 v11, 1, v2
  s_waitcnt vmcnt(6)
  v_mfma_f32_16x16x32_bf16 v[76:79], v[208:211], a[80:83], v[76:79]
  ds_read_b128 v[200:203], v9 offset:14336
  v_lshl_add_u32 v10, v11, 5, v10
  v_mfma_f32_16x16x32_bf16 v[80:83], v[212:215], a[72:75], v[80:83]
  s_waitcnt lgkmcnt(7)
  ds_read_b128 v[204:207], v9 offset:19456
  v_lshrrev_b32 v11, 1, v2
  v_mfma_f32_16x16x32_bf16 v[80:83], v[216:219], a[76:79], v[80:83]
  ds_read_b128 v[208:211], v3 offset:4096
  v_lshl_add_u32 v10, v11, 4, v10
  v_mfma_f32_16x16x32_bf16 v[80:83], v[220:223], a[80:83], v[80:83]
  s_waitcnt lgkmcnt(7)
  ds_read_b128 v[212:215], v3 offset:5120
  v_mul_u32_u24 v15, 1280, v1
  v_mfma_f32_16x16x32_bf16 v[84:87], v[176:179], a[72:75], v[84:87]
  ds_read_b128 v[216:219], v3 offset:10240
  v_lshl_add_u32 v15, v2, 3, v15
  v_mfma_f32_16x16x32_bf16 v[84:87], v[180:183], a[76:79], v[84:87]
  s_waitcnt lgkmcnt(7)
  ds_read_b128 v[220:223], v3 offset:15360
  v_mfma_f32_16x16x32_bf16 v[84:87], v[184:187], a[80:83], v[84:87]
  ds_read_b128 v[176:179], v3 offset:6144
  v_mfma_f32_16x16x32_bf16 v[88:91], v[188:191], a[72:75], v[88:91]
  s_waitcnt lgkmcnt(7)
  ds_read_b128 v[180:183], v3 offset:11264
  v_mfma_f32_16x16x32_bf16 v[88:91], v[192:195], a[76:79], v[88:91]
  ds_read_b128 v[184:187], v3 offset:16384
  v_mfma_f32_16x16x32_bf16 v[88:91], v[196:199], a[80:83], v[88:91]
  s_waitcnt lgkmcnt(7)
  ds_read_b128 v[188:191], v3 offset:7168
  v_mfma_f32_16x16x32_bf16 v[92:95], v[200:203], a[72:75], v[92:95]
  ds_read_b128 v[192:195], v3 offset:12288
  v_mfma_f32_16x16x32_bf16 v[92:95], v[204:207], a[76:79], v[92:95]
  s_waitcnt lgkmcnt(7)
  ds_read_b128 v[196:199], v3 offset:17408
  v_mfma_f32_16x16x32_bf16 v[92:95], v[208:211], a[80:83], v[92:95]
  ds_read_b128 v[200:203], v3 offset:8192
  s_waitcnt vmcnt(5)
  v_mfma_f32_16x16x32_bf16 v[76:79], v[212:215], a[84:87], v[76:79]
  s_waitcnt lgkmcnt(7)
  ds_read_b128 v[204:207], v3 offset:13312
  s_waitcnt vmcnt(4)
  v_mfma_f32_16x16x32_bf16 v[76:79], v[216:219], a[88:91], v[76:79]
  ds_read_b128 v[208:211], v3 offset:18432
  s_waitcnt vmcnt(3)
  v_mfma_f32_16x16x32_bf16 v[76:79], v[220:223], a[92:95], v[76:79]
  s_waitcnt lgkmcnt(7)
  ds_read_b128 v[212:215], v3 offset:9216
  v_mfma_f32_16x16x32_bf16 v[80:83], v[176:179], a[84:87], v[80:83]
  ds_read_b128 v[216:219], v3 offset:14336
  v_mfma_f32_16x16x32_bf16 v[80:83], v[180:183], a[88:91], v[80:83]
  s_waitcnt lgkmcnt(7)
  ds_read_b128 v[220:223], v3 offset:19456
  v_mfma_f32_16x16x32_bf16 v[80:83], v[184:187], a[92:95], v[80:83]
  ds_read_b128 v[176:179], v3 offset:20480
  v_mfma_f32_16x16x32_bf16 v[84:87], v[188:191], a[84:87], v[84:87]
  s_waitcnt lgkmcnt(7)
  ds_read_b128 v[180:183], v3 offset:25600
  v_mfma_f32_16x16x32_bf16 v[84:87], v[192:195], a[88:91], v[84:87]
  ds_read_b128 v[184:187], v3 offset:30720
  v_mfma_f32_16x16x32_bf16 v[84:87], v[196:199], a[92:95], v[84:87]
  s_waitcnt lgkmcnt(7)
  ds_read_b128 v[188:191], v3 offset:21504
  v_mfma_f32_16x16x32_bf16 v[88:91], v[200:203], a[84:87], v[88:91]
  ds_read_b128 v[192:195], v3 offset:26624
  v_mfma_f32_16x16x32_bf16 v[88:91], v[204:207], a[88:91], v[88:91]
  s_waitcnt lgkmcnt(7)
  ds_read_b128 v[196:199], v3 offset:31744
  v_mfma_f32_16x16x32_bf16 v[88:91], v[208:211], a[92:95], v[88:91]
  ds_read_b128 v[200:203], v3 offset:22528
  v_mfma_f32_16x16x32_bf16 v[92:95], v[212:215], a[84:87], v[92:95]
  s_waitcnt lgkmcnt(7)
  ds_read_b128 v[204:207], v3 offset:27648
  v_mfma_f32_16x16x32_bf16 v[92:95], v[216:219], a[88:91], v[92:95]
  ds_read_b128 v[208:211], v3 offset:32768
  v_mfma_f32_16x16x32_bf16 v[92:95], v[220:223], a[92:95], v[92:95]
  s_waitcnt lgkmcnt(7)
  ds_read_b128 v[212:215], v3 offset:23552
  s_waitcnt vmcnt(2)
  v_mfma_f32_16x16x32_bf16 v[76:79], v[176:179], a[96:99], v[76:79]
  ds_read_b128 v[216:219], v3 offset:28672
  s_waitcnt vmcnt(1)
  v_mfma_f32_16x16x32_bf16 v[76:79], v[180:183], a[100:103], v[76:79]
  s_waitcnt lgkmcnt(7)
  ds_read_b128 v[220:223], v3 offset:33792
  s_waitcnt vmcnt(0)
  v_mfma_f32_16x16x32_bf16 v[76:79], v[184:187], a[104:107], v[76:79]
  ds_read_b128 v[176:179], v3 offset:24576
  v_mfma_f32_16x16x32_bf16 v[80:83], v[188:191], a[96:99], v[80:83]
  s_waitcnt lgkmcnt(7)
  ds_read_b128 v[180:183], v3 offset:29696
  v_mfma_f32_16x16x32_bf16 v[80:83], v[192:195], a[100:103], v[80:83]
  ds_read_b128 v[184:187], v3 offset:34816
  v_mfma_f32_16x16x32_bf16 v[80:83], v[196:199], a[104:107], v[80:83]
  s_waitcnt lgkmcnt(7)
  v_mfma_f32_16x16x32_bf16 v[84:87], v[200:203], a[96:99], v[84:87]
  v_mfma_f32_16x16x32_bf16 v[84:87], v[204:207], a[100:103], v[84:87]
  s_waitcnt lgkmcnt(5)
  v_mfma_f32_16x16x32_bf16 v[84:87], v[208:211], a[104:107], v[84:87]
  v_mfma_f32_16x16x32_bf16 v[88:91], v[212:215], a[96:99], v[88:91]
  s_waitcnt lgkmcnt(3)
  v_mfma_f32_16x16x32_bf16 v[88:91], v[216:219], a[100:103], v[88:91]
  v_mfma_f32_16x16x32_bf16 v[88:91], v[220:223], a[104:107], v[88:91]
  s_waitcnt lgkmcnt(1)
  v_mfma_f32_16x16x32_bf16 v[92:95], v[176:179], a[96:99], v[92:95]
  v_mfma_f32_16x16x32_bf16 v[92:95], v[180:183], a[100:103], v[92:95]
  s_waitcnt lgkmcnt(0)
  v_mfma_f32_16x16x32_bf16 v[92:95], v[184:187], a[104:107], v[92:95]
  v_pk_fma_f32 v[76:77], v[76:77], v[48:49], v[16:17]
  v_pk_fma_f32 v[78:79], v[78:79], v[50:51], v[18:19]
  v_pk_fma_f32 v[80:81], v[80:81], v[52:53], v[20:21]
  v_pk_fma_f32 v[82:83], v[82:83], v[54:55], v[22:23]
  v_pk_fma_f32 v[84:85], v[84:85], v[56:57], v[24:25]
  v_pk_fma_f32 v[86:87], v[86:87], v[58:59], v[26:27]
  v_pk_fma_f32 v[88:89], v[88:89], v[60:61], v[28:29]
  v_pk_fma_f32 v[90:91], v[90:91], v[62:63], v[30:31]
  v_pk_fma_f32 v[92:93], v[92:93], v[64:65], v[32:33]
  v_pk_fma_f32 v[94:95], v[94:95], v[66:67], v[34:35]
  v_cvt_pk_bf16_f32 v76, v76, v77
  v_cvt_pk_bf16_f32 v77, v78, v79
  v_cvt_pk_bf16_f32 v78, v80, v81
  v_cvt_pk_bf16_f32 v79, v82, v83
  v_cvt_pk_bf16_f32 v80, v84, v85
  v_cvt_pk_bf16_f32 v81, v86, v87
  v_cvt_pk_bf16_f32 v82, v88, v89
  v_cvt_pk_bf16_f32 v83, v90, v91
  v_cvt_pk_bf16_f32 v84, v92, v93
  v_cvt_pk_bf16_f32 v85, v94, v95
  buffer_store_dwordx2 v[84:85], v15, s[12:15], s69 offen
  v_permlane16_swap_b32 v76, v78
  v_permlane16_swap_b32 v77, v79
  buffer_store_dwordx4 v[76:79], v10, s[12:15], s68 offen offset:0
  v_permlane16_swap_b32 v80, v82
  v_permlane16_swap_b32 v81, v83
  buffer_store_dwordx4 v[80:83], v10, s[12:15], s68 offen offset:64
L_end:
  s_endpgm
L_pm_w:
  s_mov_b32 s3, 0
L_pm_spin:
  s_sleep 4
  buffer_load_dword v18, v17, s[32:35], 0 offen sc1
  s_add_u32 s3, s3, 1
  s_cmp_gt_u32 s3, 1000000
  s_waitcnt vmcnt(0)
  s_cbranch_scc1 L_pm_ok
  v_cmp_gt_u32 vcc, 20, v18
  s_nop 0
  s_cbranch_vccnz L_pm_spin
  s_branch L_pm_ok
L_p2_w:
  s_mov_b32 s3, 0
L_p2_spin:
  s_sleep 4
  buffer_load_dword v18, v17, s[28:31], 0 offen sc1
  s_add_u32 s3, s3, 1
  s_cmp_gt_u32 s3, 1000000
  s_waitcnt vmcnt(0)
  s_cbranch_scc1 L_p2_ok
  v_cmp_gt_u32 vcc, 20, v18
  s_nop 0
  s_cbranch_vccnz L_p2_spin
  s_branch L_p2_ok
L_ph_w:
  s_mov_b32 s3, 0
L_ph_spin:
  s_sleep 4
  buffer_load_dword v18, v11, s[28:31], 0 offen sc1
  s_add_u32 s3, s3, 1
  s_cmp_gt_u32 s3, 1000000
  s_waitcnt vmcnt(0)
  s_cbranch_scc1 L_ph_ok
  v_cmp_gt_u32 vcc, 64, v18
  s_nop 0
  s_cbranch_vccnz L_ph_spin
  s_branch L_ph_ok
L_pk0_w:
  s_mov_b32 s3, 0
L_pk0_spin:
  s_sleep 4
  buffer_load_dword v26, v6, s[28:31], 0 offen sc1
  s_add_u32 s3, s3, 1
  s_cmp_gt_u32 s3, 1000000
  s_waitcnt vmcnt(0)
  s_cbranch_scc1 L_pk0_ok
  v_cmp_gt_u32 vcc, 32, v26
  s_nop 0
  s_cbranch_vccnz L_pk0_spin
  s_branch L_pk0_ok
L_pk1_w:
  s_mov_b32 s3, 0
L_pk1_spin:
  s_sleep 4
  buffer_load_dword v26, v6, s[28:31], 0 offen sc1
  s_add_u32 s3, s3, 1
  s_cmp_gt_u32 s3, 1000000
  s_waitcnt vmcnt(0)
  s_cbranch_scc1 L_pk1_ok
  v_cmp_gt_u32 vcc, 32, v26
  s_nop 0
  s_cbranch_vccnz L_pk1_spin
  s_branch L_pk1_ok
L_p0_w:
  s_mov_b32 s3, 0
L_p0_spin:
  s_sleep 4
  buffer_load_dword v7, v6, s[28:31], 0 offen sc1
  s_add_u32 s3, s3, 1
  s_cmp_gt_u32 s3, 1000000
  s_waitcnt vmcnt(0)
  s_cbranch_scc1 L_p0_ok
  v_cmp_gt_u32 vcc, 32, v7
  s_nop 0
  s_cbranch_vccnz L_p0_spin
  s_branch L_p0_ok
L_pt_w:
  s_mov_b32 s3, 0
L_pt_spin:
  s_sleep 4
  buffer_load_dword v22, v21, s[28:31], 0 offen sc1
  s_add_u32 s3, s3, 1
  s_cmp_gt_u32 s3, 1000000
  s_waitcnt vmcnt(0)
  s_cbranch_scc1 L_pt_ok
  v_cmp_gt_u32 vcc, 32, v22
  s_nop 0
  s_cbranch_vccnz L_pt_spin
  s_branch L_pt_ok
L_pl_w:
  s_mov_b32 vcc_lo, 0
L_pl_spin:
  v_mov_b32 v7, 0
  buffer_atomic_add v7, v16, s[28:31], s79 offen offset:128 sc0
  s_add_u32 vcc_lo, vcc_lo, 1
  s_cmp_gt_u32 vcc_lo, 1000000
  s_waitcnt vmcnt(0)
  s_cbranch_scc1 L_pl_ok
  v_readfirstlane_b32 s3, v7
  s_nop 0
  s_cmp_lt_u32 s3, 4
  s_cbranch_scc1 L_pl_spin
  s_branch L_pl_ok
L_pr_w:
  s_mov_b32 s3, 0
L_pr_spin:
  s_sleep 4
  buffer_load_dword v22, v6, s[28:31], 0 offen sc1
  s_add_u32 s3, s3, 1
  s_cmp_gt_u32 s3, 1000000
  s_waitcnt vmcnt(0)
  s_cbranch_scc1 L_pr_ok
  v_cmp_gt_u32 vcc, v21, v22
  s_nop 0
  s_cbranch_vccnz L_pr_spin
  s_branch L_pr_ok
L_pc_w:
  s_mov_b32 vcc_lo, 0
L_pc_spin:
  v_mov_b32 v18, 0
  buffer_atomic_add v18, v16, s[28:31], s79 offen sc0
  s_add_u32 vcc_lo, vcc_lo, 1
  s_cmp_gt_u32 vcc_lo, 1000000
  s_waitcnt vmcnt(0)
  s_cbranch_scc1 L_pc_ok
  v_readfirstlane_b32 s3, v18
  s_nop 0
  s_cmp_lt_u32 s3, 4
  s_cbranch_scc1 L_pc_spin
  s_branch L_pc_ok
L_t_p1_w:
  s_mov_b32 s53, 0
L_t_p1_spin:
  buffer_load_dwordx4 v[160:163], v37, s[28:31], s66 offen sc1
  s_add_u32 s53, s53, 1
  s_cmp_gt_u32 s53, 1000000
  s_waitcnt vmcnt(0)
  s_cbranch_scc1 L_t_p1_ok
  v_cmp_gt_f32 vcc, 0, v161
  v_cmp_gt_f32 s[72:73], 0, v163
  s_nop 0
  s_or_b64 vcc, vcc, s[72:73]
  s_cbranch_vccnz L_t_p1_spin
  s_branch L_t_p1_ok
L_t_p2_w:
  s_mov_b32 s53, 0
L_t_p2_spin:
  buffer_load_dwordx4 v[164:167], v37, s[28:31], s66 offen sc1
  s_add_u32 s53, s53, 1
  s_cmp_gt_u32 s53, 1000000
  s_waitcnt vmcnt(0)
  s_cbranch_scc1 L_t_p2_ok
  v_cmp_gt_f32 vcc, 0, v165
  v_cmp_gt_f32 s[72:73], 0, v167
  s_nop 0
  s_or_b64 vcc, vcc, s[72:73]
  s_cbranch_vccnz L_t_p2_spin
  s_branch L_t_p2_ok
L_t_pc_w:
  s_mov_b32 s53, 0
L_t_pc_spin:
  s_sleep 6
  buffer_load_dword v14, v13, s[28:31], 0 offen sc1
  s_add_u32 s53, s53, 1
  s_cmp_gt_u32 s53, 1000000
  s_waitcnt vmcnt(0)
  s_cbranch_scc1 L_t_pc_ok
  v_cmp_gt_u32 vcc, 8, v14
  s_nop 0
  s_cbranch_vccnz L_t_pc_spin
  s_branch L_t_pc_ok
L_t_pe2_w:
  s_mov_b32 s53, 0
L_t_pe2_spin:
  s_sleep 6
  buffer_load_dword v14, v13, s[28:31], 0 offen sc1
  s_add_u32 s53, s53, 1
  s_cmp_gt_u32 s53, 1000000
  s_waitcnt vmcnt(0)
  s_cbranch_scc1 L_t_pe2_ok
  v_cmp_gt_u32 vcc, 8, v14
  s_nop 0
  s_cbranch_vccnz L_t_pe2_spin
  s_branch L_t_pe2_ok
L_t_pe6_w:
  s_mov_b32 s53, 0
L_t_pe6_spin:
  s_sleep 6
  buffer_load_dword v14, v13, s[28:31], 0 offen sc1
  s_add_u32 s53, s53, 1
  s_cmp_gt_u32 s53, 1000000
  s_waitcnt vmcnt(0)
  s_cbranch_scc1 L_t_pe6_ok
  v_cmp_gt_u32 vcc, 8, v14
  s_nop 0
  s_cbranch_vccnz L_t_pe6_spin
  s_branch L_t_pe6_ok
L_t_pe10_w:
  s_mov_b32 s53, 0
L_t_pe10_spin:
  s_sleep 6
  buffer_load_dword v14, v13, s[28:31], 0 offen sc1
  s_add_u32 s53, s53, 1
  s_cmp_gt_u32 s53, 1000000
  s_waitcnt vmcnt(0)
  s_cbranch_scc1 L_t_pe10_ok
  v_cmp_gt_u32 vcc, 8, v14
  s_nop 0
  s_cbranch_vccnz L_t_pe10_spin
  s_branch L_t_pe10_ok
L_slow:
  s_waitcnt vmcnt(0) lgkmcnt(0)
  s_mov_b32 s69, 1
  s_mov_b32 s61, 0
  v_mov_b32 v64, 0xf149f2ca
  v_mov_b32 v65, 0xf149f2ca
  v_mov_b32 v66, 0xf149f2ca
  v_mov_b32 v67, 0xf149f2ca
  v_lshrrev_b32 v69, 4, v0
  v_lshlrev_b32 v69, 2, v69
  v_and_b32 v68, 15, v0
  v_sub_u32 v68, v68, v69
  s_and_b32 s52, s48, 1
  s_lshl_b32 s52, s52, 4
  v_add_u32 v68, s52, v68
  s_lshr_b32 s52, s48, 1
  s_lshl_b32 s36, s52, 5
  s_add_u32 s37, s36, 16
  s_sub_u32 s38, 96, s36
  s_add_u32 s39, s38, 16
  s_lshl_b32 s4, s52, 6
  s_xor_b32 s5, s4, 32
  s_xor_b32 s6, s4, 64
  s_xor_b32 s7, s4, 96
  v_mov_b32 v70, 0xf149f2ca
L_mx:
  s_barrier
  s_lshl_b32 s66, s61, 15
  s_add_u32 s66, s66, s64
  s_add_u32 m0, s56, 0
  s_nop 0
  buffer_load_dwordx4 v5, s[28:31], s66 offen offset:0 sc1 lds
  buffer_load_dwordx4 v5, s[28:31], s66 offen offset:1024 sc1 lds
  buffer_load_dwordx4 v5, s[28:31], s66 offen offset:2048 sc1 lds
  buffer_load_dwordx4 v5, s[28:31], s66 offen offset:3072 sc1 lds
  s_add_u32 m0, s56, 4096
  s_add_u32 s66, s66, 4096
  buffer_load_dwordx4 v5, s[28:31], s66 offen offset:0 sc1 lds
  buffer_load_dwordx4 v5, s[28:31], s66 offen offset:1024 sc1 lds
  buffer_load_dwordx4 v5, s[28:31], s66 offen offset:2048 sc1 lds
  buffer_load_dwordx4 v5, s[28:31], s66 offen offset:3072 sc1 lds
  s_waitcnt vmcnt(0)
  s_barrier
  s_cmp_eq_u32 s61, s58
  s_cselect_b32 s53, 0, 4096
  ds_read_b128 a[64:67], v1 offset:0
  ds_read_b128 a[68:71], v1 offset:1024
  ds_read_b128 a[72:75], v1 offset:2048
  ds_read_b128 a[76:79], v1 offset:3072
  v_subrev_u32 v69, s36, v68
  v_add_u32 v69, s53, v69
  s_waitcnt lgkmcnt(3)
  v_mfma_f32_16x16x32_bf16 v[48:51], a[64:67], a[0:3], 0
  s_waitcnt lgkmcnt(2)
  v_mfma_f32_16x16x32_bf16 v[48:51], a[68:71], a[16:19], v[48:51]
  s_waitcnt lgkmcnt(1)
  v_mfma_f32_16x16x32_bf16 v[48:51], a[72:75], a[32:35], v[48:51]
  s_waitcnt lgkmcnt(0)
  v_mfma_f32_16x16x32_bf16 v[48:51], a[76:79], a[48:51], v[48:51]
  v_mfma_f32_16x16x32_bf16 v[52:55], a[64:67], a[4:7], 0
  v_mfma_f32_16x16x32_bf16 v[52:55], a[68:71], a[20:23], v[52:55]
  v_mfma_f32_16x16x32_bf16 v[52:55], a[72:75], a[36:39], v[52:55]
  v_mfma_f32_16x16x32_bf16 v[52:55], a[76:79], a[52:55], v[52:55]
  v_mfma_f32_16x16x32_bf16 v[56:59], a[64:67], a[8:11], 0
  v_mfma_f32_16x16x32_bf16 v[56:59], a[68:71], a[24:27], v[56:59]
  v_mfma_f32_16x16x32_bf16 v[56:59], a[72:75], a[40:43], v[56:59]
  v_mfma_f32_16x16x32_bf16 v[56:59], a[76:79], a[56:59], v[56:59]
  v_mfma_f32_16x16x32_bf16 v[60:63], a[64:67], a[12:15], 0
  v_mfma_f32_16x16x32_bf16 v[60:63], a[68:71], a[28:31], v[60:63]
  v_mfma_f32_16x16x32_bf16 v[60:63], a[72:75], a[44:47], v[60:63]
  v_mfma_f32_16x16x32_bf16 v[60:63], a[76:79], a[60:63], v[60:63]
  v_add_u32 v72, s4, v69
  v_cmp_gt_i32 vcc, 0, v72
  s_nop 1
  v_cndmask_b32 v71, v48, v70, vcc
  v_max_f32 v64, v64, v71
  v_cmp_gt_i32 vcc, 1, v72
  s_nop 1
  v_cndmask_b32 v71, v49, v70, vcc
  v_max_f32 v64, v64, v71
  v_cmp_gt_i32 vcc, 2, v72
  s_nop 1
  v_cndmask_b32 v71, v50, v70, vcc
  v_max_f32 v64, v64, v71
  v_cmp_gt_i32 vcc, 3, v72
  s_nop 1
  v_cndmask_b32 v71, v51, v70, vcc
  v_max_f32 v64, v64, v71
  v_add_u32 v72, s5, v69
  v_cmp_gt_i32 vcc, 0, v72
  s_nop 1
  v_cndmask_b32 v71, v52, v70, vcc
  v_max_f32 v65, v65, v71
  v_cmp_gt_i32 vcc, 1, v72
  s_nop 1
  v_cndmask_b32 v71, v53, v70, vcc
  v_max_f32 v65, v65, v71
  v_cmp_gt_i32 vcc, 2, v72
  s_nop 1
  v_cndmask_b32 v71, v54, v70, vcc
  v_max_f32 v65, v65, v71
  v_cmp_gt_i32 vcc, 3, v72
  s_nop 1
  v_cndmask_b32 v71, v55, v70, vcc
  v_max_f32 v65, v65, v71
  v_add_u32 v72, s6, v69
  v_cmp_gt_i32 vcc, 0, v72
  s_nop 1
  v_cndmask_b32 v71, v56, v70, vcc
  v_max_f32 v66, v66, v71
  v_cmp_gt_i32 vcc, 1, v72
  s_nop 1
  v_cndmask_b32 v71, v57, v70, vcc
  v_max_f32 v66, v66, v71
  v_cmp_gt_i32 vcc, 2, v72
  s_nop 1
  v_cndmask_b32 v71, v58, v70, vcc
  v_max_f32 v66, v66, v71
  v_cmp_gt_i32 vcc, 3, v72
  s_nop 1
  v_cndmask_b32 v71, v59, v70, vcc
  v_max_f32 v66, v66, v71
  v_add_u32 v72, s7, v69
  v_cmp_gt_i32 vcc, 0, v72
  s_nop 1
  v_cndmask_b32 v71, v60, v70, vcc
  v_max_f32 v67, v67, v71
  v_cmp_gt_i32 vcc, 1, v72
  s_nop 1
  v_cndmask_b32 v71, v61, v70, vcc
  v_max_f32 v67, v67, v71
  v_cmp_gt_i32 vcc, 2, v72
  s_nop 1
  v_cndmask_b32 v71, v62, v70, vcc
  v_max_f32 v67, v67, v71
  v_cmp_gt_i32 vcc, 3, v72
  s_nop 1
  v_cndmask_b32 v71, v63, v70, vcc
  v_max_f32 v67, v67, v71
  ds_read_b128 a[80:83], v1 offset:4096
  ds_read_b128 a[84:87], v1 offset:5120
  ds_read_b128 a[88:91], v1 offset:6144
  ds_read_b128 a[92:95], v1 offset:7168
  v_subrev_u32 v69, s37, v68
  v_add_u32 v69, s53, v69
  s_waitcnt lgkmcnt(3)
  v_mfma_f32_16x16x32_bf16 v[48:51], a[80:83], a[0:3], 0
  s_waitcnt lgkmcnt(2)
  v_mfma_f32_16x16x32_bf16 v[48:51], a[84:87], a[16:19], v[48:51]
  s_waitcnt lgkmcnt(1)
  v_mfma_f32_16x16x32_bf16 v[48:51], a[88:91], a[32:35], v[48:51]
  s_waitcnt lgkmcnt(0)
  v_mfma_f32_16x16x32_bf16 v[48:51], a[92:95], a[48:51], v[48:51]
  v_mfma_f32_16x16x32_bf16 v[52:55], a[80:83], a[4:7], 0
  v_mfma_f32_16x16x32_bf16 v[52:55], a[84:87], a[20:23], v[52:55]
  v_mfma_f32_16x16x32_bf16 v[52:55], a[88:91], a[36:39], v[52:55]
  v_mfma_f32_16x16x32_bf16 v[52:55], a[92:95], a[52:55], v[52:55]
  v_mfma_f32_16x16x32_bf16 v[56:59], a[80:83], a[8:11], 0
  v_mfma_f32_16x16x32_bf16 v[56:59], a[84:87], a[24:27], v[56:59]
  v_mfma_f32_16x16x32_bf16 v[56:59], a[88:91], a[40:43], v[56:59]
  v_mfma_f32_16x16x32_bf16 v[56:59], a[92:95], a[56:59], v[56:59]
  v_mfma_f32_16x16x32_bf16 v[60:63], a[80:83], a[12:15], 0
  v_mfma_f32_16x16x32_bf16 v[60:63], a[84:87], a[28:31], v[60:63]
  v_mfma_f32_16x16x32_bf16 v[60:63], a[88:91], a[44:47], v[60:63]
  v_mfma_f32_16x16x32_bf16 v[60:63], a[92:95], a[60:63], v[60:63]
  v_add_u32 v72, s4, v69
  v_cmp_gt_i32 vcc, 0, v72
  s_nop 1
  v_cndmask_b32 v71, v48, v70, vcc
  v_max_f32 v64, v64, v71
  v_cmp_gt_i32 vcc, 1, v72
  s_nop 1
  v_cndmask_b32 v71, v49, v70, vcc
  v_max_f32 v64, v64, v71
  v_cmp_gt_i32 vcc, 2, v72
  s_nop 1
  v_cndmask_b32 v71, v50, v70, vcc
  v_max_f32 v64, v64, v71
  v_cmp_gt_i32 vcc, 3, v72
  s_nop 1
  v_cndmask_b32 v71, v51, v70, vcc
  v_max_f32 v64, v64, v71
  v_add_u32 v72, s5, v69
  v_cmp_gt_i32 vcc, 0, v72
  s_nop 1
  v_cndmask_b32 v71, v52, v70, vcc
  v_max_f32 v65, v65, v71
  v_cmp_gt_i32 vcc, 1, v72
  s_nop 1
  v_cndmask_b32 v71, v53, v70, vcc
  v_max_f32 v65, v65, v71
  v_cmp_gt_i32 vcc, 2, v72
  s_nop 1
  v_cndmask_b32 v71, v54, v70, vcc
  v_max_f32 v65, v65, v71
  v_cmp_gt_i32 vcc, 3, v72
  s_nop 1
  v_cndmask_b32 v71, v55, v70, vcc
  v_max_f32 v65, v65, v71
  v_add_u32 v72, s6, v69
  v_cmp_gt_i32 vcc, 0, v72
  s_nop 1
  v_cndmask_b32 v71, v56, v70, vcc
  v_max_f32 v66, v66, v71
  v_cmp_gt_i32 vcc, 1, v72
  s_nop 1
  v_cndmask_b32 v71, v57, v70, vcc
  v_max_f32 v66, v66, v71
  v_cmp_gt_i32 vcc, 2, v72
  s_nop 1
  v_cndmask_b32 v71, v58, v70, vcc
  v_max_f32 v66, v66, v71
  v_cmp_gt_i32 vcc, 3, v72
  s_nop 1
  v_cndmask_b32 v71, v59, v70, vcc
  v_max_f32 v66, v66, v71
  v_add_u32 v72, s7, v69
  v_cmp_gt_i32 vcc, 0, v72
  s_nop 1
  v_cndmask_b32 v71, v60, v70, vcc
  v_max_f32 v67, v67, v71
  v_cmp_gt_i32 vcc, 1, v72
  s_nop 1
  v_cndmask_b32 v71, v61, v70, vcc
  v_max_f32 v67, v67, v71
  v_cmp_gt_i32 vcc, 2, v72
  s_nop 1
  v_cndmask_b32 v71, v62, v70, vcc
  v_max_f32 v67, v67, v71
  v_cmp_gt_i32 vcc, 3, v72
  s_nop 1
  v_cndmask_b32 v71, v63, v70, vcc
  v_max_f32 v67, v67, v71
  ds_read_b128 a[96:99], v1 offset:8192
  ds_read_b128 a[100:103], v1 offset:9216
  ds_read_b128 a[104:107], v1 offset:10240
  ds_read_b128 a[108:111], v1 offset:11264
  v_subrev_u32 v69, s38, v68
  v_add_u32 v69, s53, v69
  s_waitcnt lgkmcnt(3)
  v_mfma_f32_16x16x32_bf16 v[48:51], a[96:99], a[0:3], 0
  s_waitcnt lgkmcnt(2)
  v_mfma_f32_16x16x32_bf16 v[48:51], a[100:103], a[16:19], v[48:51]
  s_waitcnt lgkmcnt(1)
  v_mfma_f32_16x16x32_bf16 v[48:51], a[104:107], a[32:35], v[48:51]
  s_waitcnt lgkmcnt(0)
  v_mfma_f32_16x16x32_bf16 v[48:51], a[108:111], a[48:51], v[48:51]
  v_mfma_f32_16x16x32_bf16 v[52:55], a[96:99], a[4:7], 0
  v_mfma_f32_16x16x32_bf16 v[52:55], a[100:103], a[20:23], v[52:55]
  v_mfma_f32_16x16x32_bf16 v[52:55], a[104:107], a[36:39], v[52:55]
  v_mfma_f32_16x16x32_bf16 v[52:55], a[108:111], a[52:55], v[52:55]
  v_mfma_f32_16x16x32_bf16 v[56:59], a[96:99], a[8:11], 0
  v_mfma_f32_16x16x32_bf16 v[56:59], a[100:103], a[24:27], v[56:59]
  v_mfma_f32_16x16x32_bf16 v[56:59], a[104:107], a[40:43], v[56:59]
  v_mfma_f32_16x16x32_bf16 v[56:59], a[108:111], a[56:59], v[56:59]
  v_mfma_f32_16x16x32_bf16 v[60:63], a[96:99], a[12:15], 0
  v_mfma_f32_16x16x32_bf16 v[60:63], a[100:103], a[28:31], v[60:63]
  v_mfma_f32_16x16x32_bf16 v[60:63], a[104:107], a[44:47], v[60:63]
  v_mfma_f32_16x16x32_bf16 v[60:63], a[108:111], a[60:63], v[60:63]
  v_add_u32 v72, s4, v69
  v_cmp_gt_i32 vcc, 0, v72
  s_nop 1
  v_cndmask_b32 v71, v48, v70, vcc
  v_max_f32 v64, v64, v71
  v_cmp_gt_i32 vcc, 1, v72
  s_nop 1
  v_cndmask_b32 v71, v49, v70, vcc
  v_max_f32 v64, v64, v71
  v_cmp_gt_i32 vcc, 2, v72
  s_nop 1
  v_cndmask_b32 v71, v50, v70, vcc
  v_max_f32 v64, v64, v71
  v_cmp_gt_i32 vcc, 3, v72
  s_nop 1
  v_cndmask_b32 v71, v51, v70, vcc
  v_max_f32 v64, v64, v71
  v_add_u32 v72, s5, v69
  v_cmp_gt_i32 vcc, 0, v72
  s_nop 1
  v_cndmask_b32 v71, v52, v70, vcc
  v_max_f32 v65, v65, v71
  v_cmp_gt_i32 vcc, 1, v72
  s_nop 1
  v_cndmask_b32 v71, v53, v70, vcc
  v_max_f32 v65, v65, v71
  v_cmp_gt_i32 vcc, 2, v72
  s_nop 1
  v_cndmask_b32 v71, v54, v70, vcc
  v_max_f32 v65, v65, v71
  v_cmp_gt_i32 vcc, 3, v72
  s_nop 1
  v_cndmask_b32 v71, v55, v70, vcc
  v_max_f32 v65, v65, v71
  v_add_u32 v72, s6, v69
  v_cmp_gt_i32 vcc, 0, v72
  s_nop 1
  v_cndmask_b32 v71, v56, v70, vcc
  v_max_f32 v66, v66, v71
  v_cmp_gt_i32 vcc, 1, v72
  s_nop 1
  v_cndmask_b32 v71, v57, v70, vcc
  v_max_f32 v66, v66, v71
  v_cmp_gt_i32 vcc, 2, v72
  s_nop 1
  v_cndmask_b32 v71, v58, v70, vcc
  v_max_f32 v66, v66, v71
  v_cmp_gt_i32 vcc, 3, v72
  s_nop 1
  v_cndmask_b32 v71, v59, v70, vcc
  v_max_f32 v66, v66, v71
  v_add_u32 v72, s7, v69
  v_cmp_gt_i32 vcc, 0, v72
  s_nop 1
  v_cndmask_b32 v71, v60, v70, vcc
  v_max_f32 v67, v67, v71
  v_cmp_gt_i32 vcc, 1, v72
  s_nop 1
  v_cndmask_b32 v71, v61, v70, vcc
  v_max_f32 v67, v67, v71
  v_cmp_gt_i32 vcc, 2, v72
  s_nop 1
  v_cndmask_b32 v71, v62, v70, vcc
  v_max_f32 v67, v67, v71
  v_cmp_gt_i32 vcc, 3, v72
  s_nop 1
  v_cndmask_b32 v71, v63, v70, vcc
  v_max_f32 v67, v67, v71
  ds_read_b128 a[112:115], v1 offset:12288
  ds_read_b128 a[116:119], v1 offset:13312
  ds_read_b128 a[120:123], v1 offset:14336
  ds_read_b128 a[124:127], v1 offset:15360
  v_subrev_u32 v69, s39, v68
  v_add_u32 v69, s53, v69
  s_waitcnt lgkmcnt(3)
  v_mfma_f32_16x16x32_bf16 v[48:51], a[112:115], a[0:3], 0
  s_waitcnt lgkmcnt(2)
  v_mfma_f32_16x16x32_bf16 v[48:51], a[116:119], a[16:19], v[48:51]
  s_waitcnt lgkmcnt(1)
  v_mfma_f32_16x16x32_bf16 v[48:51], a[120:123], a[32:35], v[48:51]
  s_waitcnt lgkmcnt(0)
  v_mfma_f32_16x16x32_bf16 v[48:51], a[124:127], a[48:51], v[48:51]
  v_mfma_f32_16x16x32_bf16 v[52:55], a[112:115], a[4:7], 0
  v_mfma_f32_16x16x32_bf16 v[52:55], a[116:119], a[20:23], v[52:55]
  v_mfma_f32_16x16x32_bf16 v[52:55], a[120:123], a[36:39], v[52:55]
  v_mfma_f32_16x16x32_bf16 v[52:55], a[124:127], a[52:55], v[52:55]
  v_mfma_f32_16x16x32_bf16 v[56:59], a[112:115], a[8:11], 0
  v_mfma_f32_16x16x32_bf16 v[56:59], a[116:119], a[24:27], v[56:59]
  v_mfma_f32_16x16x32_bf16 v[56:59], a[120:123], a[40:43], v[56:59]
  v_mfma_f32_16x16x32_bf16 v[56:59], a[124:127], a[56:59], v[56:59]
  v_mfma_f32_16x16x32_bf16 v[60:63], a[112:115], a[12:15], 0
  v_mfma_f32_16x16x32_bf16 v[60:63], a[116:119], a[28:31], v[60:63]
  v_mfma_f32_16x16x32_bf16 v[60:63], a[120:123], a[44:47], v[60:63]
  v_mfma_f32_16x16x32_bf16 v[60:63], a[124:127], a[60:63], v[60:63]
  v_add_u32 v72, s4, v69
  v_cmp_gt_i32 vcc, 0, v72
  s_nop 1
  v_cndmask_b32 v71, v48, v70, vcc
  v_max_f32 v64, v64, v71
  v_cmp_gt_i32 vcc, 1, v72
  s_nop 1
  v_cndmask_b32 v71, v49, v70, vcc
  v_max_f32 v64, v64, v71
  v_cmp_gt_i32 vcc, 2, v72
  s_nop 1
  v_cndmask_b32 v71, v50, v70, vcc
  v_max_f32 v64, v64, v71
  v_cmp_gt_i32 vcc, 3, v72
  s_nop 1
  v_cndmask_b32 v71, v51, v70, vcc
  v_max_f32 v64, v64, v71
  v_add_u32 v72, s5, v69
  v_cmp_gt_i32 vcc, 0, v72
  s_nop 1
  v_cndmask_b32 v71, v52, v70, vcc
  v_max_f32 v65, v65, v71
  v_cmp_gt_i32 vcc, 1, v72
  s_nop 1
  v_cndmask_b32 v71, v53, v70, vcc
  v_max_f32 v65, v65, v71
  v_cmp_gt_i32 vcc, 2, v72
  s_nop 1
  v_cndmask_b32 v71, v54, v70, vcc
  v_max_f32 v65, v65, v71
  v_cmp_gt_i32 vcc, 3, v72
  s_nop 1
  v_cndmask_b32 v71, v55, v70, vcc
  v_max_f32 v65, v65, v71
  v_add_u32 v72, s6, v69
  v_cmp_gt_i32 vcc, 0, v72
  s_nop 1
  v_cndmask_b32 v71, v56, v70, vcc
  v_max_f32 v66, v66, v71
  v_cmp_gt_i32 vcc, 1, v72
  s_nop 1
  v_cndmask_b32 v71, v57, v70, vcc
  v_max_f32 v66, v66, v71
  v_cmp_gt_i32 vcc, 2, v72
  s_nop 1
  v_cndmask_b32 v71, v58, v70, vcc
  v_max_f32 v66, v66, v71
  v_cmp_gt_i32 vcc, 3, v72
  s_nop 1
  v_cndmask_b32 v71, v59, v70, vcc
  v_max_f32 v66, v66, v71
  v_add_u32 v72, s7, v69
  v_cmp_gt_i32 vcc, 0, v72
  s_nop 1
  v_cndmask_b32 v71, v60, v70, vcc
  v_max_f32 v67, v67, v71
  v_cmp_gt_i32 vcc, 1, v72
  s_nop 1
  v_cndmask_b32 v71, v61, v70, vcc
  v_max_f32 v67, v67, v71
  v_cmp_gt_i32 vcc, 2, v72
  s_nop 1
  v_cndmask_b32 v71, v62, v70, vcc
  v_max_f32 v67, v67, v71
  v_cmp_gt_i32 vcc, 3, v72
  s_nop 1
  v_cndmask_b32 v71, v63, v70, vcc
  v_max_f32 v67, v67, v71
  s_waitcnt lgkmcnt(0)
  s_add_u32 s61, s61, 1
  s_cmp_le_u32 s61, s58
  s_cbranch_scc1 L_mx
  v_mov_b32 v68, v64
  s_nop 1
  v_permlane16_swap_b32 v64, v68
  v_max_f32 v64, v64, v68
  v_mov_b32 v68, v64
  s_nop 1
  v_permlane32_swap_b32 v64, v68
  v_max_f32 v64, v64, v68
  v_mov_b32 v68, v65
  s_nop 1
  v_permlane16_swap_b32 v65, v68
  v_max_f32 v65, v65, v68
  v_mov_b32 v68, v65
  s_nop 1
  v_permlane32_swap_b32 v65, v68
  v_max_f32 v65, v65, v68
  v_mov_b32 v68, v66
  s_nop 1
  v_permlane16_swap_b32 v66, v68
  v_max_f32 v66, v66, v68
  v_mov_b32 v68, v66
  s_nop 1
  v_permlane32_swap_b32 v66, v68
  v_max_f32 v66, v66, v68
  v_mov_b32 v68, v67
  s_nop 1
  v_permlane16_swap_b32 v67, v68
  v_max_f32 v67, v67, v68
  v_mov_b32 v68, v67
  s_nop 1
  v_permlane32_swap_b32 v67, v68
  v_max_f32 v67, v67, v68
  s_lshl_b32 s53, s48, 10
  v_add_u32 v19, s53, v18
  ds_write_b128 v19, v[64:67]
  v_xor_b32 v19, 0x800, v19
  s_waitcnt lgkmcnt(0)
  s_barrier
  ds_read_b128 v[68:71], v19
  s_waitcnt lgkmcnt(0)
  v_max_f32 v64, v64, v70
  v_sub_f32 v32, 0, v64
  v_sub_f32 v33, 0, v64
  v_sub_f32 v34, 0, v64
  v_sub_f32 v35, 0, v64
  v_max_f32 v65, v65, v71
  v_sub_f32 v36, 0, v65
  v_sub_f32 v37, 0, v65
  v_sub_f32 v38, 0, v65
  v_sub_f32 v39, 0, v65
  v_max_f32 v66, v66, v68
  v_sub_f32 v40, 0, v66
  v_sub_f32 v41, 0, v66
  v_sub_f32 v42, 0, v66
  v_sub_f32 v43, 0, v66
  v_max_f32 v67, v67, v69
  v_sub_f32 v44, 0, v67
  v_sub_f32 v45, 0, v67
  v_sub_f32 v46, 0, v67
  v_sub_f32 v47, 0, v67
  s_barrier
  s_lshl_b32 s66, s57, 15
  s_add_u32 s66, s66, s64
  s_add_u32 m0, s56, 32768
  s_nop 0
  buffer_load_dwordx4 v5, s[28:31], s66 offen offset:0 sc1 lds
  buffer_load_dwordx4 v5, s[28:31], s66 offen offset:1024 sc1 lds
  buffer_load_dwordx4 v5, s[28:31], s66 offen offset:2048 sc1 lds
  buffer_load_dwordx4 v5, s[28:31], s66 offen offset:3072 sc1 lds
  s_add_u32 m0, s56, 36864
  s_add_u32 s66, s66, 4096
  buffer_load_dwordx4 v5, s[28:31], s66 offen offset:0 sc1 lds
  buffer_load_dwordx4 v5, s[28:31], s66 offen offset:1024 sc1 lds
  buffer_load_dwordx4 v5, s[28:31], s66 offen offset:2048 sc1 lds
  buffer_load_dwordx4 v5, s[28:31], s66 offen offset:3072 sc1 lds
  s_lshl_b32 s67, s58, 15
  s_add_u32 s67, s67, s65
  s_add_u32 m0, s56, 98304
  s_nop 0
  buffer_load_dwordx4 v5, s[28:31], s67 offen offset:0 sc1 lds
  buffer_load_dwordx4 v5, s[28:31], s67 offen offset:1024 sc1 lds
  buffer_load_dwordx4 v5, s[28:31], s67 offen offset:2048 sc1 lds
  buffer_load_dwordx4 v5, s[28:31], s67 offen offset:3072 sc1 lds
  s_add_u32 m0, s56, 102400
  s_add_u32 s67, s67, 4096
  buffer_load_dwordx4 v5, s[28:31], s67 offen offset:0 sc1 lds
  buffer_load_dwordx4 v5, s[28:31], s67 offen offset:1024 sc1 lds
  buffer_load_dwordx4 v5, s[28:31], s67 offen offset:2048 sc1 lds
  buffer_load_dwordx4 v5, s[28:31], s67 offen offset:3072 sc1 lds
  ds_read_b128 a[64:67], v1 offset:0
  ds_read_b128 a[68:71], v1 offset:1024
  ds_read_b128 a[72:75], v1 offset:2048
  ds_read_b128 a[76:79], v1 offset:3072
  s_waitcnt vmcnt(0) lgkmcnt(0)
  s_branch L_retry
code_end:
.section .rodata,"a"
.p2align 6
.amdhsa_kernel adaLN_cond__compressed_kv_cla__mixer_gmlp__prompt_kernel
  .amdhsa_next_free_vgpr 512
  .amdhsa_next_free_sgpr 102
  .amdhsa_accum_offset 256
  .amdhsa_group_segment_fixed_size 0
  .amdhsa_kernarg_size 128
  .amdhsa_user_sgpr_count 2
  .amdhsa_user_sgpr_kernarg_segment_ptr 1
  .amdhsa_system_sgpr_workgroup_id_x 1
  .amdhsa_float_denorm_mode_32 3
.end_amdhsa_kernel
```
